```python
import torch

def _softmax(x, axis=-1):
    return torch.softmax(x, dim=axis)
def _gelu(x):
    return torch.nn.functional.gelu(x, approximate="tanh")
def _silu(x):
    return torch.nn.functional.silu(x)
def _sigmoid(x):
    return torch.sigmoid(x)
def _layernorm(x, axis=-1, eps=1e-5):
    m = x.mean(dim=axis, keepdim=True)
    v = x.var(dim=axis, keepdim=True, unbiased=False)
    return (x - m) / torch.sqrt(v + eps)
def _scatter_add(tgt, idx, src, axis=0):
    return tgt.clone().index_add_(axis, idx, src)
def _segment_sum(src, seg, n):
    out = torch.zeros((n,) + src.shape[1:], dtype=src.dtype)
    return out.index_add_(0, seg, src)
def _pad(x, pw):
    flat = tuple(v for pair in reversed(pw) for v in pair)
    return torch.nn.functional.pad(x, flat)

kernel_name = 'concat_heads__mha_block_cached__mha_block_cached__near_ridge'

def setup_inputs():

    _w = (lambda a: (lambda t: t.to(torch.bfloat16) if t.is_floating_point() else t)(torch.as_tensor(a)))
    def _A_setup():
        B, Sq, D = 8, 288, 448
        H, Sk, Dh = 16, 1024, 256
        return {
            "x": _w((lambda *s: torch.randn(*s, dtype=torch.bfloat16) * 0.8)(B, Sq, D)),
            "k_cache": _w((lambda *s: torch.randn(*s, dtype=torch.bfloat16) * 0.8)(B, H, Sk, Dh)),
            "v_cache": _w((lambda *s: torch.randn(*s, dtype=torch.bfloat16) * 0.05)(B, H, Sk, Dh)),
            "wq": _w((lambda *s: torch.randn(*s, dtype=torch.bfloat16) * 0.8)(D, H * Dh) * (D ** -0.5)),
            "wo": _w((lambda *s: torch.randn(*s, dtype=torch.bfloat16) * 0.05)(H * Dh, D) * ((H * Dh) ** -0.5)),
        }
    _A_in = _A_setup()

    def _B_setup():
        B, Sq, D = 8, 288, 448
        H, Sk, Dh = 16, 1024, 256
        return {
            "x": _w((lambda *s: torch.randn(*s, dtype=torch.bfloat16) * 0.8)(B, Sq, D)),
            "k_cache": _w((lambda *s: torch.randn(*s, dtype=torch.bfloat16) * 0.8)(B, H, Sk, Dh)),
            "v_cache": _w((lambda *s: torch.randn(*s, dtype=torch.bfloat16) * 0.05)(B, H, Sk, Dh)),
            "wq": _w((lambda *s: torch.randn(*s, dtype=torch.bfloat16) * 0.8)(D, H * Dh) * (D ** -0.5)),
            "wo": _w((lambda *s: torch.randn(*s, dtype=torch.bfloat16) * 0.05)(H * Dh, D) * ((H * Dh) ** -0.5)),
        }
    _B_in = _B_setup()

    return {
        "A_x": _A_in["x"],
        "A_k_cache": _A_in["k_cache"],
        "A_v_cache": _A_in["v_cache"],
        "A_wq": _A_in["wq"],
        "A_wo": _A_in["wo"],
        "B_x": _B_in["x"],
        "B_k_cache": _B_in["k_cache"],
        "B_v_cache": _B_in["v_cache"],
        "B_wq": _B_in["wq"],
        "B_wo": _B_in["wo"],
    }

def reference(A_x, A_k_cache, A_v_cache, A_wq, A_wo, B_x, B_k_cache, B_v_cache, B_wq, B_wo):
    def _A_ref(x, k_cache, v_cache, wq, wo):
        B, Sq, D = x.shape
        H, Dh = 16, 256
        q = (lambda x, *d: x.permute(*d))((x @ wq).reshape(B, Sq, H, Dh), 0, 2, 1, 3)
        scores = torch.einsum("bhqd,bhkd->bhqk", q, k_cache) * (Dh ** -0.5)
        p = _softmax(scores, axis=-1)
        o = torch.einsum("bhqk,bhkd->bhqd", p, v_cache)
        return (lambda x, *d: x.permute(*d))(o, 0, 2, 1, 3).reshape(B, Sq, H * Dh) @ wo

    def _B_ref(x, k_cache, v_cache, wq, wo):
        B, Sq, D = x.shape
        H, Dh = 16, 256
        q = (lambda x, *d: x.permute(*d))((x @ wq).reshape(B, Sq, H, Dh), 0, 2, 1, 3)
        scores = torch.einsum("bhqd,bhkd->bhqk", q, k_cache) * (Dh ** -0.5)
        p = _softmax(scores, axis=-1)
        o = torch.einsum("bhqk,bhkd->bhqd", p, v_cache)
        return (lambda x, *d: x.permute(*d))(o, 0, 2, 1, 3).reshape(B, Sq, H * Dh) @ wo

    a = _A_ref(A_x, A_k_cache, A_v_cache, A_wq, A_wo)
    b = _B_ref(B_x, B_k_cache, B_v_cache, B_wq, B_wo)
    return torch.concatenate([a, b], axis=-1)
```

```asm
; @launch kernel=attn_kernel grid=(256,1,1) block=(256,1,1) lds=163840
.amdgcn_target "amdgcn-amd-amdhsa--gfx950"
.text
.globl attn_kernel
.p2align 8
.type attn_kernel,@function
attn_kernel:
  s_cmp_lt_u32 s2, 256
  s_cbranch_scc1 K1_GO
  s_endpgm
K1_GO:
  s_mov_b32 s54, 0
  v_lshrrev_b32 v1, 6, v0
  s_nop 0
  v_readfirstlane_b32 s28, v1
  s_nop 3
  s_getpc_b64 s[4:5]
K1_PC0:
  s_sub_u32 s4, s4, K1_PC0-attn_kernel
  s_subb_u32 s5, s5, 0
  s_mov_b32 s6, K1_CODE_END-attn_kernel
  s_mov_b32 s7, 0x20000
  s_lshr_b32 s3, s2, 3
  s_lshl_b32 s3, s3, 2
  s_add_u32 s3, s3, s28
  s_lshl_b32 s3, s3, 11
  v_mbcnt_lo_u32_b32 v1, -1, 0
  v_lshlrev_b32 v1, 7, v1
  s_mov_b64 exec, 0xffff
  buffer_load_dword v0, v1, s[4:7], s3 offen
  s_mov_b64 exec, -1
K1_RESTART:
  s_and_b32 s3, s2, 7
  s_lshr_b32 s4, s2, 3
  s_lshr_b32 s47, s3, 2
  s_mul_i32 s5, s47, 40
  s_add_u32 s6, s0, s5
  s_addc_u32 s7, s1, 0
  s_load_dwordx8 s[56:63], s[6:7], 0
  s_load_dwordx2 s[64:65], s[0:1], 96
  s_load_dwordx2 s[66:67], s[0:1], 32
  s_load_dwordx2 s[68:69], s[0:1], 72
  s_bfe_u32 s5, s3, 0x10001
  s_lshl_b32 s5, s5, 2
  s_and_b32 s6, s4, 3
  s_add_u32 s48, s5, s6
  s_and_b32 s5, s3, 1
  s_lshl_b32 s5, s5, 3
  s_lshr_b32 s6, s4, 2
  s_add_u32 s49, s5, s6
  v_mbcnt_lo_u32_b32 v16, -1, 0
  v_mbcnt_hi_u32_b32 v16, -1, v16
  v_and_b32 v17, 15, v16
  v_lshrrev_b32 v18, 4, v16
  v_bfe_u32 v19, v16, 2, 2
  v_and_b32 v20, 3, v16
  v_lshrrev_b32 v21, 3, v16
  v_and_b32 v22, 7, v16
  v_bfe_u32 v23, v21, 1, 1
  v_and_b32 v24, 4, v21
  v_or_b32 v23, v23, v24
  v_xor_b32 v23, v23, v22
  v_lshlrev_b32 v23, 4, v23
  v_lshlrev_b32 v24, 9, v21
  v_add_u32 v7, v24, v23
  v_and_b32 v23, 6, v21
  v_xor_b32 v23, v23, v22
  v_lshlrev_b32 v23, 4, v23
  v_add_u32 v8, v24, v23
  v_and_b32 v23, 2, v21
  v_xor_b32 v23, v23, v22
  v_lshlrev_b32 v23, 4, v23
  v_lshlrev_b32 v24, 13, v21
  v_add_u32 v10, v24, v23
  v_xor_b32 v11, 64, v10
  v_mul_u32_u24 v23, 896, v17
  v_lshlrev_b32 v24, 4, v18
  v_add_u32 v12, v23, v24
  s_waitcnt lgkmcnt(0)
  s_lshl_b32 s3, s49, 9
  s_add_u32 s16, s62, s3
  s_addc_u32 s17, s63, 0
  s_sub_u32 s18, 3670016, s3
  s_mov_b32 s19, 0x20000
  s_lshl_b32 s50, s28, 7
  s_lshl_b32 s35, s28, 13
  s_add_u32 m0, s35, 0
  s_add_u32 s34, s50, 0
  buffer_load_dwordx4 v10, s[16:19], s34 offen lds
  s_add_u32 m0, s35, 1024
  s_add_u32 s34, s50, 65536
  buffer_load_dwordx4 v11, s[16:19], s34 offen lds
  s_add_u32 m0, s35, 2048
  s_add_u32 s34, s50, 131072
  buffer_load_dwordx4 v10, s[16:19], s34 offen lds
  s_add_u32 m0, s35, 3072
  s_add_u32 s34, s50, 196608
  buffer_load_dwordx4 v11, s[16:19], s34 offen lds
  s_add_u32 m0, s35, 4096
  s_add_u32 s34, s50, 262144
  buffer_load_dwordx4 v10, s[16:19], s34 offen lds
  s_add_u32 m0, s35, 5120
  s_add_u32 s34, s50, 327680
  buffer_load_dwordx4 v11, s[16:19], s34 offen lds
  s_add_u32 m0, s35, 6144
  s_add_u32 s34, s50, 393216
  buffer_load_dwordx4 v10, s[16:19], s34 offen lds
  s_add_u32 m0, s35, 7168
  s_add_u32 s34, s50, 458752
  buffer_load_dwordx4 v11, s[16:19], s34 offen lds
  s_mul_i32 s3, s48, 258048
  s_add_u32 s20, s56, s3
  s_addc_u32 s21, s57, 0
  s_mov_b32 s22, 258048
  s_mov_b32 s23, 0x20000
  s_mul_i32 s3, s28, 57344
  s_add_u32 s36, s3, 0
  s_add_u32 s37, s3, 14336
  s_add_u32 s38, s3, 28672
  s_add_u32 s39, s3, 43008
  s_lshr_b32 s3, s28, 1
  s_mul_i32 s3, s3, 14336
  s_add_u32 s40, s3, 229376
  buffer_load_dwordx4 v[128:131], v12, s[20:23], s36 offen offset:0
  buffer_load_dwordx4 v[132:135], v12, s[20:23], s36 offen offset:64
  buffer_load_dwordx4 v[136:139], v12, s[20:23], s37 offen offset:0
  buffer_load_dwordx4 v[140:143], v12, s[20:23], s37 offen offset:64
  buffer_load_dwordx4 v[144:147], v12, s[20:23], s38 offen offset:0
  buffer_load_dwordx4 v[148:151], v12, s[20:23], s38 offen offset:64
  buffer_load_dwordx4 v[152:155], v12, s[20:23], s39 offen offset:0
  buffer_load_dwordx4 v[156:159], v12, s[20:23], s39 offen offset:64
  buffer_load_dwordx4 v[160:163], v12, s[20:23], s40 offen offset:0
  buffer_load_dwordx4 v[164:167], v12, s[20:23], s40 offen offset:64
  s_add_u32 m0, s35, 32768
  s_add_u32 s34, s50, 524288
  buffer_load_dwordx4 v10, s[16:19], s34 offen lds
  s_add_u32 m0, s35, 33792
  s_add_u32 s34, s50, 589824
  buffer_load_dwordx4 v11, s[16:19], s34 offen lds
  s_add_u32 m0, s35, 34816
  s_add_u32 s34, s50, 655360
  buffer_load_dwordx4 v10, s[16:19], s34 offen lds
  s_add_u32 m0, s35, 35840
  s_add_u32 s34, s50, 720896
  buffer_load_dwordx4 v11, s[16:19], s34 offen lds
  s_add_u32 m0, s35, 36864
  s_add_u32 s34, s50, 786432
  buffer_load_dwordx4 v10, s[16:19], s34 offen lds
  s_add_u32 m0, s35, 37888
  s_add_u32 s34, s50, 851968
  buffer_load_dwordx4 v11, s[16:19], s34 offen lds
  s_add_u32 m0, s35, 38912
  s_add_u32 s34, s50, 917504
  buffer_load_dwordx4 v10, s[16:19], s34 offen lds
  s_add_u32 m0, s35, 39936
  s_add_u32 s34, s50, 983040
  buffer_load_dwordx4 v11, s[16:19], s34 offen lds
  buffer_load_dwordx4 v[168:171], v12, s[20:23], s36 offen offset:128
  buffer_load_dwordx4 v[172:175], v12, s[20:23], s36 offen offset:192
  buffer_load_dwordx4 v[176:179], v12, s[20:23], s37 offen offset:128
  buffer_load_dwordx4 v[180:183], v12, s[20:23], s37 offen offset:192
  buffer_load_dwordx4 v[184:187], v12, s[20:23], s38 offen offset:128
  buffer_load_dwordx4 v[188:191], v12, s[20:23], s38 offen offset:192
  buffer_load_dwordx4 v[192:195], v12, s[20:23], s39 offen offset:128
  buffer_load_dwordx4 v[196:199], v12, s[20:23], s39 offen offset:192
  buffer_load_dwordx4 v[200:203], v12, s[20:23], s40 offen offset:128
  buffer_load_dwordx4 v[204:207], v12, s[20:23], s40 offen offset:192
  s_add_u32 m0, s35, 65536
  s_add_u32 s34, s50, 1048576
  buffer_load_dwordx4 v10, s[16:19], s34 offen lds
  s_add_u32 m0, s35, 66560
  s_add_u32 s34, s50, 1114112
  buffer_load_dwordx4 v11, s[16:19], s34 offen lds
  s_add_u32 m0, s35, 67584
  s_add_u32 s34, s50, 1179648
  buffer_load_dwordx4 v10, s[16:19], s34 offen lds
  s_add_u32 m0, s35, 68608
  s_add_u32 s34, s50, 1245184
  buffer_load_dwordx4 v11, s[16:19], s34 offen lds
  s_add_u32 m0, s35, 69632
  s_add_u32 s34, s50, 1310720
  buffer_load_dwordx4 v10, s[16:19], s34 offen lds
  s_add_u32 m0, s35, 70656
  s_add_u32 s34, s50, 1376256
  buffer_load_dwordx4 v11, s[16:19], s34 offen lds
  s_add_u32 m0, s35, 71680
  s_add_u32 s34, s50, 1441792
  buffer_load_dwordx4 v10, s[16:19], s34 offen lds
  s_add_u32 m0, s35, 72704
  s_add_u32 s34, s50, 1507328
  buffer_load_dwordx4 v11, s[16:19], s34 offen lds
  s_lshl_b32 s3, s48, 4
  s_add_u32 s3, s3, s49
  s_lshl_b32 s3, s3, 19
  s_add_u32 s8, s58, s3
  s_addc_u32 s9, s59, 0
  s_mov_b32 s10, 524288
  s_mov_b32 s11, 0x20000
  s_add_u32 s12, s60, s3
  s_addc_u32 s13, s61, 0
  s_mov_b32 s14, 524288
  s_mov_b32 s15, 0x20000
  s_mov_b32 s24, s64
  s_mov_b32 s25, s65
  s_mov_b32 s26, 37748736
  s_mov_b32 s27, 0x20000
  s_mov_b32 s46, 1035512379
  s_lshl_b32 s30, s28, 7
  s_mov_b32 s31, s30
  s_lshl_b32 s33, s28, 13
  s_add_u32 s32, s33, 98304
  s_mul_i32 s3, s47, 144
  s_mul_i32 s4, s48, 18
  s_add_u32 s3, s3, s4
  s_lshl_b32 s4, s28, 2
  s_add_u32 s4, s4, s3
  s_lshr_b32 s5, s28, 1
  s_add_u32 s5, s5, s3
  s_add_u32 s5, s5, 16
  s_lshl_b32 s55, s49, 16
  s_add_u32 s6, s4, 0
  s_lshr_b32 s7, s6, 3
  s_lshl_b32 s7, s7, 20
  s_and_b32 s6, s6, 7
  s_lshl_b32 s6, s6, 12
  s_add_u32 s6, s6, s7
  s_add_u32 s41, s6, s55
  s_add_u32 s6, s4, 1
  s_lshr_b32 s7, s6, 3
  s_lshl_b32 s7, s7, 20
  s_and_b32 s6, s6, 7
  s_lshl_b32 s6, s6, 12
  s_add_u32 s6, s6, s7
  s_add_u32 s42, s6, s55
  s_add_u32 s6, s4, 2
  s_lshr_b32 s7, s6, 3
  s_lshl_b32 s7, s7, 20
  s_and_b32 s6, s6, 7
  s_lshl_b32 s6, s6, 12
  s_add_u32 s6, s6, s7
  s_add_u32 s43, s6, s55
  s_add_u32 s6, s4, 3
  s_lshr_b32 s7, s6, 3
  s_lshl_b32 s7, s7, 20
  s_and_b32 s6, s6, 7
  s_lshl_b32 s6, s6, 12
  s_add_u32 s6, s6, s7
  s_add_u32 s44, s6, s55
  s_mov_b32 s6, s5
  s_lshr_b32 s7, s6, 3
  s_lshl_b32 s7, s7, 20
  s_and_b32 s6, s6, 7
  s_lshl_b32 s6, s6, 12
  s_add_u32 s6, s6, s7
  s_add_u32 s45, s6, s55
  v_lshrrev_b32 v23, 1, v19
  v_and_b32 v24, 1, v18
  v_lshlrev_b32 v24, 1, v24
  v_or_b32 v23, v23, v24
  v_lshlrev_b32 v24, 3, v18
  v_add_u32 v24, v24, v19
  v_lshlrev_b32 v24, 7, v24
  v_lshlrev_b32 v25, 3, v20
  v_add_u32 v24, v24, v25
  v_xor_b32 v25, 0, v23
  v_lshlrev_b32 v25, 5, v25
  v_add_u32 v3, v24, v25
  v_xor_b32 v25, 1, v23
  v_lshlrev_b32 v25, 5, v25
  v_add_u32 v4, v24, v25
  v_xor_b32 v25, 2, v23
  v_lshlrev_b32 v25, 5, v25
  v_add_u32 v5, v24, v25
  v_xor_b32 v25, 3, v23
  v_lshlrev_b32 v25, 5, v25
  v_add_u32 v6, v24, v25
  v_and_b32 v23, 1, v18
  v_lshlrev_b32 v23, 1, v23
  v_lshrrev_b32 v24, 1, v18
  v_or_b32 v23, v23, v24
  v_bfe_u32 v24, v17, 1, 1
  v_and_b32 v25, 4, v17
  v_or_b32 v24, v24, v25
  v_xor_b32 v23, v23, v24
  v_lshlrev_b32 v23, 4, v23
  v_lshlrev_b32 v24, 7, v17
  v_add_u32 v23, v23, v24
  v_add_u32 v1, 98304, v23
  v_xor_b32 v2, 64, v1
  s_lshr_b32 s3, s28, 1
  s_lshl_b32 s3, s3, 14
  s_add_u32 s3, s3, 131072
  v_lshlrev_b32 v9, 4, v16
  v_add_u32 v9, s3, v9
  s_and_b32 s3, s28, 1
  s_cmp_eq_u32 s3, 1
  s_cbranch_scc1 K1_PAR1
  s_waitcnt vmcnt(36)
  s_barrier
  ds_read_b64_tr_b16 v[40:41], v3 offset:16384
  ds_read_b64_tr_b16 v[42:43], v3 offset:16896
  ds_read_b64_tr_b16 v[44:45], v3 offset:20480
  ds_read_b64_tr_b16 v[46:47], v3 offset:20992
  ds_read_b64_tr_b16 v[48:49], v4 offset:16384
  ds_read_b64_tr_b16 v[50:51], v4 offset:16896
  ds_read_b64_tr_b16 v[52:53], v4 offset:20480
  ds_read_b64_tr_b16 v[54:55], v4 offset:20992
  ds_read_b64_tr_b16 v[56:57], v5 offset:16384
  ds_read_b64_tr_b16 v[58:59], v5 offset:16896
  ds_read_b64_tr_b16 v[60:61], v5 offset:20480
  ds_read_b64_tr_b16 v[62:63], v5 offset:20992
  s_waitcnt vmcnt(35) lgkmcnt(10)
  v_mfma_f32_16x16x32_bf16 a[32:35], v[40:43], v[128:131], 0
  s_waitcnt vmcnt(34) lgkmcnt(8)
  v_mfma_f32_16x16x32_bf16 a[32:35], v[44:47], v[132:135], a[32:35]
  s_add_u32 m0, s35, 98304
  s_add_u32 s34, s50, 1572864
  buffer_load_dwordx4 v10, s[16:19], s34 offen lds
  s_waitcnt vmcnt(34)
  v_mfma_f32_16x16x32_bf16 a[96:99], v[40:43], v[136:139], 0
  s_waitcnt vmcnt(33)
  v_mfma_f32_16x16x32_bf16 a[96:99], v[44:47], v[140:143], a[96:99]
  s_waitcnt vmcnt(32)
  v_mfma_f32_16x16x32_bf16 a[160:163], v[40:43], v[144:147], 0
  s_waitcnt vmcnt(31)
  v_mfma_f32_16x16x32_bf16 a[160:163], v[44:47], v[148:151], a[160:163]
  s_waitcnt vmcnt(30)
  v_mfma_f32_16x16x32_bf16 a[224:227], v[40:43], v[152:155], 0
  s_waitcnt vmcnt(29)
  v_mfma_f32_16x16x32_bf16 a[224:227], v[44:47], v[156:159], a[224:227]
  ds_read_b64_tr_b16 v[24:25], v6 offset:16384
  ds_read_b64_tr_b16 v[26:27], v6 offset:16896
  s_waitcnt lgkmcnt(8)
  v_mfma_f32_16x16x32_bf16 a[36:39], v[48:51], v[128:131], 0
  ds_read_b64_tr_b16 v[28:29], v6 offset:20480
  ds_read_b64_tr_b16 v[30:31], v6 offset:20992
  s_waitcnt lgkmcnt(8)
  v_mfma_f32_16x16x32_bf16 a[36:39], v[52:55], v[132:135], a[36:39]
  buffer_load_dwordx4 v[208:211], v12, s[20:23], s36 offen offset:256
  v_mfma_f32_16x16x32_bf16 a[100:103], v[48:51], v[136:139], 0
  v_mfma_f32_16x16x32_bf16 a[100:103], v[52:55], v[140:143], a[100:103]
  v_mfma_f32_16x16x32_bf16 a[164:167], v[48:51], v[144:147], 0
  v_mfma_f32_16x16x32_bf16 a[164:167], v[52:55], v[148:151], a[164:167]
  s_add_u32 m0, s35, 99328
  s_add_u32 s34, s50, 1638400
  buffer_load_dwordx4 v11, s[16:19], s34 offen lds
  v_mfma_f32_16x16x32_bf16 a[228:231], v[48:51], v[152:155], 0
  v_mfma_f32_16x16x32_bf16 a[228:231], v[52:55], v[156:159], a[228:231]
  ds_read_b64_tr_b16 v[32:33], v3 offset:24576
  ds_read_b64_tr_b16 v[34:35], v3 offset:25088
  s_waitcnt lgkmcnt(8)
  v_mfma_f32_16x16x32_bf16 a[40:43], v[56:59], v[128:131], 0
  ds_read_b64_tr_b16 v[36:37], v3 offset:28672
  ds_read_b64_tr_b16 v[38:39], v3 offset:29184
  s_waitcnt lgkmcnt(8)
  v_mfma_f32_16x16x32_bf16 a[40:43], v[60:63], v[132:135], a[40:43]
  v_mfma_f32_16x16x32_bf16 a[104:107], v[56:59], v[136:139], 0
  v_mfma_f32_16x16x32_bf16 a[104:107], v[60:63], v[140:143], a[104:107]
  v_mfma_f32_16x16x32_bf16 a[168:171], v[56:59], v[144:147], 0
  buffer_load_dwordx4 v[212:215], v12, s[20:23], s36 offen offset:320
  v_mfma_f32_16x16x32_bf16 a[168:171], v[60:63], v[148:151], a[168:171]
  v_mfma_f32_16x16x32_bf16 a[232:235], v[56:59], v[152:155], 0
  v_mfma_f32_16x16x32_bf16 a[232:235], v[60:63], v[156:159], a[232:235]
  ds_read_b64_tr_b16 v[48:49], v4 offset:24576
  ds_read_b64_tr_b16 v[50:51], v4 offset:25088
  s_waitcnt lgkmcnt(8)
  v_mfma_f32_16x16x32_bf16 a[44:47], v[24:27], v[128:131], 0
  ds_read_b64_tr_b16 v[52:53], v4 offset:28672
  ds_read_b64_tr_b16 v[54:55], v4 offset:29184
  s_waitcnt lgkmcnt(8)
  v_mfma_f32_16x16x32_bf16 a[44:47], v[28:31], v[132:135], a[44:47]
  s_add_u32 m0, s35, 100352
  s_add_u32 s34, s50, 1703936
  buffer_load_dwordx4 v10, s[16:19], s34 offen lds
  v_mfma_f32_16x16x32_bf16 a[108:111], v[24:27], v[136:139], 0
  v_mfma_f32_16x16x32_bf16 a[108:111], v[28:31], v[140:143], a[108:111]
  v_mfma_f32_16x16x32_bf16 a[172:175], v[24:27], v[144:147], 0
  v_mfma_f32_16x16x32_bf16 a[172:175], v[28:31], v[148:151], a[172:175]
  v_mfma_f32_16x16x32_bf16 a[236:239], v[24:27], v[152:155], 0
  v_mfma_f32_16x16x32_bf16 a[236:239], v[28:31], v[156:159], a[236:239]
  ds_read_b64_tr_b16 v[56:57], v5 offset:24576
  ds_read_b64_tr_b16 v[58:59], v5 offset:25088
  s_waitcnt lgkmcnt(8)
  v_mfma_f32_16x16x32_bf16 a[48:51], v[32:35], v[128:131], 0
  ds_read_b64_tr_b16 v[60:61], v5 offset:28672
  ds_read_b64_tr_b16 v[62:63], v5 offset:29184
  s_waitcnt lgkmcnt(8)
  v_mfma_f32_16x16x32_bf16 a[48:51], v[36:39], v[132:135], a[48:51]
  buffer_load_dwordx4 v[216:219], v12, s[20:23], s37 offen offset:256
  v_mfma_f32_16x16x32_bf16 a[112:115], v[32:35], v[136:139], 0
  v_mfma_f32_16x16x32_bf16 a[112:115], v[36:39], v[140:143], a[112:115]
  v_mfma_f32_16x16x32_bf16 a[176:179], v[32:35], v[144:147], 0
  v_mfma_f32_16x16x32_bf16 a[176:179], v[36:39], v[148:151], a[176:179]
  s_add_u32 m0, s35, 101376
  s_add_u32 s34, s50, 1769472
  buffer_load_dwordx4 v11, s[16:19], s34 offen lds
  v_mfma_f32_16x16x32_bf16 a[240:243], v[32:35], v[152:155], 0
  v_mfma_f32_16x16x32_bf16 a[240:243], v[36:39], v[156:159], a[240:243]
  ds_read_b64_tr_b16 v[40:41], v6 offset:24576
  ds_read_b64_tr_b16 v[42:43], v6 offset:25088
  s_waitcnt lgkmcnt(8)
  v_mfma_f32_16x16x32_bf16 a[52:55], v[48:51], v[128:131], 0
  ds_read_b64_tr_b16 v[44:45], v6 offset:28672
  ds_read_b64_tr_b16 v[46:47], v6 offset:29184
  s_waitcnt lgkmcnt(8)
  v_mfma_f32_16x16x32_bf16 a[52:55], v[52:55], v[132:135], a[52:55]
  v_mfma_f32_16x16x32_bf16 a[116:119], v[48:51], v[136:139], 0
  v_mfma_f32_16x16x32_bf16 a[116:119], v[52:55], v[140:143], a[116:119]
  v_mfma_f32_16x16x32_bf16 a[180:183], v[48:51], v[144:147], 0
  v_mfma_f32_16x16x32_bf16 a[180:183], v[52:55], v[148:151], a[180:183]
  v_mfma_f32_16x16x32_bf16 a[244:247], v[48:51], v[152:155], 0
  buffer_load_dwordx4 v[220:223], v12, s[20:23], s37 offen offset:320
  v_mfma_f32_16x16x32_bf16 a[244:247], v[52:55], v[156:159], a[244:247]
  ds_read_b64_tr_b16 v[24:25], v3 offset:0
  ds_read_b64_tr_b16 v[26:27], v3 offset:512
  s_waitcnt lgkmcnt(8)
  v_mfma_f32_16x16x32_bf16 a[56:59], v[56:59], v[128:131], 0
  ds_read_b64_tr_b16 v[28:29], v3 offset:4096
  ds_read_b64_tr_b16 v[30:31], v3 offset:4608
  s_waitcnt lgkmcnt(8)
  v_mfma_f32_16x16x32_bf16 a[56:59], v[60:63], v[132:135], a[56:59]
  s_add_u32 m0, s35, 102400
  s_add_u32 s34, s50, 1835008
  buffer_load_dwordx4 v10, s[16:19], s34 offen lds
  v_mfma_f32_16x16x32_bf16 a[120:123], v[56:59], v[136:139], 0
  v_mfma_f32_16x16x32_bf16 a[120:123], v[60:63], v[140:143], a[120:123]
  v_mfma_f32_16x16x32_bf16 a[184:187], v[56:59], v[144:147], 0
  v_mfma_f32_16x16x32_bf16 a[184:187], v[60:63], v[148:151], a[184:187]
  v_mfma_f32_16x16x32_bf16 a[248:251], v[56:59], v[152:155], 0
  v_mfma_f32_16x16x32_bf16 a[248:251], v[60:63], v[156:159], a[248:251]
  ds_read_b64_tr_b16 v[48:49], v4 offset:0
  ds_read_b64_tr_b16 v[50:51], v4 offset:512
  s_waitcnt lgkmcnt(8)
  v_mfma_f32_16x16x32_bf16 a[60:63], v[40:43], v[128:131], 0
  ds_read_b64_tr_b16 v[52:53], v4 offset:4096
  ds_read_b64_tr_b16 v[54:55], v4 offset:4608
  s_waitcnt lgkmcnt(8)
  v_mfma_f32_16x16x32_bf16 a[60:63], v[44:47], v[132:135], a[60:63]
  v_mfma_f32_16x16x32_bf16 a[124:127], v[40:43], v[136:139], 0
  v_mfma_f32_16x16x32_bf16 a[124:127], v[44:47], v[140:143], a[124:127]
  buffer_load_dwordx4 v[224:227], v12, s[20:23], s38 offen offset:256
  v_mfma_f32_16x16x32_bf16 a[188:191], v[40:43], v[144:147], 0
  v_mfma_f32_16x16x32_bf16 a[188:191], v[44:47], v[148:151], a[188:191]
  s_add_u32 m0, s35, 103424
  s_add_u32 s34, s50, 1900544
  buffer_load_dwordx4 v11, s[16:19], s34 offen lds
  v_mfma_f32_16x16x32_bf16 a[252:255], v[40:43], v[152:155], 0
  v_mfma_f32_16x16x32_bf16 a[252:255], v[44:47], v[156:159], a[252:255]
  ds_read_b64_tr_b16 v[56:57], v5 offset:0
  ds_read_b64_tr_b16 v[58:59], v5 offset:512
  s_waitcnt lgkmcnt(8)
  v_mfma_f32_16x16x32_bf16 a[0:3], v[24:27], v[128:131], 0
  ds_read_b64_tr_b16 v[60:61], v5 offset:4096
  ds_read_b64_tr_b16 v[62:63], v5 offset:4608
  s_waitcnt lgkmcnt(8)
  v_mfma_f32_16x16x32_bf16 a[0:3], v[28:31], v[132:135], a[0:3]
  v_mfma_f32_16x16x32_bf16 a[64:67], v[24:27], v[136:139], 0
  v_mfma_f32_16x16x32_bf16 a[64:67], v[28:31], v[140:143], a[64:67]
  v_mfma_f32_16x16x32_bf16 a[128:131], v[24:27], v[144:147], 0
  v_mfma_f32_16x16x32_bf16 a[128:131], v[28:31], v[148:151], a[128:131]
  v_mfma_f32_16x16x32_bf16 a[192:195], v[24:27], v[152:155], 0
  v_mfma_f32_16x16x32_bf16 a[192:195], v[28:31], v[156:159], a[192:195]
  s_waitcnt vmcnt(38)
  v_mfma_f32_16x16x32_bf16 v[96:99], v[24:27], v[160:163], 0
  buffer_load_dwordx4 v[228:231], v12, s[20:23], s38 offen offset:320
  s_waitcnt vmcnt(38)
  v_mfma_f32_16x16x32_bf16 v[96:99], v[28:31], v[164:167], v[96:99]
  s_add_u32 m0, s35, 104448
  s_add_u32 s34, s50, 1966080
  buffer_load_dwordx4 v10, s[16:19], s34 offen lds
  s_waitcnt lgkmcnt(6)
  v_mfma_f32_16x16x32_bf16 a[4:7], v[48:51], v[128:131], 0
  ds_read_b64_tr_b16 v[32:33], v6 offset:0
  ds_read_b64_tr_b16 v[34:35], v6 offset:512
  s_waitcnt lgkmcnt(6)
  v_mfma_f32_16x16x32_bf16 a[4:7], v[52:55], v[132:135], a[4:7]
  ds_read_b64_tr_b16 v[36:37], v6 offset:4096
  ds_read_b64_tr_b16 v[38:39], v6 offset:4608
  v_mfma_f32_16x16x32_bf16 a[68:71], v[48:51], v[136:139], 0
  v_mfma_f32_16x16x32_bf16 a[68:71], v[52:55], v[140:143], a[68:71]
  v_mfma_f32_16x16x32_bf16 a[132:135], v[48:51], v[144:147], 0
  v_mfma_f32_16x16x32_bf16 a[132:135], v[52:55], v[148:151], a[132:135]
  v_mfma_f32_16x16x32_bf16 a[196:199], v[48:51], v[152:155], 0
  v_mfma_f32_16x16x32_bf16 a[196:199], v[52:55], v[156:159], a[196:199]
  v_mfma_f32_16x16x32_bf16 v[100:103], v[48:51], v[160:163], 0
  v_mfma_f32_16x16x32_bf16 v[100:103], v[52:55], v[164:167], v[100:103]
  ds_read_b64_tr_b16 v[40:41], v3 offset:8192
  ds_read_b64_tr_b16 v[42:43], v3 offset:8704
  s_waitcnt lgkmcnt(8)
  v_mfma_f32_16x16x32_bf16 a[8:11], v[56:59], v[128:131], 0
  ds_read_b64_tr_b16 v[44:45], v3 offset:12288
  ds_read_b64_tr_b16 v[46:47], v3 offset:12800
  s_waitcnt lgkmcnt(8)
  v_mfma_f32_16x16x32_bf16 a[8:11], v[60:63], v[132:135], a[8:11]
  s_add_u32 m0, s35, 105472
  s_add_u32 s34, s50, 2031616
  buffer_load_dwordx4 v11, s[16:19], s34 offen lds
  v_mfma_f32_16x16x32_bf16 a[72:75], v[56:59], v[136:139], 0
  buffer_load_dwordx4 v[232:235], v12, s[20:23], s39 offen offset:256
  v_mfma_f32_16x16x32_bf16 a[72:75], v[60:63], v[140:143], a[72:75]
  v_mfma_f32_16x16x32_bf16 a[136:139], v[56:59], v[144:147], 0
  v_mfma_f32_16x16x32_bf16 a[136:139], v[60:63], v[148:151], a[136:139]
  v_mfma_f32_16x16x32_bf16 a[200:203], v[56:59], v[152:155], 0
  v_mfma_f32_16x16x32_bf16 a[200:203], v[60:63], v[156:159], a[200:203]
  v_mfma_f32_16x16x32_bf16 v[104:107], v[56:59], v[160:163], 0
  v_mfma_f32_16x16x32_bf16 v[104:107], v[60:63], v[164:167], v[104:107]
  ds_read_b64_tr_b16 v[48:49], v4 offset:8192
  ds_read_b64_tr_b16 v[50:51], v4 offset:8704
  s_waitcnt lgkmcnt(8)
  v_mfma_f32_16x16x32_bf16 a[12:15], v[32:35], v[128:131], 0
  s_waitcnt vmcnt(33)
  s_barrier
  ds_read_b64_tr_b16 v[52:53], v4 offset:12288
  s_waitcnt lgkmcnt(7)
  v_mfma_f32_16x16x32_bf16 a[12:15], v[36:39], v[132:135], a[12:15]
  ds_read_b64_tr_b16 v[54:55], v4 offset:12800
  v_mfma_f32_16x16x32_bf16 a[76:79], v[32:35], v[136:139], 0
  v_mfma_f32_16x16x32_bf16 a[76:79], v[36:39], v[140:143], a[76:79]
  v_mfma_f32_16x16x32_bf16 a[140:143], v[32:35], v[144:147], 0
  buffer_load_dwordx4 v[236:239], v12, s[20:23], s39 offen offset:320
  v_mfma_f32_16x16x32_bf16 a[140:143], v[36:39], v[148:151], a[140:143]
  v_mfma_f32_16x16x32_bf16 a[204:207], v[32:35], v[152:155], 0
  v_mfma_f32_16x16x32_bf16 a[204:207], v[36:39], v[156:159], a[204:207]
  v_mfma_f32_16x16x32_bf16 v[108:111], v[32:35], v[160:163], 0
  v_mfma_f32_16x16x32_bf16 v[108:111], v[36:39], v[164:167], v[108:111]
  ds_read_b64_tr_b16 v[56:57], v5 offset:8192
  ds_read_b64_tr_b16 v[58:59], v5 offset:8704
  s_waitcnt lgkmcnt(8)
  v_mfma_f32_16x16x32_bf16 a[16:19], v[40:43], v[128:131], 0
  ds_read_b64_tr_b16 v[60:61], v5 offset:12288
  ds_read_b64_tr_b16 v[62:63], v5 offset:12800
  s_waitcnt lgkmcnt(8)
  v_mfma_f32_16x16x32_bf16 a[16:19], v[44:47], v[132:135], a[16:19]
  v_mfma_f32_16x16x32_bf16 a[80:83], v[40:43], v[136:139], 0
  v_mfma_f32_16x16x32_bf16 a[80:83], v[44:47], v[140:143], a[80:83]
  v_mfma_f32_16x16x32_bf16 a[144:147], v[40:43], v[144:147], 0
  v_mfma_f32_16x16x32_bf16 a[144:147], v[44:47], v[148:151], a[144:147]
  v_mfma_f32_16x16x32_bf16 a[208:211], v[40:43], v[152:155], 0
  v_mfma_f32_16x16x32_bf16 a[208:211], v[44:47], v[156:159], a[208:211]
  buffer_load_dwordx4 v[240:243], v12, s[20:23], s40 offen offset:256
  v_mfma_f32_16x16x32_bf16 v[112:115], v[40:43], v[160:163], 0
  v_mfma_f32_16x16x32_bf16 v[112:115], v[44:47], v[164:167], v[112:115]
  ds_read_b64_tr_b16 v[24:25], v6 offset:8192
  ds_read_b64_tr_b16 v[26:27], v6 offset:8704
  s_waitcnt lgkmcnt(8)
  v_mfma_f32_16x16x32_bf16 a[20:23], v[48:51], v[128:131], 0
  ds_read_b64_tr_b16 v[28:29], v6 offset:12288
  ds_read_b64_tr_b16 v[30:31], v6 offset:12800
  s_waitcnt lgkmcnt(8)
  v_mfma_f32_16x16x32_bf16 a[20:23], v[52:55], v[132:135], a[20:23]
  ds_read_b64_tr_b16 v[40:41], v3 offset:49152
  ds_read_b64_tr_b16 v[42:43], v3 offset:49664
  v_mfma_f32_16x16x32_bf16 a[84:87], v[48:51], v[136:139], 0
  ds_read_b64_tr_b16 v[44:45], v3 offset:53248
  ds_read_b64_tr_b16 v[46:47], v3 offset:53760
  v_mfma_f32_16x16x32_bf16 a[84:87], v[52:55], v[140:143], a[84:87]
  v_mfma_f32_16x16x32_bf16 a[148:151], v[48:51], v[144:147], 0
  v_mfma_f32_16x16x32_bf16 a[148:151], v[52:55], v[148:151], a[148:151]
  v_mfma_f32_16x16x32_bf16 a[212:215], v[48:51], v[152:155], 0
  v_mfma_f32_16x16x32_bf16 a[212:215], v[52:55], v[156:159], a[212:215]
  v_mfma_f32_16x16x32_bf16 v[116:119], v[48:51], v[160:163], 0
  v_mfma_f32_16x16x32_bf16 v[116:119], v[52:55], v[164:167], v[116:119]
  ds_read_b64_tr_b16 v[48:49], v4 offset:49152
  ds_read_b64_tr_b16 v[50:51], v4 offset:49664
  s_waitcnt lgkmcnt(12)
  v_mfma_f32_16x16x32_bf16 a[24:27], v[56:59], v[128:131], 0
  buffer_load_dwordx4 v[244:247], v12, s[20:23], s40 offen offset:320
  ds_read_b64_tr_b16 v[52:53], v4 offset:53248
  s_waitcnt lgkmcnt(11)
  v_mfma_f32_16x16x32_bf16 a[24:27], v[60:63], v[132:135], a[24:27]
  ds_read_b64_tr_b16 v[54:55], v4 offset:53760
  v_mfma_f32_16x16x32_bf16 a[88:91], v[56:59], v[136:139], 0
  v_mfma_f32_16x16x32_bf16 a[88:91], v[60:63], v[140:143], a[88:91]
  v_mfma_f32_16x16x32_bf16 a[152:155], v[56:59], v[144:147], 0
  v_mfma_f32_16x16x32_bf16 a[152:155], v[60:63], v[148:151], a[152:155]
  v_mfma_f32_16x16x32_bf16 a[216:219], v[56:59], v[152:155], 0
  v_mfma_f32_16x16x32_bf16 a[216:219], v[60:63], v[156:159], a[216:219]
  v_mfma_f32_16x16x32_bf16 v[120:123], v[56:59], v[160:163], 0
  v_mfma_f32_16x16x32_bf16 v[120:123], v[60:63], v[164:167], v[120:123]
  ds_read_b64_tr_b16 v[56:57], v5 offset:49152
  ds_read_b64_tr_b16 v[58:59], v5 offset:49664
  s_waitcnt lgkmcnt(12)
  v_mfma_f32_16x16x32_bf16 a[28:31], v[24:27], v[128:131], 0
  ds_read_b64_tr_b16 v[60:61], v5 offset:53248
  ds_read_b64_tr_b16 v[62:63], v5 offset:53760
  s_waitcnt lgkmcnt(12)
  v_mfma_f32_16x16x32_bf16 a[28:31], v[28:31], v[132:135], a[28:31]
  v_mfma_f32_16x16x32_bf16 a[92:95], v[24:27], v[136:139], 0
  v_mfma_f32_16x16x32_bf16 a[92:95], v[28:31], v[140:143], a[92:95]
  v_mfma_f32_16x16x32_bf16 a[156:159], v[24:27], v[144:147], 0
  v_mfma_f32_16x16x32_bf16 a[156:159], v[28:31], v[148:151], a[156:159]
  v_mfma_f32_16x16x32_bf16 a[220:223], v[24:27], v[152:155], 0
  v_mfma_f32_16x16x32_bf16 a[220:223], v[28:31], v[156:159], a[220:223]
  v_mfma_f32_16x16x32_bf16 v[124:127], v[24:27], v[160:163], 0
  v_mfma_f32_16x16x32_bf16 v[124:127], v[28:31], v[164:167], v[124:127]
  s_waitcnt vmcnt(35) lgkmcnt(10)
  v_mfma_f32_16x16x32_bf16 a[32:35], v[40:43], v[168:171], a[32:35]
  s_waitcnt vmcnt(34) lgkmcnt(8)
  v_mfma_f32_16x16x32_bf16 a[32:35], v[44:47], v[172:175], a[32:35]
  s_waitcnt vmcnt(33)
  v_mfma_f32_16x16x32_bf16 a[96:99], v[40:43], v[176:179], a[96:99]
  s_waitcnt vmcnt(32)
  v_mfma_f32_16x16x32_bf16 a[96:99], v[44:47], v[180:183], a[96:99]
  s_waitcnt vmcnt(31)
  v_mfma_f32_16x16x32_bf16 a[160:163], v[40:43], v[184:187], a[160:163]
  s_waitcnt vmcnt(30)
  v_mfma_f32_16x16x32_bf16 a[160:163], v[44:47], v[188:191], a[160:163]
  s_waitcnt vmcnt(29)
  v_mfma_f32_16x16x32_bf16 a[224:227], v[40:43], v[192:195], a[224:227]
  s_waitcnt vmcnt(28)
  v_mfma_f32_16x16x32_bf16 a[224:227], v[44:47], v[196:199], a[224:227]
  ds_read_b64_tr_b16 v[24:25], v6 offset:49152
  ds_read_b64_tr_b16 v[26:27], v6 offset:49664
  s_waitcnt lgkmcnt(8)
  v_mfma_f32_16x16x32_bf16 a[36:39], v[48:51], v[168:171], a[36:39]
  ds_read_b64_tr_b16 v[28:29], v6 offset:53248
  ds_read_b64_tr_b16 v[30:31], v6 offset:53760
  s_waitcnt lgkmcnt(8)
  v_mfma_f32_16x16x32_bf16 a[36:39], v[52:55], v[172:175], a[36:39]
  buffer_load_dwordx4 v[128:131], v12, s[20:23], s36 offen offset:384
  v_mfma_f32_16x16x32_bf16 a[100:103], v[48:51], v[176:179], a[100:103]
  v_mfma_f32_16x16x32_bf16 a[100:103], v[52:55], v[180:183], a[100:103]
  v_mfma_f32_16x16x32_bf16 a[164:167], v[48:51], v[184:187], a[164:167]
  v_mfma_f32_16x16x32_bf16 a[164:167], v[52:55], v[188:191], a[164:167]
  v_mfma_f32_16x16x32_bf16 a[228:231], v[48:51], v[192:195], a[228:231]
  v_mfma_f32_16x16x32_bf16 a[228:231], v[52:55], v[196:199], a[228:231]
  ds_read_b64_tr_b16 v[32:33], v3 offset:57344
  ds_read_b64_tr_b16 v[34:35], v3 offset:57856
  s_waitcnt lgkmcnt(8)
  v_mfma_f32_16x16x32_bf16 a[40:43], v[56:59], v[168:171], a[40:43]
  ds_read_b64_tr_b16 v[36:37], v3 offset:61440
  ds_read_b64_tr_b16 v[38:39], v3 offset:61952
  s_waitcnt lgkmcnt(8)
  v_mfma_f32_16x16x32_bf16 a[40:43], v[60:63], v[172:175], a[40:43]
  v_mfma_f32_16x16x32_bf16 a[104:107], v[56:59], v[176:179], a[104:107]
  v_mfma_f32_16x16x32_bf16 a[104:107], v[60:63], v[180:183], a[104:107]
  v_mfma_f32_16x16x32_bf16 a[168:171], v[56:59], v[184:187], a[168:171]
  buffer_load_dwordx4 v[132:135], v12, s[20:23], s36 offen offset:448
  v_mfma_f32_16x16x32_bf16 a[168:171], v[60:63], v[188:191], a[168:171]
  v_mfma_f32_16x16x32_bf16 a[232:235], v[56:59], v[192:195], a[232:235]
  v_mfma_f32_16x16x32_bf16 a[232:235], v[60:63], v[196:199], a[232:235]
  ds_read_b64_tr_b16 v[48:49], v4 offset:57344
  ds_read_b64_tr_b16 v[50:51], v4 offset:57856
  s_waitcnt lgkmcnt(8)
  v_mfma_f32_16x16x32_bf16 a[44:47], v[24:27], v[168:171], a[44:47]
  ds_read_b64_tr_b16 v[52:53], v4 offset:61440
  ds_read_b64_tr_b16 v[54:55], v4 offset:61952
  s_waitcnt lgkmcnt(8)
  v_mfma_f32_16x16x32_bf16 a[44:47], v[28:31], v[172:175], a[44:47]
  v_mfma_f32_16x16x32_bf16 a[108:111], v[24:27], v[176:179], a[108:111]
  v_mfma_f32_16x16x32_bf16 a[108:111], v[28:31], v[180:183], a[108:111]
  v_mfma_f32_16x16x32_bf16 a[172:175], v[24:27], v[184:187], a[172:175]
  v_mfma_f32_16x16x32_bf16 a[172:175], v[28:31], v[188:191], a[172:175]
  v_mfma_f32_16x16x32_bf16 a[236:239], v[24:27], v[192:195], a[236:239]
  v_mfma_f32_16x16x32_bf16 a[236:239], v[28:31], v[196:199], a[236:239]
  ds_read_b64_tr_b16 v[56:57], v5 offset:57344
  ds_read_b64_tr_b16 v[58:59], v5 offset:57856
  s_waitcnt lgkmcnt(8)
  v_mfma_f32_16x16x32_bf16 a[48:51], v[32:35], v[168:171], a[48:51]
  ds_read_b64_tr_b16 v[60:61], v5 offset:61440
  ds_read_b64_tr_b16 v[62:63], v5 offset:61952
  s_waitcnt lgkmcnt(8)
  v_mfma_f32_16x16x32_bf16 a[48:51], v[36:39], v[172:175], a[48:51]
  buffer_load_dwordx4 v[136:139], v12, s[20:23], s37 offen offset:384
  v_mfma_f32_16x16x32_bf16 a[112:115], v[32:35], v[176:179], a[112:115]
  v_mfma_f32_16x16x32_bf16 a[112:115], v[36:39], v[180:183], a[112:115]
  v_mfma_f32_16x16x32_bf16 a[176:179], v[32:35], v[184:187], a[176:179]
  v_mfma_f32_16x16x32_bf16 a[176:179], v[36:39], v[188:191], a[176:179]
  v_mfma_f32_16x16x32_bf16 a[240:243], v[32:35], v[192:195], a[240:243]
  v_mfma_f32_16x16x32_bf16 a[240:243], v[36:39], v[196:199], a[240:243]
  ds_read_b64_tr_b16 v[40:41], v6 offset:57344
  ds_read_b64_tr_b16 v[42:43], v6 offset:57856
  s_waitcnt lgkmcnt(8)
  v_mfma_f32_16x16x32_bf16 a[52:55], v[48:51], v[168:171], a[52:55]
  ds_read_b64_tr_b16 v[44:45], v6 offset:61440
  ds_read_b64_tr_b16 v[46:47], v6 offset:61952
  s_waitcnt lgkmcnt(8)
  v_mfma_f32_16x16x32_bf16 a[52:55], v[52:55], v[172:175], a[52:55]
  v_mfma_f32_16x16x32_bf16 a[116:119], v[48:51], v[176:179], a[116:119]
  v_mfma_f32_16x16x32_bf16 a[116:119], v[52:55], v[180:183], a[116:119]
  v_mfma_f32_16x16x32_bf16 a[180:183], v[48:51], v[184:187], a[180:183]
  v_mfma_f32_16x16x32_bf16 a[180:183], v[52:55], v[188:191], a[180:183]
  v_mfma_f32_16x16x32_bf16 a[244:247], v[48:51], v[192:195], a[244:247]
  buffer_load_dwordx4 v[140:143], v12, s[20:23], s37 offen offset:448
  v_mfma_f32_16x16x32_bf16 a[244:247], v[52:55], v[196:199], a[244:247]
  ds_read_b64_tr_b16 v[24:25], v3 offset:32768
  ds_read_b64_tr_b16 v[26:27], v3 offset:33280
  s_waitcnt lgkmcnt(8)
  v_mfma_f32_16x16x32_bf16 a[56:59], v[56:59], v[168:171], a[56:59]
  ds_read_b64_tr_b16 v[28:29], v3 offset:36864
  ds_read_b64_tr_b16 v[30:31], v3 offset:37376
  s_waitcnt lgkmcnt(8)
  v_mfma_f32_16x16x32_bf16 a[56:59], v[60:63], v[172:175], a[56:59]
  v_mfma_f32_16x16x32_bf16 a[120:123], v[56:59], v[176:179], a[120:123]
  v_mfma_f32_16x16x32_bf16 a[120:123], v[60:63], v[180:183], a[120:123]
  v_mfma_f32_16x16x32_bf16 a[184:187], v[56:59], v[184:187], a[184:187]
  v_mfma_f32_16x16x32_bf16 a[184:187], v[60:63], v[188:191], a[184:187]
  v_mfma_f32_16x16x32_bf16 a[248:251], v[56:59], v[192:195], a[248:251]
  v_mfma_f32_16x16x32_bf16 a[248:251], v[60:63], v[196:199], a[248:251]
  ds_read_b64_tr_b16 v[48:49], v4 offset:32768
  ds_read_b64_tr_b16 v[50:51], v4 offset:33280
  s_waitcnt lgkmcnt(8)
  v_mfma_f32_16x16x32_bf16 a[60:63], v[40:43], v[168:171], a[60:63]
  ds_read_b64_tr_b16 v[52:53], v4 offset:36864
  ds_read_b64_tr_b16 v[54:55], v4 offset:37376
  s_waitcnt lgkmcnt(8)
  v_mfma_f32_16x16x32_bf16 a[60:63], v[44:47], v[172:175], a[60:63]
  v_mfma_f32_16x16x32_bf16 a[124:127], v[40:43], v[176:179], a[124:127]
  v_mfma_f32_16x16x32_bf16 a[124:127], v[44:47], v[180:183], a[124:127]
  buffer_load_dwordx4 v[144:147], v12, s[20:23], s38 offen offset:384
  v_mfma_f32_16x16x32_bf16 a[188:191], v[40:43], v[184:187], a[188:191]
  v_mfma_f32_16x16x32_bf16 a[188:191], v[44:47], v[188:191], a[188:191]
  v_mfma_f32_16x16x32_bf16 a[252:255], v[40:43], v[192:195], a[252:255]
  v_mfma_f32_16x16x32_bf16 a[252:255], v[44:47], v[196:199], a[252:255]
  ds_read_b64_tr_b16 v[56:57], v5 offset:32768
  ds_read_b64_tr_b16 v[58:59], v5 offset:33280
  s_waitcnt lgkmcnt(8)
  v_mfma_f32_16x16x32_bf16 a[0:3], v[24:27], v[168:171], a[0:3]
  ds_read_b64_tr_b16 v[60:61], v5 offset:36864
  ds_read_b64_tr_b16 v[62:63], v5 offset:37376
  s_waitcnt lgkmcnt(8)
  v_mfma_f32_16x16x32_bf16 a[0:3], v[28:31], v[172:175], a[0:3]
  v_mfma_f32_16x16x32_bf16 a[64:67], v[24:27], v[176:179], a[64:67]
  v_mfma_f32_16x16x32_bf16 a[64:67], v[28:31], v[180:183], a[64:67]
  v_mfma_f32_16x16x32_bf16 a[128:131], v[24:27], v[184:187], a[128:131]
  v_mfma_f32_16x16x32_bf16 a[128:131], v[28:31], v[188:191], a[128:131]
  v_mfma_f32_16x16x32_bf16 a[192:195], v[24:27], v[192:195], a[192:195]
  v_mfma_f32_16x16x32_bf16 a[192:195], v[28:31], v[196:199], a[192:195]
  s_waitcnt vmcnt(32)
  v_mfma_f32_16x16x32_bf16 v[96:99], v[24:27], v[200:203], v[96:99]
  buffer_load_dwordx4 v[148:151], v12, s[20:23], s38 offen offset:448
  s_waitcnt vmcnt(32)
  v_mfma_f32_16x16x32_bf16 v[96:99], v[28:31], v[204:207], v[96:99]
  ds_read_b64_tr_b16 v[32:33], v6 offset:32768
  ds_read_b64_tr_b16 v[34:35], v6 offset:33280
  s_waitcnt lgkmcnt(8)
  v_mfma_f32_16x16x32_bf16 a[4:7], v[48:51], v[168:171], a[4:7]
  ds_read_b64_tr_b16 v[36:37], v6 offset:36864
  ds_read_b64_tr_b16 v[38:39], v6 offset:37376
  s_waitcnt lgkmcnt(8)
  v_mfma_f32_16x16x32_bf16 a[4:7], v[52:55], v[172:175], a[4:7]
  v_mfma_f32_16x16x32_bf16 a[68:71], v[48:51], v[176:179], a[68:71]
  v_mfma_f32_16x16x32_bf16 a[68:71], v[52:55], v[180:183], a[68:71]
  v_mfma_f32_16x16x32_bf16 a[132:135], v[48:51], v[184:187], a[132:135]
  v_mfma_f32_16x16x32_bf16 a[132:135], v[52:55], v[188:191], a[132:135]
  v_mfma_f32_16x16x32_bf16 a[196:199], v[48:51], v[192:195], a[196:199]
  v_mfma_f32_16x16x32_bf16 a[196:199], v[52:55], v[196:199], a[196:199]
  v_mfma_f32_16x16x32_bf16 v[100:103], v[48:51], v[200:203], v[100:103]
  v_mfma_f32_16x16x32_bf16 v[100:103], v[52:55], v[204:207], v[100:103]
  ds_read_b64_tr_b16 v[40:41], v3 offset:40960
  ds_read_b64_tr_b16 v[42:43], v3 offset:41472
  s_waitcnt lgkmcnt(8)
  v_mfma_f32_16x16x32_bf16 a[8:11], v[56:59], v[168:171], a[8:11]
  ds_read_b64_tr_b16 v[44:45], v3 offset:45056
  ds_read_b64_tr_b16 v[46:47], v3 offset:45568
  s_waitcnt lgkmcnt(8)
  v_mfma_f32_16x16x32_bf16 a[8:11], v[60:63], v[172:175], a[8:11]
  buffer_load_dwordx4 v[152:155], v12, s[20:23], s39 offen offset:384
  v_mfma_f32_16x16x32_bf16 a[72:75], v[56:59], v[176:179], a[72:75]
  v_mfma_f32_16x16x32_bf16 a[72:75], v[60:63], v[180:183], a[72:75]
  v_mfma_f32_16x16x32_bf16 a[136:139], v[56:59], v[184:187], a[136:139]
  v_mfma_f32_16x16x32_bf16 a[136:139], v[60:63], v[188:191], a[136:139]
  v_mfma_f32_16x16x32_bf16 a[200:203], v[56:59], v[192:195], a[200:203]
  v_mfma_f32_16x16x32_bf16 a[200:203], v[60:63], v[196:199], a[200:203]
  v_mfma_f32_16x16x32_bf16 v[104:107], v[56:59], v[200:203], v[104:107]
  v_mfma_f32_16x16x32_bf16 v[104:107], v[60:63], v[204:207], v[104:107]
  ds_read_b64_tr_b16 v[48:49], v4 offset:40960
  ds_read_b64_tr_b16 v[50:51], v4 offset:41472
  s_waitcnt lgkmcnt(8)
  v_mfma_f32_16x16x32_bf16 a[12:15], v[32:35], v[168:171], a[12:15]
  s_waitcnt vmcnt(25)
  s_barrier
  ds_read_b64_tr_b16 v[52:53], v4 offset:45056
  s_waitcnt lgkmcnt(7)
  v_mfma_f32_16x16x32_bf16 a[12:15], v[36:39], v[172:175], a[12:15]
  s_add_u32 m0, s35, 0
  s_add_u32 s34, s50, 2097152
  buffer_load_dwordx4 v10, s[16:19], s34 offen lds
  v_mfma_f32_16x16x32_bf16 a[76:79], v[32:35], v[176:179], a[76:79]
  ds_read_b64_tr_b16 v[54:55], v4 offset:45568
  v_mfma_f32_16x16x32_bf16 a[76:79], v[36:39], v[180:183], a[76:79]
  v_mfma_f32_16x16x32_bf16 a[140:143], v[32:35], v[184:187], a[140:143]
  buffer_load_dwordx4 v[156:159], v12, s[20:23], s39 offen offset:448
  v_mfma_f32_16x16x32_bf16 a[140:143], v[36:39], v[188:191], a[140:143]
  v_mfma_f32_16x16x32_bf16 a[204:207], v[32:35], v[192:195], a[204:207]
  v_mfma_f32_16x16x32_bf16 a[204:207], v[36:39], v[196:199], a[204:207]
  s_add_u32 m0, s35, 1024
  s_add_u32 s34, s50, 2162688
  buffer_load_dwordx4 v11, s[16:19], s34 offen lds
  v_mfma_f32_16x16x32_bf16 v[108:111], v[32:35], v[200:203], v[108:111]
  v_mfma_f32_16x16x32_bf16 v[108:111], v[36:39], v[204:207], v[108:111]
  ds_read_b64_tr_b16 v[56:57], v5 offset:40960
  ds_read_b64_tr_b16 v[58:59], v5 offset:41472
  s_waitcnt lgkmcnt(8)
  v_mfma_f32_16x16x32_bf16 a[16:19], v[40:43], v[168:171], a[16:19]
  ds_read_b64_tr_b16 v[60:61], v5 offset:45056
  ds_read_b64_tr_b16 v[62:63], v5 offset:45568
  s_waitcnt lgkmcnt(8)
  v_mfma_f32_16x16x32_bf16 a[16:19], v[44:47], v[172:175], a[16:19]
  v_mfma_f32_16x16x32_bf16 a[80:83], v[40:43], v[176:179], a[80:83]
  v_mfma_f32_16x16x32_bf16 a[80:83], v[44:47], v[180:183], a[80:83]
  s_add_u32 m0, s35, 2048
  s_add_u32 s34, s50, 2228224
  buffer_load_dwordx4 v10, s[16:19], s34 offen lds
  v_mfma_f32_16x16x32_bf16 a[144:147], v[40:43], v[184:187], a[144:147]
  v_mfma_f32_16x16x32_bf16 a[144:147], v[44:47], v[188:191], a[144:147]
  v_mfma_f32_16x16x32_bf16 a[208:211], v[40:43], v[192:195], a[208:211]
  v_mfma_f32_16x16x32_bf16 a[208:211], v[44:47], v[196:199], a[208:211]
  buffer_load_dwordx4 v[160:163], v12, s[20:23], s40 offen offset:384
  v_mfma_f32_16x16x32_bf16 v[112:115], v[40:43], v[200:203], v[112:115]
  v_mfma_f32_16x16x32_bf16 v[112:115], v[44:47], v[204:207], v[112:115]
  s_add_u32 m0, s35, 3072
  s_add_u32 s34, s50, 2293760
  buffer_load_dwordx4 v11, s[16:19], s34 offen lds
  s_waitcnt lgkmcnt(6)
  v_mfma_f32_16x16x32_bf16 a[20:23], v[48:51], v[168:171], a[20:23]
  ds_read_b64_tr_b16 v[24:25], v6 offset:40960
  ds_read_b64_tr_b16 v[26:27], v6 offset:41472
  s_waitcnt lgkmcnt(6)
  v_mfma_f32_16x16x32_bf16 a[20:23], v[52:55], v[172:175], a[20:23]
  ds_read_b64_tr_b16 v[28:29], v6 offset:45056
  ds_read_b64_tr_b16 v[30:31], v6 offset:45568
  v_mfma_f32_16x16x32_bf16 a[84:87], v[48:51], v[176:179], a[84:87]
  v_mfma_f32_16x16x32_bf16 a[84:87], v[52:55], v[180:183], a[84:87]
  v_mfma_f32_16x16x32_bf16 a[148:151], v[48:51], v[184:187], a[148:151]
  v_mfma_f32_16x16x32_bf16 a[148:151], v[52:55], v[188:191], a[148:151]
  s_add_u32 m0, s35, 4096
  s_add_u32 s34, s50, 2359296
  buffer_load_dwordx4 v10, s[16:19], s34 offen lds
  v_mfma_f32_16x16x32_bf16 a[212:215], v[48:51], v[192:195], a[212:215]
  v_mfma_f32_16x16x32_bf16 a[212:215], v[52:55], v[196:199], a[212:215]
  v_mfma_f32_16x16x32_bf16 v[116:119], v[48:51], v[200:203], v[116:119]
  v_mfma_f32_16x16x32_bf16 v[116:119], v[52:55], v[204:207], v[116:119]
  s_waitcnt lgkmcnt(6)
  v_mfma_f32_16x16x32_bf16 a[24:27], v[56:59], v[168:171], a[24:27]
  buffer_load_dwordx4 v[164:167], v12, s[20:23], s40 offen offset:448
  s_waitcnt lgkmcnt(4)
  v_mfma_f32_16x16x32_bf16 a[24:27], v[60:63], v[172:175], a[24:27]
  s_add_u32 m0, s35, 5120
  s_add_u32 s34, s50, 2424832
  buffer_load_dwordx4 v11, s[16:19], s34 offen lds
  v_mfma_f32_16x16x32_bf16 a[88:91], v[56:59], v[176:179], a[88:91]
  v_mfma_f32_16x16x32_bf16 a[88:91], v[60:63], v[180:183], a[88:91]
  v_mfma_f32_16x16x32_bf16 a[152:155], v[56:59], v[184:187], a[152:155]
  v_mfma_f32_16x16x32_bf16 a[152:155], v[60:63], v[188:191], a[152:155]
  v_mfma_f32_16x16x32_bf16 a[216:219], v[56:59], v[192:195], a[216:219]
  v_xor_b32 v3, 65536, v3
  v_xor_b32 v4, 65536, v4
  v_mfma_f32_16x16x32_bf16 a[216:219], v[60:63], v[196:199], a[216:219]
  s_add_u32 m0, s35, 6144
  s_add_u32 s34, s50, 2490368
  buffer_load_dwordx4 v10, s[16:19], s34 offen lds
  v_mfma_f32_16x16x32_bf16 v[120:123], v[56:59], v[200:203], v[120:123]
  v_xor_b32 v5, 65536, v5
  v_xor_b32 v6, 65536, v6
  v_mfma_f32_16x16x32_bf16 v[120:123], v[60:63], v[204:207], v[120:123]
  ds_read_b64_tr_b16 v[40:41], v3 offset:16384
  ds_read_b64_tr_b16 v[42:43], v3 offset:16896
  s_waitcnt lgkmcnt(4)
  v_mfma_f32_16x16x32_bf16 a[28:31], v[24:27], v[168:171], a[28:31]
  ds_read_b64_tr_b16 v[44:45], v3 offset:20480
  ds_read_b64_tr_b16 v[46:47], v3 offset:20992
  s_waitcnt lgkmcnt(4)
  v_mfma_f32_16x16x32_bf16 a[28:31], v[28:31], v[172:175], a[28:31]
  ds_read_b64_tr_b16 v[48:49], v4 offset:16384
  ds_read_b64_tr_b16 v[50:51], v4 offset:16896
  v_mfma_f32_16x16x32_bf16 a[92:95], v[24:27], v[176:179], a[92:95]
  ds_read_b64_tr_b16 v[52:53], v4 offset:20480
  ds_read_b64_tr_b16 v[54:55], v4 offset:20992
  v_mfma_f32_16x16x32_bf16 a[92:95], v[28:31], v[180:183], a[92:95]
  s_add_u32 m0, s35, 7168
  s_add_u32 s34, s50, 2555904
  buffer_load_dwordx4 v11, s[16:19], s34 offen lds
  v_mfma_f32_16x16x32_bf16 a[156:159], v[24:27], v[184:187], a[156:159]
  ds_read_b64_tr_b16 v[56:57], v5 offset:16384
  ds_read_b64_tr_b16 v[58:59], v5 offset:16896
  v_mfma_f32_16x16x32_bf16 a[156:159], v[28:31], v[188:191], a[156:159]
  ds_read_b64_tr_b16 v[60:61], v5 offset:20480
  ds_read_b64_tr_b16 v[62:63], v5 offset:20992
  v_mfma_f32_16x16x32_bf16 a[220:223], v[24:27], v[192:195], a[220:223]
  v_mfma_f32_16x16x32_bf16 a[220:223], v[28:31], v[196:199], a[220:223]
  v_mfma_f32_16x16x32_bf16 v[124:127], v[24:27], v[200:203], v[124:127]
  v_mfma_f32_16x16x32_bf16 v[124:127], v[28:31], v[204:207], v[124:127]
  s_waitcnt vmcnt(34) lgkmcnt(10)
  v_mfma_f32_16x16x32_bf16 a[32:35], v[40:43], v[208:211], a[32:35]
  s_waitcnt vmcnt(32) lgkmcnt(8)
  v_mfma_f32_16x16x32_bf16 a[32:35], v[44:47], v[212:215], a[32:35]
  s_waitcnt vmcnt(30)
  v_mfma_f32_16x16x32_bf16 a[96:99], v[40:43], v[216:219], a[96:99]
  s_waitcnt vmcnt(28)
  v_mfma_f32_16x16x32_bf16 a[96:99], v[44:47], v[220:223], a[96:99]
  s_waitcnt vmcnt(26)
  v_mfma_f32_16x16x32_bf16 a[160:163], v[40:43], v[224:227], a[160:163]
  s_waitcnt vmcnt(24)
  v_mfma_f32_16x16x32_bf16 a[160:163], v[44:47], v[228:231], a[160:163]
  s_waitcnt vmcnt(21)
  v_mfma_f32_16x16x32_bf16 a[224:227], v[40:43], v[232:235], a[224:227]
  s_waitcnt vmcnt(20)
  v_mfma_f32_16x16x32_bf16 a[224:227], v[44:47], v[236:239], a[224:227]
  ds_read_b64_tr_b16 v[24:25], v6 offset:16384
  ds_read_b64_tr_b16 v[26:27], v6 offset:16896
  s_waitcnt lgkmcnt(8)
  v_mfma_f32_16x16x32_bf16 a[36:39], v[48:51], v[208:211], a[36:39]
  ds_read_b64_tr_b16 v[28:29], v6 offset:20480
  ds_read_b64_tr_b16 v[30:31], v6 offset:20992
  s_waitcnt lgkmcnt(8)
  v_mfma_f32_16x16x32_bf16 a[36:39], v[52:55], v[212:215], a[36:39]
  buffer_load_dwordx4 v[168:171], v12, s[20:23], s36 offen offset:512
  v_mfma_f32_16x16x32_bf16 a[100:103], v[48:51], v[216:219], a[100:103]
  v_mfma_f32_16x16x32_bf16 a[100:103], v[52:55], v[220:223], a[100:103]
  v_mfma_f32_16x16x32_bf16 a[164:167], v[48:51], v[224:227], a[164:167]
  v_mfma_f32_16x16x32_bf16 a[164:167], v[52:55], v[228:231], a[164:167]
  v_mfma_f32_16x16x32_bf16 a[228:231], v[48:51], v[232:235], a[228:231]
  v_mfma_f32_16x16x32_bf16 a[228:231], v[52:55], v[236:239], a[228:231]
  ds_read_b64_tr_b16 v[32:33], v3 offset:24576
  ds_read_b64_tr_b16 v[34:35], v3 offset:25088
  s_waitcnt lgkmcnt(8)
  v_mfma_f32_16x16x32_bf16 a[40:43], v[56:59], v[208:211], a[40:43]
  ds_read_b64_tr_b16 v[36:37], v3 offset:28672
  ds_read_b64_tr_b16 v[38:39], v3 offset:29184
  s_waitcnt lgkmcnt(8)
  v_mfma_f32_16x16x32_bf16 a[40:43], v[60:63], v[212:215], a[40:43]
  v_mfma_f32_16x16x32_bf16 a[104:107], v[56:59], v[216:219], a[104:107]
  v_mfma_f32_16x16x32_bf16 a[104:107], v[60:63], v[220:223], a[104:107]
  v_mfma_f32_16x16x32_bf16 a[168:171], v[56:59], v[224:227], a[168:171]
  buffer_load_dwordx4 v[172:175], v12, s[20:23], s36 offen offset:576
  v_mfma_f32_16x16x32_bf16 a[168:171], v[60:63], v[228:231], a[168:171]
  v_mfma_f32_16x16x32_bf16 a[232:235], v[56:59], v[232:235], a[232:235]
  v_mfma_f32_16x16x32_bf16 a[232:235], v[60:63], v[236:239], a[232:235]
  ds_read_b64_tr_b16 v[48:49], v4 offset:24576
  ds_read_b64_tr_b16 v[50:51], v4 offset:25088
  s_waitcnt lgkmcnt(8)
  v_mfma_f32_16x16x32_bf16 a[44:47], v[24:27], v[208:211], a[44:47]
  ds_read_b64_tr_b16 v[52:53], v4 offset:28672
  ds_read_b64_tr_b16 v[54:55], v4 offset:29184
  s_waitcnt lgkmcnt(8)
  v_mfma_f32_16x16x32_bf16 a[44:47], v[28:31], v[212:215], a[44:47]
  v_mfma_f32_16x16x32_bf16 a[108:111], v[24:27], v[216:219], a[108:111]
  v_mfma_f32_16x16x32_bf16 a[108:111], v[28:31], v[220:223], a[108:111]
  v_mfma_f32_16x16x32_bf16 a[172:175], v[24:27], v[224:227], a[172:175]
  v_mfma_f32_16x16x32_bf16 a[172:175], v[28:31], v[228:231], a[172:175]
  v_mfma_f32_16x16x32_bf16 a[236:239], v[24:27], v[232:235], a[236:239]
  v_mfma_f32_16x16x32_bf16 a[236:239], v[28:31], v[236:239], a[236:239]
  ds_read_b64_tr_b16 v[56:57], v5 offset:24576
  ds_read_b64_tr_b16 v[58:59], v5 offset:25088
  s_waitcnt lgkmcnt(8)
  v_mfma_f32_16x16x32_bf16 a[48:51], v[32:35], v[208:211], a[48:51]
  ds_read_b64_tr_b16 v[60:61], v5 offset:28672
  ds_read_b64_tr_b16 v[62:63], v5 offset:29184
  s_waitcnt lgkmcnt(8)
  v_mfma_f32_16x16x32_bf16 a[48:51], v[36:39], v[212:215], a[48:51]
  buffer_load_dwordx4 v[176:179], v12, s[20:23], s37 offen offset:512
  v_mfma_f32_16x16x32_bf16 a[112:115], v[32:35], v[216:219], a[112:115]
  v_mfma_f32_16x16x32_bf16 a[112:115], v[36:39], v[220:223], a[112:115]
  v_mfma_f32_16x16x32_bf16 a[176:179], v[32:35], v[224:227], a[176:179]
  v_mfma_f32_16x16x32_bf16 a[176:179], v[36:39], v[228:231], a[176:179]
  v_mfma_f32_16x16x32_bf16 a[240:243], v[32:35], v[232:235], a[240:243]
  v_mfma_f32_16x16x32_bf16 a[240:243], v[36:39], v[236:239], a[240:243]
  ds_read_b64_tr_b16 v[40:41], v6 offset:24576
  ds_read_b64_tr_b16 v[42:43], v6 offset:25088
  s_waitcnt lgkmcnt(8)
  v_mfma_f32_16x16x32_bf16 a[52:55], v[48:51], v[208:211], a[52:55]
  ds_read_b64_tr_b16 v[44:45], v6 offset:28672
  ds_read_b64_tr_b16 v[46:47], v6 offset:29184
  s_waitcnt lgkmcnt(8)
  v_mfma_f32_16x16x32_bf16 a[52:55], v[52:55], v[212:215], a[52:55]
  v_mfma_f32_16x16x32_bf16 a[116:119], v[48:51], v[216:219], a[116:119]
  v_mfma_f32_16x16x32_bf16 a[116:119], v[52:55], v[220:223], a[116:119]
  v_mfma_f32_16x16x32_bf16 a[180:183], v[48:51], v[224:227], a[180:183]
  v_mfma_f32_16x16x32_bf16 a[180:183], v[52:55], v[228:231], a[180:183]
  v_mfma_f32_16x16x32_bf16 a[244:247], v[48:51], v[232:235], a[244:247]
  buffer_load_dwordx4 v[180:183], v12, s[20:23], s37 offen offset:576
  v_mfma_f32_16x16x32_bf16 a[244:247], v[52:55], v[236:239], a[244:247]
  ds_read_b64_tr_b16 v[24:25], v3 offset:0
  ds_read_b64_tr_b16 v[26:27], v3 offset:512
  s_waitcnt lgkmcnt(8)
  v_mfma_f32_16x16x32_bf16 a[56:59], v[56:59], v[208:211], a[56:59]
  ds_read_b64_tr_b16 v[28:29], v3 offset:4096
  ds_read_b64_tr_b16 v[30:31], v3 offset:4608
  s_waitcnt lgkmcnt(8)
  v_mfma_f32_16x16x32_bf16 a[56:59], v[60:63], v[212:215], a[56:59]
  v_mfma_f32_16x16x32_bf16 a[120:123], v[56:59], v[216:219], a[120:123]
  v_mfma_f32_16x16x32_bf16 a[120:123], v[60:63], v[220:223], a[120:123]
  v_mfma_f32_16x16x32_bf16 a[184:187], v[56:59], v[224:227], a[184:187]
  v_mfma_f32_16x16x32_bf16 a[184:187], v[60:63], v[228:231], a[184:187]
  v_mfma_f32_16x16x32_bf16 a[248:251], v[56:59], v[232:235], a[248:251]
  v_mfma_f32_16x16x32_bf16 a[248:251], v[60:63], v[236:239], a[248:251]
  ds_read_b64_tr_b16 v[48:49], v4 offset:0
  ds_read_b64_tr_b16 v[50:51], v4 offset:512
  s_waitcnt lgkmcnt(8)
  v_mfma_f32_16x16x32_bf16 a[60:63], v[40:43], v[208:211], a[60:63]
  ds_read_b64_tr_b16 v[52:53], v4 offset:4096
  ds_read_b64_tr_b16 v[54:55], v4 offset:4608
  s_waitcnt lgkmcnt(8)
  v_mfma_f32_16x16x32_bf16 a[60:63], v[44:47], v[212:215], a[60:63]
  v_mfma_f32_16x16x32_bf16 a[124:127], v[40:43], v[216:219], a[124:127]
  v_mfma_f32_16x16x32_bf16 a[124:127], v[44:47], v[220:223], a[124:127]
  buffer_load_dwordx4 v[184:187], v12, s[20:23], s38 offen offset:512
  v_mfma_f32_16x16x32_bf16 a[188:191], v[40:43], v[224:227], a[188:191]
  v_mfma_f32_16x16x32_bf16 a[188:191], v[44:47], v[228:231], a[188:191]
  v_mfma_f32_16x16x32_bf16 a[252:255], v[40:43], v[232:235], a[252:255]
  v_mfma_f32_16x16x32_bf16 a[252:255], v[44:47], v[236:239], a[252:255]
  ds_read_b64_tr_b16 v[56:57], v5 offset:0
  ds_read_b64_tr_b16 v[58:59], v5 offset:512
  s_waitcnt lgkmcnt(8)
  v_mfma_f32_16x16x32_bf16 a[0:3], v[24:27], v[208:211], a[0:3]
  ds_read_b64_tr_b16 v[60:61], v5 offset:4096
  ds_read_b64_tr_b16 v[62:63], v5 offset:4608
  s_waitcnt lgkmcnt(8)
  v_mfma_f32_16x16x32_bf16 a[0:3], v[28:31], v[212:215], a[0:3]
  v_mfma_f32_16x16x32_bf16 a[64:67], v[24:27], v[216:219], a[64:67]
  v_mfma_f32_16x16x32_bf16 a[64:67], v[28:31], v[220:223], a[64:67]
  v_mfma_f32_16x16x32_bf16 a[128:131], v[24:27], v[224:227], a[128:131]
  v_mfma_f32_16x16x32_bf16 a[128:131], v[28:31], v[228:231], a[128:131]
  v_mfma_f32_16x16x32_bf16 a[192:195], v[24:27], v[232:235], a[192:195]
  v_mfma_f32_16x16x32_bf16 a[192:195], v[28:31], v[236:239], a[192:195]
  s_waitcnt vmcnt(24)
  v_mfma_f32_16x16x32_bf16 v[96:99], v[24:27], v[240:243], v[96:99]
  buffer_load_dwordx4 v[188:191], v12, s[20:23], s38 offen offset:576
  s_waitcnt vmcnt(24)
  v_mfma_f32_16x16x32_bf16 v[96:99], v[28:31], v[244:247], v[96:99]
  ds_read_b64_tr_b16 v[32:33], v6 offset:0
  ds_read_b64_tr_b16 v[34:35], v6 offset:512
  s_waitcnt lgkmcnt(8)
  v_mfma_f32_16x16x32_bf16 a[4:7], v[48:51], v[208:211], a[4:7]
  ds_read_b64_tr_b16 v[36:37], v6 offset:4096
  ds_read_b64_tr_b16 v[38:39], v6 offset:4608
  s_waitcnt lgkmcnt(8)
  v_mfma_f32_16x16x32_bf16 a[4:7], v[52:55], v[212:215], a[4:7]
  v_mfma_f32_16x16x32_bf16 a[68:71], v[48:51], v[216:219], a[68:71]
  v_mfma_f32_16x16x32_bf16 a[68:71], v[52:55], v[220:223], a[68:71]
  v_mfma_f32_16x16x32_bf16 a[132:135], v[48:51], v[224:227], a[132:135]
  v_mfma_f32_16x16x32_bf16 a[132:135], v[52:55], v[228:231], a[132:135]
  v_mfma_f32_16x16x32_bf16 a[196:199], v[48:51], v[232:235], a[196:199]
  v_mfma_f32_16x16x32_bf16 a[196:199], v[52:55], v[236:239], a[196:199]
  v_mfma_f32_16x16x32_bf16 v[100:103], v[48:51], v[240:243], v[100:103]
  v_mfma_f32_16x16x32_bf16 v[100:103], v[52:55], v[244:247], v[100:103]
  ds_read_b64_tr_b16 v[40:41], v3 offset:8192
  ds_read_b64_tr_b16 v[42:43], v3 offset:8704
  s_waitcnt lgkmcnt(8)
  v_mfma_f32_16x16x32_bf16 a[8:11], v[56:59], v[208:211], a[8:11]
  ds_read_b64_tr_b16 v[44:45], v3 offset:12288
  ds_read_b64_tr_b16 v[46:47], v3 offset:12800
  s_waitcnt lgkmcnt(8)
  v_mfma_f32_16x16x32_bf16 a[8:11], v[60:63], v[212:215], a[8:11]
  buffer_load_dwordx4 v[192:195], v12, s[20:23], s39 offen offset:512
  v_mfma_f32_16x16x32_bf16 a[72:75], v[56:59], v[216:219], a[72:75]
  v_mfma_f32_16x16x32_bf16 a[72:75], v[60:63], v[220:223], a[72:75]
  v_mfma_f32_16x16x32_bf16 a[136:139], v[56:59], v[224:227], a[136:139]
  v_mfma_f32_16x16x32_bf16 a[136:139], v[60:63], v[228:231], a[136:139]
  v_mfma_f32_16x16x32_bf16 a[200:203], v[56:59], v[232:235], a[200:203]
  v_mfma_f32_16x16x32_bf16 a[200:203], v[60:63], v[236:239], a[200:203]
  v_mfma_f32_16x16x32_bf16 v[104:107], v[56:59], v[240:243], v[104:107]
  v_mfma_f32_16x16x32_bf16 v[104:107], v[60:63], v[244:247], v[104:107]
  ds_read_b64_tr_b16 v[48:49], v4 offset:8192
  ds_read_b64_tr_b16 v[50:51], v4 offset:8704
  s_waitcnt lgkmcnt(8)
  v_mfma_f32_16x16x32_bf16 a[12:15], v[32:35], v[208:211], a[12:15]
  s_barrier
  ds_read_b64_tr_b16 v[52:53], v4 offset:12288
  s_waitcnt lgkmcnt(7)
  v_mfma_f32_16x16x32_bf16 a[12:15], v[36:39], v[212:215], a[12:15]
  s_add_u32 m0, s35, 32768
  s_add_u32 s34, s50, 2621440
  buffer_load_dwordx4 v10, s[16:19], s34 offen lds
  v_mfma_f32_16x16x32_bf16 a[76:79], v[32:35], v[216:219], a[76:79]
  ds_read_b64_tr_b16 v[54:55], v4 offset:12800
  v_mfma_f32_16x16x32_bf16 a[76:79], v[36:39], v[220:223], a[76:79]
  v_mfma_f32_16x16x32_bf16 a[140:143], v[32:35], v[224:227], a[140:143]
  buffer_load_dwordx4 v[196:199], v12, s[20:23], s39 offen offset:576
  v_mfma_f32_16x16x32_bf16 a[140:143], v[36:39], v[228:231], a[140:143]
  v_mfma_f32_16x16x32_bf16 a[204:207], v[32:35], v[232:235], a[204:207]
  v_mfma_f32_16x16x32_bf16 a[204:207], v[36:39], v[236:239], a[204:207]
  s_add_u32 m0, s35, 33792
  s_add_u32 s34, s50, 2686976
  buffer_load_dwordx4 v11, s[16:19], s34 offen lds
  v_mfma_f32_16x16x32_bf16 v[108:111], v[32:35], v[240:243], v[108:111]
  v_mfma_f32_16x16x32_bf16 v[108:111], v[36:39], v[244:247], v[108:111]
  ds_read_b64_tr_b16 v[56:57], v5 offset:8192
  ds_read_b64_tr_b16 v[58:59], v5 offset:8704
  s_waitcnt lgkmcnt(8)
  v_mfma_f32_16x16x32_bf16 a[16:19], v[40:43], v[208:211], a[16:19]
  ds_read_b64_tr_b16 v[60:61], v5 offset:12288
  ds_read_b64_tr_b16 v[62:63], v5 offset:12800
  s_waitcnt lgkmcnt(8)
  v_mfma_f32_16x16x32_bf16 a[16:19], v[44:47], v[212:215], a[16:19]
  v_mfma_f32_16x16x32_bf16 a[80:83], v[40:43], v[216:219], a[80:83]
  v_mfma_f32_16x16x32_bf16 a[80:83], v[44:47], v[220:223], a[80:83]
  s_add_u32 m0, s35, 34816
  s_add_u32 s34, s50, 2752512
  buffer_load_dwordx4 v10, s[16:19], s34 offen lds
  v_mfma_f32_16x16x32_bf16 a[144:147], v[40:43], v[224:227], a[144:147]
  v_mfma_f32_16x16x32_bf16 a[144:147], v[44:47], v[228:231], a[144:147]
  v_mfma_f32_16x16x32_bf16 a[208:211], v[40:43], v[232:235], a[208:211]
  v_mfma_f32_16x16x32_bf16 a[208:211], v[44:47], v[236:239], a[208:211]
  buffer_load_dwordx4 v[200:203], v12, s[20:23], s40 offen offset:512
  v_mfma_f32_16x16x32_bf16 v[112:115], v[40:43], v[240:243], v[112:115]
  v_mfma_f32_16x16x32_bf16 v[112:115], v[44:47], v[244:247], v[112:115]
  s_add_u32 m0, s35, 35840
  s_add_u32 s34, s50, 2818048
  buffer_load_dwordx4 v11, s[16:19], s34 offen lds
  s_waitcnt lgkmcnt(6)
  v_mfma_f32_16x16x32_bf16 a[20:23], v[48:51], v[208:211], a[20:23]
  ds_read_b64_tr_b16 v[24:25], v6 offset:8192
  ds_read_b64_tr_b16 v[26:27], v6 offset:8704
  s_waitcnt lgkmcnt(6)
  v_mfma_f32_16x16x32_bf16 a[20:23], v[52:55], v[212:215], a[20:23]
  ds_read_b64_tr_b16 v[28:29], v6 offset:12288
  ds_read_b64_tr_b16 v[30:31], v6 offset:12800
  v_mfma_f32_16x16x32_bf16 a[84:87], v[48:51], v[216:219], a[84:87]
  ds_read_b64_tr_b16 v[40:41], v3 offset:49152
  ds_read_b64_tr_b16 v[42:43], v3 offset:49664
  v_mfma_f32_16x16x32_bf16 a[84:87], v[52:55], v[220:223], a[84:87]
  ds_read_b64_tr_b16 v[44:45], v3 offset:53248
  ds_read_b64_tr_b16 v[46:47], v3 offset:53760
  v_mfma_f32_16x16x32_bf16 a[148:151], v[48:51], v[224:227], a[148:151]
  v_mfma_f32_16x16x32_bf16 a[148:151], v[52:55], v[228:231], a[148:151]
  s_add_u32 m0, s35, 36864
  s_add_u32 s34, s50, 2883584
  buffer_load_dwordx4 v10, s[16:19], s34 offen lds
  v_mfma_f32_16x16x32_bf16 a[212:215], v[48:51], v[232:235], a[212:215]
  v_mfma_f32_16x16x32_bf16 a[212:215], v[52:55], v[236:239], a[212:215]
  v_mfma_f32_16x16x32_bf16 v[116:119], v[48:51], v[240:243], v[116:119]
  v_mfma_f32_16x16x32_bf16 v[116:119], v[52:55], v[244:247], v[116:119]
  ds_read_b64_tr_b16 v[48:49], v4 offset:49152
  ds_read_b64_tr_b16 v[50:51], v4 offset:49664
  s_waitcnt lgkmcnt(12)
  v_mfma_f32_16x16x32_bf16 a[24:27], v[56:59], v[208:211], a[24:27]
  buffer_load_dwordx4 v[204:207], v12, s[20:23], s40 offen offset:576
  ds_read_b64_tr_b16 v[52:53], v4 offset:53248
  s_waitcnt lgkmcnt(11)
  v_mfma_f32_16x16x32_bf16 a[24:27], v[60:63], v[212:215], a[24:27]
  s_add_u32 m0, s35, 37888
  s_add_u32 s34, s50, 2949120
  buffer_load_dwordx4 v11, s[16:19], s34 offen lds
  v_mfma_f32_16x16x32_bf16 a[88:91], v[56:59], v[216:219], a[88:91]
  ds_read_b64_tr_b16 v[54:55], v4 offset:53760
  v_mfma_f32_16x16x32_bf16 a[88:91], v[60:63], v[220:223], a[88:91]
  v_mfma_f32_16x16x32_bf16 a[152:155], v[56:59], v[224:227], a[152:155]
  v_mfma_f32_16x16x32_bf16 a[152:155], v[60:63], v[228:231], a[152:155]
  v_mfma_f32_16x16x32_bf16 a[216:219], v[56:59], v[232:235], a[216:219]
  v_mfma_f32_16x16x32_bf16 a[216:219], v[60:63], v[236:239], a[216:219]
  s_add_u32 m0, s35, 38912
  s_add_u32 s34, s50, 3014656
  buffer_load_dwordx4 v10, s[16:19], s34 offen lds
  v_mfma_f32_16x16x32_bf16 v[120:123], v[56:59], v[240:243], v[120:123]
  v_mfma_f32_16x16x32_bf16 v[120:123], v[60:63], v[244:247], v[120:123]
  ds_read_b64_tr_b16 v[56:57], v5 offset:49152
  ds_read_b64_tr_b16 v[58:59], v5 offset:49664
  s_waitcnt lgkmcnt(12)
  v_mfma_f32_16x16x32_bf16 a[28:31], v[24:27], v[208:211], a[28:31]
  ds_read_b64_tr_b16 v[60:61], v5 offset:53248
  ds_read_b64_tr_b16 v[62:63], v5 offset:53760
  s_waitcnt lgkmcnt(12)
  v_mfma_f32_16x16x32_bf16 a[28:31], v[28:31], v[212:215], a[28:31]
  v_mfma_f32_16x16x32_bf16 a[92:95], v[24:27], v[216:219], a[92:95]
  v_mfma_f32_16x16x32_bf16 a[92:95], v[28:31], v[220:223], a[92:95]
  s_add_u32 m0, s35, 39936
  s_add_u32 s34, s50, 3080192
  buffer_load_dwordx4 v11, s[16:19], s34 offen lds
  v_mfma_f32_16x16x32_bf16 a[156:159], v[24:27], v[224:227], a[156:159]
  v_mfma_f32_16x16x32_bf16 a[156:159], v[28:31], v[228:231], a[156:159]
  v_mfma_f32_16x16x32_bf16 a[220:223], v[24:27], v[232:235], a[220:223]
  v_mfma_f32_16x16x32_bf16 a[220:223], v[28:31], v[236:239], a[220:223]
  v_mfma_f32_16x16x32_bf16 v[124:127], v[24:27], v[240:243], v[124:127]
  v_mfma_f32_16x16x32_bf16 v[124:127], v[28:31], v[244:247], v[124:127]
  s_waitcnt vmcnt(35) lgkmcnt(10)
  v_mfma_f32_16x16x32_bf16 a[32:35], v[40:43], v[128:131], a[32:35]
  s_waitcnt vmcnt(34) lgkmcnt(8)
  v_mfma_f32_16x16x32_bf16 a[32:35], v[44:47], v[132:135], a[32:35]
  s_waitcnt vmcnt(33)
  v_mfma_f32_16x16x32_bf16 a[96:99], v[40:43], v[136:139], a[96:99]
  s_waitcnt vmcnt(32)
  v_mfma_f32_16x16x32_bf16 a[96:99], v[44:47], v[140:143], a[96:99]
  s_waitcnt vmcnt(31)
  v_mfma_f32_16x16x32_bf16 a[160:163], v[40:43], v[144:147], a[160:163]
  s_waitcnt vmcnt(30)
  v_mfma_f32_16x16x32_bf16 a[160:163], v[44:47], v[148:151], a[160:163]
  s_waitcnt vmcnt(29)
  v_mfma_f32_16x16x32_bf16 a[224:227], v[40:43], v[152:155], a[224:227]
  s_waitcnt vmcnt(27)
  v_mfma_f32_16x16x32_bf16 a[224:227], v[44:47], v[156:159], a[224:227]
  ds_read_b64_tr_b16 v[24:25], v6 offset:49152
  ds_read_b64_tr_b16 v[26:27], v6 offset:49664
  s_waitcnt lgkmcnt(8)
  v_mfma_f32_16x16x32_bf16 a[36:39], v[48:51], v[128:131], a[36:39]
  ds_read_b64_tr_b16 v[28:29], v6 offset:53248
  ds_read_b64_tr_b16 v[30:31], v6 offset:53760
  s_waitcnt lgkmcnt(8)
  v_mfma_f32_16x16x32_bf16 a[36:39], v[52:55], v[132:135], a[36:39]
  buffer_load_dwordx4 v[208:211], v12, s[20:23], s36 offen offset:640
  v_mfma_f32_16x16x32_bf16 a[100:103], v[48:51], v[136:139], a[100:103]
  v_mfma_f32_16x16x32_bf16 a[100:103], v[52:55], v[140:143], a[100:103]
  v_mfma_f32_16x16x32_bf16 a[164:167], v[48:51], v[144:147], a[164:167]
  v_mfma_f32_16x16x32_bf16 a[164:167], v[52:55], v[148:151], a[164:167]
  v_mfma_f32_16x16x32_bf16 a[228:231], v[48:51], v[152:155], a[228:231]
  v_mfma_f32_16x16x32_bf16 a[228:231], v[52:55], v[156:159], a[228:231]
  ds_read_b64_tr_b16 v[32:33], v3 offset:57344
  ds_read_b64_tr_b16 v[34:35], v3 offset:57856
  s_waitcnt lgkmcnt(8)
  v_mfma_f32_16x16x32_bf16 a[40:43], v[56:59], v[128:131], a[40:43]
  ds_read_b64_tr_b16 v[36:37], v3 offset:61440
  ds_read_b64_tr_b16 v[38:39], v3 offset:61952
  s_waitcnt lgkmcnt(8)
  v_mfma_f32_16x16x32_bf16 a[40:43], v[60:63], v[132:135], a[40:43]
  v_mfma_f32_16x16x32_bf16 a[104:107], v[56:59], v[136:139], a[104:107]
  v_mfma_f32_16x16x32_bf16 a[104:107], v[60:63], v[140:143], a[104:107]
  v_mfma_f32_16x16x32_bf16 a[168:171], v[56:59], v[144:147], a[168:171]
  buffer_load_dwordx4 v[212:215], v12, s[20:23], s36 offen offset:704
  v_mfma_f32_16x16x32_bf16 a[168:171], v[60:63], v[148:151], a[168:171]
  v_mfma_f32_16x16x32_bf16 a[232:235], v[56:59], v[152:155], a[232:235]
  v_mfma_f32_16x16x32_bf16 a[232:235], v[60:63], v[156:159], a[232:235]
  ds_read_b64_tr_b16 v[48:49], v4 offset:57344
  ds_read_b64_tr_b16 v[50:51], v4 offset:57856
  s_waitcnt lgkmcnt(8)
  v_mfma_f32_16x16x32_bf16 a[44:47], v[24:27], v[128:131], a[44:47]
  ds_read_b64_tr_b16 v[52:53], v4 offset:61440
  ds_read_b64_tr_b16 v[54:55], v4 offset:61952
  s_waitcnt lgkmcnt(8)
  v_mfma_f32_16x16x32_bf16 a[44:47], v[28:31], v[132:135], a[44:47]
  v_mfma_f32_16x16x32_bf16 a[108:111], v[24:27], v[136:139], a[108:111]
  v_mfma_f32_16x16x32_bf16 a[108:111], v[28:31], v[140:143], a[108:111]
  v_mfma_f32_16x16x32_bf16 a[172:175], v[24:27], v[144:147], a[172:175]
  v_mfma_f32_16x16x32_bf16 a[172:175], v[28:31], v[148:151], a[172:175]
  v_mfma_f32_16x16x32_bf16 a[236:239], v[24:27], v[152:155], a[236:239]
  v_mfma_f32_16x16x32_bf16 a[236:239], v[28:31], v[156:159], a[236:239]
  ds_read_b64_tr_b16 v[56:57], v5 offset:57344
  ds_read_b64_tr_b16 v[58:59], v5 offset:57856
  s_waitcnt lgkmcnt(8)
  v_mfma_f32_16x16x32_bf16 a[48:51], v[32:35], v[128:131], a[48:51]
  ds_read_b64_tr_b16 v[60:61], v5 offset:61440
  ds_read_b64_tr_b16 v[62:63], v5 offset:61952
  s_waitcnt lgkmcnt(8)
  v_mfma_f32_16x16x32_bf16 a[48:51], v[36:39], v[132:135], a[48:51]
  buffer_load_dwordx4 v[216:219], v12, s[20:23], s37 offen offset:640
  v_mfma_f32_16x16x32_bf16 a[112:115], v[32:35], v[136:139], a[112:115]
  v_mfma_f32_16x16x32_bf16 a[112:115], v[36:39], v[140:143], a[112:115]
  v_mfma_f32_16x16x32_bf16 a[176:179], v[32:35], v[144:147], a[176:179]
  v_mfma_f32_16x16x32_bf16 a[176:179], v[36:39], v[148:151], a[176:179]
  v_mfma_f32_16x16x32_bf16 a[240:243], v[32:35], v[152:155], a[240:243]
  v_mfma_f32_16x16x32_bf16 a[240:243], v[36:39], v[156:159], a[240:243]
  ds_read_b64_tr_b16 v[40:41], v6 offset:57344
  ds_read_b64_tr_b16 v[42:43], v6 offset:57856
  s_waitcnt lgkmcnt(8)
  v_mfma_f32_16x16x32_bf16 a[52:55], v[48:51], v[128:131], a[52:55]
  ds_read_b64_tr_b16 v[44:45], v6 offset:61440
  ds_read_b64_tr_b16 v[46:47], v6 offset:61952
  s_waitcnt lgkmcnt(8)
  v_mfma_f32_16x16x32_bf16 a[52:55], v[52:55], v[132:135], a[52:55]
  v_mfma_f32_16x16x32_bf16 a[116:119], v[48:51], v[136:139], a[116:119]
  v_mfma_f32_16x16x32_bf16 a[116:119], v[52:55], v[140:143], a[116:119]
  v_mfma_f32_16x16x32_bf16 a[180:183], v[48:51], v[144:147], a[180:183]
  v_mfma_f32_16x16x32_bf16 a[180:183], v[52:55], v[148:151], a[180:183]
  v_mfma_f32_16x16x32_bf16 a[244:247], v[48:51], v[152:155], a[244:247]
  buffer_load_dwordx4 v[220:223], v12, s[20:23], s37 offen offset:704
  v_mfma_f32_16x16x32_bf16 a[244:247], v[52:55], v[156:159], a[244:247]
  ds_read_b64_tr_b16 v[24:25], v3 offset:32768
  ds_read_b64_tr_b16 v[26:27], v3 offset:33280
  s_waitcnt lgkmcnt(8)
  v_mfma_f32_16x16x32_bf16 a[56:59], v[56:59], v[128:131], a[56:59]
  ds_read_b64_tr_b16 v[28:29], v3 offset:36864
  ds_read_b64_tr_b16 v[30:31], v3 offset:37376
  s_waitcnt lgkmcnt(8)
  v_mfma_f32_16x16x32_bf16 a[56:59], v[60:63], v[132:135], a[56:59]
  v_mfma_f32_16x16x32_bf16 a[120:123], v[56:59], v[136:139], a[120:123]
  v_mfma_f32_16x16x32_bf16 a[120:123], v[60:63], v[140:143], a[120:123]
  v_mfma_f32_16x16x32_bf16 a[184:187], v[56:59], v[144:147], a[184:187]
  v_mfma_f32_16x16x32_bf16 a[184:187], v[60:63], v[148:151], a[184:187]
  v_mfma_f32_16x16x32_bf16 a[248:251], v[56:59], v[152:155], a[248:251]
  v_mfma_f32_16x16x32_bf16 a[248:251], v[60:63], v[156:159], a[248:251]
  ds_read_b64_tr_b16 v[48:49], v4 offset:32768
  ds_read_b64_tr_b16 v[50:51], v4 offset:33280
  s_waitcnt lgkmcnt(8)
  v_mfma_f32_16x16x32_bf16 a[60:63], v[40:43], v[128:131], a[60:63]
  ds_read_b64_tr_b16 v[52:53], v4 offset:36864
  ds_read_b64_tr_b16 v[54:55], v4 offset:37376
  s_waitcnt lgkmcnt(8)
  v_mfma_f32_16x16x32_bf16 a[60:63], v[44:47], v[132:135], a[60:63]
  v_mfma_f32_16x16x32_bf16 a[124:127], v[40:43], v[136:139], a[124:127]
  v_mfma_f32_16x16x32_bf16 a[124:127], v[44:47], v[140:143], a[124:127]
  buffer_load_dwordx4 v[224:227], v12, s[20:23], s38 offen offset:640
  v_mfma_f32_16x16x32_bf16 a[188:191], v[40:43], v[144:147], a[188:191]
  v_mfma_f32_16x16x32_bf16 a[188:191], v[44:47], v[148:151], a[188:191]
  v_mfma_f32_16x16x32_bf16 a[252:255], v[40:43], v[152:155], a[252:255]
  v_mfma_f32_16x16x32_bf16 a[252:255], v[44:47], v[156:159], a[252:255]
  ds_read_b64_tr_b16 v[56:57], v5 offset:32768
  ds_read_b64_tr_b16 v[58:59], v5 offset:33280
  s_waitcnt lgkmcnt(8)
  v_mfma_f32_16x16x32_bf16 a[0:3], v[24:27], v[128:131], a[0:3]
  ds_read_b64_tr_b16 v[60:61], v5 offset:36864
  ds_read_b64_tr_b16 v[62:63], v5 offset:37376
  s_waitcnt lgkmcnt(8)
  v_mfma_f32_16x16x32_bf16 a[0:3], v[28:31], v[132:135], a[0:3]
  v_mfma_f32_16x16x32_bf16 a[64:67], v[24:27], v[136:139], a[64:67]
  v_mfma_f32_16x16x32_bf16 a[64:67], v[28:31], v[140:143], a[64:67]
  v_mfma_f32_16x16x32_bf16 a[128:131], v[24:27], v[144:147], a[128:131]
  v_mfma_f32_16x16x32_bf16 a[128:131], v[28:31], v[148:151], a[128:131]
  v_mfma_f32_16x16x32_bf16 a[192:195], v[24:27], v[152:155], a[192:195]
  v_mfma_f32_16x16x32_bf16 a[192:195], v[28:31], v[156:159], a[192:195]
  s_waitcnt vmcnt(29)
  v_mfma_f32_16x16x32_bf16 v[96:99], v[24:27], v[160:163], v[96:99]
  buffer_load_dwordx4 v[228:231], v12, s[20:23], s38 offen offset:704
  s_waitcnt vmcnt(27)
  v_mfma_f32_16x16x32_bf16 v[96:99], v[28:31], v[164:167], v[96:99]
  ds_read_b64_tr_b16 v[32:33], v6 offset:32768
  ds_read_b64_tr_b16 v[34:35], v6 offset:33280
  s_waitcnt lgkmcnt(8)
  v_mfma_f32_16x16x32_bf16 a[4:7], v[48:51], v[128:131], a[4:7]
  ds_read_b64_tr_b16 v[36:37], v6 offset:36864
  ds_read_b64_tr_b16 v[38:39], v6 offset:37376
  s_waitcnt lgkmcnt(8)
  v_mfma_f32_16x16x32_bf16 a[4:7], v[52:55], v[132:135], a[4:7]
  v_mfma_f32_16x16x32_bf16 a[68:71], v[48:51], v[136:139], a[68:71]
  v_mfma_f32_16x16x32_bf16 a[68:71], v[52:55], v[140:143], a[68:71]
  v_mfma_f32_16x16x32_bf16 a[132:135], v[48:51], v[144:147], a[132:135]
  v_mfma_f32_16x16x32_bf16 a[132:135], v[52:55], v[148:151], a[132:135]
  v_mfma_f32_16x16x32_bf16 a[196:199], v[48:51], v[152:155], a[196:199]
  v_mfma_f32_16x16x32_bf16 a[196:199], v[52:55], v[156:159], a[196:199]
  v_mfma_f32_16x16x32_bf16 v[100:103], v[48:51], v[160:163], v[100:103]
  v_mfma_f32_16x16x32_bf16 v[100:103], v[52:55], v[164:167], v[100:103]
  ds_read_b64_tr_b16 v[40:41], v3 offset:40960
  ds_read_b64_tr_b16 v[42:43], v3 offset:41472
  s_waitcnt lgkmcnt(8)
  v_mfma_f32_16x16x32_bf16 a[8:11], v[56:59], v[128:131], a[8:11]
  ds_read_b64_tr_b16 v[44:45], v3 offset:45056
  ds_read_b64_tr_b16 v[46:47], v3 offset:45568
  s_waitcnt lgkmcnt(8)
  v_mfma_f32_16x16x32_bf16 a[8:11], v[60:63], v[132:135], a[8:11]
  buffer_load_dwordx4 v[232:235], v12, s[20:23], s39 offen offset:640
  v_mfma_f32_16x16x32_bf16 a[72:75], v[56:59], v[136:139], a[72:75]
  v_mfma_f32_16x16x32_bf16 a[72:75], v[60:63], v[140:143], a[72:75]
  v_mfma_f32_16x16x32_bf16 a[136:139], v[56:59], v[144:147], a[136:139]
  v_mfma_f32_16x16x32_bf16 a[136:139], v[60:63], v[148:151], a[136:139]
  v_mfma_f32_16x16x32_bf16 a[200:203], v[56:59], v[152:155], a[200:203]
  v_mfma_f32_16x16x32_bf16 a[200:203], v[60:63], v[156:159], a[200:203]
  v_mfma_f32_16x16x32_bf16 v[104:107], v[56:59], v[160:163], v[104:107]
  v_mfma_f32_16x16x32_bf16 v[104:107], v[60:63], v[164:167], v[104:107]
  ds_read_b64_tr_b16 v[48:49], v4 offset:40960
  ds_read_b64_tr_b16 v[50:51], v4 offset:41472
  s_waitcnt lgkmcnt(8)
  v_mfma_f32_16x16x32_bf16 a[12:15], v[32:35], v[128:131], a[12:15]
  s_waitcnt vmcnt(25)
  s_barrier
  ds_read_b64_tr_b16 v[52:53], v4 offset:45056
  s_waitcnt lgkmcnt(7)
  v_mfma_f32_16x16x32_bf16 a[12:15], v[36:39], v[132:135], a[12:15]
  s_add_u32 m0, s35, 65536
  s_add_u32 s34, s50, 3145728
  buffer_load_dwordx4 v10, s[16:19], s34 offen lds
  v_mfma_f32_16x16x32_bf16 a[76:79], v[32:35], v[136:139], a[76:79]
  ds_read_b64_tr_b16 v[54:55], v4 offset:45568
  v_mfma_f32_16x16x32_bf16 a[76:79], v[36:39], v[140:143], a[76:79]
  v_mfma_f32_16x16x32_bf16 a[140:143], v[32:35], v[144:147], a[140:143]
  buffer_load_dwordx4 v[236:239], v12, s[20:23], s39 offen offset:704
  v_mfma_f32_16x16x32_bf16 a[140:143], v[36:39], v[148:151], a[140:143]
  v_mfma_f32_16x16x32_bf16 a[204:207], v[32:35], v[152:155], a[204:207]
  v_mfma_f32_16x16x32_bf16 a[204:207], v[36:39], v[156:159], a[204:207]
  s_add_u32 m0, s35, 66560
  s_add_u32 s34, s50, 3211264
  buffer_load_dwordx4 v11, s[16:19], s34 offen lds
  v_mfma_f32_16x16x32_bf16 v[108:111], v[32:35], v[160:163], v[108:111]
  v_mfma_f32_16x16x32_bf16 v[108:111], v[36:39], v[164:167], v[108:111]
  ds_read_b64_tr_b16 v[56:57], v5 offset:40960
  ds_read_b64_tr_b16 v[58:59], v5 offset:41472
  s_waitcnt lgkmcnt(8)
  v_mfma_f32_16x16x32_bf16 a[16:19], v[40:43], v[128:131], a[16:19]
  ds_read_b64_tr_b16 v[60:61], v5 offset:45056
  ds_read_b64_tr_b16 v[62:63], v5 offset:45568
  s_waitcnt lgkmcnt(8)
  v_mfma_f32_16x16x32_bf16 a[16:19], v[44:47], v[132:135], a[16:19]
  v_mfma_f32_16x16x32_bf16 a[80:83], v[40:43], v[136:139], a[80:83]
  v_mfma_f32_16x16x32_bf16 a[80:83], v[44:47], v[140:143], a[80:83]
  s_add_u32 m0, s35, 67584
  s_add_u32 s34, s50, 3276800
  buffer_load_dwordx4 v10, s[16:19], s34 offen lds
  v_mfma_f32_16x16x32_bf16 a[144:147], v[40:43], v[144:147], a[144:147]
  v_mfma_f32_16x16x32_bf16 a[144:147], v[44:47], v[148:151], a[144:147]
  v_mfma_f32_16x16x32_bf16 a[208:211], v[40:43], v[152:155], a[208:211]
  v_mfma_f32_16x16x32_bf16 a[208:211], v[44:47], v[156:159], a[208:211]
  buffer_load_dwordx4 v[240:243], v12, s[20:23], s40 offen offset:640
  v_mfma_f32_16x16x32_bf16 v[112:115], v[40:43], v[160:163], v[112:115]
  v_mfma_f32_16x16x32_bf16 v[112:115], v[44:47], v[164:167], v[112:115]
  s_add_u32 m0, s35, 68608
  s_add_u32 s34, s50, 3342336
  buffer_load_dwordx4 v11, s[16:19], s34 offen lds
  s_waitcnt lgkmcnt(6)
  v_mfma_f32_16x16x32_bf16 a[20:23], v[48:51], v[128:131], a[20:23]
  ds_read_b64_tr_b16 v[24:25], v6 offset:40960
  ds_read_b64_tr_b16 v[26:27], v6 offset:41472
  s_waitcnt lgkmcnt(6)
  v_mfma_f32_16x16x32_bf16 a[20:23], v[52:55], v[132:135], a[20:23]
  ds_read_b64_tr_b16 v[28:29], v6 offset:45056
  ds_read_b64_tr_b16 v[30:31], v6 offset:45568
  v_mfma_f32_16x16x32_bf16 a[84:87], v[48:51], v[136:139], a[84:87]
  v_mfma_f32_16x16x32_bf16 a[84:87], v[52:55], v[140:143], a[84:87]
  v_mfma_f32_16x16x32_bf16 a[148:151], v[48:51], v[144:147], a[148:151]
  v_mfma_f32_16x16x32_bf16 a[148:151], v[52:55], v[148:151], a[148:151]
  s_add_u32 m0, s35, 69632
  s_add_u32 s34, s50, 3407872
  buffer_load_dwordx4 v10, s[16:19], s34 offen lds
  v_mfma_f32_16x16x32_bf16 a[212:215], v[48:51], v[152:155], a[212:215]
  v_mfma_f32_16x16x32_bf16 a[212:215], v[52:55], v[156:159], a[212:215]
  v_mfma_f32_16x16x32_bf16 v[116:119], v[48:51], v[160:163], v[116:119]
  v_mfma_f32_16x16x32_bf16 v[116:119], v[52:55], v[164:167], v[116:119]
  s_waitcnt lgkmcnt(6)
  v_mfma_f32_16x16x32_bf16 a[24:27], v[56:59], v[128:131], a[24:27]
  buffer_load_dwordx4 v[244:247], v12, s[20:23], s40 offen offset:704
  s_waitcnt lgkmcnt(4)
  v_mfma_f32_16x16x32_bf16 a[24:27], v[60:63], v[132:135], a[24:27]
  s_add_u32 m0, s35, 70656
  s_add_u32 s34, s50, 3473408
  buffer_load_dwordx4 v11, s[16:19], s34 offen lds
  v_mfma_f32_16x16x32_bf16 a[88:91], v[56:59], v[136:139], a[88:91]
  v_mfma_f32_16x16x32_bf16 a[88:91], v[60:63], v[140:143], a[88:91]
  v_mfma_f32_16x16x32_bf16 a[152:155], v[56:59], v[144:147], a[152:155]
  v_mfma_f32_16x16x32_bf16 a[152:155], v[60:63], v[148:151], a[152:155]
  v_mfma_f32_16x16x32_bf16 a[216:219], v[56:59], v[152:155], a[216:219]
  v_xor_b32 v3, 65536, v3
  v_xor_b32 v4, 65536, v4
  v_mfma_f32_16x16x32_bf16 a[216:219], v[60:63], v[156:159], a[216:219]
  s_add_u32 m0, s35, 71680
  s_add_u32 s34, s50, 3538944
  buffer_load_dwordx4 v10, s[16:19], s34 offen lds
  v_mfma_f32_16x16x32_bf16 v[120:123], v[56:59], v[160:163], v[120:123]
  v_xor_b32 v5, 65536, v5
  v_xor_b32 v6, 65536, v6
  v_mfma_f32_16x16x32_bf16 v[120:123], v[60:63], v[164:167], v[120:123]
  ds_read_b64_tr_b16 v[40:41], v3 offset:16384
  ds_read_b64_tr_b16 v[42:43], v3 offset:16896
  s_waitcnt lgkmcnt(4)
  v_mfma_f32_16x16x32_bf16 a[28:31], v[24:27], v[128:131], a[28:31]
  ds_read_b64_tr_b16 v[44:45], v3 offset:20480
  ds_read_b64_tr_b16 v[46:47], v3 offset:20992
  s_waitcnt lgkmcnt(4)
  v_mfma_f32_16x16x32_bf16 a[28:31], v[28:31], v[132:135], a[28:31]
  ds_read_b64_tr_b16 v[48:49], v4 offset:16384
  ds_read_b64_tr_b16 v[50:51], v4 offset:16896
  v_mfma_f32_16x16x32_bf16 a[92:95], v[24:27], v[136:139], a[92:95]
  ds_read_b64_tr_b16 v[52:53], v4 offset:20480
  ds_read_b64_tr_b16 v[54:55], v4 offset:20992
  v_mfma_f32_16x16x32_bf16 a[92:95], v[28:31], v[140:143], a[92:95]
  s_add_u32 m0, s35, 72704
  s_add_u32 s34, s50, 3604480
  buffer_load_dwordx4 v11, s[16:19], s34 offen lds
  v_mfma_f32_16x16x32_bf16 a[156:159], v[24:27], v[144:147], a[156:159]
  ds_read_b64_tr_b16 v[56:57], v5 offset:16384
  ds_read_b64_tr_b16 v[58:59], v5 offset:16896
  v_mfma_f32_16x16x32_bf16 a[156:159], v[28:31], v[148:151], a[156:159]
  ds_read_b64_tr_b16 v[60:61], v5 offset:20480
  ds_read_b64_tr_b16 v[62:63], v5 offset:20992
  v_mfma_f32_16x16x32_bf16 a[220:223], v[24:27], v[152:155], a[220:223]
  v_mfma_f32_16x16x32_bf16 a[220:223], v[28:31], v[156:159], a[220:223]
  v_mfma_f32_16x16x32_bf16 v[124:127], v[24:27], v[160:163], v[124:127]
  v_mfma_f32_16x16x32_bf16 v[124:127], v[28:31], v[164:167], v[124:127]
  s_waitcnt vmcnt(35) lgkmcnt(10)
  v_mfma_f32_16x16x32_bf16 a[32:35], v[40:43], v[168:171], a[32:35]
  s_waitcnt vmcnt(34) lgkmcnt(8)
  v_mfma_f32_16x16x32_bf16 a[32:35], v[44:47], v[172:175], a[32:35]
  s_waitcnt vmcnt(33)
  v_mfma_f32_16x16x32_bf16 a[96:99], v[40:43], v[176:179], a[96:99]
  s_waitcnt vmcnt(32)
  v_mfma_f32_16x16x32_bf16 a[96:99], v[44:47], v[180:183], a[96:99]
  s_waitcnt vmcnt(31)
  v_mfma_f32_16x16x32_bf16 a[160:163], v[40:43], v[184:187], a[160:163]
  s_waitcnt vmcnt(30)
  v_mfma_f32_16x16x32_bf16 a[160:163], v[44:47], v[188:191], a[160:163]
  s_waitcnt vmcnt(29)
  v_mfma_f32_16x16x32_bf16 a[224:227], v[40:43], v[192:195], a[224:227]
  s_waitcnt vmcnt(27)
  v_mfma_f32_16x16x32_bf16 a[224:227], v[44:47], v[196:199], a[224:227]
  ds_read_b64_tr_b16 v[24:25], v6 offset:16384
  ds_read_b64_tr_b16 v[26:27], v6 offset:16896
  s_waitcnt lgkmcnt(8)
  v_mfma_f32_16x16x32_bf16 a[36:39], v[48:51], v[168:171], a[36:39]
  ds_read_b64_tr_b16 v[28:29], v6 offset:20480
  ds_read_b64_tr_b16 v[30:31], v6 offset:20992
  s_waitcnt lgkmcnt(8)
  v_mfma_f32_16x16x32_bf16 a[36:39], v[52:55], v[172:175], a[36:39]
  buffer_load_dwordx4 v[64:67], v12, s[20:23], s36 offen offset:768
  v_mfma_f32_16x16x32_bf16 a[100:103], v[48:51], v[176:179], a[100:103]
  v_mfma_f32_16x16x32_bf16 a[100:103], v[52:55], v[180:183], a[100:103]
  v_mfma_f32_16x16x32_bf16 a[164:167], v[48:51], v[184:187], a[164:167]
  v_mfma_f32_16x16x32_bf16 a[164:167], v[52:55], v[188:191], a[164:167]
  v_mfma_f32_16x16x32_bf16 a[228:231], v[48:51], v[192:195], a[228:231]
  v_mfma_f32_16x16x32_bf16 a[228:231], v[52:55], v[196:199], a[228:231]
  ds_read_b64_tr_b16 v[32:33], v3 offset:24576
  ds_read_b64_tr_b16 v[34:35], v3 offset:25088
  s_waitcnt lgkmcnt(8)
  v_mfma_f32_16x16x32_bf16 a[40:43], v[56:59], v[168:171], a[40:43]
  ds_read_b64_tr_b16 v[36:37], v3 offset:28672
  ds_read_b64_tr_b16 v[38:39], v3 offset:29184
  s_waitcnt lgkmcnt(8)
  v_mfma_f32_16x16x32_bf16 a[40:43], v[60:63], v[172:175], a[40:43]
  v_mfma_f32_16x16x32_bf16 a[104:107], v[56:59], v[176:179], a[104:107]
  v_mfma_f32_16x16x32_bf16 a[104:107], v[60:63], v[180:183], a[104:107]
  v_mfma_f32_16x16x32_bf16 a[168:171], v[56:59], v[184:187], a[168:171]
  buffer_load_dwordx4 v[68:71], v12, s[20:23], s36 offen offset:832
  v_mfma_f32_16x16x32_bf16 a[168:171], v[60:63], v[188:191], a[168:171]
  v_mfma_f32_16x16x32_bf16 a[232:235], v[56:59], v[192:195], a[232:235]
  v_mfma_f32_16x16x32_bf16 a[232:235], v[60:63], v[196:199], a[232:235]
  ds_read_b64_tr_b16 v[48:49], v4 offset:24576
  ds_read_b64_tr_b16 v[50:51], v4 offset:25088
  s_waitcnt lgkmcnt(8)
  v_mfma_f32_16x16x32_bf16 a[44:47], v[24:27], v[168:171], a[44:47]
  ds_read_b64_tr_b16 v[52:53], v4 offset:28672
  ds_read_b64_tr_b16 v[54:55], v4 offset:29184
  s_waitcnt lgkmcnt(8)
  v_mfma_f32_16x16x32_bf16 a[44:47], v[28:31], v[172:175], a[44:47]
  v_mfma_f32_16x16x32_bf16 a[108:111], v[24:27], v[176:179], a[108:111]
  v_mfma_f32_16x16x32_bf16 a[108:111], v[28:31], v[180:183], a[108:111]
  v_mfma_f32_16x16x32_bf16 a[172:175], v[24:27], v[184:187], a[172:175]
  v_mfma_f32_16x16x32_bf16 a[172:175], v[28:31], v[188:191], a[172:175]
  v_mfma_f32_16x16x32_bf16 a[236:239], v[24:27], v[192:195], a[236:239]
  v_mfma_f32_16x16x32_bf16 a[236:239], v[28:31], v[196:199], a[236:239]
  ds_read_b64_tr_b16 v[56:57], v5 offset:24576
  ds_read_b64_tr_b16 v[58:59], v5 offset:25088
  s_waitcnt lgkmcnt(8)
  v_mfma_f32_16x16x32_bf16 a[48:51], v[32:35], v[168:171], a[48:51]
  ds_read_b64_tr_b16 v[60:61], v5 offset:28672
  ds_read_b64_tr_b16 v[62:63], v5 offset:29184
  s_waitcnt lgkmcnt(8)
  v_mfma_f32_16x16x32_bf16 a[48:51], v[36:39], v[172:175], a[48:51]
  buffer_load_dwordx4 v[72:75], v12, s[20:23], s37 offen offset:768
  v_mfma_f32_16x16x32_bf16 a[112:115], v[32:35], v[176:179], a[112:115]
  v_mfma_f32_16x16x32_bf16 a[112:115], v[36:39], v[180:183], a[112:115]
  v_mfma_f32_16x16x32_bf16 a[176:179], v[32:35], v[184:187], a[176:179]
  v_mfma_f32_16x16x32_bf16 a[176:179], v[36:39], v[188:191], a[176:179]
  v_mfma_f32_16x16x32_bf16 a[240:243], v[32:35], v[192:195], a[240:243]
  v_mfma_f32_16x16x32_bf16 a[240:243], v[36:39], v[196:199], a[240:243]
  ds_read_b64_tr_b16 v[40:41], v6 offset:24576
  ds_read_b64_tr_b16 v[42:43], v6 offset:25088
  s_waitcnt lgkmcnt(8)
  v_mfma_f32_16x16x32_bf16 a[52:55], v[48:51], v[168:171], a[52:55]
  ds_read_b64_tr_b16 v[44:45], v6 offset:28672
  ds_read_b64_tr_b16 v[46:47], v6 offset:29184
  s_waitcnt lgkmcnt(8)
  v_mfma_f32_16x16x32_bf16 a[52:55], v[52:55], v[172:175], a[52:55]
  v_mfma_f32_16x16x32_bf16 a[116:119], v[48:51], v[176:179], a[116:119]
  v_mfma_f32_16x16x32_bf16 a[116:119], v[52:55], v[180:183], a[116:119]
  v_mfma_f32_16x16x32_bf16 a[180:183], v[48:51], v[184:187], a[180:183]
  v_mfma_f32_16x16x32_bf16 a[180:183], v[52:55], v[188:191], a[180:183]
  v_mfma_f32_16x16x32_bf16 a[244:247], v[48:51], v[192:195], a[244:247]
  buffer_load_dwordx4 v[76:79], v12, s[20:23], s37 offen offset:832
  v_mfma_f32_16x16x32_bf16 a[244:247], v[52:55], v[196:199], a[244:247]
  ds_read_b64_tr_b16 v[24:25], v3 offset:0
  ds_read_b64_tr_b16 v[26:27], v3 offset:512
  s_waitcnt lgkmcnt(8)
  v_mfma_f32_16x16x32_bf16 a[56:59], v[56:59], v[168:171], a[56:59]
  ds_read_b64_tr_b16 v[28:29], v3 offset:4096
  ds_read_b64_tr_b16 v[30:31], v3 offset:4608
  s_waitcnt lgkmcnt(8)
  v_mfma_f32_16x16x32_bf16 a[56:59], v[60:63], v[172:175], a[56:59]
  v_mfma_f32_16x16x32_bf16 a[120:123], v[56:59], v[176:179], a[120:123]
  v_mfma_f32_16x16x32_bf16 a[120:123], v[60:63], v[180:183], a[120:123]
  v_mfma_f32_16x16x32_bf16 a[184:187], v[56:59], v[184:187], a[184:187]
  v_mfma_f32_16x16x32_bf16 a[184:187], v[60:63], v[188:191], a[184:187]
  v_mfma_f32_16x16x32_bf16 a[248:251], v[56:59], v[192:195], a[248:251]
  v_mfma_f32_16x16x32_bf16 a[248:251], v[60:63], v[196:199], a[248:251]
  ds_read_b64_tr_b16 v[48:49], v4 offset:0
  ds_read_b64_tr_b16 v[50:51], v4 offset:512
  s_waitcnt lgkmcnt(8)
  v_mfma_f32_16x16x32_bf16 a[60:63], v[40:43], v[168:171], a[60:63]
  ds_read_b64_tr_b16 v[52:53], v4 offset:4096
  ds_read_b64_tr_b16 v[54:55], v4 offset:4608
  s_waitcnt lgkmcnt(8)
  v_mfma_f32_16x16x32_bf16 a[60:63], v[44:47], v[172:175], a[60:63]
  v_mfma_f32_16x16x32_bf16 a[124:127], v[40:43], v[176:179], a[124:127]
  v_mfma_f32_16x16x32_bf16 a[124:127], v[44:47], v[180:183], a[124:127]
  buffer_load_dwordx4 v[80:83], v12, s[20:23], s38 offen offset:768
  v_mfma_f32_16x16x32_bf16 a[188:191], v[40:43], v[184:187], a[188:191]
  v_mfma_f32_16x16x32_bf16 a[188:191], v[44:47], v[188:191], a[188:191]
  v_mfma_f32_16x16x32_bf16 a[252:255], v[40:43], v[192:195], a[252:255]
  v_mfma_f32_16x16x32_bf16 a[252:255], v[44:47], v[196:199], a[252:255]
  ds_read_b64_tr_b16 v[56:57], v5 offset:0
  ds_read_b64_tr_b16 v[58:59], v5 offset:512
  s_waitcnt lgkmcnt(8)
  v_mfma_f32_16x16x32_bf16 a[0:3], v[24:27], v[168:171], a[0:3]
  ds_read_b64_tr_b16 v[60:61], v5 offset:4096
  ds_read_b64_tr_b16 v[62:63], v5 offset:4608
  s_waitcnt lgkmcnt(8)
  v_mfma_f32_16x16x32_bf16 a[0:3], v[28:31], v[172:175], a[0:3]
  v_mfma_f32_16x16x32_bf16 a[64:67], v[24:27], v[176:179], a[64:67]
  v_mfma_f32_16x16x32_bf16 a[64:67], v[28:31], v[180:183], a[64:67]
  v_mfma_f32_16x16x32_bf16 a[128:131], v[24:27], v[184:187], a[128:131]
  v_mfma_f32_16x16x32_bf16 a[128:131], v[28:31], v[188:191], a[128:131]
  v_mfma_f32_16x16x32_bf16 a[192:195], v[24:27], v[192:195], a[192:195]
  v_mfma_f32_16x16x32_bf16 a[192:195], v[28:31], v[196:199], a[192:195]
  s_waitcnt vmcnt(29)
  v_mfma_f32_16x16x32_bf16 v[96:99], v[24:27], v[200:203], v[96:99]
  buffer_load_dwordx4 v[84:87], v12, s[20:23], s38 offen offset:832
  s_waitcnt vmcnt(27)
  v_mfma_f32_16x16x32_bf16 v[96:99], v[28:31], v[204:207], v[96:99]
  ds_read_b64_tr_b16 v[32:33], v6 offset:0
  ds_read_b64_tr_b16 v[34:35], v6 offset:512
  s_waitcnt lgkmcnt(8)
  v_mfma_f32_16x16x32_bf16 a[4:7], v[48:51], v[168:171], a[4:7]
  ds_read_b64_tr_b16 v[36:37], v6 offset:4096
  ds_read_b64_tr_b16 v[38:39], v6 offset:4608
  s_waitcnt lgkmcnt(8)
  v_mfma_f32_16x16x32_bf16 a[4:7], v[52:55], v[172:175], a[4:7]
  v_mfma_f32_16x16x32_bf16 a[68:71], v[48:51], v[176:179], a[68:71]
  v_mfma_f32_16x16x32_bf16 a[68:71], v[52:55], v[180:183], a[68:71]
  v_mfma_f32_16x16x32_bf16 a[132:135], v[48:51], v[184:187], a[132:135]
  v_mfma_f32_16x16x32_bf16 a[132:135], v[52:55], v[188:191], a[132:135]
  v_mfma_f32_16x16x32_bf16 a[196:199], v[48:51], v[192:195], a[196:199]
  v_mfma_f32_16x16x32_bf16 a[196:199], v[52:55], v[196:199], a[196:199]
  v_mfma_f32_16x16x32_bf16 v[100:103], v[48:51], v[200:203], v[100:103]
  v_mfma_f32_16x16x32_bf16 v[100:103], v[52:55], v[204:207], v[100:103]
  ds_read_b64_tr_b16 v[40:41], v3 offset:8192
  ds_read_b64_tr_b16 v[42:43], v3 offset:8704
  s_waitcnt lgkmcnt(8)
  v_mfma_f32_16x16x32_bf16 a[8:11], v[56:59], v[168:171], a[8:11]
  ds_read_b64_tr_b16 v[44:45], v3 offset:12288
  ds_read_b64_tr_b16 v[46:47], v3 offset:12800
  s_waitcnt lgkmcnt(8)
  v_mfma_f32_16x16x32_bf16 a[8:11], v[60:63], v[172:175], a[8:11]
  buffer_load_dwordx4 v[88:91], v12, s[20:23], s39 offen offset:768
  v_mfma_f32_16x16x32_bf16 a[72:75], v[56:59], v[176:179], a[72:75]
  v_mfma_f32_16x16x32_bf16 a[72:75], v[60:63], v[180:183], a[72:75]
  v_mfma_f32_16x16x32_bf16 a[136:139], v[56:59], v[184:187], a[136:139]
  v_mfma_f32_16x16x32_bf16 a[136:139], v[60:63], v[188:191], a[136:139]
  v_mfma_f32_16x16x32_bf16 a[200:203], v[56:59], v[192:195], a[200:203]
  v_mfma_f32_16x16x32_bf16 a[200:203], v[60:63], v[196:199], a[200:203]
  v_mfma_f32_16x16x32_bf16 v[104:107], v[56:59], v[200:203], v[104:107]
  v_mfma_f32_16x16x32_bf16 v[104:107], v[60:63], v[204:207], v[104:107]
  ds_read_b64_tr_b16 v[48:49], v4 offset:8192
  ds_read_b64_tr_b16 v[50:51], v4 offset:8704
  s_waitcnt lgkmcnt(8)
  v_mfma_f32_16x16x32_bf16 a[12:15], v[32:35], v[168:171], a[12:15]
  s_waitcnt vmcnt(25)
  s_barrier
  ds_read_b64_tr_b16 v[52:53], v4 offset:12288
  s_waitcnt lgkmcnt(7)
  v_mfma_f32_16x16x32_bf16 a[12:15], v[36:39], v[172:175], a[12:15]
  s_add_u32 m0, s32, 0
  s_add_u32 s34, s30, 0
  buffer_load_dwordx4 v7, s[8:11], s34 offen nt lds
  v_mfma_f32_16x16x32_bf16 a[76:79], v[32:35], v[176:179], a[76:79]
  ds_read_b64_tr_b16 v[54:55], v4 offset:12800
  v_mfma_f32_16x16x32_bf16 a[76:79], v[36:39], v[180:183], a[76:79]
  v_mfma_f32_16x16x32_bf16 a[140:143], v[32:35], v[184:187], a[140:143]
  buffer_load_dwordx4 v[92:95], v12, s[20:23], s39 offen offset:832
  v_mfma_f32_16x16x32_bf16 a[140:143], v[36:39], v[188:191], a[140:143]
  v_mfma_f32_16x16x32_bf16 a[204:207], v[32:35], v[192:195], a[204:207]
  v_mfma_f32_16x16x32_bf16 a[204:207], v[36:39], v[196:199], a[204:207]
  s_add_u32 m0, s32, 1024
  s_add_u32 s34, s30, 4096
  buffer_load_dwordx4 v7, s[8:11], s34 offen nt lds
  v_mfma_f32_16x16x32_bf16 v[108:111], v[32:35], v[200:203], v[108:111]
  v_mfma_f32_16x16x32_bf16 v[108:111], v[36:39], v[204:207], v[108:111]
  ds_read_b64_tr_b16 v[56:57], v5 offset:8192
  ds_read_b64_tr_b16 v[58:59], v5 offset:8704
  s_waitcnt lgkmcnt(8)
  v_mfma_f32_16x16x32_bf16 a[16:19], v[40:43], v[168:171], a[16:19]
  ds_read_b64_tr_b16 v[60:61], v5 offset:12288
  ds_read_b64_tr_b16 v[62:63], v5 offset:12800
  s_waitcnt lgkmcnt(8)
  v_mfma_f32_16x16x32_bf16 a[16:19], v[44:47], v[172:175], a[16:19]
  v_mfma_f32_16x16x32_bf16 a[80:83], v[40:43], v[176:179], a[80:83]
  v_mfma_f32_16x16x32_bf16 a[80:83], v[44:47], v[180:183], a[80:83]
  s_add_u32 m0, s32, 2048
  s_add_u32 s34, s30, 8192
  buffer_load_dwordx4 v7, s[8:11], s34 offen nt lds
  v_mfma_f32_16x16x32_bf16 a[144:147], v[40:43], v[184:187], a[144:147]
  v_mfma_f32_16x16x32_bf16 a[144:147], v[44:47], v[188:191], a[144:147]
  v_mfma_f32_16x16x32_bf16 a[208:211], v[40:43], v[192:195], a[208:211]
  v_mfma_f32_16x16x32_bf16 a[208:211], v[44:47], v[196:199], a[208:211]
  buffer_load_dwordx4 v[16:19], v12, s[20:23], s40 offen offset:768
  v_mfma_f32_16x16x32_bf16 v[112:115], v[40:43], v[200:203], v[112:115]
  v_mfma_f32_16x16x32_bf16 v[112:115], v[44:47], v[204:207], v[112:115]
  s_add_u32 m0, s32, 3072
  s_add_u32 s34, s30, 12288
  buffer_load_dwordx4 v7, s[8:11], s34 offen nt lds
  s_waitcnt lgkmcnt(6)
  v_mfma_f32_16x16x32_bf16 a[20:23], v[48:51], v[168:171], a[20:23]
  ds_read_b64_tr_b16 v[24:25], v6 offset:8192
  ds_read_b64_tr_b16 v[26:27], v6 offset:8704
  s_waitcnt lgkmcnt(6)
  v_mfma_f32_16x16x32_bf16 a[20:23], v[52:55], v[172:175], a[20:23]
  ds_read_b64_tr_b16 v[28:29], v6 offset:12288
  ds_read_b64_tr_b16 v[30:31], v6 offset:12800
  v_mfma_f32_16x16x32_bf16 a[84:87], v[48:51], v[176:179], a[84:87]
  ds_read_b64_tr_b16 v[40:41], v3 offset:49152
  ds_read_b64_tr_b16 v[42:43], v3 offset:49664
  v_mfma_f32_16x16x32_bf16 a[84:87], v[52:55], v[180:183], a[84:87]
  ds_read_b64_tr_b16 v[44:45], v3 offset:53248
  ds_read_b64_tr_b16 v[46:47], v3 offset:53760
  v_mfma_f32_16x16x32_bf16 a[148:151], v[48:51], v[184:187], a[148:151]
  v_mfma_f32_16x16x32_bf16 a[148:151], v[52:55], v[188:191], a[148:151]
  s_add_u32 m0, s32, 4096
  s_add_u32 s34, s30, 16384
  buffer_load_dwordx4 v7, s[8:11], s34 offen nt lds
  v_mfma_f32_16x16x32_bf16 a[212:215], v[48:51], v[192:195], a[212:215]
  v_mfma_f32_16x16x32_bf16 a[212:215], v[52:55], v[196:199], a[212:215]
  v_mfma_f32_16x16x32_bf16 v[116:119], v[48:51], v[200:203], v[116:119]
  v_mfma_f32_16x16x32_bf16 v[116:119], v[52:55], v[204:207], v[116:119]
  ds_read_b64_tr_b16 v[48:49], v4 offset:49152
  ds_read_b64_tr_b16 v[50:51], v4 offset:49664
  s_waitcnt lgkmcnt(12)
  v_mfma_f32_16x16x32_bf16 a[24:27], v[56:59], v[168:171], a[24:27]
  buffer_load_dwordx4 v[20:23], v12, s[20:23], s40 offen offset:832
  ds_read_b64_tr_b16 v[52:53], v4 offset:53248
  s_waitcnt lgkmcnt(11)
  v_mfma_f32_16x16x32_bf16 a[24:27], v[60:63], v[172:175], a[24:27]
  s_add_u32 m0, s32, 5120
  s_add_u32 s34, s30, 20480
  buffer_load_dwordx4 v7, s[8:11], s34 offen nt lds
  v_mfma_f32_16x16x32_bf16 a[88:91], v[56:59], v[176:179], a[88:91]
  ds_read_b64_tr_b16 v[54:55], v4 offset:53760
  v_mfma_f32_16x16x32_bf16 a[88:91], v[60:63], v[180:183], a[88:91]
  v_mfma_f32_16x16x32_bf16 a[152:155], v[56:59], v[184:187], a[152:155]
  v_mfma_f32_16x16x32_bf16 a[152:155], v[60:63], v[188:191], a[152:155]
  v_mfma_f32_16x16x32_bf16 a[216:219], v[56:59], v[192:195], a[216:219]
  v_mfma_f32_16x16x32_bf16 a[216:219], v[60:63], v[196:199], a[216:219]
  s_add_u32 m0, s32, 6144
  s_add_u32 s34, s30, 24576
  buffer_load_dwordx4 v7, s[8:11], s34 offen nt lds
  v_mfma_f32_16x16x32_bf16 v[120:123], v[56:59], v[200:203], v[120:123]
  v_mfma_f32_16x16x32_bf16 v[120:123], v[60:63], v[204:207], v[120:123]
  ds_read_b64_tr_b16 v[56:57], v5 offset:49152
  ds_read_b64_tr_b16 v[58:59], v5 offset:49664
  s_waitcnt lgkmcnt(12)
  v_mfma_f32_16x16x32_bf16 a[28:31], v[24:27], v[168:171], a[28:31]
  ds_read_b64_tr_b16 v[60:61], v5 offset:53248
  ds_read_b64_tr_b16 v[62:63], v5 offset:53760
  s_waitcnt lgkmcnt(12)
  v_mfma_f32_16x16x32_bf16 a[28:31], v[28:31], v[172:175], a[28:31]
  v_mfma_f32_16x16x32_bf16 a[92:95], v[24:27], v[176:179], a[92:95]
  v_mfma_f32_16x16x32_bf16 a[92:95], v[28:31], v[180:183], a[92:95]
  s_add_u32 m0, s32, 7168
  s_add_u32 s34, s30, 28672
  buffer_load_dwordx4 v7, s[8:11], s34 offen nt lds
  s_add_u32 s30, s30, 32768
  s_xor_b32 s32, s32, 65536
  v_mfma_f32_16x16x32_bf16 a[156:159], v[24:27], v[184:187], a[156:159]
  v_mfma_f32_16x16x32_bf16 a[156:159], v[28:31], v[188:191], a[156:159]
  v_mfma_f32_16x16x32_bf16 a[220:223], v[24:27], v[192:195], a[220:223]
  v_mfma_f32_16x16x32_bf16 a[220:223], v[28:31], v[196:199], a[220:223]
  v_mfma_f32_16x16x32_bf16 v[124:127], v[24:27], v[200:203], v[124:127]
  v_mfma_f32_16x16x32_bf16 v[124:127], v[28:31], v[204:207], v[124:127]
  s_waitcnt vmcnt(35) lgkmcnt(10)
  v_mfma_f32_16x16x32_bf16 a[32:35], v[40:43], v[208:211], a[32:35]
  s_waitcnt vmcnt(34) lgkmcnt(8)
  v_mfma_f32_16x16x32_bf16 a[32:35], v[44:47], v[212:215], a[32:35]
  s_waitcnt vmcnt(33)
  v_mfma_f32_16x16x32_bf16 a[96:99], v[40:43], v[216:219], a[96:99]
  s_waitcnt vmcnt(32)
  v_mfma_f32_16x16x32_bf16 a[96:99], v[44:47], v[220:223], a[96:99]
  s_waitcnt vmcnt(31)
  v_mfma_f32_16x16x32_bf16 a[160:163], v[40:43], v[224:227], a[160:163]
  s_waitcnt vmcnt(30)
  v_mfma_f32_16x16x32_bf16 a[160:163], v[44:47], v[228:231], a[160:163]
  s_waitcnt vmcnt(29)
  v_mfma_f32_16x16x32_bf16 a[224:227], v[40:43], v[232:235], a[224:227]
  s_waitcnt vmcnt(27)
  v_mfma_f32_16x16x32_bf16 a[224:227], v[44:47], v[236:239], a[224:227]
  ds_read_b64_tr_b16 v[24:25], v6 offset:49152
  ds_read_b64_tr_b16 v[26:27], v6 offset:49664
  s_waitcnt lgkmcnt(8)
  v_mfma_f32_16x16x32_bf16 a[36:39], v[48:51], v[208:211], a[36:39]
  ds_read_b64_tr_b16 v[28:29], v6 offset:53248
  ds_read_b64_tr_b16 v[30:31], v6 offset:53760
  s_waitcnt lgkmcnt(8)
  v_mfma_f32_16x16x32_bf16 a[36:39], v[52:55], v[212:215], a[36:39]
  v_mfma_f32_16x16x32_bf16 a[100:103], v[48:51], v[216:219], a[100:103]
  v_mfma_f32_16x16x32_bf16 a[100:103], v[52:55], v[220:223], a[100:103]
  v_mfma_f32_16x16x32_bf16 a[164:167], v[48:51], v[224:227], a[164:167]
  v_mfma_f32_16x16x32_bf16 a[164:167], v[52:55], v[228:231], a[164:167]
  v_mfma_f32_16x16x32_bf16 a[228:231], v[48:51], v[232:235], a[228:231]
  v_mfma_f32_16x16x32_bf16 a[228:231], v[52:55], v[236:239], a[228:231]
  ds_read_b64_tr_b16 v[32:33], v3 offset:57344
  ds_read_b64_tr_b16 v[34:35], v3 offset:57856
  s_waitcnt lgkmcnt(8)
  v_mfma_f32_16x16x32_bf16 a[40:43], v[56:59], v[208:211], a[40:43]
  ds_read_b64_tr_b16 v[36:37], v3 offset:61440
  ds_read_b64_tr_b16 v[38:39], v3 offset:61952
  s_waitcnt lgkmcnt(8)
  v_mfma_f32_16x16x32_bf16 a[40:43], v[60:63], v[212:215], a[40:43]
  v_mfma_f32_16x16x32_bf16 a[104:107], v[56:59], v[216:219], a[104:107]
  v_mfma_f32_16x16x32_bf16 a[104:107], v[60:63], v[220:223], a[104:107]
  v_mfma_f32_16x16x32_bf16 a[168:171], v[56:59], v[224:227], a[168:171]
  v_mfma_f32_16x16x32_bf16 a[168:171], v[60:63], v[228:231], a[168:171]
  v_mfma_f32_16x16x32_bf16 a[232:235], v[56:59], v[232:235], a[232:235]
  v_mfma_f32_16x16x32_bf16 a[232:235], v[60:63], v[236:239], a[232:235]
  ds_read_b64_tr_b16 v[48:49], v4 offset:57344
  ds_read_b64_tr_b16 v[50:51], v4 offset:57856
  s_waitcnt lgkmcnt(8)
  v_mfma_f32_16x16x32_bf16 a[44:47], v[24:27], v[208:211], a[44:47]
  ds_read_b64_tr_b16 v[52:53], v4 offset:61440
  ds_read_b64_tr_b16 v[54:55], v4 offset:61952
  s_waitcnt lgkmcnt(8)
  v_mfma_f32_16x16x32_bf16 a[44:47], v[28:31], v[212:215], a[44:47]
  v_mfma_f32_16x16x32_bf16 a[108:111], v[24:27], v[216:219], a[108:111]
  v_mfma_f32_16x16x32_bf16 a[108:111], v[28:31], v[220:223], a[108:111]
  v_mfma_f32_16x16x32_bf16 a[172:175], v[24:27], v[224:227], a[172:175]
  v_mfma_f32_16x16x32_bf16 a[172:175], v[28:31], v[228:231], a[172:175]
  v_mfma_f32_16x16x32_bf16 a[236:239], v[24:27], v[232:235], a[236:239]
  v_mfma_f32_16x16x32_bf16 a[236:239], v[28:31], v[236:239], a[236:239]
  ds_read_b64_tr_b16 v[56:57], v5 offset:57344
  ds_read_b64_tr_b16 v[58:59], v5 offset:57856
  s_waitcnt lgkmcnt(8)
  v_mfma_f32_16x16x32_bf16 a[48:51], v[32:35], v[208:211], a[48:51]
  ds_read_b64_tr_b16 v[60:61], v5 offset:61440
  ds_read_b64_tr_b16 v[62:63], v5 offset:61952
  s_waitcnt lgkmcnt(8)
  v_mfma_f32_16x16x32_bf16 a[48:51], v[36:39], v[212:215], a[48:51]
  v_mfma_f32_16x16x32_bf16 a[112:115], v[32:35], v[216:219], a[112:115]
  v_mfma_f32_16x16x32_bf16 a[112:115], v[36:39], v[220:223], a[112:115]
  v_mfma_f32_16x16x32_bf16 a[176:179], v[32:35], v[224:227], a[176:179]
  v_mfma_f32_16x16x32_bf16 a[176:179], v[36:39], v[228:231], a[176:179]
  v_mfma_f32_16x16x32_bf16 a[240:243], v[32:35], v[232:235], a[240:243]
  v_mfma_f32_16x16x32_bf16 a[240:243], v[36:39], v[236:239], a[240:243]
  ds_read_b64_tr_b16 v[40:41], v6 offset:57344
  ds_read_b64_tr_b16 v[42:43], v6 offset:57856
  s_waitcnt lgkmcnt(8)
  v_mfma_f32_16x16x32_bf16 a[52:55], v[48:51], v[208:211], a[52:55]
  ds_read_b64_tr_b16 v[44:45], v6 offset:61440
  ds_read_b64_tr_b16 v[46:47], v6 offset:61952
  s_waitcnt lgkmcnt(8)
  v_mfma_f32_16x16x32_bf16 a[52:55], v[52:55], v[212:215], a[52:55]
  v_mfma_f32_16x16x32_bf16 a[116:119], v[48:51], v[216:219], a[116:119]
  v_mfma_f32_16x16x32_bf16 a[116:119], v[52:55], v[220:223], a[116:119]
  v_mfma_f32_16x16x32_bf16 a[180:183], v[48:51], v[224:227], a[180:183]
  v_mfma_f32_16x16x32_bf16 a[180:183], v[52:55], v[228:231], a[180:183]
  v_mfma_f32_16x16x32_bf16 a[244:247], v[48:51], v[232:235], a[244:247]
  v_mfma_f32_16x16x32_bf16 a[244:247], v[52:55], v[236:239], a[244:247]
  ds_read_b64_tr_b16 v[24:25], v3 offset:32768
  ds_read_b64_tr_b16 v[26:27], v3 offset:33280
  s_waitcnt lgkmcnt(8)
  v_mfma_f32_16x16x32_bf16 a[56:59], v[56:59], v[208:211], a[56:59]
  ds_read_b64_tr_b16 v[28:29], v3 offset:36864
  ds_read_b64_tr_b16 v[30:31], v3 offset:37376
  s_waitcnt lgkmcnt(8)
  v_mfma_f32_16x16x32_bf16 a[56:59], v[60:63], v[212:215], a[56:59]
  v_mfma_f32_16x16x32_bf16 a[120:123], v[56:59], v[216:219], a[120:123]
  v_mfma_f32_16x16x32_bf16 a[120:123], v[60:63], v[220:223], a[120:123]
  v_mfma_f32_16x16x32_bf16 a[184:187], v[56:59], v[224:227], a[184:187]
  v_mfma_f32_16x16x32_bf16 a[184:187], v[60:63], v[228:231], a[184:187]
  v_mfma_f32_16x16x32_bf16 a[248:251], v[56:59], v[232:235], a[248:251]
  v_mfma_f32_16x16x32_bf16 a[248:251], v[60:63], v[236:239], a[248:251]
  ds_read_b64_tr_b16 v[48:49], v4 offset:32768
  ds_read_b64_tr_b16 v[50:51], v4 offset:33280
  s_waitcnt lgkmcnt(8)
  v_mfma_f32_16x16x32_bf16 a[60:63], v[40:43], v[208:211], a[60:63]
  ds_read_b64_tr_b16 v[52:53], v4 offset:36864
  ds_read_b64_tr_b16 v[54:55], v4 offset:37376
  s_waitcnt lgkmcnt(8)
  v_mfma_f32_16x16x32_bf16 a[60:63], v[44:47], v[212:215], a[60:63]
  v_mfma_f32_16x16x32_bf16 a[124:127], v[40:43], v[216:219], a[124:127]
  v_mfma_f32_16x16x32_bf16 a[124:127], v[44:47], v[220:223], a[124:127]
  v_mfma_f32_16x16x32_bf16 a[188:191], v[40:43], v[224:227], a[188:191]
  v_mfma_f32_16x16x32_bf16 a[188:191], v[44:47], v[228:231], a[188:191]
  v_mfma_f32_16x16x32_bf16 a[252:255], v[40:43], v[232:235], a[252:255]
  v_mfma_f32_16x16x32_bf16 a[252:255], v[44:47], v[236:239], a[252:255]
  ds_read_b64_tr_b16 v[56:57], v5 offset:32768
  ds_read_b64_tr_b16 v[58:59], v5 offset:33280
  s_waitcnt lgkmcnt(8)
  v_mfma_f32_16x16x32_bf16 a[0:3], v[24:27], v[208:211], a[0:3]
  ds_read_b64_tr_b16 v[60:61], v5 offset:36864
  ds_read_b64_tr_b16 v[62:63], v5 offset:37376
  s_waitcnt lgkmcnt(8)
  v_mfma_f32_16x16x32_bf16 a[0:3], v[28:31], v[212:215], a[0:3]
  v_mfma_f32_16x16x32_bf16 a[64:67], v[24:27], v[216:219], a[64:67]
  v_mfma_f32_16x16x32_bf16 a[64:67], v[28:31], v[220:223], a[64:67]
  v_mfma_f32_16x16x32_bf16 a[128:131], v[24:27], v[224:227], a[128:131]
  v_mfma_f32_16x16x32_bf16 a[128:131], v[28:31], v[228:231], a[128:131]
  v_mfma_f32_16x16x32_bf16 a[192:195], v[24:27], v[232:235], a[192:195]
  v_mfma_f32_16x16x32_bf16 a[192:195], v[28:31], v[236:239], a[192:195]
  s_waitcnt vmcnt(24)
  v_mfma_f32_16x16x32_bf16 v[96:99], v[24:27], v[240:243], v[96:99]
  s_waitcnt vmcnt(21)
  v_mfma_f32_16x16x32_bf16 v[96:99], v[28:31], v[244:247], v[96:99]
  ds_read_b64_tr_b16 v[32:33], v6 offset:32768
  ds_read_b64_tr_b16 v[34:35], v6 offset:33280
  s_waitcnt lgkmcnt(8)
  v_mfma_f32_16x16x32_bf16 a[4:7], v[48:51], v[208:211], a[4:7]
  ds_read_b64_tr_b16 v[36:37], v6 offset:36864
  ds_read_b64_tr_b16 v[38:39], v6 offset:37376
  s_waitcnt lgkmcnt(8)
  v_mfma_f32_16x16x32_bf16 a[4:7], v[52:55], v[212:215], a[4:7]
  v_mfma_f32_16x16x32_bf16 a[68:71], v[48:51], v[216:219], a[68:71]
  v_mfma_f32_16x16x32_bf16 a[68:71], v[52:55], v[220:223], a[68:71]
  v_mfma_f32_16x16x32_bf16 a[132:135], v[48:51], v[224:227], a[132:135]
  v_mfma_f32_16x16x32_bf16 a[132:135], v[52:55], v[228:231], a[132:135]
  v_mfma_f32_16x16x32_bf16 a[196:199], v[48:51], v[232:235], a[196:199]
  v_mfma_f32_16x16x32_bf16 a[196:199], v[52:55], v[236:239], a[196:199]
  v_mfma_f32_16x16x32_bf16 v[100:103], v[48:51], v[240:243], v[100:103]
  v_mfma_f32_16x16x32_bf16 v[100:103], v[52:55], v[244:247], v[100:103]
  ds_read_b64_tr_b16 v[40:41], v3 offset:40960
  ds_read_b64_tr_b16 v[42:43], v3 offset:41472
  s_waitcnt lgkmcnt(8)
  v_mfma_f32_16x16x32_bf16 a[8:11], v[56:59], v[208:211], a[8:11]
  ds_read_b64_tr_b16 v[44:45], v3 offset:45056
  ds_read_b64_tr_b16 v[46:47], v3 offset:45568
  s_waitcnt lgkmcnt(8)
  v_mfma_f32_16x16x32_bf16 a[8:11], v[60:63], v[212:215], a[8:11]
  v_mfma_f32_16x16x32_bf16 a[72:75], v[56:59], v[216:219], a[72:75]
  v_mfma_f32_16x16x32_bf16 a[72:75], v[60:63], v[220:223], a[72:75]
  v_mfma_f32_16x16x32_bf16 a[136:139], v[56:59], v[224:227], a[136:139]
  v_mfma_f32_16x16x32_bf16 a[136:139], v[60:63], v[228:231], a[136:139]
  v_mfma_f32_16x16x32_bf16 a[200:203], v[56:59], v[232:235], a[200:203]
  v_mfma_f32_16x16x32_bf16 a[200:203], v[60:63], v[236:239], a[200:203]
  v_mfma_f32_16x16x32_bf16 v[104:107], v[56:59], v[240:243], v[104:107]
  v_mfma_f32_16x16x32_bf16 v[104:107], v[60:63], v[244:247], v[104:107]
  ds_read_b64_tr_b16 v[48:49], v4 offset:40960
  ds_read_b64_tr_b16 v[50:51], v4 offset:41472
  s_waitcnt lgkmcnt(8)
  v_mfma_f32_16x16x32_bf16 a[12:15], v[32:35], v[208:211], a[12:15]
  s_waitcnt vmcnt(18)
  s_barrier
  ds_read_b64_tr_b16 v[52:53], v4 offset:45056
  s_waitcnt lgkmcnt(7)
  v_mfma_f32_16x16x32_bf16 a[12:15], v[36:39], v[212:215], a[12:15]
  s_add_u32 m0, s33, 0
  s_add_u32 s34, s31, 0
  buffer_load_dwordx4 v8, s[12:15], s34 offen nt lds
  v_mfma_f32_16x16x32_bf16 a[76:79], v[32:35], v[216:219], a[76:79]
  ds_read_b64_tr_b16 v[54:55], v4 offset:45568
  v_mfma_f32_16x16x32_bf16 a[76:79], v[36:39], v[220:223], a[76:79]
  v_mfma_f32_16x16x32_bf16 a[140:143], v[32:35], v[224:227], a[140:143]
  v_mfma_f32_16x16x32_bf16 a[140:143], v[36:39], v[228:231], a[140:143]
  v_mfma_f32_16x16x32_bf16 a[204:207], v[32:35], v[232:235], a[204:207]
  v_mfma_f32_16x16x32_bf16 a[204:207], v[36:39], v[236:239], a[204:207]
  s_add_u32 m0, s33, 1024
  s_add_u32 s34, s31, 4096
  buffer_load_dwordx4 v8, s[12:15], s34 offen nt lds
  v_mfma_f32_16x16x32_bf16 v[108:111], v[32:35], v[240:243], v[108:111]
  v_mfma_f32_16x16x32_bf16 v[108:111], v[36:39], v[244:247], v[108:111]
  ds_read_b64_tr_b16 v[56:57], v5 offset:40960
  ds_read_b64_tr_b16 v[58:59], v5 offset:41472
  s_waitcnt lgkmcnt(8)
  v_mfma_f32_16x16x32_bf16 a[16:19], v[40:43], v[208:211], a[16:19]
  ds_read_b64_tr_b16 v[60:61], v5 offset:45056
  ds_read_b64_tr_b16 v[62:63], v5 offset:45568
  s_waitcnt lgkmcnt(8)
  v_mfma_f32_16x16x32_bf16 a[16:19], v[44:47], v[212:215], a[16:19]
  v_mfma_f32_16x16x32_bf16 a[80:83], v[40:43], v[216:219], a[80:83]
  v_mfma_f32_16x16x32_bf16 a[80:83], v[44:47], v[220:223], a[80:83]
  s_add_u32 m0, s33, 2048
  s_add_u32 s34, s31, 8192
  buffer_load_dwordx4 v8, s[12:15], s34 offen nt lds
  v_mfma_f32_16x16x32_bf16 a[144:147], v[40:43], v[224:227], a[144:147]
  v_mfma_f32_16x16x32_bf16 a[144:147], v[44:47], v[228:231], a[144:147]
  v_mfma_f32_16x16x32_bf16 a[208:211], v[40:43], v[232:235], a[208:211]
  v_mfma_f32_16x16x32_bf16 a[208:211], v[44:47], v[236:239], a[208:211]
  v_mfma_f32_16x16x32_bf16 v[112:115], v[40:43], v[240:243], v[112:115]
  v_mfma_f32_16x16x32_bf16 v[112:115], v[44:47], v[244:247], v[112:115]
  s_add_u32 m0, s33, 3072
  s_add_u32 s34, s31, 12288
  buffer_load_dwordx4 v8, s[12:15], s34 offen nt lds
  s_waitcnt lgkmcnt(6)
  v_mfma_f32_16x16x32_bf16 a[20:23], v[48:51], v[208:211], a[20:23]
  ds_read_b64_tr_b16 v[24:25], v6 offset:40960
  ds_read_b64_tr_b16 v[26:27], v6 offset:41472
  s_waitcnt lgkmcnt(6)
  v_mfma_f32_16x16x32_bf16 a[20:23], v[52:55], v[212:215], a[20:23]
  ds_read_b64_tr_b16 v[28:29], v6 offset:45056
  ds_read_b64_tr_b16 v[30:31], v6 offset:45568
  v_mfma_f32_16x16x32_bf16 a[84:87], v[48:51], v[216:219], a[84:87]
  v_mfma_f32_16x16x32_bf16 a[84:87], v[52:55], v[220:223], a[84:87]
  v_mfma_f32_16x16x32_bf16 a[148:151], v[48:51], v[224:227], a[148:151]
  v_mfma_f32_16x16x32_bf16 a[148:151], v[52:55], v[228:231], a[148:151]
  s_add_u32 m0, s33, 4096
  s_add_u32 s34, s31, 16384
  buffer_load_dwordx4 v8, s[12:15], s34 offen nt lds
  v_mfma_f32_16x16x32_bf16 a[212:215], v[48:51], v[232:235], a[212:215]
  v_mfma_f32_16x16x32_bf16 a[212:215], v[52:55], v[236:239], a[212:215]
  v_mfma_f32_16x16x32_bf16 v[116:119], v[48:51], v[240:243], v[116:119]
  v_mfma_f32_16x16x32_bf16 v[116:119], v[52:55], v[244:247], v[116:119]
  s_waitcnt lgkmcnt(6)
  v_mfma_f32_16x16x32_bf16 a[24:27], v[56:59], v[208:211], a[24:27]
  s_waitcnt lgkmcnt(4)
  v_mfma_f32_16x16x32_bf16 a[24:27], v[60:63], v[212:215], a[24:27]
  s_add_u32 m0, s33, 5120
  s_add_u32 s34, s31, 20480
  buffer_load_dwordx4 v8, s[12:15], s34 offen nt lds
  v_mfma_f32_16x16x32_bf16 a[88:91], v[56:59], v[216:219], a[88:91]
  v_mfma_f32_16x16x32_bf16 a[88:91], v[60:63], v[220:223], a[88:91]
  v_mfma_f32_16x16x32_bf16 a[152:155], v[56:59], v[224:227], a[152:155]
  v_mfma_f32_16x16x32_bf16 a[152:155], v[60:63], v[228:231], a[152:155]
  v_mfma_f32_16x16x32_bf16 a[216:219], v[56:59], v[232:235], a[216:219]
  v_xor_b32 v3, 65536, v3
  v_xor_b32 v4, 65536, v4
  v_mfma_f32_16x16x32_bf16 a[216:219], v[60:63], v[236:239], a[216:219]
  s_add_u32 m0, s33, 6144
  s_add_u32 s34, s31, 24576
  buffer_load_dwordx4 v8, s[12:15], s34 offen nt lds
  v_mfma_f32_16x16x32_bf16 v[120:123], v[56:59], v[240:243], v[120:123]
  v_xor_b32 v5, 65536, v5
  v_xor_b32 v6, 65536, v6
  v_mfma_f32_16x16x32_bf16 v[120:123], v[60:63], v[244:247], v[120:123]
  ds_read_b64_tr_b16 v[40:41], v3 offset:16384
  ds_read_b64_tr_b16 v[42:43], v3 offset:16896
  s_waitcnt lgkmcnt(4)
  v_mfma_f32_16x16x32_bf16 a[28:31], v[24:27], v[208:211], a[28:31]
  ds_read_b64_tr_b16 v[44:45], v3 offset:20480
  ds_read_b64_tr_b16 v[46:47], v3 offset:20992
  s_waitcnt lgkmcnt(4)
  v_mfma_f32_16x16x32_bf16 a[28:31], v[28:31], v[212:215], a[28:31]
  ds_read_b64_tr_b16 v[48:49], v4 offset:16384
  ds_read_b64_tr_b16 v[50:51], v4 offset:16896
  v_mfma_f32_16x16x32_bf16 a[92:95], v[24:27], v[216:219], a[92:95]
  ds_read_b64_tr_b16 v[52:53], v4 offset:20480
  ds_read_b64_tr_b16 v[54:55], v4 offset:20992
  v_mfma_f32_16x16x32_bf16 a[92:95], v[28:31], v[220:223], a[92:95]
  s_add_u32 m0, s33, 7168
  s_add_u32 s34, s31, 28672
  buffer_load_dwordx4 v8, s[12:15], s34 offen nt lds
  s_add_u32 s31, s31, 32768
  s_xor_b32 s33, s33, 65536
  v_mfma_f32_16x16x32_bf16 a[156:159], v[24:27], v[224:227], a[156:159]
  ds_read_b64_tr_b16 v[56:57], v5 offset:16384
  ds_read_b64_tr_b16 v[58:59], v5 offset:16896
  v_mfma_f32_16x16x32_bf16 a[156:159], v[28:31], v[228:231], a[156:159]
  ds_read_b64_tr_b16 v[60:61], v5 offset:20480
  ds_read_b64_tr_b16 v[62:63], v5 offset:20992
  v_mfma_f32_16x16x32_bf16 a[220:223], v[24:27], v[232:235], a[220:223]
  v_mfma_f32_16x16x32_bf16 a[220:223], v[28:31], v[236:239], a[220:223]
  v_mfma_f32_16x16x32_bf16 v[124:127], v[24:27], v[240:243], v[124:127]
  v_mfma_f32_16x16x32_bf16 v[124:127], v[28:31], v[244:247], v[124:127]
  s_waitcnt vmcnt(25) lgkmcnt(10)
  v_mfma_f32_16x16x32_bf16 a[32:35], v[40:43], v[64:67], a[32:35]
  s_waitcnt vmcnt(24) lgkmcnt(8)
  v_mfma_f32_16x16x32_bf16 a[32:35], v[44:47], v[68:71], a[32:35]
  s_waitcnt vmcnt(23)
  v_mfma_f32_16x16x32_bf16 a[96:99], v[40:43], v[72:75], a[96:99]
  s_waitcnt vmcnt(22)
  v_mfma_f32_16x16x32_bf16 a[96:99], v[44:47], v[76:79], a[96:99]
  s_waitcnt vmcnt(21)
  v_mfma_f32_16x16x32_bf16 a[160:163], v[40:43], v[80:83], a[160:163]
  s_waitcnt vmcnt(20)
  v_mfma_f32_16x16x32_bf16 a[160:163], v[44:47], v[84:87], a[160:163]
  s_waitcnt vmcnt(19)
  v_mfma_f32_16x16x32_bf16 a[224:227], v[40:43], v[88:91], a[224:227]
  s_waitcnt vmcnt(17)
  v_mfma_f32_16x16x32_bf16 a[224:227], v[44:47], v[92:95], a[224:227]
  ds_read_b64_tr_b16 v[24:25], v6 offset:16384
  ds_read_b64_tr_b16 v[26:27], v6 offset:16896
  ds_read_b64_tr_b16 v[28:29], v6 offset:20480
  ds_read_b64_tr_b16 v[30:31], v6 offset:20992
  s_waitcnt lgkmcnt(10)
  v_mfma_f32_16x16x32_bf16 a[36:39], v[48:51], v[64:67], a[36:39]
  s_waitcnt lgkmcnt(8)
  v_mfma_f32_16x16x32_bf16 a[36:39], v[52:55], v[68:71], a[36:39]
  v_mfma_f32_16x16x32_bf16 a[100:103], v[48:51], v[72:75], a[100:103]
  v_mfma_f32_16x16x32_bf16 a[100:103], v[52:55], v[76:79], a[100:103]
  v_mfma_f32_16x16x32_bf16 a[164:167], v[48:51], v[80:83], a[164:167]
  v_accvgpr_read_b32 v10, a32
  v_accvgpr_read_b32 v11, a33
  v_accvgpr_read_b32 v12, a34
  v_accvgpr_read_b32 v13, a35
  v_mul_f32 v10, s46, v10
  v_mul_f32 v11, s46, v11
  v_mfma_f32_16x16x32_bf16 a[164:167], v[52:55], v[84:87], a[164:167]
  v_mul_f32 v12, s46, v12
  v_mul_f32 v13, s46, v13
  v_cvt_pk_bf16_f32 v144, v10, v11
  v_cvt_pk_bf16_f32 v145, v12, v13
  v_accvgpr_read_b32 v10, a36
  v_accvgpr_read_b32 v11, a37
  v_mfma_f32_16x16x32_bf16 a[228:231], v[48:51], v[88:91], a[228:231]
  v_accvgpr_read_b32 v12, a38
  v_accvgpr_read_b32 v13, a39
  v_mul_f32 v10, s46, v10
  v_mul_f32 v11, s46, v11
  v_mul_f32 v12, s46, v12
  v_mul_f32 v13, s46, v13
  v_mfma_f32_16x16x32_bf16 a[228:231], v[52:55], v[92:95], a[228:231]
  ds_read_b64_tr_b16 v[32:33], v3 offset:24576
  ds_read_b64_tr_b16 v[34:35], v3 offset:25088
  ds_read_b64_tr_b16 v[36:37], v3 offset:28672
  ds_read_b64_tr_b16 v[38:39], v3 offset:29184
  v_cvt_pk_bf16_f32 v146, v10, v11
  v_cvt_pk_bf16_f32 v147, v12, v13
  s_waitcnt lgkmcnt(10)
  v_mfma_f32_16x16x32_bf16 a[40:43], v[56:59], v[64:67], a[40:43]
  v_accvgpr_read_b32 v10, a96
  v_accvgpr_read_b32 v11, a97
  v_permlane16_swap_b32 v144, v146
  v_permlane16_swap_b32 v145, v147
  v_accvgpr_read_b32 v12, a98
  v_accvgpr_read_b32 v13, a99
  s_waitcnt lgkmcnt(8)
  v_mfma_f32_16x16x32_bf16 a[40:43], v[60:63], v[68:71], a[40:43]
  v_mul_f32 v10, s46, v10
  v_mul_f32 v11, s46, v11
  v_mul_f32 v12, s46, v12
  v_mul_f32 v13, s46, v13
  v_cvt_pk_bf16_f32 v176, v10, v11
  v_cvt_pk_bf16_f32 v177, v12, v13
  v_mfma_f32_16x16x32_bf16 a[104:107], v[56:59], v[72:75], a[104:107]
  v_accvgpr_read_b32 v10, a100
  v_accvgpr_read_b32 v11, a101
  v_accvgpr_read_b32 v12, a102
  v_accvgpr_read_b32 v13, a103
  v_mul_f32 v10, s46, v10
  v_mul_f32 v11, s46, v11
  v_mfma_f32_16x16x32_bf16 a[104:107], v[60:63], v[76:79], a[104:107]
  v_mul_f32 v12, s46, v12
  v_mul_f32 v13, s46, v13
  v_cvt_pk_bf16_f32 v178, v10, v11
  v_cvt_pk_bf16_f32 v179, v12, v13
  v_accvgpr_read_b32 v10, a160
  v_accvgpr_read_b32 v11, a161
  v_mfma_f32_16x16x32_bf16 a[168:171], v[56:59], v[80:83], a[168:171]
  v_permlane16_swap_b32 v176, v178
  v_permlane16_swap_b32 v177, v179
  v_accvgpr_read_b32 v12, a162
  v_accvgpr_read_b32 v13, a163
  v_mul_f32 v10, s46, v10
  v_mul_f32 v11, s46, v11
  v_mfma_f32_16x16x32_bf16 a[168:171], v[60:63], v[84:87], a[168:171]
  v_mul_f32 v12, s46, v12
  v_mul_f32 v13, s46, v13
  v_cvt_pk_bf16_f32 v208, v10, v11
  v_cvt_pk_bf16_f32 v209, v12, v13
  v_accvgpr_read_b32 v10, a164
  v_accvgpr_read_b32 v11, a165
  v_mfma_f32_16x16x32_bf16 a[232:235], v[56:59], v[88:91], a[232:235]
  v_accvgpr_read_b32 v12, a166
  v_accvgpr_read_b32 v13, a167
  v_mul_f32 v10, s46, v10
  v_mul_f32 v11, s46, v11
  v_mul_f32 v12, s46, v12
  v_mul_f32 v13, s46, v13
  v_mfma_f32_16x16x32_bf16 a[232:235], v[60:63], v[92:95], a[232:235]
  ds_read_b64_tr_b16 v[48:49], v4 offset:24576
  ds_read_b64_tr_b16 v[50:51], v4 offset:25088
  ds_read_b64_tr_b16 v[52:53], v4 offset:28672
  ds_read_b64_tr_b16 v[54:55], v4 offset:29184
  v_cvt_pk_bf16_f32 v210, v10, v11
  v_cvt_pk_bf16_f32 v211, v12, v13
  s_waitcnt lgkmcnt(10)
  v_mfma_f32_16x16x32_bf16 a[44:47], v[24:27], v[64:67], a[44:47]
  v_accvgpr_read_b32 v10, a224
  v_accvgpr_read_b32 v11, a225
  v_permlane16_swap_b32 v208, v210
  v_permlane16_swap_b32 v209, v211
  v_accvgpr_read_b32 v12, a226
  v_accvgpr_read_b32 v13, a227
  s_waitcnt lgkmcnt(8)
  v_mfma_f32_16x16x32_bf16 a[44:47], v[28:31], v[68:71], a[44:47]
  v_mul_f32 v10, s46, v10
  v_mul_f32 v11, s46, v11
  v_mul_f32 v12, s46, v12
  v_mul_f32 v13, s46, v13
  v_cvt_pk_bf16_f32 v240, v10, v11
  v_cvt_pk_bf16_f32 v241, v12, v13
  v_mfma_f32_16x16x32_bf16 a[108:111], v[24:27], v[72:75], a[108:111]
  v_accvgpr_read_b32 v10, a228
  v_accvgpr_read_b32 v11, a229
  v_accvgpr_read_b32 v12, a230
  v_accvgpr_read_b32 v13, a231
  v_mul_f32 v10, s46, v10
  v_mul_f32 v11, s46, v11
  v_mfma_f32_16x16x32_bf16 a[108:111], v[28:31], v[76:79], a[108:111]
  v_mul_f32 v12, s46, v12
  v_mul_f32 v13, s46, v13
  v_cvt_pk_bf16_f32 v242, v10, v11
  v_cvt_pk_bf16_f32 v243, v12, v13
  v_mfma_f32_16x16x32_bf16 a[172:175], v[24:27], v[80:83], a[172:175]
  v_accvgpr_read_b32 v10, a40
  v_accvgpr_read_b32 v11, a41
  v_permlane16_swap_b32 v240, v242
  v_permlane16_swap_b32 v241, v243
  v_accvgpr_read_b32 v12, a42
  v_accvgpr_read_b32 v13, a43
  v_mfma_f32_16x16x32_bf16 a[172:175], v[28:31], v[84:87], a[172:175]
  v_mul_f32 v10, s46, v10
  v_mul_f32 v11, s46, v11
  v_mul_f32 v12, s46, v12
  v_mul_f32 v13, s46, v13
  v_cvt_pk_bf16_f32 v148, v10, v11
  v_cvt_pk_bf16_f32 v149, v12, v13
  v_mfma_f32_16x16x32_bf16 a[236:239], v[24:27], v[88:91], a[236:239]
  v_accvgpr_read_b32 v10, a44
  v_accvgpr_read_b32 v11, a45
  v_accvgpr_read_b32 v12, a46
  v_accvgpr_read_b32 v13, a47
  v_mul_f32 v10, s46, v10
  v_mul_f32 v11, s46, v11
  v_mfma_f32_16x16x32_bf16 a[236:239], v[28:31], v[92:95], a[236:239]
  ds_read_b64_tr_b16 v[56:57], v5 offset:24576
  ds_read_b64_tr_b16 v[58:59], v5 offset:25088
  ds_read_b64_tr_b16 v[60:61], v5 offset:28672
  ds_read_b64_tr_b16 v[62:63], v5 offset:29184
  v_mul_f32 v12, s46, v12
  v_mul_f32 v13, s46, v13
  s_waitcnt lgkmcnt(10)
  v_mfma_f32_16x16x32_bf16 a[48:51], v[32:35], v[64:67], a[48:51]
  v_cvt_pk_bf16_f32 v150, v10, v11
  v_cvt_pk_bf16_f32 v151, v12, v13
  v_accvgpr_read_b32 v10, a104
  v_accvgpr_read_b32 v11, a105
  v_permlane16_swap_b32 v148, v150
  v_permlane16_swap_b32 v149, v151
  s_waitcnt lgkmcnt(8)
  v_mfma_f32_16x16x32_bf16 a[48:51], v[36:39], v[68:71], a[48:51]
  v_accvgpr_read_b32 v12, a106
  v_accvgpr_read_b32 v13, a107
  v_mul_f32 v10, s46, v10
  v_mul_f32 v11, s46, v11
  v_mul_f32 v12, s46, v12
  v_mul_f32 v13, s46, v13
  v_mfma_f32_16x16x32_bf16 a[112:115], v[32:35], v[72:75], a[112:115]
  v_cvt_pk_bf16_f32 v180, v10, v11
  v_cvt_pk_bf16_f32 v181, v12, v13
  v_accvgpr_read_b32 v10, a108
  v_accvgpr_read_b32 v11, a109
  v_accvgpr_read_b32 v12, a110
  v_accvgpr_read_b32 v13, a111
  v_mfma_f32_16x16x32_bf16 a[112:115], v[36:39], v[76:79], a[112:115]
  v_mul_f32 v10, s46, v10
  v_mul_f32 v11, s46, v11
  v_mul_f32 v12, s46, v12
  v_mul_f32 v13, s46, v13
  v_cvt_pk_bf16_f32 v182, v10, v11
  v_cvt_pk_bf16_f32 v183, v12, v13
  v_mfma_f32_16x16x32_bf16 a[176:179], v[32:35], v[80:83], a[176:179]
  v_accvgpr_read_b32 v10, a168
  v_accvgpr_read_b32 v11, a169
  v_permlane16_swap_b32 v180, v182
  v_permlane16_swap_b32 v181, v183
  v_accvgpr_read_b32 v12, a170
  v_accvgpr_read_b32 v13, a171
  v_mfma_f32_16x16x32_bf16 a[176:179], v[36:39], v[84:87], a[176:179]
  v_mul_f32 v10, s46, v10
  v_mul_f32 v11, s46, v11
  v_mul_f32 v12, s46, v12
  v_mul_f32 v13, s46, v13
  v_cvt_pk_bf16_f32 v212, v10, v11
  v_cvt_pk_bf16_f32 v213, v12, v13
  v_mfma_f32_16x16x32_bf16 a[240:243], v[32:35], v[88:91], a[240:243]
  v_accvgpr_read_b32 v10, a172
  v_accvgpr_read_b32 v11, a173
  v_accvgpr_read_b32 v12, a174
  v_accvgpr_read_b32 v13, a175
  v_mul_f32 v10, s46, v10
  v_mul_f32 v11, s46, v11
  v_mfma_f32_16x16x32_bf16 a[240:243], v[36:39], v[92:95], a[240:243]
  ds_read_b64_tr_b16 v[40:41], v6 offset:24576
  ds_read_b64_tr_b16 v[42:43], v6 offset:25088
  ds_read_b64_tr_b16 v[44:45], v6 offset:28672
  ds_read_b64_tr_b16 v[46:47], v6 offset:29184
  v_mul_f32 v12, s46, v12
  v_mul_f32 v13, s46, v13
  s_waitcnt lgkmcnt(10)
  v_mfma_f32_16x16x32_bf16 a[52:55], v[48:51], v[64:67], a[52:55]
  v_cvt_pk_bf16_f32 v214, v10, v11
  v_cvt_pk_bf16_f32 v215, v12, v13
  v_accvgpr_read_b32 v10, a232
  v_accvgpr_read_b32 v11, a233
  v_permlane16_swap_b32 v212, v214
  v_permlane16_swap_b32 v213, v215
  s_waitcnt lgkmcnt(8)
  v_mfma_f32_16x16x32_bf16 a[52:55], v[52:55], v[68:71], a[52:55]
  v_accvgpr_read_b32 v12, a234
  v_accvgpr_read_b32 v13, a235
  v_mul_f32 v10, s46, v10
  v_mul_f32 v11, s46, v11
  v_mul_f32 v12, s46, v12
  v_mul_f32 v13, s46, v13
  v_mfma_f32_16x16x32_bf16 a[116:119], v[48:51], v[72:75], a[116:119]
  v_cvt_pk_bf16_f32 v244, v10, v11
  v_cvt_pk_bf16_f32 v245, v12, v13
  v_accvgpr_read_b32 v10, a236
  v_accvgpr_read_b32 v11, a237
  v_accvgpr_read_b32 v12, a238
  v_accvgpr_read_b32 v13, a239
  v_mfma_f32_16x16x32_bf16 a[116:119], v[52:55], v[76:79], a[116:119]
  v_mul_f32 v10, s46, v10
  v_mul_f32 v11, s46, v11
  v_mul_f32 v12, s46, v12
  v_mul_f32 v13, s46, v13
  v_cvt_pk_bf16_f32 v246, v10, v11
  v_cvt_pk_bf16_f32 v247, v12, v13
  v_mfma_f32_16x16x32_bf16 a[180:183], v[48:51], v[80:83], a[180:183]
  v_accvgpr_read_b32 v10, a48
  v_accvgpr_read_b32 v11, a49
  v_permlane16_swap_b32 v244, v246
  v_permlane16_swap_b32 v245, v247
  v_accvgpr_read_b32 v12, a50
  v_accvgpr_read_b32 v13, a51
  v_mfma_f32_16x16x32_bf16 a[180:183], v[52:55], v[84:87], a[180:183]
  v_mul_f32 v10, s46, v10
  v_mul_f32 v11, s46, v11
  v_mul_f32 v12, s46, v12
  v_mul_f32 v13, s46, v13
  v_cvt_pk_bf16_f32 v152, v10, v11
  v_cvt_pk_bf16_f32 v153, v12, v13
  v_mfma_f32_16x16x32_bf16 a[244:247], v[48:51], v[88:91], a[244:247]
  v_accvgpr_read_b32 v10, a52
  v_accvgpr_read_b32 v11, a53
  v_accvgpr_read_b32 v12, a54
  v_accvgpr_read_b32 v13, a55
  v_mul_f32 v10, s46, v10
  v_mul_f32 v11, s46, v11
  v_mfma_f32_16x16x32_bf16 a[244:247], v[52:55], v[92:95], a[244:247]
  ds_read_b64_tr_b16 v[24:25], v3 offset:0
  ds_read_b64_tr_b16 v[26:27], v3 offset:512
  ds_read_b64_tr_b16 v[28:29], v3 offset:4096
  ds_read_b64_tr_b16 v[30:31], v3 offset:4608
  v_mul_f32 v12, s46, v12
  v_mul_f32 v13, s46, v13
  s_waitcnt lgkmcnt(10)
  v_mfma_f32_16x16x32_bf16 a[56:59], v[56:59], v[64:67], a[56:59]
  v_cvt_pk_bf16_f32 v154, v10, v11
  v_cvt_pk_bf16_f32 v155, v12, v13
  v_accvgpr_read_b32 v10, a112
  v_accvgpr_read_b32 v11, a113
  v_permlane16_swap_b32 v152, v154
  v_permlane16_swap_b32 v153, v155
  s_waitcnt lgkmcnt(8)
  v_mfma_f32_16x16x32_bf16 a[56:59], v[60:63], v[68:71], a[56:59]
  v_accvgpr_read_b32 v12, a114
  v_accvgpr_read_b32 v13, a115
  v_mul_f32 v10, s46, v10
  v_mul_f32 v11, s46, v11
  v_mul_f32 v12, s46, v12
  v_mul_f32 v13, s46, v13
  v_mfma_f32_16x16x32_bf16 a[120:123], v[56:59], v[72:75], a[120:123]
  v_cvt_pk_bf16_f32 v184, v10, v11
  v_cvt_pk_bf16_f32 v185, v12, v13
  v_accvgpr_read_b32 v10, a116
  v_accvgpr_read_b32 v11, a117
  v_accvgpr_read_b32 v12, a118
  v_accvgpr_read_b32 v13, a119
  v_mfma_f32_16x16x32_bf16 a[120:123], v[60:63], v[76:79], a[120:123]
  v_mul_f32 v10, s46, v10
  v_mul_f32 v11, s46, v11
  v_mul_f32 v12, s46, v12
  v_mul_f32 v13, s46, v13
  v_cvt_pk_bf16_f32 v186, v10, v11
  v_cvt_pk_bf16_f32 v187, v12, v13
  v_mfma_f32_16x16x32_bf16 a[184:187], v[56:59], v[80:83], a[184:187]
  v_accvgpr_read_b32 v10, a176
  v_accvgpr_read_b32 v11, a177
  v_permlane16_swap_b32 v184, v186
  v_permlane16_swap_b32 v185, v187
  v_accvgpr_read_b32 v12, a178
  v_accvgpr_read_b32 v13, a179
  v_mfma_f32_16x16x32_bf16 a[184:187], v[60:63], v[84:87], a[184:187]
  v_mul_f32 v10, s46, v10
  v_mul_f32 v11, s46, v11
  v_mul_f32 v12, s46, v12
  v_mul_f32 v13, s46, v13
  v_cvt_pk_bf16_f32 v216, v10, v11
  v_cvt_pk_bf16_f32 v217, v12, v13
  v_mfma_f32_16x16x32_bf16 a[248:251], v[56:59], v[88:91], a[248:251]
  v_accvgpr_read_b32 v10, a180
  v_accvgpr_read_b32 v11, a181
  v_accvgpr_read_b32 v12, a182
  v_accvgpr_read_b32 v13, a183
  v_mul_f32 v10, s46, v10
  v_mul_f32 v11, s46, v11
  v_mfma_f32_16x16x32_bf16 a[248:251], v[60:63], v[92:95], a[248:251]
  ds_read_b64_tr_b16 v[48:49], v4 offset:0
  ds_read_b64_tr_b16 v[50:51], v4 offset:512
  ds_read_b64_tr_b16 v[52:53], v4 offset:4096
  ds_read_b64_tr_b16 v[54:55], v4 offset:4608
  v_mul_f32 v12, s46, v12
  v_mul_f32 v13, s46, v13
  s_waitcnt lgkmcnt(10)
  v_mfma_f32_16x16x32_bf16 a[60:63], v[40:43], v[64:67], a[60:63]
  v_cvt_pk_bf16_f32 v218, v10, v11
  v_cvt_pk_bf16_f32 v219, v12, v13
  v_accvgpr_read_b32 v10, a240
  v_accvgpr_read_b32 v11, a241
  v_permlane16_swap_b32 v216, v218
  v_permlane16_swap_b32 v217, v219
  s_waitcnt lgkmcnt(8)
  v_mfma_f32_16x16x32_bf16 a[60:63], v[44:47], v[68:71], a[60:63]
  v_accvgpr_read_b32 v12, a242
  v_accvgpr_read_b32 v13, a243
  v_mul_f32 v10, s46, v10
  v_mul_f32 v11, s46, v11
  v_mul_f32 v12, s46, v12
  v_mul_f32 v13, s46, v13
  v_mfma_f32_16x16x32_bf16 a[124:127], v[40:43], v[72:75], a[124:127]
  v_cvt_pk_bf16_f32 v248, v10, v11
  v_cvt_pk_bf16_f32 v249, v12, v13
  v_accvgpr_read_b32 v10, a244
  v_accvgpr_read_b32 v11, a245
  v_accvgpr_read_b32 v12, a246
  v_accvgpr_read_b32 v13, a247
  v_mfma_f32_16x16x32_bf16 a[124:127], v[44:47], v[76:79], a[124:127]
  v_mul_f32 v10, s46, v10
  v_mul_f32 v11, s46, v11
  v_mul_f32 v12, s46, v12
  v_mul_f32 v13, s46, v13
  v_cvt_pk_bf16_f32 v250, v10, v11
  v_cvt_pk_bf16_f32 v251, v12, v13
  v_mfma_f32_16x16x32_bf16 a[188:191], v[40:43], v[80:83], a[188:191]
  v_accvgpr_read_b32 v10, a56
  v_accvgpr_read_b32 v11, a57
  v_permlane16_swap_b32 v248, v250
  v_permlane16_swap_b32 v249, v251
  v_accvgpr_read_b32 v12, a58
  v_accvgpr_read_b32 v13, a59
  v_mfma_f32_16x16x32_bf16 a[188:191], v[44:47], v[84:87], a[188:191]
  v_mul_f32 v10, s46, v10
  v_mul_f32 v11, s46, v11
  v_mul_f32 v12, s46, v12
  v_mul_f32 v13, s46, v13
  v_cvt_pk_bf16_f32 v156, v10, v11
  v_cvt_pk_bf16_f32 v157, v12, v13
  v_mfma_f32_16x16x32_bf16 a[252:255], v[40:43], v[88:91], a[252:255]
  v_accvgpr_read_b32 v10, a60
  v_accvgpr_read_b32 v11, a61
  v_accvgpr_read_b32 v12, a62
  v_accvgpr_read_b32 v13, a63
  v_mul_f32 v10, s46, v10
  v_mul_f32 v11, s46, v11
  v_mfma_f32_16x16x32_bf16 a[252:255], v[44:47], v[92:95], a[252:255]
  ds_read_b64_tr_b16 v[56:57], v5 offset:0
  ds_read_b64_tr_b16 v[58:59], v5 offset:512
  ds_read_b64_tr_b16 v[60:61], v5 offset:4096
  ds_read_b64_tr_b16 v[62:63], v5 offset:4608
  v_mul_f32 v12, s46, v12
  v_mul_f32 v13, s46, v13
  s_waitcnt lgkmcnt(10)
  v_mfma_f32_16x16x32_bf16 a[0:3], v[24:27], v[64:67], a[0:3]
  v_cvt_pk_bf16_f32 v158, v10, v11
  v_cvt_pk_bf16_f32 v159, v12, v13
  v_accvgpr_read_b32 v10, a120
  v_accvgpr_read_b32 v11, a121
  v_permlane16_swap_b32 v156, v158
  v_permlane16_swap_b32 v157, v159
  s_waitcnt lgkmcnt(8)
  v_mfma_f32_16x16x32_bf16 a[0:3], v[28:31], v[68:71], a[0:3]
  v_accvgpr_read_b32 v12, a122
  v_accvgpr_read_b32 v13, a123
  v_mul_f32 v10, s46, v10
  v_mul_f32 v11, s46, v11
  v_mul_f32 v12, s46, v12
  v_mul_f32 v13, s46, v13
  v_mfma_f32_16x16x32_bf16 a[64:67], v[24:27], v[72:75], a[64:67]
  v_cvt_pk_bf16_f32 v188, v10, v11
  v_cvt_pk_bf16_f32 v189, v12, v13
  v_accvgpr_read_b32 v10, a124
  v_accvgpr_read_b32 v11, a125
  v_accvgpr_read_b32 v12, a126
  v_accvgpr_read_b32 v13, a127
  v_mfma_f32_16x16x32_bf16 a[64:67], v[28:31], v[76:79], a[64:67]
  v_mul_f32 v10, s46, v10
  v_mul_f32 v11, s46, v11
  v_mul_f32 v12, s46, v12
  v_mul_f32 v13, s46, v13
  v_cvt_pk_bf16_f32 v190, v10, v11
  v_cvt_pk_bf16_f32 v191, v12, v13
  v_mfma_f32_16x16x32_bf16 a[128:131], v[24:27], v[80:83], a[128:131]
  v_accvgpr_read_b32 v10, a184
  v_accvgpr_read_b32 v11, a185
  v_permlane16_swap_b32 v188, v190
  v_permlane16_swap_b32 v189, v191
  v_accvgpr_read_b32 v12, a186
  v_accvgpr_read_b32 v13, a187
  v_mfma_f32_16x16x32_bf16 a[128:131], v[28:31], v[84:87], a[128:131]
  v_mul_f32 v10, s46, v10
  v_mul_f32 v11, s46, v11
  v_mul_f32 v12, s46, v12
  v_mul_f32 v13, s46, v13
  v_cvt_pk_bf16_f32 v220, v10, v11
  v_cvt_pk_bf16_f32 v221, v12, v13
  v_mfma_f32_16x16x32_bf16 a[192:195], v[24:27], v[88:91], a[192:195]
  v_accvgpr_read_b32 v10, a188
  v_accvgpr_read_b32 v11, a189
  v_accvgpr_read_b32 v12, a190
  v_accvgpr_read_b32 v13, a191
  v_mul_f32 v10, s46, v10
  v_mul_f32 v11, s46, v11
  v_mfma_f32_16x16x32_bf16 a[192:195], v[28:31], v[92:95], a[192:195]
  v_mul_f32 v12, s46, v12
  v_mul_f32 v13, s46, v13
  v_cvt_pk_bf16_f32 v222, v10, v11
  v_cvt_pk_bf16_f32 v223, v12, v13
  v_accvgpr_read_b32 v10, a248
  v_accvgpr_read_b32 v11, a249
  s_waitcnt vmcnt(14)
  v_mfma_f32_16x16x32_bf16 v[96:99], v[24:27], v[16:19], v[96:99]
  v_permlane16_swap_b32 v220, v222
  v_permlane16_swap_b32 v221, v223
  v_accvgpr_read_b32 v12, a250
  v_accvgpr_read_b32 v13, a251
  v_mul_f32 v10, s46, v10
  v_mul_f32 v11, s46, v11
  s_waitcnt vmcnt(11)
  v_mfma_f32_16x16x32_bf16 v[96:99], v[28:31], v[20:23], v[96:99]
  ds_read_b64_tr_b16 v[32:33], v6 offset:0
  ds_read_b64_tr_b16 v[34:35], v6 offset:512
  ds_read_b64_tr_b16 v[36:37], v6 offset:4096
  ds_read_b64_tr_b16 v[38:39], v6 offset:4608
  v_mul_f32 v12, s46, v12
  v_mul_f32 v13, s46, v13
  s_waitcnt lgkmcnt(10)
  v_mfma_f32_16x16x32_bf16 a[4:7], v[48:51], v[64:67], a[4:7]
  v_cvt_pk_bf16_f32 v252, v10, v11
  v_cvt_pk_bf16_f32 v253, v12, v13
  v_accvgpr_read_b32 v10, a252
  v_accvgpr_read_b32 v11, a253
  v_accvgpr_read_b32 v12, a254
  v_accvgpr_read_b32 v13, a255
  s_waitcnt lgkmcnt(8)
  v_mfma_f32_16x16x32_bf16 a[4:7], v[52:55], v[68:71], a[4:7]
  v_mul_f32 v10, s46, v10
  v_mul_f32 v11, s46, v11
  v_mul_f32 v12, s46, v12
  v_mul_f32 v13, s46, v13
  v_cvt_pk_bf16_f32 v254, v10, v11
  v_cvt_pk_bf16_f32 v255, v12, v13
  v_mfma_f32_16x16x32_bf16 a[68:71], v[48:51], v[72:75], a[68:71]
  v_mfma_f32_16x16x32_bf16 a[68:71], v[52:55], v[76:79], a[68:71]
  v_mfma_f32_16x16x32_bf16 a[132:135], v[48:51], v[80:83], a[132:135]
  v_accvgpr_read_b32 v10, a0
  v_accvgpr_read_b32 v11, a1
  v_permlane16_swap_b32 v252, v254
  v_permlane16_swap_b32 v253, v255
  v_accvgpr_read_b32 v12, a2
  v_accvgpr_read_b32 v13, a3
  v_mfma_f32_16x16x32_bf16 a[132:135], v[52:55], v[84:87], a[132:135]
  v_mul_f32 v10, s46, v10
  v_mul_f32 v11, s46, v11
  v_mul_f32 v12, s46, v12
  v_mul_f32 v13, s46, v13
  v_cvt_pk_bf16_f32 v128, v10, v11
  v_cvt_pk_bf16_f32 v129, v12, v13
  v_mfma_f32_16x16x32_bf16 a[196:199], v[48:51], v[88:91], a[196:199]
  v_accvgpr_read_b32 v10, a4
  v_accvgpr_read_b32 v11, a5
  v_accvgpr_read_b32 v12, a6
  v_accvgpr_read_b32 v13, a7
  v_mul_f32 v10, s46, v10
  v_mul_f32 v11, s46, v11
  v_mfma_f32_16x16x32_bf16 a[196:199], v[52:55], v[92:95], a[196:199]
  v_mul_f32 v12, s46, v12
  v_mul_f32 v13, s46, v13
  v_cvt_pk_bf16_f32 v130, v10, v11
  v_cvt_pk_bf16_f32 v131, v12, v13
  v_accvgpr_read_b32 v10, a64
  v_accvgpr_read_b32 v11, a65
  v_mfma_f32_16x16x32_bf16 v[100:103], v[48:51], v[16:19], v[100:103]
  v_permlane16_swap_b32 v128, v130
  v_permlane16_swap_b32 v129, v131
  v_accvgpr_read_b32 v12, a66
  v_accvgpr_read_b32 v13, a67
  v_mul_f32 v10, s46, v10
  v_mul_f32 v11, s46, v11
  v_mfma_f32_16x16x32_bf16 v[100:103], v[52:55], v[20:23], v[100:103]
  ds_read_b64_tr_b16 v[40:41], v3 offset:8192
  ds_read_b64_tr_b16 v[42:43], v3 offset:8704
  ds_read_b64_tr_b16 v[44:45], v3 offset:12288
  ds_read_b64_tr_b16 v[46:47], v3 offset:12800
  v_mul_f32 v12, s46, v12
  v_mul_f32 v13, s46, v13
  s_waitcnt lgkmcnt(10)
  v_mfma_f32_16x16x32_bf16 a[8:11], v[56:59], v[64:67], a[8:11]
  v_cvt_pk_bf16_f32 v160, v10, v11
  v_cvt_pk_bf16_f32 v161, v12, v13
  v_accvgpr_read_b32 v10, a68
  v_accvgpr_read_b32 v11, a69
  v_accvgpr_read_b32 v12, a70
  v_accvgpr_read_b32 v13, a71
  s_waitcnt lgkmcnt(8)
  v_mfma_f32_16x16x32_bf16 a[8:11], v[60:63], v[68:71], a[8:11]
  v_mul_f32 v10, s46, v10
  v_mul_f32 v11, s46, v11
  v_mul_f32 v12, s46, v12
  v_mul_f32 v13, s46, v13
  v_cvt_pk_bf16_f32 v162, v10, v11
  v_cvt_pk_bf16_f32 v163, v12, v13
  v_mfma_f32_16x16x32_bf16 a[72:75], v[56:59], v[72:75], a[72:75]
  v_accvgpr_read_b32 v10, a128
  v_accvgpr_read_b32 v11, a129
  v_permlane16_swap_b32 v160, v162
  v_permlane16_swap_b32 v161, v163
  v_accvgpr_read_b32 v12, a130
  v_accvgpr_read_b32 v13, a131
  v_mfma_f32_16x16x32_bf16 a[72:75], v[60:63], v[76:79], a[72:75]
  v_mul_f32 v10, s46, v10
  v_mul_f32 v11, s46, v11
  v_mul_f32 v12, s46, v12
  v_mul_f32 v13, s46, v13
  v_cvt_pk_bf16_f32 v192, v10, v11
  v_cvt_pk_bf16_f32 v193, v12, v13
  v_mfma_f32_16x16x32_bf16 a[136:139], v[56:59], v[80:83], a[136:139]
  v_accvgpr_read_b32 v10, a132
  v_accvgpr_read_b32 v11, a133
  v_accvgpr_read_b32 v12, a134
  v_accvgpr_read_b32 v13, a135
  v_mul_f32 v10, s46, v10
  v_mul_f32 v11, s46, v11
  v_mfma_f32_16x16x32_bf16 a[136:139], v[60:63], v[84:87], a[136:139]
  v_mul_f32 v12, s46, v12
  v_mul_f32 v13, s46, v13
  v_cvt_pk_bf16_f32 v194, v10, v11
  v_cvt_pk_bf16_f32 v195, v12, v13
  v_accvgpr_read_b32 v10, a192
  v_accvgpr_read_b32 v11, a193
  v_mfma_f32_16x16x32_bf16 a[200:203], v[56:59], v[88:91], a[200:203]
  v_permlane16_swap_b32 v192, v194
  v_permlane16_swap_b32 v193, v195
  v_accvgpr_read_b32 v12, a194
  v_accvgpr_read_b32 v13, a195
  v_mul_f32 v10, s46, v10
  v_mul_f32 v11, s46, v11
  v_mfma_f32_16x16x32_bf16 a[200:203], v[60:63], v[92:95], a[200:203]
  v_mul_f32 v12, s46, v12
  v_mul_f32 v13, s46, v13
  v_cvt_pk_bf16_f32 v224, v10, v11
  v_cvt_pk_bf16_f32 v225, v12, v13
  v_accvgpr_read_b32 v10, a196
  v_accvgpr_read_b32 v11, a197
  v_mfma_f32_16x16x32_bf16 v[104:107], v[56:59], v[16:19], v[104:107]
  v_accvgpr_read_b32 v12, a198
  v_accvgpr_read_b32 v13, a199
  v_mul_f32 v10, s46, v10
  v_mul_f32 v11, s46, v11
  v_mul_f32 v12, s46, v12
  v_mul_f32 v13, s46, v13
  v_mfma_f32_16x16x32_bf16 v[104:107], v[60:63], v[20:23], v[104:107]
  ds_read_b64_tr_b16 v[48:49], v4 offset:8192
  ds_read_b64_tr_b16 v[50:51], v4 offset:8704
  ds_read_b64_tr_b16 v[52:53], v4 offset:12288
  ds_read_b64_tr_b16 v[54:55], v4 offset:12800
  v_cvt_pk_bf16_f32 v226, v10, v11
  v_cvt_pk_bf16_f32 v227, v12, v13
  s_waitcnt lgkmcnt(10)
  v_mfma_f32_16x16x32_bf16 a[12:15], v[32:35], v[64:67], a[12:15]
  s_waitcnt vmcnt(8)
  s_barrier
  v_mul_f32 v10, s46, v96
  v_mul_f32 v11, s46, v97
  v_permlane16_swap_b32 v224, v226
  v_permlane16_swap_b32 v225, v227
  v_mul_f32 v12, s46, v98
  s_waitcnt lgkmcnt(8)
  v_mfma_f32_16x16x32_bf16 a[12:15], v[36:39], v[68:71], a[12:15]
  s_add_u32 m0, s32, 0
  s_add_u32 s34, s30, 0
  buffer_load_dwordx4 v7, s[8:11], s34 offen nt lds
  v_mul_f32 v13, s46, v99
  v_cvt_pk_bf16_f32 v96, v10, v11
  v_cvt_pk_bf16_f32 v97, v12, v13
  v_mul_f32 v10, s46, v100
  v_mfma_f32_16x16x32_bf16 a[76:79], v[32:35], v[72:75], a[76:79]
  v_mul_f32 v11, s46, v101
  v_mul_f32 v12, s46, v102
  v_mul_f32 v13, s46, v103
  v_cvt_pk_bf16_f32 v98, v10, v11
  v_cvt_pk_bf16_f32 v99, v12, v13
  v_mfma_f32_16x16x32_bf16 a[76:79], v[36:39], v[76:79], a[76:79]
  v_mfma_f32_16x16x32_bf16 a[140:143], v[32:35], v[80:83], a[140:143]
  v_accvgpr_read_b32 v10, a8
  v_accvgpr_read_b32 v11, a9
  v_permlane16_swap_b32 v96, v98
  v_permlane16_swap_b32 v97, v99
  ds_write_b128 v9, v[96:99] offset:0
  v_accvgpr_read_b32 v12, a10
  v_mfma_f32_16x16x32_bf16 a[140:143], v[36:39], v[84:87], a[140:143]
  v_accvgpr_read_b32 v13, a11
  v_mul_f32 v10, s46, v10
  v_mul_f32 v11, s46, v11
  v_mul_f32 v12, s46, v12
  v_mul_f32 v13, s46, v13
  v_cvt_pk_bf16_f32 v132, v10, v11
  v_mfma_f32_16x16x32_bf16 a[204:207], v[32:35], v[88:91], a[204:207]
  v_cvt_pk_bf16_f32 v133, v12, v13
  v_accvgpr_read_b32 v10, a12
  v_accvgpr_read_b32 v11, a13
  v_accvgpr_read_b32 v12, a14
  v_accvgpr_read_b32 v13, a15
  v_mul_f32 v10, s46, v10
  v_mfma_f32_16x16x32_bf16 a[204:207], v[36:39], v[92:95], a[204:207]
  s_add_u32 m0, s32, 1024
  s_add_u32 s34, s30, 4096
  buffer_load_dwordx4 v7, s[8:11], s34 offen nt lds
  v_mul_f32 v11, s46, v11
  v_mul_f32 v12, s46, v12
  v_mul_f32 v13, s46, v13
  v_cvt_pk_bf16_f32 v134, v10, v11
  v_mfma_f32_16x16x32_bf16 v[108:111], v[32:35], v[16:19], v[108:111]
  v_cvt_pk_bf16_f32 v135, v12, v13
  v_accvgpr_read_b32 v10, a72
  v_accvgpr_read_b32 v11, a73
  v_permlane16_swap_b32 v132, v134
  v_permlane16_swap_b32 v133, v135
  v_accvgpr_read_b32 v12, a74
  v_mfma_f32_16x16x32_bf16 v[108:111], v[36:39], v[20:23], v[108:111]
  ds_read_b64_tr_b16 v[56:57], v5 offset:8192
  ds_read_b64_tr_b16 v[58:59], v5 offset:8704
  ds_read_b64_tr_b16 v[60:61], v5 offset:12288
  ds_read_b64_tr_b16 v[62:63], v5 offset:12800
  ds_read_b128 v[32:35], v1 offset:0
  ds_read_b128 v[36:39], v2 offset:0
  s_waitcnt lgkmcnt(13)
  v_mfma_f32_16x16x32_bf16 a[16:19], v[40:43], v[64:67], a[16:19]
  v_accvgpr_read_b32 v13, a75
  v_mul_f32 v10, s46, v10
  v_mul_f32 v11, s46, v11
  v_mul_f32 v12, s46, v12
  v_mul_f32 v13, s46, v13
  v_cvt_pk_bf16_f32 v164, v10, v11
  s_waitcnt lgkmcnt(11)
  v_mfma_f32_16x16x32_bf16 a[16:19], v[44:47], v[68:71], a[16:19]
  v_cvt_pk_bf16_f32 v165, v12, v13
  v_accvgpr_read_b32 v10, a76
  v_accvgpr_read_b32 v11, a77
  v_accvgpr_read_b32 v12, a78
  v_accvgpr_read_b32 v13, a79
  v_mul_f32 v10, s46, v10
  v_mfma_f32_16x16x32_bf16 a[80:83], v[40:43], v[72:75], a[80:83]
  v_mul_f32 v11, s46, v11
  v_mul_f32 v12, s46, v12
  v_mul_f32 v13, s46, v13
  v_cvt_pk_bf16_f32 v166, v10, v11
  v_cvt_pk_bf16_f32 v167, v12, v13
  v_accvgpr_read_b32 v10, a136
  v_mfma_f32_16x16x32_bf16 a[80:83], v[44:47], v[76:79], a[80:83]
  s_add_u32 m0, s32, 2048
  s_add_u32 s34, s30, 8192
  buffer_load_dwordx4 v7, s[8:11], s34 offen nt lds
  v_accvgpr_read_b32 v11, a137
  v_permlane16_swap_b32 v164, v166
  v_permlane16_swap_b32 v165, v167
  v_accvgpr_read_b32 v12, a138
  v_mfma_f32_16x16x32_bf16 a[144:147], v[40:43], v[80:83], a[144:147]
  v_accvgpr_read_b32 v13, a139
  v_mul_f32 v10, s46, v10
  v_mul_f32 v11, s46, v11
  v_mul_f32 v12, s46, v12
  v_mul_f32 v13, s46, v13
  v_cvt_pk_bf16_f32 v196, v10, v11
  v_mfma_f32_16x16x32_bf16 a[144:147], v[44:47], v[84:87], a[144:147]
  v_cvt_pk_bf16_f32 v197, v12, v13
  v_accvgpr_read_b32 v10, a140
  v_accvgpr_read_b32 v11, a141
  v_accvgpr_read_b32 v12, a142
  v_accvgpr_read_b32 v13, a143
  v_mul_f32 v10, s46, v10
  v_mfma_f32_16x16x32_bf16 a[208:211], v[40:43], v[88:91], a[208:211]
  v_mul_f32 v11, s46, v11
  v_mul_f32 v12, s46, v12
  v_mul_f32 v13, s46, v13
  v_cvt_pk_bf16_f32 v198, v10, v11
  v_cvt_pk_bf16_f32 v199, v12, v13
  v_accvgpr_read_b32 v10, a200
  v_mfma_f32_16x16x32_bf16 a[208:211], v[44:47], v[92:95], a[208:211]
  v_accvgpr_read_b32 v11, a201
  v_permlane16_swap_b32 v196, v198
  v_permlane16_swap_b32 v197, v199
  v_accvgpr_read_b32 v12, a202
  v_accvgpr_read_b32 v13, a203
  v_mul_f32 v10, s46, v10
  v_mfma_f32_16x16x32_bf16 v[112:115], v[40:43], v[16:19], v[112:115]
  v_mul_f32 v11, s46, v11
  v_mul_f32 v12, s46, v12
  v_mul_f32 v13, s46, v13
  v_cvt_pk_bf16_f32 v228, v10, v11
  v_cvt_pk_bf16_f32 v229, v12, v13
  v_accvgpr_read_b32 v10, a204
  v_mfma_f32_16x16x32_bf16 v[112:115], v[44:47], v[20:23], v[112:115]
  s_add_u32 m0, s32, 3072
  s_add_u32 s34, s30, 12288
  buffer_load_dwordx4 v7, s[8:11], s34 offen nt lds
  ds_read_b64_tr_b16 v[24:25], v6 offset:8192
  ds_read_b64_tr_b16 v[26:27], v6 offset:8704
  ds_read_b64_tr_b16 v[28:29], v6 offset:12288
  ds_read_b64_tr_b16 v[30:31], v6 offset:12800
  s_waitcnt lgkmcnt(13)
  v_mfma_f32_16x16x32_bf16 a[20:23], v[48:51], v[64:67], a[20:23]
  ds_read_b128 v[40:43], v1 offset:8192
  ds_read_b128 v[44:47], v2 offset:8192
  v_accvgpr_read_b32 v11, a205
  v_accvgpr_read_b32 v12, a206
  v_accvgpr_read_b32 v13, a207
  v_mul_f32 v10, s46, v10
  s_waitcnt lgkmcnt(13)
  v_mfma_f32_16x16x32_bf16 a[20:23], v[52:55], v[68:71], a[20:23]
  v_mul_f32 v11, s46, v11
  v_mul_f32 v12, s46, v12
  v_mul_f32 v13, s46, v13
  v_cvt_pk_bf16_f32 v230, v10, v11
  v_cvt_pk_bf16_f32 v231, v12, v13
  v_mul_f32 v10, s46, v104
  v_mfma_f32_16x16x32_bf16 a[84:87], v[48:51], v[72:75], a[84:87]
  v_mul_f32 v11, s46, v105
  v_permlane16_swap_b32 v228, v230
  v_permlane16_swap_b32 v229, v231
  v_mul_f32 v12, s46, v106
  v_mul_f32 v13, s46, v107
  v_cvt_pk_bf16_f32 v104, v10, v11
  v_mfma_f32_16x16x32_bf16 a[84:87], v[52:55], v[76:79], a[84:87]
  v_cvt_pk_bf16_f32 v105, v12, v13
  v_mul_f32 v10, s46, v108
  v_mul_f32 v11, s46, v109
  v_mul_f32 v12, s46, v110
  v_mul_f32 v13, s46, v111
  v_cvt_pk_bf16_f32 v106, v10, v11
  v_mfma_f32_16x16x32_bf16 a[148:151], v[48:51], v[80:83], a[148:151]
  v_cvt_pk_bf16_f32 v107, v12, v13
  v_accvgpr_read_b32 v10, a16
  v_accvgpr_read_b32 v11, a17
  v_permlane16_swap_b32 v104, v106
  v_permlane16_swap_b32 v105, v107
  ds_write_b128 v9, v[104:107] offset:1024
  v_mfma_f32_16x16x32_bf16 a[148:151], v[52:55], v[84:87], a[148:151]
  s_add_u32 m0, s32, 4096
  s_add_u32 s34, s30, 16384
  buffer_load_dwordx4 v7, s[8:11], s34 offen nt lds
  v_accvgpr_read_b32 v12, a18
  v_accvgpr_read_b32 v13, a19
  v_mul_f32 v10, s46, v10
  v_mul_f32 v11, s46, v11
  v_mfma_f32_16x16x32_bf16 a[212:215], v[48:51], v[88:91], a[212:215]
  v_mul_f32 v12, s46, v12
  v_mul_f32 v13, s46, v13
  v_cvt_pk_bf16_f32 v136, v10, v11
  v_cvt_pk_bf16_f32 v137, v12, v13
  v_accvgpr_read_b32 v10, a20
  v_accvgpr_read_b32 v11, a21
  v_mfma_f32_16x16x32_bf16 a[212:215], v[52:55], v[92:95], a[212:215]
  v_accvgpr_read_b32 v12, a22
  v_accvgpr_read_b32 v13, a23
  v_mul_f32 v10, s46, v10
  v_mul_f32 v11, s46, v11
  v_mul_f32 v12, s46, v12
  v_mul_f32 v13, s46, v13
  v_mfma_f32_16x16x32_bf16 v[116:119], v[48:51], v[16:19], v[116:119]
  v_cvt_pk_bf16_f32 v138, v10, v11
  v_cvt_pk_bf16_f32 v139, v12, v13
  v_accvgpr_read_b32 v10, a80
  v_accvgpr_read_b32 v11, a81
  v_permlane16_swap_b32 v136, v138
  v_permlane16_swap_b32 v137, v139
  v_mfma_f32_16x16x32_bf16 v[116:119], v[52:55], v[20:23], v[116:119]
  ds_read_b128 v[48:51], v1 offset:16384
  ds_read_b128 v[52:55], v2 offset:16384
  v_accvgpr_read_b32 v12, a82
  v_accvgpr_read_b32 v13, a83
  v_mul_f32 v10, s46, v10
  v_mul_f32 v11, s46, v11
  s_waitcnt lgkmcnt(13)
  v_mfma_f32_16x16x32_bf16 a[24:27], v[56:59], v[64:67], a[24:27]
  v_mul_f32 v12, s46, v12
  v_mul_f32 v13, s46, v13
  v_cvt_pk_bf16_f32 v168, v10, v11
  v_cvt_pk_bf16_f32 v169, v12, v13
  v_accvgpr_read_b32 v10, a84
  v_accvgpr_read_b32 v11, a85
  s_waitcnt lgkmcnt(11)
  v_mfma_f32_16x16x32_bf16 a[24:27], v[60:63], v[68:71], a[24:27]
  s_add_u32 m0, s32, 5120
  s_add_u32 s34, s30, 20480
  buffer_load_dwordx4 v7, s[8:11], s34 offen nt lds
  v_accvgpr_read_b32 v12, a86
  v_accvgpr_read_b32 v13, a87
  v_mul_f32 v10, s46, v10
  v_mul_f32 v11, s46, v11
  v_mfma_f32_16x16x32_bf16 a[88:91], v[56:59], v[72:75], a[88:91]
  v_mul_f32 v12, s46, v12
  v_mul_f32 v13, s46, v13
  v_cvt_pk_bf16_f32 v170, v10, v11
  v_cvt_pk_bf16_f32 v171, v12, v13
  v_accvgpr_read_b32 v10, a144
  v_accvgpr_read_b32 v11, a145
  v_mfma_f32_16x16x32_bf16 a[88:91], v[60:63], v[76:79], a[88:91]
  v_permlane16_swap_b32 v168, v170
  v_permlane16_swap_b32 v169, v171
  v_accvgpr_read_b32 v12, a146
  v_accvgpr_read_b32 v13, a147
  v_mul_f32 v10, s46, v10
  v_mul_f32 v11, s46, v11
  v_mfma_f32_16x16x32_bf16 a[152:155], v[56:59], v[80:83], a[152:155]
  v_mul_f32 v12, s46, v12
  v_mul_f32 v13, s46, v13
  v_cvt_pk_bf16_f32 v200, v10, v11
  v_cvt_pk_bf16_f32 v201, v12, v13
  v_accvgpr_read_b32 v10, a148
  v_accvgpr_read_b32 v11, a149
  v_mfma_f32_16x16x32_bf16 a[152:155], v[60:63], v[84:87], a[152:155]
  v_accvgpr_read_b32 v12, a150
  v_accvgpr_read_b32 v13, a151
  v_mul_f32 v10, s46, v10
  v_mul_f32 v11, s46, v11
  v_mul_f32 v12, s46, v12
  v_mul_f32 v13, s46, v13
  v_mfma_f32_16x16x32_bf16 a[216:219], v[56:59], v[88:91], a[216:219]
  v_cvt_pk_bf16_f32 v202, v10, v11
  v_cvt_pk_bf16_f32 v203, v12, v13
  v_accvgpr_read_b32 v10, a208
  v_accvgpr_read_b32 v11, a209
  v_permlane16_swap_b32 v200, v202
  v_permlane16_swap_b32 v201, v203
  v_mfma_f32_16x16x32_bf16 a[216:219], v[60:63], v[92:95], a[216:219]
  s_add_u32 m0, s32, 6144
  s_add_u32 s34, s30, 24576
  buffer_load_dwordx4 v7, s[8:11], s34 offen nt lds
  v_accvgpr_read_b32 v12, a210
  v_accvgpr_read_b32 v13, a211
  v_mul_f32 v10, s46, v10
  v_mul_f32 v11, s46, v11
  v_mfma_f32_16x16x32_bf16 v[120:123], v[56:59], v[16:19], v[120:123]
  v_mul_f32 v12, s46, v12
  v_mul_f32 v13, s46, v13
  v_cvt_pk_bf16_f32 v232, v10, v11
  v_cvt_pk_bf16_f32 v233, v12, v13
  v_accvgpr_read_b32 v10, a212
  v_accvgpr_read_b32 v11, a213
  v_mfma_f32_16x16x32_bf16 v[120:123], v[60:63], v[20:23], v[120:123]
  ds_read_b128 v[56:59], v1 offset:24576
  ds_read_b128 v[60:63], v2 offset:24576
  v_accvgpr_read_b32 v12, a214
  v_accvgpr_read_b32 v13, a215
  v_mul_f32 v10, s46, v10
  v_mul_f32 v11, s46, v11
  s_waitcnt lgkmcnt(9)
  v_mfma_f32_16x16x32_bf16 a[28:31], v[24:27], v[64:67], a[28:31]
  v_mul_f32 v12, s46, v12
  v_mul_f32 v13, s46, v13
  v_cvt_pk_bf16_f32 v234, v10, v11
  v_cvt_pk_bf16_f32 v235, v12, v13
  v_mul_f32 v10, s46, v112
  v_mul_f32 v11, s46, v113
  s_waitcnt lgkmcnt(7)
  v_mfma_f32_16x16x32_bf16 a[28:31], v[28:31], v[68:71], a[28:31]
  v_permlane16_swap_b32 v232, v234
  v_permlane16_swap_b32 v233, v235
  v_mul_f32 v12, s46, v114
  v_mul_f32 v13, s46, v115
  v_cvt_pk_bf16_f32 v112, v10, v11
  v_cvt_pk_bf16_f32 v113, v12, v13
  v_mfma_f32_16x16x32_bf16 a[92:95], v[24:27], v[72:75], a[92:95]
  v_mul_f32 v10, s46, v116
  v_mul_f32 v11, s46, v117
  v_mul_f32 v12, s46, v118
  v_mul_f32 v13, s46, v119
  v_cvt_pk_bf16_f32 v114, v10, v11
  v_cvt_pk_bf16_f32 v115, v12, v13
  v_mfma_f32_16x16x32_bf16 a[92:95], v[28:31], v[76:79], a[92:95]
  s_add_u32 m0, s32, 7168
  s_add_u32 s34, s30, 28672
  buffer_load_dwordx4 v7, s[8:11], s34 offen nt lds
  s_add_u32 s30, s30, 32768
  s_xor_b32 s32, s32, 65536
  v_mfma_f32_16x16x32_bf16 a[156:159], v[24:27], v[80:83], a[156:159]
  v_accvgpr_read_b32 v10, a24
  v_accvgpr_read_b32 v11, a25
  v_permlane16_swap_b32 v112, v114
  v_permlane16_swap_b32 v113, v115
  ds_write_b128 v9, v[112:115] offset:2048
  v_accvgpr_read_b32 v12, a26
  v_mfma_f32_16x16x32_bf16 a[156:159], v[28:31], v[84:87], a[156:159]
  v_accvgpr_read_b32 v13, a27
  v_mul_f32 v10, s46, v10
  v_mul_f32 v11, s46, v11
  v_mul_f32 v12, s46, v12
  v_mul_f32 v13, s46, v13
  v_cvt_pk_bf16_f32 v140, v10, v11
  v_mfma_f32_16x16x32_bf16 a[220:223], v[24:27], v[88:91], a[220:223]
  v_cvt_pk_bf16_f32 v141, v12, v13
  v_accvgpr_read_b32 v10, a28
  v_accvgpr_read_b32 v11, a29
  v_accvgpr_read_b32 v12, a30
  v_accvgpr_read_b32 v13, a31
  v_mul_f32 v10, s46, v10
  v_mfma_f32_16x16x32_bf16 a[220:223], v[28:31], v[92:95], a[220:223]
  v_mul_f32 v11, s46, v11
  v_mul_f32 v12, s46, v12
  v_mul_f32 v13, s46, v13
  v_cvt_pk_bf16_f32 v142, v10, v11
  v_cvt_pk_bf16_f32 v143, v12, v13
  v_accvgpr_read_b32 v10, a88
  v_mfma_f32_16x16x32_bf16 v[124:127], v[24:27], v[16:19], v[124:127]
  v_accvgpr_read_b32 v11, a89
  v_permlane16_swap_b32 v140, v142
  v_permlane16_swap_b32 v141, v143
  v_accvgpr_read_b32 v12, a90
  v_accvgpr_read_b32 v13, a91
  v_mul_f32 v10, s46, v10
  v_mfma_f32_16x16x32_bf16 v[124:127], v[28:31], v[20:23], v[124:127]
  v_mul_f32 v11, s46, v11
  v_mul_f32 v12, s46, v12
  v_mul_f32 v13, s46, v13
  v_cvt_pk_bf16_f32 v172, v10, v11
  v_cvt_pk_bf16_f32 v173, v12, v13
  v_accvgpr_read_b32 v10, a92
  v_accvgpr_read_b32 v11, a93
  v_accvgpr_read_b32 v12, a94
  v_accvgpr_read_b32 v13, a95
  v_mul_f32 v10, s46, v10
  v_mul_f32 v11, s46, v11
  v_mul_f32 v12, s46, v12
  v_mul_f32 v13, s46, v13
  v_cvt_pk_bf16_f32 v174, v10, v11
  v_cvt_pk_bf16_f32 v175, v12, v13
  v_accvgpr_read_b32 v10, a152
  v_accvgpr_read_b32 v11, a153
  v_permlane16_swap_b32 v172, v174
  v_permlane16_swap_b32 v173, v175
  v_accvgpr_read_b32 v12, a154
  v_accvgpr_read_b32 v13, a155
  v_mul_f32 v10, s46, v10
  v_mul_f32 v11, s46, v11
  v_mul_f32 v12, s46, v12
  v_mul_f32 v13, s46, v13
  v_cvt_pk_bf16_f32 v204, v10, v11
  v_cvt_pk_bf16_f32 v205, v12, v13
  v_accvgpr_read_b32 v10, a156
  v_accvgpr_read_b32 v11, a157
  v_accvgpr_read_b32 v12, a158
  v_accvgpr_read_b32 v13, a159
  v_mul_f32 v10, s46, v10
  v_mul_f32 v11, s46, v11
  v_mul_f32 v12, s46, v12
  v_mul_f32 v13, s46, v13
  v_cvt_pk_bf16_f32 v206, v10, v11
  v_cvt_pk_bf16_f32 v207, v12, v13
  v_accvgpr_read_b32 v10, a216
  v_accvgpr_read_b32 v11, a217
  v_permlane16_swap_b32 v204, v206
  v_permlane16_swap_b32 v205, v207
  v_accvgpr_read_b32 v12, a218
  v_accvgpr_read_b32 v13, a219
  v_mul_f32 v10, s46, v10
  v_mul_f32 v11, s46, v11
  v_mul_f32 v12, s46, v12
  v_mul_f32 v13, s46, v13
  v_cvt_pk_bf16_f32 v236, v10, v11
  v_cvt_pk_bf16_f32 v237, v12, v13
  v_accvgpr_read_b32 v10, a220
  v_accvgpr_read_b32 v11, a221
  v_accvgpr_read_b32 v12, a222
  v_accvgpr_read_b32 v13, a223
  v_mul_f32 v10, s46, v10
  v_mul_f32 v11, s46, v11
  v_mul_f32 v12, s46, v12
  v_mul_f32 v13, s46, v13
  v_cvt_pk_bf16_f32 v238, v10, v11
  v_cvt_pk_bf16_f32 v239, v12, v13
  v_mul_f32 v10, s46, v120
  v_mul_f32 v11, s46, v121
  v_permlane16_swap_b32 v236, v238
  v_permlane16_swap_b32 v237, v239
  v_mul_f32 v12, s46, v122
  v_mul_f32 v13, s46, v123
  v_cvt_pk_bf16_f32 v120, v10, v11
  v_cvt_pk_bf16_f32 v121, v12, v13
  v_mul_f32 v10, s46, v124
  v_mul_f32 v11, s46, v125
  v_mul_f32 v12, s46, v126
  v_mul_f32 v13, s46, v127
  v_cvt_pk_bf16_f32 v122, v10, v11
  v_cvt_pk_bf16_f32 v123, v12, v13
  s_nop 0
  v_permlane16_swap_b32 v120, v122
  v_permlane16_swap_b32 v121, v123
  ds_write_b128 v9, v[120:123] offset:3072
  v_mbcnt_lo_u32_b32 v16, -1, 0
  v_mbcnt_hi_u32_b32 v16, -1, v16
  v_and_b32 v17, 15, v16
  v_lshrrev_b32 v18, 4, v16
  v_bfe_u32 v19, v16, 2, 2
  v_and_b32 v20, 3, v16
  v_lshrrev_b32 v21, 3, v16
  v_and_b32 v22, 7, v16
  s_lshl_b32 s3, s48, 4
  s_add_u32 s3, s3, s49
  s_lshl_b32 s3, s3, 2
  s_add_u32 s3, s3, s28
  s_mul_i32 s3, s3, 7168
  s_cmp_eq_u32 s47, 0
  s_cselect_b32 s4, s66, s68
  s_cselect_b32 s5, s67, s69
  s_add_u32 s4, s4, s3
  s_addc_u32 s5, s5, 0
  s_mov_b32 s6, 7168
  s_mov_b32 s7, 0x20000
  v_lshlrev_b32 v23, 7, v16
  buffer_load_dword v0, v23, s[4:7], 0 offen
  v_lshrrev_b32 v23, 1, v19
  v_and_b32 v24, 1, v18
  v_lshlrev_b32 v24, 1, v24
  v_or_b32 v23, v23, v24
  v_lshlrev_b32 v24, 2, v18
  v_add_u32 v24, v24, v19
  v_lshlrev_b32 v24, 7, v24
  v_lshlrev_b32 v25, 3, v20
  v_add_u32 v24, v24, v25
  v_add_u32 v24, 65536, v24
  v_xor_b32 v25, 0, v23
  v_lshlrev_b32 v25, 5, v25
  v_add_u32 v3, v24, v25
  v_xor_b32 v25, 1, v23
  v_lshlrev_b32 v25, 5, v25
  v_add_u32 v4, v24, v25
  v_xor_b32 v25, 2, v23
  v_lshlrev_b32 v25, 5, v25
  v_add_u32 v5, v24, v25
  v_xor_b32 v25, 3, v23
  v_lshlrev_b32 v25, 5, v25
  v_add_u32 v6, v24, v25
  v_mov_b32 v10, 0
  v_mov_b32 v11, 0
  v_mov_b32 v12, 0
  v_mov_b32 v13, 0
  v_mov_b32 v14, 0
  s_waitcnt lgkmcnt(0)
  s_barrier
  s_cmp_lg_u32 s54, 0
  s_cbranch_scc1 K1_SAFE_P0
  ds_read_b128 v[32:35], v1 offset:0
  ds_read_b128 v[36:39], v2 offset:0
  ds_read_b128 v[40:43], v1 offset:8192
  ds_read_b128 v[44:47], v2 offset:8192
  ds_read_b128 v[48:51], v1 offset:16384
  ds_read_b128 v[52:55], v2 offset:16384
  ds_read_b128 v[56:59], v1 offset:24576
  ds_read_b128 v[60:63], v2 offset:24576
  s_waitcnt lgkmcnt(7)
  v_mfma_f32_16x16x32_bf16 v[16:19], v[32:35], v[128:131], 0
  ds_read_b128 v[80:83], v9 offset:0
  ds_read_b128 v[84:87], v9 offset:1024
  s_waitcnt lgkmcnt(8)
  v_mfma_f32_16x16x32_bf16 v[16:19], v[36:39], v[132:135], v[16:19]
  ds_read_b128 v[88:91], v9 offset:2048
  ds_read_b128 v[92:95], v9 offset:3072
  s_waitcnt lgkmcnt(9)
  v_mfma_f32_16x16x32_bf16 v[16:19], v[40:43], v[136:139], v[16:19]
  v_xor_b32 v3, 65536, v3
  v_xor_b32 v4, 65536, v4
  s_waitcnt lgkmcnt(8)
  v_mfma_f32_16x16x32_bf16 v[16:19], v[44:47], v[140:143], v[16:19]
  v_xor_b32 v5, 65536, v5
  v_xor_b32 v6, 65536, v6
  s_waitcnt lgkmcnt(7)
  v_mfma_f32_16x16x32_bf16 v[16:19], v[48:51], v[144:147], v[16:19]
  s_waitcnt lgkmcnt(6)
  v_mfma_f32_16x16x32_bf16 v[16:19], v[52:55], v[148:151], v[16:19]
  s_waitcnt lgkmcnt(5)
  v_mfma_f32_16x16x32_bf16 v[16:19], v[56:59], v[152:155], v[16:19]
  s_waitcnt lgkmcnt(4)
  v_mfma_f32_16x16x32_bf16 v[16:19], v[60:63], v[156:159], v[16:19]
  v_mfma_f32_16x16x32_bf16 v[20:23], v[32:35], v[160:163], 0
  ds_read_b128 v[24:27], v1 offset:2048
  v_mfma_f32_16x16x32_bf16 v[20:23], v[36:39], v[164:167], v[20:23]
  ds_read_b128 v[28:31], v2 offset:2048
  v_mfma_f32_16x16x32_bf16 v[20:23], v[40:43], v[168:171], v[20:23]
  s_nop 2
  v_exp_f32 v16, v16
  v_mfma_f32_16x16x32_bf16 v[20:23], v[44:47], v[172:175], v[20:23]
  v_exp_f32 v17, v17
  v_mfma_f32_16x16x32_bf16 v[20:23], v[48:51], v[176:179], v[20:23]
  v_exp_f32 v18, v18
  v_mfma_f32_16x16x32_bf16 v[20:23], v[52:55], v[180:183], v[20:23]
  v_exp_f32 v19, v19
  v_mfma_f32_16x16x32_bf16 v[20:23], v[56:59], v[184:187], v[20:23]
  v_add_f32 v10, v10, v16
  v_add_f32 v10, v10, v17
  v_mfma_f32_16x16x32_bf16 v[20:23], v[60:63], v[188:191], v[20:23]
  v_add_f32 v10, v10, v18
  v_add_f32 v10, v10, v19
  v_cvt_pk_bf16_f32 v64, v16, v17
  v_cvt_pk_bf16_f32 v65, v18, v19
  v_mfma_f32_16x16x32_bf16 v[16:19], v[32:35], v[192:195], 0
  v_mfma_f32_16x16x32_bf16 v[16:19], v[36:39], v[196:199], v[16:19]
  v_mfma_f32_16x16x32_bf16 v[16:19], v[40:43], v[200:203], v[16:19]
  s_nop 0
  v_exp_f32 v20, v20
  v_mfma_f32_16x16x32_bf16 v[16:19], v[44:47], v[204:207], v[16:19]
  v_exp_f32 v21, v21
  v_mfma_f32_16x16x32_bf16 v[16:19], v[48:51], v[208:211], v[16:19]
  v_exp_f32 v22, v22
  v_mfma_f32_16x16x32_bf16 v[16:19], v[52:55], v[212:215], v[16:19]
  v_exp_f32 v23, v23
  v_mfma_f32_16x16x32_bf16 v[16:19], v[56:59], v[216:219], v[16:19]
  v_add_f32 v11, v11, v20
  v_add_f32 v11, v11, v21
  v_mfma_f32_16x16x32_bf16 v[16:19], v[60:63], v[220:223], v[16:19]
  v_add_f32 v11, v11, v22
  v_add_f32 v11, v11, v23
  v_cvt_pk_bf16_f32 v68, v20, v21
  v_cvt_pk_bf16_f32 v69, v22, v23
  v_mfma_f32_16x16x32_bf16 v[20:23], v[32:35], v[224:227], 0
  v_mfma_f32_16x16x32_bf16 v[20:23], v[36:39], v[228:231], v[20:23]
  v_mfma_f32_16x16x32_bf16 v[20:23], v[40:43], v[232:235], v[20:23]
  s_nop 0
  v_exp_f32 v16, v16
  v_mfma_f32_16x16x32_bf16 v[20:23], v[44:47], v[236:239], v[20:23]
  v_exp_f32 v17, v17
  v_mfma_f32_16x16x32_bf16 v[20:23], v[48:51], v[240:243], v[20:23]
  v_exp_f32 v18, v18
  v_mfma_f32_16x16x32_bf16 v[20:23], v[52:55], v[244:247], v[20:23]
  v_exp_f32 v19, v19
  v_mfma_f32_16x16x32_bf16 v[20:23], v[56:59], v[248:251], v[20:23]
  v_add_f32 v12, v12, v16
  v_add_f32 v12, v12, v17
  v_mfma_f32_16x16x32_bf16 v[20:23], v[60:63], v[252:255], v[20:23]
  v_add_f32 v12, v12, v18
  v_add_f32 v12, v12, v19
  v_cvt_pk_bf16_f32 v72, v16, v17
  v_cvt_pk_bf16_f32 v73, v18, v19
  s_waitcnt lgkmcnt(5)
  v_mfma_f32_16x16x32_bf16 v[16:19], v[32:35], v[80:83], 0
  ds_read_b128 v[80:83], v9 offset:4096
  ds_read_b128 v[32:35], v1 offset:10240
  s_waitcnt lgkmcnt(6)
  v_mfma_f32_16x16x32_bf16 v[16:19], v[36:39], v[84:87], v[16:19]
  ds_read_b128 v[84:87], v9 offset:5120
  ds_read_b128 v[36:39], v2 offset:10240
  s_waitcnt lgkmcnt(7)
  v_mfma_f32_16x16x32_bf16 v[16:19], v[40:43], v[88:91], v[16:19]
  ds_read_b128 v[88:91], v9 offset:6144
  ds_read_b128 v[40:43], v1 offset:18432
  s_waitcnt lgkmcnt(8)
  v_mfma_f32_16x16x32_bf16 v[16:19], v[44:47], v[92:95], v[16:19]
  ds_read_b128 v[92:95], v9 offset:7168
  ds_read_b128 v[44:47], v2 offset:18432
  s_waitcnt lgkmcnt(7)
  v_mfma_f32_16x16x32_bf16 v[16:19], v[48:51], v[80:83], v[16:19]
  ds_read_b128 v[48:51], v1 offset:26624
  s_waitcnt lgkmcnt(6)
  v_mfma_f32_16x16x32_bf16 v[16:19], v[52:55], v[84:87], v[16:19]
  ds_read_b128 v[52:55], v2 offset:26624
  s_waitcnt lgkmcnt(5)
  v_mfma_f32_16x16x32_bf16 v[16:19], v[56:59], v[88:91], v[16:19]
  v_exp_f32 v20, v20
  s_waitcnt lgkmcnt(3)
  v_mfma_f32_16x16x32_bf16 v[16:19], v[60:63], v[92:95], v[16:19]
  v_exp_f32 v21, v21
  v_exp_f32 v22, v22
  v_exp_f32 v23, v23
  v_add_f32 v13, v13, v20
  v_add_f32 v13, v13, v21
  v_add_f32 v13, v13, v22
  v_add_f32 v13, v13, v23
  v_cvt_pk_bf16_f32 v76, v20, v21
  v_cvt_pk_bf16_f32 v77, v22, v23
  v_mfma_f32_16x16x32_bf16 v[20:23], v[24:27], v[128:131], 0
  ds_read_b128 v[80:83], v9 offset:0
  ds_read_b128 v[84:87], v9 offset:1024
  v_mfma_f32_16x16x32_bf16 v[20:23], v[28:31], v[132:135], v[20:23]
  ds_read_b128 v[88:91], v9 offset:2048
  ds_read_b128 v[92:95], v9 offset:3072
  v_mfma_f32_16x16x32_bf16 v[20:23], v[32:35], v[136:139], v[20:23]
  v_exp_f32 v16, v16
  v_mfma_f32_16x16x32_bf16 v[20:23], v[36:39], v[140:143], v[20:23]
  v_exp_f32 v17, v17
  v_mfma_f32_16x16x32_bf16 v[20:23], v[40:43], v[144:147], v[20:23]
  v_exp_f32 v18, v18
  s_waitcnt lgkmcnt(6)
  v_mfma_f32_16x16x32_bf16 v[20:23], v[44:47], v[148:151], v[20:23]
  v_exp_f32 v19, v19
  s_waitcnt lgkmcnt(5)
  v_mfma_f32_16x16x32_bf16 v[20:23], v[48:51], v[152:155], v[20:23]
  v_add_f32 v14, v14, v16
  v_add_f32 v14, v14, v17
  s_waitcnt lgkmcnt(4)
  v_mfma_f32_16x16x32_bf16 v[20:23], v[52:55], v[156:159], v[20:23]
  v_add_f32 v14, v14, v18
  v_add_f32 v14, v14, v19
  v_cvt_pk_bf16_f32 v16, v16, v17
  v_cvt_pk_bf16_f32 v17, v18, v19
  ds_write_b64 v9, v[16:17] offset:8192
  v_mfma_f32_16x16x32_bf16 v[16:19], v[24:27], v[160:163], 0
  ds_read_b128 v[56:59], v1 offset:4096
  v_mfma_f32_16x16x32_bf16 v[16:19], v[28:31], v[164:167], v[16:19]
  ds_read_b128 v[60:63], v2 offset:4096
  v_mfma_f32_16x16x32_bf16 v[16:19], v[32:35], v[168:171], v[16:19]
  v_exp_f32 v20, v20
  v_mfma_f32_16x16x32_bf16 v[16:19], v[36:39], v[172:175], v[16:19]
  v_exp_f32 v21, v21
  v_mfma_f32_16x16x32_bf16 v[16:19], v[40:43], v[176:179], v[16:19]
  v_exp_f32 v22, v22
  v_mfma_f32_16x16x32_bf16 v[16:19], v[44:47], v[180:183], v[16:19]
  v_exp_f32 v23, v23
  v_mfma_f32_16x16x32_bf16 v[16:19], v[48:51], v[184:187], v[16:19]
  v_add_f32 v10, v10, v20
  v_add_f32 v10, v10, v21
  v_mfma_f32_16x16x32_bf16 v[16:19], v[52:55], v[188:191], v[16:19]
  v_add_f32 v10, v10, v22
  v_add_f32 v10, v10, v23
  v_cvt_pk_bf16_f32 v66, v20, v21
  v_cvt_pk_bf16_f32 v67, v22, v23
  v_mfma_f32_16x16x32_bf16 v[20:23], v[24:27], v[192:195], 0
  v_mfma_f32_16x16x32_bf16 v[20:23], v[28:31], v[196:199], v[20:23]
  v_mfma_f32_16x16x32_bf16 v[20:23], v[32:35], v[200:203], v[20:23]
  s_nop 0
  v_exp_f32 v16, v16
  v_mfma_f32_16x16x32_bf16 v[20:23], v[36:39], v[204:207], v[20:23]
  v_exp_f32 v17, v17
  v_mfma_f32_16x16x32_bf16 v[20:23], v[40:43], v[208:211], v[20:23]
  v_exp_f32 v18, v18
  v_mfma_f32_16x16x32_bf16 v[20:23], v[44:47], v[212:215], v[20:23]
  v_exp_f32 v19, v19
  v_mfma_f32_16x16x32_bf16 v[20:23], v[48:51], v[216:219], v[20:23]
  v_add_f32 v11, v11, v16
  v_add_f32 v11, v11, v17
  v_mfma_f32_16x16x32_bf16 v[20:23], v[52:55], v[220:223], v[20:23]
  v_add_f32 v11, v11, v18
  v_add_f32 v11, v11, v19
  v_cvt_pk_bf16_f32 v70, v16, v17
  v_cvt_pk_bf16_f32 v71, v18, v19
  v_mfma_f32_16x16x32_bf16 v[16:19], v[24:27], v[224:227], 0
  v_mfma_f32_16x16x32_bf16 v[16:19], v[28:31], v[228:231], v[16:19]
  v_mfma_f32_16x16x32_bf16 v[16:19], v[32:35], v[232:235], v[16:19]
  s_nop 0
  v_exp_f32 v20, v20
  v_mfma_f32_16x16x32_bf16 v[16:19], v[36:39], v[236:239], v[16:19]
  v_exp_f32 v21, v21
  v_mfma_f32_16x16x32_bf16 v[16:19], v[40:43], v[240:243], v[16:19]
  v_exp_f32 v22, v22
  v_mfma_f32_16x16x32_bf16 v[16:19], v[44:47], v[244:247], v[16:19]
  v_exp_f32 v23, v23
  v_mfma_f32_16x16x32_bf16 v[16:19], v[48:51], v[248:251], v[16:19]
  v_add_f32 v12, v12, v20
  v_add_f32 v12, v12, v21
  v_mfma_f32_16x16x32_bf16 v[16:19], v[52:55], v[252:255], v[16:19]
  v_add_f32 v12, v12, v22
  v_add_f32 v12, v12, v23
  v_cvt_pk_bf16_f32 v74, v20, v21
  v_cvt_pk_bf16_f32 v75, v22, v23
  s_waitcnt lgkmcnt(6)
  v_mfma_f32_16x16x32_bf16 v[20:23], v[24:27], v[80:83], 0
  ds_read_b128 v[80:83], v9 offset:4096
  ds_read_b128 v[24:27], v1 offset:12288
  s_waitcnt lgkmcnt(7)
  v_mfma_f32_16x16x32_bf16 v[20:23], v[28:31], v[84:87], v[20:23]
  ds_read_b128 v[84:87], v9 offset:5120
  ds_read_b128 v[28:31], v2 offset:12288
  s_waitcnt lgkmcnt(8)
  v_mfma_f32_16x16x32_bf16 v[20:23], v[32:35], v[88:91], v[20:23]
  ds_read_b128 v[88:91], v9 offset:6144
  ds_read_b128 v[32:35], v1 offset:20480
  s_waitcnt lgkmcnt(9)
  v_mfma_f32_16x16x32_bf16 v[20:23], v[36:39], v[92:95], v[20:23]
  ds_read_b128 v[92:95], v9 offset:7168
  ds_read_b128 v[36:39], v2 offset:20480
  s_waitcnt lgkmcnt(7)
  v_mfma_f32_16x16x32_bf16 v[20:23], v[40:43], v[80:83], v[20:23]
  ds_read_b128 v[40:43], v1 offset:28672
  s_waitcnt lgkmcnt(6)
  v_mfma_f32_16x16x32_bf16 v[20:23], v[44:47], v[84:87], v[20:23]
  ds_read_b128 v[44:47], v2 offset:28672
  s_waitcnt lgkmcnt(5)
  v_mfma_f32_16x16x32_bf16 v[20:23], v[48:51], v[88:91], v[20:23]
  v_exp_f32 v16, v16
  s_waitcnt lgkmcnt(3)
  v_mfma_f32_16x16x32_bf16 v[20:23], v[52:55], v[92:95], v[20:23]
  v_exp_f32 v17, v17
  v_exp_f32 v18, v18
  v_exp_f32 v19, v19
  v_add_f32 v13, v13, v16
  v_add_f32 v13, v13, v17
  v_add_f32 v13, v13, v18
  v_add_f32 v13, v13, v19
  v_cvt_pk_bf16_f32 v78, v16, v17
  v_cvt_pk_bf16_f32 v79, v18, v19
  v_mfma_f32_16x16x32_bf16 v[16:19], v[56:59], v[128:131], 0
  v_mfma_f32_16x16x32_bf16 v[16:19], v[60:63], v[132:135], v[16:19]
  v_mfma_f32_16x16x32_bf16 v[16:19], v[24:27], v[136:139], v[16:19]
  v_exp_f32 v20, v20
  v_mfma_f32_16x16x32_bf16 v[16:19], v[28:31], v[140:143], v[16:19]
  v_exp_f32 v21, v21
  v_mfma_f32_16x16x32_bf16 v[16:19], v[32:35], v[144:147], v[16:19]
  v_exp_f32 v22, v22
  s_waitcnt lgkmcnt(2)
  v_mfma_f32_16x16x32_bf16 v[16:19], v[36:39], v[148:151], v[16:19]
  v_exp_f32 v23, v23
  s_waitcnt lgkmcnt(1)
  v_mfma_f32_16x16x32_bf16 v[16:19], v[40:43], v[152:155], v[16:19]
  v_add_f32 v14, v14, v20
  v_add_f32 v14, v14, v21
  s_waitcnt lgkmcnt(0)
  v_mfma_f32_16x16x32_bf16 v[16:19], v[44:47], v[156:159], v[16:19]
  v_add_f32 v14, v14, v22
  v_add_f32 v14, v14, v23
  v_cvt_pk_bf16_f32 v20, v20, v21
  v_cvt_pk_bf16_f32 v21, v22, v23
  ds_write_b64 v9, v[20:21] offset:8200
  v_mfma_f32_16x16x32_bf16 v[20:23], v[56:59], v[160:163], 0
  ds_read_b128 v[48:51], v1 offset:6144
  v_mfma_f32_16x16x32_bf16 v[20:23], v[60:63], v[164:167], v[20:23]
  ds_read_b128 v[52:55], v2 offset:6144
  v_mfma_f32_16x16x32_bf16 v[20:23], v[24:27], v[168:171], v[20:23]
  v_exp_f32 v16, v16
  v_mfma_f32_16x16x32_bf16 v[20:23], v[28:31], v[172:175], v[20:23]
  v_exp_f32 v17, v17
  v_mfma_f32_16x16x32_bf16 v[20:23], v[32:35], v[176:179], v[20:23]
  v_exp_f32 v18, v18
  v_mfma_f32_16x16x32_bf16 v[20:23], v[36:39], v[180:183], v[20:23]
  v_exp_f32 v19, v19
  v_mfma_f32_16x16x32_bf16 v[20:23], v[40:43], v[184:187], v[20:23]
  v_add_f32 v10, v10, v16
  v_add_f32 v10, v10, v17
  v_mfma_f32_16x16x32_bf16 v[20:23], v[44:47], v[188:191], v[20:23]
  v_add_f32 v10, v10, v18
  v_add_f32 v10, v10, v19
  v_cvt_pk_bf16_f32 v80, v16, v17
  v_cvt_pk_bf16_f32 v81, v18, v19
  v_mfma_f32_16x16x32_bf16 v[16:19], v[56:59], v[192:195], 0
  s_waitcnt vmcnt(9)
  s_waitcnt lgkmcnt(2)
  s_barrier
  v_mfma_f32_16x16x32_bf16 v[16:19], v[60:63], v[196:199], v[16:19]
  s_add_u32 m0, s33, 0
  s_add_u32 s34, s31, 0
  buffer_load_dwordx4 v8, s[12:15], s34 offen nt lds
  v_mfma_f32_16x16x32_bf16 v[16:19], v[24:27], v[200:203], v[16:19]
  v_exp_f32 v20, v20
  v_mfma_f32_16x16x32_bf16 v[16:19], v[28:31], v[204:207], v[16:19]
  v_exp_f32 v21, v21
  v_mfma_f32_16x16x32_bf16 v[16:19], v[32:35], v[208:211], v[16:19]
  v_exp_f32 v22, v22
  v_mfma_f32_16x16x32_bf16 v[16:19], v[36:39], v[212:215], v[16:19]
  v_exp_f32 v23, v23
  v_mfma_f32_16x16x32_bf16 v[16:19], v[40:43], v[216:219], v[16:19]
  s_add_u32 m0, s33, 1024
  s_add_u32 s34, s31, 4096
  buffer_load_dwordx4 v8, s[12:15], s34 offen nt lds
  v_mfma_f32_16x16x32_bf16 v[16:19], v[44:47], v[220:223], v[16:19]
  v_add_f32 v11, v11, v20
  v_add_f32 v11, v11, v21
  v_add_f32 v11, v11, v22
  v_add_f32 v11, v11, v23
  v_cvt_pk_bf16_f32 v84, v20, v21
  v_cvt_pk_bf16_f32 v85, v22, v23
  v_mfma_f32_16x16x32_bf16 v[20:23], v[56:59], v[224:227], 0
  ds_read_b128 v[56:59], v1 offset:14336
  v_mfma_f32_16x16x32_bf16 v[20:23], v[60:63], v[228:231], v[20:23]
  ds_read_b128 v[60:63], v2 offset:14336
  v_mfma_f32_16x16x32_bf16 v[20:23], v[24:27], v[232:235], v[20:23]
  ds_read_b128 v[24:27], v1 offset:22528
  v_mfma_f32_16x16x32_bf16 v[20:23], v[28:31], v[236:239], v[20:23]
  s_add_u32 m0, s33, 2048
  s_add_u32 s34, s31, 8192
  buffer_load_dwordx4 v8, s[12:15], s34 offen nt lds
  v_mfma_f32_16x16x32_bf16 v[20:23], v[32:35], v[240:243], v[20:23]
  ds_read_b128 v[28:31], v2 offset:22528
  ds_read_b128 v[32:35], v1 offset:30720
  v_mfma_f32_16x16x32_bf16 v[20:23], v[36:39], v[244:247], v[20:23]
  ds_read_b128 v[36:39], v2 offset:30720
  v_mfma_f32_16x16x32_bf16 v[20:23], v[40:43], v[248:251], v[20:23]
  v_exp_f32 v16, v16
  v_mfma_f32_16x16x32_bf16 v[20:23], v[44:47], v[252:255], v[20:23]
  v_exp_f32 v17, v17
  v_exp_f32 v18, v18
  v_exp_f32 v19, v19
  v_add_f32 v12, v12, v16
  v_add_f32 v12, v12, v17
  v_add_f32 v12, v12, v18
  v_add_f32 v12, v12, v19
  v_cvt_pk_bf16_f32 v88, v16, v17
  v_cvt_pk_bf16_f32 v89, v18, v19
  s_waitcnt lgkmcnt(7)
  v_mfma_f32_16x16x32_bf16 v[16:19], v[48:51], v[128:131], 0
  s_add_u32 m0, s33, 3072
  s_add_u32 s34, s31, 12288
  buffer_load_dwordx4 v8, s[12:15], s34 offen nt lds
  s_waitcnt lgkmcnt(6)
  v_mfma_f32_16x16x32_bf16 v[16:19], v[52:55], v[132:135], v[16:19]
  s_waitcnt lgkmcnt(5)
  v_mfma_f32_16x16x32_bf16 v[16:19], v[56:59], v[136:139], v[16:19]
  v_exp_f32 v20, v20
  s_waitcnt lgkmcnt(4)
  v_mfma_f32_16x16x32_bf16 v[16:19], v[60:63], v[140:143], v[16:19]
  v_exp_f32 v21, v21
  s_waitcnt lgkmcnt(3)
  v_mfma_f32_16x16x32_bf16 v[16:19], v[24:27], v[144:147], v[16:19]
  v_exp_f32 v22, v22
  s_waitcnt lgkmcnt(2)
  v_mfma_f32_16x16x32_bf16 v[16:19], v[28:31], v[148:151], v[16:19]
  s_add_u32 m0, s33, 4096
  s_add_u32 s34, s31, 16384
  buffer_load_dwordx4 v8, s[12:15], s34 offen nt lds
  s_waitcnt lgkmcnt(1)
  v_mfma_f32_16x16x32_bf16 v[16:19], v[32:35], v[152:155], v[16:19]
  v_exp_f32 v23, v23
  s_waitcnt lgkmcnt(0)
  v_mfma_f32_16x16x32_bf16 v[16:19], v[36:39], v[156:159], v[16:19]
  v_add_f32 v13, v13, v20
  v_add_f32 v13, v13, v21
  v_add_f32 v13, v13, v22
  v_add_f32 v13, v13, v23
  v_cvt_pk_bf16_f32 v92, v20, v21
  v_cvt_pk_bf16_f32 v93, v22, v23
  v_mfma_f32_16x16x32_bf16 v[20:23], v[48:51], v[160:163], 0
  ds_read_b64_tr_b16 v[40:41], v3 offset:16384
  ds_read_b64_tr_b16 v[42:43], v3 offset:18432
  v_mfma_f32_16x16x32_bf16 v[20:23], v[52:55], v[164:167], v[20:23]
  ds_read_b64_tr_b16 v[44:45], v3 offset:20480
  ds_read_b64_tr_b16 v[46:47], v3 offset:22528
  v_mfma_f32_16x16x32_bf16 v[20:23], v[56:59], v[168:171], v[20:23]
  s_add_u32 m0, s33, 5120
  s_add_u32 s34, s31, 20480
  buffer_load_dwordx4 v8, s[12:15], s34 offen nt lds
  v_mfma_f32_16x16x32_bf16 v[20:23], v[60:63], v[172:175], v[20:23]
  v_exp_f32 v16, v16
  v_mfma_f32_16x16x32_bf16 v[20:23], v[24:27], v[176:179], v[20:23]
  v_exp_f32 v17, v17
  v_mfma_f32_16x16x32_bf16 v[20:23], v[28:31], v[180:183], v[20:23]
  v_exp_f32 v18, v18
  v_mfma_f32_16x16x32_bf16 v[20:23], v[32:35], v[184:187], v[20:23]
  v_exp_f32 v19, v19
  v_mfma_f32_16x16x32_bf16 v[20:23], v[36:39], v[188:191], v[20:23]
  v_add_f32 v10, v10, v16
  v_add_f32 v10, v10, v17
  v_add_f32 v10, v10, v18
  v_add_f32 v10, v10, v19
  v_cvt_pk_bf16_f32 v82, v16, v17
  v_cvt_pk_bf16_f32 v83, v18, v19
  s_add_u32 m0, s33, 6144
  s_add_u32 s34, s31, 24576
  buffer_load_dwordx4 v8, s[12:15], s34 offen nt lds
  v_mfma_f32_16x16x32_bf16 v[16:19], v[48:51], v[192:195], 0
  v_mfma_f32_16x16x32_bf16 v[16:19], v[52:55], v[196:199], v[16:19]
  v_mfma_f32_16x16x32_bf16 v[16:19], v[56:59], v[200:203], v[16:19]
  v_exp_f32 v20, v20
  v_mfma_f32_16x16x32_bf16 v[16:19], v[60:63], v[204:207], v[16:19]
  v_exp_f32 v21, v21
  v_mfma_f32_16x16x32_bf16 v[16:19], v[24:27], v[208:211], v[16:19]
  s_add_u32 m0, s33, 7168
  s_add_u32 s34, s31, 28672
  buffer_load_dwordx4 v8, s[12:15], s34 offen nt lds
  s_add_u32 s31, s31, 32768
  s_xor_b32 s33, s33, 65536
  v_mfma_f32_16x16x32_bf16 v[16:19], v[28:31], v[212:215], v[16:19]
  v_exp_f32 v22, v22
  v_mfma_f32_16x16x32_bf16 v[16:19], v[32:35], v[216:219], v[16:19]
  v_exp_f32 v23, v23
  v_mfma_f32_16x16x32_bf16 v[16:19], v[36:39], v[220:223], v[16:19]
  v_add_f32 v11, v11, v20
  v_add_f32 v11, v11, v21
  v_add_f32 v11, v11, v22
  v_add_f32 v11, v11, v23
  v_cvt_pk_bf16_f32 v86, v20, v21
  v_cvt_pk_bf16_f32 v87, v22, v23
  v_mfma_f32_16x16x32_bf16 v[20:23], v[48:51], v[224:227], 0
  ds_read_b64_tr_b16 v[48:49], v4 offset:16384
  ds_read_b64_tr_b16 v[50:51], v4 offset:18432
  v_mfma_f32_16x16x32_bf16 v[20:23], v[52:55], v[228:231], v[20:23]
  ds_read_b64_tr_b16 v[52:53], v4 offset:20480
  ds_read_b64_tr_b16 v[54:55], v4 offset:22528
  v_mfma_f32_16x16x32_bf16 v[20:23], v[56:59], v[232:235], v[20:23]
  v_exp_f32 v16, v16
  v_mfma_f32_16x16x32_bf16 v[20:23], v[60:63], v[236:239], v[20:23]
  v_exp_f32 v17, v17
  v_mfma_f32_16x16x32_bf16 v[20:23], v[24:27], v[240:243], v[20:23]
  v_exp_f32 v18, v18
  v_mfma_f32_16x16x32_bf16 v[20:23], v[28:31], v[244:247], v[20:23]
  v_exp_f32 v19, v19
  v_mfma_f32_16x16x32_bf16 v[20:23], v[32:35], v[248:251], v[20:23]
  v_add_f32 v12, v12, v16
  v_add_f32 v12, v12, v17
  v_mfma_f32_16x16x32_bf16 v[20:23], v[36:39], v[252:255], v[20:23]
  v_add_f32 v12, v12, v18
  v_add_f32 v12, v12, v19
  v_cvt_pk_bf16_f32 v90, v16, v17
  v_cvt_pk_bf16_f32 v91, v18, v19
  ds_read_b64_tr_b16 v[56:57], v5 offset:16384
  ds_read_b64_tr_b16 v[58:59], v5 offset:18432
  ds_read_b64_tr_b16 v[60:61], v5 offset:20480
  ds_read_b64_tr_b16 v[62:63], v5 offset:22528
  s_waitcnt lgkmcnt(10)
  v_mfma_f32_16x16x32_bf16 a[32:35], v[40:43], v[64:67], 0
  s_waitcnt lgkmcnt(8)
  v_mfma_f32_16x16x32_bf16 a[32:35], v[44:47], v[80:83], a[32:35]
  v_exp_f32 v20, v20
  v_mfma_f32_16x16x32_bf16 a[96:99], v[40:43], v[68:71], 0
  v_exp_f32 v21, v21
  v_mfma_f32_16x16x32_bf16 a[96:99], v[44:47], v[84:87], a[96:99]
  v_exp_f32 v22, v22
  v_mfma_f32_16x16x32_bf16 a[160:163], v[40:43], v[72:75], 0
  v_exp_f32 v23, v23
  v_mfma_f32_16x16x32_bf16 a[160:163], v[44:47], v[88:91], a[160:163]
  v_add_f32 v13, v13, v20
  v_add_f32 v13, v13, v21
  v_mfma_f32_16x16x32_bf16 a[224:227], v[40:43], v[76:79], 0
  v_add_f32 v13, v13, v22
  v_add_f32 v13, v13, v23
  v_cvt_pk_bf16_f32 v94, v20, v21
  v_cvt_pk_bf16_f32 v95, v22, v23
  s_nop 1
  v_mfma_f32_16x16x32_bf16 a[224:227], v[44:47], v[92:95], a[224:227]
  ds_read_b64_tr_b16 v[24:25], v6 offset:16384
  ds_read_b64_tr_b16 v[26:27], v6 offset:18432
  s_waitcnt lgkmcnt(8)
  v_mfma_f32_16x16x32_bf16 a[36:39], v[48:51], v[64:67], 0
  ds_read_b64_tr_b16 v[28:29], v6 offset:20480
  ds_read_b64_tr_b16 v[30:31], v6 offset:22528
  s_waitcnt lgkmcnt(8)
  v_mfma_f32_16x16x32_bf16 a[36:39], v[52:55], v[80:83], a[36:39]
  v_xor_b32 v1, 65536, v1
  v_xor_b32 v2, 65536, v2
  v_mfma_f32_16x16x32_bf16 a[100:103], v[48:51], v[68:71], 0
  v_mfma_f32_16x16x32_bf16 a[100:103], v[52:55], v[84:87], a[100:103]
  v_mfma_f32_16x16x32_bf16 a[164:167], v[48:51], v[72:75], 0
  ds_read_b128 v[16:19], v9 offset:8192
  ds_read_b128 v[20:23], v9 offset:9216
  v_mfma_f32_16x16x32_bf16 a[164:167], v[52:55], v[88:91], a[164:167]
  v_mfma_f32_16x16x32_bf16 a[228:231], v[48:51], v[76:79], 0
  v_mfma_f32_16x16x32_bf16 a[228:231], v[52:55], v[92:95], a[228:231]
  ds_read_b64_tr_b16 v[32:33], v3 offset:24576
  ds_read_b64_tr_b16 v[34:35], v3 offset:26624
  s_waitcnt lgkmcnt(10)
  v_mfma_f32_16x16x32_bf16 a[40:43], v[56:59], v[64:67], 0
  ds_read_b64_tr_b16 v[36:37], v3 offset:28672
  ds_read_b64_tr_b16 v[38:39], v3 offset:30720
  s_waitcnt lgkmcnt(10)
  v_mfma_f32_16x16x32_bf16 a[40:43], v[60:63], v[80:83], a[40:43]
  v_mfma_f32_16x16x32_bf16 a[104:107], v[56:59], v[68:71], 0
  v_mfma_f32_16x16x32_bf16 a[104:107], v[60:63], v[84:87], a[104:107]
  v_mfma_f32_16x16x32_bf16 a[168:171], v[56:59], v[72:75], 0
  v_mfma_f32_16x16x32_bf16 a[168:171], v[60:63], v[88:91], a[168:171]
  v_mfma_f32_16x16x32_bf16 a[232:235], v[56:59], v[76:79], 0
  v_mfma_f32_16x16x32_bf16 a[232:235], v[60:63], v[92:95], a[232:235]
  ds_read_b64_tr_b16 v[48:49], v4 offset:24576
  ds_read_b64_tr_b16 v[50:51], v4 offset:26624
  s_waitcnt lgkmcnt(10)
  v_mfma_f32_16x16x32_bf16 a[44:47], v[24:27], v[64:67], 0
  ds_read_b64_tr_b16 v[52:53], v4 offset:28672
  ds_read_b64_tr_b16 v[54:55], v4 offset:30720
  s_waitcnt lgkmcnt(10)
  v_mfma_f32_16x16x32_bf16 a[44:47], v[28:31], v[80:83], a[44:47]
  v_mfma_f32_16x16x32_bf16 a[108:111], v[24:27], v[68:71], 0
  v_mfma_f32_16x16x32_bf16 a[108:111], v[28:31], v[84:87], a[108:111]
  v_mfma_f32_16x16x32_bf16 a[172:175], v[24:27], v[72:75], 0
  v_mfma_f32_16x16x32_bf16 a[172:175], v[28:31], v[88:91], a[172:175]
  v_mfma_f32_16x16x32_bf16 a[236:239], v[24:27], v[76:79], 0
  v_mfma_f32_16x16x32_bf16 a[236:239], v[28:31], v[92:95], a[236:239]
  ds_read_b64_tr_b16 v[56:57], v5 offset:24576
  ds_read_b64_tr_b16 v[58:59], v5 offset:26624
  s_waitcnt lgkmcnt(8)
  v_mfma_f32_16x16x32_bf16 a[48:51], v[32:35], v[64:67], 0
  ds_read_b64_tr_b16 v[60:61], v5 offset:28672
  ds_read_b64_tr_b16 v[62:63], v5 offset:30720
  s_waitcnt lgkmcnt(8)
  v_mfma_f32_16x16x32_bf16 a[48:51], v[36:39], v[80:83], a[48:51]
  v_mfma_f32_16x16x32_bf16 a[112:115], v[32:35], v[68:71], 0
  v_mfma_f32_16x16x32_bf16 a[112:115], v[36:39], v[84:87], a[112:115]
  v_mfma_f32_16x16x32_bf16 a[176:179], v[32:35], v[72:75], 0
  v_mfma_f32_16x16x32_bf16 a[176:179], v[36:39], v[88:91], a[176:179]
  v_mfma_f32_16x16x32_bf16 a[240:243], v[32:35], v[76:79], 0
  v_mfma_f32_16x16x32_bf16 a[240:243], v[36:39], v[92:95], a[240:243]
  ds_read_b64_tr_b16 v[40:41], v6 offset:24576
  ds_read_b64_tr_b16 v[42:43], v6 offset:26624
  s_waitcnt lgkmcnt(8)
  v_mfma_f32_16x16x32_bf16 a[52:55], v[48:51], v[64:67], 0
  ds_read_b64_tr_b16 v[44:45], v6 offset:28672
  ds_read_b64_tr_b16 v[46:47], v6 offset:30720
  s_waitcnt lgkmcnt(8)
  v_mfma_f32_16x16x32_bf16 a[52:55], v[52:55], v[80:83], a[52:55]
  v_mfma_f32_16x16x32_bf16 a[116:119], v[48:51], v[68:71], 0
  v_mfma_f32_16x16x32_bf16 a[116:119], v[52:55], v[84:87], a[116:119]
  v_mfma_f32_16x16x32_bf16 a[180:183], v[48:51], v[72:75], 0
  v_mfma_f32_16x16x32_bf16 a[180:183], v[52:55], v[88:91], a[180:183]
  v_mfma_f32_16x16x32_bf16 a[244:247], v[48:51], v[76:79], 0
  v_mfma_f32_16x16x32_bf16 a[244:247], v[52:55], v[92:95], a[244:247]
  ds_read_b64_tr_b16 v[24:25], v3 offset:0
  ds_read_b64_tr_b16 v[26:27], v3 offset:2048
  s_waitcnt lgkmcnt(8)
  v_mfma_f32_16x16x32_bf16 a[56:59], v[56:59], v[64:67], 0
  ds_read_b64_tr_b16 v[28:29], v3 offset:4096
  ds_read_b64_tr_b16 v[30:31], v3 offset:6144
  s_waitcnt lgkmcnt(8)
  v_mfma_f32_16x16x32_bf16 a[56:59], v[60:63], v[80:83], a[56:59]
  v_mfma_f32_16x16x32_bf16 a[120:123], v[56:59], v[68:71], 0
  v_mfma_f32_16x16x32_bf16 a[120:123], v[60:63], v[84:87], a[120:123]
  v_mfma_f32_16x16x32_bf16 a[184:187], v[56:59], v[72:75], 0
  v_mfma_f32_16x16x32_bf16 a[184:187], v[60:63], v[88:91], a[184:187]
  v_mfma_f32_16x16x32_bf16 a[248:251], v[56:59], v[76:79], 0
  v_mfma_f32_16x16x32_bf16 a[248:251], v[60:63], v[92:95], a[248:251]
  ds_read_b64_tr_b16 v[48:49], v4 offset:0
  ds_read_b64_tr_b16 v[50:51], v4 offset:2048
  s_waitcnt lgkmcnt(8)
  v_mfma_f32_16x16x32_bf16 a[60:63], v[40:43], v[64:67], 0
  ds_read_b64_tr_b16 v[52:53], v4 offset:4096
  ds_read_b64_tr_b16 v[54:55], v4 offset:6144
  s_waitcnt lgkmcnt(8)
  v_mfma_f32_16x16x32_bf16 a[60:63], v[44:47], v[80:83], a[60:63]
  v_mfma_f32_16x16x32_bf16 a[124:127], v[40:43], v[68:71], 0
  v_mfma_f32_16x16x32_bf16 a[124:127], v[44:47], v[84:87], a[124:127]
  v_mfma_f32_16x16x32_bf16 a[188:191], v[40:43], v[72:75], 0
  v_mfma_f32_16x16x32_bf16 a[188:191], v[44:47], v[88:91], a[188:191]
  v_mfma_f32_16x16x32_bf16 a[252:255], v[40:43], v[76:79], 0
  v_mfma_f32_16x16x32_bf16 a[252:255], v[44:47], v[92:95], a[252:255]
  ds_read_b64_tr_b16 v[56:57], v5 offset:0
  ds_read_b64_tr_b16 v[58:59], v5 offset:2048
  s_waitcnt lgkmcnt(8)
  v_mfma_f32_16x16x32_bf16 a[0:3], v[24:27], v[64:67], 0
  ds_read_b64_tr_b16 v[60:61], v5 offset:4096
  ds_read_b64_tr_b16 v[62:63], v5 offset:6144
  s_waitcnt lgkmcnt(8)
  v_mfma_f32_16x16x32_bf16 a[0:3], v[28:31], v[80:83], a[0:3]
  v_mfma_f32_16x16x32_bf16 a[64:67], v[24:27], v[68:71], 0
  v_mfma_f32_16x16x32_bf16 a[64:67], v[28:31], v[84:87], a[64:67]
  v_mfma_f32_16x16x32_bf16 a[128:131], v[24:27], v[72:75], 0
  v_mfma_f32_16x16x32_bf16 a[128:131], v[28:31], v[88:91], a[128:131]
  v_mfma_f32_16x16x32_bf16 a[192:195], v[24:27], v[76:79], 0
  v_mfma_f32_16x16x32_bf16 a[192:195], v[28:31], v[92:95], a[192:195]
  v_mfma_f32_16x16x32_bf16 v[96:99], v[24:27], v[16:19], 0
  v_mfma_f32_16x16x32_bf16 v[96:99], v[28:31], v[20:23], v[96:99]
  ds_read_b64_tr_b16 v[32:33], v6 offset:0
  ds_read_b64_tr_b16 v[34:35], v6 offset:2048
  s_waitcnt lgkmcnt(8)
  v_mfma_f32_16x16x32_bf16 a[4:7], v[48:51], v[64:67], 0
  ds_read_b64_tr_b16 v[36:37], v6 offset:4096
  ds_read_b64_tr_b16 v[38:39], v6 offset:6144
  s_waitcnt lgkmcnt(8)
  v_mfma_f32_16x16x32_bf16 a[4:7], v[52:55], v[80:83], a[4:7]
  v_mfma_f32_16x16x32_bf16 a[68:71], v[48:51], v[68:71], 0
  v_mfma_f32_16x16x32_bf16 a[68:71], v[52:55], v[84:87], a[68:71]
  v_mfma_f32_16x16x32_bf16 a[132:135], v[48:51], v[72:75], 0
  v_mfma_f32_16x16x32_bf16 a[132:135], v[52:55], v[88:91], a[132:135]
  v_mfma_f32_16x16x32_bf16 a[196:199], v[48:51], v[76:79], 0
  v_mfma_f32_16x16x32_bf16 a[196:199], v[52:55], v[92:95], a[196:199]
  v_mfma_f32_16x16x32_bf16 v[100:103], v[48:51], v[16:19], 0
  v_mfma_f32_16x16x32_bf16 v[100:103], v[52:55], v[20:23], v[100:103]
  ds_read_b64_tr_b16 v[40:41], v3 offset:8192
  ds_read_b64_tr_b16 v[42:43], v3 offset:10240
  s_waitcnt lgkmcnt(8)
  v_mfma_f32_16x16x32_bf16 a[8:11], v[56:59], v[64:67], 0
  ds_read_b64_tr_b16 v[44:45], v3 offset:12288
  ds_read_b64_tr_b16 v[46:47], v3 offset:14336
  s_waitcnt lgkmcnt(8)
  v_mfma_f32_16x16x32_bf16 a[8:11], v[60:63], v[80:83], a[8:11]
  v_mfma_f32_16x16x32_bf16 a[72:75], v[56:59], v[68:71], 0
  v_mfma_f32_16x16x32_bf16 a[72:75], v[60:63], v[84:87], a[72:75]
  v_mfma_f32_16x16x32_bf16 a[136:139], v[56:59], v[72:75], 0
  v_mfma_f32_16x16x32_bf16 a[136:139], v[60:63], v[88:91], a[136:139]
  v_mfma_f32_16x16x32_bf16 a[200:203], v[56:59], v[76:79], 0
  v_mfma_f32_16x16x32_bf16 a[200:203], v[60:63], v[92:95], a[200:203]
  v_mfma_f32_16x16x32_bf16 v[104:107], v[56:59], v[16:19], 0
  v_mfma_f32_16x16x32_bf16 v[104:107], v[60:63], v[20:23], v[104:107]
  ds_read_b64_tr_b16 v[48:49], v4 offset:8192
  ds_read_b64_tr_b16 v[50:51], v4 offset:10240
  s_waitcnt lgkmcnt(8)
  v_mfma_f32_16x16x32_bf16 a[12:15], v[32:35], v[64:67], 0
  s_waitcnt vmcnt(9)
  s_barrier
  ds_read_b64_tr_b16 v[52:53], v4 offset:12288
  s_waitcnt lgkmcnt(7)
  v_mfma_f32_16x16x32_bf16 a[12:15], v[36:39], v[80:83], a[12:15]
  s_add_u32 m0, s32, 0
  s_add_u32 s34, s30, 0
  buffer_load_dwordx4 v7, s[8:11], s34 offen nt lds
  v_mfma_f32_16x16x32_bf16 a[76:79], v[32:35], v[68:71], 0
  ds_read_b64_tr_b16 v[54:55], v4 offset:14336
  v_mfma_f32_16x16x32_bf16 a[76:79], v[36:39], v[84:87], a[76:79]
  v_mfma_f32_16x16x32_bf16 a[140:143], v[32:35], v[72:75], 0
  v_mfma_f32_16x16x32_bf16 a[140:143], v[36:39], v[88:91], a[140:143]
  v_mfma_f32_16x16x32_bf16 a[204:207], v[32:35], v[76:79], 0
  v_mfma_f32_16x16x32_bf16 a[204:207], v[36:39], v[92:95], a[204:207]
  s_add_u32 m0, s32, 1024
  s_add_u32 s34, s30, 4096
  buffer_load_dwordx4 v7, s[8:11], s34 offen nt lds
  v_mfma_f32_16x16x32_bf16 v[108:111], v[32:35], v[16:19], 0
  v_mfma_f32_16x16x32_bf16 v[108:111], v[36:39], v[20:23], v[108:111]
  ds_read_b64_tr_b16 v[56:57], v5 offset:8192
  ds_read_b64_tr_b16 v[58:59], v5 offset:10240
  s_waitcnt lgkmcnt(8)
  v_mfma_f32_16x16x32_bf16 a[16:19], v[40:43], v[64:67], 0
  ds_read_b64_tr_b16 v[60:61], v5 offset:12288
  ds_read_b64_tr_b16 v[62:63], v5 offset:14336
  s_waitcnt lgkmcnt(8)
  v_mfma_f32_16x16x32_bf16 a[16:19], v[44:47], v[80:83], a[16:19]
  ds_read_b128 v[32:35], v1 offset:0
  ds_read_b128 v[36:39], v2 offset:0
  v_mfma_f32_16x16x32_bf16 a[80:83], v[40:43], v[68:71], 0
  v_mfma_f32_16x16x32_bf16 a[80:83], v[44:47], v[84:87], a[80:83]
  s_add_u32 m0, s32, 2048
  s_add_u32 s34, s30, 8192
  buffer_load_dwordx4 v7, s[8:11], s34 offen nt lds
  v_mfma_f32_16x16x32_bf16 a[144:147], v[40:43], v[72:75], 0
  v_mfma_f32_16x16x32_bf16 a[144:147], v[44:47], v[88:91], a[144:147]
  v_mfma_f32_16x16x32_bf16 a[208:211], v[40:43], v[76:79], 0
  v_mfma_f32_16x16x32_bf16 a[208:211], v[44:47], v[92:95], a[208:211]
  v_mfma_f32_16x16x32_bf16 v[112:115], v[40:43], v[16:19], 0
  v_mfma_f32_16x16x32_bf16 v[112:115], v[44:47], v[20:23], v[112:115]
  s_add_u32 m0, s32, 3072
  s_add_u32 s34, s30, 12288
  buffer_load_dwordx4 v7, s[8:11], s34 offen nt lds
  s_waitcnt lgkmcnt(8)
  v_mfma_f32_16x16x32_bf16 a[20:23], v[48:51], v[64:67], 0
  ds_read_b64_tr_b16 v[24:25], v6 offset:8192
  ds_read_b64_tr_b16 v[26:27], v6 offset:10240
  s_waitcnt lgkmcnt(8)
  v_mfma_f32_16x16x32_bf16 a[20:23], v[52:55], v[80:83], a[20:23]
  ds_read_b64_tr_b16 v[28:29], v6 offset:12288
  ds_read_b64_tr_b16 v[30:31], v6 offset:14336
  v_mfma_f32_16x16x32_bf16 a[84:87], v[48:51], v[68:71], 0
  ds_read_b128 v[40:43], v1 offset:8192
  ds_read_b128 v[44:47], v2 offset:8192
  v_mfma_f32_16x16x32_bf16 a[84:87], v[52:55], v[84:87], a[84:87]
  v_mfma_f32_16x16x32_bf16 a[148:151], v[48:51], v[72:75], 0
  v_mfma_f32_16x16x32_bf16 a[148:151], v[52:55], v[88:91], a[148:151]
  s_add_u32 m0, s32, 4096
  s_add_u32 s34, s30, 16384
  buffer_load_dwordx4 v7, s[8:11], s34 offen nt lds
  v_mfma_f32_16x16x32_bf16 a[212:215], v[48:51], v[76:79], 0
  v_mfma_f32_16x16x32_bf16 a[212:215], v[52:55], v[92:95], a[212:215]
  v_mfma_f32_16x16x32_bf16 v[116:119], v[48:51], v[16:19], 0
  v_mfma_f32_16x16x32_bf16 v[116:119], v[52:55], v[20:23], v[116:119]
  ds_read_b128 v[48:51], v1 offset:16384
  ds_read_b128 v[52:55], v2 offset:16384
  s_waitcnt lgkmcnt(12)
  v_mfma_f32_16x16x32_bf16 a[24:27], v[56:59], v[64:67], 0
  s_waitcnt lgkmcnt(10)
  v_mfma_f32_16x16x32_bf16 a[24:27], v[60:63], v[80:83], a[24:27]
  s_add_u32 m0, s32, 5120
  s_add_u32 s34, s30, 20480
  buffer_load_dwordx4 v7, s[8:11], s34 offen nt lds
  v_mfma_f32_16x16x32_bf16 a[88:91], v[56:59], v[68:71], 0
  v_mfma_f32_16x16x32_bf16 a[88:91], v[60:63], v[84:87], a[88:91]
  v_mfma_f32_16x16x32_bf16 a[152:155], v[56:59], v[72:75], 0
  v_mfma_f32_16x16x32_bf16 a[152:155], v[60:63], v[88:91], a[152:155]
  v_mfma_f32_16x16x32_bf16 a[216:219], v[56:59], v[76:79], 0
  v_mfma_f32_16x16x32_bf16 a[216:219], v[60:63], v[92:95], a[216:219]
  s_add_u32 m0, s32, 6144
  s_add_u32 s34, s30, 24576
  buffer_load_dwordx4 v7, s[8:11], s34 offen nt lds
  v_mfma_f32_16x16x32_bf16 v[120:123], v[56:59], v[16:19], 0
  v_mfma_f32_16x16x32_bf16 v[120:123], v[60:63], v[20:23], v[120:123]
  ds_read_b128 v[56:59], v1 offset:24576
  ds_read_b128 v[60:63], v2 offset:24576
  s_waitcnt lgkmcnt(8)
  v_mfma_f32_16x16x32_bf16 a[28:31], v[24:27], v[64:67], 0
  s_waitcnt lgkmcnt(6)
  v_mfma_f32_16x16x32_bf16 a[28:31], v[28:31], v[80:83], a[28:31]
  v_mfma_f32_16x16x32_bf16 a[92:95], v[24:27], v[68:71], 0
  v_mfma_f32_16x16x32_bf16 a[92:95], v[28:31], v[84:87], a[92:95]
  s_add_u32 m0, s32, 7168
  s_add_u32 s34, s30, 28672
  buffer_load_dwordx4 v7, s[8:11], s34 offen nt lds
  s_add_u32 s30, s30, 32768
  s_xor_b32 s32, s32, 65536
  v_mfma_f32_16x16x32_bf16 a[156:159], v[24:27], v[72:75], 0
  v_mfma_f32_16x16x32_bf16 a[156:159], v[28:31], v[88:91], a[156:159]
  v_mfma_f32_16x16x32_bf16 a[220:223], v[24:27], v[76:79], 0
  v_mfma_f32_16x16x32_bf16 a[220:223], v[28:31], v[92:95], a[220:223]
  v_mfma_f32_16x16x32_bf16 v[124:127], v[24:27], v[16:19], 0
  v_mfma_f32_16x16x32_bf16 v[124:127], v[28:31], v[20:23], v[124:127]
  s_mov_b32 s29, 14
  s_nop 9
K1_LOOP_P0:
  v_mfma_f32_16x16x32_bf16 v[16:19], v[32:35], v[128:131], 0
  ds_read_b128 v[80:83], v9 offset:0
  ds_read_b128 v[84:87], v9 offset:1024
  v_mfma_f32_16x16x32_bf16 v[16:19], v[36:39], v[132:135], v[16:19]
  ds_read_b128 v[88:91], v9 offset:2048
  ds_read_b128 v[92:95], v9 offset:3072
  s_waitcnt lgkmcnt(9)
  v_mfma_f32_16x16x32_bf16 v[16:19], v[40:43], v[136:139], v[16:19]
  v_xor_b32 v3, 65536, v3
  v_xor_b32 v4, 65536, v4
  s_waitcnt lgkmcnt(8)
  v_mfma_f32_16x16x32_bf16 v[16:19], v[44:47], v[140:143], v[16:19]
  v_xor_b32 v5, 65536, v5
  v_xor_b32 v6, 65536, v6
  s_waitcnt lgkmcnt(7)
  v_mfma_f32_16x16x32_bf16 v[16:19], v[48:51], v[144:147], v[16:19]
  s_waitcnt lgkmcnt(6)
  v_mfma_f32_16x16x32_bf16 v[16:19], v[52:55], v[148:151], v[16:19]
  s_waitcnt lgkmcnt(5)
  v_mfma_f32_16x16x32_bf16 v[16:19], v[56:59], v[152:155], v[16:19]
  s_waitcnt lgkmcnt(4)
  v_mfma_f32_16x16x32_bf16 v[16:19], v[60:63], v[156:159], v[16:19]
  v_mfma_f32_16x16x32_bf16 v[20:23], v[32:35], v[160:163], 0
  ds_read_b128 v[24:27], v1 offset:2048
  v_mfma_f32_16x16x32_bf16 v[20:23], v[36:39], v[164:167], v[20:23]
  ds_read_b128 v[28:31], v2 offset:2048
  v_mfma_f32_16x16x32_bf16 v[20:23], v[40:43], v[168:171], v[20:23]
  s_nop 2
  v_exp_f32 v16, v16
  v_mfma_f32_16x16x32_bf16 v[20:23], v[44:47], v[172:175], v[20:23]
  v_exp_f32 v17, v17
  v_mfma_f32_16x16x32_bf16 v[20:23], v[48:51], v[176:179], v[20:23]
  v_exp_f32 v18, v18
  v_mfma_f32_16x16x32_bf16 v[20:23], v[52:55], v[180:183], v[20:23]
  v_exp_f32 v19, v19
  v_mfma_f32_16x16x32_bf16 v[20:23], v[56:59], v[184:187], v[20:23]
  v_add_f32 v10, v10, v16
  v_add_f32 v10, v10, v17
  v_mfma_f32_16x16x32_bf16 v[20:23], v[60:63], v[188:191], v[20:23]
  v_add_f32 v10, v10, v18
  v_add_f32 v10, v10, v19
  v_cvt_pk_bf16_f32 v64, v16, v17
  v_cvt_pk_bf16_f32 v65, v18, v19
  v_mfma_f32_16x16x32_bf16 v[16:19], v[32:35], v[192:195], 0
  v_mfma_f32_16x16x32_bf16 v[16:19], v[36:39], v[196:199], v[16:19]
  v_mfma_f32_16x16x32_bf16 v[16:19], v[40:43], v[200:203], v[16:19]
  s_nop 0
  v_exp_f32 v20, v20
  v_mfma_f32_16x16x32_bf16 v[16:19], v[44:47], v[204:207], v[16:19]
  v_exp_f32 v21, v21
  v_mfma_f32_16x16x32_bf16 v[16:19], v[48:51], v[208:211], v[16:19]
  v_exp_f32 v22, v22
  v_mfma_f32_16x16x32_bf16 v[16:19], v[52:55], v[212:215], v[16:19]
  v_exp_f32 v23, v23
  v_mfma_f32_16x16x32_bf16 v[16:19], v[56:59], v[216:219], v[16:19]
  v_add_f32 v11, v11, v20
  v_add_f32 v11, v11, v21
  v_mfma_f32_16x16x32_bf16 v[16:19], v[60:63], v[220:223], v[16:19]
  v_add_f32 v11, v11, v22
  v_add_f32 v11, v11, v23
  v_cvt_pk_bf16_f32 v68, v20, v21
  v_cvt_pk_bf16_f32 v69, v22, v23
  v_mfma_f32_16x16x32_bf16 v[20:23], v[32:35], v[224:227], 0
  v_mfma_f32_16x16x32_bf16 v[20:23], v[36:39], v[228:231], v[20:23]
  v_mfma_f32_16x16x32_bf16 v[20:23], v[40:43], v[232:235], v[20:23]
  s_nop 0
  v_exp_f32 v16, v16
  v_mfma_f32_16x16x32_bf16 v[20:23], v[44:47], v[236:239], v[20:23]
  v_exp_f32 v17, v17
  v_mfma_f32_16x16x32_bf16 v[20:23], v[48:51], v[240:243], v[20:23]
  v_exp_f32 v18, v18
  v_mfma_f32_16x16x32_bf16 v[20:23], v[52:55], v[244:247], v[20:23]
  v_exp_f32 v19, v19
  v_mfma_f32_16x16x32_bf16 v[20:23], v[56:59], v[248:251], v[20:23]
  v_add_f32 v12, v12, v16
  v_add_f32 v12, v12, v17
  v_mfma_f32_16x16x32_bf16 v[20:23], v[60:63], v[252:255], v[20:23]
  v_add_f32 v12, v12, v18
  v_add_f32 v12, v12, v19
  v_cvt_pk_bf16_f32 v72, v16, v17
  v_cvt_pk_bf16_f32 v73, v18, v19
  s_waitcnt lgkmcnt(5)
  v_mfma_f32_16x16x32_bf16 v[16:19], v[32:35], v[80:83], 0
  ds_read_b128 v[80:83], v9 offset:4096
  ds_read_b128 v[32:35], v1 offset:10240
  s_waitcnt lgkmcnt(6)
  v_mfma_f32_16x16x32_bf16 v[16:19], v[36:39], v[84:87], v[16:19]
  ds_read_b128 v[84:87], v9 offset:5120
  ds_read_b128 v[36:39], v2 offset:10240
  s_waitcnt lgkmcnt(7)
  v_mfma_f32_16x16x32_bf16 v[16:19], v[40:43], v[88:91], v[16:19]
  ds_read_b128 v[88:91], v9 offset:6144
  ds_read_b128 v[40:43], v1 offset:18432
  s_waitcnt lgkmcnt(8)
  v_mfma_f32_16x16x32_bf16 v[16:19], v[44:47], v[92:95], v[16:19]
  ds_read_b128 v[92:95], v9 offset:7168
  ds_read_b128 v[44:47], v2 offset:18432
  s_waitcnt lgkmcnt(7)
  v_mfma_f32_16x16x32_bf16 v[16:19], v[48:51], v[80:83], v[16:19]
  ds_read_b128 v[48:51], v1 offset:26624
  s_waitcnt lgkmcnt(6)
  v_mfma_f32_16x16x32_bf16 v[16:19], v[52:55], v[84:87], v[16:19]
  ds_read_b128 v[52:55], v2 offset:26624
  s_waitcnt lgkmcnt(5)
  v_mfma_f32_16x16x32_bf16 v[16:19], v[56:59], v[88:91], v[16:19]
  v_exp_f32 v20, v20
  s_waitcnt lgkmcnt(3)
  v_mfma_f32_16x16x32_bf16 v[16:19], v[60:63], v[92:95], v[16:19]
  v_exp_f32 v21, v21
  v_exp_f32 v22, v22
  v_exp_f32 v23, v23
  v_add_f32 v13, v13, v20
  v_add_f32 v13, v13, v21
  v_add_f32 v13, v13, v22
  v_add_f32 v13, v13, v23
  v_cvt_pk_bf16_f32 v76, v20, v21
  v_cvt_pk_bf16_f32 v77, v22, v23
  v_mfma_f32_16x16x32_bf16 v[20:23], v[24:27], v[128:131], 0
  ds_read_b128 v[80:83], v9 offset:0
  ds_read_b128 v[84:87], v9 offset:1024
  v_mfma_f32_16x16x32_bf16 v[20:23], v[28:31], v[132:135], v[20:23]
  ds_read_b128 v[88:91], v9 offset:2048
  ds_read_b128 v[92:95], v9 offset:3072
  v_mfma_f32_16x16x32_bf16 v[20:23], v[32:35], v[136:139], v[20:23]
  v_exp_f32 v16, v16
  v_mfma_f32_16x16x32_bf16 v[20:23], v[36:39], v[140:143], v[20:23]
  v_exp_f32 v17, v17
  v_mfma_f32_16x16x32_bf16 v[20:23], v[40:43], v[144:147], v[20:23]
  v_exp_f32 v18, v18
  s_waitcnt lgkmcnt(6)
  v_mfma_f32_16x16x32_bf16 v[20:23], v[44:47], v[148:151], v[20:23]
  v_exp_f32 v19, v19
  s_waitcnt lgkmcnt(5)
  v_mfma_f32_16x16x32_bf16 v[20:23], v[48:51], v[152:155], v[20:23]
  v_add_f32 v14, v14, v16
  v_add_f32 v14, v14, v17
  s_waitcnt lgkmcnt(4)
  v_mfma_f32_16x16x32_bf16 v[20:23], v[52:55], v[156:159], v[20:23]
  v_add_f32 v14, v14, v18
  v_add_f32 v14, v14, v19
  v_cvt_pk_bf16_f32 v16, v16, v17
  v_cvt_pk_bf16_f32 v17, v18, v19
  ds_write_b64 v9, v[16:17] offset:8192
  v_mfma_f32_16x16x32_bf16 v[16:19], v[24:27], v[160:163], 0
  ds_read_b128 v[56:59], v1 offset:4096
  v_mfma_f32_16x16x32_bf16 v[16:19], v[28:31], v[164:167], v[16:19]
  ds_read_b128 v[60:63], v2 offset:4096
  v_mfma_f32_16x16x32_bf16 v[16:19], v[32:35], v[168:171], v[16:19]
  v_exp_f32 v20, v20
  v_mfma_f32_16x16x32_bf16 v[16:19], v[36:39], v[172:175], v[16:19]
  v_exp_f32 v21, v21
  v_mfma_f32_16x16x32_bf16 v[16:19], v[40:43], v[176:179], v[16:19]
  v_exp_f32 v22, v22
  v_mfma_f32_16x16x32_bf16 v[16:19], v[44:47], v[180:183], v[16:19]
  v_exp_f32 v23, v23
  v_mfma_f32_16x16x32_bf16 v[16:19], v[48:51], v[184:187], v[16:19]
  v_add_f32 v10, v10, v20
  v_add_f32 v10, v10, v21
  v_mfma_f32_16x16x32_bf16 v[16:19], v[52:55], v[188:191], v[16:19]
  v_add_f32 v10, v10, v22
  v_add_f32 v10, v10, v23
  v_cvt_pk_bf16_f32 v66, v20, v21
  v_cvt_pk_bf16_f32 v67, v22, v23
  v_mfma_f32_16x16x32_bf16 v[20:23], v[24:27], v[192:195], 0
  v_mfma_f32_16x16x32_bf16 v[20:23], v[28:31], v[196:199], v[20:23]
  v_mfma_f32_16x16x32_bf16 v[20:23], v[32:35], v[200:203], v[20:23]
  s_nop 0
  v_exp_f32 v16, v16
  v_mfma_f32_16x16x32_bf16 v[20:23], v[36:39], v[204:207], v[20:23]
  v_exp_f32 v17, v17
  v_mfma_f32_16x16x32_bf16 v[20:23], v[40:43], v[208:211], v[20:23]
  v_exp_f32 v18, v18
  v_mfma_f32_16x16x32_bf16 v[20:23], v[44:47], v[212:215], v[20:23]
  v_exp_f32 v19, v19
  v_mfma_f32_16x16x32_bf16 v[20:23], v[48:51], v[216:219], v[20:23]
  v_add_f32 v11, v11, v16
  v_add_f32 v11, v11, v17
  v_mfma_f32_16x16x32_bf16 v[20:23], v[52:55], v[220:223], v[20:23]
  v_add_f32 v11, v11, v18
  v_add_f32 v11, v11, v19
  v_cvt_pk_bf16_f32 v70, v16, v17
  v_cvt_pk_bf16_f32 v71, v18, v19
  v_mfma_f32_16x16x32_bf16 v[16:19], v[24:27], v[224:227], 0
  v_mfma_f32_16x16x32_bf16 v[16:19], v[28:31], v[228:231], v[16:19]
  v_mfma_f32_16x16x32_bf16 v[16:19], v[32:35], v[232:235], v[16:19]
  s_nop 0
  v_exp_f32 v20, v20
  v_mfma_f32_16x16x32_bf16 v[16:19], v[36:39], v[236:239], v[16:19]
  v_exp_f32 v21, v21
  v_mfma_f32_16x16x32_bf16 v[16:19], v[40:43], v[240:243], v[16:19]
  v_exp_f32 v22, v22
  v_mfma_f32_16x16x32_bf16 v[16:19], v[44:47], v[244:247], v[16:19]
  v_exp_f32 v23, v23
  v_mfma_f32_16x16x32_bf16 v[16:19], v[48:51], v[248:251], v[16:19]
  v_add_f32 v12, v12, v20
  v_add_f32 v12, v12, v21
  v_mfma_f32_16x16x32_bf16 v[16:19], v[52:55], v[252:255], v[16:19]
  v_add_f32 v12, v12, v22
  v_add_f32 v12, v12, v23
  v_cvt_pk_bf16_f32 v74, v20, v21
  v_cvt_pk_bf16_f32 v75, v22, v23
  s_waitcnt lgkmcnt(6)
  v_mfma_f32_16x16x32_bf16 v[20:23], v[24:27], v[80:83], 0
  ds_read_b128 v[80:83], v9 offset:4096
  ds_read_b128 v[24:27], v1 offset:12288
  s_waitcnt lgkmcnt(7)
  v_mfma_f32_16x16x32_bf16 v[20:23], v[28:31], v[84:87], v[20:23]
  ds_read_b128 v[84:87], v9 offset:5120
  ds_read_b128 v[28:31], v2 offset:12288
  s_waitcnt lgkmcnt(8)
  v_mfma_f32_16x16x32_bf16 v[20:23], v[32:35], v[88:91], v[20:23]
  ds_read_b128 v[88:91], v9 offset:6144
  ds_read_b128 v[32:35], v1 offset:20480
  s_waitcnt lgkmcnt(9)
  v_mfma_f32_16x16x32_bf16 v[20:23], v[36:39], v[92:95], v[20:23]
  ds_read_b128 v[92:95], v9 offset:7168
  ds_read_b128 v[36:39], v2 offset:20480
  s_waitcnt lgkmcnt(7)
  v_mfma_f32_16x16x32_bf16 v[20:23], v[40:43], v[80:83], v[20:23]
  ds_read_b128 v[40:43], v1 offset:28672
  s_waitcnt lgkmcnt(6)
  v_mfma_f32_16x16x32_bf16 v[20:23], v[44:47], v[84:87], v[20:23]
  ds_read_b128 v[44:47], v2 offset:28672
  s_waitcnt lgkmcnt(5)
  v_mfma_f32_16x16x32_bf16 v[20:23], v[48:51], v[88:91], v[20:23]
  v_exp_f32 v16, v16
  s_waitcnt lgkmcnt(3)
  v_mfma_f32_16x16x32_bf16 v[20:23], v[52:55], v[92:95], v[20:23]
  v_exp_f32 v17, v17
  v_exp_f32 v18, v18
  v_exp_f32 v19, v19
  v_add_f32 v13, v13, v16
  v_add_f32 v13, v13, v17
  v_add_f32 v13, v13, v18
  v_add_f32 v13, v13, v19
  v_cvt_pk_bf16_f32 v78, v16, v17
  v_cvt_pk_bf16_f32 v79, v18, v19
  v_mfma_f32_16x16x32_bf16 v[16:19], v[56:59], v[128:131], 0
  v_mfma_f32_16x16x32_bf16 v[16:19], v[60:63], v[132:135], v[16:19]
  v_mfma_f32_16x16x32_bf16 v[16:19], v[24:27], v[136:139], v[16:19]
  v_exp_f32 v20, v20
  v_mfma_f32_16x16x32_bf16 v[16:19], v[28:31], v[140:143], v[16:19]
  v_exp_f32 v21, v21
  v_mfma_f32_16x16x32_bf16 v[16:19], v[32:35], v[144:147], v[16:19]
  v_exp_f32 v22, v22
  s_waitcnt lgkmcnt(2)
  v_mfma_f32_16x16x32_bf16 v[16:19], v[36:39], v[148:151], v[16:19]
  v_exp_f32 v23, v23
  s_waitcnt lgkmcnt(1)
  v_mfma_f32_16x16x32_bf16 v[16:19], v[40:43], v[152:155], v[16:19]
  v_add_f32 v14, v14, v20
  v_add_f32 v14, v14, v21
  s_waitcnt lgkmcnt(0)
  v_mfma_f32_16x16x32_bf16 v[16:19], v[44:47], v[156:159], v[16:19]
  v_add_f32 v14, v14, v22
  v_add_f32 v14, v14, v23
  v_cvt_pk_bf16_f32 v20, v20, v21
  v_cvt_pk_bf16_f32 v21, v22, v23
  ds_write_b64 v9, v[20:21] offset:8200
  v_mfma_f32_16x16x32_bf16 v[20:23], v[56:59], v[160:163], 0
  ds_read_b128 v[48:51], v1 offset:6144
  v_mfma_f32_16x16x32_bf16 v[20:23], v[60:63], v[164:167], v[20:23]
  ds_read_b128 v[52:55], v2 offset:6144
  v_mfma_f32_16x16x32_bf16 v[20:23], v[24:27], v[168:171], v[20:23]
  v_exp_f32 v16, v16
  v_mfma_f32_16x16x32_bf16 v[20:23], v[28:31], v[172:175], v[20:23]
  v_exp_f32 v17, v17
  v_mfma_f32_16x16x32_bf16 v[20:23], v[32:35], v[176:179], v[20:23]
  v_exp_f32 v18, v18
  v_mfma_f32_16x16x32_bf16 v[20:23], v[36:39], v[180:183], v[20:23]
  v_exp_f32 v19, v19
  v_mfma_f32_16x16x32_bf16 v[20:23], v[40:43], v[184:187], v[20:23]
  v_add_f32 v10, v10, v16
  v_add_f32 v10, v10, v17
  v_mfma_f32_16x16x32_bf16 v[20:23], v[44:47], v[188:191], v[20:23]
  v_add_f32 v10, v10, v18
  v_add_f32 v10, v10, v19
  v_cvt_pk_bf16_f32 v80, v16, v17
  v_cvt_pk_bf16_f32 v81, v18, v19
  v_mfma_f32_16x16x32_bf16 v[16:19], v[56:59], v[192:195], 0
  s_waitcnt vmcnt(8)
  s_waitcnt lgkmcnt(2)
  s_barrier
  v_mfma_f32_16x16x32_bf16 v[16:19], v[60:63], v[196:199], v[16:19]
  s_add_u32 m0, s33, 0
  s_add_u32 s34, s31, 0
  buffer_load_dwordx4 v8, s[12:15], s34 offen nt lds
  v_mfma_f32_16x16x32_bf16 v[16:19], v[24:27], v[200:203], v[16:19]
  v_exp_f32 v20, v20
  v_mfma_f32_16x16x32_bf16 v[16:19], v[28:31], v[204:207], v[16:19]
  v_exp_f32 v21, v21
  v_mfma_f32_16x16x32_bf16 v[16:19], v[32:35], v[208:211], v[16:19]
  v_exp_f32 v22, v22
  v_mfma_f32_16x16x32_bf16 v[16:19], v[36:39], v[212:215], v[16:19]
  v_exp_f32 v23, v23
  v_mfma_f32_16x16x32_bf16 v[16:19], v[40:43], v[216:219], v[16:19]
  s_add_u32 m0, s33, 1024
  s_add_u32 s34, s31, 4096
  buffer_load_dwordx4 v8, s[12:15], s34 offen nt lds
  v_mfma_f32_16x16x32_bf16 v[16:19], v[44:47], v[220:223], v[16:19]
  v_add_f32 v11, v11, v20
  v_add_f32 v11, v11, v21
  v_add_f32 v11, v11, v22
  v_add_f32 v11, v11, v23
  v_cvt_pk_bf16_f32 v84, v20, v21
  v_cvt_pk_bf16_f32 v85, v22, v23
  v_mfma_f32_16x16x32_bf16 v[20:23], v[56:59], v[224:227], 0
  ds_read_b128 v[56:59], v1 offset:14336
  v_mfma_f32_16x16x32_bf16 v[20:23], v[60:63], v[228:231], v[20:23]
  ds_read_b128 v[60:63], v2 offset:14336
  v_mfma_f32_16x16x32_bf16 v[20:23], v[24:27], v[232:235], v[20:23]
  ds_read_b128 v[24:27], v1 offset:22528
  v_mfma_f32_16x16x32_bf16 v[20:23], v[28:31], v[236:239], v[20:23]
  s_add_u32 m0, s33, 2048
  s_add_u32 s34, s31, 8192
  buffer_load_dwordx4 v8, s[12:15], s34 offen nt lds
  v_mfma_f32_16x16x32_bf16 v[20:23], v[32:35], v[240:243], v[20:23]
  ds_read_b128 v[28:31], v2 offset:22528
  ds_read_b128 v[32:35], v1 offset:30720
  v_mfma_f32_16x16x32_bf16 v[20:23], v[36:39], v[244:247], v[20:23]
  ds_read_b128 v[36:39], v2 offset:30720
  v_mfma_f32_16x16x32_bf16 v[20:23], v[40:43], v[248:251], v[20:23]
  v_exp_f32 v16, v16
  v_mfma_f32_16x16x32_bf16 v[20:23], v[44:47], v[252:255], v[20:23]
  v_exp_f32 v17, v17
  v_exp_f32 v18, v18
  v_exp_f32 v19, v19
  v_add_f32 v12, v12, v16
  v_add_f32 v12, v12, v17
  v_add_f32 v12, v12, v18
  v_add_f32 v12, v12, v19
  v_cvt_pk_bf16_f32 v88, v16, v17
  v_cvt_pk_bf16_f32 v89, v18, v19
  s_waitcnt lgkmcnt(7)
  v_mfma_f32_16x16x32_bf16 v[16:19], v[48:51], v[128:131], 0
  s_add_u32 m0, s33, 3072
  s_add_u32 s34, s31, 12288
  buffer_load_dwordx4 v8, s[12:15], s34 offen nt lds
  s_waitcnt lgkmcnt(6)
  v_mfma_f32_16x16x32_bf16 v[16:19], v[52:55], v[132:135], v[16:19]
  s_waitcnt lgkmcnt(5)
  v_mfma_f32_16x16x32_bf16 v[16:19], v[56:59], v[136:139], v[16:19]
  v_exp_f32 v20, v20
  s_waitcnt lgkmcnt(4)
  v_mfma_f32_16x16x32_bf16 v[16:19], v[60:63], v[140:143], v[16:19]
  v_exp_f32 v21, v21
  s_waitcnt lgkmcnt(3)
  v_mfma_f32_16x16x32_bf16 v[16:19], v[24:27], v[144:147], v[16:19]
  v_exp_f32 v22, v22
  s_waitcnt lgkmcnt(2)
  v_mfma_f32_16x16x32_bf16 v[16:19], v[28:31], v[148:151], v[16:19]
  s_add_u32 m0, s33, 4096
  s_add_u32 s34, s31, 16384
  buffer_load_dwordx4 v8, s[12:15], s34 offen nt lds
  s_waitcnt lgkmcnt(1)
  v_mfma_f32_16x16x32_bf16 v[16:19], v[32:35], v[152:155], v[16:19]
  v_exp_f32 v23, v23
  s_waitcnt lgkmcnt(0)
  v_mfma_f32_16x16x32_bf16 v[16:19], v[36:39], v[156:159], v[16:19]
  v_add_f32 v13, v13, v20
  v_add_f32 v13, v13, v21
  v_add_f32 v13, v13, v22
  v_add_f32 v13, v13, v23
  v_cvt_pk_bf16_f32 v92, v20, v21
  v_cvt_pk_bf16_f32 v93, v22, v23
  v_mfma_f32_16x16x32_bf16 v[20:23], v[48:51], v[160:163], 0
  ds_read_b64_tr_b16 v[40:41], v3 offset:16384
  ds_read_b64_tr_b16 v[42:43], v3 offset:18432
  v_mfma_f32_16x16x32_bf16 v[20:23], v[52:55], v[164:167], v[20:23]
  ds_read_b64_tr_b16 v[44:45], v3 offset:20480
  ds_read_b64_tr_b16 v[46:47], v3 offset:22528
  v_mfma_f32_16x16x32_bf16 v[20:23], v[56:59], v[168:171], v[20:23]
  s_add_u32 m0, s33, 5120
  s_add_u32 s34, s31, 20480
  buffer_load_dwordx4 v8, s[12:15], s34 offen nt lds
  v_mfma_f32_16x16x32_bf16 v[20:23], v[60:63], v[172:175], v[20:23]
  v_exp_f32 v16, v16
  v_mfma_f32_16x16x32_bf16 v[20:23], v[24:27], v[176:179], v[20:23]
  v_exp_f32 v17, v17
  v_mfma_f32_16x16x32_bf16 v[20:23], v[28:31], v[180:183], v[20:23]
  v_exp_f32 v18, v18
  v_mfma_f32_16x16x32_bf16 v[20:23], v[32:35], v[184:187], v[20:23]
  v_exp_f32 v19, v19
  v_mfma_f32_16x16x32_bf16 v[20:23], v[36:39], v[188:191], v[20:23]
  v_add_f32 v10, v10, v16
  v_add_f32 v10, v10, v17
  v_add_f32 v10, v10, v18
  v_add_f32 v10, v10, v19
  v_cvt_pk_bf16_f32 v82, v16, v17
  v_cvt_pk_bf16_f32 v83, v18, v19
  s_add_u32 m0, s33, 6144
  s_add_u32 s34, s31, 24576
  buffer_load_dwordx4 v8, s[12:15], s34 offen nt lds
  v_mfma_f32_16x16x32_bf16 v[16:19], v[48:51], v[192:195], 0
  v_mfma_f32_16x16x32_bf16 v[16:19], v[52:55], v[196:199], v[16:19]
  v_mfma_f32_16x16x32_bf16 v[16:19], v[56:59], v[200:203], v[16:19]
  v_exp_f32 v20, v20
  v_mfma_f32_16x16x32_bf16 v[16:19], v[60:63], v[204:207], v[16:19]
  v_exp_f32 v21, v21
  v_mfma_f32_16x16x32_bf16 v[16:19], v[24:27], v[208:211], v[16:19]
  s_add_u32 m0, s33, 7168
  s_add_u32 s34, s31, 28672
  buffer_load_dwordx4 v8, s[12:15], s34 offen nt lds
  s_add_u32 s31, s31, 32768
  s_xor_b32 s33, s33, 65536
  v_mfma_f32_16x16x32_bf16 v[16:19], v[28:31], v[212:215], v[16:19]
  v_exp_f32 v22, v22
  v_mfma_f32_16x16x32_bf16 v[16:19], v[32:35], v[216:219], v[16:19]
  v_exp_f32 v23, v23
  v_mfma_f32_16x16x32_bf16 v[16:19], v[36:39], v[220:223], v[16:19]
  v_add_f32 v11, v11, v20
  v_add_f32 v11, v11, v21
  v_add_f32 v11, v11, v22
  v_add_f32 v11, v11, v23
  v_cvt_pk_bf16_f32 v86, v20, v21
  v_cvt_pk_bf16_f32 v87, v22, v23
  v_mfma_f32_16x16x32_bf16 v[20:23], v[48:51], v[224:227], 0
  ds_read_b64_tr_b16 v[48:49], v4 offset:16384
  ds_read_b64_tr_b16 v[50:51], v4 offset:18432
  v_mfma_f32_16x16x32_bf16 v[20:23], v[52:55], v[228:231], v[20:23]
  ds_read_b64_tr_b16 v[52:53], v4 offset:20480
  ds_read_b64_tr_b16 v[54:55], v4 offset:22528
  v_mfma_f32_16x16x32_bf16 v[20:23], v[56:59], v[232:235], v[20:23]
  v_exp_f32 v16, v16
  v_mfma_f32_16x16x32_bf16 v[20:23], v[60:63], v[236:239], v[20:23]
  v_exp_f32 v17, v17
  v_mfma_f32_16x16x32_bf16 v[20:23], v[24:27], v[240:243], v[20:23]
  v_exp_f32 v18, v18
  v_mfma_f32_16x16x32_bf16 v[20:23], v[28:31], v[244:247], v[20:23]
  v_exp_f32 v19, v19
  v_mfma_f32_16x16x32_bf16 v[20:23], v[32:35], v[248:251], v[20:23]
  v_add_f32 v12, v12, v16
  v_add_f32 v12, v12, v17
  v_mfma_f32_16x16x32_bf16 v[20:23], v[36:39], v[252:255], v[20:23]
  v_add_f32 v12, v12, v18
  v_add_f32 v12, v12, v19
  v_cvt_pk_bf16_f32 v90, v16, v17
  v_cvt_pk_bf16_f32 v91, v18, v19
  ds_read_b64_tr_b16 v[56:57], v5 offset:16384
  ds_read_b64_tr_b16 v[58:59], v5 offset:18432
  ds_read_b64_tr_b16 v[60:61], v5 offset:20480
  ds_read_b64_tr_b16 v[62:63], v5 offset:22528
  s_waitcnt lgkmcnt(10)
  v_mfma_f32_16x16x32_bf16 a[32:35], v[40:43], v[64:67], a[32:35]
  s_waitcnt lgkmcnt(8)
  v_mfma_f32_16x16x32_bf16 a[32:35], v[44:47], v[80:83], a[32:35]
  v_exp_f32 v20, v20
  v_mfma_f32_16x16x32_bf16 a[96:99], v[40:43], v[68:71], a[96:99]
  v_exp_f32 v21, v21
  v_mfma_f32_16x16x32_bf16 a[96:99], v[44:47], v[84:87], a[96:99]
  v_exp_f32 v22, v22
  v_mfma_f32_16x16x32_bf16 a[160:163], v[40:43], v[72:75], a[160:163]
  v_exp_f32 v23, v23
  v_mfma_f32_16x16x32_bf16 a[160:163], v[44:47], v[88:91], a[160:163]
  v_add_f32 v13, v13, v20
  v_add_f32 v13, v13, v21
  v_mfma_f32_16x16x32_bf16 a[224:227], v[40:43], v[76:79], a[224:227]
  v_add_f32 v13, v13, v22
  v_add_f32 v13, v13, v23
  v_cvt_pk_bf16_f32 v94, v20, v21
  v_cvt_pk_bf16_f32 v95, v22, v23
  s_nop 1
  v_mfma_f32_16x16x32_bf16 a[224:227], v[44:47], v[92:95], a[224:227]
  ds_read_b64_tr_b16 v[24:25], v6 offset:16384
  ds_read_b64_tr_b16 v[26:27], v6 offset:18432
  s_waitcnt lgkmcnt(8)
  v_mfma_f32_16x16x32_bf16 a[36:39], v[48:51], v[64:67], a[36:39]
  ds_read_b64_tr_b16 v[28:29], v6 offset:20480
  ds_read_b64_tr_b16 v[30:31], v6 offset:22528
  s_waitcnt lgkmcnt(8)
  v_mfma_f32_16x16x32_bf16 a[36:39], v[52:55], v[80:83], a[36:39]
  v_xor_b32 v1, 65536, v1
  v_xor_b32 v2, 65536, v2
  v_mfma_f32_16x16x32_bf16 a[100:103], v[48:51], v[68:71], a[100:103]
  v_mfma_f32_16x16x32_bf16 a[100:103], v[52:55], v[84:87], a[100:103]
  v_mfma_f32_16x16x32_bf16 a[164:167], v[48:51], v[72:75], a[164:167]
  ds_read_b128 v[16:19], v9 offset:8192
  ds_read_b128 v[20:23], v9 offset:9216
  v_mfma_f32_16x16x32_bf16 a[164:167], v[52:55], v[88:91], a[164:167]
  v_mfma_f32_16x16x32_bf16 a[228:231], v[48:51], v[76:79], a[228:231]
  v_mfma_f32_16x16x32_bf16 a[228:231], v[52:55], v[92:95], a[228:231]
  ds_read_b64_tr_b16 v[32:33], v3 offset:24576
  ds_read_b64_tr_b16 v[34:35], v3 offset:26624
  s_waitcnt lgkmcnt(10)
  v_mfma_f32_16x16x32_bf16 a[40:43], v[56:59], v[64:67], a[40:43]
  ds_read_b64_tr_b16 v[36:37], v3 offset:28672
  ds_read_b64_tr_b16 v[38:39], v3 offset:30720
  s_waitcnt lgkmcnt(10)
  v_mfma_f32_16x16x32_bf16 a[40:43], v[60:63], v[80:83], a[40:43]
  v_mfma_f32_16x16x32_bf16 a[104:107], v[56:59], v[68:71], a[104:107]
  v_mfma_f32_16x16x32_bf16 a[104:107], v[60:63], v[84:87], a[104:107]
  v_mfma_f32_16x16x32_bf16 a[168:171], v[56:59], v[72:75], a[168:171]
  v_mfma_f32_16x16x32_bf16 a[168:171], v[60:63], v[88:91], a[168:171]
  v_mfma_f32_16x16x32_bf16 a[232:235], v[56:59], v[76:79], a[232:235]
  v_mfma_f32_16x16x32_bf16 a[232:235], v[60:63], v[92:95], a[232:235]
  ds_read_b64_tr_b16 v[48:49], v4 offset:24576
  ds_read_b64_tr_b16 v[50:51], v4 offset:26624
  s_waitcnt lgkmcnt(10)
  v_mfma_f32_16x16x32_bf16 a[44:47], v[24:27], v[64:67], a[44:47]
  ds_read_b64_tr_b16 v[52:53], v4 offset:28672
  ds_read_b64_tr_b16 v[54:55], v4 offset:30720
  s_waitcnt lgkmcnt(10)
  v_mfma_f32_16x16x32_bf16 a[44:47], v[28:31], v[80:83], a[44:47]
  v_mfma_f32_16x16x32_bf16 a[108:111], v[24:27], v[68:71], a[108:111]
  v_mfma_f32_16x16x32_bf16 a[108:111], v[28:31], v[84:87], a[108:111]
  v_mfma_f32_16x16x32_bf16 a[172:175], v[24:27], v[72:75], a[172:175]
  v_mfma_f32_16x16x32_bf16 a[172:175], v[28:31], v[88:91], a[172:175]
  v_mfma_f32_16x16x32_bf16 a[236:239], v[24:27], v[76:79], a[236:239]
  v_mfma_f32_16x16x32_bf16 a[236:239], v[28:31], v[92:95], a[236:239]
  ds_read_b64_tr_b16 v[56:57], v5 offset:24576
  ds_read_b64_tr_b16 v[58:59], v5 offset:26624
  s_waitcnt lgkmcnt(8)
  v_mfma_f32_16x16x32_bf16 a[48:51], v[32:35], v[64:67], a[48:51]
  ds_read_b64_tr_b16 v[60:61], v5 offset:28672
  ds_read_b64_tr_b16 v[62:63], v5 offset:30720
  s_waitcnt lgkmcnt(8)
  v_mfma_f32_16x16x32_bf16 a[48:51], v[36:39], v[80:83], a[48:51]
  v_mfma_f32_16x16x32_bf16 a[112:115], v[32:35], v[68:71], a[112:115]
  v_mfma_f32_16x16x32_bf16 a[112:115], v[36:39], v[84:87], a[112:115]
  v_mfma_f32_16x16x32_bf16 a[176:179], v[32:35], v[72:75], a[176:179]
  v_mfma_f32_16x16x32_bf16 a[176:179], v[36:39], v[88:91], a[176:179]
  v_mfma_f32_16x16x32_bf16 a[240:243], v[32:35], v[76:79], a[240:243]
  v_mfma_f32_16x16x32_bf16 a[240:243], v[36:39], v[92:95], a[240:243]
  ds_read_b64_tr_b16 v[40:41], v6 offset:24576
  ds_read_b64_tr_b16 v[42:43], v6 offset:26624
  s_waitcnt lgkmcnt(8)
  v_mfma_f32_16x16x32_bf16 a[52:55], v[48:51], v[64:67], a[52:55]
  ds_read_b64_tr_b16 v[44:45], v6 offset:28672
  ds_read_b64_tr_b16 v[46:47], v6 offset:30720
  s_waitcnt lgkmcnt(8)
  v_mfma_f32_16x16x32_bf16 a[52:55], v[52:55], v[80:83], a[52:55]
  v_mfma_f32_16x16x32_bf16 a[116:119], v[48:51], v[68:71], a[116:119]
  v_mfma_f32_16x16x32_bf16 a[116:119], v[52:55], v[84:87], a[116:119]
  v_mfma_f32_16x16x32_bf16 a[180:183], v[48:51], v[72:75], a[180:183]
  v_mfma_f32_16x16x32_bf16 a[180:183], v[52:55], v[88:91], a[180:183]
  v_mfma_f32_16x16x32_bf16 a[244:247], v[48:51], v[76:79], a[244:247]
  v_mfma_f32_16x16x32_bf16 a[244:247], v[52:55], v[92:95], a[244:247]
  ds_read_b64_tr_b16 v[24:25], v3 offset:0
  ds_read_b64_tr_b16 v[26:27], v3 offset:2048
  s_waitcnt lgkmcnt(8)
  v_mfma_f32_16x16x32_bf16 a[56:59], v[56:59], v[64:67], a[56:59]
  ds_read_b64_tr_b16 v[28:29], v3 offset:4096
  ds_read_b64_tr_b16 v[30:31], v3 offset:6144
  s_waitcnt lgkmcnt(8)
  v_mfma_f32_16x16x32_bf16 a[56:59], v[60:63], v[80:83], a[56:59]
  v_mfma_f32_16x16x32_bf16 a[120:123], v[56:59], v[68:71], a[120:123]
  v_mfma_f32_16x16x32_bf16 a[120:123], v[60:63], v[84:87], a[120:123]
  v_mfma_f32_16x16x32_bf16 a[184:187], v[56:59], v[72:75], a[184:187]
  v_mfma_f32_16x16x32_bf16 a[184:187], v[60:63], v[88:91], a[184:187]
  v_mfma_f32_16x16x32_bf16 a[248:251], v[56:59], v[76:79], a[248:251]
  v_mfma_f32_16x16x32_bf16 a[248:251], v[60:63], v[92:95], a[248:251]
  ds_read_b64_tr_b16 v[48:49], v4 offset:0
  ds_read_b64_tr_b16 v[50:51], v4 offset:2048
  s_waitcnt lgkmcnt(8)
  v_mfma_f32_16x16x32_bf16 a[60:63], v[40:43], v[64:67], a[60:63]
  ds_read_b64_tr_b16 v[52:53], v4 offset:4096
  ds_read_b64_tr_b16 v[54:55], v4 offset:6144
  s_waitcnt lgkmcnt(8)
  v_mfma_f32_16x16x32_bf16 a[60:63], v[44:47], v[80:83], a[60:63]
  v_mfma_f32_16x16x32_bf16 a[124:127], v[40:43], v[68:71], a[124:127]
  v_mfma_f32_16x16x32_bf16 a[124:127], v[44:47], v[84:87], a[124:127]
  v_mfma_f32_16x16x32_bf16 a[188:191], v[40:43], v[72:75], a[188:191]
  v_mfma_f32_16x16x32_bf16 a[188:191], v[44:47], v[88:91], a[188:191]
  v_mfma_f32_16x16x32_bf16 a[252:255], v[40:43], v[76:79], a[252:255]
  v_mfma_f32_16x16x32_bf16 a[252:255], v[44:47], v[92:95], a[252:255]
  ds_read_b64_tr_b16 v[56:57], v5 offset:0
  ds_read_b64_tr_b16 v[58:59], v5 offset:2048
  s_waitcnt lgkmcnt(8)
  v_mfma_f32_16x16x32_bf16 a[0:3], v[24:27], v[64:67], a[0:3]
  ds_read_b64_tr_b16 v[60:61], v5 offset:4096
  ds_read_b64_tr_b16 v[62:63], v5 offset:6144
  s_waitcnt lgkmcnt(8)
  v_mfma_f32_16x16x32_bf16 a[0:3], v[28:31], v[80:83], a[0:3]
  v_mfma_f32_16x16x32_bf16 a[64:67], v[24:27], v[68:71], a[64:67]
  v_mfma_f32_16x16x32_bf16 a[64:67], v[28:31], v[84:87], a[64:67]
  v_mfma_f32_16x16x32_bf16 a[128:131], v[24:27], v[72:75], a[128:131]
  v_mfma_f32_16x16x32_bf16 a[128:131], v[28:31], v[88:91], a[128:131]
  v_mfma_f32_16x16x32_bf16 a[192:195], v[24:27], v[76:79], a[192:195]
  v_mfma_f32_16x16x32_bf16 a[192:195], v[28:31], v[92:95], a[192:195]
  v_mfma_f32_16x16x32_bf16 v[96:99], v[24:27], v[16:19], v[96:99]
  v_mfma_f32_16x16x32_bf16 v[96:99], v[28:31], v[20:23], v[96:99]
  ds_read_b64_tr_b16 v[32:33], v6 offset:0
  ds_read_b64_tr_b16 v[34:35], v6 offset:2048
  s_waitcnt lgkmcnt(8)
  v_mfma_f32_16x16x32_bf16 a[4:7], v[48:51], v[64:67], a[4:7]
  ds_read_b64_tr_b16 v[36:37], v6 offset:4096
  ds_read_b64_tr_b16 v[38:39], v6 offset:6144
  s_waitcnt lgkmcnt(8)
  v_mfma_f32_16x16x32_bf16 a[4:7], v[52:55], v[80:83], a[4:7]
  v_mfma_f32_16x16x32_bf16 a[68:71], v[48:51], v[68:71], a[68:71]
  v_mfma_f32_16x16x32_bf16 a[68:71], v[52:55], v[84:87], a[68:71]
  v_mfma_f32_16x16x32_bf16 a[132:135], v[48:51], v[72:75], a[132:135]
  v_mfma_f32_16x16x32_bf16 a[132:135], v[52:55], v[88:91], a[132:135]
  v_mfma_f32_16x16x32_bf16 a[196:199], v[48:51], v[76:79], a[196:199]
  v_mfma_f32_16x16x32_bf16 a[196:199], v[52:55], v[92:95], a[196:199]
  v_mfma_f32_16x16x32_bf16 v[100:103], v[48:51], v[16:19], v[100:103]
  v_mfma_f32_16x16x32_bf16 v[100:103], v[52:55], v[20:23], v[100:103]
  ds_read_b64_tr_b16 v[40:41], v3 offset:8192
  ds_read_b64_tr_b16 v[42:43], v3 offset:10240
  s_waitcnt lgkmcnt(8)
  v_mfma_f32_16x16x32_bf16 a[8:11], v[56:59], v[64:67], a[8:11]
  ds_read_b64_tr_b16 v[44:45], v3 offset:12288
  ds_read_b64_tr_b16 v[46:47], v3 offset:14336
  s_waitcnt lgkmcnt(8)
  v_mfma_f32_16x16x32_bf16 a[8:11], v[60:63], v[80:83], a[8:11]
  v_mfma_f32_16x16x32_bf16 a[72:75], v[56:59], v[68:71], a[72:75]
  v_mfma_f32_16x16x32_bf16 a[72:75], v[60:63], v[84:87], a[72:75]
  v_mfma_f32_16x16x32_bf16 a[136:139], v[56:59], v[72:75], a[136:139]
  v_mfma_f32_16x16x32_bf16 a[136:139], v[60:63], v[88:91], a[136:139]
  v_mfma_f32_16x16x32_bf16 a[200:203], v[56:59], v[76:79], a[200:203]
  v_mfma_f32_16x16x32_bf16 a[200:203], v[60:63], v[92:95], a[200:203]
  v_mfma_f32_16x16x32_bf16 v[104:107], v[56:59], v[16:19], v[104:107]
  v_mfma_f32_16x16x32_bf16 v[104:107], v[60:63], v[20:23], v[104:107]
  ds_read_b64_tr_b16 v[48:49], v4 offset:8192
  ds_read_b64_tr_b16 v[50:51], v4 offset:10240
  s_waitcnt lgkmcnt(8)
  v_mfma_f32_16x16x32_bf16 a[12:15], v[32:35], v[64:67], a[12:15]
  s_waitcnt vmcnt(8)
  s_barrier
  ds_read_b64_tr_b16 v[52:53], v4 offset:12288
  s_waitcnt lgkmcnt(7)
  v_mfma_f32_16x16x32_bf16 a[12:15], v[36:39], v[80:83], a[12:15]
  s_add_u32 m0, s32, 0
  s_add_u32 s34, s30, 0
  buffer_load_dwordx4 v7, s[8:11], s34 offen nt lds
  v_mfma_f32_16x16x32_bf16 a[76:79], v[32:35], v[68:71], a[76:79]
  ds_read_b64_tr_b16 v[54:55], v4 offset:14336
  v_mfma_f32_16x16x32_bf16 a[76:79], v[36:39], v[84:87], a[76:79]
  v_mfma_f32_16x16x32_bf16 a[140:143], v[32:35], v[72:75], a[140:143]
  v_mfma_f32_16x16x32_bf16 a[140:143], v[36:39], v[88:91], a[140:143]
  v_mfma_f32_16x16x32_bf16 a[204:207], v[32:35], v[76:79], a[204:207]
  v_mfma_f32_16x16x32_bf16 a[204:207], v[36:39], v[92:95], a[204:207]
  s_add_u32 m0, s32, 1024
  s_add_u32 s34, s30, 4096
  buffer_load_dwordx4 v7, s[8:11], s34 offen nt lds
  v_mfma_f32_16x16x32_bf16 v[108:111], v[32:35], v[16:19], v[108:111]
  v_mfma_f32_16x16x32_bf16 v[108:111], v[36:39], v[20:23], v[108:111]
  ds_read_b64_tr_b16 v[56:57], v5 offset:8192
  ds_read_b64_tr_b16 v[58:59], v5 offset:10240
  s_waitcnt lgkmcnt(8)
  v_mfma_f32_16x16x32_bf16 a[16:19], v[40:43], v[64:67], a[16:19]
  ds_read_b64_tr_b16 v[60:61], v5 offset:12288
  ds_read_b64_tr_b16 v[62:63], v5 offset:14336
  s_waitcnt lgkmcnt(8)
  v_mfma_f32_16x16x32_bf16 a[16:19], v[44:47], v[80:83], a[16:19]
  ds_read_b128 v[32:35], v1 offset:0
  ds_read_b128 v[36:39], v2 offset:0
  v_mfma_f32_16x16x32_bf16 a[80:83], v[40:43], v[68:71], a[80:83]
  v_mfma_f32_16x16x32_bf16 a[80:83], v[44:47], v[84:87], a[80:83]
  s_add_u32 m0, s32, 2048
  s_add_u32 s34, s30, 8192
  buffer_load_dwordx4 v7, s[8:11], s34 offen nt lds
  v_mfma_f32_16x16x32_bf16 a[144:147], v[40:43], v[72:75], a[144:147]
  v_mfma_f32_16x16x32_bf16 a[144:147], v[44:47], v[88:91], a[144:147]
  v_mfma_f32_16x16x32_bf16 a[208:211], v[40:43], v[76:79], a[208:211]
  v_mfma_f32_16x16x32_bf16 a[208:211], v[44:47], v[92:95], a[208:211]
  v_mfma_f32_16x16x32_bf16 v[112:115], v[40:43], v[16:19], v[112:115]
  v_mfma_f32_16x16x32_bf16 v[112:115], v[44:47], v[20:23], v[112:115]
  s_add_u32 m0, s32, 3072
  s_add_u32 s34, s30, 12288
  buffer_load_dwordx4 v7, s[8:11], s34 offen nt lds
  s_waitcnt lgkmcnt(8)
  v_mfma_f32_16x16x32_bf16 a[20:23], v[48:51], v[64:67], a[20:23]
  ds_read_b64_tr_b16 v[24:25], v6 offset:8192
  ds_read_b64_tr_b16 v[26:27], v6 offset:10240
  s_waitcnt lgkmcnt(8)
  v_mfma_f32_16x16x32_bf16 a[20:23], v[52:55], v[80:83], a[20:23]
  ds_read_b64_tr_b16 v[28:29], v6 offset:12288
  ds_read_b64_tr_b16 v[30:31], v6 offset:14336
  v_mfma_f32_16x16x32_bf16 a[84:87], v[48:51], v[68:71], a[84:87]
  ds_read_b128 v[40:43], v1 offset:8192
  ds_read_b128 v[44:47], v2 offset:8192
  v_mfma_f32_16x16x32_bf16 a[84:87], v[52:55], v[84:87], a[84:87]
  v_mfma_f32_16x16x32_bf16 a[148:151], v[48:51], v[72:75], a[148:151]
  v_mfma_f32_16x16x32_bf16 a[148:151], v[52:55], v[88:91], a[148:151]
  s_add_u32 m0, s32, 4096
  s_add_u32 s34, s30, 16384
  buffer_load_dwordx4 v7, s[8:11], s34 offen nt lds
  v_mfma_f32_16x16x32_bf16 a[212:215], v[48:51], v[76:79], a[212:215]
  v_mfma_f32_16x16x32_bf16 a[212:215], v[52:55], v[92:95], a[212:215]
  v_mfma_f32_16x16x32_bf16 v[116:119], v[48:51], v[16:19], v[116:119]
  v_mfma_f32_16x16x32_bf16 v[116:119], v[52:55], v[20:23], v[116:119]
  ds_read_b128 v[48:51], v1 offset:16384
  ds_read_b128 v[52:55], v2 offset:16384
  s_waitcnt lgkmcnt(12)
  v_mfma_f32_16x16x32_bf16 a[24:27], v[56:59], v[64:67], a[24:27]
  s_waitcnt lgkmcnt(10)
  v_mfma_f32_16x16x32_bf16 a[24:27], v[60:63], v[80:83], a[24:27]
  s_add_u32 m0, s32, 5120
  s_add_u32 s34, s30, 20480
  buffer_load_dwordx4 v7, s[8:11], s34 offen nt lds
  v_mfma_f32_16x16x32_bf16 a[88:91], v[56:59], v[68:71], a[88:91]
  v_mfma_f32_16x16x32_bf16 a[88:91], v[60:63], v[84:87], a[88:91]
  v_mfma_f32_16x16x32_bf16 a[152:155], v[56:59], v[72:75], a[152:155]
  v_mfma_f32_16x16x32_bf16 a[152:155], v[60:63], v[88:91], a[152:155]
  v_mfma_f32_16x16x32_bf16 a[216:219], v[56:59], v[76:79], a[216:219]
  v_mfma_f32_16x16x32_bf16 a[216:219], v[60:63], v[92:95], a[216:219]
  s_add_u32 m0, s32, 6144
  s_add_u32 s34, s30, 24576
  buffer_load_dwordx4 v7, s[8:11], s34 offen nt lds
  v_mfma_f32_16x16x32_bf16 v[120:123], v[56:59], v[16:19], v[120:123]
  v_mfma_f32_16x16x32_bf16 v[120:123], v[60:63], v[20:23], v[120:123]
  ds_read_b128 v[56:59], v1 offset:24576
  ds_read_b128 v[60:63], v2 offset:24576
  s_waitcnt lgkmcnt(8)
  v_mfma_f32_16x16x32_bf16 a[28:31], v[24:27], v[64:67], a[28:31]
  s_waitcnt lgkmcnt(6)
  v_mfma_f32_16x16x32_bf16 a[28:31], v[28:31], v[80:83], a[28:31]
  v_mfma_f32_16x16x32_bf16 a[92:95], v[24:27], v[68:71], a[92:95]
  v_mfma_f32_16x16x32_bf16 a[92:95], v[28:31], v[84:87], a[92:95]
  s_add_u32 m0, s32, 7168
  s_add_u32 s34, s30, 28672
  buffer_load_dwordx4 v7, s[8:11], s34 offen nt lds
  s_add_u32 s30, s30, 32768
  s_xor_b32 s32, s32, 65536
  v_mfma_f32_16x16x32_bf16 a[156:159], v[24:27], v[72:75], a[156:159]
  v_mfma_f32_16x16x32_bf16 a[156:159], v[28:31], v[88:91], a[156:159]
  v_mfma_f32_16x16x32_bf16 a[220:223], v[24:27], v[76:79], a[220:223]
  v_mfma_f32_16x16x32_bf16 a[220:223], v[28:31], v[92:95], a[220:223]
  v_mfma_f32_16x16x32_bf16 v[124:127], v[24:27], v[16:19], v[124:127]
  v_mfma_f32_16x16x32_bf16 v[124:127], v[28:31], v[20:23], v[124:127]
  s_sub_u32 s29, s29, 1
  s_cmp_lg_u32 s29, 0
  s_cbranch_scc1 K1_LOOP_P0
  v_mfma_f32_16x16x32_bf16 v[16:19], v[32:35], v[128:131], 0
  ds_read_b128 v[80:83], v9 offset:0
  ds_read_b128 v[84:87], v9 offset:1024
  v_mfma_f32_16x16x32_bf16 v[16:19], v[36:39], v[132:135], v[16:19]
  ds_read_b128 v[88:91], v9 offset:2048
  ds_read_b128 v[92:95], v9 offset:3072
  s_waitcnt lgkmcnt(9)
  v_mfma_f32_16x16x32_bf16 v[16:19], v[40:43], v[136:139], v[16:19]
  v_xor_b32 v3, 65536, v3
  v_xor_b32 v4, 65536, v4
  s_waitcnt lgkmcnt(8)
  v_mfma_f32_16x16x32_bf16 v[16:19], v[44:47], v[140:143], v[16:19]
  v_xor_b32 v5, 65536, v5
  v_xor_b32 v6, 65536, v6
  s_waitcnt lgkmcnt(7)
  v_mfma_f32_16x16x32_bf16 v[16:19], v[48:51], v[144:147], v[16:19]
  s_waitcnt lgkmcnt(6)
  v_mfma_f32_16x16x32_bf16 v[16:19], v[52:55], v[148:151], v[16:19]
  s_waitcnt lgkmcnt(5)
  v_mfma_f32_16x16x32_bf16 v[16:19], v[56:59], v[152:155], v[16:19]
  s_waitcnt lgkmcnt(4)
  v_mfma_f32_16x16x32_bf16 v[16:19], v[60:63], v[156:159], v[16:19]
  v_mfma_f32_16x16x32_bf16 v[20:23], v[32:35], v[160:163], 0
  ds_read_b128 v[24:27], v1 offset:2048
  v_mfma_f32_16x16x32_bf16 v[20:23], v[36:39], v[164:167], v[20:23]
  ds_read_b128 v[28:31], v2 offset:2048
  v_mfma_f32_16x16x32_bf16 v[20:23], v[40:43], v[168:171], v[20:23]
  s_nop 2
  v_exp_f32 v16, v16
  v_mfma_f32_16x16x32_bf16 v[20:23], v[44:47], v[172:175], v[20:23]
  v_exp_f32 v17, v17
  v_mfma_f32_16x16x32_bf16 v[20:23], v[48:51], v[176:179], v[20:23]
  v_exp_f32 v18, v18
  v_mfma_f32_16x16x32_bf16 v[20:23], v[52:55], v[180:183], v[20:23]
  v_exp_f32 v19, v19
  v_mfma_f32_16x16x32_bf16 v[20:23], v[56:59], v[184:187], v[20:23]
  v_add_f32 v10, v10, v16
  v_add_f32 v10, v10, v17
  v_mfma_f32_16x16x32_bf16 v[20:23], v[60:63], v[188:191], v[20:23]
  v_add_f32 v10, v10, v18
  v_add_f32 v10, v10, v19
  v_cvt_pk_bf16_f32 v64, v16, v17
  v_cvt_pk_bf16_f32 v65, v18, v19
  v_mfma_f32_16x16x32_bf16 v[16:19], v[32:35], v[192:195], 0
  v_mfma_f32_16x16x32_bf16 v[16:19], v[36:39], v[196:199], v[16:19]
  v_mfma_f32_16x16x32_bf16 v[16:19], v[40:43], v[200:203], v[16:19]
  s_nop 0
  v_exp_f32 v20, v20
  v_mfma_f32_16x16x32_bf16 v[16:19], v[44:47], v[204:207], v[16:19]
  v_exp_f32 v21, v21
  v_mfma_f32_16x16x32_bf16 v[16:19], v[48:51], v[208:211], v[16:19]
  v_exp_f32 v22, v22
  v_mfma_f32_16x16x32_bf16 v[16:19], v[52:55], v[212:215], v[16:19]
  v_exp_f32 v23, v23
  v_mfma_f32_16x16x32_bf16 v[16:19], v[56:59], v[216:219], v[16:19]
  v_add_f32 v11, v11, v20
  v_add_f32 v11, v11, v21
  v_mfma_f32_16x16x32_bf16 v[16:19], v[60:63], v[220:223], v[16:19]
  v_add_f32 v11, v11, v22
  v_add_f32 v11, v11, v23
  v_cvt_pk_bf16_f32 v68, v20, v21
  v_cvt_pk_bf16_f32 v69, v22, v23
  v_mfma_f32_16x16x32_bf16 v[20:23], v[32:35], v[224:227], 0
  v_mfma_f32_16x16x32_bf16 v[20:23], v[36:39], v[228:231], v[20:23]
  v_mfma_f32_16x16x32_bf16 v[20:23], v[40:43], v[232:235], v[20:23]
  s_nop 0
  v_exp_f32 v16, v16
  v_mfma_f32_16x16x32_bf16 v[20:23], v[44:47], v[236:239], v[20:23]
  v_exp_f32 v17, v17
  v_mfma_f32_16x16x32_bf16 v[20:23], v[48:51], v[240:243], v[20:23]
  v_exp_f32 v18, v18
  v_mfma_f32_16x16x32_bf16 v[20:23], v[52:55], v[244:247], v[20:23]
  v_exp_f32 v19, v19
  v_mfma_f32_16x16x32_bf16 v[20:23], v[56:59], v[248:251], v[20:23]
  v_add_f32 v12, v12, v16
  v_add_f32 v12, v12, v17
  v_mfma_f32_16x16x32_bf16 v[20:23], v[60:63], v[252:255], v[20:23]
  v_add_f32 v12, v12, v18
  v_add_f32 v12, v12, v19
  v_cvt_pk_bf16_f32 v72, v16, v17
  v_cvt_pk_bf16_f32 v73, v18, v19
  s_waitcnt lgkmcnt(5)
  v_mfma_f32_16x16x32_bf16 v[16:19], v[32:35], v[80:83], 0
  ds_read_b128 v[80:83], v9 offset:4096
  ds_read_b128 v[32:35], v1 offset:10240
  s_waitcnt lgkmcnt(6)
  v_mfma_f32_16x16x32_bf16 v[16:19], v[36:39], v[84:87], v[16:19]
  ds_read_b128 v[84:87], v9 offset:5120
  ds_read_b128 v[36:39], v2 offset:10240
  s_waitcnt lgkmcnt(7)
  v_mfma_f32_16x16x32_bf16 v[16:19], v[40:43], v[88:91], v[16:19]
  ds_read_b128 v[88:91], v9 offset:6144
  ds_read_b128 v[40:43], v1 offset:18432
  s_waitcnt lgkmcnt(8)
  v_mfma_f32_16x16x32_bf16 v[16:19], v[44:47], v[92:95], v[16:19]
  ds_read_b128 v[92:95], v9 offset:7168
  ds_read_b128 v[44:47], v2 offset:18432
  s_waitcnt lgkmcnt(7)
  v_mfma_f32_16x16x32_bf16 v[16:19], v[48:51], v[80:83], v[16:19]
  ds_read_b128 v[48:51], v1 offset:26624
  s_waitcnt lgkmcnt(6)
  v_mfma_f32_16x16x32_bf16 v[16:19], v[52:55], v[84:87], v[16:19]
  ds_read_b128 v[52:55], v2 offset:26624
  s_waitcnt lgkmcnt(5)
  v_mfma_f32_16x16x32_bf16 v[16:19], v[56:59], v[88:91], v[16:19]
  v_exp_f32 v20, v20
  s_waitcnt lgkmcnt(3)
  v_mfma_f32_16x16x32_bf16 v[16:19], v[60:63], v[92:95], v[16:19]
  v_exp_f32 v21, v21
  v_exp_f32 v22, v22
  v_exp_f32 v23, v23
  v_add_f32 v13, v13, v20
  v_add_f32 v13, v13, v21
  v_add_f32 v13, v13, v22
  v_add_f32 v13, v13, v23
  v_cvt_pk_bf16_f32 v76, v20, v21
  v_cvt_pk_bf16_f32 v77, v22, v23
  v_mfma_f32_16x16x32_bf16 v[20:23], v[24:27], v[128:131], 0
  ds_read_b128 v[80:83], v9 offset:0
  ds_read_b128 v[84:87], v9 offset:1024
  v_mfma_f32_16x16x32_bf16 v[20:23], v[28:31], v[132:135], v[20:23]
  ds_read_b128 v[88:91], v9 offset:2048
  ds_read_b128 v[92:95], v9 offset:3072
  v_mfma_f32_16x16x32_bf16 v[20:23], v[32:35], v[136:139], v[20:23]
  v_exp_f32 v16, v16
  v_mfma_f32_16x16x32_bf16 v[20:23], v[36:39], v[140:143], v[20:23]
  v_exp_f32 v17, v17
  v_mfma_f32_16x16x32_bf16 v[20:23], v[40:43], v[144:147], v[20:23]
  v_exp_f32 v18, v18
  s_waitcnt lgkmcnt(6)
  v_mfma_f32_16x16x32_bf16 v[20:23], v[44:47], v[148:151], v[20:23]
  v_exp_f32 v19, v19
  s_waitcnt lgkmcnt(5)
  v_mfma_f32_16x16x32_bf16 v[20:23], v[48:51], v[152:155], v[20:23]
  v_add_f32 v14, v14, v16
  v_add_f32 v14, v14, v17
  s_waitcnt lgkmcnt(4)
  v_mfma_f32_16x16x32_bf16 v[20:23], v[52:55], v[156:159], v[20:23]
  v_add_f32 v14, v14, v18
  v_add_f32 v14, v14, v19
  v_cvt_pk_bf16_f32 v16, v16, v17
  v_cvt_pk_bf16_f32 v17, v18, v19
  ds_write_b64 v9, v[16:17] offset:8192
  v_mfma_f32_16x16x32_bf16 v[16:19], v[24:27], v[160:163], 0
  ds_read_b128 v[56:59], v1 offset:4096
  v_mfma_f32_16x16x32_bf16 v[16:19], v[28:31], v[164:167], v[16:19]
  ds_read_b128 v[60:63], v2 offset:4096
  v_mfma_f32_16x16x32_bf16 v[16:19], v[32:35], v[168:171], v[16:19]
  v_exp_f32 v20, v20
  v_mfma_f32_16x16x32_bf16 v[16:19], v[36:39], v[172:175], v[16:19]
  v_exp_f32 v21, v21
  v_mfma_f32_16x16x32_bf16 v[16:19], v[40:43], v[176:179], v[16:19]
  v_exp_f32 v22, v22
  v_mfma_f32_16x16x32_bf16 v[16:19], v[44:47], v[180:183], v[16:19]
  v_exp_f32 v23, v23
  v_mfma_f32_16x16x32_bf16 v[16:19], v[48:51], v[184:187], v[16:19]
  v_add_f32 v10, v10, v20
  v_add_f32 v10, v10, v21
  v_mfma_f32_16x16x32_bf16 v[16:19], v[52:55], v[188:191], v[16:19]
  v_add_f32 v10, v10, v22
  v_add_f32 v10, v10, v23
  v_cvt_pk_bf16_f32 v66, v20, v21
  v_cvt_pk_bf16_f32 v67, v22, v23
  v_mfma_f32_16x16x32_bf16 v[20:23], v[24:27], v[192:195], 0
  v_mfma_f32_16x16x32_bf16 v[20:23], v[28:31], v[196:199], v[20:23]
  v_mfma_f32_16x16x32_bf16 v[20:23], v[32:35], v[200:203], v[20:23]
  s_nop 0
  v_exp_f32 v16, v16
  v_mfma_f32_16x16x32_bf16 v[20:23], v[36:39], v[204:207], v[20:23]
  v_exp_f32 v17, v17
  v_mfma_f32_16x16x32_bf16 v[20:23], v[40:43], v[208:211], v[20:23]
  v_exp_f32 v18, v18
  v_mfma_f32_16x16x32_bf16 v[20:23], v[44:47], v[212:215], v[20:23]
  v_exp_f32 v19, v19
  v_mfma_f32_16x16x32_bf16 v[20:23], v[48:51], v[216:219], v[20:23]
  v_add_f32 v11, v11, v16
  v_add_f32 v11, v11, v17
  v_mfma_f32_16x16x32_bf16 v[20:23], v[52:55], v[220:223], v[20:23]
  v_add_f32 v11, v11, v18
  v_add_f32 v11, v11, v19
  v_cvt_pk_bf16_f32 v70, v16, v17
  v_cvt_pk_bf16_f32 v71, v18, v19
  v_mfma_f32_16x16x32_bf16 v[16:19], v[24:27], v[224:227], 0
  v_mfma_f32_16x16x32_bf16 v[16:19], v[28:31], v[228:231], v[16:19]
  v_mfma_f32_16x16x32_bf16 v[16:19], v[32:35], v[232:235], v[16:19]
  s_nop 0
  v_exp_f32 v20, v20
  v_mfma_f32_16x16x32_bf16 v[16:19], v[36:39], v[236:239], v[16:19]
  v_exp_f32 v21, v21
  v_mfma_f32_16x16x32_bf16 v[16:19], v[40:43], v[240:243], v[16:19]
  v_exp_f32 v22, v22
  v_mfma_f32_16x16x32_bf16 v[16:19], v[44:47], v[244:247], v[16:19]
  v_exp_f32 v23, v23
  v_mfma_f32_16x16x32_bf16 v[16:19], v[48:51], v[248:251], v[16:19]
  v_add_f32 v12, v12, v20
  v_add_f32 v12, v12, v21
  v_mfma_f32_16x16x32_bf16 v[16:19], v[52:55], v[252:255], v[16:19]
  v_add_f32 v12, v12, v22
  v_add_f32 v12, v12, v23
  v_cvt_pk_bf16_f32 v74, v20, v21
  v_cvt_pk_bf16_f32 v75, v22, v23
  s_waitcnt lgkmcnt(6)
  v_mfma_f32_16x16x32_bf16 v[20:23], v[24:27], v[80:83], 0
  ds_read_b128 v[80:83], v9 offset:4096
  ds_read_b128 v[24:27], v1 offset:12288
  s_waitcnt lgkmcnt(7)
  v_mfma_f32_16x16x32_bf16 v[20:23], v[28:31], v[84:87], v[20:23]
  ds_read_b128 v[84:87], v9 offset:5120
  ds_read_b128 v[28:31], v2 offset:12288
  s_waitcnt lgkmcnt(8)
  v_mfma_f32_16x16x32_bf16 v[20:23], v[32:35], v[88:91], v[20:23]
  ds_read_b128 v[88:91], v9 offset:6144
  ds_read_b128 v[32:35], v1 offset:20480
  s_waitcnt lgkmcnt(9)
  v_mfma_f32_16x16x32_bf16 v[20:23], v[36:39], v[92:95], v[20:23]
  ds_read_b128 v[92:95], v9 offset:7168
  ds_read_b128 v[36:39], v2 offset:20480
  s_waitcnt lgkmcnt(7)
  v_mfma_f32_16x16x32_bf16 v[20:23], v[40:43], v[80:83], v[20:23]
  ds_read_b128 v[40:43], v1 offset:28672
  s_waitcnt lgkmcnt(6)
  v_mfma_f32_16x16x32_bf16 v[20:23], v[44:47], v[84:87], v[20:23]
  ds_read_b128 v[44:47], v2 offset:28672
  s_waitcnt lgkmcnt(5)
  v_mfma_f32_16x16x32_bf16 v[20:23], v[48:51], v[88:91], v[20:23]
  v_exp_f32 v16, v16
  s_waitcnt lgkmcnt(3)
  v_mfma_f32_16x16x32_bf16 v[20:23], v[52:55], v[92:95], v[20:23]
  v_exp_f32 v17, v17
  v_exp_f32 v18, v18
  v_exp_f32 v19, v19
  v_add_f32 v13, v13, v16
  v_add_f32 v13, v13, v17
  v_add_f32 v13, v13, v18
  v_add_f32 v13, v13, v19
  v_cvt_pk_bf16_f32 v78, v16, v17
  v_cvt_pk_bf16_f32 v79, v18, v19
  v_mfma_f32_16x16x32_bf16 v[16:19], v[56:59], v[128:131], 0
  v_mfma_f32_16x16x32_bf16 v[16:19], v[60:63], v[132:135], v[16:19]
  v_mfma_f32_16x16x32_bf16 v[16:19], v[24:27], v[136:139], v[16:19]
  v_exp_f32 v20, v20
  v_mfma_f32_16x16x32_bf16 v[16:19], v[28:31], v[140:143], v[16:19]
  v_exp_f32 v21, v21
  v_mfma_f32_16x16x32_bf16 v[16:19], v[32:35], v[144:147], v[16:19]
  v_exp_f32 v22, v22
  s_waitcnt lgkmcnt(2)
  v_mfma_f32_16x16x32_bf16 v[16:19], v[36:39], v[148:151], v[16:19]
  v_exp_f32 v23, v23
  s_waitcnt lgkmcnt(1)
  v_mfma_f32_16x16x32_bf16 v[16:19], v[40:43], v[152:155], v[16:19]
  v_add_f32 v14, v14, v20
  v_add_f32 v14, v14, v21
  s_waitcnt lgkmcnt(0)
  v_mfma_f32_16x16x32_bf16 v[16:19], v[44:47], v[156:159], v[16:19]
  v_add_f32 v14, v14, v22
  v_add_f32 v14, v14, v23
  v_cvt_pk_bf16_f32 v20, v20, v21
  v_cvt_pk_bf16_f32 v21, v22, v23
  ds_write_b64 v9, v[20:21] offset:8200
  v_mfma_f32_16x16x32_bf16 v[20:23], v[56:59], v[160:163], 0
  ds_read_b128 v[48:51], v1 offset:6144
  v_mfma_f32_16x16x32_bf16 v[20:23], v[60:63], v[164:167], v[20:23]
  ds_read_b128 v[52:55], v2 offset:6144
  v_mfma_f32_16x16x32_bf16 v[20:23], v[24:27], v[168:171], v[20:23]
  v_exp_f32 v16, v16
  v_mfma_f32_16x16x32_bf16 v[20:23], v[28:31], v[172:175], v[20:23]
  v_exp_f32 v17, v17
  v_mfma_f32_16x16x32_bf16 v[20:23], v[32:35], v[176:179], v[20:23]
  v_exp_f32 v18, v18
  v_mfma_f32_16x16x32_bf16 v[20:23], v[36:39], v[180:183], v[20:23]
  v_exp_f32 v19, v19
  v_mfma_f32_16x16x32_bf16 v[20:23], v[40:43], v[184:187], v[20:23]
  v_add_f32 v10, v10, v16
  v_add_f32 v10, v10, v17
  v_mfma_f32_16x16x32_bf16 v[20:23], v[44:47], v[188:191], v[20:23]
  v_add_f32 v10, v10, v18
  v_add_f32 v10, v10, v19
  v_cvt_pk_bf16_f32 v80, v16, v17
  v_cvt_pk_bf16_f32 v81, v18, v19
  v_mfma_f32_16x16x32_bf16 v[16:19], v[56:59], v[192:195], 0
  s_waitcnt vmcnt(8)
  s_waitcnt lgkmcnt(2)
  s_barrier
  v_mfma_f32_16x16x32_bf16 v[16:19], v[60:63], v[196:199], v[16:19]
  v_mfma_f32_16x16x32_bf16 v[16:19], v[24:27], v[200:203], v[16:19]
  v_exp_f32 v20, v20
  v_mfma_f32_16x16x32_bf16 v[16:19], v[28:31], v[204:207], v[16:19]
  v_exp_f32 v21, v21
  v_mfma_f32_16x16x32_bf16 v[16:19], v[32:35], v[208:211], v[16:19]
  v_exp_f32 v22, v22
  v_mfma_f32_16x16x32_bf16 v[16:19], v[36:39], v[212:215], v[16:19]
  v_exp_f32 v23, v23
  v_mfma_f32_16x16x32_bf16 v[16:19], v[40:43], v[216:219], v[16:19]
  v_add_f32 v11, v11, v20
  v_add_f32 v11, v11, v21
  v_mfma_f32_16x16x32_bf16 v[16:19], v[44:47], v[220:223], v[16:19]
  v_add_f32 v11, v11, v22
  v_add_f32 v11, v11, v23
  v_cvt_pk_bf16_f32 v84, v20, v21
  v_cvt_pk_bf16_f32 v85, v22, v23
  v_mfma_f32_16x16x32_bf16 v[20:23], v[56:59], v[224:227], 0
  ds_read_b128 v[56:59], v1 offset:14336
  v_mfma_f32_16x16x32_bf16 v[20:23], v[60:63], v[228:231], v[20:23]
  ds_read_b128 v[60:63], v2 offset:14336
  v_mfma_f32_16x16x32_bf16 v[20:23], v[24:27], v[232:235], v[20:23]
  ds_read_b128 v[24:27], v1 offset:22528
  v_mfma_f32_16x16x32_bf16 v[20:23], v[28:31], v[236:239], v[20:23]
  ds_read_b128 v[28:31], v2 offset:22528
  v_mfma_f32_16x16x32_bf16 v[20:23], v[32:35], v[240:243], v[20:23]
  ds_read_b128 v[32:35], v1 offset:30720
  v_mfma_f32_16x16x32_bf16 v[20:23], v[36:39], v[244:247], v[20:23]
  ds_read_b128 v[36:39], v2 offset:30720
  v_mfma_f32_16x16x32_bf16 v[20:23], v[40:43], v[248:251], v[20:23]
  v_exp_f32 v16, v16
  v_mfma_f32_16x16x32_bf16 v[20:23], v[44:47], v[252:255], v[20:23]
  v_exp_f32 v17, v17
  v_exp_f32 v18, v18
  v_exp_f32 v19, v19
  v_add_f32 v12, v12, v16
  v_add_f32 v12, v12, v17
  v_add_f32 v12, v12, v18
  v_add_f32 v12, v12, v19
  v_cvt_pk_bf16_f32 v88, v16, v17
  v_cvt_pk_bf16_f32 v89, v18, v19
  s_waitcnt lgkmcnt(7)
  v_mfma_f32_16x16x32_bf16 v[16:19], v[48:51], v[128:131], 0
  s_waitcnt lgkmcnt(6)
  v_mfma_f32_16x16x32_bf16 v[16:19], v[52:55], v[132:135], v[16:19]
  s_waitcnt lgkmcnt(5)
  v_mfma_f32_16x16x32_bf16 v[16:19], v[56:59], v[136:139], v[16:19]
  v_exp_f32 v20, v20
  s_waitcnt lgkmcnt(4)
  v_mfma_f32_16x16x32_bf16 v[16:19], v[60:63], v[140:143], v[16:19]
  v_exp_f32 v21, v21
  s_waitcnt lgkmcnt(3)
  v_mfma_f32_16x16x32_bf16 v[16:19], v[24:27], v[144:147], v[16:19]
  v_exp_f32 v22, v22
  s_waitcnt lgkmcnt(2)
  v_mfma_f32_16x16x32_bf16 v[16:19], v[28:31], v[148:151], v[16:19]
  v_exp_f32 v23, v23
  s_waitcnt lgkmcnt(1)
  v_mfma_f32_16x16x32_bf16 v[16:19], v[32:35], v[152:155], v[16:19]
  v_add_f32 v13, v13, v20
  v_add_f32 v13, v13, v21
  s_waitcnt lgkmcnt(0)
  v_mfma_f32_16x16x32_bf16 v[16:19], v[36:39], v[156:159], v[16:19]
  v_add_f32 v13, v13, v22
  v_add_f32 v13, v13, v23
  v_cvt_pk_bf16_f32 v92, v20, v21
  v_cvt_pk_bf16_f32 v93, v22, v23
  v_mfma_f32_16x16x32_bf16 v[20:23], v[48:51], v[160:163], 0
  ds_read_b64_tr_b16 v[40:41], v3 offset:16384
  ds_read_b64_tr_b16 v[42:43], v3 offset:18432
  v_mfma_f32_16x16x32_bf16 v[20:23], v[52:55], v[164:167], v[20:23]
  ds_read_b64_tr_b16 v[44:45], v3 offset:20480
  ds_read_b64_tr_b16 v[46:47], v3 offset:22528
  v_mfma_f32_16x16x32_bf16 v[20:23], v[56:59], v[168:171], v[20:23]
  v_exp_f32 v16, v16
  v_mfma_f32_16x16x32_bf16 v[20:23], v[60:63], v[172:175], v[20:23]
  v_exp_f32 v17, v17
  v_mfma_f32_16x16x32_bf16 v[20:23], v[24:27], v[176:179], v[20:23]
  v_exp_f32 v18, v18
  v_mfma_f32_16x16x32_bf16 v[20:23], v[28:31], v[180:183], v[20:23]
  v_exp_f32 v19, v19
  v_mfma_f32_16x16x32_bf16 v[20:23], v[32:35], v[184:187], v[20:23]
  v_add_f32 v10, v10, v16
  v_add_f32 v10, v10, v17
  v_mfma_f32_16x16x32_bf16 v[20:23], v[36:39], v[188:191], v[20:23]
  v_add_f32 v10, v10, v18
  v_add_f32 v10, v10, v19
  v_cvt_pk_bf16_f32 v82, v16, v17
  v_cvt_pk_bf16_f32 v83, v18, v19
  v_mfma_f32_16x16x32_bf16 v[16:19], v[48:51], v[192:195], 0
  v_mfma_f32_16x16x32_bf16 v[16:19], v[52:55], v[196:199], v[16:19]
  v_mfma_f32_16x16x32_bf16 v[16:19], v[56:59], v[200:203], v[16:19]
  s_nop 0
  v_exp_f32 v20, v20
  v_mfma_f32_16x16x32_bf16 v[16:19], v[60:63], v[204:207], v[16:19]
  v_exp_f32 v21, v21
  v_mfma_f32_16x16x32_bf16 v[16:19], v[24:27], v[208:211], v[16:19]
  v_exp_f32 v22, v22
  v_mfma_f32_16x16x32_bf16 v[16:19], v[28:31], v[212:215], v[16:19]
  v_exp_f32 v23, v23
  v_mfma_f32_16x16x32_bf16 v[16:19], v[32:35], v[216:219], v[16:19]
  v_add_f32 v11, v11, v20
  v_add_f32 v11, v11, v21
  v_mfma_f32_16x16x32_bf16 v[16:19], v[36:39], v[220:223], v[16:19]
  v_add_f32 v11, v11, v22
  v_add_f32 v11, v11, v23
  v_cvt_pk_bf16_f32 v86, v20, v21
  v_cvt_pk_bf16_f32 v87, v22, v23
  v_mfma_f32_16x16x32_bf16 v[20:23], v[48:51], v[224:227], 0
  ds_read_b64_tr_b16 v[48:49], v4 offset:16384
  ds_read_b64_tr_b16 v[50:51], v4 offset:18432
  v_mfma_f32_16x16x32_bf16 v[20:23], v[52:55], v[228:231], v[20:23]
  ds_read_b64_tr_b16 v[52:53], v4 offset:20480
  ds_read_b64_tr_b16 v[54:55], v4 offset:22528
  v_mfma_f32_16x16x32_bf16 v[20:23], v[56:59], v[232:235], v[20:23]
  v_exp_f32 v16, v16
  v_mfma_f32_16x16x32_bf16 v[20:23], v[60:63], v[236:239], v[20:23]
  v_exp_f32 v17, v17
  v_mfma_f32_16x16x32_bf16 v[20:23], v[24:27], v[240:243], v[20:23]
  v_exp_f32 v18, v18
  v_mfma_f32_16x16x32_bf16 v[20:23], v[28:31], v[244:247], v[20:23]
  v_exp_f32 v19, v19
  v_mfma_f32_16x16x32_bf16 v[20:23], v[32:35], v[248:251], v[20:23]
  v_add_f32 v12, v12, v16
  v_add_f32 v12, v12, v17
  v_mfma_f32_16x16x32_bf16 v[20:23], v[36:39], v[252:255], v[20:23]
  v_add_f32 v12, v12, v18
  v_add_f32 v12, v12, v19
  v_cvt_pk_bf16_f32 v90, v16, v17
  v_cvt_pk_bf16_f32 v91, v18, v19
  ds_read_b64_tr_b16 v[56:57], v5 offset:16384
  ds_read_b64_tr_b16 v[58:59], v5 offset:18432
  ds_read_b64_tr_b16 v[60:61], v5 offset:20480
  ds_read_b64_tr_b16 v[62:63], v5 offset:22528
  s_waitcnt lgkmcnt(10)
  v_mfma_f32_16x16x32_bf16 a[32:35], v[40:43], v[64:67], a[32:35]
  v_mbcnt_lo_u32_b32 v129, -1, 0
  v_mbcnt_hi_u32_b32 v129, -1, v129
  v_and_b32 v130, 15, v129
  v_bfe_u32 v131, v129, 4, 1
  v_lshl_add_u32 v130, v131, 5, v130
  v_bfe_u32 v131, v129, 5, 1
  s_waitcnt lgkmcnt(8)
  v_mfma_f32_16x16x32_bf16 a[32:35], v[44:47], v[80:83], a[32:35]
  v_exp_f32 v20, v20
  v_exp_f32 v21, v21
  v_exp_f32 v22, v22
  v_mfma_f32_16x16x32_bf16 a[96:99], v[40:43], v[68:71], a[96:99]
  v_exp_f32 v23, v23
  v_add_f32 v13, v13, v20
  v_add_f32 v13, v13, v21
  v_add_f32 v13, v13, v22
  v_add_f32 v13, v13, v23
  v_mfma_f32_16x16x32_bf16 a[96:99], v[44:47], v[84:87], a[96:99]
  v_cvt_pk_bf16_f32 v94, v20, v21
  v_cvt_pk_bf16_f32 v95, v22, v23
  v_lshl_add_u32 v130, v131, 4, v130
  v_lshlrev_b32 v128, 4, v130
  v_mov_b32 v132, 0
  v_mov_b32 v133, 0
  v_mfma_f32_16x16x32_bf16 a[160:163], v[40:43], v[72:75], a[160:163]
  v_mov_b32 v134, 0
  v_mov_b32 v135, 0
  v_mov_b32 v136, 0
  v_mov_b32 v137, 0
  v_mov_b32 v138, 0
  v_mov_b32 v139, 0
  v_mfma_f32_16x16x32_bf16 a[160:163], v[44:47], v[88:91], a[160:163]
  s_mov_b32 s3, 0x4e800000
  s_mov_b32 s4, 0x30800000
  v_mfma_f32_16x16x32_bf16 a[224:227], v[40:43], v[76:79], a[224:227]
  v_mfma_f32_16x16x32_bf16 a[224:227], v[44:47], v[92:95], a[224:227]
  ds_read_b64_tr_b16 v[24:25], v6 offset:16384
  ds_read_b64_tr_b16 v[26:27], v6 offset:18432
  ds_read_b64_tr_b16 v[28:29], v6 offset:20480
  ds_read_b64_tr_b16 v[30:31], v6 offset:22528
  s_waitcnt lgkmcnt(10)
  v_mfma_f32_16x16x32_bf16 a[36:39], v[48:51], v[64:67], a[36:39]
  s_barrier
  v_mov_b32 v140, v10
  v_mov_b32 v141, v11
  v_mov_b32 v142, v12
  v_mov_b32 v143, v13
  v_mov_b32 v144, v14
  s_waitcnt lgkmcnt(8)
  v_mfma_f32_16x16x32_bf16 a[36:39], v[52:55], v[80:83], a[36:39]
  v_permlane32_swap_b32 v10, v140
  v_permlane32_swap_b32 v11, v141
  v_permlane32_swap_b32 v12, v142
  v_permlane32_swap_b32 v13, v143
  v_permlane32_swap_b32 v14, v144
  v_add_f32 v10, v10, v140
  v_mfma_f32_16x16x32_bf16 a[100:103], v[48:51], v[68:71], a[100:103]
  s_and_b32 s7, s2, 7
  s_lshl_b32 s7, s7, 5
  s_lshr_b32 s6, s2, 3
  s_add_u32 s7, s7, s6
  s_mul_i32 s6, s7, 9363
  s_lshr_b32 s29, s6, 16
  s_mul_i32 s5, s29, 7
  s_sub_u32 s30, s7, s5
  s_cmp_ge_u32 s29, 18
  s_cselect_b32 s31, 1, 0
  s_mul_i32 s5, s31, 18
  s_sub_u32 s32, s29, s5
  s_and_b32 s33, s2, 1
  s_lshl_b32 s33, s33, 4
  s_cmp_eq_u32 s31, 0
  s_cselect_b32 s6, s66, s68
  s_cselect_b32 s5, s67, s69
  s_lshl_b32 s7, s30, 7
  s_add_u32 s12, s6, s7
  s_addc_u32 s13, s5, 0
  s_sub_u32 s14, 3670016, s7
  s_mov_b32 s15, 0x20000
  s_mul_i32 s36, s33, 114688
  s_mul_i32 s37, s28, 28672
  s_lshl_b32 s38, s28, 12
  v_add_f32 v11, v11, v141
  v_add_f32 v12, v12, v142
  v_add_f32 v13, v13, v143
  v_add_f32 v14, v14, v144
  v_mfma_f32_16x16x32_bf16 a[100:103], v[52:55], v[84:87], a[100:103]
  v_mbcnt_lo_u32_b32 v250, -1, 0
  v_mbcnt_hi_u32_b32 v250, -1, v250
  v_mov_b32 v140, v10
  v_mov_b32 v141, v11
  v_mov_b32 v142, v12
  v_mov_b32 v143, v13
  v_mfma_f32_16x16x32_bf16 a[164:167], v[48:51], v[72:75], a[164:167]
  ds_read_b128 v[16:19], v9 offset:8192
  ds_read_b128 v[20:23], v9 offset:9216
  v_lshrrev_b32 v251, 3, v250
  v_and_b32 v250, 7, v250
  v_mov_b32 v144, v14
  v_permlane16_swap_b32 v10, v140
  v_mfma_f32_16x16x32_bf16 a[164:167], v[52:55], v[88:91], a[164:167]
  v_and_b32 v252, 2, v251
  v_xor_b32 v252, v252, v250
  v_permlane16_swap_b32 v11, v141
  v_permlane16_swap_b32 v12, v142
  v_permlane16_swap_b32 v13, v143
  v_permlane16_swap_b32 v14, v144
  v_mfma_f32_16x16x32_bf16 a[228:231], v[48:51], v[76:79], a[228:231]
  v_lshlrev_b32 v252, 4, v252
  v_mul_u32_u24 v251, 896, v251
  v_add_f32 v10, v10, v140
  v_add_f32 v11, v11, v141
  v_add_f32 v12, v12, v142
  v_add_f32 v13, v13, v143
  v_mfma_f32_16x16x32_bf16 a[228:231], v[52:55], v[92:95], a[228:231]
  ds_read_b64_tr_b16 v[32:33], v3 offset:24576
  ds_read_b64_tr_b16 v[34:35], v3 offset:26624
  ds_read_b64_tr_b16 v[36:37], v3 offset:28672
  ds_read_b64_tr_b16 v[38:39], v3 offset:30720
  v_add_u32 v251, s37, v251
  v_add_u32 v248, v251, v252
  s_waitcnt lgkmcnt(12)
  v_mfma_f32_16x16x32_bf16 a[40:43], v[56:59], v[64:67], a[40:43]
  v_xor_b32 v252, 64, v252
  v_add_u32 v249, v251, v252
  v_add_f32 v14, v14, v144
  ds_write_b32 v9, v14 offset:10240
  v_cmp_nge_f32 vcc, s3, v10
  s_nop 0
  s_waitcnt lgkmcnt(11)
  v_mfma_f32_16x16x32_bf16 a[40:43], v[60:63], v[80:83], a[40:43]
  s_add_u32 m0, s38, 0
  s_add_u32 s39, s36, 0
  buffer_load_dwordx4 v248, s[12:15], s39 offen lds
  s_add_u32 m0, s38, 1024
  s_add_u32 s39, s36, 7168
  buffer_load_dwordx4 v249, s[12:15], s39 offen lds
  s_mov_b64 s[52:53], vcc
  v_cmp_nle_f32 vcc, s4, v10
  s_nop 0
  s_or_b64 s[52:53], s[52:53], vcc
  v_mfma_f32_16x16x32_bf16 a[104:107], v[56:59], v[68:71], a[104:107]
  s_add_u32 m0, s38, 2048
  s_add_u32 s39, s36, 14336
  buffer_load_dwordx4 v248, s[12:15], s39 offen lds
  s_add_u32 m0, s38, 3072
  s_add_u32 s39, s36, 21504
  buffer_load_dwordx4 v249, s[12:15], s39 offen lds
  s_add_u32 s36, s36, 114688
  s_cmp_eq_u32 s36, 3670016
  s_cselect_b32 s36, 0, s36
  s_add_u32 s38, s38, 16384
  s_and_b32 s38, s38, 131071
  v_rcp_f32 v10, v10
  v_cmp_nge_f32 vcc, s3, v11
  s_nop 0
  s_or_b64 s[52:53], s[52:53], vcc
  v_mfma_f32_16x16x32_bf16 a[104:107], v[60:63], v[84:87], a[104:107]
  s_add_u32 m0, s38, 0
  s_add_u32 s39, s36, 0
  buffer_load_dwordx4 v248, s[12:15], s39 offen lds
  s_add_u32 m0, s38, 1024
  s_add_u32 s39, s36, 7168
  buffer_load_dwordx4 v249, s[12:15], s39 offen lds
  v_cmp_nle_f32 vcc, s4, v11
  s_nop 0
  s_or_b64 s[52:53], s[52:53], vcc
  v_rcp_f32 v11, v11
  v_mfma_f32_16x16x32_bf16 a[168:171], v[56:59], v[72:75], a[168:171]
  s_add_u32 m0, s38, 2048
  s_add_u32 s39, s36, 14336
  buffer_load_dwordx4 v248, s[12:15], s39 offen lds
  s_add_u32 m0, s38, 3072
  s_add_u32 s39, s36, 21504
  buffer_load_dwordx4 v249, s[12:15], s39 offen lds
  s_add_u32 s36, s36, 114688
  s_cmp_eq_u32 s36, 3670016
  s_cselect_b32 s36, 0, s36
  s_add_u32 s38, s38, 16384
  s_and_b32 s38, s38, 131071
  v_cmp_nge_f32 vcc, s3, v12
  s_nop 0
  s_or_b64 s[52:53], s[52:53], vcc
  v_cmp_nle_f32 vcc, s4, v12
  v_mfma_f32_16x16x32_bf16 a[168:171], v[60:63], v[88:91], a[168:171]
  s_add_u32 m0, s38, 0
  s_add_u32 s39, s36, 0
  buffer_load_dwordx4 v248, s[12:15], s39 offen lds
  s_add_u32 m0, s38, 1024
  s_add_u32 s39, s36, 7168
  buffer_load_dwordx4 v249, s[12:15], s39 offen lds
  s_nop 0
  s_or_b64 s[52:53], s[52:53], vcc
  v_rcp_f32 v12, v12
  v_cmp_nge_f32 vcc, s3, v13
  v_mfma_f32_16x16x32_bf16 a[232:235], v[56:59], v[76:79], a[232:235]
  s_add_u32 m0, s38, 2048
  s_add_u32 s39, s36, 14336
  buffer_load_dwordx4 v248, s[12:15], s39 offen lds
  s_add_u32 m0, s38, 3072
  s_add_u32 s39, s36, 21504
  buffer_load_dwordx4 v249, s[12:15], s39 offen lds
  s_add_u32 s36, s36, 114688
  s_cmp_eq_u32 s36, 3670016
  s_cselect_b32 s36, 0, s36
  s_add_u32 s38, s38, 16384
  s_and_b32 s38, s38, 131071
  s_nop 0
  s_or_b64 s[52:53], s[52:53], vcc
  v_cmp_nle_f32 vcc, s4, v13
  s_nop 0
  v_mfma_f32_16x16x32_bf16 a[232:235], v[60:63], v[92:95], a[232:235]
  ds_read_b64_tr_b16 v[48:49], v4 offset:24576
  ds_read_b64_tr_b16 v[50:51], v4 offset:26624
  ds_read_b64_tr_b16 v[52:53], v4 offset:28672
  ds_read_b64_tr_b16 v[54:55], v4 offset:30720
  s_add_u32 m0, s38, 0
  s_add_u32 s39, s36, 0
  buffer_load_dwordx4 v248, s[12:15], s39 offen lds
  s_add_u32 m0, s38, 1024
  s_add_u32 s39, s36, 7168
  buffer_load_dwordx4 v249, s[12:15], s39 offen lds
  s_waitcnt lgkmcnt(13)
  v_mfma_f32_16x16x32_bf16 a[44:47], v[24:27], v[64:67], a[44:47]
  s_add_u32 m0, s38, 2048
  s_add_u32 s39, s36, 14336
  buffer_load_dwordx4 v248, s[12:15], s39 offen lds
  s_add_u32 m0, s38, 3072
  s_add_u32 s39, s36, 21504
  buffer_load_dwordx4 v249, s[12:15], s39 offen lds
  s_add_u32 s36, s36, 114688
  s_cmp_eq_u32 s36, 3670016
  s_cselect_b32 s36, 0, s36
  s_add_u32 s38, s38, 16384
  s_and_b32 s38, s38, 131071
  s_or_b64 s[52:53], s[52:53], vcc
  v_rcp_f32 v13, v13
  v_accvgpr_read_b32 v192, a32
  v_accvgpr_read_b32 v193, a33
  s_waitcnt lgkmcnt(11)
  v_mfma_f32_16x16x32_bf16 a[44:47], v[28:31], v[80:83], a[44:47]
  v_accvgpr_read_b32 v194, a34
  v_accvgpr_read_b32 v195, a35
  v_mul_f32 v192, v10, v192
  v_mul_f32 v193, v10, v193
  v_mul_f32 v194, v10, v194
  v_mul_f32 v195, v10, v195
  v_mfma_f32_16x16x32_bf16 a[108:111], v[24:27], v[68:71], a[108:111]
  v_cvt_pk_bf16_f32 v160, v192, v193
  v_cvt_pk_bf16_f32 v161, v194, v195
  v_accvgpr_read_b32 v196, a36
  v_accvgpr_read_b32 v197, a37
  v_accvgpr_read_b32 v198, a38
  v_accvgpr_read_b32 v199, a39
  v_mfma_f32_16x16x32_bf16 a[108:111], v[28:31], v[84:87], a[108:111]
  v_mul_f32 v196, v10, v196
  v_mul_f32 v197, v10, v197
  v_mul_f32 v198, v10, v198
  v_mul_f32 v199, v10, v199
  v_cvt_pk_bf16_f32 v162, v196, v197
  v_cvt_pk_bf16_f32 v163, v198, v199
  v_mfma_f32_16x16x32_bf16 a[172:175], v[24:27], v[72:75], a[172:175]
  v_accvgpr_read_b32 v200, a96
  v_accvgpr_read_b32 v201, a97
  v_permlane16_swap_b32 v160, v162
  v_permlane16_swap_b32 v161, v163
  v_accvgpr_read_b32 v202, a98
  v_accvgpr_read_b32 v203, a99
  v_mfma_f32_16x16x32_bf16 a[172:175], v[28:31], v[88:91], a[172:175]
  v_mul_f32 v200, v11, v200
  s_add_u32 s34, s41, 32768
  buffer_store_dwordx4 v[160:163], v128, s[24:27], s34 offen offset:0 sc1
  v_mfma_f32_16x16x32_bf16 v[136:139], v[132:135], v[160:163], v[136:139]
  v_mul_f32 v201, v11, v201
  v_mul_f32 v202, v11, v202
  v_mul_f32 v203, v11, v203
  v_mfma_f32_16x16x32_bf16 a[236:239], v[24:27], v[76:79], a[236:239]
  v_cvt_pk_bf16_f32 v164, v200, v201
  v_cvt_pk_bf16_f32 v165, v202, v203
  v_accvgpr_read_b32 v204, a100
  v_accvgpr_read_b32 v205, a101
  v_accvgpr_read_b32 v206, a102
  v_accvgpr_read_b32 v207, a103
  v_mfma_f32_16x16x32_bf16 a[236:239], v[28:31], v[92:95], a[236:239]
  ds_read_b64_tr_b16 v[56:57], v5 offset:24576
  ds_read_b64_tr_b16 v[58:59], v5 offset:26624
  ds_read_b64_tr_b16 v[60:61], v5 offset:28672
  ds_read_b64_tr_b16 v[62:63], v5 offset:30720
  v_mul_f32 v204, v11, v204
  v_mul_f32 v205, v11, v205
  s_waitcnt lgkmcnt(11)
  v_mfma_f32_16x16x32_bf16 a[48:51], v[32:35], v[64:67], a[48:51]
  v_mul_f32 v206, v11, v206
  v_mul_f32 v207, v11, v207
  v_cvt_pk_bf16_f32 v166, v204, v205
  v_cvt_pk_bf16_f32 v167, v206, v207
  v_accvgpr_read_b32 v208, a160
  v_accvgpr_read_b32 v209, a161
  s_waitcnt lgkmcnt(9)
  v_mfma_f32_16x16x32_bf16 a[48:51], v[36:39], v[80:83], a[48:51]
  v_permlane16_swap_b32 v164, v166
  v_permlane16_swap_b32 v165, v167
  v_accvgpr_read_b32 v210, a162
  v_accvgpr_read_b32 v211, a163
  v_mul_f32 v208, v12, v208
  s_add_u32 s34, s42, 32768
  buffer_store_dwordx4 v[164:167], v128, s[24:27], s34 offen offset:0 sc1
  v_mfma_f32_16x16x32_bf16 a[112:115], v[32:35], v[68:71], a[112:115]
  v_mfma_f32_16x16x32_bf16 v[136:139], v[132:135], v[164:167], v[136:139]
  v_mul_f32 v209, v12, v209
  v_mul_f32 v210, v12, v210
  v_mul_f32 v211, v12, v211
  v_cvt_pk_bf16_f32 v168, v208, v209
  v_cvt_pk_bf16_f32 v169, v210, v211
  v_mfma_f32_16x16x32_bf16 a[112:115], v[36:39], v[84:87], a[112:115]
  v_accvgpr_read_b32 v212, a164
  v_accvgpr_read_b32 v213, a165
  v_accvgpr_read_b32 v214, a166
  v_accvgpr_read_b32 v215, a167
  v_mul_f32 v212, v12, v212
  v_mul_f32 v213, v12, v213
  v_mfma_f32_16x16x32_bf16 a[176:179], v[32:35], v[72:75], a[176:179]
  v_mul_f32 v214, v12, v214
  v_mul_f32 v215, v12, v215
  v_cvt_pk_bf16_f32 v170, v212, v213
  v_cvt_pk_bf16_f32 v171, v214, v215
  v_accvgpr_read_b32 v216, a224
  v_accvgpr_read_b32 v217, a225
  v_mfma_f32_16x16x32_bf16 a[176:179], v[36:39], v[88:91], a[176:179]
  v_permlane16_swap_b32 v168, v170
  v_permlane16_swap_b32 v169, v171
  v_accvgpr_read_b32 v218, a226
  v_accvgpr_read_b32 v219, a227
  v_mul_f32 v216, v13, v216
  s_add_u32 s34, s43, 32768
  buffer_store_dwordx4 v[168:171], v128, s[24:27], s34 offen offset:0 sc1
  v_mfma_f32_16x16x32_bf16 a[240:243], v[32:35], v[76:79], a[240:243]
  v_mfma_f32_16x16x32_bf16 v[136:139], v[132:135], v[168:171], v[136:139]
  v_mul_f32 v217, v13, v217
  v_mul_f32 v218, v13, v218
  v_mul_f32 v219, v13, v219
  v_cvt_pk_bf16_f32 v172, v216, v217
  v_cvt_pk_bf16_f32 v173, v218, v219
  v_mfma_f32_16x16x32_bf16 a[240:243], v[36:39], v[92:95], a[240:243]
  ds_read_b64_tr_b16 v[40:41], v6 offset:24576
  ds_read_b64_tr_b16 v[42:43], v6 offset:26624
  ds_read_b64_tr_b16 v[44:45], v6 offset:28672
  ds_read_b64_tr_b16 v[46:47], v6 offset:30720
  v_accvgpr_read_b32 v220, a228
  v_accvgpr_read_b32 v221, a229
  s_waitcnt lgkmcnt(10)
  v_mfma_f32_16x16x32_bf16 a[52:55], v[48:51], v[64:67], a[52:55]
  v_accvgpr_read_b32 v222, a230
  v_accvgpr_read_b32 v223, a231
  v_mul_f32 v220, v13, v220
  v_mul_f32 v221, v13, v221
  v_mul_f32 v222, v13, v222
  v_mul_f32 v223, v13, v223
  s_waitcnt lgkmcnt(8)
  v_mfma_f32_16x16x32_bf16 a[52:55], v[52:55], v[80:83], a[52:55]
  v_cvt_pk_bf16_f32 v174, v220, v221
  v_cvt_pk_bf16_f32 v175, v222, v223
  v_accvgpr_read_b32 v192, a40
  v_accvgpr_read_b32 v193, a41
  v_permlane16_swap_b32 v172, v174
  v_permlane16_swap_b32 v173, v175
  v_mfma_f32_16x16x32_bf16 a[116:119], v[48:51], v[68:71], a[116:119]
  v_accvgpr_read_b32 v194, a42
  v_accvgpr_read_b32 v195, a43
  v_mul_f32 v192, v10, v192
  s_add_u32 s34, s44, 32768
  buffer_store_dwordx4 v[172:175], v128, s[24:27], s34 offen offset:0 sc1
  v_mfma_f32_16x16x32_bf16 v[136:139], v[132:135], v[172:175], v[136:139]
  v_mul_f32 v193, v10, v193
  v_mfma_f32_16x16x32_bf16 a[116:119], v[52:55], v[84:87], a[116:119]
  v_mul_f32 v194, v10, v194
  v_mul_f32 v195, v10, v195
  v_cvt_pk_bf16_f32 v176, v192, v193
  v_cvt_pk_bf16_f32 v177, v194, v195
  v_accvgpr_read_b32 v196, a44
  v_accvgpr_read_b32 v197, a45
  v_mfma_f32_16x16x32_bf16 a[180:183], v[48:51], v[72:75], a[180:183]
  v_accvgpr_read_b32 v198, a46
  v_accvgpr_read_b32 v199, a47
  v_mul_f32 v196, v10, v196
  v_mul_f32 v197, v10, v197
  v_mul_f32 v198, v10, v198
  v_mul_f32 v199, v10, v199
  v_mfma_f32_16x16x32_bf16 a[180:183], v[52:55], v[88:91], a[180:183]
  v_cvt_pk_bf16_f32 v178, v196, v197
  v_cvt_pk_bf16_f32 v179, v198, v199
  v_accvgpr_read_b32 v200, a104
  v_accvgpr_read_b32 v201, a105
  v_permlane16_swap_b32 v176, v178
  v_permlane16_swap_b32 v177, v179
  v_mfma_f32_16x16x32_bf16 a[244:247], v[48:51], v[76:79], a[244:247]
  v_accvgpr_read_b32 v202, a106
  v_accvgpr_read_b32 v203, a107
  v_mul_f32 v200, v11, v200
  s_add_u32 s34, s41, 32768
  buffer_store_dwordx4 v[176:179], v128, s[24:27], s34 offen offset:1024 sc1
  v_mfma_f32_16x16x32_bf16 v[136:139], v[132:135], v[176:179], v[136:139]
  v_mul_f32 v201, v11, v201
  v_mfma_f32_16x16x32_bf16 a[244:247], v[52:55], v[92:95], a[244:247]
  ds_read_b64_tr_b16 v[24:25], v3 offset:0
  ds_read_b64_tr_b16 v[26:27], v3 offset:2048
  ds_read_b64_tr_b16 v[28:29], v3 offset:4096
  ds_read_b64_tr_b16 v[30:31], v3 offset:6144
  v_mul_f32 v202, v11, v202
  v_mul_f32 v203, v11, v203
  s_waitcnt lgkmcnt(10)
  v_mfma_f32_16x16x32_bf16 a[56:59], v[56:59], v[64:67], a[56:59]
  v_cvt_pk_bf16_f32 v180, v200, v201
  v_cvt_pk_bf16_f32 v181, v202, v203
  v_accvgpr_read_b32 v204, a108
  v_accvgpr_read_b32 v205, a109
  v_accvgpr_read_b32 v206, a110
  v_accvgpr_read_b32 v207, a111
  s_waitcnt lgkmcnt(8)
  v_mfma_f32_16x16x32_bf16 a[56:59], v[60:63], v[80:83], a[56:59]
  v_mul_f32 v204, v11, v204
  v_mul_f32 v205, v11, v205
  v_mul_f32 v206, v11, v206
  v_mul_f32 v207, v11, v207
  v_cvt_pk_bf16_f32 v182, v204, v205
  v_cvt_pk_bf16_f32 v183, v206, v207
  v_mfma_f32_16x16x32_bf16 a[120:123], v[56:59], v[68:71], a[120:123]
  v_accvgpr_read_b32 v208, a168
  v_accvgpr_read_b32 v209, a169
  v_permlane16_swap_b32 v180, v182
  v_permlane16_swap_b32 v181, v183
  v_accvgpr_read_b32 v210, a170
  v_accvgpr_read_b32 v211, a171
  v_mfma_f32_16x16x32_bf16 a[120:123], v[60:63], v[84:87], a[120:123]
  v_mul_f32 v208, v12, v208
  s_add_u32 s34, s42, 32768
  buffer_store_dwordx4 v[180:183], v128, s[24:27], s34 offen offset:1024 sc1
  v_mfma_f32_16x16x32_bf16 v[136:139], v[132:135], v[180:183], v[136:139]
  v_mul_f32 v209, v12, v209
  v_mul_f32 v210, v12, v210
  v_mul_f32 v211, v12, v211
  v_mfma_f32_16x16x32_bf16 a[184:187], v[56:59], v[72:75], a[184:187]
  v_cvt_pk_bf16_f32 v184, v208, v209
  v_cvt_pk_bf16_f32 v185, v210, v211
  v_accvgpr_read_b32 v212, a172
  v_accvgpr_read_b32 v213, a173
  v_accvgpr_read_b32 v214, a174
  v_accvgpr_read_b32 v215, a175
  v_mfma_f32_16x16x32_bf16 a[184:187], v[60:63], v[88:91], a[184:187]
  v_mul_f32 v212, v12, v212
  v_mul_f32 v213, v12, v213
  v_mul_f32 v214, v12, v214
  v_mul_f32 v215, v12, v215
  v_cvt_pk_bf16_f32 v186, v212, v213
  v_cvt_pk_bf16_f32 v187, v214, v215
  v_mfma_f32_16x16x32_bf16 a[248:251], v[56:59], v[76:79], a[248:251]
  v_accvgpr_read_b32 v216, a232
  v_accvgpr_read_b32 v217, a233
  v_permlane16_swap_b32 v184, v186
  v_permlane16_swap_b32 v185, v187
  v_accvgpr_read_b32 v218, a234
  v_accvgpr_read_b32 v219, a235
  v_mfma_f32_16x16x32_bf16 a[248:251], v[60:63], v[92:95], a[248:251]
  ds_read_b64_tr_b16 v[48:49], v4 offset:0
  ds_read_b64_tr_b16 v[50:51], v4 offset:2048
  ds_read_b64_tr_b16 v[52:53], v4 offset:4096
  ds_read_b64_tr_b16 v[54:55], v4 offset:6144
  v_mul_f32 v216, v13, v216
  s_add_u32 s34, s43, 32768
  buffer_store_dwordx4 v[184:187], v128, s[24:27], s34 offen offset:1024 sc1
  s_waitcnt lgkmcnt(10)
  v_mfma_f32_16x16x32_bf16 a[60:63], v[40:43], v[64:67], a[60:63]
  v_mfma_f32_16x16x32_bf16 v[136:139], v[132:135], v[184:187], v[136:139]
  v_mul_f32 v217, v13, v217
  v_mul_f32 v218, v13, v218
  v_mul_f32 v219, v13, v219
  v_cvt_pk_bf16_f32 v188, v216, v217
  v_cvt_pk_bf16_f32 v189, v218, v219
  s_waitcnt lgkmcnt(8)
  v_mfma_f32_16x16x32_bf16 a[60:63], v[44:47], v[80:83], a[60:63]
  v_accvgpr_read_b32 v220, a236
  v_accvgpr_read_b32 v221, a237
  v_accvgpr_read_b32 v222, a238
  v_accvgpr_read_b32 v223, a239
  v_mul_f32 v220, v13, v220
  v_mul_f32 v221, v13, v221
  v_mfma_f32_16x16x32_bf16 a[124:127], v[40:43], v[68:71], a[124:127]
  v_mul_f32 v222, v13, v222
  v_mul_f32 v223, v13, v223
  v_cvt_pk_bf16_f32 v190, v220, v221
  v_cvt_pk_bf16_f32 v191, v222, v223
  v_accvgpr_read_b32 v192, a48
  v_accvgpr_read_b32 v193, a49
  v_mfma_f32_16x16x32_bf16 a[124:127], v[44:47], v[84:87], a[124:127]
  v_permlane16_swap_b32 v188, v190
  v_permlane16_swap_b32 v189, v191
  v_accvgpr_read_b32 v194, a50
  v_accvgpr_read_b32 v195, a51
  v_mul_f32 v192, v10, v192
  s_add_u32 s34, s44, 32768
  buffer_store_dwordx4 v[188:191], v128, s[24:27], s34 offen offset:1024 sc1
  v_mfma_f32_16x16x32_bf16 a[188:191], v[40:43], v[72:75], a[188:191]
  v_mfma_f32_16x16x32_bf16 v[136:139], v[132:135], v[188:191], v[136:139]
  v_mul_f32 v193, v10, v193
  v_mul_f32 v194, v10, v194
  v_mul_f32 v195, v10, v195
  v_cvt_pk_bf16_f32 v160, v192, v193
  v_cvt_pk_bf16_f32 v161, v194, v195
  v_mfma_f32_16x16x32_bf16 a[188:191], v[44:47], v[88:91], a[188:191]
  v_accvgpr_read_b32 v196, a52
  v_accvgpr_read_b32 v197, a53
  v_accvgpr_read_b32 v198, a54
  v_accvgpr_read_b32 v199, a55
  v_mul_f32 v196, v10, v196
  v_mul_f32 v197, v10, v197
  v_mfma_f32_16x16x32_bf16 a[252:255], v[40:43], v[76:79], a[252:255]
  v_mul_f32 v198, v10, v198
  v_mul_f32 v199, v10, v199
  v_cvt_pk_bf16_f32 v162, v196, v197
  v_cvt_pk_bf16_f32 v163, v198, v199
  v_accvgpr_read_b32 v200, a112
  v_accvgpr_read_b32 v201, a113
  v_mfma_f32_16x16x32_bf16 a[252:255], v[44:47], v[92:95], a[252:255]
  ds_read_b64_tr_b16 v[56:57], v5 offset:0
  ds_read_b64_tr_b16 v[58:59], v5 offset:2048
  ds_read_b64_tr_b16 v[60:61], v5 offset:4096
  ds_read_b64_tr_b16 v[62:63], v5 offset:6144
  v_permlane16_swap_b32 v160, v162
  v_permlane16_swap_b32 v161, v163
  s_waitcnt lgkmcnt(10)
  v_mfma_f32_16x16x32_bf16 a[0:3], v[24:27], v[64:67], a[0:3]
  v_accvgpr_read_b32 v202, a114
  v_accvgpr_read_b32 v203, a115
  v_mul_f32 v200, v11, v200
  s_add_u32 s34, s41, 32768
  buffer_store_dwordx4 v[160:163], v128, s[24:27], s34 offen offset:2048 sc1
  v_mfma_f32_16x16x32_bf16 v[136:139], v[132:135], v[160:163], v[136:139]
  v_mul_f32 v201, v11, v201
  s_waitcnt lgkmcnt(8)
  v_mfma_f32_16x16x32_bf16 a[0:3], v[28:31], v[80:83], a[0:3]
  v_mul_f32 v202, v11, v202
  v_mul_f32 v203, v11, v203
  v_cvt_pk_bf16_f32 v164, v200, v201
  v_cvt_pk_bf16_f32 v165, v202, v203
  v_accvgpr_read_b32 v204, a116
  v_accvgpr_read_b32 v205, a117
  v_mfma_f32_16x16x32_bf16 a[64:67], v[24:27], v[68:71], a[64:67]
  v_accvgpr_read_b32 v206, a118
  v_accvgpr_read_b32 v207, a119
  v_mul_f32 v204, v11, v204
  v_mul_f32 v205, v11, v205
  v_mul_f32 v206, v11, v206
  v_mul_f32 v207, v11, v207
  v_mfma_f32_16x16x32_bf16 a[64:67], v[28:31], v[84:87], a[64:67]
  v_cvt_pk_bf16_f32 v166, v204, v205
  v_cvt_pk_bf16_f32 v167, v206, v207
  v_accvgpr_read_b32 v208, a176
  v_accvgpr_read_b32 v209, a177
  v_permlane16_swap_b32 v164, v166
  v_permlane16_swap_b32 v165, v167
  v_mfma_f32_16x16x32_bf16 a[128:131], v[24:27], v[72:75], a[128:131]
  v_accvgpr_read_b32 v210, a178
  v_accvgpr_read_b32 v211, a179
  v_mul_f32 v208, v12, v208
  s_add_u32 s34, s42, 32768
  buffer_store_dwordx4 v[164:167], v128, s[24:27], s34 offen offset:2048 sc1
  v_mfma_f32_16x16x32_bf16 v[136:139], v[132:135], v[164:167], v[136:139]
  v_mul_f32 v209, v12, v209
  v_mfma_f32_16x16x32_bf16 a[128:131], v[28:31], v[88:91], a[128:131]
  v_mul_f32 v210, v12, v210
  v_mul_f32 v211, v12, v211
  v_cvt_pk_bf16_f32 v168, v208, v209
  v_cvt_pk_bf16_f32 v169, v210, v211
  v_accvgpr_read_b32 v212, a180
  v_accvgpr_read_b32 v213, a181
  v_mfma_f32_16x16x32_bf16 a[192:195], v[24:27], v[76:79], a[192:195]
  v_accvgpr_read_b32 v214, a182
  v_accvgpr_read_b32 v215, a183
  v_mul_f32 v212, v12, v212
  v_mul_f32 v213, v12, v213
  v_mul_f32 v214, v12, v214
  v_mul_f32 v215, v12, v215
  v_mfma_f32_16x16x32_bf16 a[192:195], v[28:31], v[92:95], a[192:195]
  v_cvt_pk_bf16_f32 v170, v212, v213
  v_cvt_pk_bf16_f32 v171, v214, v215
  v_accvgpr_read_b32 v216, a240
  v_accvgpr_read_b32 v217, a241
  v_permlane16_swap_b32 v168, v170
  v_permlane16_swap_b32 v169, v171
  v_mfma_f32_16x16x32_bf16 v[96:99], v[24:27], v[16:19], v[96:99]
  v_accvgpr_read_b32 v218, a242
  v_accvgpr_read_b32 v219, a243
  v_mul_f32 v216, v13, v216
  s_add_u32 s34, s43, 32768
  buffer_store_dwordx4 v[168:171], v128, s[24:27], s34 offen offset:2048 sc1
  v_mfma_f32_16x16x32_bf16 v[136:139], v[132:135], v[168:171], v[136:139]
  v_mul_f32 v217, v13, v217
  v_mfma_f32_16x16x32_bf16 v[96:99], v[28:31], v[20:23], v[96:99]
  ds_read_b64_tr_b16 v[32:33], v6 offset:0
  ds_read_b64_tr_b16 v[34:35], v6 offset:2048
  ds_read_b64_tr_b16 v[36:37], v6 offset:4096
  ds_read_b64_tr_b16 v[38:39], v6 offset:6144
  v_mul_f32 v218, v13, v218
  v_mul_f32 v219, v13, v219
  s_waitcnt lgkmcnt(10)
  v_mfma_f32_16x16x32_bf16 a[4:7], v[48:51], v[64:67], a[4:7]
  v_cvt_pk_bf16_f32 v172, v216, v217
  v_cvt_pk_bf16_f32 v173, v218, v219
  v_accvgpr_read_b32 v220, a244
  v_accvgpr_read_b32 v221, a245
  v_accvgpr_read_b32 v222, a246
  v_accvgpr_read_b32 v223, a247
  s_waitcnt lgkmcnt(8)
  v_mfma_f32_16x16x32_bf16 a[4:7], v[52:55], v[80:83], a[4:7]
  v_mul_f32 v220, v13, v220
  v_mul_f32 v221, v13, v221
  v_mul_f32 v222, v13, v222
  v_mul_f32 v223, v13, v223
  v_cvt_pk_bf16_f32 v174, v220, v221
  v_cvt_pk_bf16_f32 v175, v222, v223
  v_mfma_f32_16x16x32_bf16 a[68:71], v[48:51], v[68:71], a[68:71]
  v_accvgpr_read_b32 v192, a56
  v_accvgpr_read_b32 v193, a57
  v_permlane16_swap_b32 v172, v174
  v_permlane16_swap_b32 v173, v175
  v_accvgpr_read_b32 v194, a58
  v_accvgpr_read_b32 v195, a59
  v_mfma_f32_16x16x32_bf16 a[68:71], v[52:55], v[84:87], a[68:71]
  v_mul_f32 v192, v10, v192
  s_add_u32 s34, s44, 32768
  buffer_store_dwordx4 v[172:175], v128, s[24:27], s34 offen offset:2048 sc1
  v_mfma_f32_16x16x32_bf16 v[136:139], v[132:135], v[172:175], v[136:139]
  v_mul_f32 v193, v10, v193
  v_mul_f32 v194, v10, v194
  v_mul_f32 v195, v10, v195
  v_mfma_f32_16x16x32_bf16 a[132:135], v[48:51], v[72:75], a[132:135]
  v_cvt_pk_bf16_f32 v176, v192, v193
  v_cvt_pk_bf16_f32 v177, v194, v195
  v_accvgpr_read_b32 v196, a60
  v_accvgpr_read_b32 v197, a61
  v_accvgpr_read_b32 v198, a62
  v_accvgpr_read_b32 v199, a63
  v_mfma_f32_16x16x32_bf16 a[132:135], v[52:55], v[88:91], a[132:135]
  v_mul_f32 v196, v10, v196
  v_mul_f32 v197, v10, v197
  v_mul_f32 v198, v10, v198
  v_mul_f32 v199, v10, v199
  v_cvt_pk_bf16_f32 v178, v196, v197
  v_cvt_pk_bf16_f32 v179, v198, v199
  v_mfma_f32_16x16x32_bf16 a[196:199], v[48:51], v[76:79], a[196:199]
  v_accvgpr_read_b32 v200, a120
  v_accvgpr_read_b32 v201, a121
  v_permlane16_swap_b32 v176, v178
  v_permlane16_swap_b32 v177, v179
  v_accvgpr_read_b32 v202, a122
  v_accvgpr_read_b32 v203, a123
  v_mfma_f32_16x16x32_bf16 a[196:199], v[52:55], v[92:95], a[196:199]
  v_mul_f32 v200, v11, v200
  s_add_u32 s34, s41, 32768
  buffer_store_dwordx4 v[176:179], v128, s[24:27], s34 offen offset:3072 sc1
  v_mfma_f32_16x16x32_bf16 v[136:139], v[132:135], v[176:179], v[136:139]
  v_mul_f32 v201, v11, v201
  v_mul_f32 v202, v11, v202
  v_mul_f32 v203, v11, v203
  v_mfma_f32_16x16x32_bf16 v[100:103], v[48:51], v[16:19], v[100:103]
  v_cvt_pk_bf16_f32 v180, v200, v201
  v_cvt_pk_bf16_f32 v181, v202, v203
  v_accvgpr_read_b32 v204, a124
  v_accvgpr_read_b32 v205, a125
  v_accvgpr_read_b32 v206, a126
  v_accvgpr_read_b32 v207, a127
  v_mfma_f32_16x16x32_bf16 v[100:103], v[52:55], v[20:23], v[100:103]
  ds_read_b64_tr_b16 v[40:41], v3 offset:8192
  ds_read_b64_tr_b16 v[42:43], v3 offset:10240
  ds_read_b64_tr_b16 v[44:45], v3 offset:12288
  ds_read_b64_tr_b16 v[46:47], v3 offset:14336
  v_mul_f32 v204, v11, v204
  v_mul_f32 v205, v11, v205
  s_waitcnt lgkmcnt(10)
  v_mfma_f32_16x16x32_bf16 a[8:11], v[56:59], v[64:67], a[8:11]
  v_mul_f32 v206, v11, v206
  v_mul_f32 v207, v11, v207
  v_cvt_pk_bf16_f32 v182, v204, v205
  v_cvt_pk_bf16_f32 v183, v206, v207
  v_accvgpr_read_b32 v208, a184
  v_accvgpr_read_b32 v209, a185
  s_waitcnt lgkmcnt(8)
  v_mfma_f32_16x16x32_bf16 a[8:11], v[60:63], v[80:83], a[8:11]
  v_permlane16_swap_b32 v180, v182
  v_permlane16_swap_b32 v181, v183
  v_accvgpr_read_b32 v210, a186
  v_accvgpr_read_b32 v211, a187
  v_mul_f32 v208, v12, v208
  s_add_u32 s34, s42, 32768
  buffer_store_dwordx4 v[180:183], v128, s[24:27], s34 offen offset:3072 sc1
  v_mfma_f32_16x16x32_bf16 a[72:75], v[56:59], v[68:71], a[72:75]
  v_mfma_f32_16x16x32_bf16 v[136:139], v[132:135], v[180:183], v[136:139]
  v_mul_f32 v209, v12, v209
  v_mul_f32 v210, v12, v210
  v_mul_f32 v211, v12, v211
  v_cvt_pk_bf16_f32 v184, v208, v209
  v_cvt_pk_bf16_f32 v185, v210, v211
  v_mfma_f32_16x16x32_bf16 a[72:75], v[60:63], v[84:87], a[72:75]
  v_accvgpr_read_b32 v212, a188
  v_accvgpr_read_b32 v213, a189
  v_accvgpr_read_b32 v214, a190
  v_accvgpr_read_b32 v215, a191
  v_mul_f32 v212, v12, v212
  v_mul_f32 v213, v12, v213
  v_mfma_f32_16x16x32_bf16 a[136:139], v[56:59], v[72:75], a[136:139]
  v_mul_f32 v214, v12, v214
  v_mul_f32 v215, v12, v215
  v_cvt_pk_bf16_f32 v186, v212, v213
  v_cvt_pk_bf16_f32 v187, v214, v215
  v_accvgpr_read_b32 v216, a248
  v_accvgpr_read_b32 v217, a249
  v_mfma_f32_16x16x32_bf16 a[136:139], v[60:63], v[88:91], a[136:139]
  v_permlane16_swap_b32 v184, v186
  v_permlane16_swap_b32 v185, v187
  v_accvgpr_read_b32 v218, a250
  v_accvgpr_read_b32 v219, a251
  v_mul_f32 v216, v13, v216
  s_add_u32 s34, s43, 32768
  buffer_store_dwordx4 v[184:187], v128, s[24:27], s34 offen offset:3072 sc1
  v_mfma_f32_16x16x32_bf16 a[200:203], v[56:59], v[76:79], a[200:203]
  v_mfma_f32_16x16x32_bf16 v[136:139], v[132:135], v[184:187], v[136:139]
  v_mul_f32 v217, v13, v217
  v_mul_f32 v218, v13, v218
  v_mul_f32 v219, v13, v219
  v_cvt_pk_bf16_f32 v188, v216, v217
  v_cvt_pk_bf16_f32 v189, v218, v219
  v_mfma_f32_16x16x32_bf16 a[200:203], v[60:63], v[92:95], a[200:203]
  v_accvgpr_read_b32 v220, a252
  v_accvgpr_read_b32 v221, a253
  v_accvgpr_read_b32 v222, a254
  v_accvgpr_read_b32 v223, a255
  v_mul_f32 v220, v13, v220
  v_mul_f32 v221, v13, v221
  v_mfma_f32_16x16x32_bf16 v[104:107], v[56:59], v[16:19], v[104:107]
  v_mul_f32 v222, v13, v222
  v_mul_f32 v223, v13, v223
  v_cvt_pk_bf16_f32 v190, v220, v221
  v_cvt_pk_bf16_f32 v191, v222, v223
  v_accvgpr_read_b32 v192, a0
  v_accvgpr_read_b32 v193, a1
  v_mfma_f32_16x16x32_bf16 v[104:107], v[60:63], v[20:23], v[104:107]
  ds_read_b64_tr_b16 v[48:49], v4 offset:8192
  ds_read_b64_tr_b16 v[50:51], v4 offset:10240
  ds_read_b64_tr_b16 v[52:53], v4 offset:12288
  ds_read_b64_tr_b16 v[54:55], v4 offset:14336
  v_permlane16_swap_b32 v188, v190
  v_permlane16_swap_b32 v189, v191
  s_waitcnt lgkmcnt(10)
  v_mfma_f32_16x16x32_bf16 a[12:15], v[32:35], v[64:67], a[12:15]
  s_barrier
  v_accvgpr_read_b32 v194, a2
  v_accvgpr_read_b32 v195, a3
  v_mul_f32 v192, v10, v192
  s_add_u32 s34, s44, 32768
  buffer_store_dwordx4 v[188:191], v128, s[24:27], s34 offen offset:3072 sc1
  v_mfma_f32_16x16x32_bf16 v[136:139], v[132:135], v[188:191], v[136:139]
  s_waitcnt lgkmcnt(8)
  v_mfma_f32_16x16x32_bf16 a[12:15], v[36:39], v[80:83], a[12:15]
  v_mul_f32 v193, v10, v193
  v_mul_f32 v194, v10, v194
  v_mul_f32 v195, v10, v195
  v_cvt_pk_bf16_f32 v160, v192, v193
  v_cvt_pk_bf16_f32 v161, v194, v195
  v_accvgpr_read_b32 v196, a4
  v_mfma_f32_16x16x32_bf16 a[76:79], v[32:35], v[68:71], a[76:79]
  v_accvgpr_read_b32 v197, a5
  v_accvgpr_read_b32 v198, a6
  v_accvgpr_read_b32 v199, a7
  v_mul_f32 v196, v10, v196
  v_mul_f32 v197, v10, v197
  v_mul_f32 v198, v10, v198
  v_mfma_f32_16x16x32_bf16 a[76:79], v[36:39], v[84:87], a[76:79]
  v_mul_f32 v199, v10, v199
  v_cvt_pk_bf16_f32 v162, v196, v197
  v_cvt_pk_bf16_f32 v163, v198, v199
  v_accvgpr_read_b32 v200, a64
  v_accvgpr_read_b32 v201, a65
  v_permlane16_swap_b32 v160, v162
  v_mfma_f32_16x16x32_bf16 a[140:143], v[32:35], v[72:75], a[140:143]
  v_permlane16_swap_b32 v161, v163
  v_accvgpr_read_b32 v202, a66
  v_accvgpr_read_b32 v203, a67
  v_mul_f32 v200, v11, v200
  s_add_u32 s34, s41, 0
  buffer_store_dwordx4 v[160:163], v128, s[24:27], s34 offen offset:0 sc1
  v_mfma_f32_16x16x32_bf16 v[136:139], v[132:135], v[160:163], v[136:139]
  v_mfma_f32_16x16x32_bf16 a[140:143], v[36:39], v[88:91], a[140:143]
  v_mul_f32 v201, v11, v201
  v_mul_f32 v202, v11, v202
  v_mul_f32 v203, v11, v203
  v_cvt_pk_bf16_f32 v164, v200, v201
  v_cvt_pk_bf16_f32 v165, v202, v203
  v_accvgpr_read_b32 v204, a68
  v_mfma_f32_16x16x32_bf16 a[204:207], v[32:35], v[76:79], a[204:207]
  v_accvgpr_read_b32 v205, a69
  v_accvgpr_read_b32 v206, a70
  v_accvgpr_read_b32 v207, a71
  v_mul_f32 v204, v11, v204
  v_mul_f32 v205, v11, v205
  v_mul_f32 v206, v11, v206
  v_mfma_f32_16x16x32_bf16 a[204:207], v[36:39], v[92:95], a[204:207]
  v_mul_f32 v207, v11, v207
  v_cvt_pk_bf16_f32 v166, v204, v205
  v_cvt_pk_bf16_f32 v167, v206, v207
  v_accvgpr_read_b32 v208, a128
  v_accvgpr_read_b32 v209, a129
  v_permlane16_swap_b32 v164, v166
  v_mfma_f32_16x16x32_bf16 v[108:111], v[32:35], v[16:19], v[108:111]
  v_permlane16_swap_b32 v165, v167
  v_accvgpr_read_b32 v210, a130
  v_accvgpr_read_b32 v211, a131
  v_mul_f32 v208, v12, v208
  s_add_u32 s34, s42, 0
  buffer_store_dwordx4 v[164:167], v128, s[24:27], s34 offen offset:0 sc1
  v_mfma_f32_16x16x32_bf16 v[136:139], v[132:135], v[164:167], v[136:139]
  v_mfma_f32_16x16x32_bf16 v[108:111], v[36:39], v[20:23], v[108:111]
  ds_read_b64_tr_b16 v[56:57], v5 offset:8192
  ds_read_b64_tr_b16 v[58:59], v5 offset:10240
  ds_read_b64_tr_b16 v[60:61], v5 offset:12288
  ds_read_b64_tr_b16 v[62:63], v5 offset:14336
  v_mul_f32 v209, v12, v209
  v_mul_f32 v210, v12, v210
  s_waitcnt lgkmcnt(10)
  v_mfma_f32_16x16x32_bf16 a[16:19], v[40:43], v[64:67], a[16:19]
  v_mul_f32 v211, v12, v211
  v_cvt_pk_bf16_f32 v168, v208, v209
  v_cvt_pk_bf16_f32 v169, v210, v211
  v_accvgpr_read_b32 v212, a132
  v_accvgpr_read_b32 v213, a133
  v_accvgpr_read_b32 v214, a134
  s_waitcnt lgkmcnt(8)
  v_mfma_f32_16x16x32_bf16 a[16:19], v[44:47], v[80:83], a[16:19]
  v_accvgpr_read_b32 v215, a135
  v_mul_f32 v212, v12, v212
  v_mul_f32 v213, v12, v213
  v_mul_f32 v214, v12, v214
  v_mul_f32 v215, v12, v215
  v_cvt_pk_bf16_f32 v170, v212, v213
  v_mfma_f32_16x16x32_bf16 a[80:83], v[40:43], v[68:71], a[80:83]
  v_cvt_pk_bf16_f32 v171, v214, v215
  v_accvgpr_read_b32 v216, a192
  v_accvgpr_read_b32 v217, a193
  v_permlane16_swap_b32 v168, v170
  v_permlane16_swap_b32 v169, v171
  v_accvgpr_read_b32 v218, a194
  v_mfma_f32_16x16x32_bf16 a[80:83], v[44:47], v[84:87], a[80:83]
  v_accvgpr_read_b32 v219, a195
  v_mul_f32 v216, v13, v216
  s_add_u32 s34, s43, 0
  buffer_store_dwordx4 v[168:171], v128, s[24:27], s34 offen offset:0 sc1
  v_mfma_f32_16x16x32_bf16 v[136:139], v[132:135], v[168:171], v[136:139]
  v_mul_f32 v217, v13, v217
  v_mul_f32 v218, v13, v218
  v_mfma_f32_16x16x32_bf16 a[144:147], v[40:43], v[72:75], a[144:147]
  v_mul_f32 v219, v13, v219
  v_cvt_pk_bf16_f32 v172, v216, v217
  v_cvt_pk_bf16_f32 v173, v218, v219
  v_accvgpr_read_b32 v220, a196
  v_accvgpr_read_b32 v221, a197
  v_accvgpr_read_b32 v222, a198
  v_mfma_f32_16x16x32_bf16 a[144:147], v[44:47], v[88:91], a[144:147]
  v_accvgpr_read_b32 v223, a199
  v_mul_f32 v220, v13, v220
  v_mul_f32 v221, v13, v221
  v_mul_f32 v222, v13, v222
  v_mul_f32 v223, v13, v223
  v_cvt_pk_bf16_f32 v174, v220, v221
  v_mfma_f32_16x16x32_bf16 a[208:211], v[40:43], v[76:79], a[208:211]
  v_cvt_pk_bf16_f32 v175, v222, v223
  v_accvgpr_read_b32 v192, a8
  v_accvgpr_read_b32 v193, a9
  v_permlane16_swap_b32 v172, v174
  v_permlane16_swap_b32 v173, v175
  v_accvgpr_read_b32 v194, a10
  v_mfma_f32_16x16x32_bf16 a[208:211], v[44:47], v[92:95], a[208:211]
  v_accvgpr_read_b32 v195, a11
  v_mul_f32 v192, v10, v192
  s_add_u32 s34, s44, 0
  buffer_store_dwordx4 v[172:175], v128, s[24:27], s34 offen offset:0 sc1
  v_mfma_f32_16x16x32_bf16 v[136:139], v[132:135], v[172:175], v[136:139]
  v_mul_f32 v193, v10, v193
  v_mul_f32 v194, v10, v194
  v_mfma_f32_16x16x32_bf16 v[112:115], v[40:43], v[16:19], v[112:115]
  v_mul_f32 v195, v10, v195
  v_cvt_pk_bf16_f32 v176, v192, v193
  v_cvt_pk_bf16_f32 v177, v194, v195
  v_accvgpr_read_b32 v196, a12
  v_accvgpr_read_b32 v197, a13
  v_accvgpr_read_b32 v198, a14
  v_mfma_f32_16x16x32_bf16 v[112:115], v[44:47], v[20:23], v[112:115]
  ds_read_b64_tr_b16 v[24:25], v6 offset:8192
  ds_read_b64_tr_b16 v[26:27], v6 offset:10240
  ds_read_b64_tr_b16 v[28:29], v6 offset:12288
  ds_read_b64_tr_b16 v[30:31], v6 offset:14336
  v_accvgpr_read_b32 v199, a15
  v_mul_f32 v196, v10, v196
  s_waitcnt lgkmcnt(10)
  v_mfma_f32_16x16x32_bf16 a[20:23], v[48:51], v[64:67], a[20:23]
  v_mul_f32 v197, v10, v197
  v_mul_f32 v198, v10, v198
  v_mul_f32 v199, v10, v199
  v_cvt_pk_bf16_f32 v178, v196, v197
  v_cvt_pk_bf16_f32 v179, v198, v199
  v_accvgpr_read_b32 v200, a72
  s_waitcnt lgkmcnt(8)
  v_mfma_f32_16x16x32_bf16 a[20:23], v[52:55], v[80:83], a[20:23]
  v_accvgpr_read_b32 v201, a73
  v_permlane16_swap_b32 v176, v178
  v_permlane16_swap_b32 v177, v179
  v_accvgpr_read_b32 v202, a74
  v_accvgpr_read_b32 v203, a75
  v_mul_f32 v200, v11, v200
  v_mfma_f32_16x16x32_bf16 a[84:87], v[48:51], v[68:71], a[84:87]
  s_add_u32 s34, s41, 0
  buffer_store_dwordx4 v[176:179], v128, s[24:27], s34 offen offset:1024 sc1
  v_mfma_f32_16x16x32_bf16 v[136:139], v[132:135], v[176:179], v[136:139]
  v_mul_f32 v201, v11, v201
  v_mul_f32 v202, v11, v202
  v_mul_f32 v203, v11, v203
  v_cvt_pk_bf16_f32 v180, v200, v201
  v_mfma_f32_16x16x32_bf16 a[84:87], v[52:55], v[84:87], a[84:87]
  v_cvt_pk_bf16_f32 v181, v202, v203
  v_accvgpr_read_b32 v204, a76
  v_accvgpr_read_b32 v205, a77
  v_accvgpr_read_b32 v206, a78
  v_accvgpr_read_b32 v207, a79
  v_mul_f32 v204, v11, v204
  v_mfma_f32_16x16x32_bf16 a[148:151], v[48:51], v[72:75], a[148:151]
  v_mul_f32 v205, v11, v205
  v_mul_f32 v206, v11, v206
  v_mul_f32 v207, v11, v207
  v_cvt_pk_bf16_f32 v182, v204, v205
  v_cvt_pk_bf16_f32 v183, v206, v207
  v_accvgpr_read_b32 v208, a136
  v_mfma_f32_16x16x32_bf16 a[148:151], v[52:55], v[88:91], a[148:151]
  v_accvgpr_read_b32 v209, a137
  v_permlane16_swap_b32 v180, v182
  v_permlane16_swap_b32 v181, v183
  v_accvgpr_read_b32 v210, a138
  v_accvgpr_read_b32 v211, a139
  v_mul_f32 v208, v12, v208
  v_mfma_f32_16x16x32_bf16 a[212:215], v[48:51], v[76:79], a[212:215]
  s_add_u32 s34, s42, 0
  buffer_store_dwordx4 v[180:183], v128, s[24:27], s34 offen offset:1024 sc1
  v_mfma_f32_16x16x32_bf16 v[136:139], v[132:135], v[180:183], v[136:139]
  v_mul_f32 v209, v12, v209
  v_mul_f32 v210, v12, v210
  v_mul_f32 v211, v12, v211
  v_cvt_pk_bf16_f32 v184, v208, v209
  v_mfma_f32_16x16x32_bf16 a[212:215], v[52:55], v[92:95], a[212:215]
  v_cvt_pk_bf16_f32 v185, v210, v211
  v_accvgpr_read_b32 v212, a140
  v_accvgpr_read_b32 v213, a141
  v_accvgpr_read_b32 v214, a142
  v_accvgpr_read_b32 v215, a143
  v_mul_f32 v212, v12, v212
  v_mfma_f32_16x16x32_bf16 v[116:119], v[48:51], v[16:19], v[116:119]
  v_mul_f32 v213, v12, v213
  v_mul_f32 v214, v12, v214
  v_mul_f32 v215, v12, v215
  v_cvt_pk_bf16_f32 v186, v212, v213
  v_cvt_pk_bf16_f32 v187, v214, v215
  v_accvgpr_read_b32 v216, a200
  v_mfma_f32_16x16x32_bf16 v[116:119], v[52:55], v[20:23], v[116:119]
  v_accvgpr_read_b32 v217, a201
  v_permlane16_swap_b32 v184, v186
  v_permlane16_swap_b32 v185, v187
  v_accvgpr_read_b32 v218, a202
  v_accvgpr_read_b32 v219, a203
  v_mul_f32 v216, v13, v216
  s_waitcnt lgkmcnt(6)
  v_mfma_f32_16x16x32_bf16 a[24:27], v[56:59], v[64:67], a[24:27]
  s_add_u32 s34, s43, 0
  buffer_store_dwordx4 v[184:187], v128, s[24:27], s34 offen offset:1024 sc1
  v_mfma_f32_16x16x32_bf16 v[136:139], v[132:135], v[184:187], v[136:139]
  v_mul_f32 v217, v13, v217
  v_mul_f32 v218, v13, v218
  v_mul_f32 v219, v13, v219
  v_cvt_pk_bf16_f32 v188, v216, v217
  s_waitcnt lgkmcnt(4)
  v_mfma_f32_16x16x32_bf16 a[24:27], v[60:63], v[80:83], a[24:27]
  v_cvt_pk_bf16_f32 v189, v218, v219
  v_accvgpr_read_b32 v220, a204
  v_accvgpr_read_b32 v221, a205
  v_accvgpr_read_b32 v222, a206
  v_accvgpr_read_b32 v223, a207
  v_mul_f32 v220, v13, v220
  v_mfma_f32_16x16x32_bf16 a[88:91], v[56:59], v[68:71], a[88:91]
  v_mul_f32 v221, v13, v221
  v_mul_f32 v222, v13, v222
  v_mul_f32 v223, v13, v223
  v_cvt_pk_bf16_f32 v190, v220, v221
  v_cvt_pk_bf16_f32 v191, v222, v223
  v_accvgpr_read_b32 v192, a16
  v_mfma_f32_16x16x32_bf16 a[88:91], v[60:63], v[84:87], a[88:91]
  v_accvgpr_read_b32 v193, a17
  v_permlane16_swap_b32 v188, v190
  v_permlane16_swap_b32 v189, v191
  v_accvgpr_read_b32 v194, a18
  v_accvgpr_read_b32 v195, a19
  v_mul_f32 v192, v10, v192
  v_mfma_f32_16x16x32_bf16 a[152:155], v[56:59], v[72:75], a[152:155]
  s_add_u32 s34, s44, 0
  buffer_store_dwordx4 v[188:191], v128, s[24:27], s34 offen offset:1024 sc1
  v_mfma_f32_16x16x32_bf16 v[136:139], v[132:135], v[188:191], v[136:139]
  v_mul_f32 v193, v10, v193
  v_mul_f32 v194, v10, v194
  v_mul_f32 v195, v10, v195
  v_cvt_pk_bf16_f32 v160, v192, v193
  v_mfma_f32_16x16x32_bf16 a[152:155], v[60:63], v[88:91], a[152:155]
  v_cvt_pk_bf16_f32 v161, v194, v195
  v_accvgpr_read_b32 v196, a20
  v_accvgpr_read_b32 v197, a21
  v_accvgpr_read_b32 v198, a22
  v_accvgpr_read_b32 v199, a23
  v_mul_f32 v196, v10, v196
  v_mfma_f32_16x16x32_bf16 a[216:219], v[56:59], v[76:79], a[216:219]
  v_mul_f32 v197, v10, v197
  v_mul_f32 v198, v10, v198
  v_mul_f32 v199, v10, v199
  v_cvt_pk_bf16_f32 v162, v196, v197
  v_cvt_pk_bf16_f32 v163, v198, v199
  v_accvgpr_read_b32 v200, a80
  v_mfma_f32_16x16x32_bf16 a[216:219], v[60:63], v[92:95], a[216:219]
  v_accvgpr_read_b32 v201, a81
  v_permlane16_swap_b32 v160, v162
  v_permlane16_swap_b32 v161, v163
  v_accvgpr_read_b32 v202, a82
  v_accvgpr_read_b32 v203, a83
  v_mul_f32 v200, v11, v200
  v_mfma_f32_16x16x32_bf16 v[120:123], v[56:59], v[16:19], v[120:123]
  s_add_u32 s34, s41, 0
  buffer_store_dwordx4 v[160:163], v128, s[24:27], s34 offen offset:2048 sc1
  v_mfma_f32_16x16x32_bf16 v[136:139], v[132:135], v[160:163], v[136:139]
  v_mul_f32 v201, v11, v201
  v_mul_f32 v202, v11, v202
  v_mul_f32 v203, v11, v203
  v_cvt_pk_bf16_f32 v164, v200, v201
  v_mfma_f32_16x16x32_bf16 v[120:123], v[60:63], v[20:23], v[120:123]
  v_cvt_pk_bf16_f32 v165, v202, v203
  v_accvgpr_read_b32 v204, a84
  v_accvgpr_read_b32 v205, a85
  v_accvgpr_read_b32 v206, a86
  v_accvgpr_read_b32 v207, a87
  v_mul_f32 v204, v11, v204
  s_waitcnt lgkmcnt(2)
  v_mfma_f32_16x16x32_bf16 a[28:31], v[24:27], v[64:67], a[28:31]
  v_mul_f32 v205, v11, v205
  v_mul_f32 v206, v11, v206
  v_mul_f32 v207, v11, v207
  v_cvt_pk_bf16_f32 v166, v204, v205
  v_cvt_pk_bf16_f32 v167, v206, v207
  v_accvgpr_read_b32 v208, a144
  s_waitcnt lgkmcnt(0)
  v_mfma_f32_16x16x32_bf16 a[28:31], v[28:31], v[80:83], a[28:31]
  v_accvgpr_read_b32 v209, a145
  v_permlane16_swap_b32 v164, v166
  v_permlane16_swap_b32 v165, v167
  v_accvgpr_read_b32 v210, a146
  v_accvgpr_read_b32 v211, a147
  v_mul_f32 v208, v12, v208
  v_mfma_f32_16x16x32_bf16 a[92:95], v[24:27], v[68:71], a[92:95]
  s_add_u32 s34, s42, 0
  buffer_store_dwordx4 v[164:167], v128, s[24:27], s34 offen offset:2048 sc1
  v_mfma_f32_16x16x32_bf16 v[136:139], v[132:135], v[164:167], v[136:139]
  v_mul_f32 v209, v12, v209
  v_mul_f32 v210, v12, v210
  v_mul_f32 v211, v12, v211
  v_cvt_pk_bf16_f32 v168, v208, v209
  v_mfma_f32_16x16x32_bf16 a[92:95], v[28:31], v[84:87], a[92:95]
  v_cvt_pk_bf16_f32 v169, v210, v211
  v_accvgpr_read_b32 v212, a148
  v_accvgpr_read_b32 v213, a149
  v_accvgpr_read_b32 v214, a150
  v_accvgpr_read_b32 v215, a151
  v_mul_f32 v212, v12, v212
  v_mfma_f32_16x16x32_bf16 a[156:159], v[24:27], v[72:75], a[156:159]
  v_mul_f32 v213, v12, v213
  v_mul_f32 v214, v12, v214
  v_mul_f32 v215, v12, v215
  v_cvt_pk_bf16_f32 v170, v212, v213
  v_cvt_pk_bf16_f32 v171, v214, v215
  v_accvgpr_read_b32 v216, a208
  v_mfma_f32_16x16x32_bf16 a[156:159], v[28:31], v[88:91], a[156:159]
  v_accvgpr_read_b32 v217, a209
  v_permlane16_swap_b32 v168, v170
  v_permlane16_swap_b32 v169, v171
  v_accvgpr_read_b32 v218, a210
  v_accvgpr_read_b32 v219, a211
  v_mul_f32 v216, v13, v216
  v_mfma_f32_16x16x32_bf16 a[220:223], v[24:27], v[76:79], a[220:223]
  s_add_u32 s34, s43, 0
  buffer_store_dwordx4 v[168:171], v128, s[24:27], s34 offen offset:2048 sc1
  v_mfma_f32_16x16x32_bf16 v[136:139], v[132:135], v[168:171], v[136:139]
  v_mul_f32 v217, v13, v217
  v_mul_f32 v218, v13, v218
  v_mul_f32 v219, v13, v219
  v_cvt_pk_bf16_f32 v172, v216, v217
  v_mfma_f32_16x16x32_bf16 a[220:223], v[28:31], v[92:95], a[220:223]
  v_cvt_pk_bf16_f32 v173, v218, v219
  v_accvgpr_read_b32 v220, a212
  v_accvgpr_read_b32 v221, a213
  v_accvgpr_read_b32 v222, a214
  v_accvgpr_read_b32 v223, a215
  v_mul_f32 v220, v13, v220
  v_mfma_f32_16x16x32_bf16 v[124:127], v[24:27], v[16:19], v[124:127]
  v_mul_f32 v221, v13, v221
  v_mul_f32 v222, v13, v222
  v_mul_f32 v223, v13, v223
  v_cvt_pk_bf16_f32 v174, v220, v221
  v_cvt_pk_bf16_f32 v175, v222, v223
  ds_read_b32 v140, v9 offset:10244
  v_mfma_f32_16x16x32_bf16 v[124:127], v[28:31], v[20:23], v[124:127]
  s_waitcnt lgkmcnt(0)
  v_add_f32 v14, v14, v140
  v_cmp_nge_f32 vcc, s3, v14
  s_nop 0
  s_or_b64 s[52:53], s[52:53], vcc
  v_cmp_nle_f32 vcc, s4, v14
  s_nop 0
  s_or_b64 s[52:53], s[52:53], vcc
  v_rcp_f32 v14, v14
  s_nop 0
  v_mul_f32 v192, v14, v96
  v_mul_f32 v193, v14, v97
  v_permlane16_swap_b32 v172, v174
  v_permlane16_swap_b32 v173, v175
  v_mul_f32 v194, v14, v98
  v_mul_f32 v195, v14, v99
  v_cvt_pk_bf16_f32 v176, v192, v193
  s_add_u32 s34, s44, 0
  buffer_store_dwordx4 v[172:175], v128, s[24:27], s34 offen offset:2048 sc1
  v_mfma_f32_16x16x32_bf16 v[136:139], v[132:135], v[172:175], v[136:139]
  v_cvt_pk_bf16_f32 v177, v194, v195
  v_mul_f32 v196, v14, v100
  v_mul_f32 v197, v14, v101
  v_mul_f32 v198, v14, v102
  v_mul_f32 v199, v14, v103
  v_cvt_pk_bf16_f32 v178, v196, v197
  v_cvt_pk_bf16_f32 v179, v198, v199
  v_mul_f32 v200, v14, v104
  v_mul_f32 v201, v14, v105
  v_permlane16_swap_b32 v176, v178
  v_permlane16_swap_b32 v177, v179
  v_mul_f32 v202, v14, v106
  v_mul_f32 v203, v14, v107
  v_cvt_pk_bf16_f32 v180, v200, v201
  s_add_u32 s34, s45, 0
  buffer_store_dwordx4 v[176:179], v128, s[24:27], s34 offen offset:0 sc1
  v_mfma_f32_16x16x32_bf16 v[136:139], v[132:135], v[176:179], v[136:139]
  v_cvt_pk_bf16_f32 v181, v202, v203
  v_mul_f32 v204, v14, v108
  v_mul_f32 v205, v14, v109
  v_mul_f32 v206, v14, v110
  v_mul_f32 v207, v14, v111
  v_cvt_pk_bf16_f32 v182, v204, v205
  v_cvt_pk_bf16_f32 v183, v206, v207
  v_mul_f32 v208, v14, v112
  v_mul_f32 v209, v14, v113
  v_permlane16_swap_b32 v180, v182
  v_permlane16_swap_b32 v181, v183
  v_mul_f32 v210, v14, v114
  v_mul_f32 v211, v14, v115
  v_cvt_pk_bf16_f32 v184, v208, v209
  s_add_u32 s34, s45, 0
  buffer_store_dwordx4 v[180:183], v128, s[24:27], s34 offen offset:1024 sc1
  v_mfma_f32_16x16x32_bf16 v[136:139], v[132:135], v[180:183], v[136:139]
  v_cvt_pk_bf16_f32 v185, v210, v211
  v_mul_f32 v212, v14, v116
  v_mul_f32 v213, v14, v117
  v_mul_f32 v214, v14, v118
  v_mul_f32 v215, v14, v119
  v_cvt_pk_bf16_f32 v186, v212, v213
  v_cvt_pk_bf16_f32 v187, v214, v215
  v_accvgpr_read_b32 v216, a24
  v_accvgpr_read_b32 v217, a25
  v_permlane16_swap_b32 v184, v186
  v_permlane16_swap_b32 v185, v187
  v_accvgpr_read_b32 v218, a26
  v_accvgpr_read_b32 v219, a27
  v_mul_f32 v216, v10, v216
  s_add_u32 s34, s45, 0
  buffer_store_dwordx4 v[184:187], v128, s[24:27], s34 offen offset:2048 sc1
  v_mfma_f32_16x16x32_bf16 v[136:139], v[132:135], v[184:187], v[136:139]
  v_mul_f32 v217, v10, v217
  v_mul_f32 v218, v10, v218
  v_mul_f32 v219, v10, v219
  v_cvt_pk_bf16_f32 v188, v216, v217
  v_cvt_pk_bf16_f32 v189, v218, v219
  v_accvgpr_read_b32 v220, a28
  v_accvgpr_read_b32 v221, a29
  v_accvgpr_read_b32 v222, a30
  v_accvgpr_read_b32 v223, a31
  v_mul_f32 v220, v10, v220
  v_mul_f32 v221, v10, v221
  v_mul_f32 v222, v10, v222
  v_mul_f32 v223, v10, v223
  v_cvt_pk_bf16_f32 v190, v220, v221
  v_cvt_pk_bf16_f32 v191, v222, v223
  v_accvgpr_read_b32 v192, a88
  v_accvgpr_read_b32 v193, a89
  v_permlane16_swap_b32 v188, v190
  v_permlane16_swap_b32 v189, v191
  v_accvgpr_read_b32 v194, a90
  v_accvgpr_read_b32 v195, a91
  v_mul_f32 v192, v11, v192
  s_add_u32 s34, s41, 0
  buffer_store_dwordx4 v[188:191], v128, s[24:27], s34 offen offset:3072 sc1
  v_mfma_f32_16x16x32_bf16 v[136:139], v[132:135], v[188:191], v[136:139]
  v_mul_f32 v193, v11, v193
  v_mul_f32 v194, v11, v194
  v_mul_f32 v195, v11, v195
  v_cvt_pk_bf16_f32 v160, v192, v193
  v_cvt_pk_bf16_f32 v161, v194, v195
  v_accvgpr_read_b32 v196, a92
  v_accvgpr_read_b32 v197, a93
  v_accvgpr_read_b32 v198, a94
  v_accvgpr_read_b32 v199, a95
  v_mul_f32 v196, v11, v196
  v_mul_f32 v197, v11, v197
  v_mul_f32 v198, v11, v198
  v_mul_f32 v199, v11, v199
  v_cvt_pk_bf16_f32 v162, v196, v197
  v_cvt_pk_bf16_f32 v163, v198, v199
  v_accvgpr_read_b32 v200, a152
  v_accvgpr_read_b32 v201, a153
  v_permlane16_swap_b32 v160, v162
  v_permlane16_swap_b32 v161, v163
  v_accvgpr_read_b32 v202, a154
  v_accvgpr_read_b32 v203, a155
  v_mul_f32 v200, v12, v200
  s_add_u32 s34, s42, 0
  buffer_store_dwordx4 v[160:163], v128, s[24:27], s34 offen offset:3072 sc1
  v_mfma_f32_16x16x32_bf16 v[136:139], v[132:135], v[160:163], v[136:139]
  v_mul_f32 v201, v12, v201
  v_mul_f32 v202, v12, v202
  v_mul_f32 v203, v12, v203
  v_cvt_pk_bf16_f32 v164, v200, v201
  v_cvt_pk_bf16_f32 v165, v202, v203
  v_accvgpr_read_b32 v204, a156
  v_accvgpr_read_b32 v205, a157
  v_accvgpr_read_b32 v206, a158
  v_accvgpr_read_b32 v207, a159
  v_mul_f32 v204, v12, v204
  v_mul_f32 v205, v12, v205
  v_mul_f32 v206, v12, v206
  v_mul_f32 v207, v12, v207
  v_cvt_pk_bf16_f32 v166, v204, v205
  v_cvt_pk_bf16_f32 v167, v206, v207
  v_accvgpr_read_b32 v208, a216
  v_accvgpr_read_b32 v209, a217
  v_permlane16_swap_b32 v164, v166
  v_permlane16_swap_b32 v165, v167
  v_accvgpr_read_b32 v210, a218
  v_accvgpr_read_b32 v211, a219
  v_mul_f32 v208, v13, v208
  s_add_u32 s34, s43, 0
  buffer_store_dwordx4 v[164:167], v128, s[24:27], s34 offen offset:3072 sc1
  v_mfma_f32_16x16x32_bf16 v[136:139], v[132:135], v[164:167], v[136:139]
  v_mul_f32 v209, v13, v209
  v_mul_f32 v210, v13, v210
  v_mul_f32 v211, v13, v211
  v_cvt_pk_bf16_f32 v168, v208, v209
  v_cvt_pk_bf16_f32 v169, v210, v211
  v_accvgpr_read_b32 v212, a220
  v_accvgpr_read_b32 v213, a221
  v_accvgpr_read_b32 v214, a222
  v_accvgpr_read_b32 v215, a223
  v_mul_f32 v212, v13, v212
  v_mul_f32 v213, v13, v213
  v_mul_f32 v214, v13, v214
  v_mul_f32 v215, v13, v215
  v_cvt_pk_bf16_f32 v170, v212, v213
  v_cvt_pk_bf16_f32 v171, v214, v215
  v_mul_f32 v216, v14, v120
  v_mul_f32 v217, v14, v121
  v_permlane16_swap_b32 v168, v170
  v_permlane16_swap_b32 v169, v171
  v_mul_f32 v218, v14, v122
  v_mul_f32 v219, v14, v123
  v_cvt_pk_bf16_f32 v172, v216, v217
  s_add_u32 s34, s44, 0
  buffer_store_dwordx4 v[168:171], v128, s[24:27], s34 offen offset:3072 sc1
  v_mfma_f32_16x16x32_bf16 v[136:139], v[132:135], v[168:171], v[136:139]
  v_cvt_pk_bf16_f32 v173, v218, v219
  v_mul_f32 v220, v14, v124
  v_mul_f32 v221, v14, v125
  v_mul_f32 v222, v14, v126
  v_mul_f32 v223, v14, v127
  v_cvt_pk_bf16_f32 v174, v220, v221
  v_cvt_pk_bf16_f32 v175, v222, v223
  s_nop 0
  v_permlane16_swap_b32 v172, v174
  v_permlane16_swap_b32 v173, v175
  s_add_u32 s34, s45, 0
  buffer_store_dwordx4 v[172:175], v128, s[24:27], s34 offen offset:3072 sc1
  v_mfma_f32_16x16x32_bf16 v[136:139], v[132:135], v[172:175], v[136:139]
  s_nop 7
  v_cmp_u_f32 vcc, v136, v136
  s_nop 1
  s_or_b64 s[52:53], s[52:53], vcc
  s_cmp_lg_u64 s[52:53], 0
  s_cselect_b32 s3, 1, 0
  v_mov_b32 v15, s3
  s_lshl_b32 s4, s28, 2
  s_add_u32 s4, s4, 142336
  v_mov_b32 v16, s4
  ds_write_b32 v16, v15 offset:0
  s_waitcnt lgkmcnt(0)
  s_barrier
  v_mov_b32 v16, 142336
  ds_read_b128 v[20:23], v16 offset:0
  s_waitcnt lgkmcnt(0)
  v_or_b32 v20, v20, v21
  v_or3_b32 v20, v20, v22, v23
  s_nop 0
  v_readfirstlane_b32 s3, v20
  s_nop 1
  s_cmp_lg_u32 s3, 0
  s_cbranch_scc1 K1_REDO
  s_branch K1_END
K1_PAR1:
  s_waitcnt vmcnt(36)
  s_barrier
  ds_read_b64_tr_b16 v[40:41], v3 offset:0
  ds_read_b64_tr_b16 v[42:43], v3 offset:512
  ds_read_b64_tr_b16 v[44:45], v3 offset:4096
  ds_read_b64_tr_b16 v[46:47], v3 offset:4608
  ds_read_b64_tr_b16 v[48:49], v4 offset:0
  ds_read_b64_tr_b16 v[50:51], v4 offset:512
  ds_read_b64_tr_b16 v[52:53], v4 offset:4096
  ds_read_b64_tr_b16 v[54:55], v4 offset:4608
  ds_read_b64_tr_b16 v[56:57], v5 offset:0
  ds_read_b64_tr_b16 v[58:59], v5 offset:512
  ds_read_b64_tr_b16 v[60:61], v5 offset:4096
  ds_read_b64_tr_b16 v[62:63], v5 offset:4608
  s_waitcnt vmcnt(35) lgkmcnt(10)
  v_mfma_f32_16x16x32_bf16 a[0:3], v[40:43], v[128:131], 0
  s_waitcnt vmcnt(34) lgkmcnt(8)
  v_mfma_f32_16x16x32_bf16 a[0:3], v[44:47], v[132:135], a[0:3]
  s_add_u32 m0, s35, 98304
  s_add_u32 s34, s50, 1572864
  buffer_load_dwordx4 v10, s[16:19], s34 offen lds
  s_waitcnt vmcnt(34)
  v_mfma_f32_16x16x32_bf16 a[64:67], v[40:43], v[136:139], 0
  s_waitcnt vmcnt(33)
  v_mfma_f32_16x16x32_bf16 a[64:67], v[44:47], v[140:143], a[64:67]
  s_waitcnt vmcnt(32)
  v_mfma_f32_16x16x32_bf16 a[128:131], v[40:43], v[144:147], 0
  s_waitcnt vmcnt(31)
  v_mfma_f32_16x16x32_bf16 a[128:131], v[44:47], v[148:151], a[128:131]
  s_waitcnt vmcnt(30)
  v_mfma_f32_16x16x32_bf16 a[192:195], v[40:43], v[152:155], 0
  s_waitcnt vmcnt(29)
  v_mfma_f32_16x16x32_bf16 a[192:195], v[44:47], v[156:159], a[192:195]
  ds_read_b64_tr_b16 v[24:25], v6 offset:0
  ds_read_b64_tr_b16 v[26:27], v6 offset:512
  s_waitcnt lgkmcnt(8)
  v_mfma_f32_16x16x32_bf16 a[4:7], v[48:51], v[128:131], 0
  ds_read_b64_tr_b16 v[28:29], v6 offset:4096
  ds_read_b64_tr_b16 v[30:31], v6 offset:4608
  s_waitcnt lgkmcnt(8)
  v_mfma_f32_16x16x32_bf16 a[4:7], v[52:55], v[132:135], a[4:7]
  buffer_load_dwordx4 v[208:211], v12, s[20:23], s36 offen offset:256
  v_mfma_f32_16x16x32_bf16 a[68:71], v[48:51], v[136:139], 0
  v_mfma_f32_16x16x32_bf16 a[68:71], v[52:55], v[140:143], a[68:71]
  v_mfma_f32_16x16x32_bf16 a[132:135], v[48:51], v[144:147], 0
  v_mfma_f32_16x16x32_bf16 a[132:135], v[52:55], v[148:151], a[132:135]
  s_add_u32 m0, s35, 99328
  s_add_u32 s34, s50, 1638400
  buffer_load_dwordx4 v11, s[16:19], s34 offen lds
  v_mfma_f32_16x16x32_bf16 a[196:199], v[48:51], v[152:155], 0
  v_mfma_f32_16x16x32_bf16 a[196:199], v[52:55], v[156:159], a[196:199]
  ds_read_b64_tr_b16 v[32:33], v3 offset:8192
  ds_read_b64_tr_b16 v[34:35], v3 offset:8704
  s_waitcnt lgkmcnt(8)
  v_mfma_f32_16x16x32_bf16 a[8:11], v[56:59], v[128:131], 0
  ds_read_b64_tr_b16 v[36:37], v3 offset:12288
  ds_read_b64_tr_b16 v[38:39], v3 offset:12800
  s_waitcnt lgkmcnt(8)
  v_mfma_f32_16x16x32_bf16 a[8:11], v[60:63], v[132:135], a[8:11]
  v_mfma_f32_16x16x32_bf16 a[72:75], v[56:59], v[136:139], 0
  v_mfma_f32_16x16x32_bf16 a[72:75], v[60:63], v[140:143], a[72:75]
  v_mfma_f32_16x16x32_bf16 a[136:139], v[56:59], v[144:147], 0
  buffer_load_dwordx4 v[212:215], v12, s[20:23], s36 offen offset:320
  v_mfma_f32_16x16x32_bf16 a[136:139], v[60:63], v[148:151], a[136:139]
  v_mfma_f32_16x16x32_bf16 a[200:203], v[56:59], v[152:155], 0
  v_mfma_f32_16x16x32_bf16 a[200:203], v[60:63], v[156:159], a[200:203]
  ds_read_b64_tr_b16 v[48:49], v4 offset:8192
  ds_read_b64_tr_b16 v[50:51], v4 offset:8704
  s_waitcnt lgkmcnt(8)
  v_mfma_f32_16x16x32_bf16 a[12:15], v[24:27], v[128:131], 0
  ds_read_b64_tr_b16 v[52:53], v4 offset:12288
  ds_read_b64_tr_b16 v[54:55], v4 offset:12800
  s_waitcnt lgkmcnt(8)
  v_mfma_f32_16x16x32_bf16 a[12:15], v[28:31], v[132:135], a[12:15]
  s_add_u32 m0, s35, 100352
  s_add_u32 s34, s50, 1703936
  buffer_load_dwordx4 v10, s[16:19], s34 offen lds
  v_mfma_f32_16x16x32_bf16 a[76:79], v[24:27], v[136:139], 0
  v_mfma_f32_16x16x32_bf16 a[76:79], v[28:31], v[140:143], a[76:79]
  v_mfma_f32_16x16x32_bf16 a[140:143], v[24:27], v[144:147], 0
  v_mfma_f32_16x16x32_bf16 a[140:143], v[28:31], v[148:151], a[140:143]
  v_mfma_f32_16x16x32_bf16 a[204:207], v[24:27], v[152:155], 0
  v_mfma_f32_16x16x32_bf16 a[204:207], v[28:31], v[156:159], a[204:207]
  ds_read_b64_tr_b16 v[56:57], v5 offset:8192
  ds_read_b64_tr_b16 v[58:59], v5 offset:8704
  s_waitcnt lgkmcnt(8)
  v_mfma_f32_16x16x32_bf16 a[16:19], v[32:35], v[128:131], 0
  ds_read_b64_tr_b16 v[60:61], v5 offset:12288
  ds_read_b64_tr_b16 v[62:63], v5 offset:12800
  s_waitcnt lgkmcnt(8)
  v_mfma_f32_16x16x32_bf16 a[16:19], v[36:39], v[132:135], a[16:19]
  buffer_load_dwordx4 v[216:219], v12, s[20:23], s37 offen offset:256
  v_mfma_f32_16x16x32_bf16 a[80:83], v[32:35], v[136:139], 0
  v_mfma_f32_16x16x32_bf16 a[80:83], v[36:39], v[140:143], a[80:83]
  v_mfma_f32_16x16x32_bf16 a[144:147], v[32:35], v[144:147], 0
  v_mfma_f32_16x16x32_bf16 a[144:147], v[36:39], v[148:151], a[144:147]
  s_add_u32 m0, s35, 101376
  s_add_u32 s34, s50, 1769472
  buffer_load_dwordx4 v11, s[16:19], s34 offen lds
  v_mfma_f32_16x16x32_bf16 a[208:211], v[32:35], v[152:155], 0
  v_mfma_f32_16x16x32_bf16 a[208:211], v[36:39], v[156:159], a[208:211]
  ds_read_b64_tr_b16 v[40:41], v6 offset:8192
  ds_read_b64_tr_b16 v[42:43], v6 offset:8704
  s_waitcnt lgkmcnt(8)
  v_mfma_f32_16x16x32_bf16 a[20:23], v[48:51], v[128:131], 0
  ds_read_b64_tr_b16 v[44:45], v6 offset:12288
  ds_read_b64_tr_b16 v[46:47], v6 offset:12800
  s_waitcnt lgkmcnt(8)
  v_mfma_f32_16x16x32_bf16 a[20:23], v[52:55], v[132:135], a[20:23]
  v_mfma_f32_16x16x32_bf16 a[84:87], v[48:51], v[136:139], 0
  v_mfma_f32_16x16x32_bf16 a[84:87], v[52:55], v[140:143], a[84:87]
  v_mfma_f32_16x16x32_bf16 a[148:151], v[48:51], v[144:147], 0
  v_mfma_f32_16x16x32_bf16 a[148:151], v[52:55], v[148:151], a[148:151]
  v_mfma_f32_16x16x32_bf16 a[212:215], v[48:51], v[152:155], 0
  buffer_load_dwordx4 v[220:223], v12, s[20:23], s37 offen offset:320
  v_mfma_f32_16x16x32_bf16 a[212:215], v[52:55], v[156:159], a[212:215]
  ds_read_b64_tr_b16 v[24:25], v3 offset:16384
  ds_read_b64_tr_b16 v[26:27], v3 offset:16896
  s_waitcnt lgkmcnt(8)
  v_mfma_f32_16x16x32_bf16 a[24:27], v[56:59], v[128:131], 0
  ds_read_b64_tr_b16 v[28:29], v3 offset:20480
  ds_read_b64_tr_b16 v[30:31], v3 offset:20992
  s_waitcnt lgkmcnt(8)
  v_mfma_f32_16x16x32_bf16 a[24:27], v[60:63], v[132:135], a[24:27]
  s_add_u32 m0, s35, 102400
  s_add_u32 s34, s50, 1835008
  buffer_load_dwordx4 v10, s[16:19], s34 offen lds
  v_mfma_f32_16x16x32_bf16 a[88:91], v[56:59], v[136:139], 0
  v_mfma_f32_16x16x32_bf16 a[88:91], v[60:63], v[140:143], a[88:91]
  v_mfma_f32_16x16x32_bf16 a[152:155], v[56:59], v[144:147], 0
  v_mfma_f32_16x16x32_bf16 a[152:155], v[60:63], v[148:151], a[152:155]
  v_mfma_f32_16x16x32_bf16 a[216:219], v[56:59], v[152:155], 0
  v_mfma_f32_16x16x32_bf16 a[216:219], v[60:63], v[156:159], a[216:219]
  ds_read_b64_tr_b16 v[48:49], v4 offset:16384
  ds_read_b64_tr_b16 v[50:51], v4 offset:16896
  s_waitcnt lgkmcnt(8)
  v_mfma_f32_16x16x32_bf16 a[28:31], v[40:43], v[128:131], 0
  ds_read_b64_tr_b16 v[52:53], v4 offset:20480
  ds_read_b64_tr_b16 v[54:55], v4 offset:20992
  s_waitcnt lgkmcnt(8)
  v_mfma_f32_16x16x32_bf16 a[28:31], v[44:47], v[132:135], a[28:31]
  v_mfma_f32_16x16x32_bf16 a[92:95], v[40:43], v[136:139], 0
  v_mfma_f32_16x16x32_bf16 a[92:95], v[44:47], v[140:143], a[92:95]
  buffer_load_dwordx4 v[224:227], v12, s[20:23], s38 offen offset:256
  v_mfma_f32_16x16x32_bf16 a[156:159], v[40:43], v[144:147], 0
  v_mfma_f32_16x16x32_bf16 a[156:159], v[44:47], v[148:151], a[156:159]
  s_add_u32 m0, s35, 103424
  s_add_u32 s34, s50, 1900544
  buffer_load_dwordx4 v11, s[16:19], s34 offen lds
  v_mfma_f32_16x16x32_bf16 a[220:223], v[40:43], v[152:155], 0
  v_mfma_f32_16x16x32_bf16 a[220:223], v[44:47], v[156:159], a[220:223]
  ds_read_b64_tr_b16 v[56:57], v5 offset:16384
  ds_read_b64_tr_b16 v[58:59], v5 offset:16896
  s_waitcnt lgkmcnt(8)
  v_mfma_f32_16x16x32_bf16 a[32:35], v[24:27], v[128:131], 0
  ds_read_b64_tr_b16 v[60:61], v5 offset:20480
  ds_read_b64_tr_b16 v[62:63], v5 offset:20992
  s_waitcnt lgkmcnt(8)
  v_mfma_f32_16x16x32_bf16 a[32:35], v[28:31], v[132:135], a[32:35]
  v_mfma_f32_16x16x32_bf16 a[96:99], v[24:27], v[136:139], 0
  v_mfma_f32_16x16x32_bf16 a[96:99], v[28:31], v[140:143], a[96:99]
  v_mfma_f32_16x16x32_bf16 a[160:163], v[24:27], v[144:147], 0
  v_mfma_f32_16x16x32_bf16 a[160:163], v[28:31], v[148:151], a[160:163]
  v_mfma_f32_16x16x32_bf16 a[224:227], v[24:27], v[152:155], 0
  v_mfma_f32_16x16x32_bf16 a[224:227], v[28:31], v[156:159], a[224:227]
  s_waitcnt vmcnt(38)
  v_mfma_f32_16x16x32_bf16 v[96:99], v[24:27], v[160:163], 0
  buffer_load_dwordx4 v[228:231], v12, s[20:23], s38 offen offset:320
  s_waitcnt vmcnt(38)
  v_mfma_f32_16x16x32_bf16 v[96:99], v[28:31], v[164:167], v[96:99]
  s_add_u32 m0, s35, 104448
  s_add_u32 s34, s50, 1966080
  buffer_load_dwordx4 v10, s[16:19], s34 offen lds
  s_waitcnt lgkmcnt(6)
  v_mfma_f32_16x16x32_bf16 a[36:39], v[48:51], v[128:131], 0
  ds_read_b64_tr_b16 v[32:33], v6 offset:16384
  ds_read_b64_tr_b16 v[34:35], v6 offset:16896
  s_waitcnt lgkmcnt(6)
  v_mfma_f32_16x16x32_bf16 a[36:39], v[52:55], v[132:135], a[36:39]
  ds_read_b64_tr_b16 v[36:37], v6 offset:20480
  ds_read_b64_tr_b16 v[38:39], v6 offset:20992
  v_mfma_f32_16x16x32_bf16 a[100:103], v[48:51], v[136:139], 0
  v_mfma_f32_16x16x32_bf16 a[100:103], v[52:55], v[140:143], a[100:103]
  v_mfma_f32_16x16x32_bf16 a[164:167], v[48:51], v[144:147], 0
  v_mfma_f32_16x16x32_bf16 a[164:167], v[52:55], v[148:151], a[164:167]
  v_mfma_f32_16x16x32_bf16 a[228:231], v[48:51], v[152:155], 0
  v_mfma_f32_16x16x32_bf16 a[228:231], v[52:55], v[156:159], a[228:231]
  v_mfma_f32_16x16x32_bf16 v[100:103], v[48:51], v[160:163], 0
  v_mfma_f32_16x16x32_bf16 v[100:103], v[52:55], v[164:167], v[100:103]
  ds_read_b64_tr_b16 v[40:41], v3 offset:24576
  ds_read_b64_tr_b16 v[42:43], v3 offset:25088
  s_waitcnt lgkmcnt(8)
  v_mfma_f32_16x16x32_bf16 a[40:43], v[56:59], v[128:131], 0
  ds_read_b64_tr_b16 v[44:45], v3 offset:28672
  ds_read_b64_tr_b16 v[46:47], v3 offset:29184
  s_waitcnt lgkmcnt(8)
  v_mfma_f32_16x16x32_bf16 a[40:43], v[60:63], v[132:135], a[40:43]
  s_add_u32 m0, s35, 105472
  s_add_u32 s34, s50, 2031616
  buffer_load_dwordx4 v11, s[16:19], s34 offen lds
  v_mfma_f32_16x16x32_bf16 a[104:107], v[56:59], v[136:139], 0
  buffer_load_dwordx4 v[232:235], v12, s[20:23], s39 offen offset:256
  v_mfma_f32_16x16x32_bf16 a[104:107], v[60:63], v[140:143], a[104:107]
  v_mfma_f32_16x16x32_bf16 a[168:171], v[56:59], v[144:147], 0
  v_mfma_f32_16x16x32_bf16 a[168:171], v[60:63], v[148:151], a[168:171]
  v_mfma_f32_16x16x32_bf16 a[232:235], v[56:59], v[152:155], 0
  v_mfma_f32_16x16x32_bf16 a[232:235], v[60:63], v[156:159], a[232:235]
  v_mfma_f32_16x16x32_bf16 v[104:107], v[56:59], v[160:163], 0
  v_mfma_f32_16x16x32_bf16 v[104:107], v[60:63], v[164:167], v[104:107]
  ds_read_b64_tr_b16 v[48:49], v4 offset:24576
  ds_read_b64_tr_b16 v[50:51], v4 offset:25088
  s_waitcnt lgkmcnt(8)
  v_mfma_f32_16x16x32_bf16 a[44:47], v[32:35], v[128:131], 0
  s_waitcnt vmcnt(33)
  s_barrier
  ds_read_b64_tr_b16 v[52:53], v4 offset:28672
  s_waitcnt lgkmcnt(7)
  v_mfma_f32_16x16x32_bf16 a[44:47], v[36:39], v[132:135], a[44:47]
  ds_read_b64_tr_b16 v[54:55], v4 offset:29184
  v_mfma_f32_16x16x32_bf16 a[108:111], v[32:35], v[136:139], 0
  v_mfma_f32_16x16x32_bf16 a[108:111], v[36:39], v[140:143], a[108:111]
  v_mfma_f32_16x16x32_bf16 a[172:175], v[32:35], v[144:147], 0
  buffer_load_dwordx4 v[236:239], v12, s[20:23], s39 offen offset:320
  v_mfma_f32_16x16x32_bf16 a[172:175], v[36:39], v[148:151], a[172:175]
  v_mfma_f32_16x16x32_bf16 a[236:239], v[32:35], v[152:155], 0
  v_mfma_f32_16x16x32_bf16 a[236:239], v[36:39], v[156:159], a[236:239]
  v_mfma_f32_16x16x32_bf16 v[108:111], v[32:35], v[160:163], 0
  v_mfma_f32_16x16x32_bf16 v[108:111], v[36:39], v[164:167], v[108:111]
  ds_read_b64_tr_b16 v[56:57], v5 offset:24576
  ds_read_b64_tr_b16 v[58:59], v5 offset:25088
  s_waitcnt lgkmcnt(8)
  v_mfma_f32_16x16x32_bf16 a[48:51], v[40:43], v[128:131], 0
  ds_read_b64_tr_b16 v[60:61], v5 offset:28672
  ds_read_b64_tr_b16 v[62:63], v5 offset:29184
  s_waitcnt lgkmcnt(8)
  v_mfma_f32_16x16x32_bf16 a[48:51], v[44:47], v[132:135], a[48:51]
  v_mfma_f32_16x16x32_bf16 a[112:115], v[40:43], v[136:139], 0
  v_mfma_f32_16x16x32_bf16 a[112:115], v[44:47], v[140:143], a[112:115]
  v_mfma_f32_16x16x32_bf16 a[176:179], v[40:43], v[144:147], 0
  v_mfma_f32_16x16x32_bf16 a[176:179], v[44:47], v[148:151], a[176:179]
  v_mfma_f32_16x16x32_bf16 a[240:243], v[40:43], v[152:155], 0
  v_mfma_f32_16x16x32_bf16 a[240:243], v[44:47], v[156:159], a[240:243]
  buffer_load_dwordx4 v[240:243], v12, s[20:23], s40 offen offset:256
  v_mfma_f32_16x16x32_bf16 v[112:115], v[40:43], v[160:163], 0
  v_mfma_f32_16x16x32_bf16 v[112:115], v[44:47], v[164:167], v[112:115]
  ds_read_b64_tr_b16 v[24:25], v6 offset:24576
  ds_read_b64_tr_b16 v[26:27], v6 offset:25088
  s_waitcnt lgkmcnt(8)
  v_mfma_f32_16x16x32_bf16 a[52:55], v[48:51], v[128:131], 0
  ds_read_b64_tr_b16 v[28:29], v6 offset:28672
  ds_read_b64_tr_b16 v[30:31], v6 offset:29184
  s_waitcnt lgkmcnt(8)
  v_mfma_f32_16x16x32_bf16 a[52:55], v[52:55], v[132:135], a[52:55]
  ds_read_b64_tr_b16 v[40:41], v3 offset:32768
  ds_read_b64_tr_b16 v[42:43], v3 offset:33280
  v_mfma_f32_16x16x32_bf16 a[116:119], v[48:51], v[136:139], 0
  ds_read_b64_tr_b16 v[44:45], v3 offset:36864
  ds_read_b64_tr_b16 v[46:47], v3 offset:37376
  v_mfma_f32_16x16x32_bf16 a[116:119], v[52:55], v[140:143], a[116:119]
  v_mfma_f32_16x16x32_bf16 a[180:183], v[48:51], v[144:147], 0
  v_mfma_f32_16x16x32_bf16 a[180:183], v[52:55], v[148:151], a[180:183]
  v_mfma_f32_16x16x32_bf16 a[244:247], v[48:51], v[152:155], 0
  v_mfma_f32_16x16x32_bf16 a[244:247], v[52:55], v[156:159], a[244:247]
  v_mfma_f32_16x16x32_bf16 v[116:119], v[48:51], v[160:163], 0
  v_mfma_f32_16x16x32_bf16 v[116:119], v[52:55], v[164:167], v[116:119]
  ds_read_b64_tr_b16 v[48:49], v4 offset:32768
  ds_read_b64_tr_b16 v[50:51], v4 offset:33280
  s_waitcnt lgkmcnt(12)
  v_mfma_f32_16x16x32_bf16 a[56:59], v[56:59], v[128:131], 0
  buffer_load_dwordx4 v[244:247], v12, s[20:23], s40 offen offset:320
  ds_read_b64_tr_b16 v[52:53], v4 offset:36864
  s_waitcnt lgkmcnt(11)
  v_mfma_f32_16x16x32_bf16 a[56:59], v[60:63], v[132:135], a[56:59]
  ds_read_b64_tr_b16 v[54:55], v4 offset:37376
  v_mfma_f32_16x16x32_bf16 a[120:123], v[56:59], v[136:139], 0
  v_mfma_f32_16x16x32_bf16 a[120:123], v[60:63], v[140:143], a[120:123]
  v_mfma_f32_16x16x32_bf16 a[184:187], v[56:59], v[144:147], 0
  v_mfma_f32_16x16x32_bf16 a[184:187], v[60:63], v[148:151], a[184:187]
  v_mfma_f32_16x16x32_bf16 a[248:251], v[56:59], v[152:155], 0
  v_mfma_f32_16x16x32_bf16 a[248:251], v[60:63], v[156:159], a[248:251]
  v_mfma_f32_16x16x32_bf16 v[120:123], v[56:59], v[160:163], 0
  v_mfma_f32_16x16x32_bf16 v[120:123], v[60:63], v[164:167], v[120:123]
  ds_read_b64_tr_b16 v[56:57], v5 offset:32768
  ds_read_b64_tr_b16 v[58:59], v5 offset:33280
  s_waitcnt lgkmcnt(12)
  v_mfma_f32_16x16x32_bf16 a[60:63], v[24:27], v[128:131], 0
  ds_read_b64_tr_b16 v[60:61], v5 offset:36864
  ds_read_b64_tr_b16 v[62:63], v5 offset:37376
  s_waitcnt lgkmcnt(12)
  v_mfma_f32_16x16x32_bf16 a[60:63], v[28:31], v[132:135], a[60:63]
  v_mfma_f32_16x16x32_bf16 a[124:127], v[24:27], v[136:139], 0
  v_mfma_f32_16x16x32_bf16 a[124:127], v[28:31], v[140:143], a[124:127]
  v_mfma_f32_16x16x32_bf16 a[188:191], v[24:27], v[144:147], 0
  v_mfma_f32_16x16x32_bf16 a[188:191], v[28:31], v[148:151], a[188:191]
  v_mfma_f32_16x16x32_bf16 a[252:255], v[24:27], v[152:155], 0
  v_mfma_f32_16x16x32_bf16 a[252:255], v[28:31], v[156:159], a[252:255]
  v_mfma_f32_16x16x32_bf16 v[124:127], v[24:27], v[160:163], 0
  v_mfma_f32_16x16x32_bf16 v[124:127], v[28:31], v[164:167], v[124:127]
  s_waitcnt vmcnt(35) lgkmcnt(10)
  v_mfma_f32_16x16x32_bf16 a[0:3], v[40:43], v[168:171], a[0:3]
  s_waitcnt vmcnt(34) lgkmcnt(8)
  v_mfma_f32_16x16x32_bf16 a[0:3], v[44:47], v[172:175], a[0:3]
  s_waitcnt vmcnt(33)
  v_mfma_f32_16x16x32_bf16 a[64:67], v[40:43], v[176:179], a[64:67]
  s_waitcnt vmcnt(32)
  v_mfma_f32_16x16x32_bf16 a[64:67], v[44:47], v[180:183], a[64:67]
  s_waitcnt vmcnt(31)
  v_mfma_f32_16x16x32_bf16 a[128:131], v[40:43], v[184:187], a[128:131]
  s_waitcnt vmcnt(30)
  v_mfma_f32_16x16x32_bf16 a[128:131], v[44:47], v[188:191], a[128:131]
  s_waitcnt vmcnt(29)
  v_mfma_f32_16x16x32_bf16 a[192:195], v[40:43], v[192:195], a[192:195]
  s_waitcnt vmcnt(28)
  v_mfma_f32_16x16x32_bf16 a[192:195], v[44:47], v[196:199], a[192:195]
  ds_read_b64_tr_b16 v[24:25], v6 offset:32768
  ds_read_b64_tr_b16 v[26:27], v6 offset:33280
  s_waitcnt lgkmcnt(8)
  v_mfma_f32_16x16x32_bf16 a[4:7], v[48:51], v[168:171], a[4:7]
  ds_read_b64_tr_b16 v[28:29], v6 offset:36864
  ds_read_b64_tr_b16 v[30:31], v6 offset:37376
  s_waitcnt lgkmcnt(8)
  v_mfma_f32_16x16x32_bf16 a[4:7], v[52:55], v[172:175], a[4:7]
  buffer_load_dwordx4 v[128:131], v12, s[20:23], s36 offen offset:384
  v_mfma_f32_16x16x32_bf16 a[68:71], v[48:51], v[176:179], a[68:71]
  v_mfma_f32_16x16x32_bf16 a[68:71], v[52:55], v[180:183], a[68:71]
  v_mfma_f32_16x16x32_bf16 a[132:135], v[48:51], v[184:187], a[132:135]
  v_mfma_f32_16x16x32_bf16 a[132:135], v[52:55], v[188:191], a[132:135]
  v_mfma_f32_16x16x32_bf16 a[196:199], v[48:51], v[192:195], a[196:199]
  v_mfma_f32_16x16x32_bf16 a[196:199], v[52:55], v[196:199], a[196:199]
  ds_read_b64_tr_b16 v[32:33], v3 offset:40960
  ds_read_b64_tr_b16 v[34:35], v3 offset:41472
  s_waitcnt lgkmcnt(8)
  v_mfma_f32_16x16x32_bf16 a[8:11], v[56:59], v[168:171], a[8:11]
  ds_read_b64_tr_b16 v[36:37], v3 offset:45056
  ds_read_b64_tr_b16 v[38:39], v3 offset:45568
  s_waitcnt lgkmcnt(8)
  v_mfma_f32_16x16x32_bf16 a[8:11], v[60:63], v[172:175], a[8:11]
  v_mfma_f32_16x16x32_bf16 a[72:75], v[56:59], v[176:179], a[72:75]
  v_mfma_f32_16x16x32_bf16 a[72:75], v[60:63], v[180:183], a[72:75]
  v_mfma_f32_16x16x32_bf16 a[136:139], v[56:59], v[184:187], a[136:139]
  buffer_load_dwordx4 v[132:135], v12, s[20:23], s36 offen offset:448
  v_mfma_f32_16x16x32_bf16 a[136:139], v[60:63], v[188:191], a[136:139]
  v_mfma_f32_16x16x32_bf16 a[200:203], v[56:59], v[192:195], a[200:203]
  v_mfma_f32_16x16x32_bf16 a[200:203], v[60:63], v[196:199], a[200:203]
  ds_read_b64_tr_b16 v[48:49], v4 offset:40960
  ds_read_b64_tr_b16 v[50:51], v4 offset:41472
  s_waitcnt lgkmcnt(8)
  v_mfma_f32_16x16x32_bf16 a[12:15], v[24:27], v[168:171], a[12:15]
  ds_read_b64_tr_b16 v[52:53], v4 offset:45056
  ds_read_b64_tr_b16 v[54:55], v4 offset:45568
  s_waitcnt lgkmcnt(8)
  v_mfma_f32_16x16x32_bf16 a[12:15], v[28:31], v[172:175], a[12:15]
  v_mfma_f32_16x16x32_bf16 a[76:79], v[24:27], v[176:179], a[76:79]
  v_mfma_f32_16x16x32_bf16 a[76:79], v[28:31], v[180:183], a[76:79]
  v_mfma_f32_16x16x32_bf16 a[140:143], v[24:27], v[184:187], a[140:143]
  v_mfma_f32_16x16x32_bf16 a[140:143], v[28:31], v[188:191], a[140:143]
  v_mfma_f32_16x16x32_bf16 a[204:207], v[24:27], v[192:195], a[204:207]
  v_mfma_f32_16x16x32_bf16 a[204:207], v[28:31], v[196:199], a[204:207]
  ds_read_b64_tr_b16 v[56:57], v5 offset:40960
  ds_read_b64_tr_b16 v[58:59], v5 offset:41472
  s_waitcnt lgkmcnt(8)
  v_mfma_f32_16x16x32_bf16 a[16:19], v[32:35], v[168:171], a[16:19]
  ds_read_b64_tr_b16 v[60:61], v5 offset:45056
  ds_read_b64_tr_b16 v[62:63], v5 offset:45568
  s_waitcnt lgkmcnt(8)
  v_mfma_f32_16x16x32_bf16 a[16:19], v[36:39], v[172:175], a[16:19]
  buffer_load_dwordx4 v[136:139], v12, s[20:23], s37 offen offset:384
  v_mfma_f32_16x16x32_bf16 a[80:83], v[32:35], v[176:179], a[80:83]
  v_mfma_f32_16x16x32_bf16 a[80:83], v[36:39], v[180:183], a[80:83]
  v_mfma_f32_16x16x32_bf16 a[144:147], v[32:35], v[184:187], a[144:147]
  v_mfma_f32_16x16x32_bf16 a[144:147], v[36:39], v[188:191], a[144:147]
  v_mfma_f32_16x16x32_bf16 a[208:211], v[32:35], v[192:195], a[208:211]
  v_mfma_f32_16x16x32_bf16 a[208:211], v[36:39], v[196:199], a[208:211]
  ds_read_b64_tr_b16 v[40:41], v6 offset:40960
  ds_read_b64_tr_b16 v[42:43], v6 offset:41472
  s_waitcnt lgkmcnt(8)
  v_mfma_f32_16x16x32_bf16 a[20:23], v[48:51], v[168:171], a[20:23]
  ds_read_b64_tr_b16 v[44:45], v6 offset:45056
  ds_read_b64_tr_b16 v[46:47], v6 offset:45568
  s_waitcnt lgkmcnt(8)
  v_mfma_f32_16x16x32_bf16 a[20:23], v[52:55], v[172:175], a[20:23]
  v_mfma_f32_16x16x32_bf16 a[84:87], v[48:51], v[176:179], a[84:87]
  v_mfma_f32_16x16x32_bf16 a[84:87], v[52:55], v[180:183], a[84:87]
  v_mfma_f32_16x16x32_bf16 a[148:151], v[48:51], v[184:187], a[148:151]
  v_mfma_f32_16x16x32_bf16 a[148:151], v[52:55], v[188:191], a[148:151]
  v_mfma_f32_16x16x32_bf16 a[212:215], v[48:51], v[192:195], a[212:215]
  buffer_load_dwordx4 v[140:143], v12, s[20:23], s37 offen offset:448
  v_mfma_f32_16x16x32_bf16 a[212:215], v[52:55], v[196:199], a[212:215]
  ds_read_b64_tr_b16 v[24:25], v3 offset:49152
  ds_read_b64_tr_b16 v[26:27], v3 offset:49664
  s_waitcnt lgkmcnt(8)
  v_mfma_f32_16x16x32_bf16 a[24:27], v[56:59], v[168:171], a[24:27]
  ds_read_b64_tr_b16 v[28:29], v3 offset:53248
  ds_read_b64_tr_b16 v[30:31], v3 offset:53760
  s_waitcnt lgkmcnt(8)
  v_mfma_f32_16x16x32_bf16 a[24:27], v[60:63], v[172:175], a[24:27]
  v_mfma_f32_16x16x32_bf16 a[88:91], v[56:59], v[176:179], a[88:91]
  v_mfma_f32_16x16x32_bf16 a[88:91], v[60:63], v[180:183], a[88:91]
  v_mfma_f32_16x16x32_bf16 a[152:155], v[56:59], v[184:187], a[152:155]
  v_mfma_f32_16x16x32_bf16 a[152:155], v[60:63], v[188:191], a[152:155]
  v_mfma_f32_16x16x32_bf16 a[216:219], v[56:59], v[192:195], a[216:219]
  v_mfma_f32_16x16x32_bf16 a[216:219], v[60:63], v[196:199], a[216:219]
  ds_read_b64_tr_b16 v[48:49], v4 offset:49152
  ds_read_b64_tr_b16 v[50:51], v4 offset:49664
  s_waitcnt lgkmcnt(8)
  v_mfma_f32_16x16x32_bf16 a[28:31], v[40:43], v[168:171], a[28:31]
  ds_read_b64_tr_b16 v[52:53], v4 offset:53248
  ds_read_b64_tr_b16 v[54:55], v4 offset:53760
  s_waitcnt lgkmcnt(8)
  v_mfma_f32_16x16x32_bf16 a[28:31], v[44:47], v[172:175], a[28:31]
  v_mfma_f32_16x16x32_bf16 a[92:95], v[40:43], v[176:179], a[92:95]
  v_mfma_f32_16x16x32_bf16 a[92:95], v[44:47], v[180:183], a[92:95]
  buffer_load_dwordx4 v[144:147], v12, s[20:23], s38 offen offset:384
  v_mfma_f32_16x16x32_bf16 a[156:159], v[40:43], v[184:187], a[156:159]
  v_mfma_f32_16x16x32_bf16 a[156:159], v[44:47], v[188:191], a[156:159]
  v_mfma_f32_16x16x32_bf16 a[220:223], v[40:43], v[192:195], a[220:223]
  v_mfma_f32_16x16x32_bf16 a[220:223], v[44:47], v[196:199], a[220:223]
  ds_read_b64_tr_b16 v[56:57], v5 offset:49152
  ds_read_b64_tr_b16 v[58:59], v5 offset:49664
  s_waitcnt lgkmcnt(8)
  v_mfma_f32_16x16x32_bf16 a[32:35], v[24:27], v[168:171], a[32:35]
  ds_read_b64_tr_b16 v[60:61], v5 offset:53248
  ds_read_b64_tr_b16 v[62:63], v5 offset:53760
  s_waitcnt lgkmcnt(8)
  v_mfma_f32_16x16x32_bf16 a[32:35], v[28:31], v[172:175], a[32:35]
  v_mfma_f32_16x16x32_bf16 a[96:99], v[24:27], v[176:179], a[96:99]
  v_mfma_f32_16x16x32_bf16 a[96:99], v[28:31], v[180:183], a[96:99]
  v_mfma_f32_16x16x32_bf16 a[160:163], v[24:27], v[184:187], a[160:163]
  v_mfma_f32_16x16x32_bf16 a[160:163], v[28:31], v[188:191], a[160:163]
  v_mfma_f32_16x16x32_bf16 a[224:227], v[24:27], v[192:195], a[224:227]
  v_mfma_f32_16x16x32_bf16 a[224:227], v[28:31], v[196:199], a[224:227]
  s_waitcnt vmcnt(32)
  v_mfma_f32_16x16x32_bf16 v[96:99], v[24:27], v[200:203], v[96:99]
  buffer_load_dwordx4 v[148:151], v12, s[20:23], s38 offen offset:448
  s_waitcnt vmcnt(32)
  v_mfma_f32_16x16x32_bf16 v[96:99], v[28:31], v[204:207], v[96:99]
  ds_read_b64_tr_b16 v[32:33], v6 offset:49152
  ds_read_b64_tr_b16 v[34:35], v6 offset:49664
  s_waitcnt lgkmcnt(8)
  v_mfma_f32_16x16x32_bf16 a[36:39], v[48:51], v[168:171], a[36:39]
  ds_read_b64_tr_b16 v[36:37], v6 offset:53248
  ds_read_b64_tr_b16 v[38:39], v6 offset:53760
  s_waitcnt lgkmcnt(8)
  v_mfma_f32_16x16x32_bf16 a[36:39], v[52:55], v[172:175], a[36:39]
  v_mfma_f32_16x16x32_bf16 a[100:103], v[48:51], v[176:179], a[100:103]
  v_mfma_f32_16x16x32_bf16 a[100:103], v[52:55], v[180:183], a[100:103]
  v_mfma_f32_16x16x32_bf16 a[164:167], v[48:51], v[184:187], a[164:167]
  v_mfma_f32_16x16x32_bf16 a[164:167], v[52:55], v[188:191], a[164:167]
  v_mfma_f32_16x16x32_bf16 a[228:231], v[48:51], v[192:195], a[228:231]
  v_mfma_f32_16x16x32_bf16 a[228:231], v[52:55], v[196:199], a[228:231]
  v_mfma_f32_16x16x32_bf16 v[100:103], v[48:51], v[200:203], v[100:103]
  v_mfma_f32_16x16x32_bf16 v[100:103], v[52:55], v[204:207], v[100:103]
  ds_read_b64_tr_b16 v[40:41], v3 offset:57344
  ds_read_b64_tr_b16 v[42:43], v3 offset:57856
  s_waitcnt lgkmcnt(8)
  v_mfma_f32_16x16x32_bf16 a[40:43], v[56:59], v[168:171], a[40:43]
  ds_read_b64_tr_b16 v[44:45], v3 offset:61440
  ds_read_b64_tr_b16 v[46:47], v3 offset:61952
  s_waitcnt lgkmcnt(8)
  v_mfma_f32_16x16x32_bf16 a[40:43], v[60:63], v[172:175], a[40:43]
  buffer_load_dwordx4 v[152:155], v12, s[20:23], s39 offen offset:384
  v_mfma_f32_16x16x32_bf16 a[104:107], v[56:59], v[176:179], a[104:107]
  v_mfma_f32_16x16x32_bf16 a[104:107], v[60:63], v[180:183], a[104:107]
  v_mfma_f32_16x16x32_bf16 a[168:171], v[56:59], v[184:187], a[168:171]
  v_mfma_f32_16x16x32_bf16 a[168:171], v[60:63], v[188:191], a[168:171]
  v_mfma_f32_16x16x32_bf16 a[232:235], v[56:59], v[192:195], a[232:235]
  v_mfma_f32_16x16x32_bf16 a[232:235], v[60:63], v[196:199], a[232:235]
  v_mfma_f32_16x16x32_bf16 v[104:107], v[56:59], v[200:203], v[104:107]
  v_mfma_f32_16x16x32_bf16 v[104:107], v[60:63], v[204:207], v[104:107]
  ds_read_b64_tr_b16 v[48:49], v4 offset:57344
  ds_read_b64_tr_b16 v[50:51], v4 offset:57856
  s_waitcnt lgkmcnt(8)
  v_mfma_f32_16x16x32_bf16 a[44:47], v[32:35], v[168:171], a[44:47]
  s_waitcnt vmcnt(25)
  s_barrier
  ds_read_b64_tr_b16 v[52:53], v4 offset:61440
  s_waitcnt lgkmcnt(7)
  v_mfma_f32_16x16x32_bf16 a[44:47], v[36:39], v[172:175], a[44:47]
  s_add_u32 m0, s35, 0
  s_add_u32 s34, s50, 2097152
  buffer_load_dwordx4 v10, s[16:19], s34 offen lds
  v_mfma_f32_16x16x32_bf16 a[108:111], v[32:35], v[176:179], a[108:111]
  ds_read_b64_tr_b16 v[54:55], v4 offset:61952
  v_mfma_f32_16x16x32_bf16 a[108:111], v[36:39], v[180:183], a[108:111]
  v_mfma_f32_16x16x32_bf16 a[172:175], v[32:35], v[184:187], a[172:175]
  buffer_load_dwordx4 v[156:159], v12, s[20:23], s39 offen offset:448
  v_mfma_f32_16x16x32_bf16 a[172:175], v[36:39], v[188:191], a[172:175]
  v_mfma_f32_16x16x32_bf16 a[236:239], v[32:35], v[192:195], a[236:239]
  v_mfma_f32_16x16x32_bf16 a[236:239], v[36:39], v[196:199], a[236:239]
  s_add_u32 m0, s35, 1024
  s_add_u32 s34, s50, 2162688
  buffer_load_dwordx4 v11, s[16:19], s34 offen lds
  v_mfma_f32_16x16x32_bf16 v[108:111], v[32:35], v[200:203], v[108:111]
  v_mfma_f32_16x16x32_bf16 v[108:111], v[36:39], v[204:207], v[108:111]
  ds_read_b64_tr_b16 v[56:57], v5 offset:57344
  ds_read_b64_tr_b16 v[58:59], v5 offset:57856
  s_waitcnt lgkmcnt(8)
  v_mfma_f32_16x16x32_bf16 a[48:51], v[40:43], v[168:171], a[48:51]
  ds_read_b64_tr_b16 v[60:61], v5 offset:61440
  ds_read_b64_tr_b16 v[62:63], v5 offset:61952
  s_waitcnt lgkmcnt(8)
  v_mfma_f32_16x16x32_bf16 a[48:51], v[44:47], v[172:175], a[48:51]
  v_mfma_f32_16x16x32_bf16 a[112:115], v[40:43], v[176:179], a[112:115]
  v_mfma_f32_16x16x32_bf16 a[112:115], v[44:47], v[180:183], a[112:115]
  s_add_u32 m0, s35, 2048
  s_add_u32 s34, s50, 2228224
  buffer_load_dwordx4 v10, s[16:19], s34 offen lds
  v_mfma_f32_16x16x32_bf16 a[176:179], v[40:43], v[184:187], a[176:179]
  v_mfma_f32_16x16x32_bf16 a[176:179], v[44:47], v[188:191], a[176:179]
  v_mfma_f32_16x16x32_bf16 a[240:243], v[40:43], v[192:195], a[240:243]
  v_mfma_f32_16x16x32_bf16 a[240:243], v[44:47], v[196:199], a[240:243]
  buffer_load_dwordx4 v[160:163], v12, s[20:23], s40 offen offset:384
  v_mfma_f32_16x16x32_bf16 v[112:115], v[40:43], v[200:203], v[112:115]
  v_mfma_f32_16x16x32_bf16 v[112:115], v[44:47], v[204:207], v[112:115]
  s_add_u32 m0, s35, 3072
  s_add_u32 s34, s50, 2293760
  buffer_load_dwordx4 v11, s[16:19], s34 offen lds
  s_waitcnt lgkmcnt(6)
  v_mfma_f32_16x16x32_bf16 a[52:55], v[48:51], v[168:171], a[52:55]
  ds_read_b64_tr_b16 v[24:25], v6 offset:57344
  ds_read_b64_tr_b16 v[26:27], v6 offset:57856
  s_waitcnt lgkmcnt(6)
  v_mfma_f32_16x16x32_bf16 a[52:55], v[52:55], v[172:175], a[52:55]
  ds_read_b64_tr_b16 v[28:29], v6 offset:61440
  ds_read_b64_tr_b16 v[30:31], v6 offset:61952
  v_mfma_f32_16x16x32_bf16 a[116:119], v[48:51], v[176:179], a[116:119]
  v_mfma_f32_16x16x32_bf16 a[116:119], v[52:55], v[180:183], a[116:119]
  v_mfma_f32_16x16x32_bf16 a[180:183], v[48:51], v[184:187], a[180:183]
  v_mfma_f32_16x16x32_bf16 a[180:183], v[52:55], v[188:191], a[180:183]
  s_add_u32 m0, s35, 4096
  s_add_u32 s34, s50, 2359296
  buffer_load_dwordx4 v10, s[16:19], s34 offen lds
  v_mfma_f32_16x16x32_bf16 a[244:247], v[48:51], v[192:195], a[244:247]
  v_mfma_f32_16x16x32_bf16 a[244:247], v[52:55], v[196:199], a[244:247]
  v_mfma_f32_16x16x32_bf16 v[116:119], v[48:51], v[200:203], v[116:119]
  v_mfma_f32_16x16x32_bf16 v[116:119], v[52:55], v[204:207], v[116:119]
  s_waitcnt lgkmcnt(6)
  v_mfma_f32_16x16x32_bf16 a[56:59], v[56:59], v[168:171], a[56:59]
  buffer_load_dwordx4 v[164:167], v12, s[20:23], s40 offen offset:448
  s_waitcnt lgkmcnt(4)
  v_mfma_f32_16x16x32_bf16 a[56:59], v[60:63], v[172:175], a[56:59]
  s_add_u32 m0, s35, 5120
  s_add_u32 s34, s50, 2424832
  buffer_load_dwordx4 v11, s[16:19], s34 offen lds
  v_mfma_f32_16x16x32_bf16 a[120:123], v[56:59], v[176:179], a[120:123]
  v_mfma_f32_16x16x32_bf16 a[120:123], v[60:63], v[180:183], a[120:123]
  v_mfma_f32_16x16x32_bf16 a[184:187], v[56:59], v[184:187], a[184:187]
  v_mfma_f32_16x16x32_bf16 a[184:187], v[60:63], v[188:191], a[184:187]
  v_mfma_f32_16x16x32_bf16 a[248:251], v[56:59], v[192:195], a[248:251]
  v_xor_b32 v3, 65536, v3
  v_xor_b32 v4, 65536, v4
  v_mfma_f32_16x16x32_bf16 a[248:251], v[60:63], v[196:199], a[248:251]
  s_add_u32 m0, s35, 6144
  s_add_u32 s34, s50, 2490368
  buffer_load_dwordx4 v10, s[16:19], s34 offen lds
  v_mfma_f32_16x16x32_bf16 v[120:123], v[56:59], v[200:203], v[120:123]
  v_xor_b32 v5, 65536, v5
  v_xor_b32 v6, 65536, v6
  v_mfma_f32_16x16x32_bf16 v[120:123], v[60:63], v[204:207], v[120:123]
  ds_read_b64_tr_b16 v[40:41], v3 offset:0
  ds_read_b64_tr_b16 v[42:43], v3 offset:512
  s_waitcnt lgkmcnt(4)
  v_mfma_f32_16x16x32_bf16 a[60:63], v[24:27], v[168:171], a[60:63]
  ds_read_b64_tr_b16 v[44:45], v3 offset:4096
  ds_read_b64_tr_b16 v[46:47], v3 offset:4608
  s_waitcnt lgkmcnt(4)
  v_mfma_f32_16x16x32_bf16 a[60:63], v[28:31], v[172:175], a[60:63]
  ds_read_b64_tr_b16 v[48:49], v4 offset:0
  ds_read_b64_tr_b16 v[50:51], v4 offset:512
  v_mfma_f32_16x16x32_bf16 a[124:127], v[24:27], v[176:179], a[124:127]
  ds_read_b64_tr_b16 v[52:53], v4 offset:4096
  ds_read_b64_tr_b16 v[54:55], v4 offset:4608
  v_mfma_f32_16x16x32_bf16 a[124:127], v[28:31], v[180:183], a[124:127]
  s_add_u32 m0, s35, 7168
  s_add_u32 s34, s50, 2555904
  buffer_load_dwordx4 v11, s[16:19], s34 offen lds
  v_mfma_f32_16x16x32_bf16 a[188:191], v[24:27], v[184:187], a[188:191]
  ds_read_b64_tr_b16 v[56:57], v5 offset:0
  ds_read_b64_tr_b16 v[58:59], v5 offset:512
  v_mfma_f32_16x16x32_bf16 a[188:191], v[28:31], v[188:191], a[188:191]
  ds_read_b64_tr_b16 v[60:61], v5 offset:4096
  ds_read_b64_tr_b16 v[62:63], v5 offset:4608
  v_mfma_f32_16x16x32_bf16 a[252:255], v[24:27], v[192:195], a[252:255]
  v_mfma_f32_16x16x32_bf16 a[252:255], v[28:31], v[196:199], a[252:255]
  v_mfma_f32_16x16x32_bf16 v[124:127], v[24:27], v[200:203], v[124:127]
  v_mfma_f32_16x16x32_bf16 v[124:127], v[28:31], v[204:207], v[124:127]
  s_waitcnt vmcnt(34) lgkmcnt(10)
  v_mfma_f32_16x16x32_bf16 a[0:3], v[40:43], v[208:211], a[0:3]
  s_waitcnt vmcnt(32) lgkmcnt(8)
  v_mfma_f32_16x16x32_bf16 a[0:3], v[44:47], v[212:215], a[0:3]
  s_waitcnt vmcnt(30)
  v_mfma_f32_16x16x32_bf16 a[64:67], v[40:43], v[216:219], a[64:67]
  s_waitcnt vmcnt(28)
  v_mfma_f32_16x16x32_bf16 a[64:67], v[44:47], v[220:223], a[64:67]
  s_waitcnt vmcnt(26)
  v_mfma_f32_16x16x32_bf16 a[128:131], v[40:43], v[224:227], a[128:131]
  s_waitcnt vmcnt(24)
  v_mfma_f32_16x16x32_bf16 a[128:131], v[44:47], v[228:231], a[128:131]
  s_waitcnt vmcnt(21)
  v_mfma_f32_16x16x32_bf16 a[192:195], v[40:43], v[232:235], a[192:195]
  s_waitcnt vmcnt(20)
  v_mfma_f32_16x16x32_bf16 a[192:195], v[44:47], v[236:239], a[192:195]
  ds_read_b64_tr_b16 v[24:25], v6 offset:0
  ds_read_b64_tr_b16 v[26:27], v6 offset:512
  s_waitcnt lgkmcnt(8)
  v_mfma_f32_16x16x32_bf16 a[4:7], v[48:51], v[208:211], a[4:7]
  ds_read_b64_tr_b16 v[28:29], v6 offset:4096
  ds_read_b64_tr_b16 v[30:31], v6 offset:4608
  s_waitcnt lgkmcnt(8)
  v_mfma_f32_16x16x32_bf16 a[4:7], v[52:55], v[212:215], a[4:7]
  buffer_load_dwordx4 v[168:171], v12, s[20:23], s36 offen offset:512
  v_mfma_f32_16x16x32_bf16 a[68:71], v[48:51], v[216:219], a[68:71]
  v_mfma_f32_16x16x32_bf16 a[68:71], v[52:55], v[220:223], a[68:71]
  v_mfma_f32_16x16x32_bf16 a[132:135], v[48:51], v[224:227], a[132:135]
  v_mfma_f32_16x16x32_bf16 a[132:135], v[52:55], v[228:231], a[132:135]
  v_mfma_f32_16x16x32_bf16 a[196:199], v[48:51], v[232:235], a[196:199]
  v_mfma_f32_16x16x32_bf16 a[196:199], v[52:55], v[236:239], a[196:199]
  ds_read_b64_tr_b16 v[32:33], v3 offset:8192
  ds_read_b64_tr_b16 v[34:35], v3 offset:8704
  s_waitcnt lgkmcnt(8)
  v_mfma_f32_16x16x32_bf16 a[8:11], v[56:59], v[208:211], a[8:11]
  ds_read_b64_tr_b16 v[36:37], v3 offset:12288
  ds_read_b64_tr_b16 v[38:39], v3 offset:12800
  s_waitcnt lgkmcnt(8)
  v_mfma_f32_16x16x32_bf16 a[8:11], v[60:63], v[212:215], a[8:11]
  v_mfma_f32_16x16x32_bf16 a[72:75], v[56:59], v[216:219], a[72:75]
  v_mfma_f32_16x16x32_bf16 a[72:75], v[60:63], v[220:223], a[72:75]
  v_mfma_f32_16x16x32_bf16 a[136:139], v[56:59], v[224:227], a[136:139]
  buffer_load_dwordx4 v[172:175], v12, s[20:23], s36 offen offset:576
  v_mfma_f32_16x16x32_bf16 a[136:139], v[60:63], v[228:231], a[136:139]
  v_mfma_f32_16x16x32_bf16 a[200:203], v[56:59], v[232:235], a[200:203]
  v_mfma_f32_16x16x32_bf16 a[200:203], v[60:63], v[236:239], a[200:203]
  ds_read_b64_tr_b16 v[48:49], v4 offset:8192
  ds_read_b64_tr_b16 v[50:51], v4 offset:8704
  s_waitcnt lgkmcnt(8)
  v_mfma_f32_16x16x32_bf16 a[12:15], v[24:27], v[208:211], a[12:15]
  ds_read_b64_tr_b16 v[52:53], v4 offset:12288
  ds_read_b64_tr_b16 v[54:55], v4 offset:12800
  s_waitcnt lgkmcnt(8)
  v_mfma_f32_16x16x32_bf16 a[12:15], v[28:31], v[212:215], a[12:15]
  v_mfma_f32_16x16x32_bf16 a[76:79], v[24:27], v[216:219], a[76:79]
  v_mfma_f32_16x16x32_bf16 a[76:79], v[28:31], v[220:223], a[76:79]
  v_mfma_f32_16x16x32_bf16 a[140:143], v[24:27], v[224:227], a[140:143]
  v_mfma_f32_16x16x32_bf16 a[140:143], v[28:31], v[228:231], a[140:143]
  v_mfma_f32_16x16x32_bf16 a[204:207], v[24:27], v[232:235], a[204:207]
  v_mfma_f32_16x16x32_bf16 a[204:207], v[28:31], v[236:239], a[204:207]
  ds_read_b64_tr_b16 v[56:57], v5 offset:8192
  ds_read_b64_tr_b16 v[58:59], v5 offset:8704
  s_waitcnt lgkmcnt(8)
  v_mfma_f32_16x16x32_bf16 a[16:19], v[32:35], v[208:211], a[16:19]
  ds_read_b64_tr_b16 v[60:61], v5 offset:12288
  ds_read_b64_tr_b16 v[62:63], v5 offset:12800
  s_waitcnt lgkmcnt(8)
  v_mfma_f32_16x16x32_bf16 a[16:19], v[36:39], v[212:215], a[16:19]
  buffer_load_dwordx4 v[176:179], v12, s[20:23], s37 offen offset:512
  v_mfma_f32_16x16x32_bf16 a[80:83], v[32:35], v[216:219], a[80:83]
  v_mfma_f32_16x16x32_bf16 a[80:83], v[36:39], v[220:223], a[80:83]
  v_mfma_f32_16x16x32_bf16 a[144:147], v[32:35], v[224:227], a[144:147]
  v_mfma_f32_16x16x32_bf16 a[144:147], v[36:39], v[228:231], a[144:147]
  v_mfma_f32_16x16x32_bf16 a[208:211], v[32:35], v[232:235], a[208:211]
  v_mfma_f32_16x16x32_bf16 a[208:211], v[36:39], v[236:239], a[208:211]
  ds_read_b64_tr_b16 v[40:41], v6 offset:8192
  ds_read_b64_tr_b16 v[42:43], v6 offset:8704
  s_waitcnt lgkmcnt(8)
  v_mfma_f32_16x16x32_bf16 a[20:23], v[48:51], v[208:211], a[20:23]
  ds_read_b64_tr_b16 v[44:45], v6 offset:12288
  ds_read_b64_tr_b16 v[46:47], v6 offset:12800
  s_waitcnt lgkmcnt(8)
  v_mfma_f32_16x16x32_bf16 a[20:23], v[52:55], v[212:215], a[20:23]
  v_mfma_f32_16x16x32_bf16 a[84:87], v[48:51], v[216:219], a[84:87]
  v_mfma_f32_16x16x32_bf16 a[84:87], v[52:55], v[220:223], a[84:87]
  v_mfma_f32_16x16x32_bf16 a[148:151], v[48:51], v[224:227], a[148:151]
  v_mfma_f32_16x16x32_bf16 a[148:151], v[52:55], v[228:231], a[148:151]
  v_mfma_f32_16x16x32_bf16 a[212:215], v[48:51], v[232:235], a[212:215]
  buffer_load_dwordx4 v[180:183], v12, s[20:23], s37 offen offset:576
  v_mfma_f32_16x16x32_bf16 a[212:215], v[52:55], v[236:239], a[212:215]
  ds_read_b64_tr_b16 v[24:25], v3 offset:16384
  ds_read_b64_tr_b16 v[26:27], v3 offset:16896
  s_waitcnt lgkmcnt(8)
  v_mfma_f32_16x16x32_bf16 a[24:27], v[56:59], v[208:211], a[24:27]
  ds_read_b64_tr_b16 v[28:29], v3 offset:20480
  ds_read_b64_tr_b16 v[30:31], v3 offset:20992
  s_waitcnt lgkmcnt(8)
  v_mfma_f32_16x16x32_bf16 a[24:27], v[60:63], v[212:215], a[24:27]
  v_mfma_f32_16x16x32_bf16 a[88:91], v[56:59], v[216:219], a[88:91]
  v_mfma_f32_16x16x32_bf16 a[88:91], v[60:63], v[220:223], a[88:91]
  v_mfma_f32_16x16x32_bf16 a[152:155], v[56:59], v[224:227], a[152:155]
  v_mfma_f32_16x16x32_bf16 a[152:155], v[60:63], v[228:231], a[152:155]
  v_mfma_f32_16x16x32_bf16 a[216:219], v[56:59], v[232:235], a[216:219]
  v_mfma_f32_16x16x32_bf16 a[216:219], v[60:63], v[236:239], a[216:219]
  ds_read_b64_tr_b16 v[48:49], v4 offset:16384
  ds_read_b64_tr_b16 v[50:51], v4 offset:16896
  s_waitcnt lgkmcnt(8)
  v_mfma_f32_16x16x32_bf16 a[28:31], v[40:43], v[208:211], a[28:31]
  ds_read_b64_tr_b16 v[52:53], v4 offset:20480
  ds_read_b64_tr_b16 v[54:55], v4 offset:20992
  s_waitcnt lgkmcnt(8)
  v_mfma_f32_16x16x32_bf16 a[28:31], v[44:47], v[212:215], a[28:31]
  v_mfma_f32_16x16x32_bf16 a[92:95], v[40:43], v[216:219], a[92:95]
  v_mfma_f32_16x16x32_bf16 a[92:95], v[44:47], v[220:223], a[92:95]
  buffer_load_dwordx4 v[184:187], v12, s[20:23], s38 offen offset:512
  v_mfma_f32_16x16x32_bf16 a[156:159], v[40:43], v[224:227], a[156:159]
  v_mfma_f32_16x16x32_bf16 a[156:159], v[44:47], v[228:231], a[156:159]
  v_mfma_f32_16x16x32_bf16 a[220:223], v[40:43], v[232:235], a[220:223]
  v_mfma_f32_16x16x32_bf16 a[220:223], v[44:47], v[236:239], a[220:223]
  ds_read_b64_tr_b16 v[56:57], v5 offset:16384
  ds_read_b64_tr_b16 v[58:59], v5 offset:16896
  s_waitcnt lgkmcnt(8)
  v_mfma_f32_16x16x32_bf16 a[32:35], v[24:27], v[208:211], a[32:35]
  ds_read_b64_tr_b16 v[60:61], v5 offset:20480
  ds_read_b64_tr_b16 v[62:63], v5 offset:20992
  s_waitcnt lgkmcnt(8)
  v_mfma_f32_16x16x32_bf16 a[32:35], v[28:31], v[212:215], a[32:35]
  v_mfma_f32_16x16x32_bf16 a[96:99], v[24:27], v[216:219], a[96:99]
  v_mfma_f32_16x16x32_bf16 a[96:99], v[28:31], v[220:223], a[96:99]
  v_mfma_f32_16x16x32_bf16 a[160:163], v[24:27], v[224:227], a[160:163]
  v_mfma_f32_16x16x32_bf16 a[160:163], v[28:31], v[228:231], a[160:163]
  v_mfma_f32_16x16x32_bf16 a[224:227], v[24:27], v[232:235], a[224:227]
  v_mfma_f32_16x16x32_bf16 a[224:227], v[28:31], v[236:239], a[224:227]
  s_waitcnt vmcnt(24)
  v_mfma_f32_16x16x32_bf16 v[96:99], v[24:27], v[240:243], v[96:99]
  buffer_load_dwordx4 v[188:191], v12, s[20:23], s38 offen offset:576
  s_waitcnt vmcnt(24)
  v_mfma_f32_16x16x32_bf16 v[96:99], v[28:31], v[244:247], v[96:99]
  ds_read_b64_tr_b16 v[32:33], v6 offset:16384
  ds_read_b64_tr_b16 v[34:35], v6 offset:16896
  s_waitcnt lgkmcnt(8)
  v_mfma_f32_16x16x32_bf16 a[36:39], v[48:51], v[208:211], a[36:39]
  ds_read_b64_tr_b16 v[36:37], v6 offset:20480
  ds_read_b64_tr_b16 v[38:39], v6 offset:20992
  s_waitcnt lgkmcnt(8)
  v_mfma_f32_16x16x32_bf16 a[36:39], v[52:55], v[212:215], a[36:39]
  v_mfma_f32_16x16x32_bf16 a[100:103], v[48:51], v[216:219], a[100:103]
  v_mfma_f32_16x16x32_bf16 a[100:103], v[52:55], v[220:223], a[100:103]
  v_mfma_f32_16x16x32_bf16 a[164:167], v[48:51], v[224:227], a[164:167]
  v_mfma_f32_16x16x32_bf16 a[164:167], v[52:55], v[228:231], a[164:167]
  v_mfma_f32_16x16x32_bf16 a[228:231], v[48:51], v[232:235], a[228:231]
  v_mfma_f32_16x16x32_bf16 a[228:231], v[52:55], v[236:239], a[228:231]
  v_mfma_f32_16x16x32_bf16 v[100:103], v[48:51], v[240:243], v[100:103]
  v_mfma_f32_16x16x32_bf16 v[100:103], v[52:55], v[244:247], v[100:103]
  ds_read_b64_tr_b16 v[40:41], v3 offset:24576
  ds_read_b64_tr_b16 v[42:43], v3 offset:25088
  s_waitcnt lgkmcnt(8)
  v_mfma_f32_16x16x32_bf16 a[40:43], v[56:59], v[208:211], a[40:43]
  ds_read_b64_tr_b16 v[44:45], v3 offset:28672
  ds_read_b64_tr_b16 v[46:47], v3 offset:29184
  s_waitcnt lgkmcnt(8)
  v_mfma_f32_16x16x32_bf16 a[40:43], v[60:63], v[212:215], a[40:43]
  buffer_load_dwordx4 v[192:195], v12, s[20:23], s39 offen offset:512
  v_mfma_f32_16x16x32_bf16 a[104:107], v[56:59], v[216:219], a[104:107]
  v_mfma_f32_16x16x32_bf16 a[104:107], v[60:63], v[220:223], a[104:107]
  v_mfma_f32_16x16x32_bf16 a[168:171], v[56:59], v[224:227], a[168:171]
  v_mfma_f32_16x16x32_bf16 a[168:171], v[60:63], v[228:231], a[168:171]
  v_mfma_f32_16x16x32_bf16 a[232:235], v[56:59], v[232:235], a[232:235]
  v_mfma_f32_16x16x32_bf16 a[232:235], v[60:63], v[236:239], a[232:235]
  v_mfma_f32_16x16x32_bf16 v[104:107], v[56:59], v[240:243], v[104:107]
  v_mfma_f32_16x16x32_bf16 v[104:107], v[60:63], v[244:247], v[104:107]
  ds_read_b64_tr_b16 v[48:49], v4 offset:24576
  ds_read_b64_tr_b16 v[50:51], v4 offset:25088
  s_waitcnt lgkmcnt(8)
  v_mfma_f32_16x16x32_bf16 a[44:47], v[32:35], v[208:211], a[44:47]
  s_barrier
  ds_read_b64_tr_b16 v[52:53], v4 offset:28672
  s_waitcnt lgkmcnt(7)
  v_mfma_f32_16x16x32_bf16 a[44:47], v[36:39], v[212:215], a[44:47]
  s_add_u32 m0, s35, 32768
  s_add_u32 s34, s50, 2621440
  buffer_load_dwordx4 v10, s[16:19], s34 offen lds
  v_mfma_f32_16x16x32_bf16 a[108:111], v[32:35], v[216:219], a[108:111]
  ds_read_b64_tr_b16 v[54:55], v4 offset:29184
  v_mfma_f32_16x16x32_bf16 a[108:111], v[36:39], v[220:223], a[108:111]
  v_mfma_f32_16x16x32_bf16 a[172:175], v[32:35], v[224:227], a[172:175]
  buffer_load_dwordx4 v[196:199], v12, s[20:23], s39 offen offset:576
  v_mfma_f32_16x16x32_bf16 a[172:175], v[36:39], v[228:231], a[172:175]
  v_mfma_f32_16x16x32_bf16 a[236:239], v[32:35], v[232:235], a[236:239]
  v_mfma_f32_16x16x32_bf16 a[236:239], v[36:39], v[236:239], a[236:239]
  s_add_u32 m0, s35, 33792
  s_add_u32 s34, s50, 2686976
  buffer_load_dwordx4 v11, s[16:19], s34 offen lds
  v_mfma_f32_16x16x32_bf16 v[108:111], v[32:35], v[240:243], v[108:111]
  v_mfma_f32_16x16x32_bf16 v[108:111], v[36:39], v[244:247], v[108:111]
  ds_read_b64_tr_b16 v[56:57], v5 offset:24576
  ds_read_b64_tr_b16 v[58:59], v5 offset:25088
  s_waitcnt lgkmcnt(8)
  v_mfma_f32_16x16x32_bf16 a[48:51], v[40:43], v[208:211], a[48:51]
  ds_read_b64_tr_b16 v[60:61], v5 offset:28672
  ds_read_b64_tr_b16 v[62:63], v5 offset:29184
  s_waitcnt lgkmcnt(8)
  v_mfma_f32_16x16x32_bf16 a[48:51], v[44:47], v[212:215], a[48:51]
  v_mfma_f32_16x16x32_bf16 a[112:115], v[40:43], v[216:219], a[112:115]
  v_mfma_f32_16x16x32_bf16 a[112:115], v[44:47], v[220:223], a[112:115]
  s_add_u32 m0, s35, 34816
  s_add_u32 s34, s50, 2752512
  buffer_load_dwordx4 v10, s[16:19], s34 offen lds
  v_mfma_f32_16x16x32_bf16 a[176:179], v[40:43], v[224:227], a[176:179]
  v_mfma_f32_16x16x32_bf16 a[176:179], v[44:47], v[228:231], a[176:179]
  v_mfma_f32_16x16x32_bf16 a[240:243], v[40:43], v[232:235], a[240:243]
  v_mfma_f32_16x16x32_bf16 a[240:243], v[44:47], v[236:239], a[240:243]
  buffer_load_dwordx4 v[200:203], v12, s[20:23], s40 offen offset:512
  v_mfma_f32_16x16x32_bf16 v[112:115], v[40:43], v[240:243], v[112:115]
  v_mfma_f32_16x16x32_bf16 v[112:115], v[44:47], v[244:247], v[112:115]
  s_add_u32 m0, s35, 35840
  s_add_u32 s34, s50, 2818048
  buffer_load_dwordx4 v11, s[16:19], s34 offen lds
  s_waitcnt lgkmcnt(6)
  v_mfma_f32_16x16x32_bf16 a[52:55], v[48:51], v[208:211], a[52:55]
  ds_read_b64_tr_b16 v[24:25], v6 offset:24576
  ds_read_b64_tr_b16 v[26:27], v6 offset:25088
  s_waitcnt lgkmcnt(6)
  v_mfma_f32_16x16x32_bf16 a[52:55], v[52:55], v[212:215], a[52:55]
  ds_read_b64_tr_b16 v[28:29], v6 offset:28672
  ds_read_b64_tr_b16 v[30:31], v6 offset:29184
  v_mfma_f32_16x16x32_bf16 a[116:119], v[48:51], v[216:219], a[116:119]
  ds_read_b64_tr_b16 v[40:41], v3 offset:32768
  ds_read_b64_tr_b16 v[42:43], v3 offset:33280
  v_mfma_f32_16x16x32_bf16 a[116:119], v[52:55], v[220:223], a[116:119]
  ds_read_b64_tr_b16 v[44:45], v3 offset:36864
  ds_read_b64_tr_b16 v[46:47], v3 offset:37376
  v_mfma_f32_16x16x32_bf16 a[180:183], v[48:51], v[224:227], a[180:183]
  v_mfma_f32_16x16x32_bf16 a[180:183], v[52:55], v[228:231], a[180:183]
  s_add_u32 m0, s35, 36864
  s_add_u32 s34, s50, 2883584
  buffer_load_dwordx4 v10, s[16:19], s34 offen lds
  v_mfma_f32_16x16x32_bf16 a[244:247], v[48:51], v[232:235], a[244:247]
  v_mfma_f32_16x16x32_bf16 a[244:247], v[52:55], v[236:239], a[244:247]
  v_mfma_f32_16x16x32_bf16 v[116:119], v[48:51], v[240:243], v[116:119]
  v_mfma_f32_16x16x32_bf16 v[116:119], v[52:55], v[244:247], v[116:119]
  ds_read_b64_tr_b16 v[48:49], v4 offset:32768
  ds_read_b64_tr_b16 v[50:51], v4 offset:33280
  s_waitcnt lgkmcnt(12)
  v_mfma_f32_16x16x32_bf16 a[56:59], v[56:59], v[208:211], a[56:59]
  buffer_load_dwordx4 v[204:207], v12, s[20:23], s40 offen offset:576
  ds_read_b64_tr_b16 v[52:53], v4 offset:36864
  s_waitcnt lgkmcnt(11)
  v_mfma_f32_16x16x32_bf16 a[56:59], v[60:63], v[212:215], a[56:59]
  s_add_u32 m0, s35, 37888
  s_add_u32 s34, s50, 2949120
  buffer_load_dwordx4 v11, s[16:19], s34 offen lds
  v_mfma_f32_16x16x32_bf16 a[120:123], v[56:59], v[216:219], a[120:123]
  ds_read_b64_tr_b16 v[54:55], v4 offset:37376
  v_mfma_f32_16x16x32_bf16 a[120:123], v[60:63], v[220:223], a[120:123]
  v_mfma_f32_16x16x32_bf16 a[184:187], v[56:59], v[224:227], a[184:187]
  v_mfma_f32_16x16x32_bf16 a[184:187], v[60:63], v[228:231], a[184:187]
  v_mfma_f32_16x16x32_bf16 a[248:251], v[56:59], v[232:235], a[248:251]
  v_mfma_f32_16x16x32_bf16 a[248:251], v[60:63], v[236:239], a[248:251]
  s_add_u32 m0, s35, 38912
  s_add_u32 s34, s50, 3014656
  buffer_load_dwordx4 v10, s[16:19], s34 offen lds
  v_mfma_f32_16x16x32_bf16 v[120:123], v[56:59], v[240:243], v[120:123]
  v_mfma_f32_16x16x32_bf16 v[120:123], v[60:63], v[244:247], v[120:123]
  ds_read_b64_tr_b16 v[56:57], v5 offset:32768
  ds_read_b64_tr_b16 v[58:59], v5 offset:33280
  s_waitcnt lgkmcnt(12)
  v_mfma_f32_16x16x32_bf16 a[60:63], v[24:27], v[208:211], a[60:63]
  ds_read_b64_tr_b16 v[60:61], v5 offset:36864
  ds_read_b64_tr_b16 v[62:63], v5 offset:37376
  s_waitcnt lgkmcnt(12)
  v_mfma_f32_16x16x32_bf16 a[60:63], v[28:31], v[212:215], a[60:63]
  v_mfma_f32_16x16x32_bf16 a[124:127], v[24:27], v[216:219], a[124:127]
  v_mfma_f32_16x16x32_bf16 a[124:127], v[28:31], v[220:223], a[124:127]
  s_add_u32 m0, s35, 39936
  s_add_u32 s34, s50, 3080192
  buffer_load_dwordx4 v11, s[16:19], s34 offen lds
  v_mfma_f32_16x16x32_bf16 a[188:191], v[24:27], v[224:227], a[188:191]
  v_mfma_f32_16x16x32_bf16 a[188:191], v[28:31], v[228:231], a[188:191]
  v_mfma_f32_16x16x32_bf16 a[252:255], v[24:27], v[232:235], a[252:255]
  v_mfma_f32_16x16x32_bf16 a[252:255], v[28:31], v[236:239], a[252:255]
  v_mfma_f32_16x16x32_bf16 v[124:127], v[24:27], v[240:243], v[124:127]
  v_mfma_f32_16x16x32_bf16 v[124:127], v[28:31], v[244:247], v[124:127]
  s_waitcnt vmcnt(35) lgkmcnt(10)
  v_mfma_f32_16x16x32_bf16 a[0:3], v[40:43], v[128:131], a[0:3]
  s_waitcnt vmcnt(34) lgkmcnt(8)
  v_mfma_f32_16x16x32_bf16 a[0:3], v[44:47], v[132:135], a[0:3]
  s_waitcnt vmcnt(33)
  v_mfma_f32_16x16x32_bf16 a[64:67], v[40:43], v[136:139], a[64:67]
  s_waitcnt vmcnt(32)
  v_mfma_f32_16x16x32_bf16 a[64:67], v[44:47], v[140:143], a[64:67]
  s_waitcnt vmcnt(31)
  v_mfma_f32_16x16x32_bf16 a[128:131], v[40:43], v[144:147], a[128:131]
  s_waitcnt vmcnt(30)
  v_mfma_f32_16x16x32_bf16 a[128:131], v[44:47], v[148:151], a[128:131]
  s_waitcnt vmcnt(29)
  v_mfma_f32_16x16x32_bf16 a[192:195], v[40:43], v[152:155], a[192:195]
  s_waitcnt vmcnt(27)
  v_mfma_f32_16x16x32_bf16 a[192:195], v[44:47], v[156:159], a[192:195]
  ds_read_b64_tr_b16 v[24:25], v6 offset:32768
  ds_read_b64_tr_b16 v[26:27], v6 offset:33280
  s_waitcnt lgkmcnt(8)
  v_mfma_f32_16x16x32_bf16 a[4:7], v[48:51], v[128:131], a[4:7]
  ds_read_b64_tr_b16 v[28:29], v6 offset:36864
  ds_read_b64_tr_b16 v[30:31], v6 offset:37376
  s_waitcnt lgkmcnt(8)
  v_mfma_f32_16x16x32_bf16 a[4:7], v[52:55], v[132:135], a[4:7]
  buffer_load_dwordx4 v[208:211], v12, s[20:23], s36 offen offset:640
  v_mfma_f32_16x16x32_bf16 a[68:71], v[48:51], v[136:139], a[68:71]
  v_mfma_f32_16x16x32_bf16 a[68:71], v[52:55], v[140:143], a[68:71]
  v_mfma_f32_16x16x32_bf16 a[132:135], v[48:51], v[144:147], a[132:135]
  v_mfma_f32_16x16x32_bf16 a[132:135], v[52:55], v[148:151], a[132:135]
  v_mfma_f32_16x16x32_bf16 a[196:199], v[48:51], v[152:155], a[196:199]
  v_mfma_f32_16x16x32_bf16 a[196:199], v[52:55], v[156:159], a[196:199]
  ds_read_b64_tr_b16 v[32:33], v3 offset:40960
  ds_read_b64_tr_b16 v[34:35], v3 offset:41472
  s_waitcnt lgkmcnt(8)
  v_mfma_f32_16x16x32_bf16 a[8:11], v[56:59], v[128:131], a[8:11]
  ds_read_b64_tr_b16 v[36:37], v3 offset:45056
  ds_read_b64_tr_b16 v[38:39], v3 offset:45568
  s_waitcnt lgkmcnt(8)
  v_mfma_f32_16x16x32_bf16 a[8:11], v[60:63], v[132:135], a[8:11]
  v_mfma_f32_16x16x32_bf16 a[72:75], v[56:59], v[136:139], a[72:75]
  v_mfma_f32_16x16x32_bf16 a[72:75], v[60:63], v[140:143], a[72:75]
  v_mfma_f32_16x16x32_bf16 a[136:139], v[56:59], v[144:147], a[136:139]
  buffer_load_dwordx4 v[212:215], v12, s[20:23], s36 offen offset:704
  v_mfma_f32_16x16x32_bf16 a[136:139], v[60:63], v[148:151], a[136:139]
  v_mfma_f32_16x16x32_bf16 a[200:203], v[56:59], v[152:155], a[200:203]
  v_mfma_f32_16x16x32_bf16 a[200:203], v[60:63], v[156:159], a[200:203]
  ds_read_b64_tr_b16 v[48:49], v4 offset:40960
  ds_read_b64_tr_b16 v[50:51], v4 offset:41472
  s_waitcnt lgkmcnt(8)
  v_mfma_f32_16x16x32_bf16 a[12:15], v[24:27], v[128:131], a[12:15]
  ds_read_b64_tr_b16 v[52:53], v4 offset:45056
  ds_read_b64_tr_b16 v[54:55], v4 offset:45568
  s_waitcnt lgkmcnt(8)
  v_mfma_f32_16x16x32_bf16 a[12:15], v[28:31], v[132:135], a[12:15]
  v_mfma_f32_16x16x32_bf16 a[76:79], v[24:27], v[136:139], a[76:79]
  v_mfma_f32_16x16x32_bf16 a[76:79], v[28:31], v[140:143], a[76:79]
  v_mfma_f32_16x16x32_bf16 a[140:143], v[24:27], v[144:147], a[140:143]
  v_mfma_f32_16x16x32_bf16 a[140:143], v[28:31], v[148:151], a[140:143]
  v_mfma_f32_16x16x32_bf16 a[204:207], v[24:27], v[152:155], a[204:207]
  v_mfma_f32_16x16x32_bf16 a[204:207], v[28:31], v[156:159], a[204:207]
  ds_read_b64_tr_b16 v[56:57], v5 offset:40960
  ds_read_b64_tr_b16 v[58:59], v5 offset:41472
  s_waitcnt lgkmcnt(8)
  v_mfma_f32_16x16x32_bf16 a[16:19], v[32:35], v[128:131], a[16:19]
  ds_read_b64_tr_b16 v[60:61], v5 offset:45056
  ds_read_b64_tr_b16 v[62:63], v5 offset:45568
  s_waitcnt lgkmcnt(8)
  v_mfma_f32_16x16x32_bf16 a[16:19], v[36:39], v[132:135], a[16:19]
  buffer_load_dwordx4 v[216:219], v12, s[20:23], s37 offen offset:640
  v_mfma_f32_16x16x32_bf16 a[80:83], v[32:35], v[136:139], a[80:83]
  v_mfma_f32_16x16x32_bf16 a[80:83], v[36:39], v[140:143], a[80:83]
  v_mfma_f32_16x16x32_bf16 a[144:147], v[32:35], v[144:147], a[144:147]
  v_mfma_f32_16x16x32_bf16 a[144:147], v[36:39], v[148:151], a[144:147]
  v_mfma_f32_16x16x32_bf16 a[208:211], v[32:35], v[152:155], a[208:211]
  v_mfma_f32_16x16x32_bf16 a[208:211], v[36:39], v[156:159], a[208:211]
  ds_read_b64_tr_b16 v[40:41], v6 offset:40960
  ds_read_b64_tr_b16 v[42:43], v6 offset:41472
  s_waitcnt lgkmcnt(8)
  v_mfma_f32_16x16x32_bf16 a[20:23], v[48:51], v[128:131], a[20:23]
  ds_read_b64_tr_b16 v[44:45], v6 offset:45056
  ds_read_b64_tr_b16 v[46:47], v6 offset:45568
  s_waitcnt lgkmcnt(8)
  v_mfma_f32_16x16x32_bf16 a[20:23], v[52:55], v[132:135], a[20:23]
  v_mfma_f32_16x16x32_bf16 a[84:87], v[48:51], v[136:139], a[84:87]
  v_mfma_f32_16x16x32_bf16 a[84:87], v[52:55], v[140:143], a[84:87]
  v_mfma_f32_16x16x32_bf16 a[148:151], v[48:51], v[144:147], a[148:151]
  v_mfma_f32_16x16x32_bf16 a[148:151], v[52:55], v[148:151], a[148:151]
  v_mfma_f32_16x16x32_bf16 a[212:215], v[48:51], v[152:155], a[212:215]
  buffer_load_dwordx4 v[220:223], v12, s[20:23], s37 offen offset:704
  v_mfma_f32_16x16x32_bf16 a[212:215], v[52:55], v[156:159], a[212:215]
  ds_read_b64_tr_b16 v[24:25], v3 offset:49152
  ds_read_b64_tr_b16 v[26:27], v3 offset:49664
  s_waitcnt lgkmcnt(8)
  v_mfma_f32_16x16x32_bf16 a[24:27], v[56:59], v[128:131], a[24:27]
  ds_read_b64_tr_b16 v[28:29], v3 offset:53248
  ds_read_b64_tr_b16 v[30:31], v3 offset:53760
  s_waitcnt lgkmcnt(8)
  v_mfma_f32_16x16x32_bf16 a[24:27], v[60:63], v[132:135], a[24:27]
  v_mfma_f32_16x16x32_bf16 a[88:91], v[56:59], v[136:139], a[88:91]
  v_mfma_f32_16x16x32_bf16 a[88:91], v[60:63], v[140:143], a[88:91]
  v_mfma_f32_16x16x32_bf16 a[152:155], v[56:59], v[144:147], a[152:155]
  v_mfma_f32_16x16x32_bf16 a[152:155], v[60:63], v[148:151], a[152:155]
  v_mfma_f32_16x16x32_bf16 a[216:219], v[56:59], v[152:155], a[216:219]
  v_mfma_f32_16x16x32_bf16 a[216:219], v[60:63], v[156:159], a[216:219]
  ds_read_b64_tr_b16 v[48:49], v4 offset:49152
  ds_read_b64_tr_b16 v[50:51], v4 offset:49664
  s_waitcnt lgkmcnt(8)
  v_mfma_f32_16x16x32_bf16 a[28:31], v[40:43], v[128:131], a[28:31]
  ds_read_b64_tr_b16 v[52:53], v4 offset:53248
  ds_read_b64_tr_b16 v[54:55], v4 offset:53760
  s_waitcnt lgkmcnt(8)
  v_mfma_f32_16x16x32_bf16 a[28:31], v[44:47], v[132:135], a[28:31]
  v_mfma_f32_16x16x32_bf16 a[92:95], v[40:43], v[136:139], a[92:95]
  v_mfma_f32_16x16x32_bf16 a[92:95], v[44:47], v[140:143], a[92:95]
  buffer_load_dwordx4 v[224:227], v12, s[20:23], s38 offen offset:640
  v_mfma_f32_16x16x32_bf16 a[156:159], v[40:43], v[144:147], a[156:159]
  v_mfma_f32_16x16x32_bf16 a[156:159], v[44:47], v[148:151], a[156:159]
  v_mfma_f32_16x16x32_bf16 a[220:223], v[40:43], v[152:155], a[220:223]
  v_mfma_f32_16x16x32_bf16 a[220:223], v[44:47], v[156:159], a[220:223]
  ds_read_b64_tr_b16 v[56:57], v5 offset:49152
  ds_read_b64_tr_b16 v[58:59], v5 offset:49664
  s_waitcnt lgkmcnt(8)
  v_mfma_f32_16x16x32_bf16 a[32:35], v[24:27], v[128:131], a[32:35]
  ds_read_b64_tr_b16 v[60:61], v5 offset:53248
  ds_read_b64_tr_b16 v[62:63], v5 offset:53760
  s_waitcnt lgkmcnt(8)
  v_mfma_f32_16x16x32_bf16 a[32:35], v[28:31], v[132:135], a[32:35]
  v_mfma_f32_16x16x32_bf16 a[96:99], v[24:27], v[136:139], a[96:99]
  v_mfma_f32_16x16x32_bf16 a[96:99], v[28:31], v[140:143], a[96:99]
  v_mfma_f32_16x16x32_bf16 a[160:163], v[24:27], v[144:147], a[160:163]
  v_mfma_f32_16x16x32_bf16 a[160:163], v[28:31], v[148:151], a[160:163]
  v_mfma_f32_16x16x32_bf16 a[224:227], v[24:27], v[152:155], a[224:227]
  v_mfma_f32_16x16x32_bf16 a[224:227], v[28:31], v[156:159], a[224:227]
  s_waitcnt vmcnt(29)
  v_mfma_f32_16x16x32_bf16 v[96:99], v[24:27], v[160:163], v[96:99]
  buffer_load_dwordx4 v[228:231], v12, s[20:23], s38 offen offset:704
  s_waitcnt vmcnt(27)
  v_mfma_f32_16x16x32_bf16 v[96:99], v[28:31], v[164:167], v[96:99]
  ds_read_b64_tr_b16 v[32:33], v6 offset:49152
  ds_read_b64_tr_b16 v[34:35], v6 offset:49664
  s_waitcnt lgkmcnt(8)
  v_mfma_f32_16x16x32_bf16 a[36:39], v[48:51], v[128:131], a[36:39]
  ds_read_b64_tr_b16 v[36:37], v6 offset:53248
  ds_read_b64_tr_b16 v[38:39], v6 offset:53760
  s_waitcnt lgkmcnt(8)
  v_mfma_f32_16x16x32_bf16 a[36:39], v[52:55], v[132:135], a[36:39]
  v_mfma_f32_16x16x32_bf16 a[100:103], v[48:51], v[136:139], a[100:103]
  v_mfma_f32_16x16x32_bf16 a[100:103], v[52:55], v[140:143], a[100:103]
  v_mfma_f32_16x16x32_bf16 a[164:167], v[48:51], v[144:147], a[164:167]
  v_mfma_f32_16x16x32_bf16 a[164:167], v[52:55], v[148:151], a[164:167]
  v_mfma_f32_16x16x32_bf16 a[228:231], v[48:51], v[152:155], a[228:231]
  v_mfma_f32_16x16x32_bf16 a[228:231], v[52:55], v[156:159], a[228:231]
  v_mfma_f32_16x16x32_bf16 v[100:103], v[48:51], v[160:163], v[100:103]
  v_mfma_f32_16x16x32_bf16 v[100:103], v[52:55], v[164:167], v[100:103]
  ds_read_b64_tr_b16 v[40:41], v3 offset:57344
  ds_read_b64_tr_b16 v[42:43], v3 offset:57856
  s_waitcnt lgkmcnt(8)
  v_mfma_f32_16x16x32_bf16 a[40:43], v[56:59], v[128:131], a[40:43]
  ds_read_b64_tr_b16 v[44:45], v3 offset:61440
  ds_read_b64_tr_b16 v[46:47], v3 offset:61952
  s_waitcnt lgkmcnt(8)
  v_mfma_f32_16x16x32_bf16 a[40:43], v[60:63], v[132:135], a[40:43]
  buffer_load_dwordx4 v[232:235], v12, s[20:23], s39 offen offset:640
  v_mfma_f32_16x16x32_bf16 a[104:107], v[56:59], v[136:139], a[104:107]
  v_mfma_f32_16x16x32_bf16 a[104:107], v[60:63], v[140:143], a[104:107]
  v_mfma_f32_16x16x32_bf16 a[168:171], v[56:59], v[144:147], a[168:171]
  v_mfma_f32_16x16x32_bf16 a[168:171], v[60:63], v[148:151], a[168:171]
  v_mfma_f32_16x16x32_bf16 a[232:235], v[56:59], v[152:155], a[232:235]
  v_mfma_f32_16x16x32_bf16 a[232:235], v[60:63], v[156:159], a[232:235]
  v_mfma_f32_16x16x32_bf16 v[104:107], v[56:59], v[160:163], v[104:107]
  v_mfma_f32_16x16x32_bf16 v[104:107], v[60:63], v[164:167], v[104:107]
  ds_read_b64_tr_b16 v[48:49], v4 offset:57344
  ds_read_b64_tr_b16 v[50:51], v4 offset:57856
  s_waitcnt lgkmcnt(8)
  v_mfma_f32_16x16x32_bf16 a[44:47], v[32:35], v[128:131], a[44:47]
  s_waitcnt vmcnt(25)
  s_barrier
  ds_read_b64_tr_b16 v[52:53], v4 offset:61440
  s_waitcnt lgkmcnt(7)
  v_mfma_f32_16x16x32_bf16 a[44:47], v[36:39], v[132:135], a[44:47]
  s_add_u32 m0, s35, 65536
  s_add_u32 s34, s50, 3145728
  buffer_load_dwordx4 v10, s[16:19], s34 offen lds
  v_mfma_f32_16x16x32_bf16 a[108:111], v[32:35], v[136:139], a[108:111]
  ds_read_b64_tr_b16 v[54:55], v4 offset:61952
  v_mfma_f32_16x16x32_bf16 a[108:111], v[36:39], v[140:143], a[108:111]
  v_mfma_f32_16x16x32_bf16 a[172:175], v[32:35], v[144:147], a[172:175]
  buffer_load_dwordx4 v[236:239], v12, s[20:23], s39 offen offset:704
  v_mfma_f32_16x16x32_bf16 a[172:175], v[36:39], v[148:151], a[172:175]
  v_mfma_f32_16x16x32_bf16 a[236:239], v[32:35], v[152:155], a[236:239]
  v_mfma_f32_16x16x32_bf16 a[236:239], v[36:39], v[156:159], a[236:239]
  s_add_u32 m0, s35, 66560
  s_add_u32 s34, s50, 3211264
  buffer_load_dwordx4 v11, s[16:19], s34 offen lds
  v_mfma_f32_16x16x32_bf16 v[108:111], v[32:35], v[160:163], v[108:111]
  v_mfma_f32_16x16x32_bf16 v[108:111], v[36:39], v[164:167], v[108:111]
  ds_read_b64_tr_b16 v[56:57], v5 offset:57344
  ds_read_b64_tr_b16 v[58:59], v5 offset:57856
  s_waitcnt lgkmcnt(8)
  v_mfma_f32_16x16x32_bf16 a[48:51], v[40:43], v[128:131], a[48:51]
  ds_read_b64_tr_b16 v[60:61], v5 offset:61440
  ds_read_b64_tr_b16 v[62:63], v5 offset:61952
  s_waitcnt lgkmcnt(8)
  v_mfma_f32_16x16x32_bf16 a[48:51], v[44:47], v[132:135], a[48:51]
  v_mfma_f32_16x16x32_bf16 a[112:115], v[40:43], v[136:139], a[112:115]
  v_mfma_f32_16x16x32_bf16 a[112:115], v[44:47], v[140:143], a[112:115]
  s_add_u32 m0, s35, 67584
  s_add_u32 s34, s50, 3276800
  buffer_load_dwordx4 v10, s[16:19], s34 offen lds
  v_mfma_f32_16x16x32_bf16 a[176:179], v[40:43], v[144:147], a[176:179]
  v_mfma_f32_16x16x32_bf16 a[176:179], v[44:47], v[148:151], a[176:179]
  v_mfma_f32_16x16x32_bf16 a[240:243], v[40:43], v[152:155], a[240:243]
  v_mfma_f32_16x16x32_bf16 a[240:243], v[44:47], v[156:159], a[240:243]
  buffer_load_dwordx4 v[240:243], v12, s[20:23], s40 offen offset:640
  v_mfma_f32_16x16x32_bf16 v[112:115], v[40:43], v[160:163], v[112:115]
  v_mfma_f32_16x16x32_bf16 v[112:115], v[44:47], v[164:167], v[112:115]
  s_add_u32 m0, s35, 68608
  s_add_u32 s34, s50, 3342336
  buffer_load_dwordx4 v11, s[16:19], s34 offen lds
  s_waitcnt lgkmcnt(6)
  v_mfma_f32_16x16x32_bf16 a[52:55], v[48:51], v[128:131], a[52:55]
  ds_read_b64_tr_b16 v[24:25], v6 offset:57344
  ds_read_b64_tr_b16 v[26:27], v6 offset:57856
  s_waitcnt lgkmcnt(6)
  v_mfma_f32_16x16x32_bf16 a[52:55], v[52:55], v[132:135], a[52:55]
  ds_read_b64_tr_b16 v[28:29], v6 offset:61440
  ds_read_b64_tr_b16 v[30:31], v6 offset:61952
  v_mfma_f32_16x16x32_bf16 a[116:119], v[48:51], v[136:139], a[116:119]
  v_mfma_f32_16x16x32_bf16 a[116:119], v[52:55], v[140:143], a[116:119]
  v_mfma_f32_16x16x32_bf16 a[180:183], v[48:51], v[144:147], a[180:183]
  v_mfma_f32_16x16x32_bf16 a[180:183], v[52:55], v[148:151], a[180:183]
  s_add_u32 m0, s35, 69632
  s_add_u32 s34, s50, 3407872
  buffer_load_dwordx4 v10, s[16:19], s34 offen lds
  v_mfma_f32_16x16x32_bf16 a[244:247], v[48:51], v[152:155], a[244:247]
  v_mfma_f32_16x16x32_bf16 a[244:247], v[52:55], v[156:159], a[244:247]
  v_mfma_f32_16x16x32_bf16 v[116:119], v[48:51], v[160:163], v[116:119]
  v_mfma_f32_16x16x32_bf16 v[116:119], v[52:55], v[164:167], v[116:119]
  s_waitcnt lgkmcnt(6)
  v_mfma_f32_16x16x32_bf16 a[56:59], v[56:59], v[128:131], a[56:59]
  buffer_load_dwordx4 v[244:247], v12, s[20:23], s40 offen offset:704
  s_waitcnt lgkmcnt(4)
  v_mfma_f32_16x16x32_bf16 a[56:59], v[60:63], v[132:135], a[56:59]
  s_add_u32 m0, s35, 70656
  s_add_u32 s34, s50, 3473408
  buffer_load_dwordx4 v11, s[16:19], s34 offen lds
  v_mfma_f32_16x16x32_bf16 a[120:123], v[56:59], v[136:139], a[120:123]
  v_mfma_f32_16x16x32_bf16 a[120:123], v[60:63], v[140:143], a[120:123]
  v_mfma_f32_16x16x32_bf16 a[184:187], v[56:59], v[144:147], a[184:187]
  v_mfma_f32_16x16x32_bf16 a[184:187], v[60:63], v[148:151], a[184:187]
  v_mfma_f32_16x16x32_bf16 a[248:251], v[56:59], v[152:155], a[248:251]
  v_xor_b32 v3, 65536, v3
  v_xor_b32 v4, 65536, v4
  v_mfma_f32_16x16x32_bf16 a[248:251], v[60:63], v[156:159], a[248:251]
  s_add_u32 m0, s35, 71680
  s_add_u32 s34, s50, 3538944
  buffer_load_dwordx4 v10, s[16:19], s34 offen lds
  v_mfma_f32_16x16x32_bf16 v[120:123], v[56:59], v[160:163], v[120:123]
  v_xor_b32 v5, 65536, v5
  v_xor_b32 v6, 65536, v6
  v_mfma_f32_16x16x32_bf16 v[120:123], v[60:63], v[164:167], v[120:123]
  ds_read_b64_tr_b16 v[40:41], v3 offset:0
  ds_read_b64_tr_b16 v[42:43], v3 offset:512
  s_waitcnt lgkmcnt(4)
  v_mfma_f32_16x16x32_bf16 a[60:63], v[24:27], v[128:131], a[60:63]
  ds_read_b64_tr_b16 v[44:45], v3 offset:4096
  ds_read_b64_tr_b16 v[46:47], v3 offset:4608
  s_waitcnt lgkmcnt(4)
  v_mfma_f32_16x16x32_bf16 a[60:63], v[28:31], v[132:135], a[60:63]
  ds_read_b64_tr_b16 v[48:49], v4 offset:0
  ds_read_b64_tr_b16 v[50:51], v4 offset:512
  v_mfma_f32_16x16x32_bf16 a[124:127], v[24:27], v[136:139], a[124:127]
  ds_read_b64_tr_b16 v[52:53], v4 offset:4096
  ds_read_b64_tr_b16 v[54:55], v4 offset:4608
  v_mfma_f32_16x16x32_bf16 a[124:127], v[28:31], v[140:143], a[124:127]
  s_add_u32 m0, s35, 72704
  s_add_u32 s34, s50, 3604480
  buffer_load_dwordx4 v11, s[16:19], s34 offen lds
  v_mfma_f32_16x16x32_bf16 a[188:191], v[24:27], v[144:147], a[188:191]
  ds_read_b64_tr_b16 v[56:57], v5 offset:0
  ds_read_b64_tr_b16 v[58:59], v5 offset:512
  v_mfma_f32_16x16x32_bf16 a[188:191], v[28:31], v[148:151], a[188:191]
  ds_read_b64_tr_b16 v[60:61], v5 offset:4096
  ds_read_b64_tr_b16 v[62:63], v5 offset:4608
  v_mfma_f32_16x16x32_bf16 a[252:255], v[24:27], v[152:155], a[252:255]
  v_mfma_f32_16x16x32_bf16 a[252:255], v[28:31], v[156:159], a[252:255]
  v_mfma_f32_16x16x32_bf16 v[124:127], v[24:27], v[160:163], v[124:127]
  v_mfma_f32_16x16x32_bf16 v[124:127], v[28:31], v[164:167], v[124:127]
  s_waitcnt vmcnt(35) lgkmcnt(10)
  v_mfma_f32_16x16x32_bf16 a[0:3], v[40:43], v[168:171], a[0:3]
  s_waitcnt vmcnt(34) lgkmcnt(8)
  v_mfma_f32_16x16x32_bf16 a[0:3], v[44:47], v[172:175], a[0:3]
  s_waitcnt vmcnt(33)
  v_mfma_f32_16x16x32_bf16 a[64:67], v[40:43], v[176:179], a[64:67]
  s_waitcnt vmcnt(32)
  v_mfma_f32_16x16x32_bf16 a[64:67], v[44:47], v[180:183], a[64:67]
  s_waitcnt vmcnt(31)
  v_mfma_f32_16x16x32_bf16 a[128:131], v[40:43], v[184:187], a[128:131]
  s_waitcnt vmcnt(30)
  v_mfma_f32_16x16x32_bf16 a[128:131], v[44:47], v[188:191], a[128:131]
  s_waitcnt vmcnt(29)
  v_mfma_f32_16x16x32_bf16 a[192:195], v[40:43], v[192:195], a[192:195]
  s_waitcnt vmcnt(27)
  v_mfma_f32_16x16x32_bf16 a[192:195], v[44:47], v[196:199], a[192:195]
  ds_read_b64_tr_b16 v[24:25], v6 offset:0
  ds_read_b64_tr_b16 v[26:27], v6 offset:512
  s_waitcnt lgkmcnt(8)
  v_mfma_f32_16x16x32_bf16 a[4:7], v[48:51], v[168:171], a[4:7]
  ds_read_b64_tr_b16 v[28:29], v6 offset:4096
  ds_read_b64_tr_b16 v[30:31], v6 offset:4608
  s_waitcnt lgkmcnt(8)
  v_mfma_f32_16x16x32_bf16 a[4:7], v[52:55], v[172:175], a[4:7]
  buffer_load_dwordx4 v[64:67], v12, s[20:23], s36 offen offset:768
  v_mfma_f32_16x16x32_bf16 a[68:71], v[48:51], v[176:179], a[68:71]
  v_mfma_f32_16x16x32_bf16 a[68:71], v[52:55], v[180:183], a[68:71]
  v_mfma_f32_16x16x32_bf16 a[132:135], v[48:51], v[184:187], a[132:135]
  v_mfma_f32_16x16x32_bf16 a[132:135], v[52:55], v[188:191], a[132:135]
  v_mfma_f32_16x16x32_bf16 a[196:199], v[48:51], v[192:195], a[196:199]
  v_mfma_f32_16x16x32_bf16 a[196:199], v[52:55], v[196:199], a[196:199]
  ds_read_b64_tr_b16 v[32:33], v3 offset:8192
  ds_read_b64_tr_b16 v[34:35], v3 offset:8704
  s_waitcnt lgkmcnt(8)
  v_mfma_f32_16x16x32_bf16 a[8:11], v[56:59], v[168:171], a[8:11]
  ds_read_b64_tr_b16 v[36:37], v3 offset:12288
  ds_read_b64_tr_b16 v[38:39], v3 offset:12800
  s_waitcnt lgkmcnt(8)
  v_mfma_f32_16x16x32_bf16 a[8:11], v[60:63], v[172:175], a[8:11]
  v_mfma_f32_16x16x32_bf16 a[72:75], v[56:59], v[176:179], a[72:75]
  v_mfma_f32_16x16x32_bf16 a[72:75], v[60:63], v[180:183], a[72:75]
  v_mfma_f32_16x16x32_bf16 a[136:139], v[56:59], v[184:187], a[136:139]
  buffer_load_dwordx4 v[68:71], v12, s[20:23], s36 offen offset:832
  v_mfma_f32_16x16x32_bf16 a[136:139], v[60:63], v[188:191], a[136:139]
  v_mfma_f32_16x16x32_bf16 a[200:203], v[56:59], v[192:195], a[200:203]
  v_mfma_f32_16x16x32_bf16 a[200:203], v[60:63], v[196:199], a[200:203]
  ds_read_b64_tr_b16 v[48:49], v4 offset:8192
  ds_read_b64_tr_b16 v[50:51], v4 offset:8704
  s_waitcnt lgkmcnt(8)
  v_mfma_f32_16x16x32_bf16 a[12:15], v[24:27], v[168:171], a[12:15]
  ds_read_b64_tr_b16 v[52:53], v4 offset:12288
  ds_read_b64_tr_b16 v[54:55], v4 offset:12800
  s_waitcnt lgkmcnt(8)
  v_mfma_f32_16x16x32_bf16 a[12:15], v[28:31], v[172:175], a[12:15]
  v_mfma_f32_16x16x32_bf16 a[76:79], v[24:27], v[176:179], a[76:79]
  v_mfma_f32_16x16x32_bf16 a[76:79], v[28:31], v[180:183], a[76:79]
  v_mfma_f32_16x16x32_bf16 a[140:143], v[24:27], v[184:187], a[140:143]
  v_mfma_f32_16x16x32_bf16 a[140:143], v[28:31], v[188:191], a[140:143]
  v_mfma_f32_16x16x32_bf16 a[204:207], v[24:27], v[192:195], a[204:207]
  v_mfma_f32_16x16x32_bf16 a[204:207], v[28:31], v[196:199], a[204:207]
  ds_read_b64_tr_b16 v[56:57], v5 offset:8192
  ds_read_b64_tr_b16 v[58:59], v5 offset:8704
  s_waitcnt lgkmcnt(8)
  v_mfma_f32_16x16x32_bf16 a[16:19], v[32:35], v[168:171], a[16:19]
  ds_read_b64_tr_b16 v[60:61], v5 offset:12288
  ds_read_b64_tr_b16 v[62:63], v5 offset:12800
  s_waitcnt lgkmcnt(8)
  v_mfma_f32_16x16x32_bf16 a[16:19], v[36:39], v[172:175], a[16:19]
  buffer_load_dwordx4 v[72:75], v12, s[20:23], s37 offen offset:768
  v_mfma_f32_16x16x32_bf16 a[80:83], v[32:35], v[176:179], a[80:83]
  v_mfma_f32_16x16x32_bf16 a[80:83], v[36:39], v[180:183], a[80:83]
  v_mfma_f32_16x16x32_bf16 a[144:147], v[32:35], v[184:187], a[144:147]
  v_mfma_f32_16x16x32_bf16 a[144:147], v[36:39], v[188:191], a[144:147]
  v_mfma_f32_16x16x32_bf16 a[208:211], v[32:35], v[192:195], a[208:211]
  v_mfma_f32_16x16x32_bf16 a[208:211], v[36:39], v[196:199], a[208:211]
  ds_read_b64_tr_b16 v[40:41], v6 offset:8192
  ds_read_b64_tr_b16 v[42:43], v6 offset:8704
  s_waitcnt lgkmcnt(8)
  v_mfma_f32_16x16x32_bf16 a[20:23], v[48:51], v[168:171], a[20:23]
  ds_read_b64_tr_b16 v[44:45], v6 offset:12288
  ds_read_b64_tr_b16 v[46:47], v6 offset:12800
  s_waitcnt lgkmcnt(8)
  v_mfma_f32_16x16x32_bf16 a[20:23], v[52:55], v[172:175], a[20:23]
  v_mfma_f32_16x16x32_bf16 a[84:87], v[48:51], v[176:179], a[84:87]
  v_mfma_f32_16x16x32_bf16 a[84:87], v[52:55], v[180:183], a[84:87]
  v_mfma_f32_16x16x32_bf16 a[148:151], v[48:51], v[184:187], a[148:151]
  v_mfma_f32_16x16x32_bf16 a[148:151], v[52:55], v[188:191], a[148:151]
  v_mfma_f32_16x16x32_bf16 a[212:215], v[48:51], v[192:195], a[212:215]
  buffer_load_dwordx4 v[76:79], v12, s[20:23], s37 offen offset:832
  v_mfma_f32_16x16x32_bf16 a[212:215], v[52:55], v[196:199], a[212:215]
  ds_read_b64_tr_b16 v[24:25], v3 offset:16384
  ds_read_b64_tr_b16 v[26:27], v3 offset:16896
  s_waitcnt lgkmcnt(8)
  v_mfma_f32_16x16x32_bf16 a[24:27], v[56:59], v[168:171], a[24:27]
  ds_read_b64_tr_b16 v[28:29], v3 offset:20480
  ds_read_b64_tr_b16 v[30:31], v3 offset:20992
  s_waitcnt lgkmcnt(8)
  v_mfma_f32_16x16x32_bf16 a[24:27], v[60:63], v[172:175], a[24:27]
  v_mfma_f32_16x16x32_bf16 a[88:91], v[56:59], v[176:179], a[88:91]
  v_mfma_f32_16x16x32_bf16 a[88:91], v[60:63], v[180:183], a[88:91]
  v_mfma_f32_16x16x32_bf16 a[152:155], v[56:59], v[184:187], a[152:155]
  v_mfma_f32_16x16x32_bf16 a[152:155], v[60:63], v[188:191], a[152:155]
  v_mfma_f32_16x16x32_bf16 a[216:219], v[56:59], v[192:195], a[216:219]
  v_mfma_f32_16x16x32_bf16 a[216:219], v[60:63], v[196:199], a[216:219]
  ds_read_b64_tr_b16 v[48:49], v4 offset:16384
  ds_read_b64_tr_b16 v[50:51], v4 offset:16896
  s_waitcnt lgkmcnt(8)
  v_mfma_f32_16x16x32_bf16 a[28:31], v[40:43], v[168:171], a[28:31]
  ds_read_b64_tr_b16 v[52:53], v4 offset:20480
  ds_read_b64_tr_b16 v[54:55], v4 offset:20992
  s_waitcnt lgkmcnt(8)
  v_mfma_f32_16x16x32_bf16 a[28:31], v[44:47], v[172:175], a[28:31]
  v_mfma_f32_16x16x32_bf16 a[92:95], v[40:43], v[176:179], a[92:95]
  v_mfma_f32_16x16x32_bf16 a[92:95], v[44:47], v[180:183], a[92:95]
  buffer_load_dwordx4 v[80:83], v12, s[20:23], s38 offen offset:768
  v_mfma_f32_16x16x32_bf16 a[156:159], v[40:43], v[184:187], a[156:159]
  v_mfma_f32_16x16x32_bf16 a[156:159], v[44:47], v[188:191], a[156:159]
  v_mfma_f32_16x16x32_bf16 a[220:223], v[40:43], v[192:195], a[220:223]
  v_mfma_f32_16x16x32_bf16 a[220:223], v[44:47], v[196:199], a[220:223]
  ds_read_b64_tr_b16 v[56:57], v5 offset:16384
  ds_read_b64_tr_b16 v[58:59], v5 offset:16896
  s_waitcnt lgkmcnt(8)
  v_mfma_f32_16x16x32_bf16 a[32:35], v[24:27], v[168:171], a[32:35]
  ds_read_b64_tr_b16 v[60:61], v5 offset:20480
  ds_read_b64_tr_b16 v[62:63], v5 offset:20992
  s_waitcnt lgkmcnt(8)
  v_mfma_f32_16x16x32_bf16 a[32:35], v[28:31], v[172:175], a[32:35]
  v_mfma_f32_16x16x32_bf16 a[96:99], v[24:27], v[176:179], a[96:99]
  v_mfma_f32_16x16x32_bf16 a[96:99], v[28:31], v[180:183], a[96:99]
  v_mfma_f32_16x16x32_bf16 a[160:163], v[24:27], v[184:187], a[160:163]
  v_mfma_f32_16x16x32_bf16 a[160:163], v[28:31], v[188:191], a[160:163]
  v_mfma_f32_16x16x32_bf16 a[224:227], v[24:27], v[192:195], a[224:227]
  v_mfma_f32_16x16x32_bf16 a[224:227], v[28:31], v[196:199], a[224:227]
  s_waitcnt vmcnt(29)
  v_mfma_f32_16x16x32_bf16 v[96:99], v[24:27], v[200:203], v[96:99]
  buffer_load_dwordx4 v[84:87], v12, s[20:23], s38 offen offset:832
  s_waitcnt vmcnt(27)
  v_mfma_f32_16x16x32_bf16 v[96:99], v[28:31], v[204:207], v[96:99]
  ds_read_b64_tr_b16 v[32:33], v6 offset:16384
  ds_read_b64_tr_b16 v[34:35], v6 offset:16896
  s_waitcnt lgkmcnt(8)
  v_mfma_f32_16x16x32_bf16 a[36:39], v[48:51], v[168:171], a[36:39]
  ds_read_b64_tr_b16 v[36:37], v6 offset:20480
  ds_read_b64_tr_b16 v[38:39], v6 offset:20992
  s_waitcnt lgkmcnt(8)
  v_mfma_f32_16x16x32_bf16 a[36:39], v[52:55], v[172:175], a[36:39]
  v_mfma_f32_16x16x32_bf16 a[100:103], v[48:51], v[176:179], a[100:103]
  v_mfma_f32_16x16x32_bf16 a[100:103], v[52:55], v[180:183], a[100:103]
  v_mfma_f32_16x16x32_bf16 a[164:167], v[48:51], v[184:187], a[164:167]
  v_mfma_f32_16x16x32_bf16 a[164:167], v[52:55], v[188:191], a[164:167]
  v_mfma_f32_16x16x32_bf16 a[228:231], v[48:51], v[192:195], a[228:231]
  v_mfma_f32_16x16x32_bf16 a[228:231], v[52:55], v[196:199], a[228:231]
  v_mfma_f32_16x16x32_bf16 v[100:103], v[48:51], v[200:203], v[100:103]
  v_mfma_f32_16x16x32_bf16 v[100:103], v[52:55], v[204:207], v[100:103]
  ds_read_b64_tr_b16 v[40:41], v3 offset:24576
  ds_read_b64_tr_b16 v[42:43], v3 offset:25088
  s_waitcnt lgkmcnt(8)
  v_mfma_f32_16x16x32_bf16 a[40:43], v[56:59], v[168:171], a[40:43]
  ds_read_b64_tr_b16 v[44:45], v3 offset:28672
  ds_read_b64_tr_b16 v[46:47], v3 offset:29184
  s_waitcnt lgkmcnt(8)
  v_mfma_f32_16x16x32_bf16 a[40:43], v[60:63], v[172:175], a[40:43]
  buffer_load_dwordx4 v[88:91], v12, s[20:23], s39 offen offset:768
  v_mfma_f32_16x16x32_bf16 a[104:107], v[56:59], v[176:179], a[104:107]
  v_mfma_f32_16x16x32_bf16 a[104:107], v[60:63], v[180:183], a[104:107]
  v_mfma_f32_16x16x32_bf16 a[168:171], v[56:59], v[184:187], a[168:171]
  v_mfma_f32_16x16x32_bf16 a[168:171], v[60:63], v[188:191], a[168:171]
  v_mfma_f32_16x16x32_bf16 a[232:235], v[56:59], v[192:195], a[232:235]
  v_mfma_f32_16x16x32_bf16 a[232:235], v[60:63], v[196:199], a[232:235]
  v_mfma_f32_16x16x32_bf16 v[104:107], v[56:59], v[200:203], v[104:107]
  v_mfma_f32_16x16x32_bf16 v[104:107], v[60:63], v[204:207], v[104:107]
  ds_read_b64_tr_b16 v[48:49], v4 offset:24576
  ds_read_b64_tr_b16 v[50:51], v4 offset:25088
  s_waitcnt lgkmcnt(8)
  v_mfma_f32_16x16x32_bf16 a[44:47], v[32:35], v[168:171], a[44:47]
  s_waitcnt vmcnt(25)
  s_barrier
  ds_read_b64_tr_b16 v[52:53], v4 offset:28672
  s_waitcnt lgkmcnt(7)
  v_mfma_f32_16x16x32_bf16 a[44:47], v[36:39], v[172:175], a[44:47]
  s_add_u32 m0, s32, 0
  s_add_u32 s34, s30, 0
  buffer_load_dwordx4 v7, s[8:11], s34 offen nt lds
  v_mfma_f32_16x16x32_bf16 a[108:111], v[32:35], v[176:179], a[108:111]
  ds_read_b64_tr_b16 v[54:55], v4 offset:29184
  v_mfma_f32_16x16x32_bf16 a[108:111], v[36:39], v[180:183], a[108:111]
  v_mfma_f32_16x16x32_bf16 a[172:175], v[32:35], v[184:187], a[172:175]
  buffer_load_dwordx4 v[92:95], v12, s[20:23], s39 offen offset:832
  v_mfma_f32_16x16x32_bf16 a[172:175], v[36:39], v[188:191], a[172:175]
  v_mfma_f32_16x16x32_bf16 a[236:239], v[32:35], v[192:195], a[236:239]
  v_mfma_f32_16x16x32_bf16 a[236:239], v[36:39], v[196:199], a[236:239]
  s_add_u32 m0, s32, 1024
  s_add_u32 s34, s30, 4096
  buffer_load_dwordx4 v7, s[8:11], s34 offen nt lds
  v_mfma_f32_16x16x32_bf16 v[108:111], v[32:35], v[200:203], v[108:111]
  v_mfma_f32_16x16x32_bf16 v[108:111], v[36:39], v[204:207], v[108:111]
  ds_read_b64_tr_b16 v[56:57], v5 offset:24576
  ds_read_b64_tr_b16 v[58:59], v5 offset:25088
  s_waitcnt lgkmcnt(8)
  v_mfma_f32_16x16x32_bf16 a[48:51], v[40:43], v[168:171], a[48:51]
  ds_read_b64_tr_b16 v[60:61], v5 offset:28672
  ds_read_b64_tr_b16 v[62:63], v5 offset:29184
  s_waitcnt lgkmcnt(8)
  v_mfma_f32_16x16x32_bf16 a[48:51], v[44:47], v[172:175], a[48:51]
  v_mfma_f32_16x16x32_bf16 a[112:115], v[40:43], v[176:179], a[112:115]
  v_mfma_f32_16x16x32_bf16 a[112:115], v[44:47], v[180:183], a[112:115]
  s_add_u32 m0, s32, 2048
  s_add_u32 s34, s30, 8192
  buffer_load_dwordx4 v7, s[8:11], s34 offen nt lds
  v_mfma_f32_16x16x32_bf16 a[176:179], v[40:43], v[184:187], a[176:179]
  v_mfma_f32_16x16x32_bf16 a[176:179], v[44:47], v[188:191], a[176:179]
  v_mfma_f32_16x16x32_bf16 a[240:243], v[40:43], v[192:195], a[240:243]
  v_mfma_f32_16x16x32_bf16 a[240:243], v[44:47], v[196:199], a[240:243]
  buffer_load_dwordx4 v[16:19], v12, s[20:23], s40 offen offset:768
  v_mfma_f32_16x16x32_bf16 v[112:115], v[40:43], v[200:203], v[112:115]
  v_mfma_f32_16x16x32_bf16 v[112:115], v[44:47], v[204:207], v[112:115]
  s_add_u32 m0, s32, 3072
  s_add_u32 s34, s30, 12288
  buffer_load_dwordx4 v7, s[8:11], s34 offen nt lds
  s_waitcnt lgkmcnt(6)
  v_mfma_f32_16x16x32_bf16 a[52:55], v[48:51], v[168:171], a[52:55]
  ds_read_b64_tr_b16 v[24:25], v6 offset:24576
  ds_read_b64_tr_b16 v[26:27], v6 offset:25088
  s_waitcnt lgkmcnt(6)
  v_mfma_f32_16x16x32_bf16 a[52:55], v[52:55], v[172:175], a[52:55]
  ds_read_b64_tr_b16 v[28:29], v6 offset:28672
  ds_read_b64_tr_b16 v[30:31], v6 offset:29184
  v_mfma_f32_16x16x32_bf16 a[116:119], v[48:51], v[176:179], a[116:119]
  ds_read_b64_tr_b16 v[40:41], v3 offset:32768
  ds_read_b64_tr_b16 v[42:43], v3 offset:33280
  v_mfma_f32_16x16x32_bf16 a[116:119], v[52:55], v[180:183], a[116:119]
  ds_read_b64_tr_b16 v[44:45], v3 offset:36864
  ds_read_b64_tr_b16 v[46:47], v3 offset:37376
  v_mfma_f32_16x16x32_bf16 a[180:183], v[48:51], v[184:187], a[180:183]
  v_mfma_f32_16x16x32_bf16 a[180:183], v[52:55], v[188:191], a[180:183]
  s_add_u32 m0, s32, 4096
  s_add_u32 s34, s30, 16384
  buffer_load_dwordx4 v7, s[8:11], s34 offen nt lds
  v_mfma_f32_16x16x32_bf16 a[244:247], v[48:51], v[192:195], a[244:247]
  v_mfma_f32_16x16x32_bf16 a[244:247], v[52:55], v[196:199], a[244:247]
  v_mfma_f32_16x16x32_bf16 v[116:119], v[48:51], v[200:203], v[116:119]
  v_mfma_f32_16x16x32_bf16 v[116:119], v[52:55], v[204:207], v[116:119]
  ds_read_b64_tr_b16 v[48:49], v4 offset:32768
  ds_read_b64_tr_b16 v[50:51], v4 offset:33280
  s_waitcnt lgkmcnt(12)
  v_mfma_f32_16x16x32_bf16 a[56:59], v[56:59], v[168:171], a[56:59]
  buffer_load_dwordx4 v[20:23], v12, s[20:23], s40 offen offset:832
  ds_read_b64_tr_b16 v[52:53], v4 offset:36864
  s_waitcnt lgkmcnt(11)
  v_mfma_f32_16x16x32_bf16 a[56:59], v[60:63], v[172:175], a[56:59]
  s_add_u32 m0, s32, 5120
  s_add_u32 s34, s30, 20480
  buffer_load_dwordx4 v7, s[8:11], s34 offen nt lds
  v_mfma_f32_16x16x32_bf16 a[120:123], v[56:59], v[176:179], a[120:123]
  ds_read_b64_tr_b16 v[54:55], v4 offset:37376
  v_mfma_f32_16x16x32_bf16 a[120:123], v[60:63], v[180:183], a[120:123]
  v_mfma_f32_16x16x32_bf16 a[184:187], v[56:59], v[184:187], a[184:187]
  v_mfma_f32_16x16x32_bf16 a[184:187], v[60:63], v[188:191], a[184:187]
  v_mfma_f32_16x16x32_bf16 a[248:251], v[56:59], v[192:195], a[248:251]
  v_mfma_f32_16x16x32_bf16 a[248:251], v[60:63], v[196:199], a[248:251]
  s_add_u32 m0, s32, 6144
  s_add_u32 s34, s30, 24576
  buffer_load_dwordx4 v7, s[8:11], s34 offen nt lds
  v_mfma_f32_16x16x32_bf16 v[120:123], v[56:59], v[200:203], v[120:123]
  v_mfma_f32_16x16x32_bf16 v[120:123], v[60:63], v[204:207], v[120:123]
  ds_read_b64_tr_b16 v[56:57], v5 offset:32768
  ds_read_b64_tr_b16 v[58:59], v5 offset:33280
  s_waitcnt lgkmcnt(12)
  v_mfma_f32_16x16x32_bf16 a[60:63], v[24:27], v[168:171], a[60:63]
  ds_read_b64_tr_b16 v[60:61], v5 offset:36864
  ds_read_b64_tr_b16 v[62:63], v5 offset:37376
  s_waitcnt lgkmcnt(12)
  v_mfma_f32_16x16x32_bf16 a[60:63], v[28:31], v[172:175], a[60:63]
  v_mfma_f32_16x16x32_bf16 a[124:127], v[24:27], v[176:179], a[124:127]
  v_mfma_f32_16x16x32_bf16 a[124:127], v[28:31], v[180:183], a[124:127]
  s_add_u32 m0, s32, 7168
  s_add_u32 s34, s30, 28672
  buffer_load_dwordx4 v7, s[8:11], s34 offen nt lds
  s_add_u32 s30, s30, 32768
  s_xor_b32 s32, s32, 65536
  v_mfma_f32_16x16x32_bf16 a[188:191], v[24:27], v[184:187], a[188:191]
  v_mfma_f32_16x16x32_bf16 a[188:191], v[28:31], v[188:191], a[188:191]
  v_mfma_f32_16x16x32_bf16 a[252:255], v[24:27], v[192:195], a[252:255]
  v_mfma_f32_16x16x32_bf16 a[252:255], v[28:31], v[196:199], a[252:255]
  v_mfma_f32_16x16x32_bf16 v[124:127], v[24:27], v[200:203], v[124:127]
  v_mfma_f32_16x16x32_bf16 v[124:127], v[28:31], v[204:207], v[124:127]
  s_waitcnt vmcnt(35) lgkmcnt(10)
  v_mfma_f32_16x16x32_bf16 a[0:3], v[40:43], v[208:211], a[0:3]
  s_waitcnt vmcnt(34) lgkmcnt(8)
  v_mfma_f32_16x16x32_bf16 a[0:3], v[44:47], v[212:215], a[0:3]
  s_waitcnt vmcnt(33)
  v_mfma_f32_16x16x32_bf16 a[64:67], v[40:43], v[216:219], a[64:67]
  s_waitcnt vmcnt(32)
  v_mfma_f32_16x16x32_bf16 a[64:67], v[44:47], v[220:223], a[64:67]
  s_waitcnt vmcnt(31)
  v_mfma_f32_16x16x32_bf16 a[128:131], v[40:43], v[224:227], a[128:131]
  s_waitcnt vmcnt(30)
  v_mfma_f32_16x16x32_bf16 a[128:131], v[44:47], v[228:231], a[128:131]
  s_waitcnt vmcnt(29)
  v_mfma_f32_16x16x32_bf16 a[192:195], v[40:43], v[232:235], a[192:195]
  s_waitcnt vmcnt(27)
  v_mfma_f32_16x16x32_bf16 a[192:195], v[44:47], v[236:239], a[192:195]
  ds_read_b64_tr_b16 v[24:25], v6 offset:32768
  ds_read_b64_tr_b16 v[26:27], v6 offset:33280
  s_waitcnt lgkmcnt(8)
  v_mfma_f32_16x16x32_bf16 a[4:7], v[48:51], v[208:211], a[4:7]
  ds_read_b64_tr_b16 v[28:29], v6 offset:36864
  ds_read_b64_tr_b16 v[30:31], v6 offset:37376
  s_waitcnt lgkmcnt(8)
  v_mfma_f32_16x16x32_bf16 a[4:7], v[52:55], v[212:215], a[4:7]
  v_mfma_f32_16x16x32_bf16 a[68:71], v[48:51], v[216:219], a[68:71]
  v_mfma_f32_16x16x32_bf16 a[68:71], v[52:55], v[220:223], a[68:71]
  v_mfma_f32_16x16x32_bf16 a[132:135], v[48:51], v[224:227], a[132:135]
  v_mfma_f32_16x16x32_bf16 a[132:135], v[52:55], v[228:231], a[132:135]
  v_mfma_f32_16x16x32_bf16 a[196:199], v[48:51], v[232:235], a[196:199]
  v_mfma_f32_16x16x32_bf16 a[196:199], v[52:55], v[236:239], a[196:199]
  ds_read_b64_tr_b16 v[32:33], v3 offset:40960
  ds_read_b64_tr_b16 v[34:35], v3 offset:41472
  s_waitcnt lgkmcnt(8)
  v_mfma_f32_16x16x32_bf16 a[8:11], v[56:59], v[208:211], a[8:11]
  ds_read_b64_tr_b16 v[36:37], v3 offset:45056
  ds_read_b64_tr_b16 v[38:39], v3 offset:45568
  s_waitcnt lgkmcnt(8)
  v_mfma_f32_16x16x32_bf16 a[8:11], v[60:63], v[212:215], a[8:11]
  v_mfma_f32_16x16x32_bf16 a[72:75], v[56:59], v[216:219], a[72:75]
  v_mfma_f32_16x16x32_bf16 a[72:75], v[60:63], v[220:223], a[72:75]
  v_mfma_f32_16x16x32_bf16 a[136:139], v[56:59], v[224:227], a[136:139]
  v_mfma_f32_16x16x32_bf16 a[136:139], v[60:63], v[228:231], a[136:139]
  v_mfma_f32_16x16x32_bf16 a[200:203], v[56:59], v[232:235], a[200:203]
  v_mfma_f32_16x16x32_bf16 a[200:203], v[60:63], v[236:239], a[200:203]
  ds_read_b64_tr_b16 v[48:49], v4 offset:40960
  ds_read_b64_tr_b16 v[50:51], v4 offset:41472
  s_waitcnt lgkmcnt(8)
  v_mfma_f32_16x16x32_bf16 a[12:15], v[24:27], v[208:211], a[12:15]
  ds_read_b64_tr_b16 v[52:53], v4 offset:45056
  ds_read_b64_tr_b16 v[54:55], v4 offset:45568
  s_waitcnt lgkmcnt(8)
  v_mfma_f32_16x16x32_bf16 a[12:15], v[28:31], v[212:215], a[12:15]
  v_mfma_f32_16x16x32_bf16 a[76:79], v[24:27], v[216:219], a[76:79]
  v_mfma_f32_16x16x32_bf16 a[76:79], v[28:31], v[220:223], a[76:79]
  v_mfma_f32_16x16x32_bf16 a[140:143], v[24:27], v[224:227], a[140:143]
  v_mfma_f32_16x16x32_bf16 a[140:143], v[28:31], v[228:231], a[140:143]
  v_mfma_f32_16x16x32_bf16 a[204:207], v[24:27], v[232:235], a[204:207]
  v_mfma_f32_16x16x32_bf16 a[204:207], v[28:31], v[236:239], a[204:207]
  ds_read_b64_tr_b16 v[56:57], v5 offset:40960
  ds_read_b64_tr_b16 v[58:59], v5 offset:41472
  s_waitcnt lgkmcnt(8)
  v_mfma_f32_16x16x32_bf16 a[16:19], v[32:35], v[208:211], a[16:19]
  ds_read_b64_tr_b16 v[60:61], v5 offset:45056
  ds_read_b64_tr_b16 v[62:63], v5 offset:45568
  s_waitcnt lgkmcnt(8)
  v_mfma_f32_16x16x32_bf16 a[16:19], v[36:39], v[212:215], a[16:19]
  v_mfma_f32_16x16x32_bf16 a[80:83], v[32:35], v[216:219], a[80:83]
  v_mfma_f32_16x16x32_bf16 a[80:83], v[36:39], v[220:223], a[80:83]
  v_mfma_f32_16x16x32_bf16 a[144:147], v[32:35], v[224:227], a[144:147]
  v_mfma_f32_16x16x32_bf16 a[144:147], v[36:39], v[228:231], a[144:147]
  v_mfma_f32_16x16x32_bf16 a[208:211], v[32:35], v[232:235], a[208:211]
  v_mfma_f32_16x16x32_bf16 a[208:211], v[36:39], v[236:239], a[208:211]
  ds_read_b64_tr_b16 v[40:41], v6 offset:40960
  ds_read_b64_tr_b16 v[42:43], v6 offset:41472
  s_waitcnt lgkmcnt(8)
  v_mfma_f32_16x16x32_bf16 a[20:23], v[48:51], v[208:211], a[20:23]
  ds_read_b64_tr_b16 v[44:45], v6 offset:45056
  ds_read_b64_tr_b16 v[46:47], v6 offset:45568
  s_waitcnt lgkmcnt(8)
  v_mfma_f32_16x16x32_bf16 a[20:23], v[52:55], v[212:215], a[20:23]
  v_mfma_f32_16x16x32_bf16 a[84:87], v[48:51], v[216:219], a[84:87]
  v_mfma_f32_16x16x32_bf16 a[84:87], v[52:55], v[220:223], a[84:87]
  v_mfma_f32_16x16x32_bf16 a[148:151], v[48:51], v[224:227], a[148:151]
  v_mfma_f32_16x16x32_bf16 a[148:151], v[52:55], v[228:231], a[148:151]
  v_mfma_f32_16x16x32_bf16 a[212:215], v[48:51], v[232:235], a[212:215]
  v_mfma_f32_16x16x32_bf16 a[212:215], v[52:55], v[236:239], a[212:215]
  ds_read_b64_tr_b16 v[24:25], v3 offset:49152
  ds_read_b64_tr_b16 v[26:27], v3 offset:49664
  s_waitcnt lgkmcnt(8)
  v_mfma_f32_16x16x32_bf16 a[24:27], v[56:59], v[208:211], a[24:27]
  ds_read_b64_tr_b16 v[28:29], v3 offset:53248
  ds_read_b64_tr_b16 v[30:31], v3 offset:53760
  s_waitcnt lgkmcnt(8)
  v_mfma_f32_16x16x32_bf16 a[24:27], v[60:63], v[212:215], a[24:27]
  v_mfma_f32_16x16x32_bf16 a[88:91], v[56:59], v[216:219], a[88:91]
  v_mfma_f32_16x16x32_bf16 a[88:91], v[60:63], v[220:223], a[88:91]
  v_mfma_f32_16x16x32_bf16 a[152:155], v[56:59], v[224:227], a[152:155]
  v_mfma_f32_16x16x32_bf16 a[152:155], v[60:63], v[228:231], a[152:155]
  v_mfma_f32_16x16x32_bf16 a[216:219], v[56:59], v[232:235], a[216:219]
  v_mfma_f32_16x16x32_bf16 a[216:219], v[60:63], v[236:239], a[216:219]
  ds_read_b64_tr_b16 v[48:49], v4 offset:49152
  ds_read_b64_tr_b16 v[50:51], v4 offset:49664
  s_waitcnt lgkmcnt(8)
  v_mfma_f32_16x16x32_bf16 a[28:31], v[40:43], v[208:211], a[28:31]
  ds_read_b64_tr_b16 v[52:53], v4 offset:53248
  ds_read_b64_tr_b16 v[54:55], v4 offset:53760
  s_waitcnt lgkmcnt(8)
  v_mfma_f32_16x16x32_bf16 a[28:31], v[44:47], v[212:215], a[28:31]
  v_mfma_f32_16x16x32_bf16 a[92:95], v[40:43], v[216:219], a[92:95]
  v_mfma_f32_16x16x32_bf16 a[92:95], v[44:47], v[220:223], a[92:95]
  v_mfma_f32_16x16x32_bf16 a[156:159], v[40:43], v[224:227], a[156:159]
  v_mfma_f32_16x16x32_bf16 a[156:159], v[44:47], v[228:231], a[156:159]
  v_mfma_f32_16x16x32_bf16 a[220:223], v[40:43], v[232:235], a[220:223]
  v_mfma_f32_16x16x32_bf16 a[220:223], v[44:47], v[236:239], a[220:223]
  ds_read_b64_tr_b16 v[56:57], v5 offset:49152
  ds_read_b64_tr_b16 v[58:59], v5 offset:49664
  s_waitcnt lgkmcnt(8)
  v_mfma_f32_16x16x32_bf16 a[32:35], v[24:27], v[208:211], a[32:35]
  ds_read_b64_tr_b16 v[60:61], v5 offset:53248
  ds_read_b64_tr_b16 v[62:63], v5 offset:53760
  s_waitcnt lgkmcnt(8)
  v_mfma_f32_16x16x32_bf16 a[32:35], v[28:31], v[212:215], a[32:35]
  v_mfma_f32_16x16x32_bf16 a[96:99], v[24:27], v[216:219], a[96:99]
  v_mfma_f32_16x16x32_bf16 a[96:99], v[28:31], v[220:223], a[96:99]
  v_mfma_f32_16x16x32_bf16 a[160:163], v[24:27], v[224:227], a[160:163]
  v_mfma_f32_16x16x32_bf16 a[160:163], v[28:31], v[228:231], a[160:163]
  v_mfma_f32_16x16x32_bf16 a[224:227], v[24:27], v[232:235], a[224:227]
  v_mfma_f32_16x16x32_bf16 a[224:227], v[28:31], v[236:239], a[224:227]
  s_waitcnt vmcnt(24)
  v_mfma_f32_16x16x32_bf16 v[96:99], v[24:27], v[240:243], v[96:99]
  s_waitcnt vmcnt(21)
  v_mfma_f32_16x16x32_bf16 v[96:99], v[28:31], v[244:247], v[96:99]
  ds_read_b64_tr_b16 v[32:33], v6 offset:49152
  ds_read_b64_tr_b16 v[34:35], v6 offset:49664
  s_waitcnt lgkmcnt(8)
  v_mfma_f32_16x16x32_bf16 a[36:39], v[48:51], v[208:211], a[36:39]
  ds_read_b64_tr_b16 v[36:37], v6 offset:53248
  ds_read_b64_tr_b16 v[38:39], v6 offset:53760
  s_waitcnt lgkmcnt(8)
  v_mfma_f32_16x16x32_bf16 a[36:39], v[52:55], v[212:215], a[36:39]
  v_mfma_f32_16x16x32_bf16 a[100:103], v[48:51], v[216:219], a[100:103]
  v_mfma_f32_16x16x32_bf16 a[100:103], v[52:55], v[220:223], a[100:103]
  v_mfma_f32_16x16x32_bf16 a[164:167], v[48:51], v[224:227], a[164:167]
  v_mfma_f32_16x16x32_bf16 a[164:167], v[52:55], v[228:231], a[164:167]
  v_mfma_f32_16x16x32_bf16 a[228:231], v[48:51], v[232:235], a[228:231]
  v_mfma_f32_16x16x32_bf16 a[228:231], v[52:55], v[236:239], a[228:231]
  v_mfma_f32_16x16x32_bf16 v[100:103], v[48:51], v[240:243], v[100:103]
  v_mfma_f32_16x16x32_bf16 v[100:103], v[52:55], v[244:247], v[100:103]
  ds_read_b64_tr_b16 v[40:41], v3 offset:57344
  ds_read_b64_tr_b16 v[42:43], v3 offset:57856
  s_waitcnt lgkmcnt(8)
  v_mfma_f32_16x16x32_bf16 a[40:43], v[56:59], v[208:211], a[40:43]
  ds_read_b64_tr_b16 v[44:45], v3 offset:61440
  ds_read_b64_tr_b16 v[46:47], v3 offset:61952
  s_waitcnt lgkmcnt(8)
  v_mfma_f32_16x16x32_bf16 a[40:43], v[60:63], v[212:215], a[40:43]
  v_mfma_f32_16x16x32_bf16 a[104:107], v[56:59], v[216:219], a[104:107]
  v_mfma_f32_16x16x32_bf16 a[104:107], v[60:63], v[220:223], a[104:107]
  v_mfma_f32_16x16x32_bf16 a[168:171], v[56:59], v[224:227], a[168:171]
  v_mfma_f32_16x16x32_bf16 a[168:171], v[60:63], v[228:231], a[168:171]
  v_mfma_f32_16x16x32_bf16 a[232:235], v[56:59], v[232:235], a[232:235]
  v_mfma_f32_16x16x32_bf16 a[232:235], v[60:63], v[236:239], a[232:235]
  v_mfma_f32_16x16x32_bf16 v[104:107], v[56:59], v[240:243], v[104:107]
  v_mfma_f32_16x16x32_bf16 v[104:107], v[60:63], v[244:247], v[104:107]
  ds_read_b64_tr_b16 v[48:49], v4 offset:57344
  ds_read_b64_tr_b16 v[50:51], v4 offset:57856
  s_waitcnt lgkmcnt(8)
  v_mfma_f32_16x16x32_bf16 a[44:47], v[32:35], v[208:211], a[44:47]
  s_waitcnt vmcnt(18)
  s_barrier
  ds_read_b64_tr_b16 v[52:53], v4 offset:61440
  s_waitcnt lgkmcnt(7)
  v_mfma_f32_16x16x32_bf16 a[44:47], v[36:39], v[212:215], a[44:47]
  s_add_u32 m0, s33, 0
  s_add_u32 s34, s31, 0
  buffer_load_dwordx4 v8, s[12:15], s34 offen nt lds
  v_mfma_f32_16x16x32_bf16 a[108:111], v[32:35], v[216:219], a[108:111]
  ds_read_b64_tr_b16 v[54:55], v4 offset:61952
  v_mfma_f32_16x16x32_bf16 a[108:111], v[36:39], v[220:223], a[108:111]
  v_mfma_f32_16x16x32_bf16 a[172:175], v[32:35], v[224:227], a[172:175]
  v_mfma_f32_16x16x32_bf16 a[172:175], v[36:39], v[228:231], a[172:175]
  v_mfma_f32_16x16x32_bf16 a[236:239], v[32:35], v[232:235], a[236:239]
  v_mfma_f32_16x16x32_bf16 a[236:239], v[36:39], v[236:239], a[236:239]
  s_add_u32 m0, s33, 1024
  s_add_u32 s34, s31, 4096
  buffer_load_dwordx4 v8, s[12:15], s34 offen nt lds
  v_mfma_f32_16x16x32_bf16 v[108:111], v[32:35], v[240:243], v[108:111]
  v_mfma_f32_16x16x32_bf16 v[108:111], v[36:39], v[244:247], v[108:111]
  ds_read_b64_tr_b16 v[56:57], v5 offset:57344
  ds_read_b64_tr_b16 v[58:59], v5 offset:57856
  s_waitcnt lgkmcnt(8)
  v_mfma_f32_16x16x32_bf16 a[48:51], v[40:43], v[208:211], a[48:51]
  ds_read_b64_tr_b16 v[60:61], v5 offset:61440
  ds_read_b64_tr_b16 v[62:63], v5 offset:61952
  s_waitcnt lgkmcnt(8)
  v_mfma_f32_16x16x32_bf16 a[48:51], v[44:47], v[212:215], a[48:51]
  v_mfma_f32_16x16x32_bf16 a[112:115], v[40:43], v[216:219], a[112:115]
  v_mfma_f32_16x16x32_bf16 a[112:115], v[44:47], v[220:223], a[112:115]
  s_add_u32 m0, s33, 2048
  s_add_u32 s34, s31, 8192
  buffer_load_dwordx4 v8, s[12:15], s34 offen nt lds
  v_mfma_f32_16x16x32_bf16 a[176:179], v[40:43], v[224:227], a[176:179]
  v_mfma_f32_16x16x32_bf16 a[176:179], v[44:47], v[228:231], a[176:179]
  v_mfma_f32_16x16x32_bf16 a[240:243], v[40:43], v[232:235], a[240:243]
  v_mfma_f32_16x16x32_bf16 a[240:243], v[44:47], v[236:239], a[240:243]
  v_mfma_f32_16x16x32_bf16 v[112:115], v[40:43], v[240:243], v[112:115]
  v_mfma_f32_16x16x32_bf16 v[112:115], v[44:47], v[244:247], v[112:115]
  s_add_u32 m0, s33, 3072
  s_add_u32 s34, s31, 12288
  buffer_load_dwordx4 v8, s[12:15], s34 offen nt lds
  s_waitcnt lgkmcnt(6)
  v_mfma_f32_16x16x32_bf16 a[52:55], v[48:51], v[208:211], a[52:55]
  ds_read_b64_tr_b16 v[24:25], v6 offset:57344
  ds_read_b64_tr_b16 v[26:27], v6 offset:57856
  s_waitcnt lgkmcnt(6)
  v_mfma_f32_16x16x32_bf16 a[52:55], v[52:55], v[212:215], a[52:55]
  ds_read_b64_tr_b16 v[28:29], v6 offset:61440
  ds_read_b64_tr_b16 v[30:31], v6 offset:61952
  v_mfma_f32_16x16x32_bf16 a[116:119], v[48:51], v[216:219], a[116:119]
  v_mfma_f32_16x16x32_bf16 a[116:119], v[52:55], v[220:223], a[116:119]
  v_mfma_f32_16x16x32_bf16 a[180:183], v[48:51], v[224:227], a[180:183]
  v_mfma_f32_16x16x32_bf16 a[180:183], v[52:55], v[228:231], a[180:183]
  s_add_u32 m0, s33, 4096
  s_add_u32 s34, s31, 16384
  buffer_load_dwordx4 v8, s[12:15], s34 offen nt lds
  v_mfma_f32_16x16x32_bf16 a[244:247], v[48:51], v[232:235], a[244:247]
  v_mfma_f32_16x16x32_bf16 a[244:247], v[52:55], v[236:239], a[244:247]
  v_mfma_f32_16x16x32_bf16 v[116:119], v[48:51], v[240:243], v[116:119]
  v_mfma_f32_16x16x32_bf16 v[116:119], v[52:55], v[244:247], v[116:119]
  s_waitcnt lgkmcnt(6)
  v_mfma_f32_16x16x32_bf16 a[56:59], v[56:59], v[208:211], a[56:59]
  s_waitcnt lgkmcnt(4)
  v_mfma_f32_16x16x32_bf16 a[56:59], v[60:63], v[212:215], a[56:59]
  s_add_u32 m0, s33, 5120
  s_add_u32 s34, s31, 20480
  buffer_load_dwordx4 v8, s[12:15], s34 offen nt lds
  v_mfma_f32_16x16x32_bf16 a[120:123], v[56:59], v[216:219], a[120:123]
  v_mfma_f32_16x16x32_bf16 a[120:123], v[60:63], v[220:223], a[120:123]
  v_mfma_f32_16x16x32_bf16 a[184:187], v[56:59], v[224:227], a[184:187]
  v_mfma_f32_16x16x32_bf16 a[184:187], v[60:63], v[228:231], a[184:187]
  v_mfma_f32_16x16x32_bf16 a[248:251], v[56:59], v[232:235], a[248:251]
  v_xor_b32 v3, 65536, v3
  v_xor_b32 v4, 65536, v4
  v_mfma_f32_16x16x32_bf16 a[248:251], v[60:63], v[236:239], a[248:251]
  s_add_u32 m0, s33, 6144
  s_add_u32 s34, s31, 24576
  buffer_load_dwordx4 v8, s[12:15], s34 offen nt lds
  v_mfma_f32_16x16x32_bf16 v[120:123], v[56:59], v[240:243], v[120:123]
  v_xor_b32 v5, 65536, v5
  v_xor_b32 v6, 65536, v6
  v_mfma_f32_16x16x32_bf16 v[120:123], v[60:63], v[244:247], v[120:123]
  ds_read_b64_tr_b16 v[40:41], v3 offset:0
  ds_read_b64_tr_b16 v[42:43], v3 offset:512
  s_waitcnt lgkmcnt(4)
  v_mfma_f32_16x16x32_bf16 a[60:63], v[24:27], v[208:211], a[60:63]
  ds_read_b64_tr_b16 v[44:45], v3 offset:4096
  ds_read_b64_tr_b16 v[46:47], v3 offset:4608
  s_waitcnt lgkmcnt(4)
  v_mfma_f32_16x16x32_bf16 a[60:63], v[28:31], v[212:215], a[60:63]
  ds_read_b64_tr_b16 v[48:49], v4 offset:0
  ds_read_b64_tr_b16 v[50:51], v4 offset:512
  v_mfma_f32_16x16x32_bf16 a[124:127], v[24:27], v[216:219], a[124:127]
  ds_read_b64_tr_b16 v[52:53], v4 offset:4096
  ds_read_b64_tr_b16 v[54:55], v4 offset:4608
  v_mfma_f32_16x16x32_bf16 a[124:127], v[28:31], v[220:223], a[124:127]
  s_add_u32 m0, s33, 7168
  s_add_u32 s34, s31, 28672
  buffer_load_dwordx4 v8, s[12:15], s34 offen nt lds
  s_add_u32 s31, s31, 32768
  s_xor_b32 s33, s33, 65536
  v_mfma_f32_16x16x32_bf16 a[188:191], v[24:27], v[224:227], a[188:191]
  ds_read_b64_tr_b16 v[56:57], v5 offset:0
  ds_read_b64_tr_b16 v[58:59], v5 offset:512
  v_mfma_f32_16x16x32_bf16 a[188:191], v[28:31], v[228:231], a[188:191]
  ds_read_b64_tr_b16 v[60:61], v5 offset:4096
  ds_read_b64_tr_b16 v[62:63], v5 offset:4608
  v_mfma_f32_16x16x32_bf16 a[252:255], v[24:27], v[232:235], a[252:255]
  v_mfma_f32_16x16x32_bf16 a[252:255], v[28:31], v[236:239], a[252:255]
  v_mfma_f32_16x16x32_bf16 v[124:127], v[24:27], v[240:243], v[124:127]
  v_mfma_f32_16x16x32_bf16 v[124:127], v[28:31], v[244:247], v[124:127]
  s_waitcnt vmcnt(25) lgkmcnt(10)
  v_mfma_f32_16x16x32_bf16 a[0:3], v[40:43], v[64:67], a[0:3]
  s_waitcnt vmcnt(24) lgkmcnt(8)
  v_mfma_f32_16x16x32_bf16 a[0:3], v[44:47], v[68:71], a[0:3]
  s_waitcnt vmcnt(23)
  v_mfma_f32_16x16x32_bf16 a[64:67], v[40:43], v[72:75], a[64:67]
  s_waitcnt vmcnt(22)
  v_mfma_f32_16x16x32_bf16 a[64:67], v[44:47], v[76:79], a[64:67]
  s_waitcnt vmcnt(21)
  v_mfma_f32_16x16x32_bf16 a[128:131], v[40:43], v[80:83], a[128:131]
  s_waitcnt vmcnt(20)
  v_mfma_f32_16x16x32_bf16 a[128:131], v[44:47], v[84:87], a[128:131]
  s_waitcnt vmcnt(19)
  v_mfma_f32_16x16x32_bf16 a[192:195], v[40:43], v[88:91], a[192:195]
  s_waitcnt vmcnt(17)
  v_mfma_f32_16x16x32_bf16 a[192:195], v[44:47], v[92:95], a[192:195]
  ds_read_b64_tr_b16 v[24:25], v6 offset:0
  ds_read_b64_tr_b16 v[26:27], v6 offset:512
  ds_read_b64_tr_b16 v[28:29], v6 offset:4096
  ds_read_b64_tr_b16 v[30:31], v6 offset:4608
  s_waitcnt lgkmcnt(10)
  v_mfma_f32_16x16x32_bf16 a[4:7], v[48:51], v[64:67], a[4:7]
  s_waitcnt lgkmcnt(8)
  v_mfma_f32_16x16x32_bf16 a[4:7], v[52:55], v[68:71], a[4:7]
  v_mfma_f32_16x16x32_bf16 a[68:71], v[48:51], v[72:75], a[68:71]
  v_mfma_f32_16x16x32_bf16 a[68:71], v[52:55], v[76:79], a[68:71]
  v_mfma_f32_16x16x32_bf16 a[132:135], v[48:51], v[80:83], a[132:135]
  v_accvgpr_read_b32 v10, a0
  v_accvgpr_read_b32 v11, a1
  v_accvgpr_read_b32 v12, a2
  v_accvgpr_read_b32 v13, a3
  v_mul_f32 v10, s46, v10
  v_mul_f32 v11, s46, v11
  v_mfma_f32_16x16x32_bf16 a[132:135], v[52:55], v[84:87], a[132:135]
  v_mul_f32 v12, s46, v12
  v_mul_f32 v13, s46, v13
  v_cvt_pk_bf16_f32 v128, v10, v11
  v_cvt_pk_bf16_f32 v129, v12, v13
  v_accvgpr_read_b32 v10, a4
  v_accvgpr_read_b32 v11, a5
  v_mfma_f32_16x16x32_bf16 a[196:199], v[48:51], v[88:91], a[196:199]
  v_accvgpr_read_b32 v12, a6
  v_accvgpr_read_b32 v13, a7
  v_mul_f32 v10, s46, v10
  v_mul_f32 v11, s46, v11
  v_mul_f32 v12, s46, v12
  v_mul_f32 v13, s46, v13
  v_mfma_f32_16x16x32_bf16 a[196:199], v[52:55], v[92:95], a[196:199]
  ds_read_b64_tr_b16 v[32:33], v3 offset:8192
  ds_read_b64_tr_b16 v[34:35], v3 offset:8704
  ds_read_b64_tr_b16 v[36:37], v3 offset:12288
  ds_read_b64_tr_b16 v[38:39], v3 offset:12800
  v_cvt_pk_bf16_f32 v130, v10, v11
  v_cvt_pk_bf16_f32 v131, v12, v13
  s_waitcnt lgkmcnt(10)
  v_mfma_f32_16x16x32_bf16 a[8:11], v[56:59], v[64:67], a[8:11]
  v_accvgpr_read_b32 v10, a64
  v_accvgpr_read_b32 v11, a65
  v_permlane16_swap_b32 v128, v130
  v_permlane16_swap_b32 v129, v131
  v_accvgpr_read_b32 v12, a66
  v_accvgpr_read_b32 v13, a67
  s_waitcnt lgkmcnt(8)
  v_mfma_f32_16x16x32_bf16 a[8:11], v[60:63], v[68:71], a[8:11]
  v_mul_f32 v10, s46, v10
  v_mul_f32 v11, s46, v11
  v_mul_f32 v12, s46, v12
  v_mul_f32 v13, s46, v13
  v_cvt_pk_bf16_f32 v160, v10, v11
  v_cvt_pk_bf16_f32 v161, v12, v13
  v_mfma_f32_16x16x32_bf16 a[72:75], v[56:59], v[72:75], a[72:75]
  v_accvgpr_read_b32 v10, a68
  v_accvgpr_read_b32 v11, a69
  v_accvgpr_read_b32 v12, a70
  v_accvgpr_read_b32 v13, a71
  v_mul_f32 v10, s46, v10
  v_mul_f32 v11, s46, v11
  v_mfma_f32_16x16x32_bf16 a[72:75], v[60:63], v[76:79], a[72:75]
  v_mul_f32 v12, s46, v12
  v_mul_f32 v13, s46, v13
  v_cvt_pk_bf16_f32 v162, v10, v11
  v_cvt_pk_bf16_f32 v163, v12, v13
  v_accvgpr_read_b32 v10, a128
  v_accvgpr_read_b32 v11, a129
  v_mfma_f32_16x16x32_bf16 a[136:139], v[56:59], v[80:83], a[136:139]
  v_permlane16_swap_b32 v160, v162
  v_permlane16_swap_b32 v161, v163
  v_accvgpr_read_b32 v12, a130
  v_accvgpr_read_b32 v13, a131
  v_mul_f32 v10, s46, v10
  v_mul_f32 v11, s46, v11
  v_mfma_f32_16x16x32_bf16 a[136:139], v[60:63], v[84:87], a[136:139]
  v_mul_f32 v12, s46, v12
  v_mul_f32 v13, s46, v13
  v_cvt_pk_bf16_f32 v192, v10, v11
  v_cvt_pk_bf16_f32 v193, v12, v13
  v_accvgpr_read_b32 v10, a132
  v_accvgpr_read_b32 v11, a133
  v_mfma_f32_16x16x32_bf16 a[200:203], v[56:59], v[88:91], a[200:203]
  v_accvgpr_read_b32 v12, a134
  v_accvgpr_read_b32 v13, a135
  v_mul_f32 v10, s46, v10
  v_mul_f32 v11, s46, v11
  v_mul_f32 v12, s46, v12
  v_mul_f32 v13, s46, v13
  v_mfma_f32_16x16x32_bf16 a[200:203], v[60:63], v[92:95], a[200:203]
  ds_read_b64_tr_b16 v[48:49], v4 offset:8192
  ds_read_b64_tr_b16 v[50:51], v4 offset:8704
  ds_read_b64_tr_b16 v[52:53], v4 offset:12288
  ds_read_b64_tr_b16 v[54:55], v4 offset:12800
  v_cvt_pk_bf16_f32 v194, v10, v11
  v_cvt_pk_bf16_f32 v195, v12, v13
  s_waitcnt lgkmcnt(10)
  v_mfma_f32_16x16x32_bf16 a[12:15], v[24:27], v[64:67], a[12:15]
  v_accvgpr_read_b32 v10, a192
  v_accvgpr_read_b32 v11, a193
  v_permlane16_swap_b32 v192, v194
  v_permlane16_swap_b32 v193, v195
  v_accvgpr_read_b32 v12, a194
  v_accvgpr_read_b32 v13, a195
  s_waitcnt lgkmcnt(8)
  v_mfma_f32_16x16x32_bf16 a[12:15], v[28:31], v[68:71], a[12:15]
  v_mul_f32 v10, s46, v10
  v_mul_f32 v11, s46, v11
  v_mul_f32 v12, s46, v12
  v_mul_f32 v13, s46, v13
  v_cvt_pk_bf16_f32 v224, v10, v11
  v_cvt_pk_bf16_f32 v225, v12, v13
  v_mfma_f32_16x16x32_bf16 a[76:79], v[24:27], v[72:75], a[76:79]
  v_accvgpr_read_b32 v10, a196
  v_accvgpr_read_b32 v11, a197
  v_accvgpr_read_b32 v12, a198
  v_accvgpr_read_b32 v13, a199
  v_mul_f32 v10, s46, v10
  v_mul_f32 v11, s46, v11
  v_mfma_f32_16x16x32_bf16 a[76:79], v[28:31], v[76:79], a[76:79]
  v_mul_f32 v12, s46, v12
  v_mul_f32 v13, s46, v13
  v_cvt_pk_bf16_f32 v226, v10, v11
  v_cvt_pk_bf16_f32 v227, v12, v13
  v_mfma_f32_16x16x32_bf16 a[140:143], v[24:27], v[80:83], a[140:143]
  v_accvgpr_read_b32 v10, a8
  v_accvgpr_read_b32 v11, a9
  v_permlane16_swap_b32 v224, v226
  v_permlane16_swap_b32 v225, v227
  v_accvgpr_read_b32 v12, a10
  v_accvgpr_read_b32 v13, a11
  v_mfma_f32_16x16x32_bf16 a[140:143], v[28:31], v[84:87], a[140:143]
  v_mul_f32 v10, s46, v10
  v_mul_f32 v11, s46, v11
  v_mul_f32 v12, s46, v12
  v_mul_f32 v13, s46, v13
  v_cvt_pk_bf16_f32 v132, v10, v11
  v_cvt_pk_bf16_f32 v133, v12, v13
  v_mfma_f32_16x16x32_bf16 a[204:207], v[24:27], v[88:91], a[204:207]
  v_accvgpr_read_b32 v10, a12
  v_accvgpr_read_b32 v11, a13
  v_accvgpr_read_b32 v12, a14
  v_accvgpr_read_b32 v13, a15
  v_mul_f32 v10, s46, v10
  v_mul_f32 v11, s46, v11
  v_mfma_f32_16x16x32_bf16 a[204:207], v[28:31], v[92:95], a[204:207]
  ds_read_b64_tr_b16 v[56:57], v5 offset:8192
  ds_read_b64_tr_b16 v[58:59], v5 offset:8704
  ds_read_b64_tr_b16 v[60:61], v5 offset:12288
  ds_read_b64_tr_b16 v[62:63], v5 offset:12800
  v_mul_f32 v12, s46, v12
  v_mul_f32 v13, s46, v13
  s_waitcnt lgkmcnt(10)
  v_mfma_f32_16x16x32_bf16 a[16:19], v[32:35], v[64:67], a[16:19]
  v_cvt_pk_bf16_f32 v134, v10, v11
  v_cvt_pk_bf16_f32 v135, v12, v13
  v_accvgpr_read_b32 v10, a72
  v_accvgpr_read_b32 v11, a73
  v_permlane16_swap_b32 v132, v134
  v_permlane16_swap_b32 v133, v135
  s_waitcnt lgkmcnt(8)
  v_mfma_f32_16x16x32_bf16 a[16:19], v[36:39], v[68:71], a[16:19]
  v_accvgpr_read_b32 v12, a74
  v_accvgpr_read_b32 v13, a75
  v_mul_f32 v10, s46, v10
  v_mul_f32 v11, s46, v11
  v_mul_f32 v12, s46, v12
  v_mul_f32 v13, s46, v13
  v_mfma_f32_16x16x32_bf16 a[80:83], v[32:35], v[72:75], a[80:83]
  v_cvt_pk_bf16_f32 v164, v10, v11
  v_cvt_pk_bf16_f32 v165, v12, v13
  v_accvgpr_read_b32 v10, a76
  v_accvgpr_read_b32 v11, a77
  v_accvgpr_read_b32 v12, a78
  v_accvgpr_read_b32 v13, a79
  v_mfma_f32_16x16x32_bf16 a[80:83], v[36:39], v[76:79], a[80:83]
  v_mul_f32 v10, s46, v10
  v_mul_f32 v11, s46, v11
  v_mul_f32 v12, s46, v12
  v_mul_f32 v13, s46, v13
  v_cvt_pk_bf16_f32 v166, v10, v11
  v_cvt_pk_bf16_f32 v167, v12, v13
  v_mfma_f32_16x16x32_bf16 a[144:147], v[32:35], v[80:83], a[144:147]
  v_accvgpr_read_b32 v10, a136
  v_accvgpr_read_b32 v11, a137
  v_permlane16_swap_b32 v164, v166
  v_permlane16_swap_b32 v165, v167
  v_accvgpr_read_b32 v12, a138
  v_accvgpr_read_b32 v13, a139
  v_mfma_f32_16x16x32_bf16 a[144:147], v[36:39], v[84:87], a[144:147]
  v_mul_f32 v10, s46, v10
  v_mul_f32 v11, s46, v11
  v_mul_f32 v12, s46, v12
  v_mul_f32 v13, s46, v13
  v_cvt_pk_bf16_f32 v196, v10, v11
  v_cvt_pk_bf16_f32 v197, v12, v13
  v_mfma_f32_16x16x32_bf16 a[208:211], v[32:35], v[88:91], a[208:211]
  v_accvgpr_read_b32 v10, a140
  v_accvgpr_read_b32 v11, a141
  v_accvgpr_read_b32 v12, a142
  v_accvgpr_read_b32 v13, a143
  v_mul_f32 v10, s46, v10
  v_mul_f32 v11, s46, v11
  v_mfma_f32_16x16x32_bf16 a[208:211], v[36:39], v[92:95], a[208:211]
  ds_read_b64_tr_b16 v[40:41], v6 offset:8192
  ds_read_b64_tr_b16 v[42:43], v6 offset:8704
  ds_read_b64_tr_b16 v[44:45], v6 offset:12288
  ds_read_b64_tr_b16 v[46:47], v6 offset:12800
  v_mul_f32 v12, s46, v12
  v_mul_f32 v13, s46, v13
  s_waitcnt lgkmcnt(10)
  v_mfma_f32_16x16x32_bf16 a[20:23], v[48:51], v[64:67], a[20:23]
  v_cvt_pk_bf16_f32 v198, v10, v11
  v_cvt_pk_bf16_f32 v199, v12, v13
  v_accvgpr_read_b32 v10, a200
  v_accvgpr_read_b32 v11, a201
  v_permlane16_swap_b32 v196, v198
  v_permlane16_swap_b32 v197, v199
  s_waitcnt lgkmcnt(8)
  v_mfma_f32_16x16x32_bf16 a[20:23], v[52:55], v[68:71], a[20:23]
  v_accvgpr_read_b32 v12, a202
  v_accvgpr_read_b32 v13, a203
  v_mul_f32 v10, s46, v10
  v_mul_f32 v11, s46, v11
  v_mul_f32 v12, s46, v12
  v_mul_f32 v13, s46, v13
  v_mfma_f32_16x16x32_bf16 a[84:87], v[48:51], v[72:75], a[84:87]
  v_cvt_pk_bf16_f32 v228, v10, v11
  v_cvt_pk_bf16_f32 v229, v12, v13
  v_accvgpr_read_b32 v10, a204
  v_accvgpr_read_b32 v11, a205
  v_accvgpr_read_b32 v12, a206
  v_accvgpr_read_b32 v13, a207
  v_mfma_f32_16x16x32_bf16 a[84:87], v[52:55], v[76:79], a[84:87]
  v_mul_f32 v10, s46, v10
  v_mul_f32 v11, s46, v11
  v_mul_f32 v12, s46, v12
  v_mul_f32 v13, s46, v13
  v_cvt_pk_bf16_f32 v230, v10, v11
  v_cvt_pk_bf16_f32 v231, v12, v13
  v_mfma_f32_16x16x32_bf16 a[148:151], v[48:51], v[80:83], a[148:151]
  v_accvgpr_read_b32 v10, a16
  v_accvgpr_read_b32 v11, a17
  v_permlane16_swap_b32 v228, v230
  v_permlane16_swap_b32 v229, v231
  v_accvgpr_read_b32 v12, a18
  v_accvgpr_read_b32 v13, a19
  v_mfma_f32_16x16x32_bf16 a[148:151], v[52:55], v[84:87], a[148:151]
  v_mul_f32 v10, s46, v10
  v_mul_f32 v11, s46, v11
  v_mul_f32 v12, s46, v12
  v_mul_f32 v13, s46, v13
  v_cvt_pk_bf16_f32 v136, v10, v11
  v_cvt_pk_bf16_f32 v137, v12, v13
  v_mfma_f32_16x16x32_bf16 a[212:215], v[48:51], v[88:91], a[212:215]
  v_accvgpr_read_b32 v10, a20
  v_accvgpr_read_b32 v11, a21
  v_accvgpr_read_b32 v12, a22
  v_accvgpr_read_b32 v13, a23
  v_mul_f32 v10, s46, v10
  v_mul_f32 v11, s46, v11
  v_mfma_f32_16x16x32_bf16 a[212:215], v[52:55], v[92:95], a[212:215]
  ds_read_b64_tr_b16 v[24:25], v3 offset:16384
  ds_read_b64_tr_b16 v[26:27], v3 offset:16896
  ds_read_b64_tr_b16 v[28:29], v3 offset:20480
  ds_read_b64_tr_b16 v[30:31], v3 offset:20992
  v_mul_f32 v12, s46, v12
  v_mul_f32 v13, s46, v13
  s_waitcnt lgkmcnt(10)
  v_mfma_f32_16x16x32_bf16 a[24:27], v[56:59], v[64:67], a[24:27]
  v_cvt_pk_bf16_f32 v138, v10, v11
  v_cvt_pk_bf16_f32 v139, v12, v13
  v_accvgpr_read_b32 v10, a80
  v_accvgpr_read_b32 v11, a81
  v_permlane16_swap_b32 v136, v138
  v_permlane16_swap_b32 v137, v139
  s_waitcnt lgkmcnt(8)
  v_mfma_f32_16x16x32_bf16 a[24:27], v[60:63], v[68:71], a[24:27]
  v_accvgpr_read_b32 v12, a82
  v_accvgpr_read_b32 v13, a83
  v_mul_f32 v10, s46, v10
  v_mul_f32 v11, s46, v11
  v_mul_f32 v12, s46, v12
  v_mul_f32 v13, s46, v13
  v_mfma_f32_16x16x32_bf16 a[88:91], v[56:59], v[72:75], a[88:91]
  v_cvt_pk_bf16_f32 v168, v10, v11
  v_cvt_pk_bf16_f32 v169, v12, v13
  v_accvgpr_read_b32 v10, a84
  v_accvgpr_read_b32 v11, a85
  v_accvgpr_read_b32 v12, a86
  v_accvgpr_read_b32 v13, a87
  v_mfma_f32_16x16x32_bf16 a[88:91], v[60:63], v[76:79], a[88:91]
  v_mul_f32 v10, s46, v10
  v_mul_f32 v11, s46, v11
  v_mul_f32 v12, s46, v12
  v_mul_f32 v13, s46, v13
  v_cvt_pk_bf16_f32 v170, v10, v11
  v_cvt_pk_bf16_f32 v171, v12, v13
  v_mfma_f32_16x16x32_bf16 a[152:155], v[56:59], v[80:83], a[152:155]
  v_accvgpr_read_b32 v10, a144
  v_accvgpr_read_b32 v11, a145
  v_permlane16_swap_b32 v168, v170
  v_permlane16_swap_b32 v169, v171
  v_accvgpr_read_b32 v12, a146
  v_accvgpr_read_b32 v13, a147
  v_mfma_f32_16x16x32_bf16 a[152:155], v[60:63], v[84:87], a[152:155]
  v_mul_f32 v10, s46, v10
  v_mul_f32 v11, s46, v11
  v_mul_f32 v12, s46, v12
  v_mul_f32 v13, s46, v13
  v_cvt_pk_bf16_f32 v200, v10, v11
  v_cvt_pk_bf16_f32 v201, v12, v13
  v_mfma_f32_16x16x32_bf16 a[216:219], v[56:59], v[88:91], a[216:219]
  v_accvgpr_read_b32 v10, a148
  v_accvgpr_read_b32 v11, a149
  v_accvgpr_read_b32 v12, a150
  v_accvgpr_read_b32 v13, a151
  v_mul_f32 v10, s46, v10
  v_mul_f32 v11, s46, v11
  v_mfma_f32_16x16x32_bf16 a[216:219], v[60:63], v[92:95], a[216:219]
  ds_read_b64_tr_b16 v[48:49], v4 offset:16384
  ds_read_b64_tr_b16 v[50:51], v4 offset:16896
  ds_read_b64_tr_b16 v[52:53], v4 offset:20480
  ds_read_b64_tr_b16 v[54:55], v4 offset:20992
  v_mul_f32 v12, s46, v12
  v_mul_f32 v13, s46, v13
  s_waitcnt lgkmcnt(10)
  v_mfma_f32_16x16x32_bf16 a[28:31], v[40:43], v[64:67], a[28:31]
  v_cvt_pk_bf16_f32 v202, v10, v11
  v_cvt_pk_bf16_f32 v203, v12, v13
  v_accvgpr_read_b32 v10, a208
  v_accvgpr_read_b32 v11, a209
  v_permlane16_swap_b32 v200, v202
  v_permlane16_swap_b32 v201, v203
  s_waitcnt lgkmcnt(8)
  v_mfma_f32_16x16x32_bf16 a[28:31], v[44:47], v[68:71], a[28:31]
  v_accvgpr_read_b32 v12, a210
  v_accvgpr_read_b32 v13, a211
  v_mul_f32 v10, s46, v10
  v_mul_f32 v11, s46, v11
  v_mul_f32 v12, s46, v12
  v_mul_f32 v13, s46, v13
  v_mfma_f32_16x16x32_bf16 a[92:95], v[40:43], v[72:75], a[92:95]
  v_cvt_pk_bf16_f32 v232, v10, v11
  v_cvt_pk_bf16_f32 v233, v12, v13
  v_accvgpr_read_b32 v10, a212
  v_accvgpr_read_b32 v11, a213
  v_accvgpr_read_b32 v12, a214
  v_accvgpr_read_b32 v13, a215
  v_mfma_f32_16x16x32_bf16 a[92:95], v[44:47], v[76:79], a[92:95]
  v_mul_f32 v10, s46, v10
  v_mul_f32 v11, s46, v11
  v_mul_f32 v12, s46, v12
  v_mul_f32 v13, s46, v13
  v_cvt_pk_bf16_f32 v234, v10, v11
  v_cvt_pk_bf16_f32 v235, v12, v13
  v_mfma_f32_16x16x32_bf16 a[156:159], v[40:43], v[80:83], a[156:159]
  v_accvgpr_read_b32 v10, a24
  v_accvgpr_read_b32 v11, a25
  v_permlane16_swap_b32 v232, v234
  v_permlane16_swap_b32 v233, v235
  v_accvgpr_read_b32 v12, a26
  v_accvgpr_read_b32 v13, a27
  v_mfma_f32_16x16x32_bf16 a[156:159], v[44:47], v[84:87], a[156:159]
  v_mul_f32 v10, s46, v10
  v_mul_f32 v11, s46, v11
  v_mul_f32 v12, s46, v12
  v_mul_f32 v13, s46, v13
  v_cvt_pk_bf16_f32 v140, v10, v11
  v_cvt_pk_bf16_f32 v141, v12, v13
  v_mfma_f32_16x16x32_bf16 a[220:223], v[40:43], v[88:91], a[220:223]
  v_accvgpr_read_b32 v10, a28
  v_accvgpr_read_b32 v11, a29
  v_accvgpr_read_b32 v12, a30
  v_accvgpr_read_b32 v13, a31
  v_mul_f32 v10, s46, v10
  v_mul_f32 v11, s46, v11
  v_mfma_f32_16x16x32_bf16 a[220:223], v[44:47], v[92:95], a[220:223]
  ds_read_b64_tr_b16 v[56:57], v5 offset:16384
  ds_read_b64_tr_b16 v[58:59], v5 offset:16896
  ds_read_b64_tr_b16 v[60:61], v5 offset:20480
  ds_read_b64_tr_b16 v[62:63], v5 offset:20992
  v_mul_f32 v12, s46, v12
  v_mul_f32 v13, s46, v13
  s_waitcnt lgkmcnt(10)
  v_mfma_f32_16x16x32_bf16 a[32:35], v[24:27], v[64:67], a[32:35]
  v_cvt_pk_bf16_f32 v142, v10, v11
  v_cvt_pk_bf16_f32 v143, v12, v13
  v_accvgpr_read_b32 v10, a88
  v_accvgpr_read_b32 v11, a89
  v_permlane16_swap_b32 v140, v142
  v_permlane16_swap_b32 v141, v143
  s_waitcnt lgkmcnt(8)
  v_mfma_f32_16x16x32_bf16 a[32:35], v[28:31], v[68:71], a[32:35]
  v_accvgpr_read_b32 v12, a90
  v_accvgpr_read_b32 v13, a91
  v_mul_f32 v10, s46, v10
  v_mul_f32 v11, s46, v11
  v_mul_f32 v12, s46, v12
  v_mul_f32 v13, s46, v13
  v_mfma_f32_16x16x32_bf16 a[96:99], v[24:27], v[72:75], a[96:99]
  v_cvt_pk_bf16_f32 v172, v10, v11
  v_cvt_pk_bf16_f32 v173, v12, v13
  v_accvgpr_read_b32 v10, a92
  v_accvgpr_read_b32 v11, a93
  v_accvgpr_read_b32 v12, a94
  v_accvgpr_read_b32 v13, a95
  v_mfma_f32_16x16x32_bf16 a[96:99], v[28:31], v[76:79], a[96:99]
  v_mul_f32 v10, s46, v10
  v_mul_f32 v11, s46, v11
  v_mul_f32 v12, s46, v12
  v_mul_f32 v13, s46, v13
  v_cvt_pk_bf16_f32 v174, v10, v11
  v_cvt_pk_bf16_f32 v175, v12, v13
  v_mfma_f32_16x16x32_bf16 a[160:163], v[24:27], v[80:83], a[160:163]
  v_accvgpr_read_b32 v10, a152
  v_accvgpr_read_b32 v11, a153
  v_permlane16_swap_b32 v172, v174
  v_permlane16_swap_b32 v173, v175
  v_accvgpr_read_b32 v12, a154
  v_accvgpr_read_b32 v13, a155
  v_mfma_f32_16x16x32_bf16 a[160:163], v[28:31], v[84:87], a[160:163]
  v_mul_f32 v10, s46, v10
  v_mul_f32 v11, s46, v11
  v_mul_f32 v12, s46, v12
  v_mul_f32 v13, s46, v13
  v_cvt_pk_bf16_f32 v204, v10, v11
  v_cvt_pk_bf16_f32 v205, v12, v13
  v_mfma_f32_16x16x32_bf16 a[224:227], v[24:27], v[88:91], a[224:227]
  v_accvgpr_read_b32 v10, a156
  v_accvgpr_read_b32 v11, a157
  v_accvgpr_read_b32 v12, a158
  v_accvgpr_read_b32 v13, a159
  v_mul_f32 v10, s46, v10
  v_mul_f32 v11, s46, v11
  v_mfma_f32_16x16x32_bf16 a[224:227], v[28:31], v[92:95], a[224:227]
  v_mul_f32 v12, s46, v12
  v_mul_f32 v13, s46, v13
  v_cvt_pk_bf16_f32 v206, v10, v11
  v_cvt_pk_bf16_f32 v207, v12, v13
  v_accvgpr_read_b32 v10, a216
  v_accvgpr_read_b32 v11, a217
  s_waitcnt vmcnt(14)
  v_mfma_f32_16x16x32_bf16 v[96:99], v[24:27], v[16:19], v[96:99]
  v_permlane16_swap_b32 v204, v206
  v_permlane16_swap_b32 v205, v207
  v_accvgpr_read_b32 v12, a218
  v_accvgpr_read_b32 v13, a219
  v_mul_f32 v10, s46, v10
  v_mul_f32 v11, s46, v11
  s_waitcnt vmcnt(11)
  v_mfma_f32_16x16x32_bf16 v[96:99], v[28:31], v[20:23], v[96:99]
  ds_read_b64_tr_b16 v[32:33], v6 offset:16384
  ds_read_b64_tr_b16 v[34:35], v6 offset:16896
  ds_read_b64_tr_b16 v[36:37], v6 offset:20480
  ds_read_b64_tr_b16 v[38:39], v6 offset:20992
  v_mul_f32 v12, s46, v12
  v_mul_f32 v13, s46, v13
  s_waitcnt lgkmcnt(10)
  v_mfma_f32_16x16x32_bf16 a[36:39], v[48:51], v[64:67], a[36:39]
  v_cvt_pk_bf16_f32 v236, v10, v11
  v_cvt_pk_bf16_f32 v237, v12, v13
  v_accvgpr_read_b32 v10, a220
  v_accvgpr_read_b32 v11, a221
  v_accvgpr_read_b32 v12, a222
  v_accvgpr_read_b32 v13, a223
  s_waitcnt lgkmcnt(8)
  v_mfma_f32_16x16x32_bf16 a[36:39], v[52:55], v[68:71], a[36:39]
  v_mul_f32 v10, s46, v10
  v_mul_f32 v11, s46, v11
  v_mul_f32 v12, s46, v12
  v_mul_f32 v13, s46, v13
  v_cvt_pk_bf16_f32 v238, v10, v11
  v_cvt_pk_bf16_f32 v239, v12, v13
  v_mfma_f32_16x16x32_bf16 a[100:103], v[48:51], v[72:75], a[100:103]
  v_mfma_f32_16x16x32_bf16 a[100:103], v[52:55], v[76:79], a[100:103]
  v_mfma_f32_16x16x32_bf16 a[164:167], v[48:51], v[80:83], a[164:167]
  v_accvgpr_read_b32 v10, a32
  v_accvgpr_read_b32 v11, a33
  v_permlane16_swap_b32 v236, v238
  v_permlane16_swap_b32 v237, v239
  v_accvgpr_read_b32 v12, a34
  v_accvgpr_read_b32 v13, a35
  v_mfma_f32_16x16x32_bf16 a[164:167], v[52:55], v[84:87], a[164:167]
  v_mul_f32 v10, s46, v10
  v_mul_f32 v11, s46, v11
  v_mul_f32 v12, s46, v12
  v_mul_f32 v13, s46, v13
  v_cvt_pk_bf16_f32 v144, v10, v11
  v_cvt_pk_bf16_f32 v145, v12, v13
  v_mfma_f32_16x16x32_bf16 a[228:231], v[48:51], v[88:91], a[228:231]
  v_accvgpr_read_b32 v10, a36
  v_accvgpr_read_b32 v11, a37
  v_accvgpr_read_b32 v12, a38
  v_accvgpr_read_b32 v13, a39
  v_mul_f32 v10, s46, v10
  v_mul_f32 v11, s46, v11
  v_mfma_f32_16x16x32_bf16 a[228:231], v[52:55], v[92:95], a[228:231]
  v_mul_f32 v12, s46, v12
  v_mul_f32 v13, s46, v13
  v_cvt_pk_bf16_f32 v146, v10, v11
  v_cvt_pk_bf16_f32 v147, v12, v13
  v_accvgpr_read_b32 v10, a96
  v_accvgpr_read_b32 v11, a97
  v_mfma_f32_16x16x32_bf16 v[100:103], v[48:51], v[16:19], v[100:103]
  v_permlane16_swap_b32 v144, v146
  v_permlane16_swap_b32 v145, v147
  v_accvgpr_read_b32 v12, a98
  v_accvgpr_read_b32 v13, a99
  v_mul_f32 v10, s46, v10
  v_mul_f32 v11, s46, v11
  v_mfma_f32_16x16x32_bf16 v[100:103], v[52:55], v[20:23], v[100:103]
  ds_read_b64_tr_b16 v[40:41], v3 offset:24576
  ds_read_b64_tr_b16 v[42:43], v3 offset:25088
  ds_read_b64_tr_b16 v[44:45], v3 offset:28672
  ds_read_b64_tr_b16 v[46:47], v3 offset:29184
  v_mul_f32 v12, s46, v12
  v_mul_f32 v13, s46, v13
  s_waitcnt lgkmcnt(10)
  v_mfma_f32_16x16x32_bf16 a[40:43], v[56:59], v[64:67], a[40:43]
  v_cvt_pk_bf16_f32 v176, v10, v11
  v_cvt_pk_bf16_f32 v177, v12, v13
  v_accvgpr_read_b32 v10, a100
  v_accvgpr_read_b32 v11, a101
  v_accvgpr_read_b32 v12, a102
  v_accvgpr_read_b32 v13, a103
  s_waitcnt lgkmcnt(8)
  v_mfma_f32_16x16x32_bf16 a[40:43], v[60:63], v[68:71], a[40:43]
  v_mul_f32 v10, s46, v10
  v_mul_f32 v11, s46, v11
  v_mul_f32 v12, s46, v12
  v_mul_f32 v13, s46, v13
  v_cvt_pk_bf16_f32 v178, v10, v11
  v_cvt_pk_bf16_f32 v179, v12, v13
  v_mfma_f32_16x16x32_bf16 a[104:107], v[56:59], v[72:75], a[104:107]
  v_accvgpr_read_b32 v10, a160
  v_accvgpr_read_b32 v11, a161
  v_permlane16_swap_b32 v176, v178
  v_permlane16_swap_b32 v177, v179
  v_accvgpr_read_b32 v12, a162
  v_accvgpr_read_b32 v13, a163
  v_mfma_f32_16x16x32_bf16 a[104:107], v[60:63], v[76:79], a[104:107]
  v_mul_f32 v10, s46, v10
  v_mul_f32 v11, s46, v11
  v_mul_f32 v12, s46, v12
  v_mul_f32 v13, s46, v13
  v_cvt_pk_bf16_f32 v208, v10, v11
  v_cvt_pk_bf16_f32 v209, v12, v13
  v_mfma_f32_16x16x32_bf16 a[168:171], v[56:59], v[80:83], a[168:171]
  v_accvgpr_read_b32 v10, a164
  v_accvgpr_read_b32 v11, a165
  v_accvgpr_read_b32 v12, a166
  v_accvgpr_read_b32 v13, a167
  v_mul_f32 v10, s46, v10
  v_mul_f32 v11, s46, v11
  v_mfma_f32_16x16x32_bf16 a[168:171], v[60:63], v[84:87], a[168:171]
  v_mul_f32 v12, s46, v12
  v_mul_f32 v13, s46, v13
  v_cvt_pk_bf16_f32 v210, v10, v11
  v_cvt_pk_bf16_f32 v211, v12, v13
  v_accvgpr_read_b32 v10, a224
  v_accvgpr_read_b32 v11, a225
  v_mfma_f32_16x16x32_bf16 a[232:235], v[56:59], v[88:91], a[232:235]
  v_permlane16_swap_b32 v208, v210
  v_permlane16_swap_b32 v209, v211
  v_accvgpr_read_b32 v12, a226
  v_accvgpr_read_b32 v13, a227
  v_mul_f32 v10, s46, v10
  v_mul_f32 v11, s46, v11
  v_mfma_f32_16x16x32_bf16 a[232:235], v[60:63], v[92:95], a[232:235]
  v_mul_f32 v12, s46, v12
  v_mul_f32 v13, s46, v13
  v_cvt_pk_bf16_f32 v240, v10, v11
  v_cvt_pk_bf16_f32 v241, v12, v13
  v_accvgpr_read_b32 v10, a228
  v_accvgpr_read_b32 v11, a229
  v_mfma_f32_16x16x32_bf16 v[104:107], v[56:59], v[16:19], v[104:107]
  v_accvgpr_read_b32 v12, a230
  v_accvgpr_read_b32 v13, a231
  v_mul_f32 v10, s46, v10
  v_mul_f32 v11, s46, v11
  v_mul_f32 v12, s46, v12
  v_mul_f32 v13, s46, v13
  v_mfma_f32_16x16x32_bf16 v[104:107], v[60:63], v[20:23], v[104:107]
  ds_read_b64_tr_b16 v[48:49], v4 offset:24576
  ds_read_b64_tr_b16 v[50:51], v4 offset:25088
  ds_read_b64_tr_b16 v[52:53], v4 offset:28672
  ds_read_b64_tr_b16 v[54:55], v4 offset:29184
  v_cvt_pk_bf16_f32 v242, v10, v11
  v_cvt_pk_bf16_f32 v243, v12, v13
  s_waitcnt lgkmcnt(10)
  v_mfma_f32_16x16x32_bf16 a[44:47], v[32:35], v[64:67], a[44:47]
  s_waitcnt vmcnt(8)
  s_barrier
  v_mul_f32 v10, s46, v96
  v_mul_f32 v11, s46, v97
  v_permlane16_swap_b32 v240, v242
  v_permlane16_swap_b32 v241, v243
  v_mul_f32 v12, s46, v98
  s_waitcnt lgkmcnt(8)
  v_mfma_f32_16x16x32_bf16 a[44:47], v[36:39], v[68:71], a[44:47]
  s_add_u32 m0, s32, 0
  s_add_u32 s34, s30, 0
  buffer_load_dwordx4 v7, s[8:11], s34 offen nt lds
  v_mul_f32 v13, s46, v99
  v_cvt_pk_bf16_f32 v96, v10, v11
  v_cvt_pk_bf16_f32 v97, v12, v13
  v_mul_f32 v10, s46, v100
  v_mfma_f32_16x16x32_bf16 a[108:111], v[32:35], v[72:75], a[108:111]
  v_mul_f32 v11, s46, v101
  v_mul_f32 v12, s46, v102
  v_mul_f32 v13, s46, v103
  v_cvt_pk_bf16_f32 v98, v10, v11
  v_cvt_pk_bf16_f32 v99, v12, v13
  v_mfma_f32_16x16x32_bf16 a[108:111], v[36:39], v[76:79], a[108:111]
  v_mfma_f32_16x16x32_bf16 a[172:175], v[32:35], v[80:83], a[172:175]
  v_accvgpr_read_b32 v10, a40
  v_accvgpr_read_b32 v11, a41
  v_permlane16_swap_b32 v96, v98
  v_permlane16_swap_b32 v97, v99
  ds_write_b128 v9, v[96:99] offset:4096
  v_accvgpr_read_b32 v12, a42
  v_mfma_f32_16x16x32_bf16 a[172:175], v[36:39], v[84:87], a[172:175]
  v_accvgpr_read_b32 v13, a43
  v_mul_f32 v10, s46, v10
  v_mul_f32 v11, s46, v11
  v_mul_f32 v12, s46, v12
  v_mul_f32 v13, s46, v13
  v_cvt_pk_bf16_f32 v148, v10, v11
  v_mfma_f32_16x16x32_bf16 a[236:239], v[32:35], v[88:91], a[236:239]
  v_cvt_pk_bf16_f32 v149, v12, v13
  v_accvgpr_read_b32 v10, a44
  v_accvgpr_read_b32 v11, a45
  v_accvgpr_read_b32 v12, a46
  v_accvgpr_read_b32 v13, a47
  v_mul_f32 v10, s46, v10
  v_mfma_f32_16x16x32_bf16 a[236:239], v[36:39], v[92:95], a[236:239]
  s_add_u32 m0, s32, 1024
  s_add_u32 s34, s30, 4096
  buffer_load_dwordx4 v7, s[8:11], s34 offen nt lds
  v_mul_f32 v11, s46, v11
  v_mul_f32 v12, s46, v12
  v_mul_f32 v13, s46, v13
  v_cvt_pk_bf16_f32 v150, v10, v11
  v_mfma_f32_16x16x32_bf16 v[108:111], v[32:35], v[16:19], v[108:111]
  v_cvt_pk_bf16_f32 v151, v12, v13
  v_accvgpr_read_b32 v10, a104
  v_accvgpr_read_b32 v11, a105
  v_permlane16_swap_b32 v148, v150
  v_permlane16_swap_b32 v149, v151
  v_accvgpr_read_b32 v12, a106
  v_mfma_f32_16x16x32_bf16 v[108:111], v[36:39], v[20:23], v[108:111]
  ds_read_b64_tr_b16 v[56:57], v5 offset:24576
  ds_read_b64_tr_b16 v[58:59], v5 offset:25088
  ds_read_b64_tr_b16 v[60:61], v5 offset:28672
  ds_read_b64_tr_b16 v[62:63], v5 offset:29184
  ds_read_b128 v[32:35], v1 offset:4096
  ds_read_b128 v[36:39], v2 offset:4096
  s_waitcnt lgkmcnt(13)
  v_mfma_f32_16x16x32_bf16 a[48:51], v[40:43], v[64:67], a[48:51]
  v_accvgpr_read_b32 v13, a107
  v_mul_f32 v10, s46, v10
  v_mul_f32 v11, s46, v11
  v_mul_f32 v12, s46, v12
  v_mul_f32 v13, s46, v13
  v_cvt_pk_bf16_f32 v180, v10, v11
  s_waitcnt lgkmcnt(11)
  v_mfma_f32_16x16x32_bf16 a[48:51], v[44:47], v[68:71], a[48:51]
  v_cvt_pk_bf16_f32 v181, v12, v13
  v_accvgpr_read_b32 v10, a108
  v_accvgpr_read_b32 v11, a109
  v_accvgpr_read_b32 v12, a110
  v_accvgpr_read_b32 v13, a111
  v_mul_f32 v10, s46, v10
  v_mfma_f32_16x16x32_bf16 a[112:115], v[40:43], v[72:75], a[112:115]
  v_mul_f32 v11, s46, v11
  v_mul_f32 v12, s46, v12
  v_mul_f32 v13, s46, v13
  v_cvt_pk_bf16_f32 v182, v10, v11
  v_cvt_pk_bf16_f32 v183, v12, v13
  v_accvgpr_read_b32 v10, a168
  v_mfma_f32_16x16x32_bf16 a[112:115], v[44:47], v[76:79], a[112:115]
  s_add_u32 m0, s32, 2048
  s_add_u32 s34, s30, 8192
  buffer_load_dwordx4 v7, s[8:11], s34 offen nt lds
  v_accvgpr_read_b32 v11, a169
  v_permlane16_swap_b32 v180, v182
  v_permlane16_swap_b32 v181, v183
  v_accvgpr_read_b32 v12, a170
  v_mfma_f32_16x16x32_bf16 a[176:179], v[40:43], v[80:83], a[176:179]
  v_accvgpr_read_b32 v13, a171
  v_mul_f32 v10, s46, v10
  v_mul_f32 v11, s46, v11
  v_mul_f32 v12, s46, v12
  v_mul_f32 v13, s46, v13
  v_cvt_pk_bf16_f32 v212, v10, v11
  v_mfma_f32_16x16x32_bf16 a[176:179], v[44:47], v[84:87], a[176:179]
  v_cvt_pk_bf16_f32 v213, v12, v13
  v_accvgpr_read_b32 v10, a172
  v_accvgpr_read_b32 v11, a173
  v_accvgpr_read_b32 v12, a174
  v_accvgpr_read_b32 v13, a175
  v_mul_f32 v10, s46, v10
  v_mfma_f32_16x16x32_bf16 a[240:243], v[40:43], v[88:91], a[240:243]
  v_mul_f32 v11, s46, v11
  v_mul_f32 v12, s46, v12
  v_mul_f32 v13, s46, v13
  v_cvt_pk_bf16_f32 v214, v10, v11
  v_cvt_pk_bf16_f32 v215, v12, v13
  v_accvgpr_read_b32 v10, a232
  v_mfma_f32_16x16x32_bf16 a[240:243], v[44:47], v[92:95], a[240:243]
  v_accvgpr_read_b32 v11, a233
  v_permlane16_swap_b32 v212, v214
  v_permlane16_swap_b32 v213, v215
  v_accvgpr_read_b32 v12, a234
  v_accvgpr_read_b32 v13, a235
  v_mul_f32 v10, s46, v10
  v_mfma_f32_16x16x32_bf16 v[112:115], v[40:43], v[16:19], v[112:115]
  v_mul_f32 v11, s46, v11
  v_mul_f32 v12, s46, v12
  v_mul_f32 v13, s46, v13
  v_cvt_pk_bf16_f32 v244, v10, v11
  v_cvt_pk_bf16_f32 v245, v12, v13
  v_accvgpr_read_b32 v10, a236
  v_mfma_f32_16x16x32_bf16 v[112:115], v[44:47], v[20:23], v[112:115]
  s_add_u32 m0, s32, 3072
  s_add_u32 s34, s30, 12288
  buffer_load_dwordx4 v7, s[8:11], s34 offen nt lds
  ds_read_b64_tr_b16 v[24:25], v6 offset:24576
  ds_read_b64_tr_b16 v[26:27], v6 offset:25088
  ds_read_b64_tr_b16 v[28:29], v6 offset:28672
  ds_read_b64_tr_b16 v[30:31], v6 offset:29184
  s_waitcnt lgkmcnt(13)
  v_mfma_f32_16x16x32_bf16 a[52:55], v[48:51], v[64:67], a[52:55]
  ds_read_b128 v[40:43], v1 offset:12288
  ds_read_b128 v[44:47], v2 offset:12288
  v_accvgpr_read_b32 v11, a237
  v_accvgpr_read_b32 v12, a238
  v_accvgpr_read_b32 v13, a239
  v_mul_f32 v10, s46, v10
  s_waitcnt lgkmcnt(13)
  v_mfma_f32_16x16x32_bf16 a[52:55], v[52:55], v[68:71], a[52:55]
  v_mul_f32 v11, s46, v11
  v_mul_f32 v12, s46, v12
  v_mul_f32 v13, s46, v13
  v_cvt_pk_bf16_f32 v246, v10, v11
  v_cvt_pk_bf16_f32 v247, v12, v13
  v_mul_f32 v10, s46, v104
  v_mfma_f32_16x16x32_bf16 a[116:119], v[48:51], v[72:75], a[116:119]
  v_mul_f32 v11, s46, v105
  v_permlane16_swap_b32 v244, v246
  v_permlane16_swap_b32 v245, v247
  v_mul_f32 v12, s46, v106
  v_mul_f32 v13, s46, v107
  v_cvt_pk_bf16_f32 v104, v10, v11
  v_mfma_f32_16x16x32_bf16 a[116:119], v[52:55], v[76:79], a[116:119]
  v_cvt_pk_bf16_f32 v105, v12, v13
  v_mul_f32 v10, s46, v108
  v_mul_f32 v11, s46, v109
  v_mul_f32 v12, s46, v110
  v_mul_f32 v13, s46, v111
  v_cvt_pk_bf16_f32 v106, v10, v11
  v_mfma_f32_16x16x32_bf16 a[180:183], v[48:51], v[80:83], a[180:183]
  v_cvt_pk_bf16_f32 v107, v12, v13
  v_accvgpr_read_b32 v10, a48
  v_accvgpr_read_b32 v11, a49
  v_permlane16_swap_b32 v104, v106
  v_permlane16_swap_b32 v105, v107
  ds_write_b128 v9, v[104:107] offset:5120
  v_mfma_f32_16x16x32_bf16 a[180:183], v[52:55], v[84:87], a[180:183]
  s_add_u32 m0, s32, 4096
  s_add_u32 s34, s30, 16384
  buffer_load_dwordx4 v7, s[8:11], s34 offen nt lds
  v_accvgpr_read_b32 v12, a50
  v_accvgpr_read_b32 v13, a51
  v_mul_f32 v10, s46, v10
  v_mul_f32 v11, s46, v11
  v_mfma_f32_16x16x32_bf16 a[244:247], v[48:51], v[88:91], a[244:247]
  v_mul_f32 v12, s46, v12
  v_mul_f32 v13, s46, v13
  v_cvt_pk_bf16_f32 v152, v10, v11
  v_cvt_pk_bf16_f32 v153, v12, v13
  v_accvgpr_read_b32 v10, a52
  v_accvgpr_read_b32 v11, a53
  v_mfma_f32_16x16x32_bf16 a[244:247], v[52:55], v[92:95], a[244:247]
  v_accvgpr_read_b32 v12, a54
  v_accvgpr_read_b32 v13, a55
  v_mul_f32 v10, s46, v10
  v_mul_f32 v11, s46, v11
  v_mul_f32 v12, s46, v12
  v_mul_f32 v13, s46, v13
  v_mfma_f32_16x16x32_bf16 v[116:119], v[48:51], v[16:19], v[116:119]
  v_cvt_pk_bf16_f32 v154, v10, v11
  v_cvt_pk_bf16_f32 v155, v12, v13
  v_accvgpr_read_b32 v10, a112
  v_accvgpr_read_b32 v11, a113
  v_permlane16_swap_b32 v152, v154
  v_permlane16_swap_b32 v153, v155
  v_mfma_f32_16x16x32_bf16 v[116:119], v[52:55], v[20:23], v[116:119]
  ds_read_b128 v[48:51], v1 offset:20480
  ds_read_b128 v[52:55], v2 offset:20480
  v_accvgpr_read_b32 v12, a114
  v_accvgpr_read_b32 v13, a115
  v_mul_f32 v10, s46, v10
  v_mul_f32 v11, s46, v11
  s_waitcnt lgkmcnt(13)
  v_mfma_f32_16x16x32_bf16 a[56:59], v[56:59], v[64:67], a[56:59]
  v_mul_f32 v12, s46, v12
  v_mul_f32 v13, s46, v13
  v_cvt_pk_bf16_f32 v184, v10, v11
  v_cvt_pk_bf16_f32 v185, v12, v13
  v_accvgpr_read_b32 v10, a116
  v_accvgpr_read_b32 v11, a117
  s_waitcnt lgkmcnt(11)
  v_mfma_f32_16x16x32_bf16 a[56:59], v[60:63], v[68:71], a[56:59]
  s_add_u32 m0, s32, 5120
  s_add_u32 s34, s30, 20480
  buffer_load_dwordx4 v7, s[8:11], s34 offen nt lds
  v_accvgpr_read_b32 v12, a118
  v_accvgpr_read_b32 v13, a119
  v_mul_f32 v10, s46, v10
  v_mul_f32 v11, s46, v11
  v_mfma_f32_16x16x32_bf16 a[120:123], v[56:59], v[72:75], a[120:123]
  v_mul_f32 v12, s46, v12
  v_mul_f32 v13, s46, v13
  v_cvt_pk_bf16_f32 v186, v10, v11
  v_cvt_pk_bf16_f32 v187, v12, v13
  v_accvgpr_read_b32 v10, a176
  v_accvgpr_read_b32 v11, a177
  v_mfma_f32_16x16x32_bf16 a[120:123], v[60:63], v[76:79], a[120:123]
  v_permlane16_swap_b32 v184, v186
  v_permlane16_swap_b32 v185, v187
  v_accvgpr_read_b32 v12, a178
  v_accvgpr_read_b32 v13, a179
  v_mul_f32 v10, s46, v10
  v_mul_f32 v11, s46, v11
  v_mfma_f32_16x16x32_bf16 a[184:187], v[56:59], v[80:83], a[184:187]
  v_mul_f32 v12, s46, v12
  v_mul_f32 v13, s46, v13
  v_cvt_pk_bf16_f32 v216, v10, v11
  v_cvt_pk_bf16_f32 v217, v12, v13
  v_accvgpr_read_b32 v10, a180
  v_accvgpr_read_b32 v11, a181
  v_mfma_f32_16x16x32_bf16 a[184:187], v[60:63], v[84:87], a[184:187]
  v_accvgpr_read_b32 v12, a182
  v_accvgpr_read_b32 v13, a183
  v_mul_f32 v10, s46, v10
  v_mul_f32 v11, s46, v11
  v_mul_f32 v12, s46, v12
  v_mul_f32 v13, s46, v13
  v_mfma_f32_16x16x32_bf16 a[248:251], v[56:59], v[88:91], a[248:251]
  v_cvt_pk_bf16_f32 v218, v10, v11
  v_cvt_pk_bf16_f32 v219, v12, v13
  v_accvgpr_read_b32 v10, a240
  v_accvgpr_read_b32 v11, a241
  v_permlane16_swap_b32 v216, v218
  v_permlane16_swap_b32 v217, v219
  v_mfma_f32_16x16x32_bf16 a[248:251], v[60:63], v[92:95], a[248:251]
  s_add_u32 m0, s32, 6144
  s_add_u32 s34, s30, 24576
  buffer_load_dwordx4 v7, s[8:11], s34 offen nt lds
  v_accvgpr_read_b32 v12, a242
  v_accvgpr_read_b32 v13, a243
  v_mul_f32 v10, s46, v10
  v_mul_f32 v11, s46, v11
  v_mfma_f32_16x16x32_bf16 v[120:123], v[56:59], v[16:19], v[120:123]
  v_mul_f32 v12, s46, v12
  v_mul_f32 v13, s46, v13
  v_cvt_pk_bf16_f32 v248, v10, v11
  v_cvt_pk_bf16_f32 v249, v12, v13
  v_accvgpr_read_b32 v10, a244
  v_accvgpr_read_b32 v11, a245
  v_mfma_f32_16x16x32_bf16 v[120:123], v[60:63], v[20:23], v[120:123]
  ds_read_b128 v[56:59], v1 offset:28672
  ds_read_b128 v[60:63], v2 offset:28672
  v_accvgpr_read_b32 v12, a246
  v_accvgpr_read_b32 v13, a247
  v_mul_f32 v10, s46, v10
  v_mul_f32 v11, s46, v11
  s_waitcnt lgkmcnt(9)
  v_mfma_f32_16x16x32_bf16 a[60:63], v[24:27], v[64:67], a[60:63]
  v_mul_f32 v12, s46, v12
  v_mul_f32 v13, s46, v13
  v_cvt_pk_bf16_f32 v250, v10, v11
  v_cvt_pk_bf16_f32 v251, v12, v13
  v_mul_f32 v10, s46, v112
  v_mul_f32 v11, s46, v113
  s_waitcnt lgkmcnt(7)
  v_mfma_f32_16x16x32_bf16 a[60:63], v[28:31], v[68:71], a[60:63]
  v_permlane16_swap_b32 v248, v250
  v_permlane16_swap_b32 v249, v251
  v_mul_f32 v12, s46, v114
  v_mul_f32 v13, s46, v115
  v_cvt_pk_bf16_f32 v112, v10, v11
  v_cvt_pk_bf16_f32 v113, v12, v13
  v_mfma_f32_16x16x32_bf16 a[124:127], v[24:27], v[72:75], a[124:127]
  v_mul_f32 v10, s46, v116
  v_mul_f32 v11, s46, v117
  v_mul_f32 v12, s46, v118
  v_mul_f32 v13, s46, v119
  v_cvt_pk_bf16_f32 v114, v10, v11
  v_cvt_pk_bf16_f32 v115, v12, v13
  v_mfma_f32_16x16x32_bf16 a[124:127], v[28:31], v[76:79], a[124:127]
  s_add_u32 m0, s32, 7168
  s_add_u32 s34, s30, 28672
  buffer_load_dwordx4 v7, s[8:11], s34 offen nt lds
  s_add_u32 s30, s30, 32768
  s_xor_b32 s32, s32, 65536
  v_mfma_f32_16x16x32_bf16 a[188:191], v[24:27], v[80:83], a[188:191]
  v_accvgpr_read_b32 v10, a56
  v_accvgpr_read_b32 v11, a57
  v_permlane16_swap_b32 v112, v114
  v_permlane16_swap_b32 v113, v115
  ds_write_b128 v9, v[112:115] offset:6144
  v_accvgpr_read_b32 v12, a58
  v_mfma_f32_16x16x32_bf16 a[188:191], v[28:31], v[84:87], a[188:191]
  v_accvgpr_read_b32 v13, a59
  v_mul_f32 v10, s46, v10
  v_mul_f32 v11, s46, v11
  v_mul_f32 v12, s46, v12
  v_mul_f32 v13, s46, v13
  v_cvt_pk_bf16_f32 v156, v10, v11
  v_mfma_f32_16x16x32_bf16 a[252:255], v[24:27], v[88:91], a[252:255]
  v_cvt_pk_bf16_f32 v157, v12, v13
  v_accvgpr_read_b32 v10, a60
  v_accvgpr_read_b32 v11, a61
  v_accvgpr_read_b32 v12, a62
  v_accvgpr_read_b32 v13, a63
  v_mul_f32 v10, s46, v10
  v_mfma_f32_16x16x32_bf16 a[252:255], v[28:31], v[92:95], a[252:255]
  v_mul_f32 v11, s46, v11
  v_mul_f32 v12, s46, v12
  v_mul_f32 v13, s46, v13
  v_cvt_pk_bf16_f32 v158, v10, v11
  v_cvt_pk_bf16_f32 v159, v12, v13
  v_accvgpr_read_b32 v10, a120
  v_mfma_f32_16x16x32_bf16 v[124:127], v[24:27], v[16:19], v[124:127]
  v_accvgpr_read_b32 v11, a121
  v_permlane16_swap_b32 v156, v158
  v_permlane16_swap_b32 v157, v159
  v_accvgpr_read_b32 v12, a122
  v_accvgpr_read_b32 v13, a123
  v_mul_f32 v10, s46, v10
  v_mfma_f32_16x16x32_bf16 v[124:127], v[28:31], v[20:23], v[124:127]
  v_mul_f32 v11, s46, v11
  v_mul_f32 v12, s46, v12
  v_mul_f32 v13, s46, v13
  v_cvt_pk_bf16_f32 v188, v10, v11
  v_cvt_pk_bf16_f32 v189, v12, v13
  v_accvgpr_read_b32 v10, a124
  v_accvgpr_read_b32 v11, a125
  v_accvgpr_read_b32 v12, a126
  v_accvgpr_read_b32 v13, a127
  v_mul_f32 v10, s46, v10
  v_mul_f32 v11, s46, v11
  v_mul_f32 v12, s46, v12
  v_mul_f32 v13, s46, v13
  v_cvt_pk_bf16_f32 v190, v10, v11
  v_cvt_pk_bf16_f32 v191, v12, v13
  v_accvgpr_read_b32 v10, a184
  v_accvgpr_read_b32 v11, a185
  v_permlane16_swap_b32 v188, v190
  v_permlane16_swap_b32 v189, v191
  v_accvgpr_read_b32 v12, a186
  v_accvgpr_read_b32 v13, a187
  v_mul_f32 v10, s46, v10
  v_mul_f32 v11, s46, v11
  v_mul_f32 v12, s46, v12
  v_mul_f32 v13, s46, v13
  v_cvt_pk_bf16_f32 v220, v10, v11
  v_cvt_pk_bf16_f32 v221, v12, v13
  v_accvgpr_read_b32 v10, a188
  v_accvgpr_read_b32 v11, a189
  v_accvgpr_read_b32 v12, a190
  v_accvgpr_read_b32 v13, a191
  v_mul_f32 v10, s46, v10
  v_mul_f32 v11, s46, v11
  v_mul_f32 v12, s46, v12
  v_mul_f32 v13, s46, v13
  v_cvt_pk_bf16_f32 v222, v10, v11
  v_cvt_pk_bf16_f32 v223, v12, v13
  v_accvgpr_read_b32 v10, a248
  v_accvgpr_read_b32 v11, a249
  v_permlane16_swap_b32 v220, v222
  v_permlane16_swap_b32 v221, v223
  v_accvgpr_read_b32 v12, a250
  v_accvgpr_read_b32 v13, a251
  v_mul_f32 v10, s46, v10
  v_mul_f32 v11, s46, v11
  v_mul_f32 v12, s46, v12
  v_mul_f32 v13, s46, v13
  v_cvt_pk_bf16_f32 v252, v10, v11
  v_cvt_pk_bf16_f32 v253, v12, v13
  v_accvgpr_read_b32 v10, a252
  v_accvgpr_read_b32 v11, a253
  v_accvgpr_read_b32 v12, a254
  v_accvgpr_read_b32 v13, a255
  v_mul_f32 v10, s46, v10
  v_mul_f32 v11, s46, v11
  v_mul_f32 v12, s46, v12
  v_mul_f32 v13, s46, v13
  v_cvt_pk_bf16_f32 v254, v10, v11
  v_cvt_pk_bf16_f32 v255, v12, v13
  v_mul_f32 v10, s46, v120
  v_mul_f32 v11, s46, v121
  v_permlane16_swap_b32 v252, v254
  v_permlane16_swap_b32 v253, v255
  v_mul_f32 v12, s46, v122
  v_mul_f32 v13, s46, v123
  v_cvt_pk_bf16_f32 v120, v10, v11
  v_cvt_pk_bf16_f32 v121, v12, v13
  v_mul_f32 v10, s46, v124
  v_mul_f32 v11, s46, v125
  v_mul_f32 v12, s46, v126
  v_mul_f32 v13, s46, v127
  v_cvt_pk_bf16_f32 v122, v10, v11
  v_cvt_pk_bf16_f32 v123, v12, v13
  s_nop 0
  v_permlane16_swap_b32 v120, v122
  v_permlane16_swap_b32 v121, v123
  ds_write_b128 v9, v[120:123] offset:7168
  v_mbcnt_lo_u32_b32 v16, -1, 0
  v_mbcnt_hi_u32_b32 v16, -1, v16
  v_and_b32 v17, 15, v16
  v_lshrrev_b32 v18, 4, v16
  v_bfe_u32 v19, v16, 2, 2
  v_and_b32 v20, 3, v16
  v_lshrrev_b32 v21, 3, v16
  v_and_b32 v22, 7, v16
  s_lshl_b32 s3, s48, 4
  s_add_u32 s3, s3, s49
  s_lshl_b32 s3, s3, 2
  s_add_u32 s3, s3, s28
  s_mul_i32 s3, s3, 7168
  s_cmp_eq_u32 s47, 0
  s_cselect_b32 s4, s66, s68
  s_cselect_b32 s5, s67, s69
  s_add_u32 s4, s4, s3
  s_addc_u32 s5, s5, 0
  s_mov_b32 s6, 7168
  s_mov_b32 s7, 0x20000
  v_lshlrev_b32 v23, 7, v16
  buffer_load_dword v0, v23, s[4:7], 0 offen
  v_lshrrev_b32 v23, 1, v19
  v_and_b32 v24, 1, v18
  v_lshlrev_b32 v24, 1, v24
  v_or_b32 v23, v23, v24
  v_lshlrev_b32 v24, 2, v18
  v_add_u32 v24, v24, v19
  v_lshlrev_b32 v24, 7, v24
  v_lshlrev_b32 v25, 3, v20
  v_add_u32 v24, v24, v25
  v_add_u32 v24, 65536, v24
  v_xor_b32 v25, 0, v23
  v_lshlrev_b32 v25, 5, v25
  v_add_u32 v3, v24, v25
  v_xor_b32 v25, 1, v23
  v_lshlrev_b32 v25, 5, v25
  v_add_u32 v4, v24, v25
  v_xor_b32 v25, 2, v23
  v_lshlrev_b32 v25, 5, v25
  v_add_u32 v5, v24, v25
  v_xor_b32 v25, 3, v23
  v_lshlrev_b32 v25, 5, v25
  v_add_u32 v6, v24, v25
  v_mov_b32 v10, 0
  v_mov_b32 v11, 0
  v_mov_b32 v12, 0
  v_mov_b32 v13, 0
  v_mov_b32 v14, 0
  s_waitcnt lgkmcnt(0)
  s_barrier
  s_cmp_lg_u32 s54, 0
  s_cbranch_scc1 K1_SAFE_P1
  ds_read_b128 v[32:35], v1 offset:4096
  ds_read_b128 v[36:39], v2 offset:4096
  ds_read_b128 v[40:43], v1 offset:12288
  ds_read_b128 v[44:47], v2 offset:12288
  ds_read_b128 v[48:51], v1 offset:20480
  ds_read_b128 v[52:55], v2 offset:20480
  ds_read_b128 v[56:59], v1 offset:28672
  ds_read_b128 v[60:63], v2 offset:28672
  s_waitcnt lgkmcnt(7)
  v_mfma_f32_16x16x32_bf16 v[16:19], v[32:35], v[128:131], 0
  ds_read_b128 v[80:83], v9 offset:0
  ds_read_b128 v[84:87], v9 offset:1024
  s_waitcnt lgkmcnt(8)
  v_mfma_f32_16x16x32_bf16 v[16:19], v[36:39], v[132:135], v[16:19]
  ds_read_b128 v[88:91], v9 offset:2048
  ds_read_b128 v[92:95], v9 offset:3072
  s_waitcnt lgkmcnt(9)
  v_mfma_f32_16x16x32_bf16 v[16:19], v[40:43], v[136:139], v[16:19]
  v_xor_b32 v3, 65536, v3
  v_xor_b32 v4, 65536, v4
  s_waitcnt lgkmcnt(8)
  v_mfma_f32_16x16x32_bf16 v[16:19], v[44:47], v[140:143], v[16:19]
  v_xor_b32 v5, 65536, v5
  v_xor_b32 v6, 65536, v6
  s_waitcnt lgkmcnt(7)
  v_mfma_f32_16x16x32_bf16 v[16:19], v[48:51], v[144:147], v[16:19]
  s_waitcnt lgkmcnt(6)
  v_mfma_f32_16x16x32_bf16 v[16:19], v[52:55], v[148:151], v[16:19]
  s_waitcnt lgkmcnt(5)
  v_mfma_f32_16x16x32_bf16 v[16:19], v[56:59], v[152:155], v[16:19]
  s_waitcnt lgkmcnt(4)
  v_mfma_f32_16x16x32_bf16 v[16:19], v[60:63], v[156:159], v[16:19]
  v_mfma_f32_16x16x32_bf16 v[20:23], v[32:35], v[160:163], 0
  ds_read_b128 v[24:27], v1 offset:6144
  v_mfma_f32_16x16x32_bf16 v[20:23], v[36:39], v[164:167], v[20:23]
  ds_read_b128 v[28:31], v2 offset:6144
  v_mfma_f32_16x16x32_bf16 v[20:23], v[40:43], v[168:171], v[20:23]
  s_nop 2
  v_exp_f32 v16, v16
  v_mfma_f32_16x16x32_bf16 v[20:23], v[44:47], v[172:175], v[20:23]
  v_exp_f32 v17, v17
  v_mfma_f32_16x16x32_bf16 v[20:23], v[48:51], v[176:179], v[20:23]
  v_exp_f32 v18, v18
  v_mfma_f32_16x16x32_bf16 v[20:23], v[52:55], v[180:183], v[20:23]
  v_exp_f32 v19, v19
  v_mfma_f32_16x16x32_bf16 v[20:23], v[56:59], v[184:187], v[20:23]
  v_add_f32 v10, v10, v16
  v_add_f32 v10, v10, v17
  v_mfma_f32_16x16x32_bf16 v[20:23], v[60:63], v[188:191], v[20:23]
  v_add_f32 v10, v10, v18
  v_add_f32 v10, v10, v19
  v_cvt_pk_bf16_f32 v64, v16, v17
  v_cvt_pk_bf16_f32 v65, v18, v19
  v_mfma_f32_16x16x32_bf16 v[16:19], v[32:35], v[192:195], 0
  v_mfma_f32_16x16x32_bf16 v[16:19], v[36:39], v[196:199], v[16:19]
  v_mfma_f32_16x16x32_bf16 v[16:19], v[40:43], v[200:203], v[16:19]
  s_nop 0
  v_exp_f32 v20, v20
  v_mfma_f32_16x16x32_bf16 v[16:19], v[44:47], v[204:207], v[16:19]
  v_exp_f32 v21, v21
  v_mfma_f32_16x16x32_bf16 v[16:19], v[48:51], v[208:211], v[16:19]
  v_exp_f32 v22, v22
  v_mfma_f32_16x16x32_bf16 v[16:19], v[52:55], v[212:215], v[16:19]
  v_exp_f32 v23, v23
  v_mfma_f32_16x16x32_bf16 v[16:19], v[56:59], v[216:219], v[16:19]
  v_add_f32 v11, v11, v20
  v_add_f32 v11, v11, v21
  v_mfma_f32_16x16x32_bf16 v[16:19], v[60:63], v[220:223], v[16:19]
  v_add_f32 v11, v11, v22
  v_add_f32 v11, v11, v23
  v_cvt_pk_bf16_f32 v68, v20, v21
  v_cvt_pk_bf16_f32 v69, v22, v23
  v_mfma_f32_16x16x32_bf16 v[20:23], v[32:35], v[224:227], 0
  v_mfma_f32_16x16x32_bf16 v[20:23], v[36:39], v[228:231], v[20:23]
  v_mfma_f32_16x16x32_bf16 v[20:23], v[40:43], v[232:235], v[20:23]
  s_nop 0
  v_exp_f32 v16, v16
  v_mfma_f32_16x16x32_bf16 v[20:23], v[44:47], v[236:239], v[20:23]
  v_exp_f32 v17, v17
  v_mfma_f32_16x16x32_bf16 v[20:23], v[48:51], v[240:243], v[20:23]
  v_exp_f32 v18, v18
  v_mfma_f32_16x16x32_bf16 v[20:23], v[52:55], v[244:247], v[20:23]
  v_exp_f32 v19, v19
  v_mfma_f32_16x16x32_bf16 v[20:23], v[56:59], v[248:251], v[20:23]
  v_add_f32 v12, v12, v16
  v_add_f32 v12, v12, v17
  v_mfma_f32_16x16x32_bf16 v[20:23], v[60:63], v[252:255], v[20:23]
  v_add_f32 v12, v12, v18
  v_add_f32 v12, v12, v19
  v_cvt_pk_bf16_f32 v72, v16, v17
  v_cvt_pk_bf16_f32 v73, v18, v19
  s_waitcnt lgkmcnt(5)
  v_mfma_f32_16x16x32_bf16 v[16:19], v[32:35], v[80:83], 0
  ds_read_b128 v[80:83], v9 offset:4096
  ds_read_b128 v[32:35], v1 offset:14336
  s_waitcnt lgkmcnt(6)
  v_mfma_f32_16x16x32_bf16 v[16:19], v[36:39], v[84:87], v[16:19]
  ds_read_b128 v[84:87], v9 offset:5120
  ds_read_b128 v[36:39], v2 offset:14336
  s_waitcnt lgkmcnt(7)
  v_mfma_f32_16x16x32_bf16 v[16:19], v[40:43], v[88:91], v[16:19]
  ds_read_b128 v[88:91], v9 offset:6144
  ds_read_b128 v[40:43], v1 offset:22528
  s_waitcnt lgkmcnt(8)
  v_mfma_f32_16x16x32_bf16 v[16:19], v[44:47], v[92:95], v[16:19]
  ds_read_b128 v[92:95], v9 offset:7168
  ds_read_b128 v[44:47], v2 offset:22528
  s_waitcnt lgkmcnt(7)
  v_mfma_f32_16x16x32_bf16 v[16:19], v[48:51], v[80:83], v[16:19]
  ds_read_b128 v[48:51], v1 offset:30720
  s_waitcnt lgkmcnt(6)
  v_mfma_f32_16x16x32_bf16 v[16:19], v[52:55], v[84:87], v[16:19]
  ds_read_b128 v[52:55], v2 offset:30720
  s_waitcnt lgkmcnt(5)
  v_mfma_f32_16x16x32_bf16 v[16:19], v[56:59], v[88:91], v[16:19]
  v_exp_f32 v20, v20
  s_waitcnt lgkmcnt(3)
  v_mfma_f32_16x16x32_bf16 v[16:19], v[60:63], v[92:95], v[16:19]
  v_exp_f32 v21, v21
  v_exp_f32 v22, v22
  v_exp_f32 v23, v23
  v_add_f32 v13, v13, v20
  v_add_f32 v13, v13, v21
  v_add_f32 v13, v13, v22
  v_add_f32 v13, v13, v23
  v_cvt_pk_bf16_f32 v76, v20, v21
  v_cvt_pk_bf16_f32 v77, v22, v23
  v_mfma_f32_16x16x32_bf16 v[20:23], v[24:27], v[128:131], 0
  ds_read_b128 v[80:83], v9 offset:0
  ds_read_b128 v[84:87], v9 offset:1024
  v_mfma_f32_16x16x32_bf16 v[20:23], v[28:31], v[132:135], v[20:23]
  ds_read_b128 v[88:91], v9 offset:2048
  ds_read_b128 v[92:95], v9 offset:3072
  v_mfma_f32_16x16x32_bf16 v[20:23], v[32:35], v[136:139], v[20:23]
  v_exp_f32 v16, v16
  v_mfma_f32_16x16x32_bf16 v[20:23], v[36:39], v[140:143], v[20:23]
  v_exp_f32 v17, v17
  v_mfma_f32_16x16x32_bf16 v[20:23], v[40:43], v[144:147], v[20:23]
  v_exp_f32 v18, v18
  s_waitcnt lgkmcnt(6)
  v_mfma_f32_16x16x32_bf16 v[20:23], v[44:47], v[148:151], v[20:23]
  v_exp_f32 v19, v19
  s_waitcnt lgkmcnt(5)
  v_mfma_f32_16x16x32_bf16 v[20:23], v[48:51], v[152:155], v[20:23]
  v_add_f32 v14, v14, v16
  v_add_f32 v14, v14, v17
  s_waitcnt lgkmcnt(4)
  v_mfma_f32_16x16x32_bf16 v[20:23], v[52:55], v[156:159], v[20:23]
  v_add_f32 v14, v14, v18
  v_add_f32 v14, v14, v19
  v_cvt_pk_bf16_f32 v16, v16, v17
  v_cvt_pk_bf16_f32 v17, v18, v19
  ds_write_b64 v9, v[16:17] offset:9216
  v_mfma_f32_16x16x32_bf16 v[16:19], v[24:27], v[160:163], 0
  ds_read_b128 v[56:59], v1 offset:0
  v_mfma_f32_16x16x32_bf16 v[16:19], v[28:31], v[164:167], v[16:19]
  ds_read_b128 v[60:63], v2 offset:0
  v_mfma_f32_16x16x32_bf16 v[16:19], v[32:35], v[168:171], v[16:19]
  v_exp_f32 v20, v20
  v_mfma_f32_16x16x32_bf16 v[16:19], v[36:39], v[172:175], v[16:19]
  v_exp_f32 v21, v21
  v_mfma_f32_16x16x32_bf16 v[16:19], v[40:43], v[176:179], v[16:19]
  v_exp_f32 v22, v22
  v_mfma_f32_16x16x32_bf16 v[16:19], v[44:47], v[180:183], v[16:19]
  v_exp_f32 v23, v23
  v_mfma_f32_16x16x32_bf16 v[16:19], v[48:51], v[184:187], v[16:19]
  v_add_f32 v10, v10, v20
  v_add_f32 v10, v10, v21
  v_mfma_f32_16x16x32_bf16 v[16:19], v[52:55], v[188:191], v[16:19]
  v_add_f32 v10, v10, v22
  v_add_f32 v10, v10, v23
  v_cvt_pk_bf16_f32 v66, v20, v21
  v_cvt_pk_bf16_f32 v67, v22, v23
  v_mfma_f32_16x16x32_bf16 v[20:23], v[24:27], v[192:195], 0
  v_mfma_f32_16x16x32_bf16 v[20:23], v[28:31], v[196:199], v[20:23]
  v_mfma_f32_16x16x32_bf16 v[20:23], v[32:35], v[200:203], v[20:23]
  s_nop 0
  v_exp_f32 v16, v16
  v_mfma_f32_16x16x32_bf16 v[20:23], v[36:39], v[204:207], v[20:23]
  v_exp_f32 v17, v17
  v_mfma_f32_16x16x32_bf16 v[20:23], v[40:43], v[208:211], v[20:23]
  v_exp_f32 v18, v18
  v_mfma_f32_16x16x32_bf16 v[20:23], v[44:47], v[212:215], v[20:23]
  v_exp_f32 v19, v19
  v_mfma_f32_16x16x32_bf16 v[20:23], v[48:51], v[216:219], v[20:23]
  v_add_f32 v11, v11, v16
  v_add_f32 v11, v11, v17
  v_mfma_f32_16x16x32_bf16 v[20:23], v[52:55], v[220:223], v[20:23]
  v_add_f32 v11, v11, v18
  v_add_f32 v11, v11, v19
  v_cvt_pk_bf16_f32 v70, v16, v17
  v_cvt_pk_bf16_f32 v71, v18, v19
  v_mfma_f32_16x16x32_bf16 v[16:19], v[24:27], v[224:227], 0
  v_mfma_f32_16x16x32_bf16 v[16:19], v[28:31], v[228:231], v[16:19]
  v_mfma_f32_16x16x32_bf16 v[16:19], v[32:35], v[232:235], v[16:19]
  s_nop 0
  v_exp_f32 v20, v20
  v_mfma_f32_16x16x32_bf16 v[16:19], v[36:39], v[236:239], v[16:19]
  v_exp_f32 v21, v21
  v_mfma_f32_16x16x32_bf16 v[16:19], v[40:43], v[240:243], v[16:19]
  v_exp_f32 v22, v22
  v_mfma_f32_16x16x32_bf16 v[16:19], v[44:47], v[244:247], v[16:19]
  v_exp_f32 v23, v23
  v_mfma_f32_16x16x32_bf16 v[16:19], v[48:51], v[248:251], v[16:19]
  v_add_f32 v12, v12, v20
  v_add_f32 v12, v12, v21
  v_mfma_f32_16x16x32_bf16 v[16:19], v[52:55], v[252:255], v[16:19]
  v_add_f32 v12, v12, v22
  v_add_f32 v12, v12, v23
  v_cvt_pk_bf16_f32 v74, v20, v21
  v_cvt_pk_bf16_f32 v75, v22, v23
  s_waitcnt lgkmcnt(6)
  v_mfma_f32_16x16x32_bf16 v[20:23], v[24:27], v[80:83], 0
  ds_read_b128 v[80:83], v9 offset:4096
  ds_read_b128 v[24:27], v1 offset:8192
  s_waitcnt lgkmcnt(7)
  v_mfma_f32_16x16x32_bf16 v[20:23], v[28:31], v[84:87], v[20:23]
  ds_read_b128 v[84:87], v9 offset:5120
  ds_read_b128 v[28:31], v2 offset:8192
  s_waitcnt lgkmcnt(8)
  v_mfma_f32_16x16x32_bf16 v[20:23], v[32:35], v[88:91], v[20:23]
  ds_read_b128 v[88:91], v9 offset:6144
  ds_read_b128 v[32:35], v1 offset:16384
  s_waitcnt lgkmcnt(9)
  v_mfma_f32_16x16x32_bf16 v[20:23], v[36:39], v[92:95], v[20:23]
  ds_read_b128 v[92:95], v9 offset:7168
  ds_read_b128 v[36:39], v2 offset:16384
  s_waitcnt lgkmcnt(7)
  v_mfma_f32_16x16x32_bf16 v[20:23], v[40:43], v[80:83], v[20:23]
  ds_read_b128 v[40:43], v1 offset:24576
  s_waitcnt lgkmcnt(6)
  v_mfma_f32_16x16x32_bf16 v[20:23], v[44:47], v[84:87], v[20:23]
  ds_read_b128 v[44:47], v2 offset:24576
  s_waitcnt lgkmcnt(5)
  v_mfma_f32_16x16x32_bf16 v[20:23], v[48:51], v[88:91], v[20:23]
  v_exp_f32 v16, v16
  s_waitcnt lgkmcnt(3)
  v_mfma_f32_16x16x32_bf16 v[20:23], v[52:55], v[92:95], v[20:23]
  v_exp_f32 v17, v17
  v_exp_f32 v18, v18
  v_exp_f32 v19, v19
  v_add_f32 v13, v13, v16
  v_add_f32 v13, v13, v17
  v_add_f32 v13, v13, v18
  v_add_f32 v13, v13, v19
  v_cvt_pk_bf16_f32 v78, v16, v17
  v_cvt_pk_bf16_f32 v79, v18, v19
  v_mfma_f32_16x16x32_bf16 v[16:19], v[56:59], v[128:131], 0
  v_mfma_f32_16x16x32_bf16 v[16:19], v[60:63], v[132:135], v[16:19]
  v_mfma_f32_16x16x32_bf16 v[16:19], v[24:27], v[136:139], v[16:19]
  v_exp_f32 v20, v20
  v_mfma_f32_16x16x32_bf16 v[16:19], v[28:31], v[140:143], v[16:19]
  v_exp_f32 v21, v21
  v_mfma_f32_16x16x32_bf16 v[16:19], v[32:35], v[144:147], v[16:19]
  v_exp_f32 v22, v22
  s_waitcnt lgkmcnt(2)
  v_mfma_f32_16x16x32_bf16 v[16:19], v[36:39], v[148:151], v[16:19]
  v_exp_f32 v23, v23
  s_waitcnt lgkmcnt(1)
  v_mfma_f32_16x16x32_bf16 v[16:19], v[40:43], v[152:155], v[16:19]
  v_add_f32 v14, v14, v20
  v_add_f32 v14, v14, v21
  s_waitcnt lgkmcnt(0)
  v_mfma_f32_16x16x32_bf16 v[16:19], v[44:47], v[156:159], v[16:19]
  v_add_f32 v14, v14, v22
  v_add_f32 v14, v14, v23
  v_cvt_pk_bf16_f32 v20, v20, v21
  v_cvt_pk_bf16_f32 v21, v22, v23
  ds_write_b64 v9, v[20:21] offset:9224
  v_mfma_f32_16x16x32_bf16 v[20:23], v[56:59], v[160:163], 0
  ds_read_b128 v[48:51], v1 offset:2048
  v_mfma_f32_16x16x32_bf16 v[20:23], v[60:63], v[164:167], v[20:23]
  ds_read_b128 v[52:55], v2 offset:2048
  v_mfma_f32_16x16x32_bf16 v[20:23], v[24:27], v[168:171], v[20:23]
  v_exp_f32 v16, v16
  v_mfma_f32_16x16x32_bf16 v[20:23], v[28:31], v[172:175], v[20:23]
  v_exp_f32 v17, v17
  v_mfma_f32_16x16x32_bf16 v[20:23], v[32:35], v[176:179], v[20:23]
  v_exp_f32 v18, v18
  v_mfma_f32_16x16x32_bf16 v[20:23], v[36:39], v[180:183], v[20:23]
  v_exp_f32 v19, v19
  v_mfma_f32_16x16x32_bf16 v[20:23], v[40:43], v[184:187], v[20:23]
  v_add_f32 v10, v10, v16
  v_add_f32 v10, v10, v17
  v_mfma_f32_16x16x32_bf16 v[20:23], v[44:47], v[188:191], v[20:23]
  v_add_f32 v10, v10, v18
  v_add_f32 v10, v10, v19
  v_cvt_pk_bf16_f32 v80, v16, v17
  v_cvt_pk_bf16_f32 v81, v18, v19
  v_mfma_f32_16x16x32_bf16 v[16:19], v[56:59], v[192:195], 0
  s_waitcnt vmcnt(9)
  s_waitcnt lgkmcnt(2)
  s_barrier
  v_mfma_f32_16x16x32_bf16 v[16:19], v[60:63], v[196:199], v[16:19]
  s_add_u32 m0, s33, 0
  s_add_u32 s34, s31, 0
  buffer_load_dwordx4 v8, s[12:15], s34 offen nt lds
  v_mfma_f32_16x16x32_bf16 v[16:19], v[24:27], v[200:203], v[16:19]
  v_exp_f32 v20, v20
  v_mfma_f32_16x16x32_bf16 v[16:19], v[28:31], v[204:207], v[16:19]
  v_exp_f32 v21, v21
  v_mfma_f32_16x16x32_bf16 v[16:19], v[32:35], v[208:211], v[16:19]
  v_exp_f32 v22, v22
  v_mfma_f32_16x16x32_bf16 v[16:19], v[36:39], v[212:215], v[16:19]
  v_exp_f32 v23, v23
  v_mfma_f32_16x16x32_bf16 v[16:19], v[40:43], v[216:219], v[16:19]
  s_add_u32 m0, s33, 1024
  s_add_u32 s34, s31, 4096
  buffer_load_dwordx4 v8, s[12:15], s34 offen nt lds
  v_mfma_f32_16x16x32_bf16 v[16:19], v[44:47], v[220:223], v[16:19]
  v_add_f32 v11, v11, v20
  v_add_f32 v11, v11, v21
  v_add_f32 v11, v11, v22
  v_add_f32 v11, v11, v23
  v_cvt_pk_bf16_f32 v84, v20, v21
  v_cvt_pk_bf16_f32 v85, v22, v23
  v_mfma_f32_16x16x32_bf16 v[20:23], v[56:59], v[224:227], 0
  ds_read_b128 v[56:59], v1 offset:10240
  v_mfma_f32_16x16x32_bf16 v[20:23], v[60:63], v[228:231], v[20:23]
  ds_read_b128 v[60:63], v2 offset:10240
  v_mfma_f32_16x16x32_bf16 v[20:23], v[24:27], v[232:235], v[20:23]
  ds_read_b128 v[24:27], v1 offset:18432
  v_mfma_f32_16x16x32_bf16 v[20:23], v[28:31], v[236:239], v[20:23]
  s_add_u32 m0, s33, 2048
  s_add_u32 s34, s31, 8192
  buffer_load_dwordx4 v8, s[12:15], s34 offen nt lds
  v_mfma_f32_16x16x32_bf16 v[20:23], v[32:35], v[240:243], v[20:23]
  ds_read_b128 v[28:31], v2 offset:18432
  ds_read_b128 v[32:35], v1 offset:26624
  v_mfma_f32_16x16x32_bf16 v[20:23], v[36:39], v[244:247], v[20:23]
  ds_read_b128 v[36:39], v2 offset:26624
  v_mfma_f32_16x16x32_bf16 v[20:23], v[40:43], v[248:251], v[20:23]
  v_exp_f32 v16, v16
  v_mfma_f32_16x16x32_bf16 v[20:23], v[44:47], v[252:255], v[20:23]
  v_exp_f32 v17, v17
  v_exp_f32 v18, v18
  v_exp_f32 v19, v19
  v_add_f32 v12, v12, v16
  v_add_f32 v12, v12, v17
  v_add_f32 v12, v12, v18
  v_add_f32 v12, v12, v19
  v_cvt_pk_bf16_f32 v88, v16, v17
  v_cvt_pk_bf16_f32 v89, v18, v19
  s_waitcnt lgkmcnt(7)
  v_mfma_f32_16x16x32_bf16 v[16:19], v[48:51], v[128:131], 0
  s_add_u32 m0, s33, 3072
  s_add_u32 s34, s31, 12288
  buffer_load_dwordx4 v8, s[12:15], s34 offen nt lds
  s_waitcnt lgkmcnt(6)
  v_mfma_f32_16x16x32_bf16 v[16:19], v[52:55], v[132:135], v[16:19]
  s_waitcnt lgkmcnt(5)
  v_mfma_f32_16x16x32_bf16 v[16:19], v[56:59], v[136:139], v[16:19]
  v_exp_f32 v20, v20
  s_waitcnt lgkmcnt(4)
  v_mfma_f32_16x16x32_bf16 v[16:19], v[60:63], v[140:143], v[16:19]
  v_exp_f32 v21, v21
  s_waitcnt lgkmcnt(3)
  v_mfma_f32_16x16x32_bf16 v[16:19], v[24:27], v[144:147], v[16:19]
  v_exp_f32 v22, v22
  s_waitcnt lgkmcnt(2)
  v_mfma_f32_16x16x32_bf16 v[16:19], v[28:31], v[148:151], v[16:19]
  s_add_u32 m0, s33, 4096
  s_add_u32 s34, s31, 16384
  buffer_load_dwordx4 v8, s[12:15], s34 offen nt lds
  s_waitcnt lgkmcnt(1)
  v_mfma_f32_16x16x32_bf16 v[16:19], v[32:35], v[152:155], v[16:19]
  v_exp_f32 v23, v23
  s_waitcnt lgkmcnt(0)
  v_mfma_f32_16x16x32_bf16 v[16:19], v[36:39], v[156:159], v[16:19]
  v_add_f32 v13, v13, v20
  v_add_f32 v13, v13, v21
  v_add_f32 v13, v13, v22
  v_add_f32 v13, v13, v23
  v_cvt_pk_bf16_f32 v92, v20, v21
  v_cvt_pk_bf16_f32 v93, v22, v23
  v_mfma_f32_16x16x32_bf16 v[20:23], v[48:51], v[160:163], 0
  ds_read_b64_tr_b16 v[40:41], v3 offset:4096
  ds_read_b64_tr_b16 v[42:43], v3 offset:6144
  v_mfma_f32_16x16x32_bf16 v[20:23], v[52:55], v[164:167], v[20:23]
  ds_read_b64_tr_b16 v[44:45], v3 offset:0
  ds_read_b64_tr_b16 v[46:47], v3 offset:2048
  v_mfma_f32_16x16x32_bf16 v[20:23], v[56:59], v[168:171], v[20:23]
  s_add_u32 m0, s33, 5120
  s_add_u32 s34, s31, 20480
  buffer_load_dwordx4 v8, s[12:15], s34 offen nt lds
  v_mfma_f32_16x16x32_bf16 v[20:23], v[60:63], v[172:175], v[20:23]
  v_exp_f32 v16, v16
  v_mfma_f32_16x16x32_bf16 v[20:23], v[24:27], v[176:179], v[20:23]
  v_exp_f32 v17, v17
  v_mfma_f32_16x16x32_bf16 v[20:23], v[28:31], v[180:183], v[20:23]
  v_exp_f32 v18, v18
  v_mfma_f32_16x16x32_bf16 v[20:23], v[32:35], v[184:187], v[20:23]
  v_exp_f32 v19, v19
  v_mfma_f32_16x16x32_bf16 v[20:23], v[36:39], v[188:191], v[20:23]
  v_add_f32 v10, v10, v16
  v_add_f32 v10, v10, v17
  v_add_f32 v10, v10, v18
  v_add_f32 v10, v10, v19
  v_cvt_pk_bf16_f32 v82, v16, v17
  v_cvt_pk_bf16_f32 v83, v18, v19
  s_add_u32 m0, s33, 6144
  s_add_u32 s34, s31, 24576
  buffer_load_dwordx4 v8, s[12:15], s34 offen nt lds
  v_mfma_f32_16x16x32_bf16 v[16:19], v[48:51], v[192:195], 0
  v_mfma_f32_16x16x32_bf16 v[16:19], v[52:55], v[196:199], v[16:19]
  v_mfma_f32_16x16x32_bf16 v[16:19], v[56:59], v[200:203], v[16:19]
  v_exp_f32 v20, v20
  v_mfma_f32_16x16x32_bf16 v[16:19], v[60:63], v[204:207], v[16:19]
  v_exp_f32 v21, v21
  v_mfma_f32_16x16x32_bf16 v[16:19], v[24:27], v[208:211], v[16:19]
  s_add_u32 m0, s33, 7168
  s_add_u32 s34, s31, 28672
  buffer_load_dwordx4 v8, s[12:15], s34 offen nt lds
  s_add_u32 s31, s31, 32768
  s_xor_b32 s33, s33, 65536
  v_mfma_f32_16x16x32_bf16 v[16:19], v[28:31], v[212:215], v[16:19]
  v_exp_f32 v22, v22
  v_mfma_f32_16x16x32_bf16 v[16:19], v[32:35], v[216:219], v[16:19]
  v_exp_f32 v23, v23
  v_mfma_f32_16x16x32_bf16 v[16:19], v[36:39], v[220:223], v[16:19]
  v_add_f32 v11, v11, v20
  v_add_f32 v11, v11, v21
  v_add_f32 v11, v11, v22
  v_add_f32 v11, v11, v23
  v_cvt_pk_bf16_f32 v86, v20, v21
  v_cvt_pk_bf16_f32 v87, v22, v23
  v_mfma_f32_16x16x32_bf16 v[20:23], v[48:51], v[224:227], 0
  ds_read_b64_tr_b16 v[48:49], v4 offset:4096
  ds_read_b64_tr_b16 v[50:51], v4 offset:6144
  v_mfma_f32_16x16x32_bf16 v[20:23], v[52:55], v[228:231], v[20:23]
  ds_read_b64_tr_b16 v[52:53], v4 offset:0
  ds_read_b64_tr_b16 v[54:55], v4 offset:2048
  v_mfma_f32_16x16x32_bf16 v[20:23], v[56:59], v[232:235], v[20:23]
  v_exp_f32 v16, v16
  v_mfma_f32_16x16x32_bf16 v[20:23], v[60:63], v[236:239], v[20:23]
  v_exp_f32 v17, v17
  v_mfma_f32_16x16x32_bf16 v[20:23], v[24:27], v[240:243], v[20:23]
  v_exp_f32 v18, v18
  v_mfma_f32_16x16x32_bf16 v[20:23], v[28:31], v[244:247], v[20:23]
  v_exp_f32 v19, v19
  v_mfma_f32_16x16x32_bf16 v[20:23], v[32:35], v[248:251], v[20:23]
  v_add_f32 v12, v12, v16
  v_add_f32 v12, v12, v17
  v_mfma_f32_16x16x32_bf16 v[20:23], v[36:39], v[252:255], v[20:23]
  v_add_f32 v12, v12, v18
  v_add_f32 v12, v12, v19
  v_cvt_pk_bf16_f32 v90, v16, v17
  v_cvt_pk_bf16_f32 v91, v18, v19
  ds_read_b64_tr_b16 v[56:57], v5 offset:4096
  ds_read_b64_tr_b16 v[58:59], v5 offset:6144
  ds_read_b64_tr_b16 v[60:61], v5 offset:0
  ds_read_b64_tr_b16 v[62:63], v5 offset:2048
  s_waitcnt lgkmcnt(10)
  v_mfma_f32_16x16x32_bf16 a[0:3], v[40:43], v[64:67], 0
  s_waitcnt lgkmcnt(8)
  v_mfma_f32_16x16x32_bf16 a[0:3], v[44:47], v[80:83], a[0:3]
  v_exp_f32 v20, v20
  v_mfma_f32_16x16x32_bf16 a[64:67], v[40:43], v[68:71], 0
  v_exp_f32 v21, v21
  v_mfma_f32_16x16x32_bf16 a[64:67], v[44:47], v[84:87], a[64:67]
  v_exp_f32 v22, v22
  v_mfma_f32_16x16x32_bf16 a[128:131], v[40:43], v[72:75], 0
  v_exp_f32 v23, v23
  v_mfma_f32_16x16x32_bf16 a[128:131], v[44:47], v[88:91], a[128:131]
  v_add_f32 v13, v13, v20
  v_add_f32 v13, v13, v21
  v_mfma_f32_16x16x32_bf16 a[192:195], v[40:43], v[76:79], 0
  v_add_f32 v13, v13, v22
  v_add_f32 v13, v13, v23
  v_cvt_pk_bf16_f32 v94, v20, v21
  v_cvt_pk_bf16_f32 v95, v22, v23
  s_nop 1
  v_mfma_f32_16x16x32_bf16 a[192:195], v[44:47], v[92:95], a[192:195]
  ds_read_b64_tr_b16 v[24:25], v6 offset:4096
  ds_read_b64_tr_b16 v[26:27], v6 offset:6144
  s_waitcnt lgkmcnt(8)
  v_mfma_f32_16x16x32_bf16 a[4:7], v[48:51], v[64:67], 0
  ds_read_b64_tr_b16 v[28:29], v6 offset:0
  ds_read_b64_tr_b16 v[30:31], v6 offset:2048
  s_waitcnt lgkmcnt(8)
  v_mfma_f32_16x16x32_bf16 a[4:7], v[52:55], v[80:83], a[4:7]
  v_xor_b32 v1, 65536, v1
  v_xor_b32 v2, 65536, v2
  v_mfma_f32_16x16x32_bf16 a[68:71], v[48:51], v[68:71], 0
  v_mfma_f32_16x16x32_bf16 a[68:71], v[52:55], v[84:87], a[68:71]
  v_mfma_f32_16x16x32_bf16 a[132:135], v[48:51], v[72:75], 0
  ds_read_b128 v[16:19], v9 offset:9216
  ds_read_b128 v[20:23], v9 offset:8192
  v_mfma_f32_16x16x32_bf16 a[132:135], v[52:55], v[88:91], a[132:135]
  v_mfma_f32_16x16x32_bf16 a[196:199], v[48:51], v[76:79], 0
  v_mfma_f32_16x16x32_bf16 a[196:199], v[52:55], v[92:95], a[196:199]
  ds_read_b64_tr_b16 v[32:33], v3 offset:12288
  ds_read_b64_tr_b16 v[34:35], v3 offset:14336
  s_waitcnt lgkmcnt(10)
  v_mfma_f32_16x16x32_bf16 a[8:11], v[56:59], v[64:67], 0
  ds_read_b64_tr_b16 v[36:37], v3 offset:8192
  ds_read_b64_tr_b16 v[38:39], v3 offset:10240
  s_waitcnt lgkmcnt(10)
  v_mfma_f32_16x16x32_bf16 a[8:11], v[60:63], v[80:83], a[8:11]
  v_mfma_f32_16x16x32_bf16 a[72:75], v[56:59], v[68:71], 0
  v_mfma_f32_16x16x32_bf16 a[72:75], v[60:63], v[84:87], a[72:75]
  v_mfma_f32_16x16x32_bf16 a[136:139], v[56:59], v[72:75], 0
  v_mfma_f32_16x16x32_bf16 a[136:139], v[60:63], v[88:91], a[136:139]
  v_mfma_f32_16x16x32_bf16 a[200:203], v[56:59], v[76:79], 0
  v_mfma_f32_16x16x32_bf16 a[200:203], v[60:63], v[92:95], a[200:203]
  ds_read_b64_tr_b16 v[48:49], v4 offset:12288
  ds_read_b64_tr_b16 v[50:51], v4 offset:14336
  s_waitcnt lgkmcnt(10)
  v_mfma_f32_16x16x32_bf16 a[12:15], v[24:27], v[64:67], 0
  ds_read_b64_tr_b16 v[52:53], v4 offset:8192
  ds_read_b64_tr_b16 v[54:55], v4 offset:10240
  s_waitcnt lgkmcnt(10)
  v_mfma_f32_16x16x32_bf16 a[12:15], v[28:31], v[80:83], a[12:15]
  v_mfma_f32_16x16x32_bf16 a[76:79], v[24:27], v[68:71], 0
  v_mfma_f32_16x16x32_bf16 a[76:79], v[28:31], v[84:87], a[76:79]
  v_mfma_f32_16x16x32_bf16 a[140:143], v[24:27], v[72:75], 0
  v_mfma_f32_16x16x32_bf16 a[140:143], v[28:31], v[88:91], a[140:143]
  v_mfma_f32_16x16x32_bf16 a[204:207], v[24:27], v[76:79], 0
  v_mfma_f32_16x16x32_bf16 a[204:207], v[28:31], v[92:95], a[204:207]
  ds_read_b64_tr_b16 v[56:57], v5 offset:12288
  ds_read_b64_tr_b16 v[58:59], v5 offset:14336
  s_waitcnt lgkmcnt(8)
  v_mfma_f32_16x16x32_bf16 a[16:19], v[32:35], v[64:67], 0
  ds_read_b64_tr_b16 v[60:61], v5 offset:8192
  ds_read_b64_tr_b16 v[62:63], v5 offset:10240
  s_waitcnt lgkmcnt(8)
  v_mfma_f32_16x16x32_bf16 a[16:19], v[36:39], v[80:83], a[16:19]
  v_mfma_f32_16x16x32_bf16 a[80:83], v[32:35], v[68:71], 0
  v_mfma_f32_16x16x32_bf16 a[80:83], v[36:39], v[84:87], a[80:83]
  v_mfma_f32_16x16x32_bf16 a[144:147], v[32:35], v[72:75], 0
  v_mfma_f32_16x16x32_bf16 a[144:147], v[36:39], v[88:91], a[144:147]
  v_mfma_f32_16x16x32_bf16 a[208:211], v[32:35], v[76:79], 0
  v_mfma_f32_16x16x32_bf16 a[208:211], v[36:39], v[92:95], a[208:211]
  ds_read_b64_tr_b16 v[40:41], v6 offset:12288
  ds_read_b64_tr_b16 v[42:43], v6 offset:14336
  s_waitcnt lgkmcnt(8)
  v_mfma_f32_16x16x32_bf16 a[20:23], v[48:51], v[64:67], 0
  ds_read_b64_tr_b16 v[44:45], v6 offset:8192
  ds_read_b64_tr_b16 v[46:47], v6 offset:10240
  s_waitcnt lgkmcnt(8)
  v_mfma_f32_16x16x32_bf16 a[20:23], v[52:55], v[80:83], a[20:23]
  v_mfma_f32_16x16x32_bf16 a[84:87], v[48:51], v[68:71], 0
  v_mfma_f32_16x16x32_bf16 a[84:87], v[52:55], v[84:87], a[84:87]
  v_mfma_f32_16x16x32_bf16 a[148:151], v[48:51], v[72:75], 0
  v_mfma_f32_16x16x32_bf16 a[148:151], v[52:55], v[88:91], a[148:151]
  v_mfma_f32_16x16x32_bf16 a[212:215], v[48:51], v[76:79], 0
  v_mfma_f32_16x16x32_bf16 a[212:215], v[52:55], v[92:95], a[212:215]
  ds_read_b64_tr_b16 v[24:25], v3 offset:20480
  ds_read_b64_tr_b16 v[26:27], v3 offset:22528
  s_waitcnt lgkmcnt(8)
  v_mfma_f32_16x16x32_bf16 a[24:27], v[56:59], v[64:67], 0
  ds_read_b64_tr_b16 v[28:29], v3 offset:16384
  ds_read_b64_tr_b16 v[30:31], v3 offset:18432
  s_waitcnt lgkmcnt(8)
  v_mfma_f32_16x16x32_bf16 a[24:27], v[60:63], v[80:83], a[24:27]
  v_mfma_f32_16x16x32_bf16 a[88:91], v[56:59], v[68:71], 0
  v_mfma_f32_16x16x32_bf16 a[88:91], v[60:63], v[84:87], a[88:91]
  v_mfma_f32_16x16x32_bf16 a[152:155], v[56:59], v[72:75], 0
  v_mfma_f32_16x16x32_bf16 a[152:155], v[60:63], v[88:91], a[152:155]
  v_mfma_f32_16x16x32_bf16 a[216:219], v[56:59], v[76:79], 0
  v_mfma_f32_16x16x32_bf16 a[216:219], v[60:63], v[92:95], a[216:219]
  ds_read_b64_tr_b16 v[48:49], v4 offset:20480
  ds_read_b64_tr_b16 v[50:51], v4 offset:22528
  s_waitcnt lgkmcnt(8)
  v_mfma_f32_16x16x32_bf16 a[28:31], v[40:43], v[64:67], 0
  ds_read_b64_tr_b16 v[52:53], v4 offset:16384
  ds_read_b64_tr_b16 v[54:55], v4 offset:18432
  s_waitcnt lgkmcnt(8)
  v_mfma_f32_16x16x32_bf16 a[28:31], v[44:47], v[80:83], a[28:31]
  v_mfma_f32_16x16x32_bf16 a[92:95], v[40:43], v[68:71], 0
  v_mfma_f32_16x16x32_bf16 a[92:95], v[44:47], v[84:87], a[92:95]
  v_mfma_f32_16x16x32_bf16 a[156:159], v[40:43], v[72:75], 0
  v_mfma_f32_16x16x32_bf16 a[156:159], v[44:47], v[88:91], a[156:159]
  v_mfma_f32_16x16x32_bf16 a[220:223], v[40:43], v[76:79], 0
  v_mfma_f32_16x16x32_bf16 a[220:223], v[44:47], v[92:95], a[220:223]
  ds_read_b64_tr_b16 v[56:57], v5 offset:20480
  ds_read_b64_tr_b16 v[58:59], v5 offset:22528
  s_waitcnt lgkmcnt(8)
  v_mfma_f32_16x16x32_bf16 a[32:35], v[24:27], v[64:67], 0
  ds_read_b64_tr_b16 v[60:61], v5 offset:16384
  ds_read_b64_tr_b16 v[62:63], v5 offset:18432
  s_waitcnt lgkmcnt(8)
  v_mfma_f32_16x16x32_bf16 a[32:35], v[28:31], v[80:83], a[32:35]
  v_mfma_f32_16x16x32_bf16 a[96:99], v[24:27], v[68:71], 0
  v_mfma_f32_16x16x32_bf16 a[96:99], v[28:31], v[84:87], a[96:99]
  v_mfma_f32_16x16x32_bf16 a[160:163], v[24:27], v[72:75], 0
  v_mfma_f32_16x16x32_bf16 a[160:163], v[28:31], v[88:91], a[160:163]
  v_mfma_f32_16x16x32_bf16 a[224:227], v[24:27], v[76:79], 0
  v_mfma_f32_16x16x32_bf16 a[224:227], v[28:31], v[92:95], a[224:227]
  v_mfma_f32_16x16x32_bf16 v[96:99], v[24:27], v[16:19], 0
  v_mfma_f32_16x16x32_bf16 v[96:99], v[28:31], v[20:23], v[96:99]
  ds_read_b64_tr_b16 v[32:33], v6 offset:20480
  ds_read_b64_tr_b16 v[34:35], v6 offset:22528
  s_waitcnt lgkmcnt(8)
  v_mfma_f32_16x16x32_bf16 a[36:39], v[48:51], v[64:67], 0
  ds_read_b64_tr_b16 v[36:37], v6 offset:16384
  ds_read_b64_tr_b16 v[38:39], v6 offset:18432
  s_waitcnt lgkmcnt(8)
  v_mfma_f32_16x16x32_bf16 a[36:39], v[52:55], v[80:83], a[36:39]
  v_mfma_f32_16x16x32_bf16 a[100:103], v[48:51], v[68:71], 0
  v_mfma_f32_16x16x32_bf16 a[100:103], v[52:55], v[84:87], a[100:103]
  v_mfma_f32_16x16x32_bf16 a[164:167], v[48:51], v[72:75], 0
  v_mfma_f32_16x16x32_bf16 a[164:167], v[52:55], v[88:91], a[164:167]
  v_mfma_f32_16x16x32_bf16 a[228:231], v[48:51], v[76:79], 0
  v_mfma_f32_16x16x32_bf16 a[228:231], v[52:55], v[92:95], a[228:231]
  v_mfma_f32_16x16x32_bf16 v[100:103], v[48:51], v[16:19], 0
  v_mfma_f32_16x16x32_bf16 v[100:103], v[52:55], v[20:23], v[100:103]
  ds_read_b64_tr_b16 v[40:41], v3 offset:28672
  ds_read_b64_tr_b16 v[42:43], v3 offset:30720
  s_waitcnt lgkmcnt(8)
  v_mfma_f32_16x16x32_bf16 a[40:43], v[56:59], v[64:67], 0
  ds_read_b64_tr_b16 v[44:45], v3 offset:24576
  ds_read_b64_tr_b16 v[46:47], v3 offset:26624
  s_waitcnt lgkmcnt(8)
  v_mfma_f32_16x16x32_bf16 a[40:43], v[60:63], v[80:83], a[40:43]
  v_mfma_f32_16x16x32_bf16 a[104:107], v[56:59], v[68:71], 0
  v_mfma_f32_16x16x32_bf16 a[104:107], v[60:63], v[84:87], a[104:107]
  v_mfma_f32_16x16x32_bf16 a[168:171], v[56:59], v[72:75], 0
  v_mfma_f32_16x16x32_bf16 a[168:171], v[60:63], v[88:91], a[168:171]
  v_mfma_f32_16x16x32_bf16 a[232:235], v[56:59], v[76:79], 0
  v_mfma_f32_16x16x32_bf16 a[232:235], v[60:63], v[92:95], a[232:235]
  v_mfma_f32_16x16x32_bf16 v[104:107], v[56:59], v[16:19], 0
  v_mfma_f32_16x16x32_bf16 v[104:107], v[60:63], v[20:23], v[104:107]
  ds_read_b64_tr_b16 v[48:49], v4 offset:28672
  ds_read_b64_tr_b16 v[50:51], v4 offset:30720
  s_waitcnt lgkmcnt(8)
  v_mfma_f32_16x16x32_bf16 a[44:47], v[32:35], v[64:67], 0
  s_waitcnt vmcnt(9)
  s_barrier
  ds_read_b64_tr_b16 v[52:53], v4 offset:24576
  s_waitcnt lgkmcnt(7)
  v_mfma_f32_16x16x32_bf16 a[44:47], v[36:39], v[80:83], a[44:47]
  s_add_u32 m0, s32, 0
  s_add_u32 s34, s30, 0
  buffer_load_dwordx4 v7, s[8:11], s34 offen nt lds
  v_mfma_f32_16x16x32_bf16 a[108:111], v[32:35], v[68:71], 0
  ds_read_b64_tr_b16 v[54:55], v4 offset:26624
  v_mfma_f32_16x16x32_bf16 a[108:111], v[36:39], v[84:87], a[108:111]
  v_mfma_f32_16x16x32_bf16 a[172:175], v[32:35], v[72:75], 0
  v_mfma_f32_16x16x32_bf16 a[172:175], v[36:39], v[88:91], a[172:175]
  v_mfma_f32_16x16x32_bf16 a[236:239], v[32:35], v[76:79], 0
  v_mfma_f32_16x16x32_bf16 a[236:239], v[36:39], v[92:95], a[236:239]
  s_add_u32 m0, s32, 1024
  s_add_u32 s34, s30, 4096
  buffer_load_dwordx4 v7, s[8:11], s34 offen nt lds
  v_mfma_f32_16x16x32_bf16 v[108:111], v[32:35], v[16:19], 0
  v_mfma_f32_16x16x32_bf16 v[108:111], v[36:39], v[20:23], v[108:111]
  ds_read_b64_tr_b16 v[56:57], v5 offset:28672
  ds_read_b64_tr_b16 v[58:59], v5 offset:30720
  s_waitcnt lgkmcnt(8)
  v_mfma_f32_16x16x32_bf16 a[48:51], v[40:43], v[64:67], 0
  ds_read_b64_tr_b16 v[60:61], v5 offset:24576
  ds_read_b64_tr_b16 v[62:63], v5 offset:26624
  s_waitcnt lgkmcnt(8)
  v_mfma_f32_16x16x32_bf16 a[48:51], v[44:47], v[80:83], a[48:51]
  ds_read_b128 v[32:35], v1 offset:4096
  ds_read_b128 v[36:39], v2 offset:4096
  v_mfma_f32_16x16x32_bf16 a[112:115], v[40:43], v[68:71], 0
  v_mfma_f32_16x16x32_bf16 a[112:115], v[44:47], v[84:87], a[112:115]
  s_add_u32 m0, s32, 2048
  s_add_u32 s34, s30, 8192
  buffer_load_dwordx4 v7, s[8:11], s34 offen nt lds
  v_mfma_f32_16x16x32_bf16 a[176:179], v[40:43], v[72:75], 0
  v_mfma_f32_16x16x32_bf16 a[176:179], v[44:47], v[88:91], a[176:179]
  v_mfma_f32_16x16x32_bf16 a[240:243], v[40:43], v[76:79], 0
  v_mfma_f32_16x16x32_bf16 a[240:243], v[44:47], v[92:95], a[240:243]
  v_mfma_f32_16x16x32_bf16 v[112:115], v[40:43], v[16:19], 0
  v_mfma_f32_16x16x32_bf16 v[112:115], v[44:47], v[20:23], v[112:115]
  s_add_u32 m0, s32, 3072
  s_add_u32 s34, s30, 12288
  buffer_load_dwordx4 v7, s[8:11], s34 offen nt lds
  s_waitcnt lgkmcnt(8)
  v_mfma_f32_16x16x32_bf16 a[52:55], v[48:51], v[64:67], 0
  ds_read_b64_tr_b16 v[24:25], v6 offset:28672
  ds_read_b64_tr_b16 v[26:27], v6 offset:30720
  s_waitcnt lgkmcnt(8)
  v_mfma_f32_16x16x32_bf16 a[52:55], v[52:55], v[80:83], a[52:55]
  ds_read_b64_tr_b16 v[28:29], v6 offset:24576
  ds_read_b64_tr_b16 v[30:31], v6 offset:26624
  v_mfma_f32_16x16x32_bf16 a[116:119], v[48:51], v[68:71], 0
  ds_read_b128 v[40:43], v1 offset:12288
  ds_read_b128 v[44:47], v2 offset:12288
  v_mfma_f32_16x16x32_bf16 a[116:119], v[52:55], v[84:87], a[116:119]
  v_mfma_f32_16x16x32_bf16 a[180:183], v[48:51], v[72:75], 0
  v_mfma_f32_16x16x32_bf16 a[180:183], v[52:55], v[88:91], a[180:183]
  s_add_u32 m0, s32, 4096
  s_add_u32 s34, s30, 16384
  buffer_load_dwordx4 v7, s[8:11], s34 offen nt lds
  v_mfma_f32_16x16x32_bf16 a[244:247], v[48:51], v[76:79], 0
  v_mfma_f32_16x16x32_bf16 a[244:247], v[52:55], v[92:95], a[244:247]
  v_mfma_f32_16x16x32_bf16 v[116:119], v[48:51], v[16:19], 0
  v_mfma_f32_16x16x32_bf16 v[116:119], v[52:55], v[20:23], v[116:119]
  ds_read_b128 v[48:51], v1 offset:20480
  ds_read_b128 v[52:55], v2 offset:20480
  s_waitcnt lgkmcnt(12)
  v_mfma_f32_16x16x32_bf16 a[56:59], v[56:59], v[64:67], 0
  s_waitcnt lgkmcnt(10)
  v_mfma_f32_16x16x32_bf16 a[56:59], v[60:63], v[80:83], a[56:59]
  s_add_u32 m0, s32, 5120
  s_add_u32 s34, s30, 20480
  buffer_load_dwordx4 v7, s[8:11], s34 offen nt lds
  v_mfma_f32_16x16x32_bf16 a[120:123], v[56:59], v[68:71], 0
  v_mfma_f32_16x16x32_bf16 a[120:123], v[60:63], v[84:87], a[120:123]
  v_mfma_f32_16x16x32_bf16 a[184:187], v[56:59], v[72:75], 0
  v_mfma_f32_16x16x32_bf16 a[184:187], v[60:63], v[88:91], a[184:187]
  v_mfma_f32_16x16x32_bf16 a[248:251], v[56:59], v[76:79], 0
  v_mfma_f32_16x16x32_bf16 a[248:251], v[60:63], v[92:95], a[248:251]
  s_add_u32 m0, s32, 6144
  s_add_u32 s34, s30, 24576
  buffer_load_dwordx4 v7, s[8:11], s34 offen nt lds
  v_mfma_f32_16x16x32_bf16 v[120:123], v[56:59], v[16:19], 0
  v_mfma_f32_16x16x32_bf16 v[120:123], v[60:63], v[20:23], v[120:123]
  ds_read_b128 v[56:59], v1 offset:28672
  ds_read_b128 v[60:63], v2 offset:28672
  s_waitcnt lgkmcnt(8)
  v_mfma_f32_16x16x32_bf16 a[60:63], v[24:27], v[64:67], 0
  s_waitcnt lgkmcnt(6)
  v_mfma_f32_16x16x32_bf16 a[60:63], v[28:31], v[80:83], a[60:63]
  v_mfma_f32_16x16x32_bf16 a[124:127], v[24:27], v[68:71], 0
  v_mfma_f32_16x16x32_bf16 a[124:127], v[28:31], v[84:87], a[124:127]
  s_add_u32 m0, s32, 7168
  s_add_u32 s34, s30, 28672
  buffer_load_dwordx4 v7, s[8:11], s34 offen nt lds
  s_add_u32 s30, s30, 32768
  s_xor_b32 s32, s32, 65536
  v_mfma_f32_16x16x32_bf16 a[188:191], v[24:27], v[72:75], 0
  v_mfma_f32_16x16x32_bf16 a[188:191], v[28:31], v[88:91], a[188:191]
  v_mfma_f32_16x16x32_bf16 a[252:255], v[24:27], v[76:79], 0
  v_mfma_f32_16x16x32_bf16 a[252:255], v[28:31], v[92:95], a[252:255]
  v_mfma_f32_16x16x32_bf16 v[124:127], v[24:27], v[16:19], 0
  v_mfma_f32_16x16x32_bf16 v[124:127], v[28:31], v[20:23], v[124:127]
  s_mov_b32 s29, 14
  s_nop 9
K1_LOOP_P1:
  v_mfma_f32_16x16x32_bf16 v[16:19], v[32:35], v[128:131], 0
  ds_read_b128 v[80:83], v9 offset:0
  ds_read_b128 v[84:87], v9 offset:1024
  v_mfma_f32_16x16x32_bf16 v[16:19], v[36:39], v[132:135], v[16:19]
  ds_read_b128 v[88:91], v9 offset:2048
  ds_read_b128 v[92:95], v9 offset:3072
  s_waitcnt lgkmcnt(9)
  v_mfma_f32_16x16x32_bf16 v[16:19], v[40:43], v[136:139], v[16:19]
  v_xor_b32 v3, 65536, v3
  v_xor_b32 v4, 65536, v4
  s_waitcnt lgkmcnt(8)
  v_mfma_f32_16x16x32_bf16 v[16:19], v[44:47], v[140:143], v[16:19]
  v_xor_b32 v5, 65536, v5
  v_xor_b32 v6, 65536, v6
  s_waitcnt lgkmcnt(7)
  v_mfma_f32_16x16x32_bf16 v[16:19], v[48:51], v[144:147], v[16:19]
  s_waitcnt lgkmcnt(6)
  v_mfma_f32_16x16x32_bf16 v[16:19], v[52:55], v[148:151], v[16:19]
  s_waitcnt lgkmcnt(5)
  v_mfma_f32_16x16x32_bf16 v[16:19], v[56:59], v[152:155], v[16:19]
  s_waitcnt lgkmcnt(4)
  v_mfma_f32_16x16x32_bf16 v[16:19], v[60:63], v[156:159], v[16:19]
  v_mfma_f32_16x16x32_bf16 v[20:23], v[32:35], v[160:163], 0
  ds_read_b128 v[24:27], v1 offset:6144
  v_mfma_f32_16x16x32_bf16 v[20:23], v[36:39], v[164:167], v[20:23]
  ds_read_b128 v[28:31], v2 offset:6144
  v_mfma_f32_16x16x32_bf16 v[20:23], v[40:43], v[168:171], v[20:23]
  s_nop 2
  v_exp_f32 v16, v16
  v_mfma_f32_16x16x32_bf16 v[20:23], v[44:47], v[172:175], v[20:23]
  v_exp_f32 v17, v17
  v_mfma_f32_16x16x32_bf16 v[20:23], v[48:51], v[176:179], v[20:23]
  v_exp_f32 v18, v18
  v_mfma_f32_16x16x32_bf16 v[20:23], v[52:55], v[180:183], v[20:23]
  v_exp_f32 v19, v19
  v_mfma_f32_16x16x32_bf16 v[20:23], v[56:59], v[184:187], v[20:23]
  v_add_f32 v10, v10, v16
  v_add_f32 v10, v10, v17
  v_mfma_f32_16x16x32_bf16 v[20:23], v[60:63], v[188:191], v[20:23]
  v_add_f32 v10, v10, v18
  v_add_f32 v10, v10, v19
  v_cvt_pk_bf16_f32 v64, v16, v17
  v_cvt_pk_bf16_f32 v65, v18, v19
  v_mfma_f32_16x16x32_bf16 v[16:19], v[32:35], v[192:195], 0
  v_mfma_f32_16x16x32_bf16 v[16:19], v[36:39], v[196:199], v[16:19]
  v_mfma_f32_16x16x32_bf16 v[16:19], v[40:43], v[200:203], v[16:19]
  s_nop 0
  v_exp_f32 v20, v20
  v_mfma_f32_16x16x32_bf16 v[16:19], v[44:47], v[204:207], v[16:19]
  v_exp_f32 v21, v21
  v_mfma_f32_16x16x32_bf16 v[16:19], v[48:51], v[208:211], v[16:19]
  v_exp_f32 v22, v22
  v_mfma_f32_16x16x32_bf16 v[16:19], v[52:55], v[212:215], v[16:19]
  v_exp_f32 v23, v23
  v_mfma_f32_16x16x32_bf16 v[16:19], v[56:59], v[216:219], v[16:19]
  v_add_f32 v11, v11, v20
  v_add_f32 v11, v11, v21
  v_mfma_f32_16x16x32_bf16 v[16:19], v[60:63], v[220:223], v[16:19]
  v_add_f32 v11, v11, v22
  v_add_f32 v11, v11, v23
  v_cvt_pk_bf16_f32 v68, v20, v21
  v_cvt_pk_bf16_f32 v69, v22, v23
  v_mfma_f32_16x16x32_bf16 v[20:23], v[32:35], v[224:227], 0
  v_mfma_f32_16x16x32_bf16 v[20:23], v[36:39], v[228:231], v[20:23]
  v_mfma_f32_16x16x32_bf16 v[20:23], v[40:43], v[232:235], v[20:23]
  s_nop 0
  v_exp_f32 v16, v16
  v_mfma_f32_16x16x32_bf16 v[20:23], v[44:47], v[236:239], v[20:23]
  v_exp_f32 v17, v17
  v_mfma_f32_16x16x32_bf16 v[20:23], v[48:51], v[240:243], v[20:23]
  v_exp_f32 v18, v18
  v_mfma_f32_16x16x32_bf16 v[20:23], v[52:55], v[244:247], v[20:23]
  v_exp_f32 v19, v19
  v_mfma_f32_16x16x32_bf16 v[20:23], v[56:59], v[248:251], v[20:23]
  v_add_f32 v12, v12, v16
  v_add_f32 v12, v12, v17
  v_mfma_f32_16x16x32_bf16 v[20:23], v[60:63], v[252:255], v[20:23]
  v_add_f32 v12, v12, v18
  v_add_f32 v12, v12, v19
  v_cvt_pk_bf16_f32 v72, v16, v17
  v_cvt_pk_bf16_f32 v73, v18, v19
  s_waitcnt lgkmcnt(5)
  v_mfma_f32_16x16x32_bf16 v[16:19], v[32:35], v[80:83], 0
  ds_read_b128 v[80:83], v9 offset:4096
  ds_read_b128 v[32:35], v1 offset:14336
  s_waitcnt lgkmcnt(6)
  v_mfma_f32_16x16x32_bf16 v[16:19], v[36:39], v[84:87], v[16:19]
  ds_read_b128 v[84:87], v9 offset:5120
  ds_read_b128 v[36:39], v2 offset:14336
  s_waitcnt lgkmcnt(7)
  v_mfma_f32_16x16x32_bf16 v[16:19], v[40:43], v[88:91], v[16:19]
  ds_read_b128 v[88:91], v9 offset:6144
  ds_read_b128 v[40:43], v1 offset:22528
  s_waitcnt lgkmcnt(8)
  v_mfma_f32_16x16x32_bf16 v[16:19], v[44:47], v[92:95], v[16:19]
  ds_read_b128 v[92:95], v9 offset:7168
  ds_read_b128 v[44:47], v2 offset:22528
  s_waitcnt lgkmcnt(7)
  v_mfma_f32_16x16x32_bf16 v[16:19], v[48:51], v[80:83], v[16:19]
  ds_read_b128 v[48:51], v1 offset:30720
  s_waitcnt lgkmcnt(6)
  v_mfma_f32_16x16x32_bf16 v[16:19], v[52:55], v[84:87], v[16:19]
  ds_read_b128 v[52:55], v2 offset:30720
  s_waitcnt lgkmcnt(5)
  v_mfma_f32_16x16x32_bf16 v[16:19], v[56:59], v[88:91], v[16:19]
  v_exp_f32 v20, v20
  s_waitcnt lgkmcnt(3)
  v_mfma_f32_16x16x32_bf16 v[16:19], v[60:63], v[92:95], v[16:19]
  v_exp_f32 v21, v21
  v_exp_f32 v22, v22
  v_exp_f32 v23, v23
  v_add_f32 v13, v13, v20
  v_add_f32 v13, v13, v21
  v_add_f32 v13, v13, v22
  v_add_f32 v13, v13, v23
  v_cvt_pk_bf16_f32 v76, v20, v21
  v_cvt_pk_bf16_f32 v77, v22, v23
  v_mfma_f32_16x16x32_bf16 v[20:23], v[24:27], v[128:131], 0
  ds_read_b128 v[80:83], v9 offset:0
  ds_read_b128 v[84:87], v9 offset:1024
  v_mfma_f32_16x16x32_bf16 v[20:23], v[28:31], v[132:135], v[20:23]
  ds_read_b128 v[88:91], v9 offset:2048
  ds_read_b128 v[92:95], v9 offset:3072
  v_mfma_f32_16x16x32_bf16 v[20:23], v[32:35], v[136:139], v[20:23]
  v_exp_f32 v16, v16
  v_mfma_f32_16x16x32_bf16 v[20:23], v[36:39], v[140:143], v[20:23]
  v_exp_f32 v17, v17
  v_mfma_f32_16x16x32_bf16 v[20:23], v[40:43], v[144:147], v[20:23]
  v_exp_f32 v18, v18
  s_waitcnt lgkmcnt(6)
  v_mfma_f32_16x16x32_bf16 v[20:23], v[44:47], v[148:151], v[20:23]
  v_exp_f32 v19, v19
  s_waitcnt lgkmcnt(5)
  v_mfma_f32_16x16x32_bf16 v[20:23], v[48:51], v[152:155], v[20:23]
  v_add_f32 v14, v14, v16
  v_add_f32 v14, v14, v17
  s_waitcnt lgkmcnt(4)
  v_mfma_f32_16x16x32_bf16 v[20:23], v[52:55], v[156:159], v[20:23]
  v_add_f32 v14, v14, v18
  v_add_f32 v14, v14, v19
  v_cvt_pk_bf16_f32 v16, v16, v17
  v_cvt_pk_bf16_f32 v17, v18, v19
  ds_write_b64 v9, v[16:17] offset:9216
  v_mfma_f32_16x16x32_bf16 v[16:19], v[24:27], v[160:163], 0
  ds_read_b128 v[56:59], v1 offset:0
  v_mfma_f32_16x16x32_bf16 v[16:19], v[28:31], v[164:167], v[16:19]
  ds_read_b128 v[60:63], v2 offset:0
  v_mfma_f32_16x16x32_bf16 v[16:19], v[32:35], v[168:171], v[16:19]
  v_exp_f32 v20, v20
  v_mfma_f32_16x16x32_bf16 v[16:19], v[36:39], v[172:175], v[16:19]
  v_exp_f32 v21, v21
  v_mfma_f32_16x16x32_bf16 v[16:19], v[40:43], v[176:179], v[16:19]
  v_exp_f32 v22, v22
  v_mfma_f32_16x16x32_bf16 v[16:19], v[44:47], v[180:183], v[16:19]
  v_exp_f32 v23, v23
  v_mfma_f32_16x16x32_bf16 v[16:19], v[48:51], v[184:187], v[16:19]
  v_add_f32 v10, v10, v20
  v_add_f32 v10, v10, v21
  v_mfma_f32_16x16x32_bf16 v[16:19], v[52:55], v[188:191], v[16:19]
  v_add_f32 v10, v10, v22
  v_add_f32 v10, v10, v23
  v_cvt_pk_bf16_f32 v66, v20, v21
  v_cvt_pk_bf16_f32 v67, v22, v23
  v_mfma_f32_16x16x32_bf16 v[20:23], v[24:27], v[192:195], 0
  v_mfma_f32_16x16x32_bf16 v[20:23], v[28:31], v[196:199], v[20:23]
  v_mfma_f32_16x16x32_bf16 v[20:23], v[32:35], v[200:203], v[20:23]
  s_nop 0
  v_exp_f32 v16, v16
  v_mfma_f32_16x16x32_bf16 v[20:23], v[36:39], v[204:207], v[20:23]
  v_exp_f32 v17, v17
  v_mfma_f32_16x16x32_bf16 v[20:23], v[40:43], v[208:211], v[20:23]
  v_exp_f32 v18, v18
  v_mfma_f32_16x16x32_bf16 v[20:23], v[44:47], v[212:215], v[20:23]
  v_exp_f32 v19, v19
  v_mfma_f32_16x16x32_bf16 v[20:23], v[48:51], v[216:219], v[20:23]
  v_add_f32 v11, v11, v16
  v_add_f32 v11, v11, v17
  v_mfma_f32_16x16x32_bf16 v[20:23], v[52:55], v[220:223], v[20:23]
  v_add_f32 v11, v11, v18
  v_add_f32 v11, v11, v19
  v_cvt_pk_bf16_f32 v70, v16, v17
  v_cvt_pk_bf16_f32 v71, v18, v19
  v_mfma_f32_16x16x32_bf16 v[16:19], v[24:27], v[224:227], 0
  v_mfma_f32_16x16x32_bf16 v[16:19], v[28:31], v[228:231], v[16:19]
  v_mfma_f32_16x16x32_bf16 v[16:19], v[32:35], v[232:235], v[16:19]
  s_nop 0
  v_exp_f32 v20, v20
  v_mfma_f32_16x16x32_bf16 v[16:19], v[36:39], v[236:239], v[16:19]
  v_exp_f32 v21, v21
  v_mfma_f32_16x16x32_bf16 v[16:19], v[40:43], v[240:243], v[16:19]
  v_exp_f32 v22, v22
  v_mfma_f32_16x16x32_bf16 v[16:19], v[44:47], v[244:247], v[16:19]
  v_exp_f32 v23, v23
  v_mfma_f32_16x16x32_bf16 v[16:19], v[48:51], v[248:251], v[16:19]
  v_add_f32 v12, v12, v20
  v_add_f32 v12, v12, v21
  v_mfma_f32_16x16x32_bf16 v[16:19], v[52:55], v[252:255], v[16:19]
  v_add_f32 v12, v12, v22
  v_add_f32 v12, v12, v23
  v_cvt_pk_bf16_f32 v74, v20, v21
  v_cvt_pk_bf16_f32 v75, v22, v23
  s_waitcnt lgkmcnt(6)
  v_mfma_f32_16x16x32_bf16 v[20:23], v[24:27], v[80:83], 0
  ds_read_b128 v[80:83], v9 offset:4096
  ds_read_b128 v[24:27], v1 offset:8192
  s_waitcnt lgkmcnt(7)
  v_mfma_f32_16x16x32_bf16 v[20:23], v[28:31], v[84:87], v[20:23]
  ds_read_b128 v[84:87], v9 offset:5120
  ds_read_b128 v[28:31], v2 offset:8192
  s_waitcnt lgkmcnt(8)
  v_mfma_f32_16x16x32_bf16 v[20:23], v[32:35], v[88:91], v[20:23]
  ds_read_b128 v[88:91], v9 offset:6144
  ds_read_b128 v[32:35], v1 offset:16384
  s_waitcnt lgkmcnt(9)
  v_mfma_f32_16x16x32_bf16 v[20:23], v[36:39], v[92:95], v[20:23]
  ds_read_b128 v[92:95], v9 offset:7168
  ds_read_b128 v[36:39], v2 offset:16384
  s_waitcnt lgkmcnt(7)
  v_mfma_f32_16x16x32_bf16 v[20:23], v[40:43], v[80:83], v[20:23]
  ds_read_b128 v[40:43], v1 offset:24576
  s_waitcnt lgkmcnt(6)
  v_mfma_f32_16x16x32_bf16 v[20:23], v[44:47], v[84:87], v[20:23]
  ds_read_b128 v[44:47], v2 offset:24576
  s_waitcnt lgkmcnt(5)
  v_mfma_f32_16x16x32_bf16 v[20:23], v[48:51], v[88:91], v[20:23]
  v_exp_f32 v16, v16
  s_waitcnt lgkmcnt(3)
  v_mfma_f32_16x16x32_bf16 v[20:23], v[52:55], v[92:95], v[20:23]
  v_exp_f32 v17, v17
  v_exp_f32 v18, v18
  v_exp_f32 v19, v19
  v_add_f32 v13, v13, v16
  v_add_f32 v13, v13, v17
  v_add_f32 v13, v13, v18
  v_add_f32 v13, v13, v19
  v_cvt_pk_bf16_f32 v78, v16, v17
  v_cvt_pk_bf16_f32 v79, v18, v19
  v_mfma_f32_16x16x32_bf16 v[16:19], v[56:59], v[128:131], 0
  v_mfma_f32_16x16x32_bf16 v[16:19], v[60:63], v[132:135], v[16:19]
  v_mfma_f32_16x16x32_bf16 v[16:19], v[24:27], v[136:139], v[16:19]
  v_exp_f32 v20, v20
  v_mfma_f32_16x16x32_bf16 v[16:19], v[28:31], v[140:143], v[16:19]
  v_exp_f32 v21, v21
  v_mfma_f32_16x16x32_bf16 v[16:19], v[32:35], v[144:147], v[16:19]
  v_exp_f32 v22, v22
  s_waitcnt lgkmcnt(2)
  v_mfma_f32_16x16x32_bf16 v[16:19], v[36:39], v[148:151], v[16:19]
  v_exp_f32 v23, v23
  s_waitcnt lgkmcnt(1)
  v_mfma_f32_16x16x32_bf16 v[16:19], v[40:43], v[152:155], v[16:19]
  v_add_f32 v14, v14, v20
  v_add_f32 v14, v14, v21
  s_waitcnt lgkmcnt(0)
  v_mfma_f32_16x16x32_bf16 v[16:19], v[44:47], v[156:159], v[16:19]
  v_add_f32 v14, v14, v22
  v_add_f32 v14, v14, v23
  v_cvt_pk_bf16_f32 v20, v20, v21
  v_cvt_pk_bf16_f32 v21, v22, v23
  ds_write_b64 v9, v[20:21] offset:9224
  v_mfma_f32_16x16x32_bf16 v[20:23], v[56:59], v[160:163], 0
  ds_read_b128 v[48:51], v1 offset:2048
  v_mfma_f32_16x16x32_bf16 v[20:23], v[60:63], v[164:167], v[20:23]
  ds_read_b128 v[52:55], v2 offset:2048
  v_mfma_f32_16x16x32_bf16 v[20:23], v[24:27], v[168:171], v[20:23]
  v_exp_f32 v16, v16
  v_mfma_f32_16x16x32_bf16 v[20:23], v[28:31], v[172:175], v[20:23]
  v_exp_f32 v17, v17
  v_mfma_f32_16x16x32_bf16 v[20:23], v[32:35], v[176:179], v[20:23]
  v_exp_f32 v18, v18
  v_mfma_f32_16x16x32_bf16 v[20:23], v[36:39], v[180:183], v[20:23]
  v_exp_f32 v19, v19
  v_mfma_f32_16x16x32_bf16 v[20:23], v[40:43], v[184:187], v[20:23]
  v_add_f32 v10, v10, v16
  v_add_f32 v10, v10, v17
  v_mfma_f32_16x16x32_bf16 v[20:23], v[44:47], v[188:191], v[20:23]
  v_add_f32 v10, v10, v18
  v_add_f32 v10, v10, v19
  v_cvt_pk_bf16_f32 v80, v16, v17
  v_cvt_pk_bf16_f32 v81, v18, v19
  v_mfma_f32_16x16x32_bf16 v[16:19], v[56:59], v[192:195], 0
  s_waitcnt vmcnt(8)
  s_waitcnt lgkmcnt(2)
  s_barrier
  v_mfma_f32_16x16x32_bf16 v[16:19], v[60:63], v[196:199], v[16:19]
  s_add_u32 m0, s33, 0
  s_add_u32 s34, s31, 0
  buffer_load_dwordx4 v8, s[12:15], s34 offen nt lds
  v_mfma_f32_16x16x32_bf16 v[16:19], v[24:27], v[200:203], v[16:19]
  v_exp_f32 v20, v20
  v_mfma_f32_16x16x32_bf16 v[16:19], v[28:31], v[204:207], v[16:19]
  v_exp_f32 v21, v21
  v_mfma_f32_16x16x32_bf16 v[16:19], v[32:35], v[208:211], v[16:19]
  v_exp_f32 v22, v22
  v_mfma_f32_16x16x32_bf16 v[16:19], v[36:39], v[212:215], v[16:19]
  v_exp_f32 v23, v23
  v_mfma_f32_16x16x32_bf16 v[16:19], v[40:43], v[216:219], v[16:19]
  s_add_u32 m0, s33, 1024
  s_add_u32 s34, s31, 4096
  buffer_load_dwordx4 v8, s[12:15], s34 offen nt lds
  v_mfma_f32_16x16x32_bf16 v[16:19], v[44:47], v[220:223], v[16:19]
  v_add_f32 v11, v11, v20
  v_add_f32 v11, v11, v21
  v_add_f32 v11, v11, v22
  v_add_f32 v11, v11, v23
  v_cvt_pk_bf16_f32 v84, v20, v21
  v_cvt_pk_bf16_f32 v85, v22, v23
  v_mfma_f32_16x16x32_bf16 v[20:23], v[56:59], v[224:227], 0
  ds_read_b128 v[56:59], v1 offset:10240
  v_mfma_f32_16x16x32_bf16 v[20:23], v[60:63], v[228:231], v[20:23]
  ds_read_b128 v[60:63], v2 offset:10240
  v_mfma_f32_16x16x32_bf16 v[20:23], v[24:27], v[232:235], v[20:23]
  ds_read_b128 v[24:27], v1 offset:18432
  v_mfma_f32_16x16x32_bf16 v[20:23], v[28:31], v[236:239], v[20:23]
  s_add_u32 m0, s33, 2048
  s_add_u32 s34, s31, 8192
  buffer_load_dwordx4 v8, s[12:15], s34 offen nt lds
  v_mfma_f32_16x16x32_bf16 v[20:23], v[32:35], v[240:243], v[20:23]
  ds_read_b128 v[28:31], v2 offset:18432
  ds_read_b128 v[32:35], v1 offset:26624
  v_mfma_f32_16x16x32_bf16 v[20:23], v[36:39], v[244:247], v[20:23]
  ds_read_b128 v[36:39], v2 offset:26624
  v_mfma_f32_16x16x32_bf16 v[20:23], v[40:43], v[248:251], v[20:23]
  v_exp_f32 v16, v16
  v_mfma_f32_16x16x32_bf16 v[20:23], v[44:47], v[252:255], v[20:23]
  v_exp_f32 v17, v17
  v_exp_f32 v18, v18
  v_exp_f32 v19, v19
  v_add_f32 v12, v12, v16
  v_add_f32 v12, v12, v17
  v_add_f32 v12, v12, v18
  v_add_f32 v12, v12, v19
  v_cvt_pk_bf16_f32 v88, v16, v17
  v_cvt_pk_bf16_f32 v89, v18, v19
  s_waitcnt lgkmcnt(7)
  v_mfma_f32_16x16x32_bf16 v[16:19], v[48:51], v[128:131], 0
  s_add_u32 m0, s33, 3072
  s_add_u32 s34, s31, 12288
  buffer_load_dwordx4 v8, s[12:15], s34 offen nt lds
  s_waitcnt lgkmcnt(6)
  v_mfma_f32_16x16x32_bf16 v[16:19], v[52:55], v[132:135], v[16:19]
  s_waitcnt lgkmcnt(5)
  v_mfma_f32_16x16x32_bf16 v[16:19], v[56:59], v[136:139], v[16:19]
  v_exp_f32 v20, v20
  s_waitcnt lgkmcnt(4)
  v_mfma_f32_16x16x32_bf16 v[16:19], v[60:63], v[140:143], v[16:19]
  v_exp_f32 v21, v21
  s_waitcnt lgkmcnt(3)
  v_mfma_f32_16x16x32_bf16 v[16:19], v[24:27], v[144:147], v[16:19]
  v_exp_f32 v22, v22
  s_waitcnt lgkmcnt(2)
  v_mfma_f32_16x16x32_bf16 v[16:19], v[28:31], v[148:151], v[16:19]
  s_add_u32 m0, s33, 4096
  s_add_u32 s34, s31, 16384
  buffer_load_dwordx4 v8, s[12:15], s34 offen nt lds
  s_waitcnt lgkmcnt(1)
  v_mfma_f32_16x16x32_bf16 v[16:19], v[32:35], v[152:155], v[16:19]
  v_exp_f32 v23, v23
  s_waitcnt lgkmcnt(0)
  v_mfma_f32_16x16x32_bf16 v[16:19], v[36:39], v[156:159], v[16:19]
  v_add_f32 v13, v13, v20
  v_add_f32 v13, v13, v21
  v_add_f32 v13, v13, v22
  v_add_f32 v13, v13, v23
  v_cvt_pk_bf16_f32 v92, v20, v21
  v_cvt_pk_bf16_f32 v93, v22, v23
  v_mfma_f32_16x16x32_bf16 v[20:23], v[48:51], v[160:163], 0
  ds_read_b64_tr_b16 v[40:41], v3 offset:4096
  ds_read_b64_tr_b16 v[42:43], v3 offset:6144
  v_mfma_f32_16x16x32_bf16 v[20:23], v[52:55], v[164:167], v[20:23]
  ds_read_b64_tr_b16 v[44:45], v3 offset:0
  ds_read_b64_tr_b16 v[46:47], v3 offset:2048
  v_mfma_f32_16x16x32_bf16 v[20:23], v[56:59], v[168:171], v[20:23]
  s_add_u32 m0, s33, 5120
  s_add_u32 s34, s31, 20480
  buffer_load_dwordx4 v8, s[12:15], s34 offen nt lds
  v_mfma_f32_16x16x32_bf16 v[20:23], v[60:63], v[172:175], v[20:23]
  v_exp_f32 v16, v16
  v_mfma_f32_16x16x32_bf16 v[20:23], v[24:27], v[176:179], v[20:23]
  v_exp_f32 v17, v17
  v_mfma_f32_16x16x32_bf16 v[20:23], v[28:31], v[180:183], v[20:23]
  v_exp_f32 v18, v18
  v_mfma_f32_16x16x32_bf16 v[20:23], v[32:35], v[184:187], v[20:23]
  v_exp_f32 v19, v19
  v_mfma_f32_16x16x32_bf16 v[20:23], v[36:39], v[188:191], v[20:23]
  v_add_f32 v10, v10, v16
  v_add_f32 v10, v10, v17
  v_add_f32 v10, v10, v18
  v_add_f32 v10, v10, v19
  v_cvt_pk_bf16_f32 v82, v16, v17
  v_cvt_pk_bf16_f32 v83, v18, v19
  s_add_u32 m0, s33, 6144
  s_add_u32 s34, s31, 24576
  buffer_load_dwordx4 v8, s[12:15], s34 offen nt lds
  v_mfma_f32_16x16x32_bf16 v[16:19], v[48:51], v[192:195], 0
  v_mfma_f32_16x16x32_bf16 v[16:19], v[52:55], v[196:199], v[16:19]
  v_mfma_f32_16x16x32_bf16 v[16:19], v[56:59], v[200:203], v[16:19]
  v_exp_f32 v20, v20
  v_mfma_f32_16x16x32_bf16 v[16:19], v[60:63], v[204:207], v[16:19]
  v_exp_f32 v21, v21
  v_mfma_f32_16x16x32_bf16 v[16:19], v[24:27], v[208:211], v[16:19]
  s_add_u32 m0, s33, 7168
  s_add_u32 s34, s31, 28672
  buffer_load_dwordx4 v8, s[12:15], s34 offen nt lds
  s_add_u32 s31, s31, 32768
  s_xor_b32 s33, s33, 65536
  v_mfma_f32_16x16x32_bf16 v[16:19], v[28:31], v[212:215], v[16:19]
  v_exp_f32 v22, v22
  v_mfma_f32_16x16x32_bf16 v[16:19], v[32:35], v[216:219], v[16:19]
  v_exp_f32 v23, v23
  v_mfma_f32_16x16x32_bf16 v[16:19], v[36:39], v[220:223], v[16:19]
  v_add_f32 v11, v11, v20
  v_add_f32 v11, v11, v21
  v_add_f32 v11, v11, v22
  v_add_f32 v11, v11, v23
  v_cvt_pk_bf16_f32 v86, v20, v21
  v_cvt_pk_bf16_f32 v87, v22, v23
  v_mfma_f32_16x16x32_bf16 v[20:23], v[48:51], v[224:227], 0
  ds_read_b64_tr_b16 v[48:49], v4 offset:4096
  ds_read_b64_tr_b16 v[50:51], v4 offset:6144
  v_mfma_f32_16x16x32_bf16 v[20:23], v[52:55], v[228:231], v[20:23]
  ds_read_b64_tr_b16 v[52:53], v4 offset:0
  ds_read_b64_tr_b16 v[54:55], v4 offset:2048
  v_mfma_f32_16x16x32_bf16 v[20:23], v[56:59], v[232:235], v[20:23]
  v_exp_f32 v16, v16
  v_mfma_f32_16x16x32_bf16 v[20:23], v[60:63], v[236:239], v[20:23]
  v_exp_f32 v17, v17
  v_mfma_f32_16x16x32_bf16 v[20:23], v[24:27], v[240:243], v[20:23]
  v_exp_f32 v18, v18
  v_mfma_f32_16x16x32_bf16 v[20:23], v[28:31], v[244:247], v[20:23]
  v_exp_f32 v19, v19
  v_mfma_f32_16x16x32_bf16 v[20:23], v[32:35], v[248:251], v[20:23]
  v_add_f32 v12, v12, v16
  v_add_f32 v12, v12, v17
  v_mfma_f32_16x16x32_bf16 v[20:23], v[36:39], v[252:255], v[20:23]
  v_add_f32 v12, v12, v18
  v_add_f32 v12, v12, v19
  v_cvt_pk_bf16_f32 v90, v16, v17
  v_cvt_pk_bf16_f32 v91, v18, v19
  ds_read_b64_tr_b16 v[56:57], v5 offset:4096
  ds_read_b64_tr_b16 v[58:59], v5 offset:6144
  ds_read_b64_tr_b16 v[60:61], v5 offset:0
  ds_read_b64_tr_b16 v[62:63], v5 offset:2048
  s_waitcnt lgkmcnt(10)
  v_mfma_f32_16x16x32_bf16 a[0:3], v[40:43], v[64:67], a[0:3]
  s_waitcnt lgkmcnt(8)
  v_mfma_f32_16x16x32_bf16 a[0:3], v[44:47], v[80:83], a[0:3]
  v_exp_f32 v20, v20
  v_mfma_f32_16x16x32_bf16 a[64:67], v[40:43], v[68:71], a[64:67]
  v_exp_f32 v21, v21
  v_mfma_f32_16x16x32_bf16 a[64:67], v[44:47], v[84:87], a[64:67]
  v_exp_f32 v22, v22
  v_mfma_f32_16x16x32_bf16 a[128:131], v[40:43], v[72:75], a[128:131]
  v_exp_f32 v23, v23
  v_mfma_f32_16x16x32_bf16 a[128:131], v[44:47], v[88:91], a[128:131]
  v_add_f32 v13, v13, v20
  v_add_f32 v13, v13, v21
  v_mfma_f32_16x16x32_bf16 a[192:195], v[40:43], v[76:79], a[192:195]
  v_add_f32 v13, v13, v22
  v_add_f32 v13, v13, v23
  v_cvt_pk_bf16_f32 v94, v20, v21
  v_cvt_pk_bf16_f32 v95, v22, v23
  s_nop 1
  v_mfma_f32_16x16x32_bf16 a[192:195], v[44:47], v[92:95], a[192:195]
  ds_read_b64_tr_b16 v[24:25], v6 offset:4096
  ds_read_b64_tr_b16 v[26:27], v6 offset:6144
  s_waitcnt lgkmcnt(8)
  v_mfma_f32_16x16x32_bf16 a[4:7], v[48:51], v[64:67], a[4:7]
  ds_read_b64_tr_b16 v[28:29], v6 offset:0
  ds_read_b64_tr_b16 v[30:31], v6 offset:2048
  s_waitcnt lgkmcnt(8)
  v_mfma_f32_16x16x32_bf16 a[4:7], v[52:55], v[80:83], a[4:7]
  v_xor_b32 v1, 65536, v1
  v_xor_b32 v2, 65536, v2
  v_mfma_f32_16x16x32_bf16 a[68:71], v[48:51], v[68:71], a[68:71]
  v_mfma_f32_16x16x32_bf16 a[68:71], v[52:55], v[84:87], a[68:71]
  v_mfma_f32_16x16x32_bf16 a[132:135], v[48:51], v[72:75], a[132:135]
  ds_read_b128 v[16:19], v9 offset:9216
  ds_read_b128 v[20:23], v9 offset:8192
  v_mfma_f32_16x16x32_bf16 a[132:135], v[52:55], v[88:91], a[132:135]
  v_mfma_f32_16x16x32_bf16 a[196:199], v[48:51], v[76:79], a[196:199]
  v_mfma_f32_16x16x32_bf16 a[196:199], v[52:55], v[92:95], a[196:199]
  ds_read_b64_tr_b16 v[32:33], v3 offset:12288
  ds_read_b64_tr_b16 v[34:35], v3 offset:14336
  s_waitcnt lgkmcnt(10)
  v_mfma_f32_16x16x32_bf16 a[8:11], v[56:59], v[64:67], a[8:11]
  ds_read_b64_tr_b16 v[36:37], v3 offset:8192
  ds_read_b64_tr_b16 v[38:39], v3 offset:10240
  s_waitcnt lgkmcnt(10)
  v_mfma_f32_16x16x32_bf16 a[8:11], v[60:63], v[80:83], a[8:11]
  v_mfma_f32_16x16x32_bf16 a[72:75], v[56:59], v[68:71], a[72:75]
  v_mfma_f32_16x16x32_bf16 a[72:75], v[60:63], v[84:87], a[72:75]
  v_mfma_f32_16x16x32_bf16 a[136:139], v[56:59], v[72:75], a[136:139]
  v_mfma_f32_16x16x32_bf16 a[136:139], v[60:63], v[88:91], a[136:139]
  v_mfma_f32_16x16x32_bf16 a[200:203], v[56:59], v[76:79], a[200:203]
  v_mfma_f32_16x16x32_bf16 a[200:203], v[60:63], v[92:95], a[200:203]
  ds_read_b64_tr_b16 v[48:49], v4 offset:12288
  ds_read_b64_tr_b16 v[50:51], v4 offset:14336
  s_waitcnt lgkmcnt(10)
  v_mfma_f32_16x16x32_bf16 a[12:15], v[24:27], v[64:67], a[12:15]
  ds_read_b64_tr_b16 v[52:53], v4 offset:8192
  ds_read_b64_tr_b16 v[54:55], v4 offset:10240
  s_waitcnt lgkmcnt(10)
  v_mfma_f32_16x16x32_bf16 a[12:15], v[28:31], v[80:83], a[12:15]
  v_mfma_f32_16x16x32_bf16 a[76:79], v[24:27], v[68:71], a[76:79]
  v_mfma_f32_16x16x32_bf16 a[76:79], v[28:31], v[84:87], a[76:79]
  v_mfma_f32_16x16x32_bf16 a[140:143], v[24:27], v[72:75], a[140:143]
  v_mfma_f32_16x16x32_bf16 a[140:143], v[28:31], v[88:91], a[140:143]
  v_mfma_f32_16x16x32_bf16 a[204:207], v[24:27], v[76:79], a[204:207]
  v_mfma_f32_16x16x32_bf16 a[204:207], v[28:31], v[92:95], a[204:207]
  ds_read_b64_tr_b16 v[56:57], v5 offset:12288
  ds_read_b64_tr_b16 v[58:59], v5 offset:14336
  s_waitcnt lgkmcnt(8)
  v_mfma_f32_16x16x32_bf16 a[16:19], v[32:35], v[64:67], a[16:19]
  ds_read_b64_tr_b16 v[60:61], v5 offset:8192
  ds_read_b64_tr_b16 v[62:63], v5 offset:10240
  s_waitcnt lgkmcnt(8)
  v_mfma_f32_16x16x32_bf16 a[16:19], v[36:39], v[80:83], a[16:19]
  v_mfma_f32_16x16x32_bf16 a[80:83], v[32:35], v[68:71], a[80:83]
  v_mfma_f32_16x16x32_bf16 a[80:83], v[36:39], v[84:87], a[80:83]
  v_mfma_f32_16x16x32_bf16 a[144:147], v[32:35], v[72:75], a[144:147]
  v_mfma_f32_16x16x32_bf16 a[144:147], v[36:39], v[88:91], a[144:147]
  v_mfma_f32_16x16x32_bf16 a[208:211], v[32:35], v[76:79], a[208:211]
  v_mfma_f32_16x16x32_bf16 a[208:211], v[36:39], v[92:95], a[208:211]
  ds_read_b64_tr_b16 v[40:41], v6 offset:12288
  ds_read_b64_tr_b16 v[42:43], v6 offset:14336
  s_waitcnt lgkmcnt(8)
  v_mfma_f32_16x16x32_bf16 a[20:23], v[48:51], v[64:67], a[20:23]
  ds_read_b64_tr_b16 v[44:45], v6 offset:8192
  ds_read_b64_tr_b16 v[46:47], v6 offset:10240
  s_waitcnt lgkmcnt(8)
  v_mfma_f32_16x16x32_bf16 a[20:23], v[52:55], v[80:83], a[20:23]
  v_mfma_f32_16x16x32_bf16 a[84:87], v[48:51], v[68:71], a[84:87]
  v_mfma_f32_16x16x32_bf16 a[84:87], v[52:55], v[84:87], a[84:87]
  v_mfma_f32_16x16x32_bf16 a[148:151], v[48:51], v[72:75], a[148:151]
  v_mfma_f32_16x16x32_bf16 a[148:151], v[52:55], v[88:91], a[148:151]
  v_mfma_f32_16x16x32_bf16 a[212:215], v[48:51], v[76:79], a[212:215]
  v_mfma_f32_16x16x32_bf16 a[212:215], v[52:55], v[92:95], a[212:215]
  ds_read_b64_tr_b16 v[24:25], v3 offset:20480
  ds_read_b64_tr_b16 v[26:27], v3 offset:22528
  s_waitcnt lgkmcnt(8)
  v_mfma_f32_16x16x32_bf16 a[24:27], v[56:59], v[64:67], a[24:27]
  ds_read_b64_tr_b16 v[28:29], v3 offset:16384
  ds_read_b64_tr_b16 v[30:31], v3 offset:18432
  s_waitcnt lgkmcnt(8)
  v_mfma_f32_16x16x32_bf16 a[24:27], v[60:63], v[80:83], a[24:27]
  v_mfma_f32_16x16x32_bf16 a[88:91], v[56:59], v[68:71], a[88:91]
  v_mfma_f32_16x16x32_bf16 a[88:91], v[60:63], v[84:87], a[88:91]
  v_mfma_f32_16x16x32_bf16 a[152:155], v[56:59], v[72:75], a[152:155]
  v_mfma_f32_16x16x32_bf16 a[152:155], v[60:63], v[88:91], a[152:155]
  v_mfma_f32_16x16x32_bf16 a[216:219], v[56:59], v[76:79], a[216:219]
  v_mfma_f32_16x16x32_bf16 a[216:219], v[60:63], v[92:95], a[216:219]
  ds_read_b64_tr_b16 v[48:49], v4 offset:20480
  ds_read_b64_tr_b16 v[50:51], v4 offset:22528
  s_waitcnt lgkmcnt(8)
  v_mfma_f32_16x16x32_bf16 a[28:31], v[40:43], v[64:67], a[28:31]
  ds_read_b64_tr_b16 v[52:53], v4 offset:16384
  ds_read_b64_tr_b16 v[54:55], v4 offset:18432
  s_waitcnt lgkmcnt(8)
  v_mfma_f32_16x16x32_bf16 a[28:31], v[44:47], v[80:83], a[28:31]
  v_mfma_f32_16x16x32_bf16 a[92:95], v[40:43], v[68:71], a[92:95]
  v_mfma_f32_16x16x32_bf16 a[92:95], v[44:47], v[84:87], a[92:95]
  v_mfma_f32_16x16x32_bf16 a[156:159], v[40:43], v[72:75], a[156:159]
  v_mfma_f32_16x16x32_bf16 a[156:159], v[44:47], v[88:91], a[156:159]
  v_mfma_f32_16x16x32_bf16 a[220:223], v[40:43], v[76:79], a[220:223]
  v_mfma_f32_16x16x32_bf16 a[220:223], v[44:47], v[92:95], a[220:223]
  ds_read_b64_tr_b16 v[56:57], v5 offset:20480
  ds_read_b64_tr_b16 v[58:59], v5 offset:22528
  s_waitcnt lgkmcnt(8)
  v_mfma_f32_16x16x32_bf16 a[32:35], v[24:27], v[64:67], a[32:35]
  ds_read_b64_tr_b16 v[60:61], v5 offset:16384
  ds_read_b64_tr_b16 v[62:63], v5 offset:18432
  s_waitcnt lgkmcnt(8)
  v_mfma_f32_16x16x32_bf16 a[32:35], v[28:31], v[80:83], a[32:35]
  v_mfma_f32_16x16x32_bf16 a[96:99], v[24:27], v[68:71], a[96:99]
  v_mfma_f32_16x16x32_bf16 a[96:99], v[28:31], v[84:87], a[96:99]
  v_mfma_f32_16x16x32_bf16 a[160:163], v[24:27], v[72:75], a[160:163]
  v_mfma_f32_16x16x32_bf16 a[160:163], v[28:31], v[88:91], a[160:163]
  v_mfma_f32_16x16x32_bf16 a[224:227], v[24:27], v[76:79], a[224:227]
  v_mfma_f32_16x16x32_bf16 a[224:227], v[28:31], v[92:95], a[224:227]
  v_mfma_f32_16x16x32_bf16 v[96:99], v[24:27], v[16:19], v[96:99]
  v_mfma_f32_16x16x32_bf16 v[96:99], v[28:31], v[20:23], v[96:99]
  ds_read_b64_tr_b16 v[32:33], v6 offset:20480
  ds_read_b64_tr_b16 v[34:35], v6 offset:22528
  s_waitcnt lgkmcnt(8)
  v_mfma_f32_16x16x32_bf16 a[36:39], v[48:51], v[64:67], a[36:39]
  ds_read_b64_tr_b16 v[36:37], v6 offset:16384
  ds_read_b64_tr_b16 v[38:39], v6 offset:18432
  s_waitcnt lgkmcnt(8)
  v_mfma_f32_16x16x32_bf16 a[36:39], v[52:55], v[80:83], a[36:39]
  v_mfma_f32_16x16x32_bf16 a[100:103], v[48:51], v[68:71], a[100:103]
  v_mfma_f32_16x16x32_bf16 a[100:103], v[52:55], v[84:87], a[100:103]
  v_mfma_f32_16x16x32_bf16 a[164:167], v[48:51], v[72:75], a[164:167]
  v_mfma_f32_16x16x32_bf16 a[164:167], v[52:55], v[88:91], a[164:167]
  v_mfma_f32_16x16x32_bf16 a[228:231], v[48:51], v[76:79], a[228:231]
  v_mfma_f32_16x16x32_bf16 a[228:231], v[52:55], v[92:95], a[228:231]
  v_mfma_f32_16x16x32_bf16 v[100:103], v[48:51], v[16:19], v[100:103]
  v_mfma_f32_16x16x32_bf16 v[100:103], v[52:55], v[20:23], v[100:103]
  ds_read_b64_tr_b16 v[40:41], v3 offset:28672
  ds_read_b64_tr_b16 v[42:43], v3 offset:30720
  s_waitcnt lgkmcnt(8)
  v_mfma_f32_16x16x32_bf16 a[40:43], v[56:59], v[64:67], a[40:43]
  ds_read_b64_tr_b16 v[44:45], v3 offset:24576
  ds_read_b64_tr_b16 v[46:47], v3 offset:26624
  s_waitcnt lgkmcnt(8)
  v_mfma_f32_16x16x32_bf16 a[40:43], v[60:63], v[80:83], a[40:43]
  v_mfma_f32_16x16x32_bf16 a[104:107], v[56:59], v[68:71], a[104:107]
  v_mfma_f32_16x16x32_bf16 a[104:107], v[60:63], v[84:87], a[104:107]
  v_mfma_f32_16x16x32_bf16 a[168:171], v[56:59], v[72:75], a[168:171]
  v_mfma_f32_16x16x32_bf16 a[168:171], v[60:63], v[88:91], a[168:171]
  v_mfma_f32_16x16x32_bf16 a[232:235], v[56:59], v[76:79], a[232:235]
  v_mfma_f32_16x16x32_bf16 a[232:235], v[60:63], v[92:95], a[232:235]
  v_mfma_f32_16x16x32_bf16 v[104:107], v[56:59], v[16:19], v[104:107]
  v_mfma_f32_16x16x32_bf16 v[104:107], v[60:63], v[20:23], v[104:107]
  ds_read_b64_tr_b16 v[48:49], v4 offset:28672
  ds_read_b64_tr_b16 v[50:51], v4 offset:30720
  s_waitcnt lgkmcnt(8)
  v_mfma_f32_16x16x32_bf16 a[44:47], v[32:35], v[64:67], a[44:47]
  s_waitcnt vmcnt(8)
  s_barrier
  ds_read_b64_tr_b16 v[52:53], v4 offset:24576
  s_waitcnt lgkmcnt(7)
  v_mfma_f32_16x16x32_bf16 a[44:47], v[36:39], v[80:83], a[44:47]
  s_add_u32 m0, s32, 0
  s_add_u32 s34, s30, 0
  buffer_load_dwordx4 v7, s[8:11], s34 offen nt lds
  v_mfma_f32_16x16x32_bf16 a[108:111], v[32:35], v[68:71], a[108:111]
  ds_read_b64_tr_b16 v[54:55], v4 offset:26624
  v_mfma_f32_16x16x32_bf16 a[108:111], v[36:39], v[84:87], a[108:111]
  v_mfma_f32_16x16x32_bf16 a[172:175], v[32:35], v[72:75], a[172:175]
  v_mfma_f32_16x16x32_bf16 a[172:175], v[36:39], v[88:91], a[172:175]
  v_mfma_f32_16x16x32_bf16 a[236:239], v[32:35], v[76:79], a[236:239]
  v_mfma_f32_16x16x32_bf16 a[236:239], v[36:39], v[92:95], a[236:239]
  s_add_u32 m0, s32, 1024
  s_add_u32 s34, s30, 4096
  buffer_load_dwordx4 v7, s[8:11], s34 offen nt lds
  v_mfma_f32_16x16x32_bf16 v[108:111], v[32:35], v[16:19], v[108:111]
  v_mfma_f32_16x16x32_bf16 v[108:111], v[36:39], v[20:23], v[108:111]
  ds_read_b64_tr_b16 v[56:57], v5 offset:28672
  ds_read_b64_tr_b16 v[58:59], v5 offset:30720
  s_waitcnt lgkmcnt(8)
  v_mfma_f32_16x16x32_bf16 a[48:51], v[40:43], v[64:67], a[48:51]
  ds_read_b64_tr_b16 v[60:61], v5 offset:24576
  ds_read_b64_tr_b16 v[62:63], v5 offset:26624
  s_waitcnt lgkmcnt(8)
  v_mfma_f32_16x16x32_bf16 a[48:51], v[44:47], v[80:83], a[48:51]
  ds_read_b128 v[32:35], v1 offset:4096
  ds_read_b128 v[36:39], v2 offset:4096
  v_mfma_f32_16x16x32_bf16 a[112:115], v[40:43], v[68:71], a[112:115]
  v_mfma_f32_16x16x32_bf16 a[112:115], v[44:47], v[84:87], a[112:115]
  s_add_u32 m0, s32, 2048
  s_add_u32 s34, s30, 8192
  buffer_load_dwordx4 v7, s[8:11], s34 offen nt lds
  v_mfma_f32_16x16x32_bf16 a[176:179], v[40:43], v[72:75], a[176:179]
  v_mfma_f32_16x16x32_bf16 a[176:179], v[44:47], v[88:91], a[176:179]
  v_mfma_f32_16x16x32_bf16 a[240:243], v[40:43], v[76:79], a[240:243]
  v_mfma_f32_16x16x32_bf16 a[240:243], v[44:47], v[92:95], a[240:243]
  v_mfma_f32_16x16x32_bf16 v[112:115], v[40:43], v[16:19], v[112:115]
  v_mfma_f32_16x16x32_bf16 v[112:115], v[44:47], v[20:23], v[112:115]
  s_add_u32 m0, s32, 3072
  s_add_u32 s34, s30, 12288
  buffer_load_dwordx4 v7, s[8:11], s34 offen nt lds
  s_waitcnt lgkmcnt(8)
  v_mfma_f32_16x16x32_bf16 a[52:55], v[48:51], v[64:67], a[52:55]
  ds_read_b64_tr_b16 v[24:25], v6 offset:28672
  ds_read_b64_tr_b16 v[26:27], v6 offset:30720
  s_waitcnt lgkmcnt(8)
  v_mfma_f32_16x16x32_bf16 a[52:55], v[52:55], v[80:83], a[52:55]
  ds_read_b64_tr_b16 v[28:29], v6 offset:24576
  ds_read_b64_tr_b16 v[30:31], v6 offset:26624
  v_mfma_f32_16x16x32_bf16 a[116:119], v[48:51], v[68:71], a[116:119]
  ds_read_b128 v[40:43], v1 offset:12288
  ds_read_b128 v[44:47], v2 offset:12288
  v_mfma_f32_16x16x32_bf16 a[116:119], v[52:55], v[84:87], a[116:119]
  v_mfma_f32_16x16x32_bf16 a[180:183], v[48:51], v[72:75], a[180:183]
  v_mfma_f32_16x16x32_bf16 a[180:183], v[52:55], v[88:91], a[180:183]
  s_add_u32 m0, s32, 4096
  s_add_u32 s34, s30, 16384
  buffer_load_dwordx4 v7, s[8:11], s34 offen nt lds
  v_mfma_f32_16x16x32_bf16 a[244:247], v[48:51], v[76:79], a[244:247]
  v_mfma_f32_16x16x32_bf16 a[244:247], v[52:55], v[92:95], a[244:247]
  v_mfma_f32_16x16x32_bf16 v[116:119], v[48:51], v[16:19], v[116:119]
  v_mfma_f32_16x16x32_bf16 v[116:119], v[52:55], v[20:23], v[116:119]
  ds_read_b128 v[48:51], v1 offset:20480
  ds_read_b128 v[52:55], v2 offset:20480
  s_waitcnt lgkmcnt(12)
  v_mfma_f32_16x16x32_bf16 a[56:59], v[56:59], v[64:67], a[56:59]
  s_waitcnt lgkmcnt(10)
  v_mfma_f32_16x16x32_bf16 a[56:59], v[60:63], v[80:83], a[56:59]
  s_add_u32 m0, s32, 5120
  s_add_u32 s34, s30, 20480
  buffer_load_dwordx4 v7, s[8:11], s34 offen nt lds
  v_mfma_f32_16x16x32_bf16 a[120:123], v[56:59], v[68:71], a[120:123]
  v_mfma_f32_16x16x32_bf16 a[120:123], v[60:63], v[84:87], a[120:123]
  v_mfma_f32_16x16x32_bf16 a[184:187], v[56:59], v[72:75], a[184:187]
  v_mfma_f32_16x16x32_bf16 a[184:187], v[60:63], v[88:91], a[184:187]
  v_mfma_f32_16x16x32_bf16 a[248:251], v[56:59], v[76:79], a[248:251]
  v_mfma_f32_16x16x32_bf16 a[248:251], v[60:63], v[92:95], a[248:251]
  s_add_u32 m0, s32, 6144
  s_add_u32 s34, s30, 24576
  buffer_load_dwordx4 v7, s[8:11], s34 offen nt lds
  v_mfma_f32_16x16x32_bf16 v[120:123], v[56:59], v[16:19], v[120:123]
  v_mfma_f32_16x16x32_bf16 v[120:123], v[60:63], v[20:23], v[120:123]
  ds_read_b128 v[56:59], v1 offset:28672
  ds_read_b128 v[60:63], v2 offset:28672
  s_waitcnt lgkmcnt(8)
  v_mfma_f32_16x16x32_bf16 a[60:63], v[24:27], v[64:67], a[60:63]
  s_waitcnt lgkmcnt(6)
  v_mfma_f32_16x16x32_bf16 a[60:63], v[28:31], v[80:83], a[60:63]
  v_mfma_f32_16x16x32_bf16 a[124:127], v[24:27], v[68:71], a[124:127]
  v_mfma_f32_16x16x32_bf16 a[124:127], v[28:31], v[84:87], a[124:127]
  s_add_u32 m0, s32, 7168
  s_add_u32 s34, s30, 28672
  buffer_load_dwordx4 v7, s[8:11], s34 offen nt lds
  s_add_u32 s30, s30, 32768
  s_xor_b32 s32, s32, 65536
  v_mfma_f32_16x16x32_bf16 a[188:191], v[24:27], v[72:75], a[188:191]
  v_mfma_f32_16x16x32_bf16 a[188:191], v[28:31], v[88:91], a[188:191]
  v_mfma_f32_16x16x32_bf16 a[252:255], v[24:27], v[76:79], a[252:255]
  v_mfma_f32_16x16x32_bf16 a[252:255], v[28:31], v[92:95], a[252:255]
  v_mfma_f32_16x16x32_bf16 v[124:127], v[24:27], v[16:19], v[124:127]
  v_mfma_f32_16x16x32_bf16 v[124:127], v[28:31], v[20:23], v[124:127]
  s_sub_u32 s29, s29, 1
  s_cmp_lg_u32 s29, 0
  s_cbranch_scc1 K1_LOOP_P1
  v_mfma_f32_16x16x32_bf16 v[16:19], v[32:35], v[128:131], 0
  ds_read_b128 v[80:83], v9 offset:0
  ds_read_b128 v[84:87], v9 offset:1024
  v_mfma_f32_16x16x32_bf16 v[16:19], v[36:39], v[132:135], v[16:19]
  ds_read_b128 v[88:91], v9 offset:2048
  ds_read_b128 v[92:95], v9 offset:3072
  s_waitcnt lgkmcnt(9)
  v_mfma_f32_16x16x32_bf16 v[16:19], v[40:43], v[136:139], v[16:19]
  v_xor_b32 v3, 65536, v3
  v_xor_b32 v4, 65536, v4
  s_waitcnt lgkmcnt(8)
  v_mfma_f32_16x16x32_bf16 v[16:19], v[44:47], v[140:143], v[16:19]
  v_xor_b32 v5, 65536, v5
  v_xor_b32 v6, 65536, v6
  s_waitcnt lgkmcnt(7)
  v_mfma_f32_16x16x32_bf16 v[16:19], v[48:51], v[144:147], v[16:19]
  s_waitcnt lgkmcnt(6)
  v_mfma_f32_16x16x32_bf16 v[16:19], v[52:55], v[148:151], v[16:19]
  s_waitcnt lgkmcnt(5)
  v_mfma_f32_16x16x32_bf16 v[16:19], v[56:59], v[152:155], v[16:19]
  s_waitcnt lgkmcnt(4)
  v_mfma_f32_16x16x32_bf16 v[16:19], v[60:63], v[156:159], v[16:19]
  v_mfma_f32_16x16x32_bf16 v[20:23], v[32:35], v[160:163], 0
  ds_read_b128 v[24:27], v1 offset:6144
  v_mfma_f32_16x16x32_bf16 v[20:23], v[36:39], v[164:167], v[20:23]
  ds_read_b128 v[28:31], v2 offset:6144
  v_mfma_f32_16x16x32_bf16 v[20:23], v[40:43], v[168:171], v[20:23]
  s_nop 2
  v_exp_f32 v16, v16
  v_mfma_f32_16x16x32_bf16 v[20:23], v[44:47], v[172:175], v[20:23]
  v_exp_f32 v17, v17
  v_mfma_f32_16x16x32_bf16 v[20:23], v[48:51], v[176:179], v[20:23]
  v_exp_f32 v18, v18
  v_mfma_f32_16x16x32_bf16 v[20:23], v[52:55], v[180:183], v[20:23]
  v_exp_f32 v19, v19
  v_mfma_f32_16x16x32_bf16 v[20:23], v[56:59], v[184:187], v[20:23]
  v_add_f32 v10, v10, v16
  v_add_f32 v10, v10, v17
  v_mfma_f32_16x16x32_bf16 v[20:23], v[60:63], v[188:191], v[20:23]
  v_add_f32 v10, v10, v18
  v_add_f32 v10, v10, v19
  v_cvt_pk_bf16_f32 v64, v16, v17
  v_cvt_pk_bf16_f32 v65, v18, v19
  v_mfma_f32_16x16x32_bf16 v[16:19], v[32:35], v[192:195], 0
  v_mfma_f32_16x16x32_bf16 v[16:19], v[36:39], v[196:199], v[16:19]
  v_mfma_f32_16x16x32_bf16 v[16:19], v[40:43], v[200:203], v[16:19]
  s_nop 0
  v_exp_f32 v20, v20
  v_mfma_f32_16x16x32_bf16 v[16:19], v[44:47], v[204:207], v[16:19]
  v_exp_f32 v21, v21
  v_mfma_f32_16x16x32_bf16 v[16:19], v[48:51], v[208:211], v[16:19]
  v_exp_f32 v22, v22
  v_mfma_f32_16x16x32_bf16 v[16:19], v[52:55], v[212:215], v[16:19]
  v_exp_f32 v23, v23
  v_mfma_f32_16x16x32_bf16 v[16:19], v[56:59], v[216:219], v[16:19]
  v_add_f32 v11, v11, v20
  v_add_f32 v11, v11, v21
  v_mfma_f32_16x16x32_bf16 v[16:19], v[60:63], v[220:223], v[16:19]
  v_add_f32 v11, v11, v22
  v_add_f32 v11, v11, v23
  v_cvt_pk_bf16_f32 v68, v20, v21
  v_cvt_pk_bf16_f32 v69, v22, v23
  v_mfma_f32_16x16x32_bf16 v[20:23], v[32:35], v[224:227], 0
  v_mfma_f32_16x16x32_bf16 v[20:23], v[36:39], v[228:231], v[20:23]
  v_mfma_f32_16x16x32_bf16 v[20:23], v[40:43], v[232:235], v[20:23]
  s_nop 0
  v_exp_f32 v16, v16
  v_mfma_f32_16x16x32_bf16 v[20:23], v[44:47], v[236:239], v[20:23]
  v_exp_f32 v17, v17
  v_mfma_f32_16x16x32_bf16 v[20:23], v[48:51], v[240:243], v[20:23]
  v_exp_f32 v18, v18
  v_mfma_f32_16x16x32_bf16 v[20:23], v[52:55], v[244:247], v[20:23]
  v_exp_f32 v19, v19
  v_mfma_f32_16x16x32_bf16 v[20:23], v[56:59], v[248:251], v[20:23]
  v_add_f32 v12, v12, v16
  v_add_f32 v12, v12, v17
  v_mfma_f32_16x16x32_bf16 v[20:23], v[60:63], v[252:255], v[20:23]
  v_add_f32 v12, v12, v18
  v_add_f32 v12, v12, v19
  v_cvt_pk_bf16_f32 v72, v16, v17
  v_cvt_pk_bf16_f32 v73, v18, v19
  s_waitcnt lgkmcnt(5)
  v_mfma_f32_16x16x32_bf16 v[16:19], v[32:35], v[80:83], 0
  ds_read_b128 v[80:83], v9 offset:4096
  ds_read_b128 v[32:35], v1 offset:14336
  s_waitcnt lgkmcnt(6)
  v_mfma_f32_16x16x32_bf16 v[16:19], v[36:39], v[84:87], v[16:19]
  ds_read_b128 v[84:87], v9 offset:5120
  ds_read_b128 v[36:39], v2 offset:14336
  s_waitcnt lgkmcnt(7)
  v_mfma_f32_16x16x32_bf16 v[16:19], v[40:43], v[88:91], v[16:19]
  ds_read_b128 v[88:91], v9 offset:6144
  ds_read_b128 v[40:43], v1 offset:22528
  s_waitcnt lgkmcnt(8)
  v_mfma_f32_16x16x32_bf16 v[16:19], v[44:47], v[92:95], v[16:19]
  ds_read_b128 v[92:95], v9 offset:7168
  ds_read_b128 v[44:47], v2 offset:22528
  s_waitcnt lgkmcnt(7)
  v_mfma_f32_16x16x32_bf16 v[16:19], v[48:51], v[80:83], v[16:19]
  ds_read_b128 v[48:51], v1 offset:30720
  s_waitcnt lgkmcnt(6)
  v_mfma_f32_16x16x32_bf16 v[16:19], v[52:55], v[84:87], v[16:19]
  ds_read_b128 v[52:55], v2 offset:30720
  s_waitcnt lgkmcnt(5)
  v_mfma_f32_16x16x32_bf16 v[16:19], v[56:59], v[88:91], v[16:19]
  v_exp_f32 v20, v20
  s_waitcnt lgkmcnt(3)
  v_mfma_f32_16x16x32_bf16 v[16:19], v[60:63], v[92:95], v[16:19]
  v_exp_f32 v21, v21
  v_exp_f32 v22, v22
  v_exp_f32 v23, v23
  v_add_f32 v13, v13, v20
  v_add_f32 v13, v13, v21
  v_add_f32 v13, v13, v22
  v_add_f32 v13, v13, v23
  v_cvt_pk_bf16_f32 v76, v20, v21
  v_cvt_pk_bf16_f32 v77, v22, v23
  v_mfma_f32_16x16x32_bf16 v[20:23], v[24:27], v[128:131], 0
  ds_read_b128 v[80:83], v9 offset:0
  ds_read_b128 v[84:87], v9 offset:1024
  v_mfma_f32_16x16x32_bf16 v[20:23], v[28:31], v[132:135], v[20:23]
  ds_read_b128 v[88:91], v9 offset:2048
  ds_read_b128 v[92:95], v9 offset:3072
  v_mfma_f32_16x16x32_bf16 v[20:23], v[32:35], v[136:139], v[20:23]
  v_exp_f32 v16, v16
  v_mfma_f32_16x16x32_bf16 v[20:23], v[36:39], v[140:143], v[20:23]
  v_exp_f32 v17, v17
  v_mfma_f32_16x16x32_bf16 v[20:23], v[40:43], v[144:147], v[20:23]
  v_exp_f32 v18, v18
  s_waitcnt lgkmcnt(6)
  v_mfma_f32_16x16x32_bf16 v[20:23], v[44:47], v[148:151], v[20:23]
  v_exp_f32 v19, v19
  s_waitcnt lgkmcnt(5)
  v_mfma_f32_16x16x32_bf16 v[20:23], v[48:51], v[152:155], v[20:23]
  v_add_f32 v14, v14, v16
  v_add_f32 v14, v14, v17
  s_waitcnt lgkmcnt(4)
  v_mfma_f32_16x16x32_bf16 v[20:23], v[52:55], v[156:159], v[20:23]
  v_add_f32 v14, v14, v18
  v_add_f32 v14, v14, v19
  v_cvt_pk_bf16_f32 v16, v16, v17
  v_cvt_pk_bf16_f32 v17, v18, v19
  ds_write_b64 v9, v[16:17] offset:9216
  v_mfma_f32_16x16x32_bf16 v[16:19], v[24:27], v[160:163], 0
  ds_read_b128 v[56:59], v1 offset:0
  v_mfma_f32_16x16x32_bf16 v[16:19], v[28:31], v[164:167], v[16:19]
  ds_read_b128 v[60:63], v2 offset:0
  v_mfma_f32_16x16x32_bf16 v[16:19], v[32:35], v[168:171], v[16:19]
  v_exp_f32 v20, v20
  v_mfma_f32_16x16x32_bf16 v[16:19], v[36:39], v[172:175], v[16:19]
  v_exp_f32 v21, v21
  v_mfma_f32_16x16x32_bf16 v[16:19], v[40:43], v[176:179], v[16:19]
  v_exp_f32 v22, v22
  v_mfma_f32_16x16x32_bf16 v[16:19], v[44:47], v[180:183], v[16:19]
  v_exp_f32 v23, v23
  v_mfma_f32_16x16x32_bf16 v[16:19], v[48:51], v[184:187], v[16:19]
  v_add_f32 v10, v10, v20
  v_add_f32 v10, v10, v21
  v_mfma_f32_16x16x32_bf16 v[16:19], v[52:55], v[188:191], v[16:19]
  v_add_f32 v10, v10, v22
  v_add_f32 v10, v10, v23
  v_cvt_pk_bf16_f32 v66, v20, v21
  v_cvt_pk_bf16_f32 v67, v22, v23
  v_mfma_f32_16x16x32_bf16 v[20:23], v[24:27], v[192:195], 0
  v_mfma_f32_16x16x32_bf16 v[20:23], v[28:31], v[196:199], v[20:23]
  v_mfma_f32_16x16x32_bf16 v[20:23], v[32:35], v[200:203], v[20:23]
  s_nop 0
  v_exp_f32 v16, v16
  v_mfma_f32_16x16x32_bf16 v[20:23], v[36:39], v[204:207], v[20:23]
  v_exp_f32 v17, v17
  v_mfma_f32_16x16x32_bf16 v[20:23], v[40:43], v[208:211], v[20:23]
  v_exp_f32 v18, v18
  v_mfma_f32_16x16x32_bf16 v[20:23], v[44:47], v[212:215], v[20:23]
  v_exp_f32 v19, v19
  v_mfma_f32_16x16x32_bf16 v[20:23], v[48:51], v[216:219], v[20:23]
  v_add_f32 v11, v11, v16
  v_add_f32 v11, v11, v17
  v_mfma_f32_16x16x32_bf16 v[20:23], v[52:55], v[220:223], v[20:23]
  v_add_f32 v11, v11, v18
  v_add_f32 v11, v11, v19
  v_cvt_pk_bf16_f32 v70, v16, v17
  v_cvt_pk_bf16_f32 v71, v18, v19
  v_mfma_f32_16x16x32_bf16 v[16:19], v[24:27], v[224:227], 0
  v_mfma_f32_16x16x32_bf16 v[16:19], v[28:31], v[228:231], v[16:19]
  v_mfma_f32_16x16x32_bf16 v[16:19], v[32:35], v[232:235], v[16:19]
  s_nop 0
  v_exp_f32 v20, v20
  v_mfma_f32_16x16x32_bf16 v[16:19], v[36:39], v[236:239], v[16:19]
  v_exp_f32 v21, v21
  v_mfma_f32_16x16x32_bf16 v[16:19], v[40:43], v[240:243], v[16:19]
  v_exp_f32 v22, v22
  v_mfma_f32_16x16x32_bf16 v[16:19], v[44:47], v[244:247], v[16:19]
  v_exp_f32 v23, v23
  v_mfma_f32_16x16x32_bf16 v[16:19], v[48:51], v[248:251], v[16:19]
  v_add_f32 v12, v12, v20
  v_add_f32 v12, v12, v21
  v_mfma_f32_16x16x32_bf16 v[16:19], v[52:55], v[252:255], v[16:19]
  v_add_f32 v12, v12, v22
  v_add_f32 v12, v12, v23
  v_cvt_pk_bf16_f32 v74, v20, v21
  v_cvt_pk_bf16_f32 v75, v22, v23
  s_waitcnt lgkmcnt(6)
  v_mfma_f32_16x16x32_bf16 v[20:23], v[24:27], v[80:83], 0
  ds_read_b128 v[80:83], v9 offset:4096
  ds_read_b128 v[24:27], v1 offset:8192
  s_waitcnt lgkmcnt(7)
  v_mfma_f32_16x16x32_bf16 v[20:23], v[28:31], v[84:87], v[20:23]
  ds_read_b128 v[84:87], v9 offset:5120
  ds_read_b128 v[28:31], v2 offset:8192
  s_waitcnt lgkmcnt(8)
  v_mfma_f32_16x16x32_bf16 v[20:23], v[32:35], v[88:91], v[20:23]
  ds_read_b128 v[88:91], v9 offset:6144
  ds_read_b128 v[32:35], v1 offset:16384
  s_waitcnt lgkmcnt(9)
  v_mfma_f32_16x16x32_bf16 v[20:23], v[36:39], v[92:95], v[20:23]
  ds_read_b128 v[92:95], v9 offset:7168
  ds_read_b128 v[36:39], v2 offset:16384
  s_waitcnt lgkmcnt(7)
  v_mfma_f32_16x16x32_bf16 v[20:23], v[40:43], v[80:83], v[20:23]
  ds_read_b128 v[40:43], v1 offset:24576
  s_waitcnt lgkmcnt(6)
  v_mfma_f32_16x16x32_bf16 v[20:23], v[44:47], v[84:87], v[20:23]
  ds_read_b128 v[44:47], v2 offset:24576
  s_waitcnt lgkmcnt(5)
  v_mfma_f32_16x16x32_bf16 v[20:23], v[48:51], v[88:91], v[20:23]
  v_exp_f32 v16, v16
  s_waitcnt lgkmcnt(3)
  v_mfma_f32_16x16x32_bf16 v[20:23], v[52:55], v[92:95], v[20:23]
  v_exp_f32 v17, v17
  v_exp_f32 v18, v18
  v_exp_f32 v19, v19
  v_add_f32 v13, v13, v16
  v_add_f32 v13, v13, v17
  v_add_f32 v13, v13, v18
  v_add_f32 v13, v13, v19
  v_cvt_pk_bf16_f32 v78, v16, v17
  v_cvt_pk_bf16_f32 v79, v18, v19
  v_mfma_f32_16x16x32_bf16 v[16:19], v[56:59], v[128:131], 0
  v_mfma_f32_16x16x32_bf16 v[16:19], v[60:63], v[132:135], v[16:19]
  v_mfma_f32_16x16x32_bf16 v[16:19], v[24:27], v[136:139], v[16:19]
  v_exp_f32 v20, v20
  v_mfma_f32_16x16x32_bf16 v[16:19], v[28:31], v[140:143], v[16:19]
  v_exp_f32 v21, v21
  v_mfma_f32_16x16x32_bf16 v[16:19], v[32:35], v[144:147], v[16:19]
  v_exp_f32 v22, v22
  s_waitcnt lgkmcnt(2)
  v_mfma_f32_16x16x32_bf16 v[16:19], v[36:39], v[148:151], v[16:19]
  v_exp_f32 v23, v23
  s_waitcnt lgkmcnt(1)
  v_mfma_f32_16x16x32_bf16 v[16:19], v[40:43], v[152:155], v[16:19]
  v_add_f32 v14, v14, v20
  v_add_f32 v14, v14, v21
  s_waitcnt lgkmcnt(0)
  v_mfma_f32_16x16x32_bf16 v[16:19], v[44:47], v[156:159], v[16:19]
  v_add_f32 v14, v14, v22
  v_add_f32 v14, v14, v23
  v_cvt_pk_bf16_f32 v20, v20, v21
  v_cvt_pk_bf16_f32 v21, v22, v23
  ds_write_b64 v9, v[20:21] offset:9224
  v_mfma_f32_16x16x32_bf16 v[20:23], v[56:59], v[160:163], 0
  ds_read_b128 v[48:51], v1 offset:2048
  v_mfma_f32_16x16x32_bf16 v[20:23], v[60:63], v[164:167], v[20:23]
  ds_read_b128 v[52:55], v2 offset:2048
  v_mfma_f32_16x16x32_bf16 v[20:23], v[24:27], v[168:171], v[20:23]
  v_exp_f32 v16, v16
  v_mfma_f32_16x16x32_bf16 v[20:23], v[28:31], v[172:175], v[20:23]
  v_exp_f32 v17, v17
  v_mfma_f32_16x16x32_bf16 v[20:23], v[32:35], v[176:179], v[20:23]
  v_exp_f32 v18, v18
  v_mfma_f32_16x16x32_bf16 v[20:23], v[36:39], v[180:183], v[20:23]
  v_exp_f32 v19, v19
  v_mfma_f32_16x16x32_bf16 v[20:23], v[40:43], v[184:187], v[20:23]
  v_add_f32 v10, v10, v16
  v_add_f32 v10, v10, v17
  v_mfma_f32_16x16x32_bf16 v[20:23], v[44:47], v[188:191], v[20:23]
  v_add_f32 v10, v10, v18
  v_add_f32 v10, v10, v19
  v_cvt_pk_bf16_f32 v80, v16, v17
  v_cvt_pk_bf16_f32 v81, v18, v19
  v_mfma_f32_16x16x32_bf16 v[16:19], v[56:59], v[192:195], 0
  s_waitcnt vmcnt(8)
  s_waitcnt lgkmcnt(2)
  s_barrier
  v_mfma_f32_16x16x32_bf16 v[16:19], v[60:63], v[196:199], v[16:19]
  v_mfma_f32_16x16x32_bf16 v[16:19], v[24:27], v[200:203], v[16:19]
  v_exp_f32 v20, v20
  v_mfma_f32_16x16x32_bf16 v[16:19], v[28:31], v[204:207], v[16:19]
  v_exp_f32 v21, v21
  v_mfma_f32_16x16x32_bf16 v[16:19], v[32:35], v[208:211], v[16:19]
  v_exp_f32 v22, v22
  v_mfma_f32_16x16x32_bf16 v[16:19], v[36:39], v[212:215], v[16:19]
  v_exp_f32 v23, v23
  v_mfma_f32_16x16x32_bf16 v[16:19], v[40:43], v[216:219], v[16:19]
  v_add_f32 v11, v11, v20
  v_add_f32 v11, v11, v21
  v_mfma_f32_16x16x32_bf16 v[16:19], v[44:47], v[220:223], v[16:19]
  v_add_f32 v11, v11, v22
  v_add_f32 v11, v11, v23
  v_cvt_pk_bf16_f32 v84, v20, v21
  v_cvt_pk_bf16_f32 v85, v22, v23
  v_mfma_f32_16x16x32_bf16 v[20:23], v[56:59], v[224:227], 0
  ds_read_b128 v[56:59], v1 offset:10240
  v_mfma_f32_16x16x32_bf16 v[20:23], v[60:63], v[228:231], v[20:23]
  ds_read_b128 v[60:63], v2 offset:10240
  v_mfma_f32_16x16x32_bf16 v[20:23], v[24:27], v[232:235], v[20:23]
  ds_read_b128 v[24:27], v1 offset:18432
  v_mfma_f32_16x16x32_bf16 v[20:23], v[28:31], v[236:239], v[20:23]
  ds_read_b128 v[28:31], v2 offset:18432
  v_mfma_f32_16x16x32_bf16 v[20:23], v[32:35], v[240:243], v[20:23]
  ds_read_b128 v[32:35], v1 offset:26624
  v_mfma_f32_16x16x32_bf16 v[20:23], v[36:39], v[244:247], v[20:23]
  ds_read_b128 v[36:39], v2 offset:26624
  v_mfma_f32_16x16x32_bf16 v[20:23], v[40:43], v[248:251], v[20:23]
  v_exp_f32 v16, v16
  v_mfma_f32_16x16x32_bf16 v[20:23], v[44:47], v[252:255], v[20:23]
  v_exp_f32 v17, v17
  v_exp_f32 v18, v18
  v_exp_f32 v19, v19
  v_add_f32 v12, v12, v16
  v_add_f32 v12, v12, v17
  v_add_f32 v12, v12, v18
  v_add_f32 v12, v12, v19
  v_cvt_pk_bf16_f32 v88, v16, v17
  v_cvt_pk_bf16_f32 v89, v18, v19
  s_waitcnt lgkmcnt(7)
  v_mfma_f32_16x16x32_bf16 v[16:19], v[48:51], v[128:131], 0
  s_waitcnt lgkmcnt(6)
  v_mfma_f32_16x16x32_bf16 v[16:19], v[52:55], v[132:135], v[16:19]
  s_waitcnt lgkmcnt(5)
  v_mfma_f32_16x16x32_bf16 v[16:19], v[56:59], v[136:139], v[16:19]
  v_exp_f32 v20, v20
  s_waitcnt lgkmcnt(4)
  v_mfma_f32_16x16x32_bf16 v[16:19], v[60:63], v[140:143], v[16:19]
  v_exp_f32 v21, v21
  s_waitcnt lgkmcnt(3)
  v_mfma_f32_16x16x32_bf16 v[16:19], v[24:27], v[144:147], v[16:19]
  v_exp_f32 v22, v22
  s_waitcnt lgkmcnt(2)
  v_mfma_f32_16x16x32_bf16 v[16:19], v[28:31], v[148:151], v[16:19]
  v_exp_f32 v23, v23
  s_waitcnt lgkmcnt(1)
  v_mfma_f32_16x16x32_bf16 v[16:19], v[32:35], v[152:155], v[16:19]
  v_add_f32 v13, v13, v20
  v_add_f32 v13, v13, v21
  s_waitcnt lgkmcnt(0)
  v_mfma_f32_16x16x32_bf16 v[16:19], v[36:39], v[156:159], v[16:19]
  v_add_f32 v13, v13, v22
  v_add_f32 v13, v13, v23
  v_cvt_pk_bf16_f32 v92, v20, v21
  v_cvt_pk_bf16_f32 v93, v22, v23
  v_mfma_f32_16x16x32_bf16 v[20:23], v[48:51], v[160:163], 0
  ds_read_b64_tr_b16 v[40:41], v3 offset:4096
  ds_read_b64_tr_b16 v[42:43], v3 offset:6144
  v_mfma_f32_16x16x32_bf16 v[20:23], v[52:55], v[164:167], v[20:23]
  ds_read_b64_tr_b16 v[44:45], v3 offset:0
  ds_read_b64_tr_b16 v[46:47], v3 offset:2048
  v_mfma_f32_16x16x32_bf16 v[20:23], v[56:59], v[168:171], v[20:23]
  v_exp_f32 v16, v16
  v_mfma_f32_16x16x32_bf16 v[20:23], v[60:63], v[172:175], v[20:23]
  v_exp_f32 v17, v17
  v_mfma_f32_16x16x32_bf16 v[20:23], v[24:27], v[176:179], v[20:23]
  v_exp_f32 v18, v18
  v_mfma_f32_16x16x32_bf16 v[20:23], v[28:31], v[180:183], v[20:23]
  v_exp_f32 v19, v19
  v_mfma_f32_16x16x32_bf16 v[20:23], v[32:35], v[184:187], v[20:23]
  v_add_f32 v10, v10, v16
  v_add_f32 v10, v10, v17
  v_mfma_f32_16x16x32_bf16 v[20:23], v[36:39], v[188:191], v[20:23]
  v_add_f32 v10, v10, v18
  v_add_f32 v10, v10, v19
  v_cvt_pk_bf16_f32 v82, v16, v17
  v_cvt_pk_bf16_f32 v83, v18, v19
  v_mfma_f32_16x16x32_bf16 v[16:19], v[48:51], v[192:195], 0
  v_mfma_f32_16x16x32_bf16 v[16:19], v[52:55], v[196:199], v[16:19]
  v_mfma_f32_16x16x32_bf16 v[16:19], v[56:59], v[200:203], v[16:19]
  s_nop 0
  v_exp_f32 v20, v20
  v_mfma_f32_16x16x32_bf16 v[16:19], v[60:63], v[204:207], v[16:19]
  v_exp_f32 v21, v21
  v_mfma_f32_16x16x32_bf16 v[16:19], v[24:27], v[208:211], v[16:19]
  v_exp_f32 v22, v22
  v_mfma_f32_16x16x32_bf16 v[16:19], v[28:31], v[212:215], v[16:19]
  v_exp_f32 v23, v23
  v_mfma_f32_16x16x32_bf16 v[16:19], v[32:35], v[216:219], v[16:19]
  v_add_f32 v11, v11, v20
  v_add_f32 v11, v11, v21
  v_mfma_f32_16x16x32_bf16 v[16:19], v[36:39], v[220:223], v[16:19]
  v_add_f32 v11, v11, v22
  v_add_f32 v11, v11, v23
  v_cvt_pk_bf16_f32 v86, v20, v21
  v_cvt_pk_bf16_f32 v87, v22, v23
  v_mfma_f32_16x16x32_bf16 v[20:23], v[48:51], v[224:227], 0
  ds_read_b64_tr_b16 v[48:49], v4 offset:4096
  ds_read_b64_tr_b16 v[50:51], v4 offset:6144
  v_mfma_f32_16x16x32_bf16 v[20:23], v[52:55], v[228:231], v[20:23]
  ds_read_b64_tr_b16 v[52:53], v4 offset:0
  ds_read_b64_tr_b16 v[54:55], v4 offset:2048
  v_mfma_f32_16x16x32_bf16 v[20:23], v[56:59], v[232:235], v[20:23]
  v_exp_f32 v16, v16
  v_mfma_f32_16x16x32_bf16 v[20:23], v[60:63], v[236:239], v[20:23]
  v_exp_f32 v17, v17
  v_mfma_f32_16x16x32_bf16 v[20:23], v[24:27], v[240:243], v[20:23]
  v_exp_f32 v18, v18
  v_mfma_f32_16x16x32_bf16 v[20:23], v[28:31], v[244:247], v[20:23]
  v_exp_f32 v19, v19
  v_mfma_f32_16x16x32_bf16 v[20:23], v[32:35], v[248:251], v[20:23]
  v_add_f32 v12, v12, v16
  v_add_f32 v12, v12, v17
  v_mfma_f32_16x16x32_bf16 v[20:23], v[36:39], v[252:255], v[20:23]
  v_add_f32 v12, v12, v18
  v_add_f32 v12, v12, v19
  v_cvt_pk_bf16_f32 v90, v16, v17
  v_cvt_pk_bf16_f32 v91, v18, v19
  ds_read_b64_tr_b16 v[56:57], v5 offset:4096
  ds_read_b64_tr_b16 v[58:59], v5 offset:6144
  ds_read_b64_tr_b16 v[60:61], v5 offset:0
  ds_read_b64_tr_b16 v[62:63], v5 offset:2048
  s_waitcnt lgkmcnt(10)
  v_mfma_f32_16x16x32_bf16 a[0:3], v[40:43], v[64:67], a[0:3]
  v_mbcnt_lo_u32_b32 v129, -1, 0
  v_mbcnt_hi_u32_b32 v129, -1, v129
  v_and_b32 v130, 15, v129
  v_bfe_u32 v131, v129, 4, 1
  v_lshl_add_u32 v130, v131, 5, v130
  v_bfe_u32 v131, v129, 5, 1
  s_waitcnt lgkmcnt(8)
  v_mfma_f32_16x16x32_bf16 a[0:3], v[44:47], v[80:83], a[0:3]
  v_exp_f32 v20, v20
  v_exp_f32 v21, v21
  v_exp_f32 v22, v22
  v_mfma_f32_16x16x32_bf16 a[64:67], v[40:43], v[68:71], a[64:67]
  v_exp_f32 v23, v23
  v_add_f32 v13, v13, v20
  v_add_f32 v13, v13, v21
  v_add_f32 v13, v13, v22
  v_add_f32 v13, v13, v23
  v_mfma_f32_16x16x32_bf16 a[64:67], v[44:47], v[84:87], a[64:67]
  v_cvt_pk_bf16_f32 v94, v20, v21
  v_cvt_pk_bf16_f32 v95, v22, v23
  v_lshl_add_u32 v130, v131, 4, v130
  v_lshlrev_b32 v128, 4, v130
  v_mov_b32 v132, 0
  v_mov_b32 v133, 0
  v_mfma_f32_16x16x32_bf16 a[128:131], v[40:43], v[72:75], a[128:131]
  v_mov_b32 v134, 0
  v_mov_b32 v135, 0
  v_mov_b32 v136, 0
  v_mov_b32 v137, 0
  v_mov_b32 v138, 0
  v_mov_b32 v139, 0
  v_mfma_f32_16x16x32_bf16 a[128:131], v[44:47], v[88:91], a[128:131]
  s_mov_b32 s3, 0x4e800000
  s_mov_b32 s4, 0x30800000
  v_mfma_f32_16x16x32_bf16 a[192:195], v[40:43], v[76:79], a[192:195]
  v_mfma_f32_16x16x32_bf16 a[192:195], v[44:47], v[92:95], a[192:195]
  ds_read_b64_tr_b16 v[24:25], v6 offset:4096
  ds_read_b64_tr_b16 v[26:27], v6 offset:6144
  ds_read_b64_tr_b16 v[28:29], v6 offset:0
  ds_read_b64_tr_b16 v[30:31], v6 offset:2048
  s_waitcnt lgkmcnt(10)
  v_mfma_f32_16x16x32_bf16 a[4:7], v[48:51], v[64:67], a[4:7]
  s_barrier
  v_mov_b32 v140, v10
  v_mov_b32 v141, v11
  v_mov_b32 v142, v12
  v_mov_b32 v143, v13
  v_mov_b32 v144, v14
  s_waitcnt lgkmcnt(8)
  v_mfma_f32_16x16x32_bf16 a[4:7], v[52:55], v[80:83], a[4:7]
  v_permlane32_swap_b32 v10, v140
  v_permlane32_swap_b32 v11, v141
  v_permlane32_swap_b32 v12, v142
  v_permlane32_swap_b32 v13, v143
  v_permlane32_swap_b32 v14, v144
  v_add_f32 v10, v10, v140
  v_mfma_f32_16x16x32_bf16 a[68:71], v[48:51], v[68:71], a[68:71]
  s_and_b32 s7, s2, 7
  s_lshl_b32 s7, s7, 5
  s_lshr_b32 s6, s2, 3
  s_add_u32 s7, s7, s6
  s_mul_i32 s6, s7, 9363
  s_lshr_b32 s29, s6, 16
  s_mul_i32 s5, s29, 7
  s_sub_u32 s30, s7, s5
  s_cmp_ge_u32 s29, 18
  s_cselect_b32 s31, 1, 0
  s_mul_i32 s5, s31, 18
  s_sub_u32 s32, s29, s5
  s_and_b32 s33, s2, 1
  s_lshl_b32 s33, s33, 4
  s_cmp_eq_u32 s31, 0
  s_cselect_b32 s6, s66, s68
  s_cselect_b32 s5, s67, s69
  s_lshl_b32 s7, s30, 7
  s_add_u32 s12, s6, s7
  s_addc_u32 s13, s5, 0
  s_sub_u32 s14, 3670016, s7
  s_mov_b32 s15, 0x20000
  s_mul_i32 s36, s33, 114688
  s_mul_i32 s37, s28, 28672
  s_lshl_b32 s38, s28, 12
  v_add_f32 v11, v11, v141
  v_add_f32 v12, v12, v142
  v_add_f32 v13, v13, v143
  v_add_f32 v14, v14, v144
  v_mfma_f32_16x16x32_bf16 a[68:71], v[52:55], v[84:87], a[68:71]
  v_mbcnt_lo_u32_b32 v250, -1, 0
  v_mbcnt_hi_u32_b32 v250, -1, v250
  v_mov_b32 v140, v10
  v_mov_b32 v141, v11
  v_mov_b32 v142, v12
  v_mov_b32 v143, v13
  v_mfma_f32_16x16x32_bf16 a[132:135], v[48:51], v[72:75], a[132:135]
  ds_read_b128 v[16:19], v9 offset:9216
  ds_read_b128 v[20:23], v9 offset:8192
  v_lshrrev_b32 v251, 3, v250
  v_and_b32 v250, 7, v250
  v_mov_b32 v144, v14
  v_permlane16_swap_b32 v10, v140
  v_mfma_f32_16x16x32_bf16 a[132:135], v[52:55], v[88:91], a[132:135]
  v_and_b32 v252, 2, v251
  v_xor_b32 v252, v252, v250
  v_permlane16_swap_b32 v11, v141
  v_permlane16_swap_b32 v12, v142
  v_permlane16_swap_b32 v13, v143
  v_permlane16_swap_b32 v14, v144
  v_mfma_f32_16x16x32_bf16 a[196:199], v[48:51], v[76:79], a[196:199]
  v_lshlrev_b32 v252, 4, v252
  v_mul_u32_u24 v251, 896, v251
  v_add_f32 v10, v10, v140
  v_add_f32 v11, v11, v141
  v_add_f32 v12, v12, v142
  v_add_f32 v13, v13, v143
  v_mfma_f32_16x16x32_bf16 a[196:199], v[52:55], v[92:95], a[196:199]
  ds_read_b64_tr_b16 v[32:33], v3 offset:12288
  ds_read_b64_tr_b16 v[34:35], v3 offset:14336
  ds_read_b64_tr_b16 v[36:37], v3 offset:8192
  ds_read_b64_tr_b16 v[38:39], v3 offset:10240
  v_add_u32 v251, s37, v251
  v_add_u32 v248, v251, v252
  s_waitcnt lgkmcnt(12)
  v_mfma_f32_16x16x32_bf16 a[8:11], v[56:59], v[64:67], a[8:11]
  v_xor_b32 v252, 64, v252
  v_add_u32 v249, v251, v252
  v_add_f32 v14, v14, v144
  ds_write_b32 v9, v14 offset:10244
  v_cmp_nge_f32 vcc, s3, v10
  s_nop 0
  s_waitcnt lgkmcnt(11)
  v_mfma_f32_16x16x32_bf16 a[8:11], v[60:63], v[80:83], a[8:11]
  s_add_u32 m0, s38, 0
  s_add_u32 s39, s36, 0
  buffer_load_dwordx4 v248, s[12:15], s39 offen lds
  s_add_u32 m0, s38, 1024
  s_add_u32 s39, s36, 7168
  buffer_load_dwordx4 v249, s[12:15], s39 offen lds
  s_mov_b64 s[52:53], vcc
  v_cmp_nle_f32 vcc, s4, v10
  s_nop 0
  s_or_b64 s[52:53], s[52:53], vcc
  v_mfma_f32_16x16x32_bf16 a[72:75], v[56:59], v[68:71], a[72:75]
  s_add_u32 m0, s38, 2048
  s_add_u32 s39, s36, 14336
  buffer_load_dwordx4 v248, s[12:15], s39 offen lds
  s_add_u32 m0, s38, 3072
  s_add_u32 s39, s36, 21504
  buffer_load_dwordx4 v249, s[12:15], s39 offen lds
  s_add_u32 s36, s36, 114688
  s_cmp_eq_u32 s36, 3670016
  s_cselect_b32 s36, 0, s36
  s_add_u32 s38, s38, 16384
  s_and_b32 s38, s38, 131071
  v_rcp_f32 v10, v10
  v_cmp_nge_f32 vcc, s3, v11
  s_nop 0
  s_or_b64 s[52:53], s[52:53], vcc
  v_mfma_f32_16x16x32_bf16 a[72:75], v[60:63], v[84:87], a[72:75]
  s_add_u32 m0, s38, 0
  s_add_u32 s39, s36, 0
  buffer_load_dwordx4 v248, s[12:15], s39 offen lds
  s_add_u32 m0, s38, 1024
  s_add_u32 s39, s36, 7168
  buffer_load_dwordx4 v249, s[12:15], s39 offen lds
  v_cmp_nle_f32 vcc, s4, v11
  s_nop 0
  s_or_b64 s[52:53], s[52:53], vcc
  v_rcp_f32 v11, v11
  v_mfma_f32_16x16x32_bf16 a[136:139], v[56:59], v[72:75], a[136:139]
  s_add_u32 m0, s38, 2048
  s_add_u32 s39, s36, 14336
  buffer_load_dwordx4 v248, s[12:15], s39 offen lds
  s_add_u32 m0, s38, 3072
  s_add_u32 s39, s36, 21504
  buffer_load_dwordx4 v249, s[12:15], s39 offen lds
  s_add_u32 s36, s36, 114688
  s_cmp_eq_u32 s36, 3670016
  s_cselect_b32 s36, 0, s36
  s_add_u32 s38, s38, 16384
  s_and_b32 s38, s38, 131071
  v_cmp_nge_f32 vcc, s3, v12
  s_nop 0
  s_or_b64 s[52:53], s[52:53], vcc
  v_cmp_nle_f32 vcc, s4, v12
  v_mfma_f32_16x16x32_bf16 a[136:139], v[60:63], v[88:91], a[136:139]
  s_add_u32 m0, s38, 0
  s_add_u32 s39, s36, 0
  buffer_load_dwordx4 v248, s[12:15], s39 offen lds
  s_add_u32 m0, s38, 1024
  s_add_u32 s39, s36, 7168
  buffer_load_dwordx4 v249, s[12:15], s39 offen lds
  s_nop 0
  s_or_b64 s[52:53], s[52:53], vcc
  v_rcp_f32 v12, v12
  v_cmp_nge_f32 vcc, s3, v13
  v_mfma_f32_16x16x32_bf16 a[200:203], v[56:59], v[76:79], a[200:203]
  s_add_u32 m0, s38, 2048
  s_add_u32 s39, s36, 14336
  buffer_load_dwordx4 v248, s[12:15], s39 offen lds
  s_add_u32 m0, s38, 3072
  s_add_u32 s39, s36, 21504
  buffer_load_dwordx4 v249, s[12:15], s39 offen lds
  s_add_u32 s36, s36, 114688
  s_cmp_eq_u32 s36, 3670016
  s_cselect_b32 s36, 0, s36
  s_add_u32 s38, s38, 16384
  s_and_b32 s38, s38, 131071
  s_nop 0
  s_or_b64 s[52:53], s[52:53], vcc
  v_cmp_nle_f32 vcc, s4, v13
  s_nop 0
  v_mfma_f32_16x16x32_bf16 a[200:203], v[60:63], v[92:95], a[200:203]
  ds_read_b64_tr_b16 v[48:49], v4 offset:12288
  ds_read_b64_tr_b16 v[50:51], v4 offset:14336
  ds_read_b64_tr_b16 v[52:53], v4 offset:8192
  ds_read_b64_tr_b16 v[54:55], v4 offset:10240
  s_add_u32 m0, s38, 0
  s_add_u32 s39, s36, 0
  buffer_load_dwordx4 v248, s[12:15], s39 offen lds
  s_add_u32 m0, s38, 1024
  s_add_u32 s39, s36, 7168
  buffer_load_dwordx4 v249, s[12:15], s39 offen lds
  s_waitcnt lgkmcnt(13)
  v_mfma_f32_16x16x32_bf16 a[12:15], v[24:27], v[64:67], a[12:15]
  s_add_u32 m0, s38, 2048
  s_add_u32 s39, s36, 14336
  buffer_load_dwordx4 v248, s[12:15], s39 offen lds
  s_add_u32 m0, s38, 3072
  s_add_u32 s39, s36, 21504
  buffer_load_dwordx4 v249, s[12:15], s39 offen lds
  s_add_u32 s36, s36, 114688
  s_cmp_eq_u32 s36, 3670016
  s_cselect_b32 s36, 0, s36
  s_add_u32 s38, s38, 16384
  s_and_b32 s38, s38, 131071
  s_or_b64 s[52:53], s[52:53], vcc
  v_rcp_f32 v13, v13
  v_accvgpr_read_b32 v192, a0
  v_accvgpr_read_b32 v193, a1
  s_waitcnt lgkmcnt(11)
  v_mfma_f32_16x16x32_bf16 a[12:15], v[28:31], v[80:83], a[12:15]
  v_accvgpr_read_b32 v194, a2
  v_accvgpr_read_b32 v195, a3
  v_mul_f32 v192, v10, v192
  v_mul_f32 v193, v10, v193
  v_mul_f32 v194, v10, v194
  v_mul_f32 v195, v10, v195
  v_mfma_f32_16x16x32_bf16 a[76:79], v[24:27], v[68:71], a[76:79]
  v_cvt_pk_bf16_f32 v160, v192, v193
  v_cvt_pk_bf16_f32 v161, v194, v195
  v_accvgpr_read_b32 v196, a4
  v_accvgpr_read_b32 v197, a5
  v_accvgpr_read_b32 v198, a6
  v_accvgpr_read_b32 v199, a7
  v_mfma_f32_16x16x32_bf16 a[76:79], v[28:31], v[84:87], a[76:79]
  v_mul_f32 v196, v10, v196
  v_mul_f32 v197, v10, v197
  v_mul_f32 v198, v10, v198
  v_mul_f32 v199, v10, v199
  v_cvt_pk_bf16_f32 v162, v196, v197
  v_cvt_pk_bf16_f32 v163, v198, v199
  v_mfma_f32_16x16x32_bf16 a[140:143], v[24:27], v[72:75], a[140:143]
  v_accvgpr_read_b32 v200, a64
  v_accvgpr_read_b32 v201, a65
  v_permlane16_swap_b32 v160, v162
  v_permlane16_swap_b32 v161, v163
  v_accvgpr_read_b32 v202, a66
  v_accvgpr_read_b32 v203, a67
  v_mfma_f32_16x16x32_bf16 a[140:143], v[28:31], v[88:91], a[140:143]
  v_mul_f32 v200, v11, v200
  s_add_u32 s34, s41, 0
  buffer_store_dwordx4 v[160:163], v128, s[24:27], s34 offen offset:0 sc1
  v_mfma_f32_16x16x32_bf16 v[136:139], v[132:135], v[160:163], v[136:139]
  v_mul_f32 v201, v11, v201
  v_mul_f32 v202, v11, v202
  v_mul_f32 v203, v11, v203
  v_mfma_f32_16x16x32_bf16 a[204:207], v[24:27], v[76:79], a[204:207]
  v_cvt_pk_bf16_f32 v164, v200, v201
  v_cvt_pk_bf16_f32 v165, v202, v203
  v_accvgpr_read_b32 v204, a68
  v_accvgpr_read_b32 v205, a69
  v_accvgpr_read_b32 v206, a70
  v_accvgpr_read_b32 v207, a71
  v_mfma_f32_16x16x32_bf16 a[204:207], v[28:31], v[92:95], a[204:207]
  ds_read_b64_tr_b16 v[56:57], v5 offset:12288
  ds_read_b64_tr_b16 v[58:59], v5 offset:14336
  ds_read_b64_tr_b16 v[60:61], v5 offset:8192
  ds_read_b64_tr_b16 v[62:63], v5 offset:10240
  v_mul_f32 v204, v11, v204
  v_mul_f32 v205, v11, v205
  s_waitcnt lgkmcnt(11)
  v_mfma_f32_16x16x32_bf16 a[16:19], v[32:35], v[64:67], a[16:19]
  v_mul_f32 v206, v11, v206
  v_mul_f32 v207, v11, v207
  v_cvt_pk_bf16_f32 v166, v204, v205
  v_cvt_pk_bf16_f32 v167, v206, v207
  v_accvgpr_read_b32 v208, a128
  v_accvgpr_read_b32 v209, a129
  s_waitcnt lgkmcnt(9)
  v_mfma_f32_16x16x32_bf16 a[16:19], v[36:39], v[80:83], a[16:19]
  v_permlane16_swap_b32 v164, v166
  v_permlane16_swap_b32 v165, v167
  v_accvgpr_read_b32 v210, a130
  v_accvgpr_read_b32 v211, a131
  v_mul_f32 v208, v12, v208
  s_add_u32 s34, s42, 0
  buffer_store_dwordx4 v[164:167], v128, s[24:27], s34 offen offset:0 sc1
  v_mfma_f32_16x16x32_bf16 a[80:83], v[32:35], v[68:71], a[80:83]
  v_mfma_f32_16x16x32_bf16 v[136:139], v[132:135], v[164:167], v[136:139]
  v_mul_f32 v209, v12, v209
  v_mul_f32 v210, v12, v210
  v_mul_f32 v211, v12, v211
  v_cvt_pk_bf16_f32 v168, v208, v209
  v_cvt_pk_bf16_f32 v169, v210, v211
  v_mfma_f32_16x16x32_bf16 a[80:83], v[36:39], v[84:87], a[80:83]
  v_accvgpr_read_b32 v212, a132
  v_accvgpr_read_b32 v213, a133
  v_accvgpr_read_b32 v214, a134
  v_accvgpr_read_b32 v215, a135
  v_mul_f32 v212, v12, v212
  v_mul_f32 v213, v12, v213
  v_mfma_f32_16x16x32_bf16 a[144:147], v[32:35], v[72:75], a[144:147]
  v_mul_f32 v214, v12, v214
  v_mul_f32 v215, v12, v215
  v_cvt_pk_bf16_f32 v170, v212, v213
  v_cvt_pk_bf16_f32 v171, v214, v215
  v_accvgpr_read_b32 v216, a192
  v_accvgpr_read_b32 v217, a193
  v_mfma_f32_16x16x32_bf16 a[144:147], v[36:39], v[88:91], a[144:147]
  v_permlane16_swap_b32 v168, v170
  v_permlane16_swap_b32 v169, v171
  v_accvgpr_read_b32 v218, a194
  v_accvgpr_read_b32 v219, a195
  v_mul_f32 v216, v13, v216
  s_add_u32 s34, s43, 0
  buffer_store_dwordx4 v[168:171], v128, s[24:27], s34 offen offset:0 sc1
  v_mfma_f32_16x16x32_bf16 a[208:211], v[32:35], v[76:79], a[208:211]
  v_mfma_f32_16x16x32_bf16 v[136:139], v[132:135], v[168:171], v[136:139]
  v_mul_f32 v217, v13, v217
  v_mul_f32 v218, v13, v218
  v_mul_f32 v219, v13, v219
  v_cvt_pk_bf16_f32 v172, v216, v217
  v_cvt_pk_bf16_f32 v173, v218, v219
  v_mfma_f32_16x16x32_bf16 a[208:211], v[36:39], v[92:95], a[208:211]
  ds_read_b64_tr_b16 v[40:41], v6 offset:12288
  ds_read_b64_tr_b16 v[42:43], v6 offset:14336
  ds_read_b64_tr_b16 v[44:45], v6 offset:8192
  ds_read_b64_tr_b16 v[46:47], v6 offset:10240
  v_accvgpr_read_b32 v220, a196
  v_accvgpr_read_b32 v221, a197
  s_waitcnt lgkmcnt(10)
  v_mfma_f32_16x16x32_bf16 a[20:23], v[48:51], v[64:67], a[20:23]
  v_accvgpr_read_b32 v222, a198
  v_accvgpr_read_b32 v223, a199
  v_mul_f32 v220, v13, v220
  v_mul_f32 v221, v13, v221
  v_mul_f32 v222, v13, v222
  v_mul_f32 v223, v13, v223
  s_waitcnt lgkmcnt(8)
  v_mfma_f32_16x16x32_bf16 a[20:23], v[52:55], v[80:83], a[20:23]
  v_cvt_pk_bf16_f32 v174, v220, v221
  v_cvt_pk_bf16_f32 v175, v222, v223
  v_accvgpr_read_b32 v192, a8
  v_accvgpr_read_b32 v193, a9
  v_permlane16_swap_b32 v172, v174
  v_permlane16_swap_b32 v173, v175
  v_mfma_f32_16x16x32_bf16 a[84:87], v[48:51], v[68:71], a[84:87]
  v_accvgpr_read_b32 v194, a10
  v_accvgpr_read_b32 v195, a11
  v_mul_f32 v192, v10, v192
  s_add_u32 s34, s44, 0
  buffer_store_dwordx4 v[172:175], v128, s[24:27], s34 offen offset:0 sc1
  v_mfma_f32_16x16x32_bf16 v[136:139], v[132:135], v[172:175], v[136:139]
  v_mul_f32 v193, v10, v193
  v_mfma_f32_16x16x32_bf16 a[84:87], v[52:55], v[84:87], a[84:87]
  v_mul_f32 v194, v10, v194
  v_mul_f32 v195, v10, v195
  v_cvt_pk_bf16_f32 v176, v192, v193
  v_cvt_pk_bf16_f32 v177, v194, v195
  v_accvgpr_read_b32 v196, a12
  v_accvgpr_read_b32 v197, a13
  v_mfma_f32_16x16x32_bf16 a[148:151], v[48:51], v[72:75], a[148:151]
  v_accvgpr_read_b32 v198, a14
  v_accvgpr_read_b32 v199, a15
  v_mul_f32 v196, v10, v196
  v_mul_f32 v197, v10, v197
  v_mul_f32 v198, v10, v198
  v_mul_f32 v199, v10, v199
  v_mfma_f32_16x16x32_bf16 a[148:151], v[52:55], v[88:91], a[148:151]
  v_cvt_pk_bf16_f32 v178, v196, v197
  v_cvt_pk_bf16_f32 v179, v198, v199
  v_accvgpr_read_b32 v200, a72
  v_accvgpr_read_b32 v201, a73
  v_permlane16_swap_b32 v176, v178
  v_permlane16_swap_b32 v177, v179
  v_mfma_f32_16x16x32_bf16 a[212:215], v[48:51], v[76:79], a[212:215]
  v_accvgpr_read_b32 v202, a74
  v_accvgpr_read_b32 v203, a75
  v_mul_f32 v200, v11, v200
  s_add_u32 s34, s41, 0
  buffer_store_dwordx4 v[176:179], v128, s[24:27], s34 offen offset:1024 sc1
  v_mfma_f32_16x16x32_bf16 v[136:139], v[132:135], v[176:179], v[136:139]
  v_mul_f32 v201, v11, v201
  v_mfma_f32_16x16x32_bf16 a[212:215], v[52:55], v[92:95], a[212:215]
  ds_read_b64_tr_b16 v[24:25], v3 offset:20480
  ds_read_b64_tr_b16 v[26:27], v3 offset:22528
  ds_read_b64_tr_b16 v[28:29], v3 offset:16384
  ds_read_b64_tr_b16 v[30:31], v3 offset:18432
  v_mul_f32 v202, v11, v202
  v_mul_f32 v203, v11, v203
  s_waitcnt lgkmcnt(10)
  v_mfma_f32_16x16x32_bf16 a[24:27], v[56:59], v[64:67], a[24:27]
  v_cvt_pk_bf16_f32 v180, v200, v201
  v_cvt_pk_bf16_f32 v181, v202, v203
  v_accvgpr_read_b32 v204, a76
  v_accvgpr_read_b32 v205, a77
  v_accvgpr_read_b32 v206, a78
  v_accvgpr_read_b32 v207, a79
  s_waitcnt lgkmcnt(8)
  v_mfma_f32_16x16x32_bf16 a[24:27], v[60:63], v[80:83], a[24:27]
  v_mul_f32 v204, v11, v204
  v_mul_f32 v205, v11, v205
  v_mul_f32 v206, v11, v206
  v_mul_f32 v207, v11, v207
  v_cvt_pk_bf16_f32 v182, v204, v205
  v_cvt_pk_bf16_f32 v183, v206, v207
  v_mfma_f32_16x16x32_bf16 a[88:91], v[56:59], v[68:71], a[88:91]
  v_accvgpr_read_b32 v208, a136
  v_accvgpr_read_b32 v209, a137
  v_permlane16_swap_b32 v180, v182
  v_permlane16_swap_b32 v181, v183
  v_accvgpr_read_b32 v210, a138
  v_accvgpr_read_b32 v211, a139
  v_mfma_f32_16x16x32_bf16 a[88:91], v[60:63], v[84:87], a[88:91]
  v_mul_f32 v208, v12, v208
  s_add_u32 s34, s42, 0
  buffer_store_dwordx4 v[180:183], v128, s[24:27], s34 offen offset:1024 sc1
  v_mfma_f32_16x16x32_bf16 v[136:139], v[132:135], v[180:183], v[136:139]
  v_mul_f32 v209, v12, v209
  v_mul_f32 v210, v12, v210
  v_mul_f32 v211, v12, v211
  v_mfma_f32_16x16x32_bf16 a[152:155], v[56:59], v[72:75], a[152:155]
  v_cvt_pk_bf16_f32 v184, v208, v209
  v_cvt_pk_bf16_f32 v185, v210, v211
  v_accvgpr_read_b32 v212, a140
  v_accvgpr_read_b32 v213, a141
  v_accvgpr_read_b32 v214, a142
  v_accvgpr_read_b32 v215, a143
  v_mfma_f32_16x16x32_bf16 a[152:155], v[60:63], v[88:91], a[152:155]
  v_mul_f32 v212, v12, v212
  v_mul_f32 v213, v12, v213
  v_mul_f32 v214, v12, v214
  v_mul_f32 v215, v12, v215
  v_cvt_pk_bf16_f32 v186, v212, v213
  v_cvt_pk_bf16_f32 v187, v214, v215
  v_mfma_f32_16x16x32_bf16 a[216:219], v[56:59], v[76:79], a[216:219]
  v_accvgpr_read_b32 v216, a200
  v_accvgpr_read_b32 v217, a201
  v_permlane16_swap_b32 v184, v186
  v_permlane16_swap_b32 v185, v187
  v_accvgpr_read_b32 v218, a202
  v_accvgpr_read_b32 v219, a203
  v_mfma_f32_16x16x32_bf16 a[216:219], v[60:63], v[92:95], a[216:219]
  ds_read_b64_tr_b16 v[48:49], v4 offset:20480
  ds_read_b64_tr_b16 v[50:51], v4 offset:22528
  ds_read_b64_tr_b16 v[52:53], v4 offset:16384
  ds_read_b64_tr_b16 v[54:55], v4 offset:18432
  v_mul_f32 v216, v13, v216
  s_add_u32 s34, s43, 0
  buffer_store_dwordx4 v[184:187], v128, s[24:27], s34 offen offset:1024 sc1
  s_waitcnt lgkmcnt(10)
  v_mfma_f32_16x16x32_bf16 a[28:31], v[40:43], v[64:67], a[28:31]
  v_mfma_f32_16x16x32_bf16 v[136:139], v[132:135], v[184:187], v[136:139]
  v_mul_f32 v217, v13, v217
  v_mul_f32 v218, v13, v218
  v_mul_f32 v219, v13, v219
  v_cvt_pk_bf16_f32 v188, v216, v217
  v_cvt_pk_bf16_f32 v189, v218, v219
  s_waitcnt lgkmcnt(8)
  v_mfma_f32_16x16x32_bf16 a[28:31], v[44:47], v[80:83], a[28:31]
  v_accvgpr_read_b32 v220, a204
  v_accvgpr_read_b32 v221, a205
  v_accvgpr_read_b32 v222, a206
  v_accvgpr_read_b32 v223, a207
  v_mul_f32 v220, v13, v220
  v_mul_f32 v221, v13, v221
  v_mfma_f32_16x16x32_bf16 a[92:95], v[40:43], v[68:71], a[92:95]
  v_mul_f32 v222, v13, v222
  v_mul_f32 v223, v13, v223
  v_cvt_pk_bf16_f32 v190, v220, v221
  v_cvt_pk_bf16_f32 v191, v222, v223
  v_accvgpr_read_b32 v192, a16
  v_accvgpr_read_b32 v193, a17
  v_mfma_f32_16x16x32_bf16 a[92:95], v[44:47], v[84:87], a[92:95]
  v_permlane16_swap_b32 v188, v190
  v_permlane16_swap_b32 v189, v191
  v_accvgpr_read_b32 v194, a18
  v_accvgpr_read_b32 v195, a19
  v_mul_f32 v192, v10, v192
  s_add_u32 s34, s44, 0
  buffer_store_dwordx4 v[188:191], v128, s[24:27], s34 offen offset:1024 sc1
  v_mfma_f32_16x16x32_bf16 a[156:159], v[40:43], v[72:75], a[156:159]
  v_mfma_f32_16x16x32_bf16 v[136:139], v[132:135], v[188:191], v[136:139]
  v_mul_f32 v193, v10, v193
  v_mul_f32 v194, v10, v194
  v_mul_f32 v195, v10, v195
  v_cvt_pk_bf16_f32 v160, v192, v193
  v_cvt_pk_bf16_f32 v161, v194, v195
  v_mfma_f32_16x16x32_bf16 a[156:159], v[44:47], v[88:91], a[156:159]
  v_accvgpr_read_b32 v196, a20
  v_accvgpr_read_b32 v197, a21
  v_accvgpr_read_b32 v198, a22
  v_accvgpr_read_b32 v199, a23
  v_mul_f32 v196, v10, v196
  v_mul_f32 v197, v10, v197
  v_mfma_f32_16x16x32_bf16 a[220:223], v[40:43], v[76:79], a[220:223]
  v_mul_f32 v198, v10, v198
  v_mul_f32 v199, v10, v199
  v_cvt_pk_bf16_f32 v162, v196, v197
  v_cvt_pk_bf16_f32 v163, v198, v199
  v_accvgpr_read_b32 v200, a80
  v_accvgpr_read_b32 v201, a81
  v_mfma_f32_16x16x32_bf16 a[220:223], v[44:47], v[92:95], a[220:223]
  ds_read_b64_tr_b16 v[56:57], v5 offset:20480
  ds_read_b64_tr_b16 v[58:59], v5 offset:22528
  ds_read_b64_tr_b16 v[60:61], v5 offset:16384
  ds_read_b64_tr_b16 v[62:63], v5 offset:18432
  v_permlane16_swap_b32 v160, v162
  v_permlane16_swap_b32 v161, v163
  s_waitcnt lgkmcnt(10)
  v_mfma_f32_16x16x32_bf16 a[32:35], v[24:27], v[64:67], a[32:35]
  v_accvgpr_read_b32 v202, a82
  v_accvgpr_read_b32 v203, a83
  v_mul_f32 v200, v11, v200
  s_add_u32 s34, s41, 0
  buffer_store_dwordx4 v[160:163], v128, s[24:27], s34 offen offset:2048 sc1
  v_mfma_f32_16x16x32_bf16 v[136:139], v[132:135], v[160:163], v[136:139]
  v_mul_f32 v201, v11, v201
  s_waitcnt lgkmcnt(8)
  v_mfma_f32_16x16x32_bf16 a[32:35], v[28:31], v[80:83], a[32:35]
  v_mul_f32 v202, v11, v202
  v_mul_f32 v203, v11, v203
  v_cvt_pk_bf16_f32 v164, v200, v201
  v_cvt_pk_bf16_f32 v165, v202, v203
  v_accvgpr_read_b32 v204, a84
  v_accvgpr_read_b32 v205, a85
  v_mfma_f32_16x16x32_bf16 a[96:99], v[24:27], v[68:71], a[96:99]
  v_accvgpr_read_b32 v206, a86
  v_accvgpr_read_b32 v207, a87
  v_mul_f32 v204, v11, v204
  v_mul_f32 v205, v11, v205
  v_mul_f32 v206, v11, v206
  v_mul_f32 v207, v11, v207
  v_mfma_f32_16x16x32_bf16 a[96:99], v[28:31], v[84:87], a[96:99]
  v_cvt_pk_bf16_f32 v166, v204, v205
  v_cvt_pk_bf16_f32 v167, v206, v207
  v_accvgpr_read_b32 v208, a144
  v_accvgpr_read_b32 v209, a145
  v_permlane16_swap_b32 v164, v166
  v_permlane16_swap_b32 v165, v167
  v_mfma_f32_16x16x32_bf16 a[160:163], v[24:27], v[72:75], a[160:163]
  v_accvgpr_read_b32 v210, a146
  v_accvgpr_read_b32 v211, a147
  v_mul_f32 v208, v12, v208
  s_add_u32 s34, s42, 0
  buffer_store_dwordx4 v[164:167], v128, s[24:27], s34 offen offset:2048 sc1
  v_mfma_f32_16x16x32_bf16 v[136:139], v[132:135], v[164:167], v[136:139]
  v_mul_f32 v209, v12, v209
  v_mfma_f32_16x16x32_bf16 a[160:163], v[28:31], v[88:91], a[160:163]
  v_mul_f32 v210, v12, v210
  v_mul_f32 v211, v12, v211
  v_cvt_pk_bf16_f32 v168, v208, v209
  v_cvt_pk_bf16_f32 v169, v210, v211
  v_accvgpr_read_b32 v212, a148
  v_accvgpr_read_b32 v213, a149
  v_mfma_f32_16x16x32_bf16 a[224:227], v[24:27], v[76:79], a[224:227]
  v_accvgpr_read_b32 v214, a150
  v_accvgpr_read_b32 v215, a151
  v_mul_f32 v212, v12, v212
  v_mul_f32 v213, v12, v213
  v_mul_f32 v214, v12, v214
  v_mul_f32 v215, v12, v215
  v_mfma_f32_16x16x32_bf16 a[224:227], v[28:31], v[92:95], a[224:227]
  v_cvt_pk_bf16_f32 v170, v212, v213
  v_cvt_pk_bf16_f32 v171, v214, v215
  v_accvgpr_read_b32 v216, a208
  v_accvgpr_read_b32 v217, a209
  v_permlane16_swap_b32 v168, v170
  v_permlane16_swap_b32 v169, v171
  v_mfma_f32_16x16x32_bf16 v[96:99], v[24:27], v[16:19], v[96:99]
  v_accvgpr_read_b32 v218, a210
  v_accvgpr_read_b32 v219, a211
  v_mul_f32 v216, v13, v216
  s_add_u32 s34, s43, 0
  buffer_store_dwordx4 v[168:171], v128, s[24:27], s34 offen offset:2048 sc1
  v_mfma_f32_16x16x32_bf16 v[136:139], v[132:135], v[168:171], v[136:139]
  v_mul_f32 v217, v13, v217
  v_mfma_f32_16x16x32_bf16 v[96:99], v[28:31], v[20:23], v[96:99]
  ds_read_b64_tr_b16 v[32:33], v6 offset:20480
  ds_read_b64_tr_b16 v[34:35], v6 offset:22528
  ds_read_b64_tr_b16 v[36:37], v6 offset:16384
  ds_read_b64_tr_b16 v[38:39], v6 offset:18432
  v_mul_f32 v218, v13, v218
  v_mul_f32 v219, v13, v219
  s_waitcnt lgkmcnt(10)
  v_mfma_f32_16x16x32_bf16 a[36:39], v[48:51], v[64:67], a[36:39]
  v_cvt_pk_bf16_f32 v172, v216, v217
  v_cvt_pk_bf16_f32 v173, v218, v219
  v_accvgpr_read_b32 v220, a212
  v_accvgpr_read_b32 v221, a213
  v_accvgpr_read_b32 v222, a214
  v_accvgpr_read_b32 v223, a215
  s_waitcnt lgkmcnt(8)
  v_mfma_f32_16x16x32_bf16 a[36:39], v[52:55], v[80:83], a[36:39]
  v_mul_f32 v220, v13, v220
  v_mul_f32 v221, v13, v221
  v_mul_f32 v222, v13, v222
  v_mul_f32 v223, v13, v223
  v_cvt_pk_bf16_f32 v174, v220, v221
  v_cvt_pk_bf16_f32 v175, v222, v223
  v_mfma_f32_16x16x32_bf16 a[100:103], v[48:51], v[68:71], a[100:103]
  v_accvgpr_read_b32 v192, a24
  v_accvgpr_read_b32 v193, a25
  v_permlane16_swap_b32 v172, v174
  v_permlane16_swap_b32 v173, v175
  v_accvgpr_read_b32 v194, a26
  v_accvgpr_read_b32 v195, a27
  v_mfma_f32_16x16x32_bf16 a[100:103], v[52:55], v[84:87], a[100:103]
  v_mul_f32 v192, v10, v192
  s_add_u32 s34, s44, 0
  buffer_store_dwordx4 v[172:175], v128, s[24:27], s34 offen offset:2048 sc1
  v_mfma_f32_16x16x32_bf16 v[136:139], v[132:135], v[172:175], v[136:139]
  v_mul_f32 v193, v10, v193
  v_mul_f32 v194, v10, v194
  v_mul_f32 v195, v10, v195
  v_mfma_f32_16x16x32_bf16 a[164:167], v[48:51], v[72:75], a[164:167]
  v_cvt_pk_bf16_f32 v176, v192, v193
  v_cvt_pk_bf16_f32 v177, v194, v195
  v_accvgpr_read_b32 v196, a28
  v_accvgpr_read_b32 v197, a29
  v_accvgpr_read_b32 v198, a30
  v_accvgpr_read_b32 v199, a31
  v_mfma_f32_16x16x32_bf16 a[164:167], v[52:55], v[88:91], a[164:167]
  v_mul_f32 v196, v10, v196
  v_mul_f32 v197, v10, v197
  v_mul_f32 v198, v10, v198
  v_mul_f32 v199, v10, v199
  v_cvt_pk_bf16_f32 v178, v196, v197
  v_cvt_pk_bf16_f32 v179, v198, v199
  v_mfma_f32_16x16x32_bf16 a[228:231], v[48:51], v[76:79], a[228:231]
  v_accvgpr_read_b32 v200, a88
  v_accvgpr_read_b32 v201, a89
  v_permlane16_swap_b32 v176, v178
  v_permlane16_swap_b32 v177, v179
  v_accvgpr_read_b32 v202, a90
  v_accvgpr_read_b32 v203, a91
  v_mfma_f32_16x16x32_bf16 a[228:231], v[52:55], v[92:95], a[228:231]
  v_mul_f32 v200, v11, v200
  s_add_u32 s34, s41, 0
  buffer_store_dwordx4 v[176:179], v128, s[24:27], s34 offen offset:3072 sc1
  v_mfma_f32_16x16x32_bf16 v[136:139], v[132:135], v[176:179], v[136:139]
  v_mul_f32 v201, v11, v201
  v_mul_f32 v202, v11, v202
  v_mul_f32 v203, v11, v203
  v_mfma_f32_16x16x32_bf16 v[100:103], v[48:51], v[16:19], v[100:103]
  v_cvt_pk_bf16_f32 v180, v200, v201
  v_cvt_pk_bf16_f32 v181, v202, v203
  v_accvgpr_read_b32 v204, a92
  v_accvgpr_read_b32 v205, a93
  v_accvgpr_read_b32 v206, a94
  v_accvgpr_read_b32 v207, a95
  v_mfma_f32_16x16x32_bf16 v[100:103], v[52:55], v[20:23], v[100:103]
  ds_read_b64_tr_b16 v[40:41], v3 offset:28672
  ds_read_b64_tr_b16 v[42:43], v3 offset:30720
  ds_read_b64_tr_b16 v[44:45], v3 offset:24576
  ds_read_b64_tr_b16 v[46:47], v3 offset:26624
  v_mul_f32 v204, v11, v204
  v_mul_f32 v205, v11, v205
  s_waitcnt lgkmcnt(10)
  v_mfma_f32_16x16x32_bf16 a[40:43], v[56:59], v[64:67], a[40:43]
  v_mul_f32 v206, v11, v206
  v_mul_f32 v207, v11, v207
  v_cvt_pk_bf16_f32 v182, v204, v205
  v_cvt_pk_bf16_f32 v183, v206, v207
  v_accvgpr_read_b32 v208, a152
  v_accvgpr_read_b32 v209, a153
  s_waitcnt lgkmcnt(8)
  v_mfma_f32_16x16x32_bf16 a[40:43], v[60:63], v[80:83], a[40:43]
  v_permlane16_swap_b32 v180, v182
  v_permlane16_swap_b32 v181, v183
  v_accvgpr_read_b32 v210, a154
  v_accvgpr_read_b32 v211, a155
  v_mul_f32 v208, v12, v208
  s_add_u32 s34, s42, 0
  buffer_store_dwordx4 v[180:183], v128, s[24:27], s34 offen offset:3072 sc1
  v_mfma_f32_16x16x32_bf16 a[104:107], v[56:59], v[68:71], a[104:107]
  v_mfma_f32_16x16x32_bf16 v[136:139], v[132:135], v[180:183], v[136:139]
  v_mul_f32 v209, v12, v209
  v_mul_f32 v210, v12, v210
  v_mul_f32 v211, v12, v211
  v_cvt_pk_bf16_f32 v184, v208, v209
  v_cvt_pk_bf16_f32 v185, v210, v211
  v_mfma_f32_16x16x32_bf16 a[104:107], v[60:63], v[84:87], a[104:107]
  v_accvgpr_read_b32 v212, a156
  v_accvgpr_read_b32 v213, a157
  v_accvgpr_read_b32 v214, a158
  v_accvgpr_read_b32 v215, a159
  v_mul_f32 v212, v12, v212
  v_mul_f32 v213, v12, v213
  v_mfma_f32_16x16x32_bf16 a[168:171], v[56:59], v[72:75], a[168:171]
  v_mul_f32 v214, v12, v214
  v_mul_f32 v215, v12, v215
  v_cvt_pk_bf16_f32 v186, v212, v213
  v_cvt_pk_bf16_f32 v187, v214, v215
  v_accvgpr_read_b32 v216, a216
  v_accvgpr_read_b32 v217, a217
  v_mfma_f32_16x16x32_bf16 a[168:171], v[60:63], v[88:91], a[168:171]
  v_permlane16_swap_b32 v184, v186
  v_permlane16_swap_b32 v185, v187
  v_accvgpr_read_b32 v218, a218
  v_accvgpr_read_b32 v219, a219
  v_mul_f32 v216, v13, v216
  s_add_u32 s34, s43, 0
  buffer_store_dwordx4 v[184:187], v128, s[24:27], s34 offen offset:3072 sc1
  v_mfma_f32_16x16x32_bf16 a[232:235], v[56:59], v[76:79], a[232:235]
  v_mfma_f32_16x16x32_bf16 v[136:139], v[132:135], v[184:187], v[136:139]
  v_mul_f32 v217, v13, v217
  v_mul_f32 v218, v13, v218
  v_mul_f32 v219, v13, v219
  v_cvt_pk_bf16_f32 v188, v216, v217
  v_cvt_pk_bf16_f32 v189, v218, v219
  v_mfma_f32_16x16x32_bf16 a[232:235], v[60:63], v[92:95], a[232:235]
  v_accvgpr_read_b32 v220, a220
  v_accvgpr_read_b32 v221, a221
  v_accvgpr_read_b32 v222, a222
  v_accvgpr_read_b32 v223, a223
  v_mul_f32 v220, v13, v220
  v_mul_f32 v221, v13, v221
  v_mfma_f32_16x16x32_bf16 v[104:107], v[56:59], v[16:19], v[104:107]
  v_mul_f32 v222, v13, v222
  v_mul_f32 v223, v13, v223
  v_cvt_pk_bf16_f32 v190, v220, v221
  v_cvt_pk_bf16_f32 v191, v222, v223
  v_accvgpr_read_b32 v192, a32
  v_accvgpr_read_b32 v193, a33
  v_mfma_f32_16x16x32_bf16 v[104:107], v[60:63], v[20:23], v[104:107]
  ds_read_b64_tr_b16 v[48:49], v4 offset:28672
  ds_read_b64_tr_b16 v[50:51], v4 offset:30720
  ds_read_b64_tr_b16 v[52:53], v4 offset:24576
  ds_read_b64_tr_b16 v[54:55], v4 offset:26624
  v_permlane16_swap_b32 v188, v190
  v_permlane16_swap_b32 v189, v191
  s_waitcnt lgkmcnt(10)
  v_mfma_f32_16x16x32_bf16 a[44:47], v[32:35], v[64:67], a[44:47]
  s_barrier
  v_accvgpr_read_b32 v194, a34
  v_accvgpr_read_b32 v195, a35
  v_mul_f32 v192, v10, v192
  s_add_u32 s34, s44, 0
  buffer_store_dwordx4 v[188:191], v128, s[24:27], s34 offen offset:3072 sc1
  v_mfma_f32_16x16x32_bf16 v[136:139], v[132:135], v[188:191], v[136:139]
  s_waitcnt lgkmcnt(8)
  v_mfma_f32_16x16x32_bf16 a[44:47], v[36:39], v[80:83], a[44:47]
  v_mul_f32 v193, v10, v193
  v_mul_f32 v194, v10, v194
  v_mul_f32 v195, v10, v195
  v_cvt_pk_bf16_f32 v160, v192, v193
  v_cvt_pk_bf16_f32 v161, v194, v195
  v_accvgpr_read_b32 v196, a36
  v_mfma_f32_16x16x32_bf16 a[108:111], v[32:35], v[68:71], a[108:111]
  v_accvgpr_read_b32 v197, a37
  v_accvgpr_read_b32 v198, a38
  v_accvgpr_read_b32 v199, a39
  v_mul_f32 v196, v10, v196
  v_mul_f32 v197, v10, v197
  v_mul_f32 v198, v10, v198
  v_mfma_f32_16x16x32_bf16 a[108:111], v[36:39], v[84:87], a[108:111]
  v_mul_f32 v199, v10, v199
  v_cvt_pk_bf16_f32 v162, v196, v197
  v_cvt_pk_bf16_f32 v163, v198, v199
  v_accvgpr_read_b32 v200, a96
  v_accvgpr_read_b32 v201, a97
  v_permlane16_swap_b32 v160, v162
  v_mfma_f32_16x16x32_bf16 a[172:175], v[32:35], v[72:75], a[172:175]
  v_permlane16_swap_b32 v161, v163
  v_accvgpr_read_b32 v202, a98
  v_accvgpr_read_b32 v203, a99
  v_mul_f32 v200, v11, v200
  s_add_u32 s34, s41, 32768
  buffer_store_dwordx4 v[160:163], v128, s[24:27], s34 offen offset:0 sc1
  v_mfma_f32_16x16x32_bf16 v[136:139], v[132:135], v[160:163], v[136:139]
  v_mfma_f32_16x16x32_bf16 a[172:175], v[36:39], v[88:91], a[172:175]
  v_mul_f32 v201, v11, v201
  v_mul_f32 v202, v11, v202
  v_mul_f32 v203, v11, v203
  v_cvt_pk_bf16_f32 v164, v200, v201
  v_cvt_pk_bf16_f32 v165, v202, v203
  v_accvgpr_read_b32 v204, a100
  v_mfma_f32_16x16x32_bf16 a[236:239], v[32:35], v[76:79], a[236:239]
  v_accvgpr_read_b32 v205, a101
  v_accvgpr_read_b32 v206, a102
  v_accvgpr_read_b32 v207, a103
  v_mul_f32 v204, v11, v204
  v_mul_f32 v205, v11, v205
  v_mul_f32 v206, v11, v206
  v_mfma_f32_16x16x32_bf16 a[236:239], v[36:39], v[92:95], a[236:239]
  v_mul_f32 v207, v11, v207
  v_cvt_pk_bf16_f32 v166, v204, v205
  v_cvt_pk_bf16_f32 v167, v206, v207
  v_accvgpr_read_b32 v208, a160
  v_accvgpr_read_b32 v209, a161
  v_permlane16_swap_b32 v164, v166
  v_mfma_f32_16x16x32_bf16 v[108:111], v[32:35], v[16:19], v[108:111]
  v_permlane16_swap_b32 v165, v167
  v_accvgpr_read_b32 v210, a162
  v_accvgpr_read_b32 v211, a163
  v_mul_f32 v208, v12, v208
  s_add_u32 s34, s42, 32768
  buffer_store_dwordx4 v[164:167], v128, s[24:27], s34 offen offset:0 sc1
  v_mfma_f32_16x16x32_bf16 v[136:139], v[132:135], v[164:167], v[136:139]
  v_mfma_f32_16x16x32_bf16 v[108:111], v[36:39], v[20:23], v[108:111]
  ds_read_b64_tr_b16 v[56:57], v5 offset:28672
  ds_read_b64_tr_b16 v[58:59], v5 offset:30720
  ds_read_b64_tr_b16 v[60:61], v5 offset:24576
  ds_read_b64_tr_b16 v[62:63], v5 offset:26624
  v_mul_f32 v209, v12, v209
  v_mul_f32 v210, v12, v210
  s_waitcnt lgkmcnt(10)
  v_mfma_f32_16x16x32_bf16 a[48:51], v[40:43], v[64:67], a[48:51]
  v_mul_f32 v211, v12, v211
  v_cvt_pk_bf16_f32 v168, v208, v209
  v_cvt_pk_bf16_f32 v169, v210, v211
  v_accvgpr_read_b32 v212, a164
  v_accvgpr_read_b32 v213, a165
  v_accvgpr_read_b32 v214, a166
  s_waitcnt lgkmcnt(8)
  v_mfma_f32_16x16x32_bf16 a[48:51], v[44:47], v[80:83], a[48:51]
  v_accvgpr_read_b32 v215, a167
  v_mul_f32 v212, v12, v212
  v_mul_f32 v213, v12, v213
  v_mul_f32 v214, v12, v214
  v_mul_f32 v215, v12, v215
  v_cvt_pk_bf16_f32 v170, v212, v213
  v_mfma_f32_16x16x32_bf16 a[112:115], v[40:43], v[68:71], a[112:115]
  v_cvt_pk_bf16_f32 v171, v214, v215
  v_accvgpr_read_b32 v216, a224
  v_accvgpr_read_b32 v217, a225
  v_permlane16_swap_b32 v168, v170
  v_permlane16_swap_b32 v169, v171
  v_accvgpr_read_b32 v218, a226
  v_mfma_f32_16x16x32_bf16 a[112:115], v[44:47], v[84:87], a[112:115]
  v_accvgpr_read_b32 v219, a227
  v_mul_f32 v216, v13, v216
  s_add_u32 s34, s43, 32768
  buffer_store_dwordx4 v[168:171], v128, s[24:27], s34 offen offset:0 sc1
  v_mfma_f32_16x16x32_bf16 v[136:139], v[132:135], v[168:171], v[136:139]
  v_mul_f32 v217, v13, v217
  v_mul_f32 v218, v13, v218
  v_mfma_f32_16x16x32_bf16 a[176:179], v[40:43], v[72:75], a[176:179]
  v_mul_f32 v219, v13, v219
  v_cvt_pk_bf16_f32 v172, v216, v217
  v_cvt_pk_bf16_f32 v173, v218, v219
  v_accvgpr_read_b32 v220, a228
  v_accvgpr_read_b32 v221, a229
  v_accvgpr_read_b32 v222, a230
  v_mfma_f32_16x16x32_bf16 a[176:179], v[44:47], v[88:91], a[176:179]
  v_accvgpr_read_b32 v223, a231
  v_mul_f32 v220, v13, v220
  v_mul_f32 v221, v13, v221
  v_mul_f32 v222, v13, v222
  v_mul_f32 v223, v13, v223
  v_cvt_pk_bf16_f32 v174, v220, v221
  v_mfma_f32_16x16x32_bf16 a[240:243], v[40:43], v[76:79], a[240:243]
  v_cvt_pk_bf16_f32 v175, v222, v223
  v_accvgpr_read_b32 v192, a40
  v_accvgpr_read_b32 v193, a41
  v_permlane16_swap_b32 v172, v174
  v_permlane16_swap_b32 v173, v175
  v_accvgpr_read_b32 v194, a42
  v_mfma_f32_16x16x32_bf16 a[240:243], v[44:47], v[92:95], a[240:243]
  v_accvgpr_read_b32 v195, a43
  v_mul_f32 v192, v10, v192
  s_add_u32 s34, s44, 32768
  buffer_store_dwordx4 v[172:175], v128, s[24:27], s34 offen offset:0 sc1
  v_mfma_f32_16x16x32_bf16 v[136:139], v[132:135], v[172:175], v[136:139]
  v_mul_f32 v193, v10, v193
  v_mul_f32 v194, v10, v194
  v_mfma_f32_16x16x32_bf16 v[112:115], v[40:43], v[16:19], v[112:115]
  v_mul_f32 v195, v10, v195
  v_cvt_pk_bf16_f32 v176, v192, v193
  v_cvt_pk_bf16_f32 v177, v194, v195
  v_accvgpr_read_b32 v196, a44
  v_accvgpr_read_b32 v197, a45
  v_accvgpr_read_b32 v198, a46
  v_mfma_f32_16x16x32_bf16 v[112:115], v[44:47], v[20:23], v[112:115]
  ds_read_b64_tr_b16 v[24:25], v6 offset:28672
  ds_read_b64_tr_b16 v[26:27], v6 offset:30720
  ds_read_b64_tr_b16 v[28:29], v6 offset:24576
  ds_read_b64_tr_b16 v[30:31], v6 offset:26624
  v_accvgpr_read_b32 v199, a47
  v_mul_f32 v196, v10, v196
  s_waitcnt lgkmcnt(10)
  v_mfma_f32_16x16x32_bf16 a[52:55], v[48:51], v[64:67], a[52:55]
  v_mul_f32 v197, v10, v197
  v_mul_f32 v198, v10, v198
  v_mul_f32 v199, v10, v199
  v_cvt_pk_bf16_f32 v178, v196, v197
  v_cvt_pk_bf16_f32 v179, v198, v199
  v_accvgpr_read_b32 v200, a104
  s_waitcnt lgkmcnt(8)
  v_mfma_f32_16x16x32_bf16 a[52:55], v[52:55], v[80:83], a[52:55]
  v_accvgpr_read_b32 v201, a105
  v_permlane16_swap_b32 v176, v178
  v_permlane16_swap_b32 v177, v179
  v_accvgpr_read_b32 v202, a106
  v_accvgpr_read_b32 v203, a107
  v_mul_f32 v200, v11, v200
  v_mfma_f32_16x16x32_bf16 a[116:119], v[48:51], v[68:71], a[116:119]
  s_add_u32 s34, s41, 32768
  buffer_store_dwordx4 v[176:179], v128, s[24:27], s34 offen offset:1024 sc1
  v_mfma_f32_16x16x32_bf16 v[136:139], v[132:135], v[176:179], v[136:139]
  v_mul_f32 v201, v11, v201
  v_mul_f32 v202, v11, v202
  v_mul_f32 v203, v11, v203
  v_cvt_pk_bf16_f32 v180, v200, v201
  v_mfma_f32_16x16x32_bf16 a[116:119], v[52:55], v[84:87], a[116:119]
  v_cvt_pk_bf16_f32 v181, v202, v203
  v_accvgpr_read_b32 v204, a108
  v_accvgpr_read_b32 v205, a109
  v_accvgpr_read_b32 v206, a110
  v_accvgpr_read_b32 v207, a111
  v_mul_f32 v204, v11, v204
  v_mfma_f32_16x16x32_bf16 a[180:183], v[48:51], v[72:75], a[180:183]
  v_mul_f32 v205, v11, v205
  v_mul_f32 v206, v11, v206
  v_mul_f32 v207, v11, v207
  v_cvt_pk_bf16_f32 v182, v204, v205
  v_cvt_pk_bf16_f32 v183, v206, v207
  v_accvgpr_read_b32 v208, a168
  v_mfma_f32_16x16x32_bf16 a[180:183], v[52:55], v[88:91], a[180:183]
  v_accvgpr_read_b32 v209, a169
  v_permlane16_swap_b32 v180, v182
  v_permlane16_swap_b32 v181, v183
  v_accvgpr_read_b32 v210, a170
  v_accvgpr_read_b32 v211, a171
  v_mul_f32 v208, v12, v208
  v_mfma_f32_16x16x32_bf16 a[244:247], v[48:51], v[76:79], a[244:247]
  s_add_u32 s34, s42, 32768
  buffer_store_dwordx4 v[180:183], v128, s[24:27], s34 offen offset:1024 sc1
  v_mfma_f32_16x16x32_bf16 v[136:139], v[132:135], v[180:183], v[136:139]
  v_mul_f32 v209, v12, v209
  v_mul_f32 v210, v12, v210
  v_mul_f32 v211, v12, v211
  v_cvt_pk_bf16_f32 v184, v208, v209
  v_mfma_f32_16x16x32_bf16 a[244:247], v[52:55], v[92:95], a[244:247]
  v_cvt_pk_bf16_f32 v185, v210, v211
  v_accvgpr_read_b32 v212, a172
  v_accvgpr_read_b32 v213, a173
  v_accvgpr_read_b32 v214, a174
  v_accvgpr_read_b32 v215, a175
  v_mul_f32 v212, v12, v212
  v_mfma_f32_16x16x32_bf16 v[116:119], v[48:51], v[16:19], v[116:119]
  v_mul_f32 v213, v12, v213
  v_mul_f32 v214, v12, v214
  v_mul_f32 v215, v12, v215
  v_cvt_pk_bf16_f32 v186, v212, v213
  v_cvt_pk_bf16_f32 v187, v214, v215
  v_accvgpr_read_b32 v216, a232
  v_mfma_f32_16x16x32_bf16 v[116:119], v[52:55], v[20:23], v[116:119]
  v_accvgpr_read_b32 v217, a233
  v_permlane16_swap_b32 v184, v186
  v_permlane16_swap_b32 v185, v187
  v_accvgpr_read_b32 v218, a234
  v_accvgpr_read_b32 v219, a235
  v_mul_f32 v216, v13, v216
  s_waitcnt lgkmcnt(6)
  v_mfma_f32_16x16x32_bf16 a[56:59], v[56:59], v[64:67], a[56:59]
  s_add_u32 s34, s43, 32768
  buffer_store_dwordx4 v[184:187], v128, s[24:27], s34 offen offset:1024 sc1
  v_mfma_f32_16x16x32_bf16 v[136:139], v[132:135], v[184:187], v[136:139]
  v_mul_f32 v217, v13, v217
  v_mul_f32 v218, v13, v218
  v_mul_f32 v219, v13, v219
  v_cvt_pk_bf16_f32 v188, v216, v217
  s_waitcnt lgkmcnt(4)
  v_mfma_f32_16x16x32_bf16 a[56:59], v[60:63], v[80:83], a[56:59]
  v_cvt_pk_bf16_f32 v189, v218, v219
  v_accvgpr_read_b32 v220, a236
  v_accvgpr_read_b32 v221, a237
  v_accvgpr_read_b32 v222, a238
  v_accvgpr_read_b32 v223, a239
  v_mul_f32 v220, v13, v220
  v_mfma_f32_16x16x32_bf16 a[120:123], v[56:59], v[68:71], a[120:123]
  v_mul_f32 v221, v13, v221
  v_mul_f32 v222, v13, v222
  v_mul_f32 v223, v13, v223
  v_cvt_pk_bf16_f32 v190, v220, v221
  v_cvt_pk_bf16_f32 v191, v222, v223
  v_accvgpr_read_b32 v192, a48
  v_mfma_f32_16x16x32_bf16 a[120:123], v[60:63], v[84:87], a[120:123]
  v_accvgpr_read_b32 v193, a49
  v_permlane16_swap_b32 v188, v190
  v_permlane16_swap_b32 v189, v191
  v_accvgpr_read_b32 v194, a50
  v_accvgpr_read_b32 v195, a51
  v_mul_f32 v192, v10, v192
  v_mfma_f32_16x16x32_bf16 a[184:187], v[56:59], v[72:75], a[184:187]
  s_add_u32 s34, s44, 32768
  buffer_store_dwordx4 v[188:191], v128, s[24:27], s34 offen offset:1024 sc1
  v_mfma_f32_16x16x32_bf16 v[136:139], v[132:135], v[188:191], v[136:139]
  v_mul_f32 v193, v10, v193
  v_mul_f32 v194, v10, v194
  v_mul_f32 v195, v10, v195
  v_cvt_pk_bf16_f32 v160, v192, v193
  v_mfma_f32_16x16x32_bf16 a[184:187], v[60:63], v[88:91], a[184:187]
  v_cvt_pk_bf16_f32 v161, v194, v195
  v_accvgpr_read_b32 v196, a52
  v_accvgpr_read_b32 v197, a53
  v_accvgpr_read_b32 v198, a54
  v_accvgpr_read_b32 v199, a55
  v_mul_f32 v196, v10, v196
  v_mfma_f32_16x16x32_bf16 a[248:251], v[56:59], v[76:79], a[248:251]
  v_mul_f32 v197, v10, v197
  v_mul_f32 v198, v10, v198
  v_mul_f32 v199, v10, v199
  v_cvt_pk_bf16_f32 v162, v196, v197
  v_cvt_pk_bf16_f32 v163, v198, v199
  v_accvgpr_read_b32 v200, a112
  v_mfma_f32_16x16x32_bf16 a[248:251], v[60:63], v[92:95], a[248:251]
  v_accvgpr_read_b32 v201, a113
  v_permlane16_swap_b32 v160, v162
  v_permlane16_swap_b32 v161, v163
  v_accvgpr_read_b32 v202, a114
  v_accvgpr_read_b32 v203, a115
  v_mul_f32 v200, v11, v200
  v_mfma_f32_16x16x32_bf16 v[120:123], v[56:59], v[16:19], v[120:123]
  s_add_u32 s34, s41, 32768
  buffer_store_dwordx4 v[160:163], v128, s[24:27], s34 offen offset:2048 sc1
  v_mfma_f32_16x16x32_bf16 v[136:139], v[132:135], v[160:163], v[136:139]
  v_mul_f32 v201, v11, v201
  v_mul_f32 v202, v11, v202
  v_mul_f32 v203, v11, v203
  v_cvt_pk_bf16_f32 v164, v200, v201
  v_mfma_f32_16x16x32_bf16 v[120:123], v[60:63], v[20:23], v[120:123]
  v_cvt_pk_bf16_f32 v165, v202, v203
  v_accvgpr_read_b32 v204, a116
  v_accvgpr_read_b32 v205, a117
  v_accvgpr_read_b32 v206, a118
  v_accvgpr_read_b32 v207, a119
  v_mul_f32 v204, v11, v204
  s_waitcnt lgkmcnt(2)
  v_mfma_f32_16x16x32_bf16 a[60:63], v[24:27], v[64:67], a[60:63]
  v_mul_f32 v205, v11, v205
  v_mul_f32 v206, v11, v206
  v_mul_f32 v207, v11, v207
  v_cvt_pk_bf16_f32 v166, v204, v205
  v_cvt_pk_bf16_f32 v167, v206, v207
  v_accvgpr_read_b32 v208, a176
  s_waitcnt lgkmcnt(0)
  v_mfma_f32_16x16x32_bf16 a[60:63], v[28:31], v[80:83], a[60:63]
  v_accvgpr_read_b32 v209, a177
  v_permlane16_swap_b32 v164, v166
  v_permlane16_swap_b32 v165, v167
  v_accvgpr_read_b32 v210, a178
  v_accvgpr_read_b32 v211, a179
  v_mul_f32 v208, v12, v208
  v_mfma_f32_16x16x32_bf16 a[124:127], v[24:27], v[68:71], a[124:127]
  s_add_u32 s34, s42, 32768
  buffer_store_dwordx4 v[164:167], v128, s[24:27], s34 offen offset:2048 sc1
  v_mfma_f32_16x16x32_bf16 v[136:139], v[132:135], v[164:167], v[136:139]
  v_mul_f32 v209, v12, v209
  v_mul_f32 v210, v12, v210
  v_mul_f32 v211, v12, v211
  v_cvt_pk_bf16_f32 v168, v208, v209
  v_mfma_f32_16x16x32_bf16 a[124:127], v[28:31], v[84:87], a[124:127]
  v_cvt_pk_bf16_f32 v169, v210, v211
  v_accvgpr_read_b32 v212, a180
  v_accvgpr_read_b32 v213, a181
  v_accvgpr_read_b32 v214, a182
  v_accvgpr_read_b32 v215, a183
  v_mul_f32 v212, v12, v212
  v_mfma_f32_16x16x32_bf16 a[188:191], v[24:27], v[72:75], a[188:191]
  v_mul_f32 v213, v12, v213
  v_mul_f32 v214, v12, v214
  v_mul_f32 v215, v12, v215
  v_cvt_pk_bf16_f32 v170, v212, v213
  v_cvt_pk_bf16_f32 v171, v214, v215
  v_accvgpr_read_b32 v216, a240
  v_mfma_f32_16x16x32_bf16 a[188:191], v[28:31], v[88:91], a[188:191]
  v_accvgpr_read_b32 v217, a241
  v_permlane16_swap_b32 v168, v170
  v_permlane16_swap_b32 v169, v171
  v_accvgpr_read_b32 v218, a242
  v_accvgpr_read_b32 v219, a243
  v_mul_f32 v216, v13, v216
  v_mfma_f32_16x16x32_bf16 a[252:255], v[24:27], v[76:79], a[252:255]
  s_add_u32 s34, s43, 32768
  buffer_store_dwordx4 v[168:171], v128, s[24:27], s34 offen offset:2048 sc1
  v_mfma_f32_16x16x32_bf16 v[136:139], v[132:135], v[168:171], v[136:139]
  v_mul_f32 v217, v13, v217
  v_mul_f32 v218, v13, v218
  v_mul_f32 v219, v13, v219
  v_cvt_pk_bf16_f32 v172, v216, v217
  v_mfma_f32_16x16x32_bf16 a[252:255], v[28:31], v[92:95], a[252:255]
  v_cvt_pk_bf16_f32 v173, v218, v219
  v_accvgpr_read_b32 v220, a244
  v_accvgpr_read_b32 v221, a245
  v_accvgpr_read_b32 v222, a246
  v_accvgpr_read_b32 v223, a247
  v_mul_f32 v220, v13, v220
  v_mfma_f32_16x16x32_bf16 v[124:127], v[24:27], v[16:19], v[124:127]
  v_mul_f32 v221, v13, v221
  v_mul_f32 v222, v13, v222
  v_mul_f32 v223, v13, v223
  v_cvt_pk_bf16_f32 v174, v220, v221
  v_cvt_pk_bf16_f32 v175, v222, v223
  ds_read_b32 v140, v9 offset:10240
  v_mfma_f32_16x16x32_bf16 v[124:127], v[28:31], v[20:23], v[124:127]
  s_waitcnt lgkmcnt(0)
  v_add_f32 v14, v14, v140
  v_cmp_nge_f32 vcc, s3, v14
  s_nop 0
  s_or_b64 s[52:53], s[52:53], vcc
  v_cmp_nle_f32 vcc, s4, v14
  s_nop 0
  s_or_b64 s[52:53], s[52:53], vcc
  v_rcp_f32 v14, v14
  s_nop 0
  v_mul_f32 v192, v14, v96
  v_mul_f32 v193, v14, v97
  v_permlane16_swap_b32 v172, v174
  v_permlane16_swap_b32 v173, v175
  v_mul_f32 v194, v14, v98
  v_mul_f32 v195, v14, v99
  v_cvt_pk_bf16_f32 v176, v192, v193
  s_add_u32 s34, s44, 32768
  buffer_store_dwordx4 v[172:175], v128, s[24:27], s34 offen offset:2048 sc1
  v_mfma_f32_16x16x32_bf16 v[136:139], v[132:135], v[172:175], v[136:139]
  v_cvt_pk_bf16_f32 v177, v194, v195
  v_mul_f32 v196, v14, v100
  v_mul_f32 v197, v14, v101
  v_mul_f32 v198, v14, v102
  v_mul_f32 v199, v14, v103
  v_cvt_pk_bf16_f32 v178, v196, v197
  v_cvt_pk_bf16_f32 v179, v198, v199
  v_mul_f32 v200, v14, v104
  v_mul_f32 v201, v14, v105
  v_permlane16_swap_b32 v176, v178
  v_permlane16_swap_b32 v177, v179
  v_mul_f32 v202, v14, v106
  v_mul_f32 v203, v14, v107
  v_cvt_pk_bf16_f32 v180, v200, v201
  s_add_u32 s34, s45, 32768
  buffer_store_dwordx4 v[176:179], v128, s[24:27], s34 offen offset:0 sc1
  v_mfma_f32_16x16x32_bf16 v[136:139], v[132:135], v[176:179], v[136:139]
  v_cvt_pk_bf16_f32 v181, v202, v203
  v_mul_f32 v204, v14, v108
  v_mul_f32 v205, v14, v109
  v_mul_f32 v206, v14, v110
  v_mul_f32 v207, v14, v111
  v_cvt_pk_bf16_f32 v182, v204, v205
  v_cvt_pk_bf16_f32 v183, v206, v207
  v_mul_f32 v208, v14, v112
  v_mul_f32 v209, v14, v113
  v_permlane16_swap_b32 v180, v182
  v_permlane16_swap_b32 v181, v183
  v_mul_f32 v210, v14, v114
  v_mul_f32 v211, v14, v115
  v_cvt_pk_bf16_f32 v184, v208, v209
  s_add_u32 s34, s45, 32768
  buffer_store_dwordx4 v[180:183], v128, s[24:27], s34 offen offset:1024 sc1
  v_mfma_f32_16x16x32_bf16 v[136:139], v[132:135], v[180:183], v[136:139]
  v_cvt_pk_bf16_f32 v185, v210, v211
  v_mul_f32 v212, v14, v116
  v_mul_f32 v213, v14, v117
  v_mul_f32 v214, v14, v118
  v_mul_f32 v215, v14, v119
  v_cvt_pk_bf16_f32 v186, v212, v213
  v_cvt_pk_bf16_f32 v187, v214, v215
  v_accvgpr_read_b32 v216, a56
  v_accvgpr_read_b32 v217, a57
  v_permlane16_swap_b32 v184, v186
  v_permlane16_swap_b32 v185, v187
  v_accvgpr_read_b32 v218, a58
  v_accvgpr_read_b32 v219, a59
  v_mul_f32 v216, v10, v216
  s_add_u32 s34, s45, 32768
  buffer_store_dwordx4 v[184:187], v128, s[24:27], s34 offen offset:2048 sc1
  v_mfma_f32_16x16x32_bf16 v[136:139], v[132:135], v[184:187], v[136:139]
  v_mul_f32 v217, v10, v217
  v_mul_f32 v218, v10, v218
  v_mul_f32 v219, v10, v219
  v_cvt_pk_bf16_f32 v188, v216, v217
  v_cvt_pk_bf16_f32 v189, v218, v219
  v_accvgpr_read_b32 v220, a60
  v_accvgpr_read_b32 v221, a61
  v_accvgpr_read_b32 v222, a62
  v_accvgpr_read_b32 v223, a63
  v_mul_f32 v220, v10, v220
  v_mul_f32 v221, v10, v221
  v_mul_f32 v222, v10, v222
  v_mul_f32 v223, v10, v223
  v_cvt_pk_bf16_f32 v190, v220, v221
  v_cvt_pk_bf16_f32 v191, v222, v223
  v_accvgpr_read_b32 v192, a120
  v_accvgpr_read_b32 v193, a121
  v_permlane16_swap_b32 v188, v190
  v_permlane16_swap_b32 v189, v191
  v_accvgpr_read_b32 v194, a122
  v_accvgpr_read_b32 v195, a123
  v_mul_f32 v192, v11, v192
  s_add_u32 s34, s41, 32768
  buffer_store_dwordx4 v[188:191], v128, s[24:27], s34 offen offset:3072 sc1
  v_mfma_f32_16x16x32_bf16 v[136:139], v[132:135], v[188:191], v[136:139]
  v_mul_f32 v193, v11, v193
  v_mul_f32 v194, v11, v194
  v_mul_f32 v195, v11, v195
  v_cvt_pk_bf16_f32 v160, v192, v193
  v_cvt_pk_bf16_f32 v161, v194, v195
  v_accvgpr_read_b32 v196, a124
  v_accvgpr_read_b32 v197, a125
  v_accvgpr_read_b32 v198, a126
  v_accvgpr_read_b32 v199, a127
  v_mul_f32 v196, v11, v196
  v_mul_f32 v197, v11, v197
  v_mul_f32 v198, v11, v198
  v_mul_f32 v199, v11, v199
  v_cvt_pk_bf16_f32 v162, v196, v197
  v_cvt_pk_bf16_f32 v163, v198, v199
  v_accvgpr_read_b32 v200, a184
  v_accvgpr_read_b32 v201, a185
  v_permlane16_swap_b32 v160, v162
  v_permlane16_swap_b32 v161, v163
  v_accvgpr_read_b32 v202, a186
  v_accvgpr_read_b32 v203, a187
  v_mul_f32 v200, v12, v200
  s_add_u32 s34, s42, 32768
  buffer_store_dwordx4 v[160:163], v128, s[24:27], s34 offen offset:3072 sc1
  v_mfma_f32_16x16x32_bf16 v[136:139], v[132:135], v[160:163], v[136:139]
  v_mul_f32 v201, v12, v201
  v_mul_f32 v202, v12, v202
  v_mul_f32 v203, v12, v203
  v_cvt_pk_bf16_f32 v164, v200, v201
  v_cvt_pk_bf16_f32 v165, v202, v203
  v_accvgpr_read_b32 v204, a188
  v_accvgpr_read_b32 v205, a189
  v_accvgpr_read_b32 v206, a190
  v_accvgpr_read_b32 v207, a191
  v_mul_f32 v204, v12, v204
  v_mul_f32 v205, v12, v205
  v_mul_f32 v206, v12, v206
  v_mul_f32 v207, v12, v207
  v_cvt_pk_bf16_f32 v166, v204, v205
  v_cvt_pk_bf16_f32 v167, v206, v207
  v_accvgpr_read_b32 v208, a248
  v_accvgpr_read_b32 v209, a249
  v_permlane16_swap_b32 v164, v166
  v_permlane16_swap_b32 v165, v167
  v_accvgpr_read_b32 v210, a250
  v_accvgpr_read_b32 v211, a251
  v_mul_f32 v208, v13, v208
  s_add_u32 s34, s43, 32768
  buffer_store_dwordx4 v[164:167], v128, s[24:27], s34 offen offset:3072 sc1
  v_mfma_f32_16x16x32_bf16 v[136:139], v[132:135], v[164:167], v[136:139]
  v_mul_f32 v209, v13, v209
  v_mul_f32 v210, v13, v210
  v_mul_f32 v211, v13, v211
  v_cvt_pk_bf16_f32 v168, v208, v209
  v_cvt_pk_bf16_f32 v169, v210, v211
  v_accvgpr_read_b32 v212, a252
  v_accvgpr_read_b32 v213, a253
  v_accvgpr_read_b32 v214, a254
  v_accvgpr_read_b32 v215, a255
  v_mul_f32 v212, v13, v212
  v_mul_f32 v213, v13, v213
  v_mul_f32 v214, v13, v214
  v_mul_f32 v215, v13, v215
  v_cvt_pk_bf16_f32 v170, v212, v213
  v_cvt_pk_bf16_f32 v171, v214, v215
  v_mul_f32 v216, v14, v120
  v_mul_f32 v217, v14, v121
  v_permlane16_swap_b32 v168, v170
  v_permlane16_swap_b32 v169, v171
  v_mul_f32 v218, v14, v122
  v_mul_f32 v219, v14, v123
  v_cvt_pk_bf16_f32 v172, v216, v217
  s_add_u32 s34, s44, 32768
  buffer_store_dwordx4 v[168:171], v128, s[24:27], s34 offen offset:3072 sc1
  v_mfma_f32_16x16x32_bf16 v[136:139], v[132:135], v[168:171], v[136:139]
  v_cvt_pk_bf16_f32 v173, v218, v219
  v_mul_f32 v220, v14, v124
  v_mul_f32 v221, v14, v125
  v_mul_f32 v222, v14, v126
  v_mul_f32 v223, v14, v127
  v_cvt_pk_bf16_f32 v174, v220, v221
  v_cvt_pk_bf16_f32 v175, v222, v223
  s_nop 0
  v_permlane16_swap_b32 v172, v174
  v_permlane16_swap_b32 v173, v175
  s_add_u32 s34, s45, 32768
  buffer_store_dwordx4 v[172:175], v128, s[24:27], s34 offen offset:3072 sc1
  v_mfma_f32_16x16x32_bf16 v[136:139], v[132:135], v[172:175], v[136:139]
  s_nop 7
  v_cmp_u_f32 vcc, v136, v136
  s_nop 1
  s_or_b64 s[52:53], s[52:53], vcc
  s_cmp_lg_u64 s[52:53], 0
  s_cselect_b32 s3, 1, 0
  v_mov_b32 v15, s3
  s_lshl_b32 s4, s28, 2
  s_add_u32 s4, s4, 142336
  v_mov_b32 v16, s4
  ds_write_b32 v16, v15 offset:0
  s_waitcnt lgkmcnt(0)
  s_barrier
  v_mov_b32 v16, 142336
  ds_read_b128 v[20:23], v16 offset:0
  s_waitcnt lgkmcnt(0)
  v_or_b32 v20, v20, v21
  v_or3_b32 v20, v20, v22, v23
  s_nop 0
  v_readfirstlane_b32 s3, v20
  s_nop 1
  s_cmp_lg_u32 s3, 0
  s_cbranch_scc1 K1_REDO
K1_END:
  s_load_dwordx4 s[56:59], s[0:1], 80
  s_waitcnt vmcnt(0) lgkmcnt(0)
  s_barrier
  s_mov_b32 s60, s58
  s_mov_b32 s61, s59
  s_mov_b32 s62, 256
  s_mov_b32 s63, 0x20000
  v_mbcnt_lo_u32_b32 v16, -1, 0
  v_mbcnt_hi_u32_b32 v16, -1, v16
  v_and_b32 v17, 15, v16
  v_lshrrev_b32 v18, 4, v16
  v_bfe_u32 v19, v16, 2, 2
  v_and_b32 v20, 3, v16
  v_lshrrev_b32 v21, 3, v16
  v_and_b32 v22, 7, v16
  s_cmp_lg_u32 s28, 0
  s_cbranch_scc1 OP_NOSIG
  s_lshl_b32 s3, s47, 3
  s_add_u32 s3, s3, s48
  s_lshl_b32 s3, s3, 1
  s_lshr_b32 s4, s49, 3
  s_add_u32 s3, s3, s4
  s_lshl_b32 s3, s3, 2
  v_mov_b32 v1, 1
  v_mov_b32 v2, 0
  s_mov_b64 exec, 1
  s_nop 1
  buffer_atomic_add v1, v2, s[60:63], s3 offen sc1
  s_mov_b64 exec, -1
  s_nop 1
OP_NOSIG:
  s_cmp_lt_u32 s29, 36
  s_cbranch_scc1 OP_GO
  s_endpgm
OP_GO:
  s_add_u32 m0, s38, 0
  s_add_u32 s39, s36, 0
  buffer_load_dwordx4 v248, s[12:15], s39 offen lds
  s_add_u32 m0, s38, 1024
  s_add_u32 s39, s36, 7168
  buffer_load_dwordx4 v249, s[12:15], s39 offen lds
  s_add_u32 m0, s38, 2048
  s_add_u32 s39, s36, 14336
  buffer_load_dwordx4 v248, s[12:15], s39 offen lds
  s_add_u32 m0, s38, 3072
  s_add_u32 s39, s36, 21504
  buffer_load_dwordx4 v249, s[12:15], s39 offen lds
  s_add_u32 s36, s36, 114688
  s_cmp_eq_u32 s36, 3670016
  s_cselect_b32 s36, 0, s36
  s_add_u32 s38, s38, 16384
  s_and_b32 s38, s38, 131071
  s_add_u32 m0, s38, 0
  s_add_u32 s39, s36, 0
  buffer_load_dwordx4 v248, s[12:15], s39 offen lds
  s_add_u32 m0, s38, 1024
  s_add_u32 s39, s36, 7168
  buffer_load_dwordx4 v249, s[12:15], s39 offen lds
  s_add_u32 m0, s38, 2048
  s_add_u32 s39, s36, 14336
  buffer_load_dwordx4 v248, s[12:15], s39 offen lds
  s_add_u32 m0, s38, 3072
  s_add_u32 s39, s36, 21504
  buffer_load_dwordx4 v249, s[12:15], s39 offen lds
  s_add_u32 s36, s36, 114688
  s_cmp_eq_u32 s36, 3670016
  s_cselect_b32 s36, 0, s36
  s_add_u32 s38, s38, 16384
  s_and_b32 s38, s38, 131071
  s_add_u32 m0, s38, 0
  s_add_u32 s39, s36, 0
  buffer_load_dwordx4 v248, s[12:15], s39 offen lds
  s_add_u32 m0, s38, 1024
  s_add_u32 s39, s36, 7168
  buffer_load_dwordx4 v249, s[12:15], s39 offen lds
  s_add_u32 m0, s38, 2048
  s_add_u32 s39, s36, 14336
  buffer_load_dwordx4 v248, s[12:15], s39 offen lds
  s_add_u32 m0, s38, 3072
  s_add_u32 s39, s36, 21504
  buffer_load_dwordx4 v249, s[12:15], s39 offen lds
  s_add_u32 s36, s36, 114688
  s_cmp_eq_u32 s36, 3670016
  s_cselect_b32 s36, 0, s36
  s_add_u32 s38, s38, 16384
  s_and_b32 s38, s38, 131071
  s_lshl_b32 s3, s29, 20
  s_add_u32 s8, s64, s3
  s_addc_u32 s9, s65, 0
  s_mov_b32 s10, 0x100000
  s_mov_b32 s11, 0x20000
  s_lshl_b32 s34, s33, 15
  s_lshl_b32 s3, s28, 13
  v_lshlrev_b32 v2, 4, v16
  v_add_u32 v2, s3, v2
  v_add_u32 v3, 4096, v2
  v_lshrrev_b32 v23, 1, v19
  v_and_b32 v24, 1, v18
  v_lshlrev_b32 v24, 1, v24
  v_or_b32 v23, v23, v24
  v_lshlrev_b32 v24, 3, v18
  v_add_u32 v24, v24, v19
  v_lshlrev_b32 v24, 7, v24
  v_lshlrev_b32 v25, 3, v20
  v_add_u32 v24, v24, v25
  v_xor_b32 v25, 0, v23
  v_lshlrev_b32 v25, 5, v25
  v_add_u32 v8, v24, v25
  v_xor_b32 v25, 1, v23
  v_lshlrev_b32 v25, 5, v25
  v_add_u32 v9, v24, v25
  v_xor_b32 v25, 2, v23
  v_lshlrev_b32 v25, 5, v25
  v_add_u32 v10, v24, v25
  v_xor_b32 v25, 3, v23
  v_lshlrev_b32 v25, 5, v25
  v_add_u32 v11, v24, v25
  v_and_b32 v23, 1, v18
  v_lshlrev_b32 v23, 1, v23
  v_lshrrev_b32 v24, 1, v18
  v_or_b32 v23, v23, v24
  v_lshlrev_b32 v23, 4, v23
  v_mul_u32_u24 v24, 1792, v17
  v_add_u32 v12, v24, v23
  v_mov_b32 v32, 0
  v_mov_b32 v33, 0
  v_mov_b32 v34, 0
  v_mov_b32 v35, 0
  v_mov_b32 v36, 0
  v_mov_b32 v37, 0
  v_mov_b32 v38, 0
  v_mov_b32 v39, 0
  v_mov_b32 v40, 0
  v_mov_b32 v41, 0
  v_mov_b32 v42, 0
  v_mov_b32 v43, 0
  v_mov_b32 v44, 0
  v_mov_b32 v45, 0
  v_mov_b32 v46, 0
  v_mov_b32 v47, 0
  v_mov_b32 v48, 0
  v_mov_b32 v49, 0
  v_mov_b32 v50, 0
  v_mov_b32 v51, 0
  v_mov_b32 v52, 0
  v_mov_b32 v53, 0
  v_mov_b32 v54, 0
  v_mov_b32 v55, 0
  v_mov_b32 v56, 0
  v_mov_b32 v57, 0
  v_mov_b32 v58, 0
  v_mov_b32 v59, 0
  v_mov_b32 v60, 0
  v_mov_b32 v61, 0
  v_mov_b32 v62, 0
  v_mov_b32 v63, 0
  s_mov_b32 s16, s56
  s_mov_b32 s17, s57
  s_mov_b32 s18, 4128768
  s_mov_b32 s19, 0x20000
  s_lshl_b32 s3, s32, 2
  s_mul_i32 s4, s3, 7282
  s_lshr_b32 s4, s4, 16
  s_lshl_b32 s3, s32, 7
  s_add_u32 s3, s3, 127
  s_lshr_b32 s3, s3, 5
  s_mul_i32 s5, s3, 7282
  s_lshr_b32 s5, s5, 16
  s_lshl_b32 s3, s31, 3
  s_add_u32 s4, s4, s3
  s_add_u32 s5, s5, s3
  s_lshr_b32 s3, s33, 2
  s_lshl_b32 s40, s4, 3
  s_add_u32 s40, s40, s3
  s_lshl_b32 s41, s5, 3
  s_add_u32 s41, s41, s3
  v_mov_b32 v13, 0
  s_nop 1
  s_cmp_lg_u32 s28, 0
  s_cbranch_scc1 OP1_WAITED
  s_mov_b32 s6, 200000
  s_mov_b64 exec, 1
  s_nop 1
OP1_POLL:
  buffer_load_dword v14, v13, s[60:63], s40 offen sc1
  buffer_load_dword v15, v13, s[60:63], s41 offen sc1
  s_waitcnt vmcnt(0)
  v_min_u32 v14, v14, v15
  s_nop 1
  v_readfirstlane_b32 s3, v14
  s_nop 3
  s_cmp_ge_u32 s3, 8
  s_cbranch_scc1 OP1_POLLED
  s_sleep 4
  s_sub_u32 s6, s6, 1
  s_cmp_lg_u32 s6, 0
  s_cbranch_scc1 OP1_POLL
OP1_POLLED:
  s_mov_b64 exec, -1
  s_nop 4
OP1_WAITED:
  s_xor_b32 s40, s40, 4
  s_xor_b32 s41, s41, 4
  s_barrier
  buffer_load_dwordx4 a[0:3], v2, s[8:11], s34 offen offset:0 sc1
  buffer_load_dwordx4 a[4:7], v2, s[8:11], s34 offen offset:1024 sc1
  buffer_load_dwordx4 a[8:11], v2, s[8:11], s34 offen offset:2048 sc1
  buffer_load_dwordx4 a[12:15], v2, s[8:11], s34 offen offset:3072 sc1
  buffer_load_dwordx4 a[16:19], v3, s[8:11], s34 offen offset:0 sc1
  buffer_load_dwordx4 a[20:23], v3, s[8:11], s34 offen offset:1024 sc1
  buffer_load_dwordx4 a[24:27], v3, s[8:11], s34 offen offset:2048 sc1
  buffer_load_dwordx4 a[28:31], v3, s[8:11], s34 offen offset:3072 sc1
  s_add_u32 s34, s34, 32768
  s_and_b32 s34, s34, 0xfffff
  buffer_load_dwordx4 a[32:35], v2, s[8:11], s34 offen offset:0 sc1
  buffer_load_dwordx4 a[36:39], v2, s[8:11], s34 offen offset:1024 sc1
  buffer_load_dwordx4 a[40:43], v2, s[8:11], s34 offen offset:2048 sc1
  buffer_load_dwordx4 a[44:47], v2, s[8:11], s34 offen offset:3072 sc1
  buffer_load_dwordx4 a[48:51], v3, s[8:11], s34 offen offset:0 sc1
  buffer_load_dwordx4 a[52:55], v3, s[8:11], s34 offen offset:1024 sc1
  buffer_load_dwordx4 a[56:59], v3, s[8:11], s34 offen offset:2048 sc1
  buffer_load_dwordx4 a[60:63], v3, s[8:11], s34 offen offset:3072 sc1
  s_add_u32 s34, s34, 32768
  s_and_b32 s34, s34, 0xfffff
  buffer_load_dwordx4 a[64:67], v2, s[8:11], s34 offen offset:0 sc1
  buffer_load_dwordx4 a[68:71], v2, s[8:11], s34 offen offset:1024 sc1
  buffer_load_dwordx4 a[72:75], v2, s[8:11], s34 offen offset:2048 sc1
  buffer_load_dwordx4 a[76:79], v2, s[8:11], s34 offen offset:3072 sc1
  buffer_load_dwordx4 a[80:83], v3, s[8:11], s34 offen offset:0 sc1
  buffer_load_dwordx4 a[84:87], v3, s[8:11], s34 offen offset:1024 sc1
  buffer_load_dwordx4 a[88:91], v3, s[8:11], s34 offen offset:2048 sc1
  buffer_load_dwordx4 a[92:95], v3, s[8:11], s34 offen offset:3072 sc1
  s_add_u32 s34, s34, 32768
  s_and_b32 s34, s34, 0xfffff
  s_barrier
  ds_read_b64_tr_b16 v[64:65], v8 offset:0
  ds_read_b64_tr_b16 v[66:67], v8 offset:512
  ds_read_b64_tr_b16 v[68:69], v8 offset:4096
  ds_read_b64_tr_b16 v[70:71], v8 offset:4608
  ds_read_b64_tr_b16 v[72:73], v8 offset:8192
  ds_read_b64_tr_b16 v[74:75], v8 offset:8704
  ds_read_b64_tr_b16 v[76:77], v8 offset:12288
  ds_read_b64_tr_b16 v[78:79], v8 offset:12800
  s_waitcnt vmcnt(23) lgkmcnt(6)
  v_mfma_f32_16x16x32_bf16 v[32:35], v[64:67], a[0:3], v[32:35]
  ds_read_b64_tr_b16 v[80:81], v9 offset:0
  ds_read_b64_tr_b16 v[82:83], v9 offset:512
  s_waitcnt vmcnt(22) lgkmcnt(6)
  v_mfma_f32_16x16x32_bf16 v[32:35], v[68:71], a[4:7], v[32:35]
  ds_read_b64_tr_b16 v[84:85], v9 offset:4096
  ds_read_b64_tr_b16 v[86:87], v9 offset:4608
  s_waitcnt vmcnt(21) lgkmcnt(6)
  v_mfma_f32_16x16x32_bf16 v[32:35], v[72:75], a[8:11], v[32:35]
  ds_read_b64_tr_b16 v[88:89], v9 offset:8192
  ds_read_b64_tr_b16 v[90:91], v9 offset:8704
  s_waitcnt vmcnt(20) lgkmcnt(6)
  v_mfma_f32_16x16x32_bf16 v[32:35], v[76:79], a[12:15], v[32:35]
  ds_read_b64_tr_b16 v[92:93], v9 offset:12288
  ds_read_b64_tr_b16 v[94:95], v9 offset:12800
  s_waitcnt vmcnt(19)
  v_mfma_f32_16x16x32_bf16 v[36:39], v[64:67], a[16:19], v[36:39]
  ds_read_b64_tr_b16 v[64:65], v10 offset:0
  ds_read_b64_tr_b16 v[66:67], v10 offset:512
  s_waitcnt vmcnt(18)
  v_mfma_f32_16x16x32_bf16 v[36:39], v[68:71], a[20:23], v[36:39]
  ds_read_b64_tr_b16 v[68:69], v10 offset:4096
  ds_read_b64_tr_b16 v[70:71], v10 offset:4608
  s_waitcnt vmcnt(17)
  v_mfma_f32_16x16x32_bf16 v[36:39], v[72:75], a[24:27], v[36:39]
  ds_read_b64_tr_b16 v[72:73], v10 offset:8192
  ds_read_b64_tr_b16 v[74:75], v10 offset:8704
  s_waitcnt vmcnt(16)
  v_mfma_f32_16x16x32_bf16 v[36:39], v[76:79], a[28:31], v[36:39]
  ds_read_b64_tr_b16 v[76:77], v10 offset:12288
  ds_read_b64_tr_b16 v[78:79], v10 offset:12800
  s_waitcnt lgkmcnt(14)
  v_mfma_f32_16x16x32_bf16 v[40:43], v[80:83], a[0:3], v[40:43]
  buffer_load_dwordx4 a[96:99], v2, s[8:11], s34 offen offset:0 sc1
  buffer_load_dwordx4 a[100:103], v2, s[8:11], s34 offen offset:1024 sc1
  s_waitcnt lgkmcnt(12)
  v_mfma_f32_16x16x32_bf16 v[40:43], v[84:87], a[4:7], v[40:43]
  buffer_load_dwordx4 a[104:107], v2, s[8:11], s34 offen offset:2048 sc1
  buffer_load_dwordx4 a[108:111], v2, s[8:11], s34 offen offset:3072 sc1
  s_waitcnt lgkmcnt(10)
  v_mfma_f32_16x16x32_bf16 v[40:43], v[88:91], a[8:11], v[40:43]
  buffer_load_dwordx4 a[112:115], v3, s[8:11], s34 offen offset:0 sc1
  buffer_load_dwordx4 a[116:119], v3, s[8:11], s34 offen offset:1024 sc1
  s_waitcnt lgkmcnt(8)
  v_mfma_f32_16x16x32_bf16 v[40:43], v[92:95], a[12:15], v[40:43]
  v_mfma_f32_16x16x32_bf16 v[44:47], v[80:83], a[16:19], v[44:47]
  ds_read_b64_tr_b16 v[80:81], v11 offset:0
  ds_read_b64_tr_b16 v[82:83], v11 offset:512
  v_mfma_f32_16x16x32_bf16 v[44:47], v[84:87], a[20:23], v[44:47]
  ds_read_b64_tr_b16 v[84:85], v11 offset:4096
  ds_read_b64_tr_b16 v[86:87], v11 offset:4608
  v_mfma_f32_16x16x32_bf16 v[44:47], v[88:91], a[24:27], v[44:47]
  ds_read_b64_tr_b16 v[88:89], v11 offset:8192
  ds_read_b64_tr_b16 v[90:91], v11 offset:8704
  v_mfma_f32_16x16x32_bf16 v[44:47], v[92:95], a[28:31], v[44:47]
  ds_read_b64_tr_b16 v[92:93], v11 offset:12288
  ds_read_b64_tr_b16 v[94:95], v11 offset:12800
  s_waitcnt lgkmcnt(14)
  v_mfma_f32_16x16x32_bf16 v[48:51], v[64:67], a[0:3], v[48:51]
  buffer_load_dwordx4 a[120:123], v3, s[8:11], s34 offen offset:2048 sc1
  buffer_load_dwordx4 a[124:127], v3, s[8:11], s34 offen offset:3072 sc1
  s_waitcnt lgkmcnt(12)
  v_mfma_f32_16x16x32_bf16 v[48:51], v[68:71], a[4:7], v[48:51]
  s_add_u32 s34, s34, 32768
  s_and_b32 s34, s34, 0xfffff
  s_waitcnt lgkmcnt(10)
  v_mfma_f32_16x16x32_bf16 v[48:51], v[72:75], a[8:11], v[48:51]
  s_barrier
  s_waitcnt lgkmcnt(8)
  v_mfma_f32_16x16x32_bf16 v[48:51], v[76:79], a[12:15], v[48:51]
  v_mfma_f32_16x16x32_bf16 v[52:55], v[64:67], a[16:19], v[52:55]
  ds_read_b64_tr_b16 v[64:65], v8 offset:16384
  ds_read_b64_tr_b16 v[66:67], v8 offset:16896
  v_mfma_f32_16x16x32_bf16 v[52:55], v[68:71], a[20:23], v[52:55]
  s_add_u32 m0, s38, 0
  s_add_u32 s39, s36, 0
  buffer_load_dwordx4 v248, s[12:15], s39 offen lds
  v_mfma_f32_16x16x32_bf16 v[52:55], v[72:75], a[24:27], v[52:55]
  ds_read_b64_tr_b16 v[68:69], v8 offset:20480
  ds_read_b64_tr_b16 v[70:71], v8 offset:20992
  v_mfma_f32_16x16x32_bf16 v[52:55], v[76:79], a[28:31], v[52:55]
  ds_read_b64_tr_b16 v[72:73], v8 offset:24576
  ds_read_b64_tr_b16 v[74:75], v8 offset:25088
  s_waitcnt lgkmcnt(12)
  v_mfma_f32_16x16x32_bf16 v[56:59], v[80:83], a[0:3], v[56:59]
  s_add_u32 m0, s38, 1024
  s_add_u32 s39, s36, 7168
  buffer_load_dwordx4 v249, s[12:15], s39 offen lds
  s_waitcnt lgkmcnt(10)
  v_mfma_f32_16x16x32_bf16 v[56:59], v[84:87], a[4:7], v[56:59]
  ds_read_b64_tr_b16 v[76:77], v8 offset:28672
  ds_read_b64_tr_b16 v[78:79], v8 offset:29184
  s_waitcnt lgkmcnt(10)
  v_mfma_f32_16x16x32_bf16 v[56:59], v[88:91], a[8:11], v[56:59]
  s_waitcnt lgkmcnt(8)
  v_mfma_f32_16x16x32_bf16 v[56:59], v[92:95], a[12:15], v[56:59]
  s_add_u32 m0, s38, 2048
  s_add_u32 s39, s36, 14336
  buffer_load_dwordx4 v248, s[12:15], s39 offen lds
  v_mfma_f32_16x16x32_bf16 v[60:63], v[80:83], a[16:19], v[60:63]
  v_mfma_f32_16x16x32_bf16 v[60:63], v[84:87], a[20:23], v[60:63]
  v_mfma_f32_16x16x32_bf16 v[60:63], v[88:91], a[24:27], v[60:63]
  s_add_u32 m0, s38, 3072
  s_add_u32 s39, s36, 21504
  buffer_load_dwordx4 v249, s[12:15], s39 offen lds
  s_add_u32 s36, s36, 114688
  s_cmp_eq_u32 s36, 3670016
  s_cselect_b32 s36, 0, s36
  s_add_u32 s38, s38, 16384
  s_and_b32 s38, s38, 131071
  v_mfma_f32_16x16x32_bf16 v[60:63], v[92:95], a[28:31], v[60:63]
  s_waitcnt vmcnt(27) lgkmcnt(6)
  v_mfma_f32_16x16x32_bf16 v[32:35], v[64:67], a[32:35], v[32:35]
  ds_read_b64_tr_b16 v[80:81], v9 offset:16384
  ds_read_b64_tr_b16 v[82:83], v9 offset:16896
  s_waitcnt vmcnt(26) lgkmcnt(6)
  v_mfma_f32_16x16x32_bf16 v[32:35], v[68:71], a[36:39], v[32:35]
  ds_read_b64_tr_b16 v[84:85], v9 offset:20480
  ds_read_b64_tr_b16 v[86:87], v9 offset:20992
  s_waitcnt vmcnt(25) lgkmcnt(6)
  v_mfma_f32_16x16x32_bf16 v[32:35], v[72:75], a[40:43], v[32:35]
  ds_read_b64_tr_b16 v[88:89], v9 offset:24576
  ds_read_b64_tr_b16 v[90:91], v9 offset:25088
  s_waitcnt vmcnt(24) lgkmcnt(6)
  v_mfma_f32_16x16x32_bf16 v[32:35], v[76:79], a[44:47], v[32:35]
  ds_read_b64_tr_b16 v[92:93], v9 offset:28672
  ds_read_b64_tr_b16 v[94:95], v9 offset:29184
  s_waitcnt vmcnt(23)
  v_mfma_f32_16x16x32_bf16 v[36:39], v[64:67], a[48:51], v[36:39]
  ds_read_b64_tr_b16 v[64:65], v10 offset:16384
  ds_read_b64_tr_b16 v[66:67], v10 offset:16896
  s_waitcnt vmcnt(22)
  v_mfma_f32_16x16x32_bf16 v[36:39], v[68:71], a[52:55], v[36:39]
  ds_read_b64_tr_b16 v[68:69], v10 offset:20480
  ds_read_b64_tr_b16 v[70:71], v10 offset:20992
  s_waitcnt vmcnt(21)
  v_mfma_f32_16x16x32_bf16 v[36:39], v[72:75], a[56:59], v[36:39]
  ds_read_b64_tr_b16 v[72:73], v10 offset:24576
  ds_read_b64_tr_b16 v[74:75], v10 offset:25088
  s_waitcnt vmcnt(20)
  v_mfma_f32_16x16x32_bf16 v[36:39], v[76:79], a[60:63], v[36:39]
  ds_read_b64_tr_b16 v[76:77], v10 offset:28672
  ds_read_b64_tr_b16 v[78:79], v10 offset:29184
  s_waitcnt lgkmcnt(14)
  v_mfma_f32_16x16x32_bf16 v[40:43], v[80:83], a[32:35], v[40:43]
  buffer_load_dwordx4 a[128:131], v2, s[8:11], s34 offen offset:0 sc1
  buffer_load_dwordx4 a[132:135], v2, s[8:11], s34 offen offset:1024 sc1
  s_waitcnt lgkmcnt(12)
  v_mfma_f32_16x16x32_bf16 v[40:43], v[84:87], a[36:39], v[40:43]
  buffer_load_dwordx4 a[136:139], v2, s[8:11], s34 offen offset:2048 sc1
  buffer_load_dwordx4 a[140:143], v2, s[8:11], s34 offen offset:3072 sc1
  s_waitcnt lgkmcnt(10)
  v_mfma_f32_16x16x32_bf16 v[40:43], v[88:91], a[40:43], v[40:43]
  buffer_load_dwordx4 a[144:147], v3, s[8:11], s34 offen offset:0 sc1
  buffer_load_dwordx4 a[148:151], v3, s[8:11], s34 offen offset:1024 sc1
  s_waitcnt lgkmcnt(8)
  v_mfma_f32_16x16x32_bf16 v[40:43], v[92:95], a[44:47], v[40:43]
  v_mfma_f32_16x16x32_bf16 v[44:47], v[80:83], a[48:51], v[44:47]
  ds_read_b64_tr_b16 v[80:81], v11 offset:16384
  ds_read_b64_tr_b16 v[82:83], v11 offset:16896
  v_mfma_f32_16x16x32_bf16 v[44:47], v[84:87], a[52:55], v[44:47]
  ds_read_b64_tr_b16 v[84:85], v11 offset:20480
  ds_read_b64_tr_b16 v[86:87], v11 offset:20992
  v_mfma_f32_16x16x32_bf16 v[44:47], v[88:91], a[56:59], v[44:47]
  ds_read_b64_tr_b16 v[88:89], v11 offset:24576
  ds_read_b64_tr_b16 v[90:91], v11 offset:25088
  v_mfma_f32_16x16x32_bf16 v[44:47], v[92:95], a[60:63], v[44:47]
  ds_read_b64_tr_b16 v[92:93], v11 offset:28672
  ds_read_b64_tr_b16 v[94:95], v11 offset:29184
  s_waitcnt lgkmcnt(14)
  v_mfma_f32_16x16x32_bf16 v[48:51], v[64:67], a[32:35], v[48:51]
  buffer_load_dwordx4 a[152:155], v3, s[8:11], s34 offen offset:2048 sc1
  buffer_load_dwordx4 a[156:159], v3, s[8:11], s34 offen offset:3072 sc1
  s_waitcnt lgkmcnt(12)
  v_mfma_f32_16x16x32_bf16 v[48:51], v[68:71], a[36:39], v[48:51]
  s_add_u32 s34, s34, 32768
  s_and_b32 s34, s34, 0xfffff
  s_waitcnt lgkmcnt(10)
  v_mfma_f32_16x16x32_bf16 v[48:51], v[72:75], a[40:43], v[48:51]
  s_barrier
  s_waitcnt lgkmcnt(8)
  v_mfma_f32_16x16x32_bf16 v[48:51], v[76:79], a[44:47], v[48:51]
  v_mfma_f32_16x16x32_bf16 v[52:55], v[64:67], a[48:51], v[52:55]
  ds_read_b64_tr_b16 v[64:65], v8 offset:32768
  ds_read_b64_tr_b16 v[66:67], v8 offset:33280
  v_mfma_f32_16x16x32_bf16 v[52:55], v[68:71], a[52:55], v[52:55]
  s_add_u32 m0, s38, 0
  s_add_u32 s39, s36, 0
  buffer_load_dwordx4 v248, s[12:15], s39 offen lds
  v_mfma_f32_16x16x32_bf16 v[52:55], v[72:75], a[56:59], v[52:55]
  ds_read_b64_tr_b16 v[68:69], v8 offset:36864
  ds_read_b64_tr_b16 v[70:71], v8 offset:37376
  v_mfma_f32_16x16x32_bf16 v[52:55], v[76:79], a[60:63], v[52:55]
  ds_read_b64_tr_b16 v[72:73], v8 offset:40960
  ds_read_b64_tr_b16 v[74:75], v8 offset:41472
  s_waitcnt lgkmcnt(12)
  v_mfma_f32_16x16x32_bf16 v[56:59], v[80:83], a[32:35], v[56:59]
  s_add_u32 m0, s38, 1024
  s_add_u32 s39, s36, 7168
  buffer_load_dwordx4 v249, s[12:15], s39 offen lds
  s_waitcnt lgkmcnt(10)
  v_mfma_f32_16x16x32_bf16 v[56:59], v[84:87], a[36:39], v[56:59]
  ds_read_b64_tr_b16 v[76:77], v8 offset:45056
  ds_read_b64_tr_b16 v[78:79], v8 offset:45568
  s_waitcnt lgkmcnt(10)
  v_mfma_f32_16x16x32_bf16 v[56:59], v[88:91], a[40:43], v[56:59]
  s_waitcnt lgkmcnt(8)
  v_mfma_f32_16x16x32_bf16 v[56:59], v[92:95], a[44:47], v[56:59]
  s_add_u32 m0, s38, 2048
  s_add_u32 s39, s36, 14336
  buffer_load_dwordx4 v248, s[12:15], s39 offen lds
  v_mfma_f32_16x16x32_bf16 v[60:63], v[80:83], a[48:51], v[60:63]
  v_mfma_f32_16x16x32_bf16 v[60:63], v[84:87], a[52:55], v[60:63]
  v_mfma_f32_16x16x32_bf16 v[60:63], v[88:91], a[56:59], v[60:63]
  s_add_u32 m0, s38, 3072
  s_add_u32 s39, s36, 21504
  buffer_load_dwordx4 v249, s[12:15], s39 offen lds
  s_add_u32 s36, s36, 114688
  s_cmp_eq_u32 s36, 3670016
  s_cselect_b32 s36, 0, s36
  s_add_u32 s38, s38, 16384
  s_and_b32 s38, s38, 131071
  v_mfma_f32_16x16x32_bf16 v[60:63], v[92:95], a[60:63], v[60:63]
  s_waitcnt vmcnt(31) lgkmcnt(6)
  v_mfma_f32_16x16x32_bf16 v[32:35], v[64:67], a[64:67], v[32:35]
  ds_read_b64_tr_b16 v[80:81], v9 offset:32768
  ds_read_b64_tr_b16 v[82:83], v9 offset:33280
  s_waitcnt vmcnt(30) lgkmcnt(6)
  v_mfma_f32_16x16x32_bf16 v[32:35], v[68:71], a[68:71], v[32:35]
  ds_read_b64_tr_b16 v[84:85], v9 offset:36864
  ds_read_b64_tr_b16 v[86:87], v9 offset:37376
  s_waitcnt vmcnt(29) lgkmcnt(6)
  v_mfma_f32_16x16x32_bf16 v[32:35], v[72:75], a[72:75], v[32:35]
  ds_read_b64_tr_b16 v[88:89], v9 offset:40960
  ds_read_b64_tr_b16 v[90:91], v9 offset:41472
  s_waitcnt vmcnt(28) lgkmcnt(6)
  v_mfma_f32_16x16x32_bf16 v[32:35], v[76:79], a[76:79], v[32:35]
  ds_read_b64_tr_b16 v[92:93], v9 offset:45056
  ds_read_b64_tr_b16 v[94:95], v9 offset:45568
  s_waitcnt vmcnt(27)
  v_mfma_f32_16x16x32_bf16 v[36:39], v[64:67], a[80:83], v[36:39]
  ds_read_b64_tr_b16 v[64:65], v10 offset:32768
  ds_read_b64_tr_b16 v[66:67], v10 offset:33280
  s_waitcnt vmcnt(26)
  v_mfma_f32_16x16x32_bf16 v[36:39], v[68:71], a[84:87], v[36:39]
  ds_read_b64_tr_b16 v[68:69], v10 offset:36864
  ds_read_b64_tr_b16 v[70:71], v10 offset:37376
  s_waitcnt vmcnt(25)
  v_mfma_f32_16x16x32_bf16 v[36:39], v[72:75], a[88:91], v[36:39]
  ds_read_b64_tr_b16 v[72:73], v10 offset:40960
  ds_read_b64_tr_b16 v[74:75], v10 offset:41472
  s_waitcnt vmcnt(24)
  v_mfma_f32_16x16x32_bf16 v[36:39], v[76:79], a[92:95], v[36:39]
  ds_read_b64_tr_b16 v[76:77], v10 offset:45056
  ds_read_b64_tr_b16 v[78:79], v10 offset:45568
  s_waitcnt lgkmcnt(14)
  v_mfma_f32_16x16x32_bf16 v[40:43], v[80:83], a[64:67], v[40:43]
  buffer_load_dwordx4 a[160:163], v2, s[8:11], s34 offen offset:0 sc1
  buffer_load_dwordx4 a[164:167], v2, s[8:11], s34 offen offset:1024 sc1
  s_waitcnt lgkmcnt(12)
  v_mfma_f32_16x16x32_bf16 v[40:43], v[84:87], a[68:71], v[40:43]
  buffer_load_dwordx4 a[168:171], v2, s[8:11], s34 offen offset:2048 sc1
  buffer_load_dwordx4 a[172:175], v2, s[8:11], s34 offen offset:3072 sc1
  s_waitcnt lgkmcnt(10)
  v_mfma_f32_16x16x32_bf16 v[40:43], v[88:91], a[72:75], v[40:43]
  buffer_load_dwordx4 a[176:179], v3, s[8:11], s34 offen offset:0 sc1
  buffer_load_dwordx4 a[180:183], v3, s[8:11], s34 offen offset:1024 sc1
  s_waitcnt lgkmcnt(8)
  v_mfma_f32_16x16x32_bf16 v[40:43], v[92:95], a[76:79], v[40:43]
  v_mfma_f32_16x16x32_bf16 v[44:47], v[80:83], a[80:83], v[44:47]
  ds_read_b64_tr_b16 v[80:81], v11 offset:32768
  ds_read_b64_tr_b16 v[82:83], v11 offset:33280
  v_mfma_f32_16x16x32_bf16 v[44:47], v[84:87], a[84:87], v[44:47]
  ds_read_b64_tr_b16 v[84:85], v11 offset:36864
  ds_read_b64_tr_b16 v[86:87], v11 offset:37376
  v_mfma_f32_16x16x32_bf16 v[44:47], v[88:91], a[88:91], v[44:47]
  ds_read_b64_tr_b16 v[88:89], v11 offset:40960
  ds_read_b64_tr_b16 v[90:91], v11 offset:41472
  v_mfma_f32_16x16x32_bf16 v[44:47], v[92:95], a[92:95], v[44:47]
  ds_read_b64_tr_b16 v[92:93], v11 offset:45056
  ds_read_b64_tr_b16 v[94:95], v11 offset:45568
  s_waitcnt lgkmcnt(14)
  v_mfma_f32_16x16x32_bf16 v[48:51], v[64:67], a[64:67], v[48:51]
  buffer_load_dwordx4 a[184:187], v3, s[8:11], s34 offen offset:2048 sc1
  buffer_load_dwordx4 a[188:191], v3, s[8:11], s34 offen offset:3072 sc1
  s_waitcnt lgkmcnt(12)
  v_mfma_f32_16x16x32_bf16 v[48:51], v[68:71], a[68:71], v[48:51]
  s_add_u32 s34, s34, 32768
  s_and_b32 s34, s34, 0xfffff
  s_waitcnt lgkmcnt(10)
  v_mfma_f32_16x16x32_bf16 v[48:51], v[72:75], a[72:75], v[48:51]
  s_barrier
  s_waitcnt lgkmcnt(8)
  v_mfma_f32_16x16x32_bf16 v[48:51], v[76:79], a[76:79], v[48:51]
  v_mfma_f32_16x16x32_bf16 v[52:55], v[64:67], a[80:83], v[52:55]
  ds_read_b64_tr_b16 v[64:65], v8 offset:49152
  ds_read_b64_tr_b16 v[66:67], v8 offset:49664
  v_mfma_f32_16x16x32_bf16 v[52:55], v[68:71], a[84:87], v[52:55]
  s_add_u32 m0, s38, 0
  s_add_u32 s39, s36, 0
  buffer_load_dwordx4 v248, s[12:15], s39 offen lds
  v_mfma_f32_16x16x32_bf16 v[52:55], v[72:75], a[88:91], v[52:55]
  ds_read_b64_tr_b16 v[68:69], v8 offset:53248
  ds_read_b64_tr_b16 v[70:71], v8 offset:53760
  v_mfma_f32_16x16x32_bf16 v[52:55], v[76:79], a[92:95], v[52:55]
  ds_read_b64_tr_b16 v[72:73], v8 offset:57344
  ds_read_b64_tr_b16 v[74:75], v8 offset:57856
  s_waitcnt lgkmcnt(12)
  v_mfma_f32_16x16x32_bf16 v[56:59], v[80:83], a[64:67], v[56:59]
  s_add_u32 m0, s38, 1024
  s_add_u32 s39, s36, 7168
  buffer_load_dwordx4 v249, s[12:15], s39 offen lds
  s_waitcnt lgkmcnt(10)
  v_mfma_f32_16x16x32_bf16 v[56:59], v[84:87], a[68:71], v[56:59]
  ds_read_b64_tr_b16 v[76:77], v8 offset:61440
  ds_read_b64_tr_b16 v[78:79], v8 offset:61952
  s_waitcnt lgkmcnt(10)
  v_mfma_f32_16x16x32_bf16 v[56:59], v[88:91], a[72:75], v[56:59]
  s_waitcnt lgkmcnt(8)
  v_mfma_f32_16x16x32_bf16 v[56:59], v[92:95], a[76:79], v[56:59]
  s_add_u32 m0, s38, 2048
  s_add_u32 s39, s36, 14336
  buffer_load_dwordx4 v248, s[12:15], s39 offen lds
  v_mfma_f32_16x16x32_bf16 v[60:63], v[80:83], a[80:83], v[60:63]
  v_mfma_f32_16x16x32_bf16 v[60:63], v[84:87], a[84:87], v[60:63]
  v_mfma_f32_16x16x32_bf16 v[60:63], v[88:91], a[88:91], v[60:63]
  s_add_u32 m0, s38, 3072
  s_add_u32 s39, s36, 21504
  buffer_load_dwordx4 v249, s[12:15], s39 offen lds
  s_add_u32 s36, s36, 114688
  s_cmp_eq_u32 s36, 3670016
  s_cselect_b32 s36, 0, s36
  s_add_u32 s38, s38, 16384
  s_and_b32 s38, s38, 131071
  v_mfma_f32_16x16x32_bf16 v[60:63], v[92:95], a[92:95], v[60:63]
  s_waitcnt vmcnt(35) lgkmcnt(6)
  v_mfma_f32_16x16x32_bf16 v[32:35], v[64:67], a[96:99], v[32:35]
  ds_read_b64_tr_b16 v[80:81], v9 offset:49152
  ds_read_b64_tr_b16 v[82:83], v9 offset:49664
  s_waitcnt vmcnt(34) lgkmcnt(6)
  v_mfma_f32_16x16x32_bf16 v[32:35], v[68:71], a[100:103], v[32:35]
  ds_read_b64_tr_b16 v[84:85], v9 offset:53248
  ds_read_b64_tr_b16 v[86:87], v9 offset:53760
  s_waitcnt vmcnt(33) lgkmcnt(6)
  v_mfma_f32_16x16x32_bf16 v[32:35], v[72:75], a[104:107], v[32:35]
  ds_read_b64_tr_b16 v[88:89], v9 offset:57344
  ds_read_b64_tr_b16 v[90:91], v9 offset:57856
  s_waitcnt vmcnt(32) lgkmcnt(6)
  v_mfma_f32_16x16x32_bf16 v[32:35], v[76:79], a[108:111], v[32:35]
  ds_read_b64_tr_b16 v[92:93], v9 offset:61440
  ds_read_b64_tr_b16 v[94:95], v9 offset:61952
  s_waitcnt vmcnt(31)
  v_mfma_f32_16x16x32_bf16 v[36:39], v[64:67], a[112:115], v[36:39]
  ds_read_b64_tr_b16 v[64:65], v10 offset:49152
  ds_read_b64_tr_b16 v[66:67], v10 offset:49664
  s_waitcnt vmcnt(30)
  v_mfma_f32_16x16x32_bf16 v[36:39], v[68:71], a[116:119], v[36:39]
  ds_read_b64_tr_b16 v[68:69], v10 offset:53248
  ds_read_b64_tr_b16 v[70:71], v10 offset:53760
  s_waitcnt vmcnt(29)
  v_mfma_f32_16x16x32_bf16 v[36:39], v[72:75], a[120:123], v[36:39]
  ds_read_b64_tr_b16 v[72:73], v10 offset:57344
  ds_read_b64_tr_b16 v[74:75], v10 offset:57856
  s_waitcnt vmcnt(28)
  v_mfma_f32_16x16x32_bf16 v[36:39], v[76:79], a[124:127], v[36:39]
  ds_read_b64_tr_b16 v[76:77], v10 offset:61440
  ds_read_b64_tr_b16 v[78:79], v10 offset:61952
  s_waitcnt lgkmcnt(14)
  v_mfma_f32_16x16x32_bf16 v[40:43], v[80:83], a[96:99], v[40:43]
  buffer_load_dwordx4 a[192:195], v2, s[8:11], s34 offen offset:0 sc1
  buffer_load_dwordx4 a[196:199], v2, s[8:11], s34 offen offset:1024 sc1
  s_waitcnt lgkmcnt(12)
  v_mfma_f32_16x16x32_bf16 v[40:43], v[84:87], a[100:103], v[40:43]
  buffer_load_dwordx4 a[200:203], v2, s[8:11], s34 offen offset:2048 sc1
  buffer_load_dwordx4 a[204:207], v2, s[8:11], s34 offen offset:3072 sc1
  s_waitcnt lgkmcnt(10)
  v_mfma_f32_16x16x32_bf16 v[40:43], v[88:91], a[104:107], v[40:43]
  buffer_load_dwordx4 a[208:211], v3, s[8:11], s34 offen offset:0 sc1
  buffer_load_dwordx4 a[212:215], v3, s[8:11], s34 offen offset:1024 sc1
  s_waitcnt lgkmcnt(8)
  v_mfma_f32_16x16x32_bf16 v[40:43], v[92:95], a[108:111], v[40:43]
  v_mfma_f32_16x16x32_bf16 v[44:47], v[80:83], a[112:115], v[44:47]
  ds_read_b64_tr_b16 v[80:81], v11 offset:49152
  ds_read_b64_tr_b16 v[82:83], v11 offset:49664
  v_mfma_f32_16x16x32_bf16 v[44:47], v[84:87], a[116:119], v[44:47]
  ds_read_b64_tr_b16 v[84:85], v11 offset:53248
  ds_read_b64_tr_b16 v[86:87], v11 offset:53760
  v_mfma_f32_16x16x32_bf16 v[44:47], v[88:91], a[120:123], v[44:47]
  ds_read_b64_tr_b16 v[88:89], v11 offset:57344
  ds_read_b64_tr_b16 v[90:91], v11 offset:57856
  v_mfma_f32_16x16x32_bf16 v[44:47], v[92:95], a[124:127], v[44:47]
  ds_read_b64_tr_b16 v[92:93], v11 offset:61440
  ds_read_b64_tr_b16 v[94:95], v11 offset:61952
  s_waitcnt lgkmcnt(14)
  v_mfma_f32_16x16x32_bf16 v[48:51], v[64:67], a[96:99], v[48:51]
  buffer_load_dwordx4 a[216:219], v3, s[8:11], s34 offen offset:2048 sc1
  buffer_load_dwordx4 a[220:223], v3, s[8:11], s34 offen offset:3072 sc1
  s_waitcnt lgkmcnt(12)
  v_mfma_f32_16x16x32_bf16 v[48:51], v[68:71], a[100:103], v[48:51]
  s_add_u32 s34, s34, 32768
  s_and_b32 s34, s34, 0xfffff
  s_waitcnt lgkmcnt(10)
  v_mfma_f32_16x16x32_bf16 v[48:51], v[72:75], a[104:107], v[48:51]
  s_barrier
  s_waitcnt lgkmcnt(8)
  v_mfma_f32_16x16x32_bf16 v[48:51], v[76:79], a[108:111], v[48:51]
  v_mfma_f32_16x16x32_bf16 v[52:55], v[64:67], a[112:115], v[52:55]
  v_mfma_f32_16x16x32_bf16 v[52:55], v[68:71], a[116:119], v[52:55]
  s_add_u32 m0, s38, 0
  s_add_u32 s39, s36, 0
  buffer_load_dwordx4 v248, s[12:15], s39 offen lds
  v_mfma_f32_16x16x32_bf16 v[52:55], v[72:75], a[120:123], v[52:55]
  v_xor_b32 v8, 65536, v8
  v_xor_b32 v9, 65536, v9
  v_mfma_f32_16x16x32_bf16 v[52:55], v[76:79], a[124:127], v[52:55]
  v_xor_b32 v10, 65536, v10
  v_xor_b32 v11, 65536, v11
  s_waitcnt lgkmcnt(6)
  v_mfma_f32_16x16x32_bf16 v[56:59], v[80:83], a[96:99], v[56:59]
  s_add_u32 m0, s38, 1024
  s_add_u32 s39, s36, 7168
  buffer_load_dwordx4 v249, s[12:15], s39 offen lds
  s_waitcnt lgkmcnt(4)
  v_mfma_f32_16x16x32_bf16 v[56:59], v[84:87], a[100:103], v[56:59]
  ds_read_b64_tr_b16 v[64:65], v8 offset:0
  ds_read_b64_tr_b16 v[66:67], v8 offset:512
  s_waitcnt lgkmcnt(4)
  v_mfma_f32_16x16x32_bf16 v[56:59], v[88:91], a[104:107], v[56:59]
  ds_read_b64_tr_b16 v[68:69], v8 offset:4096
  ds_read_b64_tr_b16 v[70:71], v8 offset:4608
  s_waitcnt lgkmcnt(4)
  v_mfma_f32_16x16x32_bf16 v[56:59], v[92:95], a[108:111], v[56:59]
  s_add_u32 m0, s38, 2048
  s_add_u32 s39, s36, 14336
  buffer_load_dwordx4 v248, s[12:15], s39 offen lds
  v_mfma_f32_16x16x32_bf16 v[60:63], v[80:83], a[112:115], v[60:63]
  ds_read_b64_tr_b16 v[72:73], v8 offset:8192
  ds_read_b64_tr_b16 v[74:75], v8 offset:8704
  v_mfma_f32_16x16x32_bf16 v[60:63], v[84:87], a[116:119], v[60:63]
  ds_read_b64_tr_b16 v[76:77], v8 offset:12288
  ds_read_b64_tr_b16 v[78:79], v8 offset:12800
  v_mfma_f32_16x16x32_bf16 v[60:63], v[88:91], a[120:123], v[60:63]
  s_add_u32 m0, s38, 3072
  s_add_u32 s39, s36, 21504
  buffer_load_dwordx4 v249, s[12:15], s39 offen lds
  s_add_u32 s36, s36, 114688
  s_cmp_eq_u32 s36, 3670016
  s_cselect_b32 s36, 0, s36
  s_add_u32 s38, s38, 16384
  s_and_b32 s38, s38, 131071
  v_mfma_f32_16x16x32_bf16 v[60:63], v[92:95], a[124:127], v[60:63]
  s_waitcnt vmcnt(35) lgkmcnt(6)
  v_mfma_f32_16x16x32_bf16 v[32:35], v[64:67], a[128:131], v[32:35]
  ds_read_b64_tr_b16 v[80:81], v9 offset:0
  ds_read_b64_tr_b16 v[82:83], v9 offset:512
  s_waitcnt vmcnt(34) lgkmcnt(6)
  v_mfma_f32_16x16x32_bf16 v[32:35], v[68:71], a[132:135], v[32:35]
  ds_read_b64_tr_b16 v[84:85], v9 offset:4096
  ds_read_b64_tr_b16 v[86:87], v9 offset:4608
  s_waitcnt vmcnt(33) lgkmcnt(6)
  v_mfma_f32_16x16x32_bf16 v[32:35], v[72:75], a[136:139], v[32:35]
  ds_read_b64_tr_b16 v[88:89], v9 offset:8192
  ds_read_b64_tr_b16 v[90:91], v9 offset:8704
  s_waitcnt vmcnt(32) lgkmcnt(6)
  v_mfma_f32_16x16x32_bf16 v[32:35], v[76:79], a[140:143], v[32:35]
  ds_read_b64_tr_b16 v[92:93], v9 offset:12288
  ds_read_b64_tr_b16 v[94:95], v9 offset:12800
  s_waitcnt vmcnt(31)
  v_mfma_f32_16x16x32_bf16 v[36:39], v[64:67], a[144:147], v[36:39]
  ds_read_b64_tr_b16 v[64:65], v10 offset:0
  ds_read_b64_tr_b16 v[66:67], v10 offset:512
  s_waitcnt vmcnt(30)
  v_mfma_f32_16x16x32_bf16 v[36:39], v[68:71], a[148:151], v[36:39]
  ds_read_b64_tr_b16 v[68:69], v10 offset:4096
  ds_read_b64_tr_b16 v[70:71], v10 offset:4608
  s_waitcnt vmcnt(29)
  v_mfma_f32_16x16x32_bf16 v[36:39], v[72:75], a[152:155], v[36:39]
  ds_read_b64_tr_b16 v[72:73], v10 offset:8192
  ds_read_b64_tr_b16 v[74:75], v10 offset:8704
  s_waitcnt vmcnt(28)
  v_mfma_f32_16x16x32_bf16 v[36:39], v[76:79], a[156:159], v[36:39]
  ds_read_b64_tr_b16 v[76:77], v10 offset:12288
  ds_read_b64_tr_b16 v[78:79], v10 offset:12800
  s_waitcnt lgkmcnt(14)
  v_mfma_f32_16x16x32_bf16 v[40:43], v[80:83], a[128:131], v[40:43]
  buffer_load_dwordx4 a[224:227], v2, s[8:11], s34 offen offset:0 sc1
  buffer_load_dwordx4 a[228:231], v2, s[8:11], s34 offen offset:1024 sc1
  s_waitcnt lgkmcnt(12)
  v_mfma_f32_16x16x32_bf16 v[40:43], v[84:87], a[132:135], v[40:43]
  buffer_load_dwordx4 a[232:235], v2, s[8:11], s34 offen offset:2048 sc1
  buffer_load_dwordx4 a[236:239], v2, s[8:11], s34 offen offset:3072 sc1
  s_waitcnt lgkmcnt(10)
  v_mfma_f32_16x16x32_bf16 v[40:43], v[88:91], a[136:139], v[40:43]
  buffer_load_dwordx4 a[240:243], v3, s[8:11], s34 offen offset:0 sc1
  buffer_load_dwordx4 a[244:247], v3, s[8:11], s34 offen offset:1024 sc1
  s_waitcnt lgkmcnt(8)
  v_mfma_f32_16x16x32_bf16 v[40:43], v[92:95], a[140:143], v[40:43]
  v_mfma_f32_16x16x32_bf16 v[44:47], v[80:83], a[144:147], v[44:47]
  ds_read_b64_tr_b16 v[80:81], v11 offset:0
  ds_read_b64_tr_b16 v[82:83], v11 offset:512
  v_mfma_f32_16x16x32_bf16 v[44:47], v[84:87], a[148:151], v[44:47]
  ds_read_b64_tr_b16 v[84:85], v11 offset:4096
  ds_read_b64_tr_b16 v[86:87], v11 offset:4608
  v_mfma_f32_16x16x32_bf16 v[44:47], v[88:91], a[152:155], v[44:47]
  ds_read_b64_tr_b16 v[88:89], v11 offset:8192
  ds_read_b64_tr_b16 v[90:91], v11 offset:8704
  v_mfma_f32_16x16x32_bf16 v[44:47], v[92:95], a[156:159], v[44:47]
  ds_read_b64_tr_b16 v[92:93], v11 offset:12288
  ds_read_b64_tr_b16 v[94:95], v11 offset:12800
  s_waitcnt lgkmcnt(14)
  v_mfma_f32_16x16x32_bf16 v[48:51], v[64:67], a[128:131], v[48:51]
  buffer_load_dwordx4 a[248:251], v3, s[8:11], s34 offen offset:2048 sc1
  buffer_load_dwordx4 a[252:255], v3, s[8:11], s34 offen offset:3072 sc1
  s_waitcnt lgkmcnt(12)
  v_mfma_f32_16x16x32_bf16 v[48:51], v[68:71], a[132:135], v[48:51]
  s_add_u32 s34, s34, 32768
  s_and_b32 s34, s34, 0xfffff
  s_waitcnt lgkmcnt(10)
  v_mfma_f32_16x16x32_bf16 v[48:51], v[72:75], a[136:139], v[48:51]
  s_barrier
  s_waitcnt lgkmcnt(8)
  v_mfma_f32_16x16x32_bf16 v[48:51], v[76:79], a[140:143], v[48:51]
  v_mfma_f32_16x16x32_bf16 v[52:55], v[64:67], a[144:147], v[52:55]
  ds_read_b64_tr_b16 v[64:65], v8 offset:16384
  ds_read_b64_tr_b16 v[66:67], v8 offset:16896
  v_mfma_f32_16x16x32_bf16 v[52:55], v[68:71], a[148:151], v[52:55]
  s_add_u32 m0, s38, 0
  s_add_u32 s39, s36, 0
  buffer_load_dwordx4 v248, s[12:15], s39 offen lds
  v_mfma_f32_16x16x32_bf16 v[52:55], v[72:75], a[152:155], v[52:55]
  ds_read_b64_tr_b16 v[68:69], v8 offset:20480
  ds_read_b64_tr_b16 v[70:71], v8 offset:20992
  v_mfma_f32_16x16x32_bf16 v[52:55], v[76:79], a[156:159], v[52:55]
  ds_read_b64_tr_b16 v[72:73], v8 offset:24576
  ds_read_b64_tr_b16 v[74:75], v8 offset:25088
  s_waitcnt lgkmcnt(12)
  v_mfma_f32_16x16x32_bf16 v[56:59], v[80:83], a[128:131], v[56:59]
  s_add_u32 m0, s38, 1024
  s_add_u32 s39, s36, 7168
  buffer_load_dwordx4 v249, s[12:15], s39 offen lds
  s_waitcnt lgkmcnt(10)
  v_mfma_f32_16x16x32_bf16 v[56:59], v[84:87], a[132:135], v[56:59]
  ds_read_b64_tr_b16 v[76:77], v8 offset:28672
  ds_read_b64_tr_b16 v[78:79], v8 offset:29184
  s_waitcnt lgkmcnt(10)
  v_mfma_f32_16x16x32_bf16 v[56:59], v[88:91], a[136:139], v[56:59]
  s_waitcnt lgkmcnt(8)
  v_mfma_f32_16x16x32_bf16 v[56:59], v[92:95], a[140:143], v[56:59]
  s_add_u32 m0, s38, 2048
  s_add_u32 s39, s36, 14336
  buffer_load_dwordx4 v248, s[12:15], s39 offen lds
  v_mfma_f32_16x16x32_bf16 v[60:63], v[80:83], a[144:147], v[60:63]
  v_mfma_f32_16x16x32_bf16 v[60:63], v[84:87], a[148:151], v[60:63]
  v_mfma_f32_16x16x32_bf16 v[60:63], v[88:91], a[152:155], v[60:63]
  s_add_u32 m0, s38, 3072
  s_add_u32 s39, s36, 21504
  buffer_load_dwordx4 v249, s[12:15], s39 offen lds
  s_add_u32 s36, s36, 114688
  s_cmp_eq_u32 s36, 3670016
  s_cselect_b32 s36, 0, s36
  s_add_u32 s38, s38, 16384
  s_and_b32 s38, s38, 131071
  v_mfma_f32_16x16x32_bf16 v[60:63], v[92:95], a[156:159], v[60:63]
  s_waitcnt vmcnt(35) lgkmcnt(6)
  v_mfma_f32_16x16x32_bf16 v[32:35], v[64:67], a[160:163], v[32:35]
  ds_read_b64_tr_b16 v[80:81], v9 offset:16384
  ds_read_b64_tr_b16 v[82:83], v9 offset:16896
  s_waitcnt vmcnt(34) lgkmcnt(6)
  v_mfma_f32_16x16x32_bf16 v[32:35], v[68:71], a[164:167], v[32:35]
  ds_read_b64_tr_b16 v[84:85], v9 offset:20480
  ds_read_b64_tr_b16 v[86:87], v9 offset:20992
  s_waitcnt vmcnt(33) lgkmcnt(6)
  v_mfma_f32_16x16x32_bf16 v[32:35], v[72:75], a[168:171], v[32:35]
  ds_read_b64_tr_b16 v[88:89], v9 offset:24576
  ds_read_b64_tr_b16 v[90:91], v9 offset:25088
  s_waitcnt vmcnt(32) lgkmcnt(6)
  v_mfma_f32_16x16x32_bf16 v[32:35], v[76:79], a[172:175], v[32:35]
  ds_read_b64_tr_b16 v[92:93], v9 offset:28672
  ds_read_b64_tr_b16 v[94:95], v9 offset:29184
  s_waitcnt vmcnt(31)
  v_mfma_f32_16x16x32_bf16 v[36:39], v[64:67], a[176:179], v[36:39]
  ds_read_b64_tr_b16 v[64:65], v10 offset:16384
  ds_read_b64_tr_b16 v[66:67], v10 offset:16896
  s_waitcnt vmcnt(30)
  v_mfma_f32_16x16x32_bf16 v[36:39], v[68:71], a[180:183], v[36:39]
  ds_read_b64_tr_b16 v[68:69], v10 offset:20480
  ds_read_b64_tr_b16 v[70:71], v10 offset:20992
  s_waitcnt vmcnt(29)
  v_mfma_f32_16x16x32_bf16 v[36:39], v[72:75], a[184:187], v[36:39]
  ds_read_b64_tr_b16 v[72:73], v10 offset:24576
  ds_read_b64_tr_b16 v[74:75], v10 offset:25088
  s_waitcnt vmcnt(28)
  v_mfma_f32_16x16x32_bf16 v[36:39], v[76:79], a[188:191], v[36:39]
  ds_read_b64_tr_b16 v[76:77], v10 offset:28672
  ds_read_b64_tr_b16 v[78:79], v10 offset:29184
  s_waitcnt lgkmcnt(14)
  v_mfma_f32_16x16x32_bf16 v[40:43], v[80:83], a[160:163], v[40:43]
  buffer_load_dwordx4 a[0:3], v2, s[8:11], s34 offen offset:0 sc1
  buffer_load_dwordx4 a[4:7], v2, s[8:11], s34 offen offset:1024 sc1
  s_waitcnt lgkmcnt(12)
  v_mfma_f32_16x16x32_bf16 v[40:43], v[84:87], a[164:167], v[40:43]
  buffer_load_dwordx4 a[8:11], v2, s[8:11], s34 offen offset:2048 sc1
  buffer_load_dwordx4 a[12:15], v2, s[8:11], s34 offen offset:3072 sc1
  s_waitcnt lgkmcnt(10)
  v_mfma_f32_16x16x32_bf16 v[40:43], v[88:91], a[168:171], v[40:43]
  buffer_load_dwordx4 a[16:19], v3, s[8:11], s34 offen offset:0 sc1
  buffer_load_dwordx4 a[20:23], v3, s[8:11], s34 offen offset:1024 sc1
  s_waitcnt lgkmcnt(8)
  v_mfma_f32_16x16x32_bf16 v[40:43], v[92:95], a[172:175], v[40:43]
  v_mfma_f32_16x16x32_bf16 v[44:47], v[80:83], a[176:179], v[44:47]
  ds_read_b64_tr_b16 v[80:81], v11 offset:16384
  ds_read_b64_tr_b16 v[82:83], v11 offset:16896
  v_mfma_f32_16x16x32_bf16 v[44:47], v[84:87], a[180:183], v[44:47]
  ds_read_b64_tr_b16 v[84:85], v11 offset:20480
  ds_read_b64_tr_b16 v[86:87], v11 offset:20992
  v_mfma_f32_16x16x32_bf16 v[44:47], v[88:91], a[184:187], v[44:47]
  ds_read_b64_tr_b16 v[88:89], v11 offset:24576
  ds_read_b64_tr_b16 v[90:91], v11 offset:25088
  v_mfma_f32_16x16x32_bf16 v[44:47], v[92:95], a[188:191], v[44:47]
  ds_read_b64_tr_b16 v[92:93], v11 offset:28672
  ds_read_b64_tr_b16 v[94:95], v11 offset:29184
  s_waitcnt lgkmcnt(14)
  v_mfma_f32_16x16x32_bf16 v[48:51], v[64:67], a[160:163], v[48:51]
  buffer_load_dwordx4 a[24:27], v3, s[8:11], s34 offen offset:2048 sc1
  buffer_load_dwordx4 a[28:31], v3, s[8:11], s34 offen offset:3072 sc1
  s_waitcnt lgkmcnt(12)
  v_mfma_f32_16x16x32_bf16 v[48:51], v[68:71], a[164:167], v[48:51]
  s_add_u32 s34, s34, 32768
  s_and_b32 s34, s34, 0xfffff
  s_waitcnt lgkmcnt(10)
  v_mfma_f32_16x16x32_bf16 v[48:51], v[72:75], a[168:171], v[48:51]
  s_barrier
  s_waitcnt lgkmcnt(8)
  v_mfma_f32_16x16x32_bf16 v[48:51], v[76:79], a[172:175], v[48:51]
  v_mfma_f32_16x16x32_bf16 v[52:55], v[64:67], a[176:179], v[52:55]
  ds_read_b64_tr_b16 v[64:65], v8 offset:32768
  ds_read_b64_tr_b16 v[66:67], v8 offset:33280
  v_mfma_f32_16x16x32_bf16 v[52:55], v[68:71], a[180:183], v[52:55]
  s_add_u32 m0, s38, 0
  s_add_u32 s39, s36, 0
  buffer_load_dwordx4 v248, s[12:15], s39 offen lds
  v_mfma_f32_16x16x32_bf16 v[52:55], v[72:75], a[184:187], v[52:55]
  ds_read_b64_tr_b16 v[68:69], v8 offset:36864
  ds_read_b64_tr_b16 v[70:71], v8 offset:37376
  v_mfma_f32_16x16x32_bf16 v[52:55], v[76:79], a[188:191], v[52:55]
  ds_read_b64_tr_b16 v[72:73], v8 offset:40960
  ds_read_b64_tr_b16 v[74:75], v8 offset:41472
  s_waitcnt lgkmcnt(12)
  v_mfma_f32_16x16x32_bf16 v[56:59], v[80:83], a[160:163], v[56:59]
  s_add_u32 m0, s38, 1024
  s_add_u32 s39, s36, 7168
  buffer_load_dwordx4 v249, s[12:15], s39 offen lds
  s_waitcnt lgkmcnt(10)
  v_mfma_f32_16x16x32_bf16 v[56:59], v[84:87], a[164:167], v[56:59]
  ds_read_b64_tr_b16 v[76:77], v8 offset:45056
  ds_read_b64_tr_b16 v[78:79], v8 offset:45568
  s_waitcnt lgkmcnt(10)
  v_mfma_f32_16x16x32_bf16 v[56:59], v[88:91], a[168:171], v[56:59]
  s_waitcnt lgkmcnt(8)
  v_mfma_f32_16x16x32_bf16 v[56:59], v[92:95], a[172:175], v[56:59]
  s_add_u32 m0, s38, 2048
  s_add_u32 s39, s36, 14336
  buffer_load_dwordx4 v248, s[12:15], s39 offen lds
  v_mfma_f32_16x16x32_bf16 v[60:63], v[80:83], a[176:179], v[60:63]
  v_mfma_f32_16x16x32_bf16 v[60:63], v[84:87], a[180:183], v[60:63]
  v_mfma_f32_16x16x32_bf16 v[60:63], v[88:91], a[184:187], v[60:63]
  s_add_u32 m0, s38, 3072
  s_add_u32 s39, s36, 21504
  buffer_load_dwordx4 v249, s[12:15], s39 offen lds
  s_add_u32 s36, s36, 114688
  s_cmp_eq_u32 s36, 3670016
  s_cselect_b32 s36, 0, s36
  s_add_u32 s38, s38, 16384
  s_and_b32 s38, s38, 131071
  v_mfma_f32_16x16x32_bf16 v[60:63], v[92:95], a[188:191], v[60:63]
  s_waitcnt vmcnt(35) lgkmcnt(6)
  v_mfma_f32_16x16x32_bf16 v[32:35], v[64:67], a[192:195], v[32:35]
  ds_read_b64_tr_b16 v[80:81], v9 offset:32768
  ds_read_b64_tr_b16 v[82:83], v9 offset:33280
  s_waitcnt vmcnt(34) lgkmcnt(6)
  v_mfma_f32_16x16x32_bf16 v[32:35], v[68:71], a[196:199], v[32:35]
  ds_read_b64_tr_b16 v[84:85], v9 offset:36864
  ds_read_b64_tr_b16 v[86:87], v9 offset:37376
  s_waitcnt vmcnt(33) lgkmcnt(6)
  v_mfma_f32_16x16x32_bf16 v[32:35], v[72:75], a[200:203], v[32:35]
  ds_read_b64_tr_b16 v[88:89], v9 offset:40960
  ds_read_b64_tr_b16 v[90:91], v9 offset:41472
  s_waitcnt vmcnt(32) lgkmcnt(6)
  v_mfma_f32_16x16x32_bf16 v[32:35], v[76:79], a[204:207], v[32:35]
  ds_read_b64_tr_b16 v[92:93], v9 offset:45056
  ds_read_b64_tr_b16 v[94:95], v9 offset:45568
  s_waitcnt vmcnt(31)
  v_mfma_f32_16x16x32_bf16 v[36:39], v[64:67], a[208:211], v[36:39]
  ds_read_b64_tr_b16 v[64:65], v10 offset:32768
  ds_read_b64_tr_b16 v[66:67], v10 offset:33280
  s_waitcnt vmcnt(30)
  v_mfma_f32_16x16x32_bf16 v[36:39], v[68:71], a[212:215], v[36:39]
  ds_read_b64_tr_b16 v[68:69], v10 offset:36864
  ds_read_b64_tr_b16 v[70:71], v10 offset:37376
  s_waitcnt vmcnt(29)
  v_mfma_f32_16x16x32_bf16 v[36:39], v[72:75], a[216:219], v[36:39]
  ds_read_b64_tr_b16 v[72:73], v10 offset:40960
  ds_read_b64_tr_b16 v[74:75], v10 offset:41472
  s_waitcnt vmcnt(28)
  v_mfma_f32_16x16x32_bf16 v[36:39], v[76:79], a[220:223], v[36:39]
  ds_read_b64_tr_b16 v[76:77], v10 offset:45056
  ds_read_b64_tr_b16 v[78:79], v10 offset:45568
  s_waitcnt lgkmcnt(14)
  v_mfma_f32_16x16x32_bf16 v[40:43], v[80:83], a[192:195], v[40:43]
  buffer_load_dwordx4 a[32:35], v2, s[8:11], s34 offen offset:0 sc1
  buffer_load_dwordx4 a[36:39], v2, s[8:11], s34 offen offset:1024 sc1
  s_waitcnt lgkmcnt(12)
  v_mfma_f32_16x16x32_bf16 v[40:43], v[84:87], a[196:199], v[40:43]
  buffer_load_dwordx4 a[40:43], v2, s[8:11], s34 offen offset:2048 sc1
  buffer_load_dwordx4 a[44:47], v2, s[8:11], s34 offen offset:3072 sc1
  s_waitcnt lgkmcnt(10)
  v_mfma_f32_16x16x32_bf16 v[40:43], v[88:91], a[200:203], v[40:43]
  buffer_load_dwordx4 a[48:51], v3, s[8:11], s34 offen offset:0 sc1
  buffer_load_dwordx4 a[52:55], v3, s[8:11], s34 offen offset:1024 sc1
  s_waitcnt lgkmcnt(8)
  v_mfma_f32_16x16x32_bf16 v[40:43], v[92:95], a[204:207], v[40:43]
  v_mfma_f32_16x16x32_bf16 v[44:47], v[80:83], a[208:211], v[44:47]
  ds_read_b64_tr_b16 v[80:81], v11 offset:32768
  ds_read_b64_tr_b16 v[82:83], v11 offset:33280
  v_mfma_f32_16x16x32_bf16 v[44:47], v[84:87], a[212:215], v[44:47]
  ds_read_b64_tr_b16 v[84:85], v11 offset:36864
  ds_read_b64_tr_b16 v[86:87], v11 offset:37376
  v_mfma_f32_16x16x32_bf16 v[44:47], v[88:91], a[216:219], v[44:47]
  ds_read_b64_tr_b16 v[88:89], v11 offset:40960
  ds_read_b64_tr_b16 v[90:91], v11 offset:41472
  v_mfma_f32_16x16x32_bf16 v[44:47], v[92:95], a[220:223], v[44:47]
  ds_read_b64_tr_b16 v[92:93], v11 offset:45056
  ds_read_b64_tr_b16 v[94:95], v11 offset:45568
  s_waitcnt lgkmcnt(14)
  v_mfma_f32_16x16x32_bf16 v[48:51], v[64:67], a[192:195], v[48:51]
  buffer_load_dwordx4 a[56:59], v3, s[8:11], s34 offen offset:2048 sc1
  buffer_load_dwordx4 a[60:63], v3, s[8:11], s34 offen offset:3072 sc1
  s_waitcnt lgkmcnt(12)
  v_mfma_f32_16x16x32_bf16 v[48:51], v[68:71], a[196:199], v[48:51]
  s_add_u32 s34, s34, 32768
  s_and_b32 s34, s34, 0xfffff
  s_waitcnt lgkmcnt(10)
  v_mfma_f32_16x16x32_bf16 v[48:51], v[72:75], a[200:203], v[48:51]
  s_barrier
  s_waitcnt lgkmcnt(8)
  v_mfma_f32_16x16x32_bf16 v[48:51], v[76:79], a[204:207], v[48:51]
  v_mfma_f32_16x16x32_bf16 v[52:55], v[64:67], a[208:211], v[52:55]
  ds_read_b64_tr_b16 v[64:65], v8 offset:49152
  ds_read_b64_tr_b16 v[66:67], v8 offset:49664
  v_mfma_f32_16x16x32_bf16 v[52:55], v[68:71], a[212:215], v[52:55]
  s_add_u32 m0, s38, 0
  s_add_u32 s39, s36, 0
  buffer_load_dwordx4 v248, s[12:15], s39 offen lds
  v_mfma_f32_16x16x32_bf16 v[52:55], v[72:75], a[216:219], v[52:55]
  ds_read_b64_tr_b16 v[68:69], v8 offset:53248
  ds_read_b64_tr_b16 v[70:71], v8 offset:53760
  v_mfma_f32_16x16x32_bf16 v[52:55], v[76:79], a[220:223], v[52:55]
  ds_read_b64_tr_b16 v[72:73], v8 offset:57344
  ds_read_b64_tr_b16 v[74:75], v8 offset:57856
  s_waitcnt lgkmcnt(12)
  v_mfma_f32_16x16x32_bf16 v[56:59], v[80:83], a[192:195], v[56:59]
  s_add_u32 m0, s38, 1024
  s_add_u32 s39, s36, 7168
  buffer_load_dwordx4 v249, s[12:15], s39 offen lds
  s_waitcnt lgkmcnt(10)
  v_mfma_f32_16x16x32_bf16 v[56:59], v[84:87], a[196:199], v[56:59]
  ds_read_b64_tr_b16 v[76:77], v8 offset:61440
  ds_read_b64_tr_b16 v[78:79], v8 offset:61952
  s_waitcnt lgkmcnt(10)
  v_mfma_f32_16x16x32_bf16 v[56:59], v[88:91], a[200:203], v[56:59]
  s_waitcnt lgkmcnt(8)
  v_mfma_f32_16x16x32_bf16 v[56:59], v[92:95], a[204:207], v[56:59]
  s_add_u32 m0, s38, 2048
  s_add_u32 s39, s36, 14336
  buffer_load_dwordx4 v248, s[12:15], s39 offen lds
  v_mfma_f32_16x16x32_bf16 v[60:63], v[80:83], a[208:211], v[60:63]
  v_mfma_f32_16x16x32_bf16 v[60:63], v[84:87], a[212:215], v[60:63]
  v_mfma_f32_16x16x32_bf16 v[60:63], v[88:91], a[216:219], v[60:63]
  s_add_u32 m0, s38, 3072
  s_add_u32 s39, s36, 21504
  buffer_load_dwordx4 v249, s[12:15], s39 offen lds
  s_add_u32 s36, s36, 114688
  s_cmp_eq_u32 s36, 3670016
  s_cselect_b32 s36, 0, s36
  s_add_u32 s38, s38, 16384
  s_and_b32 s38, s38, 131071
  v_mfma_f32_16x16x32_bf16 v[60:63], v[92:95], a[220:223], v[60:63]
  s_waitcnt vmcnt(35) lgkmcnt(6)
  v_mfma_f32_16x16x32_bf16 v[32:35], v[64:67], a[224:227], v[32:35]
  ds_read_b64_tr_b16 v[80:81], v9 offset:49152
  ds_read_b64_tr_b16 v[82:83], v9 offset:49664
  s_waitcnt vmcnt(34) lgkmcnt(6)
  v_mfma_f32_16x16x32_bf16 v[32:35], v[68:71], a[228:231], v[32:35]
  ds_read_b64_tr_b16 v[84:85], v9 offset:53248
  ds_read_b64_tr_b16 v[86:87], v9 offset:53760
  s_waitcnt vmcnt(33) lgkmcnt(6)
  v_mfma_f32_16x16x32_bf16 v[32:35], v[72:75], a[232:235], v[32:35]
  ds_read_b64_tr_b16 v[88:89], v9 offset:57344
  ds_read_b64_tr_b16 v[90:91], v9 offset:57856
  s_waitcnt vmcnt(32) lgkmcnt(6)
  v_mfma_f32_16x16x32_bf16 v[32:35], v[76:79], a[236:239], v[32:35]
  ds_read_b64_tr_b16 v[92:93], v9 offset:61440
  ds_read_b64_tr_b16 v[94:95], v9 offset:61952
  s_waitcnt vmcnt(31)
  v_mfma_f32_16x16x32_bf16 v[36:39], v[64:67], a[240:243], v[36:39]
  ds_read_b64_tr_b16 v[64:65], v10 offset:49152
  ds_read_b64_tr_b16 v[66:67], v10 offset:49664
  s_waitcnt vmcnt(30)
  v_mfma_f32_16x16x32_bf16 v[36:39], v[68:71], a[244:247], v[36:39]
  ds_read_b64_tr_b16 v[68:69], v10 offset:53248
  ds_read_b64_tr_b16 v[70:71], v10 offset:53760
  s_waitcnt vmcnt(29)
  v_mfma_f32_16x16x32_bf16 v[36:39], v[72:75], a[248:251], v[36:39]
  ds_read_b64_tr_b16 v[72:73], v10 offset:57344
  ds_read_b64_tr_b16 v[74:75], v10 offset:57856
  s_waitcnt vmcnt(28)
  v_mfma_f32_16x16x32_bf16 v[36:39], v[76:79], a[252:255], v[36:39]
  ds_read_b64_tr_b16 v[76:77], v10 offset:61440
  ds_read_b64_tr_b16 v[78:79], v10 offset:61952
  s_waitcnt lgkmcnt(14)
  v_mfma_f32_16x16x32_bf16 v[40:43], v[80:83], a[224:227], v[40:43]
  buffer_load_dwordx4 a[64:67], v2, s[8:11], s34 offen offset:0 sc1
  buffer_load_dwordx4 a[68:71], v2, s[8:11], s34 offen offset:1024 sc1
  s_waitcnt lgkmcnt(12)
  v_mfma_f32_16x16x32_bf16 v[40:43], v[84:87], a[228:231], v[40:43]
  buffer_load_dwordx4 a[72:75], v2, s[8:11], s34 offen offset:2048 sc1
  buffer_load_dwordx4 a[76:79], v2, s[8:11], s34 offen offset:3072 sc1
  s_waitcnt lgkmcnt(10)
  v_mfma_f32_16x16x32_bf16 v[40:43], v[88:91], a[232:235], v[40:43]
  buffer_load_dwordx4 a[80:83], v3, s[8:11], s34 offen offset:0 sc1
  buffer_load_dwordx4 a[84:87], v3, s[8:11], s34 offen offset:1024 sc1
  s_waitcnt lgkmcnt(8)
  v_mfma_f32_16x16x32_bf16 v[40:43], v[92:95], a[236:239], v[40:43]
  v_mfma_f32_16x16x32_bf16 v[44:47], v[80:83], a[240:243], v[44:47]
  ds_read_b64_tr_b16 v[80:81], v11 offset:49152
  ds_read_b64_tr_b16 v[82:83], v11 offset:49664
  v_mfma_f32_16x16x32_bf16 v[44:47], v[84:87], a[244:247], v[44:47]
  ds_read_b64_tr_b16 v[84:85], v11 offset:53248
  ds_read_b64_tr_b16 v[86:87], v11 offset:53760
  v_mfma_f32_16x16x32_bf16 v[44:47], v[88:91], a[248:251], v[44:47]
  ds_read_b64_tr_b16 v[88:89], v11 offset:57344
  ds_read_b64_tr_b16 v[90:91], v11 offset:57856
  v_mfma_f32_16x16x32_bf16 v[44:47], v[92:95], a[252:255], v[44:47]
  ds_read_b64_tr_b16 v[92:93], v11 offset:61440
  ds_read_b64_tr_b16 v[94:95], v11 offset:61952
  s_waitcnt lgkmcnt(14)
  v_mfma_f32_16x16x32_bf16 v[48:51], v[64:67], a[224:227], v[48:51]
  buffer_load_dwordx4 a[88:91], v3, s[8:11], s34 offen offset:2048 sc1
  buffer_load_dwordx4 a[92:95], v3, s[8:11], s34 offen offset:3072 sc1
  s_waitcnt lgkmcnt(12)
  v_mfma_f32_16x16x32_bf16 v[48:51], v[68:71], a[228:231], v[48:51]
  s_add_u32 s34, s34, 32768
  s_and_b32 s34, s34, 0xfffff
  s_waitcnt lgkmcnt(10)
  v_mfma_f32_16x16x32_bf16 v[48:51], v[72:75], a[232:235], v[48:51]
  s_barrier
  s_waitcnt lgkmcnt(8)
  v_mfma_f32_16x16x32_bf16 v[48:51], v[76:79], a[236:239], v[48:51]
  v_mfma_f32_16x16x32_bf16 v[52:55], v[64:67], a[240:243], v[52:55]
  v_mfma_f32_16x16x32_bf16 v[52:55], v[68:71], a[244:247], v[52:55]
  s_add_u32 m0, s38, 0
  s_add_u32 s39, s36, 0
  buffer_load_dwordx4 v248, s[12:15], s39 offen lds
  v_mfma_f32_16x16x32_bf16 v[52:55], v[72:75], a[248:251], v[52:55]
  v_xor_b32 v8, 65536, v8
  v_xor_b32 v9, 65536, v9
  v_mfma_f32_16x16x32_bf16 v[52:55], v[76:79], a[252:255], v[52:55]
  v_xor_b32 v10, 65536, v10
  v_xor_b32 v11, 65536, v11
  s_waitcnt lgkmcnt(6)
  v_mfma_f32_16x16x32_bf16 v[56:59], v[80:83], a[224:227], v[56:59]
  s_add_u32 m0, s38, 1024
  s_add_u32 s39, s36, 7168
  buffer_load_dwordx4 v249, s[12:15], s39 offen lds
  s_waitcnt lgkmcnt(4)
  v_mfma_f32_16x16x32_bf16 v[56:59], v[84:87], a[228:231], v[56:59]
  ds_read_b64_tr_b16 v[64:65], v8 offset:0
  ds_read_b64_tr_b16 v[66:67], v8 offset:512
  s_waitcnt lgkmcnt(4)
  v_mfma_f32_16x16x32_bf16 v[56:59], v[88:91], a[232:235], v[56:59]
  ds_read_b64_tr_b16 v[68:69], v8 offset:4096
  ds_read_b64_tr_b16 v[70:71], v8 offset:4608
  s_waitcnt lgkmcnt(4)
  v_mfma_f32_16x16x32_bf16 v[56:59], v[92:95], a[236:239], v[56:59]
  s_add_u32 m0, s38, 2048
  s_add_u32 s39, s36, 14336
  buffer_load_dwordx4 v248, s[12:15], s39 offen lds
  v_mfma_f32_16x16x32_bf16 v[60:63], v[80:83], a[240:243], v[60:63]
  ds_read_b64_tr_b16 v[72:73], v8 offset:8192
  ds_read_b64_tr_b16 v[74:75], v8 offset:8704
  v_mfma_f32_16x16x32_bf16 v[60:63], v[84:87], a[244:247], v[60:63]
  ds_read_b64_tr_b16 v[76:77], v8 offset:12288
  ds_read_b64_tr_b16 v[78:79], v8 offset:12800
  v_mfma_f32_16x16x32_bf16 v[60:63], v[88:91], a[248:251], v[60:63]
  s_add_u32 m0, s38, 3072
  s_add_u32 s39, s36, 21504
  buffer_load_dwordx4 v249, s[12:15], s39 offen lds
  s_add_u32 s36, s36, 114688
  s_cmp_eq_u32 s36, 3670016
  s_cselect_b32 s36, 0, s36
  s_add_u32 s38, s38, 16384
  s_and_b32 s38, s38, 131071
  v_mfma_f32_16x16x32_bf16 v[60:63], v[92:95], a[252:255], v[60:63]
  s_mov_b32 s29, 2
  s_nop 9
OP_LOOP:
  s_waitcnt vmcnt(35) lgkmcnt(6)
  v_mfma_f32_16x16x32_bf16 v[32:35], v[64:67], a[0:3], v[32:35]
  ds_read_b64_tr_b16 v[80:81], v9 offset:0
  ds_read_b64_tr_b16 v[82:83], v9 offset:512
  s_waitcnt vmcnt(34) lgkmcnt(6)
  v_mfma_f32_16x16x32_bf16 v[32:35], v[68:71], a[4:7], v[32:35]
  ds_read_b64_tr_b16 v[84:85], v9 offset:4096
  ds_read_b64_tr_b16 v[86:87], v9 offset:4608
  s_waitcnt vmcnt(33) lgkmcnt(6)
  v_mfma_f32_16x16x32_bf16 v[32:35], v[72:75], a[8:11], v[32:35]
  ds_read_b64_tr_b16 v[88:89], v9 offset:8192
  ds_read_b64_tr_b16 v[90:91], v9 offset:8704
  s_waitcnt vmcnt(32) lgkmcnt(6)
  v_mfma_f32_16x16x32_bf16 v[32:35], v[76:79], a[12:15], v[32:35]
  ds_read_b64_tr_b16 v[92:93], v9 offset:12288
  ds_read_b64_tr_b16 v[94:95], v9 offset:12800
  s_waitcnt vmcnt(31)
  v_mfma_f32_16x16x32_bf16 v[36:39], v[64:67], a[16:19], v[36:39]
  ds_read_b64_tr_b16 v[64:65], v10 offset:0
  ds_read_b64_tr_b16 v[66:67], v10 offset:512
  s_waitcnt vmcnt(30)
  v_mfma_f32_16x16x32_bf16 v[36:39], v[68:71], a[20:23], v[36:39]
  ds_read_b64_tr_b16 v[68:69], v10 offset:4096
  ds_read_b64_tr_b16 v[70:71], v10 offset:4608
  s_waitcnt vmcnt(29)
  v_mfma_f32_16x16x32_bf16 v[36:39], v[72:75], a[24:27], v[36:39]
  ds_read_b64_tr_b16 v[72:73], v10 offset:8192
  ds_read_b64_tr_b16 v[74:75], v10 offset:8704
  s_waitcnt vmcnt(28)
  v_mfma_f32_16x16x32_bf16 v[36:39], v[76:79], a[28:31], v[36:39]
  ds_read_b64_tr_b16 v[76:77], v10 offset:12288
  ds_read_b64_tr_b16 v[78:79], v10 offset:12800
  s_waitcnt lgkmcnt(14)
  v_mfma_f32_16x16x32_bf16 v[40:43], v[80:83], a[0:3], v[40:43]
  buffer_load_dwordx4 a[96:99], v2, s[8:11], s34 offen offset:0 sc1
  buffer_load_dwordx4 a[100:103], v2, s[8:11], s34 offen offset:1024 sc1
  s_waitcnt lgkmcnt(12)
  v_mfma_f32_16x16x32_bf16 v[40:43], v[84:87], a[4:7], v[40:43]
  buffer_load_dwordx4 a[104:107], v2, s[8:11], s34 offen offset:2048 sc1
  buffer_load_dwordx4 a[108:111], v2, s[8:11], s34 offen offset:3072 sc1
  s_waitcnt lgkmcnt(10)
  v_mfma_f32_16x16x32_bf16 v[40:43], v[88:91], a[8:11], v[40:43]
  buffer_load_dwordx4 a[112:115], v3, s[8:11], s34 offen offset:0 sc1
  buffer_load_dwordx4 a[116:119], v3, s[8:11], s34 offen offset:1024 sc1
  s_waitcnt lgkmcnt(8)
  v_mfma_f32_16x16x32_bf16 v[40:43], v[92:95], a[12:15], v[40:43]
  v_mfma_f32_16x16x32_bf16 v[44:47], v[80:83], a[16:19], v[44:47]
  ds_read_b64_tr_b16 v[80:81], v11 offset:0
  ds_read_b64_tr_b16 v[82:83], v11 offset:512
  v_mfma_f32_16x16x32_bf16 v[44:47], v[84:87], a[20:23], v[44:47]
  ds_read_b64_tr_b16 v[84:85], v11 offset:4096
  ds_read_b64_tr_b16 v[86:87], v11 offset:4608
  v_mfma_f32_16x16x32_bf16 v[44:47], v[88:91], a[24:27], v[44:47]
  ds_read_b64_tr_b16 v[88:89], v11 offset:8192
  ds_read_b64_tr_b16 v[90:91], v11 offset:8704
  v_mfma_f32_16x16x32_bf16 v[44:47], v[92:95], a[28:31], v[44:47]
  ds_read_b64_tr_b16 v[92:93], v11 offset:12288
  ds_read_b64_tr_b16 v[94:95], v11 offset:12800
  s_waitcnt lgkmcnt(14)
  v_mfma_f32_16x16x32_bf16 v[48:51], v[64:67], a[0:3], v[48:51]
  buffer_load_dwordx4 a[120:123], v3, s[8:11], s34 offen offset:2048 sc1
  buffer_load_dwordx4 a[124:127], v3, s[8:11], s34 offen offset:3072 sc1
  s_waitcnt lgkmcnt(12)
  v_mfma_f32_16x16x32_bf16 v[48:51], v[68:71], a[4:7], v[48:51]
  s_add_u32 s34, s34, 32768
  s_and_b32 s34, s34, 0xfffff
  s_waitcnt lgkmcnt(10)
  v_mfma_f32_16x16x32_bf16 v[48:51], v[72:75], a[8:11], v[48:51]
  s_barrier
  s_waitcnt lgkmcnt(8)
  v_mfma_f32_16x16x32_bf16 v[48:51], v[76:79], a[12:15], v[48:51]
  v_mfma_f32_16x16x32_bf16 v[52:55], v[64:67], a[16:19], v[52:55]
  ds_read_b64_tr_b16 v[64:65], v8 offset:16384
  ds_read_b64_tr_b16 v[66:67], v8 offset:16896
  v_mfma_f32_16x16x32_bf16 v[52:55], v[68:71], a[20:23], v[52:55]
  s_add_u32 m0, s38, 0
  s_add_u32 s39, s36, 0
  buffer_load_dwordx4 v248, s[12:15], s39 offen lds
  v_mfma_f32_16x16x32_bf16 v[52:55], v[72:75], a[24:27], v[52:55]
  ds_read_b64_tr_b16 v[68:69], v8 offset:20480
  ds_read_b64_tr_b16 v[70:71], v8 offset:20992
  v_mfma_f32_16x16x32_bf16 v[52:55], v[76:79], a[28:31], v[52:55]
  ds_read_b64_tr_b16 v[72:73], v8 offset:24576
  ds_read_b64_tr_b16 v[74:75], v8 offset:25088
  s_waitcnt lgkmcnt(12)
  v_mfma_f32_16x16x32_bf16 v[56:59], v[80:83], a[0:3], v[56:59]
  s_add_u32 m0, s38, 1024
  s_add_u32 s39, s36, 7168
  buffer_load_dwordx4 v249, s[12:15], s39 offen lds
  s_waitcnt lgkmcnt(10)
  v_mfma_f32_16x16x32_bf16 v[56:59], v[84:87], a[4:7], v[56:59]
  ds_read_b64_tr_b16 v[76:77], v8 offset:28672
  ds_read_b64_tr_b16 v[78:79], v8 offset:29184
  s_waitcnt lgkmcnt(10)
  v_mfma_f32_16x16x32_bf16 v[56:59], v[88:91], a[8:11], v[56:59]
  s_waitcnt lgkmcnt(8)
  v_mfma_f32_16x16x32_bf16 v[56:59], v[92:95], a[12:15], v[56:59]
  s_add_u32 m0, s38, 2048
  s_add_u32 s39, s36, 14336
  buffer_load_dwordx4 v248, s[12:15], s39 offen lds
  v_mfma_f32_16x16x32_bf16 v[60:63], v[80:83], a[16:19], v[60:63]
  v_mfma_f32_16x16x32_bf16 v[60:63], v[84:87], a[20:23], v[60:63]
  v_mfma_f32_16x16x32_bf16 v[60:63], v[88:91], a[24:27], v[60:63]
  s_add_u32 m0, s38, 3072
  s_add_u32 s39, s36, 21504
  buffer_load_dwordx4 v249, s[12:15], s39 offen lds
  s_add_u32 s36, s36, 114688
  s_cmp_eq_u32 s36, 3670016
  s_cselect_b32 s36, 0, s36
  s_add_u32 s38, s38, 16384
  s_and_b32 s38, s38, 131071
  v_mfma_f32_16x16x32_bf16 v[60:63], v[92:95], a[28:31], v[60:63]
  s_waitcnt vmcnt(35) lgkmcnt(6)
  v_mfma_f32_16x16x32_bf16 v[32:35], v[64:67], a[32:35], v[32:35]
  ds_read_b64_tr_b16 v[80:81], v9 offset:16384
  ds_read_b64_tr_b16 v[82:83], v9 offset:16896
  s_waitcnt vmcnt(34) lgkmcnt(6)
  v_mfma_f32_16x16x32_bf16 v[32:35], v[68:71], a[36:39], v[32:35]
  ds_read_b64_tr_b16 v[84:85], v9 offset:20480
  ds_read_b64_tr_b16 v[86:87], v9 offset:20992
  s_waitcnt vmcnt(33) lgkmcnt(6)
  v_mfma_f32_16x16x32_bf16 v[32:35], v[72:75], a[40:43], v[32:35]
  ds_read_b64_tr_b16 v[88:89], v9 offset:24576
  ds_read_b64_tr_b16 v[90:91], v9 offset:25088
  s_waitcnt vmcnt(32) lgkmcnt(6)
  v_mfma_f32_16x16x32_bf16 v[32:35], v[76:79], a[44:47], v[32:35]
  ds_read_b64_tr_b16 v[92:93], v9 offset:28672
  ds_read_b64_tr_b16 v[94:95], v9 offset:29184
  s_waitcnt vmcnt(31)
  v_mfma_f32_16x16x32_bf16 v[36:39], v[64:67], a[48:51], v[36:39]
  ds_read_b64_tr_b16 v[64:65], v10 offset:16384
  ds_read_b64_tr_b16 v[66:67], v10 offset:16896
  s_waitcnt vmcnt(30)
  v_mfma_f32_16x16x32_bf16 v[36:39], v[68:71], a[52:55], v[36:39]
  ds_read_b64_tr_b16 v[68:69], v10 offset:20480
  ds_read_b64_tr_b16 v[70:71], v10 offset:20992
  s_waitcnt vmcnt(29)
  v_mfma_f32_16x16x32_bf16 v[36:39], v[72:75], a[56:59], v[36:39]
  ds_read_b64_tr_b16 v[72:73], v10 offset:24576
  ds_read_b64_tr_b16 v[74:75], v10 offset:25088
  s_waitcnt vmcnt(28)
  v_mfma_f32_16x16x32_bf16 v[36:39], v[76:79], a[60:63], v[36:39]
  ds_read_b64_tr_b16 v[76:77], v10 offset:28672
  ds_read_b64_tr_b16 v[78:79], v10 offset:29184
  s_waitcnt lgkmcnt(14)
  v_mfma_f32_16x16x32_bf16 v[40:43], v[80:83], a[32:35], v[40:43]
  buffer_load_dwordx4 a[128:131], v2, s[8:11], s34 offen offset:0 sc1
  buffer_load_dwordx4 a[132:135], v2, s[8:11], s34 offen offset:1024 sc1
  s_waitcnt lgkmcnt(12)
  v_mfma_f32_16x16x32_bf16 v[40:43], v[84:87], a[36:39], v[40:43]
  buffer_load_dwordx4 a[136:139], v2, s[8:11], s34 offen offset:2048 sc1
  buffer_load_dwordx4 a[140:143], v2, s[8:11], s34 offen offset:3072 sc1
  s_waitcnt lgkmcnt(10)
  v_mfma_f32_16x16x32_bf16 v[40:43], v[88:91], a[40:43], v[40:43]
  buffer_load_dwordx4 a[144:147], v3, s[8:11], s34 offen offset:0 sc1
  buffer_load_dwordx4 a[148:151], v3, s[8:11], s34 offen offset:1024 sc1
  s_waitcnt lgkmcnt(8)
  v_mfma_f32_16x16x32_bf16 v[40:43], v[92:95], a[44:47], v[40:43]
  v_mfma_f32_16x16x32_bf16 v[44:47], v[80:83], a[48:51], v[44:47]
  ds_read_b64_tr_b16 v[80:81], v11 offset:16384
  ds_read_b64_tr_b16 v[82:83], v11 offset:16896
  v_mfma_f32_16x16x32_bf16 v[44:47], v[84:87], a[52:55], v[44:47]
  ds_read_b64_tr_b16 v[84:85], v11 offset:20480
  ds_read_b64_tr_b16 v[86:87], v11 offset:20992
  v_mfma_f32_16x16x32_bf16 v[44:47], v[88:91], a[56:59], v[44:47]
  ds_read_b64_tr_b16 v[88:89], v11 offset:24576
  ds_read_b64_tr_b16 v[90:91], v11 offset:25088
  v_mfma_f32_16x16x32_bf16 v[44:47], v[92:95], a[60:63], v[44:47]
  ds_read_b64_tr_b16 v[92:93], v11 offset:28672
  ds_read_b64_tr_b16 v[94:95], v11 offset:29184
  s_waitcnt lgkmcnt(14)
  v_mfma_f32_16x16x32_bf16 v[48:51], v[64:67], a[32:35], v[48:51]
  buffer_load_dwordx4 a[152:155], v3, s[8:11], s34 offen offset:2048 sc1
  buffer_load_dwordx4 a[156:159], v3, s[8:11], s34 offen offset:3072 sc1
  s_waitcnt lgkmcnt(12)
  v_mfma_f32_16x16x32_bf16 v[48:51], v[68:71], a[36:39], v[48:51]
  s_add_u32 s34, s34, 32768
  s_and_b32 s34, s34, 0xfffff
  s_waitcnt lgkmcnt(10)
  v_mfma_f32_16x16x32_bf16 v[48:51], v[72:75], a[40:43], v[48:51]
  s_barrier
  s_waitcnt lgkmcnt(8)
  v_mfma_f32_16x16x32_bf16 v[48:51], v[76:79], a[44:47], v[48:51]
  v_mfma_f32_16x16x32_bf16 v[52:55], v[64:67], a[48:51], v[52:55]
  ds_read_b64_tr_b16 v[64:65], v8 offset:32768
  ds_read_b64_tr_b16 v[66:67], v8 offset:33280
  v_mfma_f32_16x16x32_bf16 v[52:55], v[68:71], a[52:55], v[52:55]
  s_add_u32 m0, s38, 0
  s_add_u32 s39, s36, 0
  buffer_load_dwordx4 v248, s[12:15], s39 offen lds
  v_mfma_f32_16x16x32_bf16 v[52:55], v[72:75], a[56:59], v[52:55]
  ds_read_b64_tr_b16 v[68:69], v8 offset:36864
  ds_read_b64_tr_b16 v[70:71], v8 offset:37376
  v_mfma_f32_16x16x32_bf16 v[52:55], v[76:79], a[60:63], v[52:55]
  ds_read_b64_tr_b16 v[72:73], v8 offset:40960
  ds_read_b64_tr_b16 v[74:75], v8 offset:41472
  s_waitcnt lgkmcnt(12)
  v_mfma_f32_16x16x32_bf16 v[56:59], v[80:83], a[32:35], v[56:59]
  s_add_u32 m0, s38, 1024
  s_add_u32 s39, s36, 7168
  buffer_load_dwordx4 v249, s[12:15], s39 offen lds
  s_waitcnt lgkmcnt(10)
  v_mfma_f32_16x16x32_bf16 v[56:59], v[84:87], a[36:39], v[56:59]
  ds_read_b64_tr_b16 v[76:77], v8 offset:45056
  ds_read_b64_tr_b16 v[78:79], v8 offset:45568
  s_waitcnt lgkmcnt(10)
  v_mfma_f32_16x16x32_bf16 v[56:59], v[88:91], a[40:43], v[56:59]
  s_waitcnt lgkmcnt(8)
  v_mfma_f32_16x16x32_bf16 v[56:59], v[92:95], a[44:47], v[56:59]
  s_add_u32 m0, s38, 2048
  s_add_u32 s39, s36, 14336
  buffer_load_dwordx4 v248, s[12:15], s39 offen lds
  v_mfma_f32_16x16x32_bf16 v[60:63], v[80:83], a[48:51], v[60:63]
  v_mfma_f32_16x16x32_bf16 v[60:63], v[84:87], a[52:55], v[60:63]
  v_mfma_f32_16x16x32_bf16 v[60:63], v[88:91], a[56:59], v[60:63]
  s_add_u32 m0, s38, 3072
  s_add_u32 s39, s36, 21504
  buffer_load_dwordx4 v249, s[12:15], s39 offen lds
  s_add_u32 s36, s36, 114688
  s_cmp_eq_u32 s36, 3670016
  s_cselect_b32 s36, 0, s36
  s_add_u32 s38, s38, 16384
  s_and_b32 s38, s38, 131071
  v_mfma_f32_16x16x32_bf16 v[60:63], v[92:95], a[60:63], v[60:63]
  s_waitcnt vmcnt(35) lgkmcnt(6)
  v_mfma_f32_16x16x32_bf16 v[32:35], v[64:67], a[64:67], v[32:35]
  ds_read_b64_tr_b16 v[80:81], v9 offset:32768
  ds_read_b64_tr_b16 v[82:83], v9 offset:33280
  s_waitcnt vmcnt(34) lgkmcnt(6)
  v_mfma_f32_16x16x32_bf16 v[32:35], v[68:71], a[68:71], v[32:35]
  ds_read_b64_tr_b16 v[84:85], v9 offset:36864
  ds_read_b64_tr_b16 v[86:87], v9 offset:37376
  s_waitcnt vmcnt(33) lgkmcnt(6)
  v_mfma_f32_16x16x32_bf16 v[32:35], v[72:75], a[72:75], v[32:35]
  ds_read_b64_tr_b16 v[88:89], v9 offset:40960
  ds_read_b64_tr_b16 v[90:91], v9 offset:41472
  s_waitcnt vmcnt(32) lgkmcnt(6)
  v_mfma_f32_16x16x32_bf16 v[32:35], v[76:79], a[76:79], v[32:35]
  ds_read_b64_tr_b16 v[92:93], v9 offset:45056
  ds_read_b64_tr_b16 v[94:95], v9 offset:45568
  s_waitcnt vmcnt(31)
  v_mfma_f32_16x16x32_bf16 v[36:39], v[64:67], a[80:83], v[36:39]
  ds_read_b64_tr_b16 v[64:65], v10 offset:32768
  ds_read_b64_tr_b16 v[66:67], v10 offset:33280
  s_waitcnt vmcnt(30)
  v_mfma_f32_16x16x32_bf16 v[36:39], v[68:71], a[84:87], v[36:39]
  ds_read_b64_tr_b16 v[68:69], v10 offset:36864
  ds_read_b64_tr_b16 v[70:71], v10 offset:37376
  s_waitcnt vmcnt(29)
  v_mfma_f32_16x16x32_bf16 v[36:39], v[72:75], a[88:91], v[36:39]
  ds_read_b64_tr_b16 v[72:73], v10 offset:40960
  ds_read_b64_tr_b16 v[74:75], v10 offset:41472
  s_waitcnt vmcnt(28)
  v_mfma_f32_16x16x32_bf16 v[36:39], v[76:79], a[92:95], v[36:39]
  ds_read_b64_tr_b16 v[76:77], v10 offset:45056
  ds_read_b64_tr_b16 v[78:79], v10 offset:45568
  s_waitcnt lgkmcnt(14)
  v_mfma_f32_16x16x32_bf16 v[40:43], v[80:83], a[64:67], v[40:43]
  buffer_load_dwordx4 a[160:163], v2, s[8:11], s34 offen offset:0 sc1
  buffer_load_dwordx4 a[164:167], v2, s[8:11], s34 offen offset:1024 sc1
  s_waitcnt lgkmcnt(12)
  v_mfma_f32_16x16x32_bf16 v[40:43], v[84:87], a[68:71], v[40:43]
  buffer_load_dwordx4 a[168:171], v2, s[8:11], s34 offen offset:2048 sc1
  buffer_load_dwordx4 a[172:175], v2, s[8:11], s34 offen offset:3072 sc1
  s_waitcnt lgkmcnt(10)
  v_mfma_f32_16x16x32_bf16 v[40:43], v[88:91], a[72:75], v[40:43]
  buffer_load_dwordx4 a[176:179], v3, s[8:11], s34 offen offset:0 sc1
  buffer_load_dwordx4 a[180:183], v3, s[8:11], s34 offen offset:1024 sc1
  s_waitcnt lgkmcnt(8)
  v_mfma_f32_16x16x32_bf16 v[40:43], v[92:95], a[76:79], v[40:43]
  v_mfma_f32_16x16x32_bf16 v[44:47], v[80:83], a[80:83], v[44:47]
  ds_read_b64_tr_b16 v[80:81], v11 offset:32768
  ds_read_b64_tr_b16 v[82:83], v11 offset:33280
  v_mfma_f32_16x16x32_bf16 v[44:47], v[84:87], a[84:87], v[44:47]
  ds_read_b64_tr_b16 v[84:85], v11 offset:36864
  ds_read_b64_tr_b16 v[86:87], v11 offset:37376
  v_mfma_f32_16x16x32_bf16 v[44:47], v[88:91], a[88:91], v[44:47]
  ds_read_b64_tr_b16 v[88:89], v11 offset:40960
  ds_read_b64_tr_b16 v[90:91], v11 offset:41472
  v_mfma_f32_16x16x32_bf16 v[44:47], v[92:95], a[92:95], v[44:47]
  ds_read_b64_tr_b16 v[92:93], v11 offset:45056
  ds_read_b64_tr_b16 v[94:95], v11 offset:45568
  s_waitcnt lgkmcnt(14)
  v_mfma_f32_16x16x32_bf16 v[48:51], v[64:67], a[64:67], v[48:51]
  buffer_load_dwordx4 a[184:187], v3, s[8:11], s34 offen offset:2048 sc1
  buffer_load_dwordx4 a[188:191], v3, s[8:11], s34 offen offset:3072 sc1
  s_waitcnt lgkmcnt(12)
  v_mfma_f32_16x16x32_bf16 v[48:51], v[68:71], a[68:71], v[48:51]
  s_add_u32 s34, s34, 32768
  s_and_b32 s34, s34, 0xfffff
  s_waitcnt lgkmcnt(10)
  v_mfma_f32_16x16x32_bf16 v[48:51], v[72:75], a[72:75], v[48:51]
  s_barrier
  s_waitcnt lgkmcnt(8)
  v_mfma_f32_16x16x32_bf16 v[48:51], v[76:79], a[76:79], v[48:51]
  v_mfma_f32_16x16x32_bf16 v[52:55], v[64:67], a[80:83], v[52:55]
  ds_read_b64_tr_b16 v[64:65], v8 offset:49152
  ds_read_b64_tr_b16 v[66:67], v8 offset:49664
  v_mfma_f32_16x16x32_bf16 v[52:55], v[68:71], a[84:87], v[52:55]
  s_add_u32 m0, s38, 0
  s_add_u32 s39, s36, 0
  buffer_load_dwordx4 v248, s[12:15], s39 offen lds
  v_mfma_f32_16x16x32_bf16 v[52:55], v[72:75], a[88:91], v[52:55]
  ds_read_b64_tr_b16 v[68:69], v8 offset:53248
  ds_read_b64_tr_b16 v[70:71], v8 offset:53760
  v_mfma_f32_16x16x32_bf16 v[52:55], v[76:79], a[92:95], v[52:55]
  ds_read_b64_tr_b16 v[72:73], v8 offset:57344
  ds_read_b64_tr_b16 v[74:75], v8 offset:57856
  s_waitcnt lgkmcnt(12)
  v_mfma_f32_16x16x32_bf16 v[56:59], v[80:83], a[64:67], v[56:59]
  s_add_u32 m0, s38, 1024
  s_add_u32 s39, s36, 7168
  buffer_load_dwordx4 v249, s[12:15], s39 offen lds
  s_waitcnt lgkmcnt(10)
  v_mfma_f32_16x16x32_bf16 v[56:59], v[84:87], a[68:71], v[56:59]
  ds_read_b64_tr_b16 v[76:77], v8 offset:61440
  ds_read_b64_tr_b16 v[78:79], v8 offset:61952
  s_waitcnt lgkmcnt(10)
  v_mfma_f32_16x16x32_bf16 v[56:59], v[88:91], a[72:75], v[56:59]
  s_waitcnt lgkmcnt(8)
  v_mfma_f32_16x16x32_bf16 v[56:59], v[92:95], a[76:79], v[56:59]
  s_add_u32 m0, s38, 2048
  s_add_u32 s39, s36, 14336
  buffer_load_dwordx4 v248, s[12:15], s39 offen lds
  v_mfma_f32_16x16x32_bf16 v[60:63], v[80:83], a[80:83], v[60:63]
  v_mfma_f32_16x16x32_bf16 v[60:63], v[84:87], a[84:87], v[60:63]
  v_mfma_f32_16x16x32_bf16 v[60:63], v[88:91], a[88:91], v[60:63]
  s_add_u32 m0, s38, 3072
  s_add_u32 s39, s36, 21504
  buffer_load_dwordx4 v249, s[12:15], s39 offen lds
  s_add_u32 s36, s36, 114688
  s_cmp_eq_u32 s36, 3670016
  s_cselect_b32 s36, 0, s36
  s_add_u32 s38, s38, 16384
  s_and_b32 s38, s38, 131071
  v_mfma_f32_16x16x32_bf16 v[60:63], v[92:95], a[92:95], v[60:63]
  s_waitcnt vmcnt(35) lgkmcnt(6)
  v_mfma_f32_16x16x32_bf16 v[32:35], v[64:67], a[96:99], v[32:35]
  ds_read_b64_tr_b16 v[80:81], v9 offset:49152
  ds_read_b64_tr_b16 v[82:83], v9 offset:49664
  s_waitcnt vmcnt(34) lgkmcnt(6)
  v_mfma_f32_16x16x32_bf16 v[32:35], v[68:71], a[100:103], v[32:35]
  ds_read_b64_tr_b16 v[84:85], v9 offset:53248
  ds_read_b64_tr_b16 v[86:87], v9 offset:53760
  s_waitcnt vmcnt(33) lgkmcnt(6)
  v_mfma_f32_16x16x32_bf16 v[32:35], v[72:75], a[104:107], v[32:35]
  ds_read_b64_tr_b16 v[88:89], v9 offset:57344
  ds_read_b64_tr_b16 v[90:91], v9 offset:57856
  s_waitcnt vmcnt(32) lgkmcnt(6)
  v_mfma_f32_16x16x32_bf16 v[32:35], v[76:79], a[108:111], v[32:35]
  ds_read_b64_tr_b16 v[92:93], v9 offset:61440
  ds_read_b64_tr_b16 v[94:95], v9 offset:61952
  s_waitcnt vmcnt(31)
  v_mfma_f32_16x16x32_bf16 v[36:39], v[64:67], a[112:115], v[36:39]
  ds_read_b64_tr_b16 v[64:65], v10 offset:49152
  ds_read_b64_tr_b16 v[66:67], v10 offset:49664
  s_waitcnt vmcnt(30)
  v_mfma_f32_16x16x32_bf16 v[36:39], v[68:71], a[116:119], v[36:39]
  ds_read_b64_tr_b16 v[68:69], v10 offset:53248
  ds_read_b64_tr_b16 v[70:71], v10 offset:53760
  s_waitcnt vmcnt(29)
  v_mfma_f32_16x16x32_bf16 v[36:39], v[72:75], a[120:123], v[36:39]
  ds_read_b64_tr_b16 v[72:73], v10 offset:57344
  ds_read_b64_tr_b16 v[74:75], v10 offset:57856
  s_waitcnt vmcnt(28)
  v_mfma_f32_16x16x32_bf16 v[36:39], v[76:79], a[124:127], v[36:39]
  ds_read_b64_tr_b16 v[76:77], v10 offset:61440
  ds_read_b64_tr_b16 v[78:79], v10 offset:61952
  s_waitcnt lgkmcnt(14)
  v_mfma_f32_16x16x32_bf16 v[40:43], v[80:83], a[96:99], v[40:43]
  buffer_load_dwordx4 a[192:195], v2, s[8:11], s34 offen offset:0 sc1
  buffer_load_dwordx4 a[196:199], v2, s[8:11], s34 offen offset:1024 sc1
  s_waitcnt lgkmcnt(12)
  v_mfma_f32_16x16x32_bf16 v[40:43], v[84:87], a[100:103], v[40:43]
  buffer_load_dwordx4 a[200:203], v2, s[8:11], s34 offen offset:2048 sc1
  buffer_load_dwordx4 a[204:207], v2, s[8:11], s34 offen offset:3072 sc1
  s_waitcnt lgkmcnt(10)
  v_mfma_f32_16x16x32_bf16 v[40:43], v[88:91], a[104:107], v[40:43]
  buffer_load_dwordx4 a[208:211], v3, s[8:11], s34 offen offset:0 sc1
  buffer_load_dwordx4 a[212:215], v3, s[8:11], s34 offen offset:1024 sc1
  s_waitcnt lgkmcnt(8)
  v_mfma_f32_16x16x32_bf16 v[40:43], v[92:95], a[108:111], v[40:43]
  v_mfma_f32_16x16x32_bf16 v[44:47], v[80:83], a[112:115], v[44:47]
  ds_read_b64_tr_b16 v[80:81], v11 offset:49152
  ds_read_b64_tr_b16 v[82:83], v11 offset:49664
  v_mfma_f32_16x16x32_bf16 v[44:47], v[84:87], a[116:119], v[44:47]
  ds_read_b64_tr_b16 v[84:85], v11 offset:53248
  ds_read_b64_tr_b16 v[86:87], v11 offset:53760
  v_mfma_f32_16x16x32_bf16 v[44:47], v[88:91], a[120:123], v[44:47]
  ds_read_b64_tr_b16 v[88:89], v11 offset:57344
  ds_read_b64_tr_b16 v[90:91], v11 offset:57856
  v_mfma_f32_16x16x32_bf16 v[44:47], v[92:95], a[124:127], v[44:47]
  ds_read_b64_tr_b16 v[92:93], v11 offset:61440
  ds_read_b64_tr_b16 v[94:95], v11 offset:61952
  s_waitcnt lgkmcnt(14)
  v_mfma_f32_16x16x32_bf16 v[48:51], v[64:67], a[96:99], v[48:51]
  buffer_load_dwordx4 a[216:219], v3, s[8:11], s34 offen offset:2048 sc1
  buffer_load_dwordx4 a[220:223], v3, s[8:11], s34 offen offset:3072 sc1
  s_waitcnt lgkmcnt(12)
  v_mfma_f32_16x16x32_bf16 v[48:51], v[68:71], a[100:103], v[48:51]
  s_add_u32 s34, s34, 32768
  s_and_b32 s34, s34, 0xfffff
  s_waitcnt lgkmcnt(10)
  v_mfma_f32_16x16x32_bf16 v[48:51], v[72:75], a[104:107], v[48:51]
  s_barrier
  s_waitcnt lgkmcnt(8)
  v_mfma_f32_16x16x32_bf16 v[48:51], v[76:79], a[108:111], v[48:51]
  v_mfma_f32_16x16x32_bf16 v[52:55], v[64:67], a[112:115], v[52:55]
  v_mfma_f32_16x16x32_bf16 v[52:55], v[68:71], a[116:119], v[52:55]
  s_add_u32 m0, s38, 0
  s_add_u32 s39, s36, 0
  buffer_load_dwordx4 v248, s[12:15], s39 offen lds
  v_mfma_f32_16x16x32_bf16 v[52:55], v[72:75], a[120:123], v[52:55]
  v_xor_b32 v8, 65536, v8
  v_xor_b32 v9, 65536, v9
  v_mfma_f32_16x16x32_bf16 v[52:55], v[76:79], a[124:127], v[52:55]
  v_xor_b32 v10, 65536, v10
  v_xor_b32 v11, 65536, v11
  s_waitcnt lgkmcnt(6)
  v_mfma_f32_16x16x32_bf16 v[56:59], v[80:83], a[96:99], v[56:59]
  s_add_u32 m0, s38, 1024
  s_add_u32 s39, s36, 7168
  buffer_load_dwordx4 v249, s[12:15], s39 offen lds
  s_waitcnt lgkmcnt(4)
  v_mfma_f32_16x16x32_bf16 v[56:59], v[84:87], a[100:103], v[56:59]
  ds_read_b64_tr_b16 v[64:65], v8 offset:0
  ds_read_b64_tr_b16 v[66:67], v8 offset:512
  s_waitcnt lgkmcnt(4)
  v_mfma_f32_16x16x32_bf16 v[56:59], v[88:91], a[104:107], v[56:59]
  ds_read_b64_tr_b16 v[68:69], v8 offset:4096
  ds_read_b64_tr_b16 v[70:71], v8 offset:4608
  s_waitcnt lgkmcnt(4)
  v_mfma_f32_16x16x32_bf16 v[56:59], v[92:95], a[108:111], v[56:59]
  s_add_u32 m0, s38, 2048
  s_add_u32 s39, s36, 14336
  buffer_load_dwordx4 v248, s[12:15], s39 offen lds
  v_mfma_f32_16x16x32_bf16 v[60:63], v[80:83], a[112:115], v[60:63]
  ds_read_b64_tr_b16 v[72:73], v8 offset:8192
  ds_read_b64_tr_b16 v[74:75], v8 offset:8704
  v_mfma_f32_16x16x32_bf16 v[60:63], v[84:87], a[116:119], v[60:63]
  ds_read_b64_tr_b16 v[76:77], v8 offset:12288
  ds_read_b64_tr_b16 v[78:79], v8 offset:12800
  v_mfma_f32_16x16x32_bf16 v[60:63], v[88:91], a[120:123], v[60:63]
  s_add_u32 m0, s38, 3072
  s_add_u32 s39, s36, 21504
  buffer_load_dwordx4 v249, s[12:15], s39 offen lds
  s_add_u32 s36, s36, 114688
  s_cmp_eq_u32 s36, 3670016
  s_cselect_b32 s36, 0, s36
  s_add_u32 s38, s38, 16384
  s_and_b32 s38, s38, 131071
  v_mfma_f32_16x16x32_bf16 v[60:63], v[92:95], a[124:127], v[60:63]
  s_waitcnt vmcnt(35) lgkmcnt(6)
  v_mfma_f32_16x16x32_bf16 v[32:35], v[64:67], a[128:131], v[32:35]
  ds_read_b64_tr_b16 v[80:81], v9 offset:0
  ds_read_b64_tr_b16 v[82:83], v9 offset:512
  s_waitcnt vmcnt(34) lgkmcnt(6)
  v_mfma_f32_16x16x32_bf16 v[32:35], v[68:71], a[132:135], v[32:35]
  ds_read_b64_tr_b16 v[84:85], v9 offset:4096
  ds_read_b64_tr_b16 v[86:87], v9 offset:4608
  s_waitcnt vmcnt(33) lgkmcnt(6)
  v_mfma_f32_16x16x32_bf16 v[32:35], v[72:75], a[136:139], v[32:35]
  ds_read_b64_tr_b16 v[88:89], v9 offset:8192
  ds_read_b64_tr_b16 v[90:91], v9 offset:8704
  s_waitcnt vmcnt(32) lgkmcnt(6)
  v_mfma_f32_16x16x32_bf16 v[32:35], v[76:79], a[140:143], v[32:35]
  ds_read_b64_tr_b16 v[92:93], v9 offset:12288
  ds_read_b64_tr_b16 v[94:95], v9 offset:12800
  s_waitcnt vmcnt(31)
  v_mfma_f32_16x16x32_bf16 v[36:39], v[64:67], a[144:147], v[36:39]
  ds_read_b64_tr_b16 v[64:65], v10 offset:0
  ds_read_b64_tr_b16 v[66:67], v10 offset:512
  s_waitcnt vmcnt(30)
  v_mfma_f32_16x16x32_bf16 v[36:39], v[68:71], a[148:151], v[36:39]
  ds_read_b64_tr_b16 v[68:69], v10 offset:4096
  ds_read_b64_tr_b16 v[70:71], v10 offset:4608
  s_waitcnt vmcnt(29)
  v_mfma_f32_16x16x32_bf16 v[36:39], v[72:75], a[152:155], v[36:39]
  ds_read_b64_tr_b16 v[72:73], v10 offset:8192
  ds_read_b64_tr_b16 v[74:75], v10 offset:8704
  s_waitcnt vmcnt(28)
  v_mfma_f32_16x16x32_bf16 v[36:39], v[76:79], a[156:159], v[36:39]
  ds_read_b64_tr_b16 v[76:77], v10 offset:12288
  ds_read_b64_tr_b16 v[78:79], v10 offset:12800
  s_waitcnt lgkmcnt(14)
  v_mfma_f32_16x16x32_bf16 v[40:43], v[80:83], a[128:131], v[40:43]
  buffer_load_dwordx4 a[224:227], v2, s[8:11], s34 offen offset:0 sc1
  buffer_load_dwordx4 a[228:231], v2, s[8:11], s34 offen offset:1024 sc1
  s_waitcnt lgkmcnt(12)
  v_mfma_f32_16x16x32_bf16 v[40:43], v[84:87], a[132:135], v[40:43]
  buffer_load_dwordx4 a[232:235], v2, s[8:11], s34 offen offset:2048 sc1
  buffer_load_dwordx4 a[236:239], v2, s[8:11], s34 offen offset:3072 sc1
  s_waitcnt lgkmcnt(10)
  v_mfma_f32_16x16x32_bf16 v[40:43], v[88:91], a[136:139], v[40:43]
  buffer_load_dwordx4 a[240:243], v3, s[8:11], s34 offen offset:0 sc1
  buffer_load_dwordx4 a[244:247], v3, s[8:11], s34 offen offset:1024 sc1
  s_waitcnt lgkmcnt(8)
  v_mfma_f32_16x16x32_bf16 v[40:43], v[92:95], a[140:143], v[40:43]
  v_mfma_f32_16x16x32_bf16 v[44:47], v[80:83], a[144:147], v[44:47]
  ds_read_b64_tr_b16 v[80:81], v11 offset:0
  ds_read_b64_tr_b16 v[82:83], v11 offset:512
  v_mfma_f32_16x16x32_bf16 v[44:47], v[84:87], a[148:151], v[44:47]
  ds_read_b64_tr_b16 v[84:85], v11 offset:4096
  ds_read_b64_tr_b16 v[86:87], v11 offset:4608
  v_mfma_f32_16x16x32_bf16 v[44:47], v[88:91], a[152:155], v[44:47]
  ds_read_b64_tr_b16 v[88:89], v11 offset:8192
  ds_read_b64_tr_b16 v[90:91], v11 offset:8704
  v_mfma_f32_16x16x32_bf16 v[44:47], v[92:95], a[156:159], v[44:47]
  ds_read_b64_tr_b16 v[92:93], v11 offset:12288
  ds_read_b64_tr_b16 v[94:95], v11 offset:12800
  s_waitcnt lgkmcnt(14)
  v_mfma_f32_16x16x32_bf16 v[48:51], v[64:67], a[128:131], v[48:51]
  buffer_load_dwordx4 a[248:251], v3, s[8:11], s34 offen offset:2048 sc1
  buffer_load_dwordx4 a[252:255], v3, s[8:11], s34 offen offset:3072 sc1
  s_waitcnt lgkmcnt(12)
  v_mfma_f32_16x16x32_bf16 v[48:51], v[68:71], a[132:135], v[48:51]
  s_add_u32 s34, s34, 32768
  s_and_b32 s34, s34, 0xfffff
  s_waitcnt lgkmcnt(10)
  v_mfma_f32_16x16x32_bf16 v[48:51], v[72:75], a[136:139], v[48:51]
  s_cmp_lg_u32 s29, 2
  s_cbranch_scc1 OPM4
  s_cmp_lg_u32 s28, 0
  s_cbranch_scc1 OP5_WAITED
  s_mov_b32 s6, 200000
  s_mov_b64 exec, 1
  s_nop 1
OP5_POLL:
  buffer_load_dword v14, v13, s[60:63], s40 offen sc1
  buffer_load_dword v15, v13, s[60:63], s41 offen sc1
  s_waitcnt vmcnt(0)
  v_min_u32 v14, v14, v15
  s_nop 1
  v_readfirstlane_b32 s3, v14
  s_nop 3
  s_cmp_ge_u32 s3, 8
  s_cbranch_scc1 OP5_POLLED
  s_sleep 4
  s_sub_u32 s6, s6, 1
  s_cmp_lg_u32 s6, 0
  s_cbranch_scc1 OP5_POLL
OP5_POLLED:
  s_mov_b64 exec, -1
  s_nop 4
OP5_WAITED:
OPM4:
  s_barrier
  s_waitcnt lgkmcnt(8)
  v_mfma_f32_16x16x32_bf16 v[48:51], v[76:79], a[140:143], v[48:51]
  v_mfma_f32_16x16x32_bf16 v[52:55], v[64:67], a[144:147], v[52:55]
  ds_read_b64_tr_b16 v[64:65], v8 offset:16384
  ds_read_b64_tr_b16 v[66:67], v8 offset:16896
  v_mfma_f32_16x16x32_bf16 v[52:55], v[68:71], a[148:151], v[52:55]
  s_add_u32 m0, s38, 0
  s_add_u32 s39, s36, 0
  buffer_load_dwordx4 v248, s[12:15], s39 offen lds
  v_mfma_f32_16x16x32_bf16 v[52:55], v[72:75], a[152:155], v[52:55]
  ds_read_b64_tr_b16 v[68:69], v8 offset:20480
  ds_read_b64_tr_b16 v[70:71], v8 offset:20992
  v_mfma_f32_16x16x32_bf16 v[52:55], v[76:79], a[156:159], v[52:55]
  ds_read_b64_tr_b16 v[72:73], v8 offset:24576
  ds_read_b64_tr_b16 v[74:75], v8 offset:25088
  s_waitcnt lgkmcnt(12)
  v_mfma_f32_16x16x32_bf16 v[56:59], v[80:83], a[128:131], v[56:59]
  s_add_u32 m0, s38, 1024
  s_add_u32 s39, s36, 7168
  buffer_load_dwordx4 v249, s[12:15], s39 offen lds
  s_waitcnt lgkmcnt(10)
  v_mfma_f32_16x16x32_bf16 v[56:59], v[84:87], a[132:135], v[56:59]
  ds_read_b64_tr_b16 v[76:77], v8 offset:28672
  ds_read_b64_tr_b16 v[78:79], v8 offset:29184
  s_waitcnt lgkmcnt(10)
  v_mfma_f32_16x16x32_bf16 v[56:59], v[88:91], a[136:139], v[56:59]
  s_waitcnt lgkmcnt(8)
  v_mfma_f32_16x16x32_bf16 v[56:59], v[92:95], a[140:143], v[56:59]
  s_add_u32 m0, s38, 2048
  s_add_u32 s39, s36, 14336
  buffer_load_dwordx4 v248, s[12:15], s39 offen lds
  v_mfma_f32_16x16x32_bf16 v[60:63], v[80:83], a[144:147], v[60:63]
  v_mfma_f32_16x16x32_bf16 v[60:63], v[84:87], a[148:151], v[60:63]
  v_mfma_f32_16x16x32_bf16 v[60:63], v[88:91], a[152:155], v[60:63]
  s_add_u32 m0, s38, 3072
  s_add_u32 s39, s36, 21504
  buffer_load_dwordx4 v249, s[12:15], s39 offen lds
  s_add_u32 s36, s36, 114688
  s_cmp_eq_u32 s36, 3670016
  s_cselect_b32 s36, 0, s36
  s_add_u32 s38, s38, 16384
  s_and_b32 s38, s38, 131071
  v_mfma_f32_16x16x32_bf16 v[60:63], v[92:95], a[156:159], v[60:63]
  s_waitcnt vmcnt(35) lgkmcnt(6)
  v_mfma_f32_16x16x32_bf16 v[32:35], v[64:67], a[160:163], v[32:35]
  ds_read_b64_tr_b16 v[80:81], v9 offset:16384
  ds_read_b64_tr_b16 v[82:83], v9 offset:16896
  s_waitcnt vmcnt(34) lgkmcnt(6)
  v_mfma_f32_16x16x32_bf16 v[32:35], v[68:71], a[164:167], v[32:35]
  ds_read_b64_tr_b16 v[84:85], v9 offset:20480
  ds_read_b64_tr_b16 v[86:87], v9 offset:20992
  s_waitcnt vmcnt(33) lgkmcnt(6)
  v_mfma_f32_16x16x32_bf16 v[32:35], v[72:75], a[168:171], v[32:35]
  ds_read_b64_tr_b16 v[88:89], v9 offset:24576
  ds_read_b64_tr_b16 v[90:91], v9 offset:25088
  s_waitcnt vmcnt(32) lgkmcnt(6)
  v_mfma_f32_16x16x32_bf16 v[32:35], v[76:79], a[172:175], v[32:35]
  ds_read_b64_tr_b16 v[92:93], v9 offset:28672
  ds_read_b64_tr_b16 v[94:95], v9 offset:29184
  s_waitcnt vmcnt(31)
  v_mfma_f32_16x16x32_bf16 v[36:39], v[64:67], a[176:179], v[36:39]
  ds_read_b64_tr_b16 v[64:65], v10 offset:16384
  ds_read_b64_tr_b16 v[66:67], v10 offset:16896
  s_waitcnt vmcnt(30)
  v_mfma_f32_16x16x32_bf16 v[36:39], v[68:71], a[180:183], v[36:39]
  ds_read_b64_tr_b16 v[68:69], v10 offset:20480
  ds_read_b64_tr_b16 v[70:71], v10 offset:20992
  s_waitcnt vmcnt(29)
  v_mfma_f32_16x16x32_bf16 v[36:39], v[72:75], a[184:187], v[36:39]
  ds_read_b64_tr_b16 v[72:73], v10 offset:24576
  ds_read_b64_tr_b16 v[74:75], v10 offset:25088
  s_waitcnt vmcnt(28)
  v_mfma_f32_16x16x32_bf16 v[36:39], v[76:79], a[188:191], v[36:39]
  ds_read_b64_tr_b16 v[76:77], v10 offset:28672
  ds_read_b64_tr_b16 v[78:79], v10 offset:29184
  s_waitcnt lgkmcnt(14)
  v_mfma_f32_16x16x32_bf16 v[40:43], v[80:83], a[160:163], v[40:43]
  buffer_load_dwordx4 a[0:3], v2, s[8:11], s34 offen offset:0 sc1
  buffer_load_dwordx4 a[4:7], v2, s[8:11], s34 offen offset:1024 sc1
  s_waitcnt lgkmcnt(12)
  v_mfma_f32_16x16x32_bf16 v[40:43], v[84:87], a[164:167], v[40:43]
  buffer_load_dwordx4 a[8:11], v2, s[8:11], s34 offen offset:2048 sc1
  buffer_load_dwordx4 a[12:15], v2, s[8:11], s34 offen offset:3072 sc1
  s_waitcnt lgkmcnt(10)
  v_mfma_f32_16x16x32_bf16 v[40:43], v[88:91], a[168:171], v[40:43]
  buffer_load_dwordx4 a[16:19], v3, s[8:11], s34 offen offset:0 sc1
  buffer_load_dwordx4 a[20:23], v3, s[8:11], s34 offen offset:1024 sc1
  s_waitcnt lgkmcnt(8)
  v_mfma_f32_16x16x32_bf16 v[40:43], v[92:95], a[172:175], v[40:43]
  v_mfma_f32_16x16x32_bf16 v[44:47], v[80:83], a[176:179], v[44:47]
  ds_read_b64_tr_b16 v[80:81], v11 offset:16384
  ds_read_b64_tr_b16 v[82:83], v11 offset:16896
  v_mfma_f32_16x16x32_bf16 v[44:47], v[84:87], a[180:183], v[44:47]
  ds_read_b64_tr_b16 v[84:85], v11 offset:20480
  ds_read_b64_tr_b16 v[86:87], v11 offset:20992
  v_mfma_f32_16x16x32_bf16 v[44:47], v[88:91], a[184:187], v[44:47]
  ds_read_b64_tr_b16 v[88:89], v11 offset:24576
  ds_read_b64_tr_b16 v[90:91], v11 offset:25088
  v_mfma_f32_16x16x32_bf16 v[44:47], v[92:95], a[188:191], v[44:47]
  ds_read_b64_tr_b16 v[92:93], v11 offset:28672
  ds_read_b64_tr_b16 v[94:95], v11 offset:29184
  s_waitcnt lgkmcnt(14)
  v_mfma_f32_16x16x32_bf16 v[48:51], v[64:67], a[160:163], v[48:51]
  buffer_load_dwordx4 a[24:27], v3, s[8:11], s34 offen offset:2048 sc1
  buffer_load_dwordx4 a[28:31], v3, s[8:11], s34 offen offset:3072 sc1
  s_waitcnt lgkmcnt(12)
  v_mfma_f32_16x16x32_bf16 v[48:51], v[68:71], a[164:167], v[48:51]
  s_add_u32 s34, s34, 32768
  s_and_b32 s34, s34, 0xfffff
  s_waitcnt lgkmcnt(10)
  v_mfma_f32_16x16x32_bf16 v[48:51], v[72:75], a[168:171], v[48:51]
  s_barrier
  s_waitcnt lgkmcnt(8)
  v_mfma_f32_16x16x32_bf16 v[48:51], v[76:79], a[172:175], v[48:51]
  v_mfma_f32_16x16x32_bf16 v[52:55], v[64:67], a[176:179], v[52:55]
  ds_read_b64_tr_b16 v[64:65], v8 offset:32768
  ds_read_b64_tr_b16 v[66:67], v8 offset:33280
  v_mfma_f32_16x16x32_bf16 v[52:55], v[68:71], a[180:183], v[52:55]
  s_add_u32 m0, s38, 0
  s_add_u32 s39, s36, 0
  buffer_load_dwordx4 v248, s[12:15], s39 offen lds
  v_mfma_f32_16x16x32_bf16 v[52:55], v[72:75], a[184:187], v[52:55]
  ds_read_b64_tr_b16 v[68:69], v8 offset:36864
  ds_read_b64_tr_b16 v[70:71], v8 offset:37376
  v_mfma_f32_16x16x32_bf16 v[52:55], v[76:79], a[188:191], v[52:55]
  ds_read_b64_tr_b16 v[72:73], v8 offset:40960
  ds_read_b64_tr_b16 v[74:75], v8 offset:41472
  s_waitcnt lgkmcnt(12)
  v_mfma_f32_16x16x32_bf16 v[56:59], v[80:83], a[160:163], v[56:59]
  s_add_u32 m0, s38, 1024
  s_add_u32 s39, s36, 7168
  buffer_load_dwordx4 v249, s[12:15], s39 offen lds
  s_waitcnt lgkmcnt(10)
  v_mfma_f32_16x16x32_bf16 v[56:59], v[84:87], a[164:167], v[56:59]
  ds_read_b64_tr_b16 v[76:77], v8 offset:45056
  ds_read_b64_tr_b16 v[78:79], v8 offset:45568
  s_waitcnt lgkmcnt(10)
  v_mfma_f32_16x16x32_bf16 v[56:59], v[88:91], a[168:171], v[56:59]
  s_waitcnt lgkmcnt(8)
  v_mfma_f32_16x16x32_bf16 v[56:59], v[92:95], a[172:175], v[56:59]
  s_add_u32 m0, s38, 2048
  s_add_u32 s39, s36, 14336
  buffer_load_dwordx4 v248, s[12:15], s39 offen lds
  v_mfma_f32_16x16x32_bf16 v[60:63], v[80:83], a[176:179], v[60:63]
  v_mfma_f32_16x16x32_bf16 v[60:63], v[84:87], a[180:183], v[60:63]
  v_mfma_f32_16x16x32_bf16 v[60:63], v[88:91], a[184:187], v[60:63]
  s_add_u32 m0, s38, 3072
  s_add_u32 s39, s36, 21504
  buffer_load_dwordx4 v249, s[12:15], s39 offen lds
  s_add_u32 s36, s36, 114688
  s_cmp_eq_u32 s36, 3670016
  s_cselect_b32 s36, 0, s36
  s_add_u32 s38, s38, 16384
  s_and_b32 s38, s38, 131071
  v_mfma_f32_16x16x32_bf16 v[60:63], v[92:95], a[188:191], v[60:63]
  s_waitcnt vmcnt(35) lgkmcnt(6)
  v_mfma_f32_16x16x32_bf16 v[32:35], v[64:67], a[192:195], v[32:35]
  ds_read_b64_tr_b16 v[80:81], v9 offset:32768
  ds_read_b64_tr_b16 v[82:83], v9 offset:33280
  s_waitcnt vmcnt(34) lgkmcnt(6)
  v_mfma_f32_16x16x32_bf16 v[32:35], v[68:71], a[196:199], v[32:35]
  ds_read_b64_tr_b16 v[84:85], v9 offset:36864
  ds_read_b64_tr_b16 v[86:87], v9 offset:37376
  s_waitcnt vmcnt(33) lgkmcnt(6)
  v_mfma_f32_16x16x32_bf16 v[32:35], v[72:75], a[200:203], v[32:35]
  ds_read_b64_tr_b16 v[88:89], v9 offset:40960
  ds_read_b64_tr_b16 v[90:91], v9 offset:41472
  s_waitcnt vmcnt(32) lgkmcnt(6)
  v_mfma_f32_16x16x32_bf16 v[32:35], v[76:79], a[204:207], v[32:35]
  ds_read_b64_tr_b16 v[92:93], v9 offset:45056
  ds_read_b64_tr_b16 v[94:95], v9 offset:45568
  s_waitcnt vmcnt(31)
  v_mfma_f32_16x16x32_bf16 v[36:39], v[64:67], a[208:211], v[36:39]
  ds_read_b64_tr_b16 v[64:65], v10 offset:32768
  ds_read_b64_tr_b16 v[66:67], v10 offset:33280
  s_waitcnt vmcnt(30)
  v_mfma_f32_16x16x32_bf16 v[36:39], v[68:71], a[212:215], v[36:39]
  ds_read_b64_tr_b16 v[68:69], v10 offset:36864
  ds_read_b64_tr_b16 v[70:71], v10 offset:37376
  s_waitcnt vmcnt(29)
  v_mfma_f32_16x16x32_bf16 v[36:39], v[72:75], a[216:219], v[36:39]
  ds_read_b64_tr_b16 v[72:73], v10 offset:40960
  ds_read_b64_tr_b16 v[74:75], v10 offset:41472
  s_waitcnt vmcnt(28)
  v_mfma_f32_16x16x32_bf16 v[36:39], v[76:79], a[220:223], v[36:39]
  ds_read_b64_tr_b16 v[76:77], v10 offset:45056
  ds_read_b64_tr_b16 v[78:79], v10 offset:45568
  s_waitcnt lgkmcnt(14)
  v_mfma_f32_16x16x32_bf16 v[40:43], v[80:83], a[192:195], v[40:43]
  buffer_load_dwordx4 a[32:35], v2, s[8:11], s34 offen offset:0 sc1
  buffer_load_dwordx4 a[36:39], v2, s[8:11], s34 offen offset:1024 sc1
  s_waitcnt lgkmcnt(12)
  v_mfma_f32_16x16x32_bf16 v[40:43], v[84:87], a[196:199], v[40:43]
  buffer_load_dwordx4 a[40:43], v2, s[8:11], s34 offen offset:2048 sc1
  buffer_load_dwordx4 a[44:47], v2, s[8:11], s34 offen offset:3072 sc1
  s_waitcnt lgkmcnt(10)
  v_mfma_f32_16x16x32_bf16 v[40:43], v[88:91], a[200:203], v[40:43]
  buffer_load_dwordx4 a[48:51], v3, s[8:11], s34 offen offset:0 sc1
  buffer_load_dwordx4 a[52:55], v3, s[8:11], s34 offen offset:1024 sc1
  s_waitcnt lgkmcnt(8)
  v_mfma_f32_16x16x32_bf16 v[40:43], v[92:95], a[204:207], v[40:43]
  v_mfma_f32_16x16x32_bf16 v[44:47], v[80:83], a[208:211], v[44:47]
  ds_read_b64_tr_b16 v[80:81], v11 offset:32768
  ds_read_b64_tr_b16 v[82:83], v11 offset:33280
  v_mfma_f32_16x16x32_bf16 v[44:47], v[84:87], a[212:215], v[44:47]
  ds_read_b64_tr_b16 v[84:85], v11 offset:36864
  ds_read_b64_tr_b16 v[86:87], v11 offset:37376
  v_mfma_f32_16x16x32_bf16 v[44:47], v[88:91], a[216:219], v[44:47]
  ds_read_b64_tr_b16 v[88:89], v11 offset:40960
  ds_read_b64_tr_b16 v[90:91], v11 offset:41472
  v_mfma_f32_16x16x32_bf16 v[44:47], v[92:95], a[220:223], v[44:47]
  ds_read_b64_tr_b16 v[92:93], v11 offset:45056
  ds_read_b64_tr_b16 v[94:95], v11 offset:45568
  s_waitcnt lgkmcnt(14)
  v_mfma_f32_16x16x32_bf16 v[48:51], v[64:67], a[192:195], v[48:51]
  buffer_load_dwordx4 a[56:59], v3, s[8:11], s34 offen offset:2048 sc1
  buffer_load_dwordx4 a[60:63], v3, s[8:11], s34 offen offset:3072 sc1
  s_waitcnt lgkmcnt(12)
  v_mfma_f32_16x16x32_bf16 v[48:51], v[68:71], a[196:199], v[48:51]
  s_add_u32 s34, s34, 32768
  s_and_b32 s34, s34, 0xfffff
  s_waitcnt lgkmcnt(10)
  v_mfma_f32_16x16x32_bf16 v[48:51], v[72:75], a[200:203], v[48:51]
  s_barrier
  s_waitcnt lgkmcnt(8)
  v_mfma_f32_16x16x32_bf16 v[48:51], v[76:79], a[204:207], v[48:51]
  v_mfma_f32_16x16x32_bf16 v[52:55], v[64:67], a[208:211], v[52:55]
  ds_read_b64_tr_b16 v[64:65], v8 offset:49152
  ds_read_b64_tr_b16 v[66:67], v8 offset:49664
  v_mfma_f32_16x16x32_bf16 v[52:55], v[68:71], a[212:215], v[52:55]
  s_add_u32 m0, s38, 0
  s_add_u32 s39, s36, 0
  buffer_load_dwordx4 v248, s[12:15], s39 offen lds
  v_mfma_f32_16x16x32_bf16 v[52:55], v[72:75], a[216:219], v[52:55]
  ds_read_b64_tr_b16 v[68:69], v8 offset:53248
  ds_read_b64_tr_b16 v[70:71], v8 offset:53760
  v_mfma_f32_16x16x32_bf16 v[52:55], v[76:79], a[220:223], v[52:55]
  ds_read_b64_tr_b16 v[72:73], v8 offset:57344
  ds_read_b64_tr_b16 v[74:75], v8 offset:57856
  s_waitcnt lgkmcnt(12)
  v_mfma_f32_16x16x32_bf16 v[56:59], v[80:83], a[192:195], v[56:59]
  s_add_u32 m0, s38, 1024
  s_add_u32 s39, s36, 7168
  buffer_load_dwordx4 v249, s[12:15], s39 offen lds
  s_waitcnt lgkmcnt(10)
  v_mfma_f32_16x16x32_bf16 v[56:59], v[84:87], a[196:199], v[56:59]
  ds_read_b64_tr_b16 v[76:77], v8 offset:61440
  ds_read_b64_tr_b16 v[78:79], v8 offset:61952
  s_waitcnt lgkmcnt(10)
  v_mfma_f32_16x16x32_bf16 v[56:59], v[88:91], a[200:203], v[56:59]
  s_waitcnt lgkmcnt(8)
  v_mfma_f32_16x16x32_bf16 v[56:59], v[92:95], a[204:207], v[56:59]
  s_add_u32 m0, s38, 2048
  s_add_u32 s39, s36, 14336
  buffer_load_dwordx4 v248, s[12:15], s39 offen lds
  v_mfma_f32_16x16x32_bf16 v[60:63], v[80:83], a[208:211], v[60:63]
  v_mfma_f32_16x16x32_bf16 v[60:63], v[84:87], a[212:215], v[60:63]
  v_mfma_f32_16x16x32_bf16 v[60:63], v[88:91], a[216:219], v[60:63]
  s_add_u32 m0, s38, 3072
  s_add_u32 s39, s36, 21504
  buffer_load_dwordx4 v249, s[12:15], s39 offen lds
  s_add_u32 s36, s36, 114688
  s_cmp_eq_u32 s36, 3670016
  s_cselect_b32 s36, 0, s36
  s_add_u32 s38, s38, 16384
  s_and_b32 s38, s38, 131071
  v_mfma_f32_16x16x32_bf16 v[60:63], v[92:95], a[220:223], v[60:63]
  s_waitcnt vmcnt(35) lgkmcnt(6)
  v_mfma_f32_16x16x32_bf16 v[32:35], v[64:67], a[224:227], v[32:35]
  ds_read_b64_tr_b16 v[80:81], v9 offset:49152
  ds_read_b64_tr_b16 v[82:83], v9 offset:49664
  s_waitcnt vmcnt(34) lgkmcnt(6)
  v_mfma_f32_16x16x32_bf16 v[32:35], v[68:71], a[228:231], v[32:35]
  ds_read_b64_tr_b16 v[84:85], v9 offset:53248
  ds_read_b64_tr_b16 v[86:87], v9 offset:53760
  s_waitcnt vmcnt(33) lgkmcnt(6)
  v_mfma_f32_16x16x32_bf16 v[32:35], v[72:75], a[232:235], v[32:35]
  ds_read_b64_tr_b16 v[88:89], v9 offset:57344
  ds_read_b64_tr_b16 v[90:91], v9 offset:57856
  s_waitcnt vmcnt(32) lgkmcnt(6)
  v_mfma_f32_16x16x32_bf16 v[32:35], v[76:79], a[236:239], v[32:35]
  ds_read_b64_tr_b16 v[92:93], v9 offset:61440
  ds_read_b64_tr_b16 v[94:95], v9 offset:61952
  s_waitcnt vmcnt(31)
  v_mfma_f32_16x16x32_bf16 v[36:39], v[64:67], a[240:243], v[36:39]
  ds_read_b64_tr_b16 v[64:65], v10 offset:49152
  ds_read_b64_tr_b16 v[66:67], v10 offset:49664
  s_waitcnt vmcnt(30)
  v_mfma_f32_16x16x32_bf16 v[36:39], v[68:71], a[244:247], v[36:39]
  ds_read_b64_tr_b16 v[68:69], v10 offset:53248
  ds_read_b64_tr_b16 v[70:71], v10 offset:53760
  s_waitcnt vmcnt(29)
  v_mfma_f32_16x16x32_bf16 v[36:39], v[72:75], a[248:251], v[36:39]
  ds_read_b64_tr_b16 v[72:73], v10 offset:57344
  ds_read_b64_tr_b16 v[74:75], v10 offset:57856
  s_waitcnt vmcnt(28)
  v_mfma_f32_16x16x32_bf16 v[36:39], v[76:79], a[252:255], v[36:39]
  ds_read_b64_tr_b16 v[76:77], v10 offset:61440
  ds_read_b64_tr_b16 v[78:79], v10 offset:61952
  s_waitcnt lgkmcnt(14)
  v_mfma_f32_16x16x32_bf16 v[40:43], v[80:83], a[224:227], v[40:43]
  buffer_load_dwordx4 a[64:67], v2, s[8:11], s34 offen offset:0 sc1
  buffer_load_dwordx4 a[68:71], v2, s[8:11], s34 offen offset:1024 sc1
  s_waitcnt lgkmcnt(12)
  v_mfma_f32_16x16x32_bf16 v[40:43], v[84:87], a[228:231], v[40:43]
  buffer_load_dwordx4 a[72:75], v2, s[8:11], s34 offen offset:2048 sc1
  buffer_load_dwordx4 a[76:79], v2, s[8:11], s34 offen offset:3072 sc1
  s_waitcnt lgkmcnt(10)
  v_mfma_f32_16x16x32_bf16 v[40:43], v[88:91], a[232:235], v[40:43]
  buffer_load_dwordx4 a[80:83], v3, s[8:11], s34 offen offset:0 sc1
  buffer_load_dwordx4 a[84:87], v3, s[8:11], s34 offen offset:1024 sc1
  s_waitcnt lgkmcnt(8)
  v_mfma_f32_16x16x32_bf16 v[40:43], v[92:95], a[236:239], v[40:43]
  v_mfma_f32_16x16x32_bf16 v[44:47], v[80:83], a[240:243], v[44:47]
  ds_read_b64_tr_b16 v[80:81], v11 offset:49152
  ds_read_b64_tr_b16 v[82:83], v11 offset:49664
  v_mfma_f32_16x16x32_bf16 v[44:47], v[84:87], a[244:247], v[44:47]
  ds_read_b64_tr_b16 v[84:85], v11 offset:53248
  ds_read_b64_tr_b16 v[86:87], v11 offset:53760
  v_mfma_f32_16x16x32_bf16 v[44:47], v[88:91], a[248:251], v[44:47]
  ds_read_b64_tr_b16 v[88:89], v11 offset:57344
  ds_read_b64_tr_b16 v[90:91], v11 offset:57856
  v_mfma_f32_16x16x32_bf16 v[44:47], v[92:95], a[252:255], v[44:47]
  ds_read_b64_tr_b16 v[92:93], v11 offset:61440
  ds_read_b64_tr_b16 v[94:95], v11 offset:61952
  s_waitcnt lgkmcnt(14)
  v_mfma_f32_16x16x32_bf16 v[48:51], v[64:67], a[224:227], v[48:51]
  buffer_load_dwordx4 a[88:91], v3, s[8:11], s34 offen offset:2048 sc1
  buffer_load_dwordx4 a[92:95], v3, s[8:11], s34 offen offset:3072 sc1
  s_waitcnt lgkmcnt(12)
  v_mfma_f32_16x16x32_bf16 v[48:51], v[68:71], a[228:231], v[48:51]
  s_add_u32 s34, s34, 32768
  s_and_b32 s34, s34, 0xfffff
  s_waitcnt lgkmcnt(10)
  v_mfma_f32_16x16x32_bf16 v[48:51], v[72:75], a[232:235], v[48:51]
  s_barrier
  s_waitcnt lgkmcnt(8)
  v_mfma_f32_16x16x32_bf16 v[48:51], v[76:79], a[236:239], v[48:51]
  v_mfma_f32_16x16x32_bf16 v[52:55], v[64:67], a[240:243], v[52:55]
  v_mfma_f32_16x16x32_bf16 v[52:55], v[68:71], a[244:247], v[52:55]
  s_add_u32 m0, s38, 0
  s_add_u32 s39, s36, 0
  buffer_load_dwordx4 v248, s[12:15], s39 offen lds
  v_mfma_f32_16x16x32_bf16 v[52:55], v[72:75], a[248:251], v[52:55]
  v_xor_b32 v8, 65536, v8
  v_xor_b32 v9, 65536, v9
  v_mfma_f32_16x16x32_bf16 v[52:55], v[76:79], a[252:255], v[52:55]
  v_xor_b32 v10, 65536, v10
  v_xor_b32 v11, 65536, v11
  s_waitcnt lgkmcnt(6)
  v_mfma_f32_16x16x32_bf16 v[56:59], v[80:83], a[224:227], v[56:59]
  s_add_u32 m0, s38, 1024
  s_add_u32 s39, s36, 7168
  buffer_load_dwordx4 v249, s[12:15], s39 offen lds
  s_waitcnt lgkmcnt(4)
  v_mfma_f32_16x16x32_bf16 v[56:59], v[84:87], a[228:231], v[56:59]
  ds_read_b64_tr_b16 v[64:65], v8 offset:0
  ds_read_b64_tr_b16 v[66:67], v8 offset:512
  s_waitcnt lgkmcnt(4)
  v_mfma_f32_16x16x32_bf16 v[56:59], v[88:91], a[232:235], v[56:59]
  ds_read_b64_tr_b16 v[68:69], v8 offset:4096
  ds_read_b64_tr_b16 v[70:71], v8 offset:4608
  s_waitcnt lgkmcnt(4)
  v_mfma_f32_16x16x32_bf16 v[56:59], v[92:95], a[236:239], v[56:59]
  s_add_u32 m0, s38, 2048
  s_add_u32 s39, s36, 14336
  buffer_load_dwordx4 v248, s[12:15], s39 offen lds
  v_mfma_f32_16x16x32_bf16 v[60:63], v[80:83], a[240:243], v[60:63]
  ds_read_b64_tr_b16 v[72:73], v8 offset:8192
  ds_read_b64_tr_b16 v[74:75], v8 offset:8704
  v_mfma_f32_16x16x32_bf16 v[60:63], v[84:87], a[244:247], v[60:63]
  ds_read_b64_tr_b16 v[76:77], v8 offset:12288
  ds_read_b64_tr_b16 v[78:79], v8 offset:12800
  v_mfma_f32_16x16x32_bf16 v[60:63], v[88:91], a[248:251], v[60:63]
  s_add_u32 m0, s38, 3072
  s_add_u32 s39, s36, 21504
  buffer_load_dwordx4 v249, s[12:15], s39 offen lds
  s_add_u32 s36, s36, 114688
  s_cmp_eq_u32 s36, 3670016
  s_cselect_b32 s36, 0, s36
  s_add_u32 s38, s38, 16384
  s_and_b32 s38, s38, 131071
  v_mfma_f32_16x16x32_bf16 v[60:63], v[92:95], a[252:255], v[60:63]
  s_sub_u32 s29, s29, 1
  s_cmp_lg_u32 s29, 0
  s_cbranch_scc1 OP_LOOP
  s_waitcnt vmcnt(35) lgkmcnt(6)
  v_mfma_f32_16x16x32_bf16 v[32:35], v[64:67], a[0:3], v[32:35]
  ds_read_b64_tr_b16 v[80:81], v9 offset:0
  ds_read_b64_tr_b16 v[82:83], v9 offset:512
  s_waitcnt vmcnt(34) lgkmcnt(6)
  v_mfma_f32_16x16x32_bf16 v[32:35], v[68:71], a[4:7], v[32:35]
  ds_read_b64_tr_b16 v[84:85], v9 offset:4096
  ds_read_b64_tr_b16 v[86:87], v9 offset:4608
  s_waitcnt vmcnt(33) lgkmcnt(6)
  v_mfma_f32_16x16x32_bf16 v[32:35], v[72:75], a[8:11], v[32:35]
  ds_read_b64_tr_b16 v[88:89], v9 offset:8192
  ds_read_b64_tr_b16 v[90:91], v9 offset:8704
  s_waitcnt vmcnt(32) lgkmcnt(6)
  v_mfma_f32_16x16x32_bf16 v[32:35], v[76:79], a[12:15], v[32:35]
  ds_read_b64_tr_b16 v[92:93], v9 offset:12288
  ds_read_b64_tr_b16 v[94:95], v9 offset:12800
  s_waitcnt vmcnt(31)
  v_mfma_f32_16x16x32_bf16 v[36:39], v[64:67], a[16:19], v[36:39]
  ds_read_b64_tr_b16 v[64:65], v10 offset:0
  ds_read_b64_tr_b16 v[66:67], v10 offset:512
  s_waitcnt vmcnt(30)
  v_mfma_f32_16x16x32_bf16 v[36:39], v[68:71], a[20:23], v[36:39]
  ds_read_b64_tr_b16 v[68:69], v10 offset:4096
  ds_read_b64_tr_b16 v[70:71], v10 offset:4608
  s_waitcnt vmcnt(29)
  v_mfma_f32_16x16x32_bf16 v[36:39], v[72:75], a[24:27], v[36:39]
  ds_read_b64_tr_b16 v[72:73], v10 offset:8192
  ds_read_b64_tr_b16 v[74:75], v10 offset:8704
  s_waitcnt vmcnt(28)
  v_mfma_f32_16x16x32_bf16 v[36:39], v[76:79], a[28:31], v[36:39]
  ds_read_b64_tr_b16 v[76:77], v10 offset:12288
  ds_read_b64_tr_b16 v[78:79], v10 offset:12800
  s_waitcnt lgkmcnt(14)
  v_mfma_f32_16x16x32_bf16 v[40:43], v[80:83], a[0:3], v[40:43]
  buffer_load_dwordx4 a[96:99], v2, s[8:11], s34 offen offset:0 sc1
  buffer_load_dwordx4 a[100:103], v2, s[8:11], s34 offen offset:1024 sc1
  s_waitcnt lgkmcnt(12)
  v_mfma_f32_16x16x32_bf16 v[40:43], v[84:87], a[4:7], v[40:43]
  buffer_load_dwordx4 a[104:107], v2, s[8:11], s34 offen offset:2048 sc1
  buffer_load_dwordx4 a[108:111], v2, s[8:11], s34 offen offset:3072 sc1
  s_waitcnt lgkmcnt(10)
  v_mfma_f32_16x16x32_bf16 v[40:43], v[88:91], a[8:11], v[40:43]
  buffer_load_dwordx4 a[112:115], v3, s[8:11], s34 offen offset:0 sc1
  buffer_load_dwordx4 a[116:119], v3, s[8:11], s34 offen offset:1024 sc1
  s_waitcnt lgkmcnt(8)
  v_mfma_f32_16x16x32_bf16 v[40:43], v[92:95], a[12:15], v[40:43]
  v_mfma_f32_16x16x32_bf16 v[44:47], v[80:83], a[16:19], v[44:47]
  ds_read_b64_tr_b16 v[80:81], v11 offset:0
  ds_read_b64_tr_b16 v[82:83], v11 offset:512
  v_mfma_f32_16x16x32_bf16 v[44:47], v[84:87], a[20:23], v[44:47]
  ds_read_b64_tr_b16 v[84:85], v11 offset:4096
  ds_read_b64_tr_b16 v[86:87], v11 offset:4608
  v_mfma_f32_16x16x32_bf16 v[44:47], v[88:91], a[24:27], v[44:47]
  ds_read_b64_tr_b16 v[88:89], v11 offset:8192
  ds_read_b64_tr_b16 v[90:91], v11 offset:8704
  v_mfma_f32_16x16x32_bf16 v[44:47], v[92:95], a[28:31], v[44:47]
  ds_read_b64_tr_b16 v[92:93], v11 offset:12288
  ds_read_b64_tr_b16 v[94:95], v11 offset:12800
  s_waitcnt lgkmcnt(14)
  v_mfma_f32_16x16x32_bf16 v[48:51], v[64:67], a[0:3], v[48:51]
  buffer_load_dwordx4 a[120:123], v3, s[8:11], s34 offen offset:2048 sc1
  buffer_load_dwordx4 a[124:127], v3, s[8:11], s34 offen offset:3072 sc1
  s_waitcnt lgkmcnt(12)
  v_mfma_f32_16x16x32_bf16 v[48:51], v[68:71], a[4:7], v[48:51]
  s_add_u32 s34, s34, 32768
  s_and_b32 s34, s34, 0xfffff
  s_waitcnt lgkmcnt(10)
  v_mfma_f32_16x16x32_bf16 v[48:51], v[72:75], a[8:11], v[48:51]
  s_barrier
  s_waitcnt lgkmcnt(8)
  v_mfma_f32_16x16x32_bf16 v[48:51], v[76:79], a[12:15], v[48:51]
  v_mfma_f32_16x16x32_bf16 v[52:55], v[64:67], a[16:19], v[52:55]
  ds_read_b64_tr_b16 v[64:65], v8 offset:16384
  ds_read_b64_tr_b16 v[66:67], v8 offset:16896
  v_mfma_f32_16x16x32_bf16 v[52:55], v[68:71], a[20:23], v[52:55]
  s_add_u32 m0, s38, 0
  s_add_u32 s39, s36, 0
  buffer_load_dwordx4 v248, s[12:15], s39 offen lds
  v_mfma_f32_16x16x32_bf16 v[52:55], v[72:75], a[24:27], v[52:55]
  ds_read_b64_tr_b16 v[68:69], v8 offset:20480
  ds_read_b64_tr_b16 v[70:71], v8 offset:20992
  v_mfma_f32_16x16x32_bf16 v[52:55], v[76:79], a[28:31], v[52:55]
  ds_read_b64_tr_b16 v[72:73], v8 offset:24576
  ds_read_b64_tr_b16 v[74:75], v8 offset:25088
  s_waitcnt lgkmcnt(12)
  v_mfma_f32_16x16x32_bf16 v[56:59], v[80:83], a[0:3], v[56:59]
  s_add_u32 m0, s38, 1024
  s_add_u32 s39, s36, 7168
  buffer_load_dwordx4 v249, s[12:15], s39 offen lds
  s_waitcnt lgkmcnt(10)
  v_mfma_f32_16x16x32_bf16 v[56:59], v[84:87], a[4:7], v[56:59]
  ds_read_b64_tr_b16 v[76:77], v8 offset:28672
  ds_read_b64_tr_b16 v[78:79], v8 offset:29184
  s_waitcnt lgkmcnt(10)
  v_mfma_f32_16x16x32_bf16 v[56:59], v[88:91], a[8:11], v[56:59]
  s_waitcnt lgkmcnt(8)
  v_mfma_f32_16x16x32_bf16 v[56:59], v[92:95], a[12:15], v[56:59]
  s_add_u32 m0, s38, 2048
  s_add_u32 s39, s36, 14336
  buffer_load_dwordx4 v248, s[12:15], s39 offen lds
  v_mfma_f32_16x16x32_bf16 v[60:63], v[80:83], a[16:19], v[60:63]
  v_mfma_f32_16x16x32_bf16 v[60:63], v[84:87], a[20:23], v[60:63]
  v_mfma_f32_16x16x32_bf16 v[60:63], v[88:91], a[24:27], v[60:63]
  s_add_u32 m0, s38, 3072
  s_add_u32 s39, s36, 21504
  buffer_load_dwordx4 v249, s[12:15], s39 offen lds
  s_add_u32 s36, s36, 114688
  s_cmp_eq_u32 s36, 3670016
  s_cselect_b32 s36, 0, s36
  s_add_u32 s38, s38, 16384
  s_and_b32 s38, s38, 131071
  v_mfma_f32_16x16x32_bf16 v[60:63], v[92:95], a[28:31], v[60:63]
  s_waitcnt vmcnt(35) lgkmcnt(6)
  v_mfma_f32_16x16x32_bf16 v[32:35], v[64:67], a[32:35], v[32:35]
  ds_read_b64_tr_b16 v[80:81], v9 offset:16384
  ds_read_b64_tr_b16 v[82:83], v9 offset:16896
  s_waitcnt vmcnt(34) lgkmcnt(6)
  v_mfma_f32_16x16x32_bf16 v[32:35], v[68:71], a[36:39], v[32:35]
  ds_read_b64_tr_b16 v[84:85], v9 offset:20480
  ds_read_b64_tr_b16 v[86:87], v9 offset:20992
  s_waitcnt vmcnt(33) lgkmcnt(6)
  v_mfma_f32_16x16x32_bf16 v[32:35], v[72:75], a[40:43], v[32:35]
  ds_read_b64_tr_b16 v[88:89], v9 offset:24576
  ds_read_b64_tr_b16 v[90:91], v9 offset:25088
  s_waitcnt vmcnt(32) lgkmcnt(6)
  v_mfma_f32_16x16x32_bf16 v[32:35], v[76:79], a[44:47], v[32:35]
  ds_read_b64_tr_b16 v[92:93], v9 offset:28672
  ds_read_b64_tr_b16 v[94:95], v9 offset:29184
  s_waitcnt vmcnt(31)
  v_mfma_f32_16x16x32_bf16 v[36:39], v[64:67], a[48:51], v[36:39]
  ds_read_b64_tr_b16 v[64:65], v10 offset:16384
  ds_read_b64_tr_b16 v[66:67], v10 offset:16896
  s_waitcnt vmcnt(30)
  v_mfma_f32_16x16x32_bf16 v[36:39], v[68:71], a[52:55], v[36:39]
  ds_read_b64_tr_b16 v[68:69], v10 offset:20480
  ds_read_b64_tr_b16 v[70:71], v10 offset:20992
  s_waitcnt vmcnt(29)
  v_mfma_f32_16x16x32_bf16 v[36:39], v[72:75], a[56:59], v[36:39]
  ds_read_b64_tr_b16 v[72:73], v10 offset:24576
  ds_read_b64_tr_b16 v[74:75], v10 offset:25088
  s_waitcnt vmcnt(28)
  v_mfma_f32_16x16x32_bf16 v[36:39], v[76:79], a[60:63], v[36:39]
  ds_read_b64_tr_b16 v[76:77], v10 offset:28672
  ds_read_b64_tr_b16 v[78:79], v10 offset:29184
  s_waitcnt lgkmcnt(14)
  v_mfma_f32_16x16x32_bf16 v[40:43], v[80:83], a[32:35], v[40:43]
  buffer_load_dwordx4 a[128:131], v2, s[8:11], s34 offen offset:0 sc1
  buffer_load_dwordx4 a[132:135], v2, s[8:11], s34 offen offset:1024 sc1
  s_waitcnt lgkmcnt(12)
  v_mfma_f32_16x16x32_bf16 v[40:43], v[84:87], a[36:39], v[40:43]
  buffer_load_dwordx4 a[136:139], v2, s[8:11], s34 offen offset:2048 sc1
  buffer_load_dwordx4 a[140:143], v2, s[8:11], s34 offen offset:3072 sc1
  s_waitcnt lgkmcnt(10)
  v_mfma_f32_16x16x32_bf16 v[40:43], v[88:91], a[40:43], v[40:43]
  buffer_load_dwordx4 a[144:147], v3, s[8:11], s34 offen offset:0 sc1
  s_waitcnt lgkmcnt(8)
  v_mfma_f32_16x16x32_bf16 v[40:43], v[92:95], a[44:47], v[40:43]
  v_mfma_f32_16x16x32_bf16 v[44:47], v[80:83], a[48:51], v[44:47]
  ds_read_b64_tr_b16 v[80:81], v11 offset:16384
  ds_read_b64_tr_b16 v[82:83], v11 offset:16896
  v_mfma_f32_16x16x32_bf16 v[44:47], v[84:87], a[52:55], v[44:47]
  ds_read_b64_tr_b16 v[84:85], v11 offset:20480
  ds_read_b64_tr_b16 v[86:87], v11 offset:20992
  v_mfma_f32_16x16x32_bf16 v[44:47], v[88:91], a[56:59], v[44:47]
  ds_read_b64_tr_b16 v[88:89], v11 offset:24576
  ds_read_b64_tr_b16 v[90:91], v11 offset:25088
  v_mfma_f32_16x16x32_bf16 v[44:47], v[92:95], a[60:63], v[44:47]
  ds_read_b64_tr_b16 v[92:93], v11 offset:28672
  ds_read_b64_tr_b16 v[94:95], v11 offset:29184
  s_waitcnt lgkmcnt(14)
  v_mfma_f32_16x16x32_bf16 v[48:51], v[64:67], a[32:35], v[48:51]
  buffer_load_dwordx4 a[148:151], v3, s[8:11], s34 offen offset:1024 sc1
  buffer_load_dwordx4 a[152:155], v3, s[8:11], s34 offen offset:2048 sc1
  s_waitcnt lgkmcnt(12)
  v_mfma_f32_16x16x32_bf16 v[48:51], v[68:71], a[36:39], v[48:51]
  buffer_load_dwordx4 a[156:159], v3, s[8:11], s34 offen offset:3072 sc1
  s_waitcnt lgkmcnt(10)
  v_mfma_f32_16x16x32_bf16 v[48:51], v[72:75], a[40:43], v[48:51]
  s_barrier
  s_waitcnt lgkmcnt(8)
  v_mfma_f32_16x16x32_bf16 v[48:51], v[76:79], a[44:47], v[48:51]
  v_mfma_f32_16x16x32_bf16 v[52:55], v[64:67], a[48:51], v[52:55]
  s_add_u32 s34, s34, 32768
  s_and_b32 s34, s34, 0xfffff
  ds_read_b64_tr_b16 v[64:65], v8 offset:32768
  v_mfma_f32_16x16x32_bf16 v[52:55], v[68:71], a[52:55], v[52:55]
  ds_read_b64_tr_b16 v[66:67], v8 offset:33280
  ds_read_b64_tr_b16 v[68:69], v8 offset:36864
  v_mfma_f32_16x16x32_bf16 v[52:55], v[72:75], a[56:59], v[52:55]
  ds_read_b64_tr_b16 v[70:71], v8 offset:37376
  ds_read_b64_tr_b16 v[72:73], v8 offset:40960
  v_mfma_f32_16x16x32_bf16 v[52:55], v[76:79], a[60:63], v[52:55]
  ds_read_b64_tr_b16 v[74:75], v8 offset:41472
  ds_read_b64_tr_b16 v[76:77], v8 offset:45056
  s_waitcnt lgkmcnt(13)
  v_mfma_f32_16x16x32_bf16 v[56:59], v[80:83], a[32:35], v[56:59]
  ds_read_b64_tr_b16 v[78:79], v8 offset:45568
  s_waitcnt lgkmcnt(12)
  v_mfma_f32_16x16x32_bf16 v[56:59], v[84:87], a[36:39], v[56:59]
  s_waitcnt lgkmcnt(10)
  v_mfma_f32_16x16x32_bf16 v[56:59], v[88:91], a[40:43], v[56:59]
  s_waitcnt lgkmcnt(8)
  v_mfma_f32_16x16x32_bf16 v[56:59], v[92:95], a[44:47], v[56:59]
  v_mfma_f32_16x16x32_bf16 v[60:63], v[80:83], a[48:51], v[60:63]
  v_mfma_f32_16x16x32_bf16 v[60:63], v[84:87], a[52:55], v[60:63]
  v_mfma_f32_16x16x32_bf16 v[60:63], v[88:91], a[56:59], v[60:63]
  v_mfma_f32_16x16x32_bf16 v[60:63], v[92:95], a[60:63], v[60:63]
  s_waitcnt vmcnt(31) lgkmcnt(6)
  v_mfma_f32_16x16x32_bf16 v[32:35], v[64:67], a[64:67], v[32:35]
  ds_read_b64_tr_b16 v[80:81], v9 offset:32768
  ds_read_b64_tr_b16 v[82:83], v9 offset:33280
  s_waitcnt vmcnt(30) lgkmcnt(6)
  v_mfma_f32_16x16x32_bf16 v[32:35], v[68:71], a[68:71], v[32:35]
  ds_read_b64_tr_b16 v[84:85], v9 offset:36864
  ds_read_b64_tr_b16 v[86:87], v9 offset:37376
  s_waitcnt vmcnt(29) lgkmcnt(6)
  v_mfma_f32_16x16x32_bf16 v[32:35], v[72:75], a[72:75], v[32:35]
  ds_read_b64_tr_b16 v[88:89], v9 offset:40960
  ds_read_b64_tr_b16 v[90:91], v9 offset:41472
  s_waitcnt vmcnt(28) lgkmcnt(6)
  v_mfma_f32_16x16x32_bf16 v[32:35], v[76:79], a[76:79], v[32:35]
  ds_read_b64_tr_b16 v[92:93], v9 offset:45056
  ds_read_b64_tr_b16 v[94:95], v9 offset:45568
  s_waitcnt vmcnt(27)
  v_mfma_f32_16x16x32_bf16 v[36:39], v[64:67], a[80:83], v[36:39]
  ds_read_b64_tr_b16 v[64:65], v10 offset:32768
  ds_read_b64_tr_b16 v[66:67], v10 offset:33280
  s_waitcnt vmcnt(26)
  v_mfma_f32_16x16x32_bf16 v[36:39], v[68:71], a[84:87], v[36:39]
  ds_read_b64_tr_b16 v[68:69], v10 offset:36864
  ds_read_b64_tr_b16 v[70:71], v10 offset:37376
  s_waitcnt vmcnt(25)
  v_mfma_f32_16x16x32_bf16 v[36:39], v[72:75], a[88:91], v[36:39]
  ds_read_b64_tr_b16 v[72:73], v10 offset:40960
  ds_read_b64_tr_b16 v[74:75], v10 offset:41472
  s_waitcnt vmcnt(24)
  v_mfma_f32_16x16x32_bf16 v[36:39], v[76:79], a[92:95], v[36:39]
  ds_read_b64_tr_b16 v[76:77], v10 offset:45056
  ds_read_b64_tr_b16 v[78:79], v10 offset:45568
  s_waitcnt lgkmcnt(14)
  v_mfma_f32_16x16x32_bf16 v[40:43], v[80:83], a[64:67], v[40:43]
  buffer_load_dwordx4 a[160:163], v2, s[8:11], s34 offen offset:0 sc1
  buffer_load_dwordx4 a[164:167], v2, s[8:11], s34 offen offset:1024 sc1
  s_waitcnt lgkmcnt(12)
  v_mfma_f32_16x16x32_bf16 v[40:43], v[84:87], a[68:71], v[40:43]
  buffer_load_dwordx4 a[168:171], v2, s[8:11], s34 offen offset:2048 sc1
  buffer_load_dwordx4 a[172:175], v2, s[8:11], s34 offen offset:3072 sc1
  s_waitcnt lgkmcnt(10)
  v_mfma_f32_16x16x32_bf16 v[40:43], v[88:91], a[72:75], v[40:43]
  buffer_load_dwordx4 a[176:179], v3, s[8:11], s34 offen offset:0 sc1
  s_waitcnt lgkmcnt(8)
  v_mfma_f32_16x16x32_bf16 v[40:43], v[92:95], a[76:79], v[40:43]
  v_mfma_f32_16x16x32_bf16 v[44:47], v[80:83], a[80:83], v[44:47]
  ds_read_b64_tr_b16 v[80:81], v11 offset:32768
  ds_read_b64_tr_b16 v[82:83], v11 offset:33280
  v_mfma_f32_16x16x32_bf16 v[44:47], v[84:87], a[84:87], v[44:47]
  ds_read_b64_tr_b16 v[84:85], v11 offset:36864
  ds_read_b64_tr_b16 v[86:87], v11 offset:37376
  v_mfma_f32_16x16x32_bf16 v[44:47], v[88:91], a[88:91], v[44:47]
  ds_read_b64_tr_b16 v[88:89], v11 offset:40960
  ds_read_b64_tr_b16 v[90:91], v11 offset:41472
  v_mfma_f32_16x16x32_bf16 v[44:47], v[92:95], a[92:95], v[44:47]
  ds_read_b64_tr_b16 v[92:93], v11 offset:45056
  ds_read_b64_tr_b16 v[94:95], v11 offset:45568
  s_waitcnt lgkmcnt(14)
  v_mfma_f32_16x16x32_bf16 v[48:51], v[64:67], a[64:67], v[48:51]
  buffer_load_dwordx4 a[180:183], v3, s[8:11], s34 offen offset:1024 sc1
  buffer_load_dwordx4 a[184:187], v3, s[8:11], s34 offen offset:2048 sc1
  s_waitcnt lgkmcnt(12)
  v_mfma_f32_16x16x32_bf16 v[48:51], v[68:71], a[68:71], v[48:51]
  buffer_load_dwordx4 a[188:191], v3, s[8:11], s34 offen offset:3072 sc1
  s_waitcnt lgkmcnt(10)
  v_mfma_f32_16x16x32_bf16 v[48:51], v[72:75], a[72:75], v[48:51]
  s_barrier
  s_waitcnt lgkmcnt(8)
  v_mfma_f32_16x16x32_bf16 v[48:51], v[76:79], a[76:79], v[48:51]
  v_mfma_f32_16x16x32_bf16 v[52:55], v[64:67], a[80:83], v[52:55]
  s_add_u32 s34, s34, 32768
  s_and_b32 s34, s34, 0xfffff
  ds_read_b64_tr_b16 v[64:65], v8 offset:49152
  v_mfma_f32_16x16x32_bf16 v[52:55], v[68:71], a[84:87], v[52:55]
  ds_read_b64_tr_b16 v[66:67], v8 offset:49664
  ds_read_b64_tr_b16 v[68:69], v8 offset:53248
  v_mfma_f32_16x16x32_bf16 v[52:55], v[72:75], a[88:91], v[52:55]
  ds_read_b64_tr_b16 v[70:71], v8 offset:53760
  ds_read_b64_tr_b16 v[72:73], v8 offset:57344
  v_mfma_f32_16x16x32_bf16 v[52:55], v[76:79], a[92:95], v[52:55]
  ds_read_b64_tr_b16 v[74:75], v8 offset:57856
  ds_read_b64_tr_b16 v[76:77], v8 offset:61440
  s_waitcnt lgkmcnt(13)
  v_mfma_f32_16x16x32_bf16 v[56:59], v[80:83], a[64:67], v[56:59]
  ds_read_b64_tr_b16 v[78:79], v8 offset:61952
  s_waitcnt lgkmcnt(12)
  v_mfma_f32_16x16x32_bf16 v[56:59], v[84:87], a[68:71], v[56:59]
  s_waitcnt lgkmcnt(10)
  v_mfma_f32_16x16x32_bf16 v[56:59], v[88:91], a[72:75], v[56:59]
  s_waitcnt lgkmcnt(8)
  v_mfma_f32_16x16x32_bf16 v[56:59], v[92:95], a[76:79], v[56:59]
  v_mfma_f32_16x16x32_bf16 v[60:63], v[80:83], a[80:83], v[60:63]
  v_mfma_f32_16x16x32_bf16 v[60:63], v[84:87], a[84:87], v[60:63]
  v_mfma_f32_16x16x32_bf16 v[60:63], v[88:91], a[88:91], v[60:63]
  v_mfma_f32_16x16x32_bf16 v[60:63], v[92:95], a[92:95], v[60:63]
  s_waitcnt vmcnt(27) lgkmcnt(6)
  v_mfma_f32_16x16x32_bf16 v[32:35], v[64:67], a[96:99], v[32:35]
  ds_read_b64_tr_b16 v[80:81], v9 offset:49152
  ds_read_b64_tr_b16 v[82:83], v9 offset:49664
  s_waitcnt vmcnt(26) lgkmcnt(6)
  v_mfma_f32_16x16x32_bf16 v[32:35], v[68:71], a[100:103], v[32:35]
  ds_read_b64_tr_b16 v[84:85], v9 offset:53248
  ds_read_b64_tr_b16 v[86:87], v9 offset:53760
  s_waitcnt vmcnt(25) lgkmcnt(6)
  v_mfma_f32_16x16x32_bf16 v[32:35], v[72:75], a[104:107], v[32:35]
  ds_read_b64_tr_b16 v[88:89], v9 offset:57344
  ds_read_b64_tr_b16 v[90:91], v9 offset:57856
  s_waitcnt vmcnt(24) lgkmcnt(6)
  v_mfma_f32_16x16x32_bf16 v[32:35], v[76:79], a[108:111], v[32:35]
  ds_read_b64_tr_b16 v[92:93], v9 offset:61440
  ds_read_b64_tr_b16 v[94:95], v9 offset:61952
  s_waitcnt vmcnt(23)
  v_mfma_f32_16x16x32_bf16 v[36:39], v[64:67], a[112:115], v[36:39]
  ds_read_b64_tr_b16 v[64:65], v10 offset:49152
  ds_read_b64_tr_b16 v[66:67], v10 offset:49664
  s_waitcnt vmcnt(22)
  v_mfma_f32_16x16x32_bf16 v[36:39], v[68:71], a[116:119], v[36:39]
  ds_read_b64_tr_b16 v[68:69], v10 offset:53248
  ds_read_b64_tr_b16 v[70:71], v10 offset:53760
  s_waitcnt vmcnt(21)
  v_mfma_f32_16x16x32_bf16 v[36:39], v[72:75], a[120:123], v[36:39]
  ds_read_b64_tr_b16 v[72:73], v10 offset:57344
  ds_read_b64_tr_b16 v[74:75], v10 offset:57856
  s_waitcnt vmcnt(20)
  v_mfma_f32_16x16x32_bf16 v[36:39], v[76:79], a[124:127], v[36:39]
  ds_read_b64_tr_b16 v[76:77], v10 offset:61440
  ds_read_b64_tr_b16 v[78:79], v10 offset:61952
  s_waitcnt lgkmcnt(14)
  v_mfma_f32_16x16x32_bf16 v[40:43], v[80:83], a[96:99], v[40:43]
  buffer_load_dwordx4 a[192:195], v2, s[8:11], s34 offen offset:0 sc1
  buffer_load_dwordx4 a[196:199], v2, s[8:11], s34 offen offset:1024 sc1
  s_waitcnt lgkmcnt(12)
  v_mfma_f32_16x16x32_bf16 v[40:43], v[84:87], a[100:103], v[40:43]
  buffer_load_dwordx4 a[200:203], v2, s[8:11], s34 offen offset:2048 sc1
  buffer_load_dwordx4 a[204:207], v2, s[8:11], s34 offen offset:3072 sc1
  s_waitcnt lgkmcnt(10)
  v_mfma_f32_16x16x32_bf16 v[40:43], v[88:91], a[104:107], v[40:43]
  buffer_load_dwordx4 a[208:211], v3, s[8:11], s34 offen offset:0 sc1
  s_waitcnt lgkmcnt(8)
  v_mfma_f32_16x16x32_bf16 v[40:43], v[92:95], a[108:111], v[40:43]
  v_mfma_f32_16x16x32_bf16 v[44:47], v[80:83], a[112:115], v[44:47]
  ds_read_b64_tr_b16 v[80:81], v11 offset:49152
  ds_read_b64_tr_b16 v[82:83], v11 offset:49664
  v_mfma_f32_16x16x32_bf16 v[44:47], v[84:87], a[116:119], v[44:47]
  ds_read_b64_tr_b16 v[84:85], v11 offset:53248
  ds_read_b64_tr_b16 v[86:87], v11 offset:53760
  v_mfma_f32_16x16x32_bf16 v[44:47], v[88:91], a[120:123], v[44:47]
  ds_read_b64_tr_b16 v[88:89], v11 offset:57344
  ds_read_b64_tr_b16 v[90:91], v11 offset:57856
  v_mfma_f32_16x16x32_bf16 v[44:47], v[92:95], a[124:127], v[44:47]
  ds_read_b64_tr_b16 v[92:93], v11 offset:61440
  ds_read_b64_tr_b16 v[94:95], v11 offset:61952
  s_waitcnt lgkmcnt(14)
  v_mfma_f32_16x16x32_bf16 v[48:51], v[64:67], a[96:99], v[48:51]
  buffer_load_dwordx4 a[212:215], v3, s[8:11], s34 offen offset:1024 sc1
  buffer_load_dwordx4 a[216:219], v3, s[8:11], s34 offen offset:2048 sc1
  s_waitcnt lgkmcnt(12)
  v_mfma_f32_16x16x32_bf16 v[48:51], v[68:71], a[100:103], v[48:51]
  buffer_load_dwordx4 a[220:223], v3, s[8:11], s34 offen offset:3072 sc1
  s_waitcnt lgkmcnt(10)
  v_mfma_f32_16x16x32_bf16 v[48:51], v[72:75], a[104:107], v[48:51]
  s_barrier
  s_waitcnt lgkmcnt(8)
  v_mfma_f32_16x16x32_bf16 v[48:51], v[76:79], a[108:111], v[48:51]
  v_mfma_f32_16x16x32_bf16 v[52:55], v[64:67], a[112:115], v[52:55]
  s_add_u32 s34, s34, 32768
  s_and_b32 s34, s34, 0xfffff
  v_mfma_f32_16x16x32_bf16 v[52:55], v[68:71], a[116:119], v[52:55]
  v_mfma_f32_16x16x32_bf16 v[52:55], v[72:75], a[120:123], v[52:55]
  v_xor_b32 v8, 65536, v8
  v_xor_b32 v9, 65536, v9
  v_mfma_f32_16x16x32_bf16 v[52:55], v[76:79], a[124:127], v[52:55]
  v_xor_b32 v10, 65536, v10
  v_xor_b32 v11, 65536, v11
  s_waitcnt lgkmcnt(6)
  v_mfma_f32_16x16x32_bf16 v[56:59], v[80:83], a[96:99], v[56:59]
  ds_read_b64_tr_b16 v[64:65], v8 offset:0
  ds_read_b64_tr_b16 v[66:67], v8 offset:512
  s_waitcnt lgkmcnt(6)
  v_mfma_f32_16x16x32_bf16 v[56:59], v[84:87], a[100:103], v[56:59]
  ds_read_b64_tr_b16 v[68:69], v8 offset:4096
  ds_read_b64_tr_b16 v[70:71], v8 offset:4608
  s_waitcnt lgkmcnt(6)
  v_mfma_f32_16x16x32_bf16 v[56:59], v[88:91], a[104:107], v[56:59]
  ds_read_b64_tr_b16 v[72:73], v8 offset:8192
  ds_read_b64_tr_b16 v[74:75], v8 offset:8704
  s_waitcnt lgkmcnt(6)
  v_mfma_f32_16x16x32_bf16 v[56:59], v[92:95], a[108:111], v[56:59]
  ds_read_b64_tr_b16 v[76:77], v8 offset:12288
  ds_read_b64_tr_b16 v[78:79], v8 offset:12800
  v_mfma_f32_16x16x32_bf16 v[60:63], v[80:83], a[112:115], v[60:63]
  v_mfma_f32_16x16x32_bf16 v[60:63], v[84:87], a[116:119], v[60:63]
  v_mfma_f32_16x16x32_bf16 v[60:63], v[88:91], a[120:123], v[60:63]
  v_mfma_f32_16x16x32_bf16 v[60:63], v[92:95], a[124:127], v[60:63]
  s_waitcnt vmcnt(23) lgkmcnt(6)
  v_mfma_f32_16x16x32_bf16 v[32:35], v[64:67], a[128:131], v[32:35]
  ds_read_b64_tr_b16 v[80:81], v9 offset:0
  ds_read_b64_tr_b16 v[82:83], v9 offset:512
  s_waitcnt vmcnt(22) lgkmcnt(6)
  v_mfma_f32_16x16x32_bf16 v[32:35], v[68:71], a[132:135], v[32:35]
  ds_read_b64_tr_b16 v[84:85], v9 offset:4096
  ds_read_b64_tr_b16 v[86:87], v9 offset:4608
  s_waitcnt vmcnt(21) lgkmcnt(6)
  v_mfma_f32_16x16x32_bf16 v[32:35], v[72:75], a[136:139], v[32:35]
  ds_read_b64_tr_b16 v[88:89], v9 offset:8192
  ds_read_b64_tr_b16 v[90:91], v9 offset:8704
  s_waitcnt vmcnt(20) lgkmcnt(6)
  v_mfma_f32_16x16x32_bf16 v[32:35], v[76:79], a[140:143], v[32:35]
  ds_read_b64_tr_b16 v[92:93], v9 offset:12288
  ds_read_b64_tr_b16 v[94:95], v9 offset:12800
  s_waitcnt vmcnt(19)
  v_mfma_f32_16x16x32_bf16 v[36:39], v[64:67], a[144:147], v[36:39]
  ds_read_b64_tr_b16 v[64:65], v10 offset:0
  ds_read_b64_tr_b16 v[66:67], v10 offset:512
  s_waitcnt vmcnt(18)
  v_mfma_f32_16x16x32_bf16 v[36:39], v[68:71], a[148:151], v[36:39]
  ds_read_b64_tr_b16 v[68:69], v10 offset:4096
  ds_read_b64_tr_b16 v[70:71], v10 offset:4608
  s_waitcnt vmcnt(17)
  v_mfma_f32_16x16x32_bf16 v[36:39], v[72:75], a[152:155], v[36:39]
  ds_read_b64_tr_b16 v[72:73], v10 offset:8192
  ds_read_b64_tr_b16 v[74:75], v10 offset:8704
  s_waitcnt vmcnt(16)
  v_mfma_f32_16x16x32_bf16 v[36:39], v[76:79], a[156:159], v[36:39]
  ds_read_b64_tr_b16 v[76:77], v10 offset:12288
  ds_read_b64_tr_b16 v[78:79], v10 offset:12800
  s_waitcnt lgkmcnt(14)
  v_mfma_f32_16x16x32_bf16 v[40:43], v[80:83], a[128:131], v[40:43]
  buffer_load_dwordx4 a[224:227], v2, s[8:11], s34 offen offset:0 sc1
  buffer_load_dwordx4 a[228:231], v2, s[8:11], s34 offen offset:1024 sc1
  s_waitcnt lgkmcnt(12)
  v_mfma_f32_16x16x32_bf16 v[40:43], v[84:87], a[132:135], v[40:43]
  buffer_load_dwordx4 a[232:235], v2, s[8:11], s34 offen offset:2048 sc1
  buffer_load_dwordx4 a[236:239], v2, s[8:11], s34 offen offset:3072 sc1
  s_waitcnt lgkmcnt(10)
  v_mfma_f32_16x16x32_bf16 v[40:43], v[88:91], a[136:139], v[40:43]
  buffer_load_dwordx4 a[240:243], v3, s[8:11], s34 offen offset:0 sc1
  s_waitcnt lgkmcnt(8)
  v_mfma_f32_16x16x32_bf16 v[40:43], v[92:95], a[140:143], v[40:43]
  v_mfma_f32_16x16x32_bf16 v[44:47], v[80:83], a[144:147], v[44:47]
  ds_read_b64_tr_b16 v[80:81], v11 offset:0
  ds_read_b64_tr_b16 v[82:83], v11 offset:512
  v_mfma_f32_16x16x32_bf16 v[44:47], v[84:87], a[148:151], v[44:47]
  ds_read_b64_tr_b16 v[84:85], v11 offset:4096
  ds_read_b64_tr_b16 v[86:87], v11 offset:4608
  v_mfma_f32_16x16x32_bf16 v[44:47], v[88:91], a[152:155], v[44:47]
  ds_read_b64_tr_b16 v[88:89], v11 offset:8192
  ds_read_b64_tr_b16 v[90:91], v11 offset:8704
  v_mfma_f32_16x16x32_bf16 v[44:47], v[92:95], a[156:159], v[44:47]
  ds_read_b64_tr_b16 v[92:93], v11 offset:12288
  ds_read_b64_tr_b16 v[94:95], v11 offset:12800
  s_waitcnt lgkmcnt(14)
  v_mfma_f32_16x16x32_bf16 v[48:51], v[64:67], a[128:131], v[48:51]
  buffer_load_dwordx4 a[244:247], v3, s[8:11], s34 offen offset:1024 sc1
  buffer_load_dwordx4 a[248:251], v3, s[8:11], s34 offen offset:2048 sc1
  s_waitcnt lgkmcnt(12)
  v_mfma_f32_16x16x32_bf16 v[48:51], v[68:71], a[132:135], v[48:51]
  buffer_load_dwordx4 a[252:255], v3, s[8:11], s34 offen offset:3072 sc1
  s_waitcnt lgkmcnt(10)
  v_mfma_f32_16x16x32_bf16 v[48:51], v[72:75], a[136:139], v[48:51]
  s_barrier
  s_waitcnt lgkmcnt(8)
  v_mfma_f32_16x16x32_bf16 v[48:51], v[76:79], a[140:143], v[48:51]
  v_mfma_f32_16x16x32_bf16 v[52:55], v[64:67], a[144:147], v[52:55]
  s_add_u32 s34, s34, 32768
  s_and_b32 s34, s34, 0xfffff
  ds_read_b64_tr_b16 v[64:65], v8 offset:16384
  v_mfma_f32_16x16x32_bf16 v[52:55], v[68:71], a[148:151], v[52:55]
  ds_read_b64_tr_b16 v[66:67], v8 offset:16896
  ds_read_b64_tr_b16 v[68:69], v8 offset:20480
  v_mfma_f32_16x16x32_bf16 v[52:55], v[72:75], a[152:155], v[52:55]
  ds_read_b64_tr_b16 v[70:71], v8 offset:20992
  ds_read_b64_tr_b16 v[72:73], v8 offset:24576
  v_mfma_f32_16x16x32_bf16 v[52:55], v[76:79], a[156:159], v[52:55]
  ds_read_b64_tr_b16 v[74:75], v8 offset:25088
  ds_read_b64_tr_b16 v[76:77], v8 offset:28672
  s_waitcnt lgkmcnt(13)
  v_mfma_f32_16x16x32_bf16 v[56:59], v[80:83], a[128:131], v[56:59]
  ds_read_b64_tr_b16 v[78:79], v8 offset:29184
  s_waitcnt lgkmcnt(12)
  v_mfma_f32_16x16x32_bf16 v[56:59], v[84:87], a[132:135], v[56:59]
  s_waitcnt lgkmcnt(10)
  v_mfma_f32_16x16x32_bf16 v[56:59], v[88:91], a[136:139], v[56:59]
  s_waitcnt lgkmcnt(8)
  v_mfma_f32_16x16x32_bf16 v[56:59], v[92:95], a[140:143], v[56:59]
  v_mfma_f32_16x16x32_bf16 v[60:63], v[80:83], a[144:147], v[60:63]
  v_mfma_f32_16x16x32_bf16 v[60:63], v[84:87], a[148:151], v[60:63]
  v_mfma_f32_16x16x32_bf16 v[60:63], v[88:91], a[152:155], v[60:63]
  v_mfma_f32_16x16x32_bf16 v[60:63], v[92:95], a[156:159], v[60:63]
  s_waitcnt vmcnt(23) lgkmcnt(6)
  v_mfma_f32_16x16x32_bf16 v[32:35], v[64:67], a[160:163], v[32:35]
  ds_read_b64_tr_b16 v[80:81], v9 offset:16384
  ds_read_b64_tr_b16 v[82:83], v9 offset:16896
  s_waitcnt vmcnt(22) lgkmcnt(6)
  v_mfma_f32_16x16x32_bf16 v[32:35], v[68:71], a[164:167], v[32:35]
  ds_read_b64_tr_b16 v[84:85], v9 offset:20480
  ds_read_b64_tr_b16 v[86:87], v9 offset:20992
  s_waitcnt vmcnt(21) lgkmcnt(6)
  v_mfma_f32_16x16x32_bf16 v[32:35], v[72:75], a[168:171], v[32:35]
  ds_read_b64_tr_b16 v[88:89], v9 offset:24576
  ds_read_b64_tr_b16 v[90:91], v9 offset:25088
  s_waitcnt vmcnt(20) lgkmcnt(6)
  v_mfma_f32_16x16x32_bf16 v[32:35], v[76:79], a[172:175], v[32:35]
  ds_read_b64_tr_b16 v[92:93], v9 offset:28672
  ds_read_b64_tr_b16 v[94:95], v9 offset:29184
  s_waitcnt vmcnt(19)
  v_mfma_f32_16x16x32_bf16 v[36:39], v[64:67], a[176:179], v[36:39]
  ds_read_b64_tr_b16 v[64:65], v10 offset:16384
  ds_read_b64_tr_b16 v[66:67], v10 offset:16896
  s_waitcnt vmcnt(18)
  v_mfma_f32_16x16x32_bf16 v[36:39], v[68:71], a[180:183], v[36:39]
  ds_read_b64_tr_b16 v[68:69], v10 offset:20480
  ds_read_b64_tr_b16 v[70:71], v10 offset:20992
  s_waitcnt vmcnt(17)
  v_mfma_f32_16x16x32_bf16 v[36:39], v[72:75], a[184:187], v[36:39]
  ds_read_b64_tr_b16 v[72:73], v10 offset:24576
  ds_read_b64_tr_b16 v[74:75], v10 offset:25088
  s_waitcnt vmcnt(16)
  v_mfma_f32_16x16x32_bf16 v[36:39], v[76:79], a[188:191], v[36:39]
  ds_read_b64_tr_b16 v[76:77], v10 offset:28672
  ds_read_b64_tr_b16 v[78:79], v10 offset:29184
  s_waitcnt lgkmcnt(14)
  v_mfma_f32_16x16x32_bf16 v[40:43], v[80:83], a[160:163], v[40:43]
  s_waitcnt lgkmcnt(12)
  v_mfma_f32_16x16x32_bf16 v[40:43], v[84:87], a[164:167], v[40:43]
  s_waitcnt lgkmcnt(10)
  v_mfma_f32_16x16x32_bf16 v[40:43], v[88:91], a[168:171], v[40:43]
  s_waitcnt lgkmcnt(8)
  v_mfma_f32_16x16x32_bf16 v[40:43], v[92:95], a[172:175], v[40:43]
  v_mfma_f32_16x16x32_bf16 v[44:47], v[80:83], a[176:179], v[44:47]
  ds_read_b64_tr_b16 v[80:81], v11 offset:16384
  ds_read_b64_tr_b16 v[82:83], v11 offset:16896
  v_mfma_f32_16x16x32_bf16 v[44:47], v[84:87], a[180:183], v[44:47]
  ds_read_b64_tr_b16 v[84:85], v11 offset:20480
  ds_read_b64_tr_b16 v[86:87], v11 offset:20992
  v_mfma_f32_16x16x32_bf16 v[44:47], v[88:91], a[184:187], v[44:47]
  ds_read_b64_tr_b16 v[88:89], v11 offset:24576
  ds_read_b64_tr_b16 v[90:91], v11 offset:25088
  v_mfma_f32_16x16x32_bf16 v[44:47], v[92:95], a[188:191], v[44:47]
  ds_read_b64_tr_b16 v[92:93], v11 offset:28672
  ds_read_b64_tr_b16 v[94:95], v11 offset:29184
  s_waitcnt lgkmcnt(14)
  v_mfma_f32_16x16x32_bf16 v[48:51], v[64:67], a[160:163], v[48:51]
  s_waitcnt lgkmcnt(12)
  v_mfma_f32_16x16x32_bf16 v[48:51], v[68:71], a[164:167], v[48:51]
  s_waitcnt lgkmcnt(10)
  v_mfma_f32_16x16x32_bf16 v[48:51], v[72:75], a[168:171], v[48:51]
  s_barrier
  s_waitcnt lgkmcnt(8)
  v_mfma_f32_16x16x32_bf16 v[48:51], v[76:79], a[172:175], v[48:51]
  v_mfma_f32_16x16x32_bf16 v[52:55], v[64:67], a[176:179], v[52:55]
  ds_read_b64_tr_b16 v[64:65], v8 offset:32768
  ds_read_b64_tr_b16 v[66:67], v8 offset:33280
  v_mfma_f32_16x16x32_bf16 v[52:55], v[68:71], a[180:183], v[52:55]
  ds_read_b64_tr_b16 v[68:69], v8 offset:36864
  ds_read_b64_tr_b16 v[70:71], v8 offset:37376
  v_mfma_f32_16x16x32_bf16 v[52:55], v[72:75], a[184:187], v[52:55]
  ds_read_b64_tr_b16 v[72:73], v8 offset:40960
  ds_read_b64_tr_b16 v[74:75], v8 offset:41472
  v_mfma_f32_16x16x32_bf16 v[52:55], v[76:79], a[188:191], v[52:55]
  ds_read_b64_tr_b16 v[76:77], v8 offset:45056
  ds_read_b64_tr_b16 v[78:79], v8 offset:45568
  s_waitcnt lgkmcnt(14)
  v_mfma_f32_16x16x32_bf16 v[56:59], v[80:83], a[160:163], v[56:59]
  s_waitcnt lgkmcnt(12)
  v_mfma_f32_16x16x32_bf16 v[56:59], v[84:87], a[164:167], v[56:59]
  s_waitcnt lgkmcnt(10)
  v_mfma_f32_16x16x32_bf16 v[56:59], v[88:91], a[168:171], v[56:59]
  s_waitcnt lgkmcnt(8)
  v_mfma_f32_16x16x32_bf16 v[56:59], v[92:95], a[172:175], v[56:59]
  v_mfma_f32_16x16x32_bf16 v[60:63], v[80:83], a[176:179], v[60:63]
  v_mfma_f32_16x16x32_bf16 v[60:63], v[84:87], a[180:183], v[60:63]
  v_mfma_f32_16x16x32_bf16 v[60:63], v[88:91], a[184:187], v[60:63]
  v_mfma_f32_16x16x32_bf16 v[60:63], v[92:95], a[188:191], v[60:63]
  s_waitcnt vmcnt(15) lgkmcnt(6)
  v_mfma_f32_16x16x32_bf16 v[32:35], v[64:67], a[192:195], v[32:35]
  ds_read_b64_tr_b16 v[80:81], v9 offset:32768
  ds_read_b64_tr_b16 v[82:83], v9 offset:33280
  s_waitcnt vmcnt(14) lgkmcnt(6)
  v_mfma_f32_16x16x32_bf16 v[32:35], v[68:71], a[196:199], v[32:35]
  ds_read_b64_tr_b16 v[84:85], v9 offset:36864
  ds_read_b64_tr_b16 v[86:87], v9 offset:37376
  s_waitcnt vmcnt(13) lgkmcnt(6)
  v_mfma_f32_16x16x32_bf16 v[32:35], v[72:75], a[200:203], v[32:35]
  ds_read_b64_tr_b16 v[88:89], v9 offset:40960
  ds_read_b64_tr_b16 v[90:91], v9 offset:41472
  s_waitcnt vmcnt(12) lgkmcnt(6)
  v_mfma_f32_16x16x32_bf16 v[32:35], v[76:79], a[204:207], v[32:35]
  ds_read_b64_tr_b16 v[92:93], v9 offset:45056
  ds_read_b64_tr_b16 v[94:95], v9 offset:45568
  s_waitcnt vmcnt(11)
  v_mfma_f32_16x16x32_bf16 v[36:39], v[64:67], a[208:211], v[36:39]
  ds_read_b64_tr_b16 v[64:65], v10 offset:32768
  ds_read_b64_tr_b16 v[66:67], v10 offset:33280
  s_waitcnt vmcnt(10)
  v_mfma_f32_16x16x32_bf16 v[36:39], v[68:71], a[212:215], v[36:39]
  ds_read_b64_tr_b16 v[68:69], v10 offset:36864
  ds_read_b64_tr_b16 v[70:71], v10 offset:37376
  s_waitcnt vmcnt(9)
  v_mfma_f32_16x16x32_bf16 v[36:39], v[72:75], a[216:219], v[36:39]
  ds_read_b64_tr_b16 v[72:73], v10 offset:40960
  ds_read_b64_tr_b16 v[74:75], v10 offset:41472
  s_waitcnt vmcnt(8)
  v_mfma_f32_16x16x32_bf16 v[36:39], v[76:79], a[220:223], v[36:39]
  ds_read_b64_tr_b16 v[76:77], v10 offset:45056
  ds_read_b64_tr_b16 v[78:79], v10 offset:45568
  s_waitcnt lgkmcnt(14)
  v_mfma_f32_16x16x32_bf16 v[40:43], v[80:83], a[192:195], v[40:43]
  s_waitcnt lgkmcnt(12)
  v_mfma_f32_16x16x32_bf16 v[40:43], v[84:87], a[196:199], v[40:43]
  s_waitcnt lgkmcnt(10)
  v_mfma_f32_16x16x32_bf16 v[40:43], v[88:91], a[200:203], v[40:43]
  s_waitcnt lgkmcnt(8)
  v_mfma_f32_16x16x32_bf16 v[40:43], v[92:95], a[204:207], v[40:43]
  v_mfma_f32_16x16x32_bf16 v[44:47], v[80:83], a[208:211], v[44:47]
  ds_read_b64_tr_b16 v[80:81], v11 offset:32768
  ds_read_b64_tr_b16 v[82:83], v11 offset:33280
  v_mfma_f32_16x16x32_bf16 v[44:47], v[84:87], a[212:215], v[44:47]
  ds_read_b64_tr_b16 v[84:85], v11 offset:36864
  ds_read_b64_tr_b16 v[86:87], v11 offset:37376
  v_mfma_f32_16x16x32_bf16 v[44:47], v[88:91], a[216:219], v[44:47]
  ds_read_b64_tr_b16 v[88:89], v11 offset:40960
  ds_read_b64_tr_b16 v[90:91], v11 offset:41472
  v_mfma_f32_16x16x32_bf16 v[44:47], v[92:95], a[220:223], v[44:47]
  ds_read_b64_tr_b16 v[92:93], v11 offset:45056
  ds_read_b64_tr_b16 v[94:95], v11 offset:45568
  s_waitcnt lgkmcnt(14)
  v_mfma_f32_16x16x32_bf16 v[48:51], v[64:67], a[192:195], v[48:51]
  s_waitcnt lgkmcnt(12)
  v_mfma_f32_16x16x32_bf16 v[48:51], v[68:71], a[196:199], v[48:51]
  s_waitcnt lgkmcnt(10)
  v_mfma_f32_16x16x32_bf16 v[48:51], v[72:75], a[200:203], v[48:51]
  s_barrier
  s_waitcnt lgkmcnt(8)
  v_mfma_f32_16x16x32_bf16 v[48:51], v[76:79], a[204:207], v[48:51]
  v_mfma_f32_16x16x32_bf16 v[52:55], v[64:67], a[208:211], v[52:55]
  ds_read_b64_tr_b16 v[64:65], v8 offset:49152
  ds_read_b64_tr_b16 v[66:67], v8 offset:49664
  v_mfma_f32_16x16x32_bf16 v[52:55], v[68:71], a[212:215], v[52:55]
  ds_read_b64_tr_b16 v[68:69], v8 offset:53248
  ds_read_b64_tr_b16 v[70:71], v8 offset:53760
  v_mfma_f32_16x16x32_bf16 v[52:55], v[72:75], a[216:219], v[52:55]
  ds_read_b64_tr_b16 v[72:73], v8 offset:57344
  ds_read_b64_tr_b16 v[74:75], v8 offset:57856
  v_mfma_f32_16x16x32_bf16 v[52:55], v[76:79], a[220:223], v[52:55]
  ds_read_b64_tr_b16 v[76:77], v8 offset:61440
  ds_read_b64_tr_b16 v[78:79], v8 offset:61952
  s_waitcnt lgkmcnt(14)
  v_mfma_f32_16x16x32_bf16 v[56:59], v[80:83], a[192:195], v[56:59]
  s_waitcnt lgkmcnt(12)
  v_mfma_f32_16x16x32_bf16 v[56:59], v[84:87], a[196:199], v[56:59]
  s_waitcnt lgkmcnt(10)
  v_mfma_f32_16x16x32_bf16 v[56:59], v[88:91], a[200:203], v[56:59]
  s_waitcnt lgkmcnt(8)
  v_mfma_f32_16x16x32_bf16 v[56:59], v[92:95], a[204:207], v[56:59]
  v_mfma_f32_16x16x32_bf16 v[60:63], v[80:83], a[208:211], v[60:63]
  v_mfma_f32_16x16x32_bf16 v[60:63], v[84:87], a[212:215], v[60:63]
  v_mfma_f32_16x16x32_bf16 v[60:63], v[88:91], a[216:219], v[60:63]
  v_mfma_f32_16x16x32_bf16 v[60:63], v[92:95], a[220:223], v[60:63]
  s_waitcnt vmcnt(7) lgkmcnt(6)
  v_mfma_f32_16x16x32_bf16 v[32:35], v[64:67], a[224:227], v[32:35]
  ds_read_b64_tr_b16 v[80:81], v9 offset:49152
  ds_read_b64_tr_b16 v[82:83], v9 offset:49664
  s_waitcnt vmcnt(6) lgkmcnt(6)
  v_mfma_f32_16x16x32_bf16 v[32:35], v[68:71], a[228:231], v[32:35]
  ds_read_b64_tr_b16 v[84:85], v9 offset:53248
  ds_read_b64_tr_b16 v[86:87], v9 offset:53760
  s_waitcnt vmcnt(5) lgkmcnt(6)
  v_mfma_f32_16x16x32_bf16 v[32:35], v[72:75], a[232:235], v[32:35]
  ds_read_b64_tr_b16 v[88:89], v9 offset:57344
  ds_read_b64_tr_b16 v[90:91], v9 offset:57856
  s_waitcnt vmcnt(4) lgkmcnt(6)
  v_mfma_f32_16x16x32_bf16 v[32:35], v[76:79], a[236:239], v[32:35]
  ds_read_b64_tr_b16 v[92:93], v9 offset:61440
  ds_read_b64_tr_b16 v[94:95], v9 offset:61952
  s_waitcnt vmcnt(3)
  v_mfma_f32_16x16x32_bf16 v[36:39], v[64:67], a[240:243], v[36:39]
  ds_read_b64_tr_b16 v[64:65], v10 offset:49152
  ds_read_b64_tr_b16 v[66:67], v10 offset:49664
  s_waitcnt vmcnt(2)
  v_mfma_f32_16x16x32_bf16 v[36:39], v[68:71], a[244:247], v[36:39]
  ds_read_b64_tr_b16 v[68:69], v10 offset:53248
  ds_read_b64_tr_b16 v[70:71], v10 offset:53760
  s_waitcnt vmcnt(1)
  v_mfma_f32_16x16x32_bf16 v[36:39], v[72:75], a[248:251], v[36:39]
  ds_read_b64_tr_b16 v[72:73], v10 offset:57344
  ds_read_b64_tr_b16 v[74:75], v10 offset:57856
  s_waitcnt vmcnt(0)
  v_mfma_f32_16x16x32_bf16 v[36:39], v[76:79], a[252:255], v[36:39]
  ds_read_b64_tr_b16 v[76:77], v10 offset:61440
  ds_read_b64_tr_b16 v[78:79], v10 offset:61952
  s_waitcnt lgkmcnt(14)
  v_mfma_f32_16x16x32_bf16 v[40:43], v[80:83], a[224:227], v[40:43]
  s_waitcnt lgkmcnt(12)
  v_mfma_f32_16x16x32_bf16 v[40:43], v[84:87], a[228:231], v[40:43]
  s_waitcnt lgkmcnt(10)
  v_mfma_f32_16x16x32_bf16 v[40:43], v[88:91], a[232:235], v[40:43]
  s_waitcnt lgkmcnt(8)
  v_mfma_f32_16x16x32_bf16 v[40:43], v[92:95], a[236:239], v[40:43]
  v_mfma_f32_16x16x32_bf16 v[44:47], v[80:83], a[240:243], v[44:47]
  ds_read_b64_tr_b16 v[80:81], v11 offset:49152
  ds_read_b64_tr_b16 v[82:83], v11 offset:49664
  v_mfma_f32_16x16x32_bf16 v[44:47], v[84:87], a[244:247], v[44:47]
  ds_read_b64_tr_b16 v[84:85], v11 offset:53248
  ds_read_b64_tr_b16 v[86:87], v11 offset:53760
  v_mfma_f32_16x16x32_bf16 v[44:47], v[88:91], a[248:251], v[44:47]
  ds_read_b64_tr_b16 v[88:89], v11 offset:57344
  ds_read_b64_tr_b16 v[90:91], v11 offset:57856
  v_mfma_f32_16x16x32_bf16 v[44:47], v[92:95], a[252:255], v[44:47]
  ds_read_b64_tr_b16 v[92:93], v11 offset:61440
  ds_read_b64_tr_b16 v[94:95], v11 offset:61952
  s_waitcnt lgkmcnt(14)
  v_mfma_f32_16x16x32_bf16 v[48:51], v[64:67], a[224:227], v[48:51]
  s_waitcnt lgkmcnt(12)
  v_mfma_f32_16x16x32_bf16 v[48:51], v[68:71], a[228:231], v[48:51]
  s_waitcnt lgkmcnt(10)
  v_mfma_f32_16x16x32_bf16 v[48:51], v[72:75], a[232:235], v[48:51]
  s_waitcnt lgkmcnt(8)
  v_mfma_f32_16x16x32_bf16 v[48:51], v[76:79], a[236:239], v[48:51]
  v_mfma_f32_16x16x32_bf16 v[52:55], v[64:67], a[240:243], v[52:55]
  v_mfma_f32_16x16x32_bf16 v[52:55], v[68:71], a[244:247], v[52:55]
  v_mfma_f32_16x16x32_bf16 v[52:55], v[72:75], a[248:251], v[52:55]
  v_mfma_f32_16x16x32_bf16 v[52:55], v[76:79], a[252:255], v[52:55]
  s_waitcnt lgkmcnt(6)
  v_mfma_f32_16x16x32_bf16 v[56:59], v[80:83], a[224:227], v[56:59]
  s_waitcnt lgkmcnt(4)
  v_mfma_f32_16x16x32_bf16 v[56:59], v[84:87], a[228:231], v[56:59]
  s_waitcnt lgkmcnt(2)
  v_mfma_f32_16x16x32_bf16 v[56:59], v[88:91], a[232:235], v[56:59]
  s_waitcnt lgkmcnt(0)
  v_mfma_f32_16x16x32_bf16 v[56:59], v[92:95], a[236:239], v[56:59]
  v_mfma_f32_16x16x32_bf16 v[60:63], v[80:83], a[240:243], v[60:63]
  v_mfma_f32_16x16x32_bf16 v[60:63], v[84:87], a[244:247], v[60:63]
  v_mfma_f32_16x16x32_bf16 v[60:63], v[88:91], a[248:251], v[60:63]
  v_mfma_f32_16x16x32_bf16 v[60:63], v[92:95], a[252:255], v[60:63]
  s_lshl_b32 s3, s32, 7
  s_lshl_b32 s4, s28, 5
  s_add_u32 s3, s3, s4
  s_mul_i32 s3, s3, 1792
  s_mul_i32 s4, s31, 896
  s_add_u32 s3, s3, s4
  s_lshl_b32 s4, s30, 7
  s_add_u32 s3, s3, s4
  s_add_u32 s4, s3, 28672
  v_cvt_pk_bf16_f32 v64, v32, v33
  v_cvt_pk_bf16_f32 v65, v34, v35
  v_cvt_pk_bf16_f32 v66, v40, v41
  v_cvt_pk_bf16_f32 v67, v42, v43
  s_nop 0
  v_permlane16_swap_b32 v64, v66
  v_permlane16_swap_b32 v65, v67
  buffer_store_dwordx4 v[64:67], v12, s[16:19], s3 offen offset:0 sc0 sc1
  v_cvt_pk_bf16_f32 v68, v48, v49
  v_cvt_pk_bf16_f32 v69, v50, v51
  v_cvt_pk_bf16_f32 v70, v56, v57
  v_cvt_pk_bf16_f32 v71, v58, v59
  s_nop 0
  v_permlane16_swap_b32 v68, v70
  v_permlane16_swap_b32 v69, v71
  buffer_store_dwordx4 v[68:71], v12, s[16:19], s3 offen offset:64 sc0 sc1
  v_cvt_pk_bf16_f32 v72, v36, v37
  v_cvt_pk_bf16_f32 v73, v38, v39
  v_cvt_pk_bf16_f32 v74, v44, v45
  v_cvt_pk_bf16_f32 v75, v46, v47
  s_nop 0
  v_permlane16_swap_b32 v72, v74
  v_permlane16_swap_b32 v73, v75
  buffer_store_dwordx4 v[72:75], v12, s[16:19], s4 offen offset:0 sc0 sc1
  v_cvt_pk_bf16_f32 v76, v52, v53
  v_cvt_pk_bf16_f32 v77, v54, v55
  v_cvt_pk_bf16_f32 v78, v60, v61
  v_cvt_pk_bf16_f32 v79, v62, v63
  s_nop 0
  v_permlane16_swap_b32 v76, v78
  v_permlane16_swap_b32 v77, v79
  buffer_store_dwordx4 v[76:79], v12, s[16:19], s4 offen offset:64 sc0 sc1
  s_endpgm
K1_REDO:
  s_waitcnt vmcnt(0) lgkmcnt(0)
  s_barrier
  s_mov_b32 s54, 1
  s_nop 7
  s_branch K1_RESTART
K1_SAFE_P0:
  s_waitcnt vmcnt(0)
  s_waitcnt lgkmcnt(0)
  s_barrier
  s_nop 9
  s_lshl_b32 s30, s28, 7
  s_mov_b32 s31, s30
  s_lshl_b32 s33, s28, 13
  s_add_u32 s32, s33, 98304
  v_mbcnt_lo_u32_b32 v16, -1, 0
  v_mbcnt_hi_u32_b32 v16, -1, v16
  v_and_b32 v17, 15, v16
  v_lshrrev_b32 v18, 4, v16
  v_bfe_u32 v19, v16, 2, 2
  v_and_b32 v20, 3, v16
  v_lshrrev_b32 v21, 3, v16
  v_and_b32 v22, 7, v16
  v_and_b32 v23, 1, v18
  v_lshlrev_b32 v23, 1, v23
  v_lshrrev_b32 v24, 1, v18
  v_or_b32 v23, v23, v24
  v_bfe_u32 v24, v17, 1, 1
  v_and_b32 v25, 4, v17
  v_or_b32 v24, v24, v25
  v_xor_b32 v23, v23, v24
  v_lshlrev_b32 v23, 4, v23
  v_lshlrev_b32 v24, 7, v17
  v_add_u32 v23, v23, v24
  v_add_u32 v1, 98304, v23
  v_xor_b32 v2, 64, v1
  v_mov_b32 v10, 4286578688
  v_mov_b32 v11, 4286578688
  v_mov_b32 v12, 4286578688
  v_mov_b32 v13, 4286578688
  v_mov_b32 v14, 4286578688
  s_mov_b32 s29, 16
  s_nop 3
K1_MAXL_P0:
  s_add_u32 m0, s32, 0
  s_add_u32 s34, s30, 0
  buffer_load_dwordx4 v7, s[8:11], s34 offen nt lds
  s_add_u32 m0, s32, 1024
  s_add_u32 s34, s30, 4096
  buffer_load_dwordx4 v7, s[8:11], s34 offen nt lds
  s_add_u32 m0, s32, 2048
  s_add_u32 s34, s30, 8192
  buffer_load_dwordx4 v7, s[8:11], s34 offen nt lds
  s_add_u32 m0, s32, 3072
  s_add_u32 s34, s30, 12288
  buffer_load_dwordx4 v7, s[8:11], s34 offen nt lds
  s_add_u32 m0, s32, 4096
  s_add_u32 s34, s30, 16384
  buffer_load_dwordx4 v7, s[8:11], s34 offen nt lds
  s_add_u32 m0, s32, 5120
  s_add_u32 s34, s30, 20480
  buffer_load_dwordx4 v7, s[8:11], s34 offen nt lds
  s_add_u32 m0, s32, 6144
  s_add_u32 s34, s30, 24576
  buffer_load_dwordx4 v7, s[8:11], s34 offen nt lds
  s_add_u32 m0, s32, 7168
  s_add_u32 s34, s30, 28672
  buffer_load_dwordx4 v7, s[8:11], s34 offen nt lds
  s_add_u32 s30, s30, 32768
  s_xor_b32 s32, s32, 65536
  s_xor_b32 s32, s32, 65536
  s_waitcnt vmcnt(0)
  s_barrier
  ds_read_b128 v[32:35], v1 offset:0
  ds_read_b128 v[36:39], v2 offset:0
  ds_read_b128 v[40:43], v1 offset:8192
  ds_read_b128 v[44:47], v2 offset:8192
  ds_read_b128 v[48:51], v1 offset:16384
  ds_read_b128 v[52:55], v2 offset:16384
  ds_read_b128 v[56:59], v1 offset:24576
  ds_read_b128 v[60:63], v2 offset:24576
  s_waitcnt lgkmcnt(7)
  v_mfma_f32_16x16x32_bf16 v[16:19], v[32:35], v[128:131], 0
  s_waitcnt lgkmcnt(6)
  v_mfma_f32_16x16x32_bf16 v[16:19], v[36:39], v[132:135], v[16:19]
  s_waitcnt lgkmcnt(5)
  v_mfma_f32_16x16x32_bf16 v[16:19], v[40:43], v[136:139], v[16:19]
  s_waitcnt lgkmcnt(4)
  v_mfma_f32_16x16x32_bf16 v[16:19], v[44:47], v[140:143], v[16:19]
  s_waitcnt lgkmcnt(3)
  v_mfma_f32_16x16x32_bf16 v[16:19], v[48:51], v[144:147], v[16:19]
  s_waitcnt lgkmcnt(2)
  v_mfma_f32_16x16x32_bf16 v[16:19], v[52:55], v[148:151], v[16:19]
  s_waitcnt lgkmcnt(1)
  v_mfma_f32_16x16x32_bf16 v[16:19], v[56:59], v[152:155], v[16:19]
  s_waitcnt lgkmcnt(0)
  v_mfma_f32_16x16x32_bf16 v[16:19], v[60:63], v[156:159], v[16:19]
  s_nop 7
  v_max3_f32 v10, v16, v17, v10
  v_max3_f32 v10, v18, v19, v10
  v_mfma_f32_16x16x32_bf16 v[20:23], v[32:35], v[160:163], 0
  v_mfma_f32_16x16x32_bf16 v[20:23], v[36:39], v[164:167], v[20:23]
  v_mfma_f32_16x16x32_bf16 v[20:23], v[40:43], v[168:171], v[20:23]
  v_mfma_f32_16x16x32_bf16 v[20:23], v[44:47], v[172:175], v[20:23]
  v_mfma_f32_16x16x32_bf16 v[20:23], v[48:51], v[176:179], v[20:23]
  v_mfma_f32_16x16x32_bf16 v[20:23], v[52:55], v[180:183], v[20:23]
  v_mfma_f32_16x16x32_bf16 v[20:23], v[56:59], v[184:187], v[20:23]
  v_mfma_f32_16x16x32_bf16 v[20:23], v[60:63], v[188:191], v[20:23]
  s_nop 7
  v_max3_f32 v11, v20, v21, v11
  v_max3_f32 v11, v22, v23, v11
  v_mfma_f32_16x16x32_bf16 v[16:19], v[32:35], v[192:195], 0
  v_mfma_f32_16x16x32_bf16 v[16:19], v[36:39], v[196:199], v[16:19]
  v_mfma_f32_16x16x32_bf16 v[16:19], v[40:43], v[200:203], v[16:19]
  v_mfma_f32_16x16x32_bf16 v[16:19], v[44:47], v[204:207], v[16:19]
  v_mfma_f32_16x16x32_bf16 v[16:19], v[48:51], v[208:211], v[16:19]
  v_mfma_f32_16x16x32_bf16 v[16:19], v[52:55], v[212:215], v[16:19]
  v_mfma_f32_16x16x32_bf16 v[16:19], v[56:59], v[216:219], v[16:19]
  v_mfma_f32_16x16x32_bf16 v[16:19], v[60:63], v[220:223], v[16:19]
  s_nop 7
  v_max3_f32 v12, v16, v17, v12
  v_max3_f32 v12, v18, v19, v12
  v_mfma_f32_16x16x32_bf16 v[20:23], v[32:35], v[224:227], 0
  v_mfma_f32_16x16x32_bf16 v[20:23], v[36:39], v[228:231], v[20:23]
  v_mfma_f32_16x16x32_bf16 v[20:23], v[40:43], v[232:235], v[20:23]
  v_mfma_f32_16x16x32_bf16 v[20:23], v[44:47], v[236:239], v[20:23]
  v_mfma_f32_16x16x32_bf16 v[20:23], v[48:51], v[240:243], v[20:23]
  v_mfma_f32_16x16x32_bf16 v[20:23], v[52:55], v[244:247], v[20:23]
  v_mfma_f32_16x16x32_bf16 v[20:23], v[56:59], v[248:251], v[20:23]
  v_mfma_f32_16x16x32_bf16 v[20:23], v[60:63], v[252:255], v[20:23]
  s_nop 7
  v_max3_f32 v13, v20, v21, v13
  v_max3_f32 v13, v22, v23, v13
  ds_read_b128 v[64:67], v9 offset:0
  ds_read_b128 v[68:71], v9 offset:1024
  ds_read_b128 v[72:75], v9 offset:2048
  ds_read_b128 v[76:79], v9 offset:3072
  ds_read_b128 v[80:83], v9 offset:4096
  ds_read_b128 v[84:87], v9 offset:5120
  ds_read_b128 v[88:91], v9 offset:6144
  ds_read_b128 v[92:95], v9 offset:7168
  s_waitcnt lgkmcnt(7)
  v_mfma_f32_16x16x32_bf16 v[16:19], v[32:35], v[64:67], 0
  s_waitcnt lgkmcnt(6)
  v_mfma_f32_16x16x32_bf16 v[16:19], v[36:39], v[68:71], v[16:19]
  s_waitcnt lgkmcnt(5)
  v_mfma_f32_16x16x32_bf16 v[16:19], v[40:43], v[72:75], v[16:19]
  s_waitcnt lgkmcnt(4)
  v_mfma_f32_16x16x32_bf16 v[16:19], v[44:47], v[76:79], v[16:19]
  s_waitcnt lgkmcnt(3)
  v_mfma_f32_16x16x32_bf16 v[16:19], v[48:51], v[80:83], v[16:19]
  s_waitcnt lgkmcnt(2)
  v_mfma_f32_16x16x32_bf16 v[16:19], v[52:55], v[84:87], v[16:19]
  s_waitcnt lgkmcnt(1)
  v_mfma_f32_16x16x32_bf16 v[16:19], v[56:59], v[88:91], v[16:19]
  s_waitcnt lgkmcnt(0)
  v_mfma_f32_16x16x32_bf16 v[16:19], v[60:63], v[92:95], v[16:19]
  s_nop 7
  v_max3_f32 v14, v16, v17, v14
  v_max3_f32 v14, v18, v19, v14
  ds_read_b128 v[32:35], v1 offset:2048
  ds_read_b128 v[36:39], v2 offset:2048
  ds_read_b128 v[40:43], v1 offset:10240
  ds_read_b128 v[44:47], v2 offset:10240
  ds_read_b128 v[48:51], v1 offset:18432
  ds_read_b128 v[52:55], v2 offset:18432
  ds_read_b128 v[56:59], v1 offset:26624
  ds_read_b128 v[60:63], v2 offset:26624
  s_waitcnt lgkmcnt(7)
  v_mfma_f32_16x16x32_bf16 v[20:23], v[32:35], v[128:131], 0
  s_waitcnt lgkmcnt(6)
  v_mfma_f32_16x16x32_bf16 v[20:23], v[36:39], v[132:135], v[20:23]
  s_waitcnt lgkmcnt(5)
  v_mfma_f32_16x16x32_bf16 v[20:23], v[40:43], v[136:139], v[20:23]
  s_waitcnt lgkmcnt(4)
  v_mfma_f32_16x16x32_bf16 v[20:23], v[44:47], v[140:143], v[20:23]
  s_waitcnt lgkmcnt(3)
  v_mfma_f32_16x16x32_bf16 v[20:23], v[48:51], v[144:147], v[20:23]
  s_waitcnt lgkmcnt(2)
  v_mfma_f32_16x16x32_bf16 v[20:23], v[52:55], v[148:151], v[20:23]
  s_waitcnt lgkmcnt(1)
  v_mfma_f32_16x16x32_bf16 v[20:23], v[56:59], v[152:155], v[20:23]
  s_waitcnt lgkmcnt(0)
  v_mfma_f32_16x16x32_bf16 v[20:23], v[60:63], v[156:159], v[20:23]
  s_nop 7
  v_max3_f32 v10, v20, v21, v10
  v_max3_f32 v10, v22, v23, v10
  v_mfma_f32_16x16x32_bf16 v[16:19], v[32:35], v[160:163], 0
  v_mfma_f32_16x16x32_bf16 v[16:19], v[36:39], v[164:167], v[16:19]
  v_mfma_f32_16x16x32_bf16 v[16:19], v[40:43], v[168:171], v[16:19]
  v_mfma_f32_16x16x32_bf16 v[16:19], v[44:47], v[172:175], v[16:19]
  v_mfma_f32_16x16x32_bf16 v[16:19], v[48:51], v[176:179], v[16:19]
  v_mfma_f32_16x16x32_bf16 v[16:19], v[52:55], v[180:183], v[16:19]
  v_mfma_f32_16x16x32_bf16 v[16:19], v[56:59], v[184:187], v[16:19]
  v_mfma_f32_16x16x32_bf16 v[16:19], v[60:63], v[188:191], v[16:19]
  s_nop 7
  v_max3_f32 v11, v16, v17, v11
  v_max3_f32 v11, v18, v19, v11
  v_mfma_f32_16x16x32_bf16 v[20:23], v[32:35], v[192:195], 0
  v_mfma_f32_16x16x32_bf16 v[20:23], v[36:39], v[196:199], v[20:23]
  v_mfma_f32_16x16x32_bf16 v[20:23], v[40:43], v[200:203], v[20:23]
  v_mfma_f32_16x16x32_bf16 v[20:23], v[44:47], v[204:207], v[20:23]
  v_mfma_f32_16x16x32_bf16 v[20:23], v[48:51], v[208:211], v[20:23]
  v_mfma_f32_16x16x32_bf16 v[20:23], v[52:55], v[212:215], v[20:23]
  v_mfma_f32_16x16x32_bf16 v[20:23], v[56:59], v[216:219], v[20:23]
  v_mfma_f32_16x16x32_bf16 v[20:23], v[60:63], v[220:223], v[20:23]
  s_nop 7
  v_max3_f32 v12, v20, v21, v12
  v_max3_f32 v12, v22, v23, v12
  v_mfma_f32_16x16x32_bf16 v[16:19], v[32:35], v[224:227], 0
  v_mfma_f32_16x16x32_bf16 v[16:19], v[36:39], v[228:231], v[16:19]
  v_mfma_f32_16x16x32_bf16 v[16:19], v[40:43], v[232:235], v[16:19]
  v_mfma_f32_16x16x32_bf16 v[16:19], v[44:47], v[236:239], v[16:19]
  v_mfma_f32_16x16x32_bf16 v[16:19], v[48:51], v[240:243], v[16:19]
  v_mfma_f32_16x16x32_bf16 v[16:19], v[52:55], v[244:247], v[16:19]
  v_mfma_f32_16x16x32_bf16 v[16:19], v[56:59], v[248:251], v[16:19]
  v_mfma_f32_16x16x32_bf16 v[16:19], v[60:63], v[252:255], v[16:19]
  s_nop 7
  v_max3_f32 v13, v16, v17, v13
  v_max3_f32 v13, v18, v19, v13
  ds_read_b128 v[64:67], v9 offset:0
  ds_read_b128 v[68:71], v9 offset:1024
  ds_read_b128 v[72:75], v9 offset:2048
  ds_read_b128 v[76:79], v9 offset:3072
  ds_read_b128 v[80:83], v9 offset:4096
  ds_read_b128 v[84:87], v9 offset:5120
  ds_read_b128 v[88:91], v9 offset:6144
  ds_read_b128 v[92:95], v9 offset:7168
  s_waitcnt lgkmcnt(7)
  v_mfma_f32_16x16x32_bf16 v[20:23], v[32:35], v[64:67], 0
  s_waitcnt lgkmcnt(6)
  v_mfma_f32_16x16x32_bf16 v[20:23], v[36:39], v[68:71], v[20:23]
  s_waitcnt lgkmcnt(5)
  v_mfma_f32_16x16x32_bf16 v[20:23], v[40:43], v[72:75], v[20:23]
  s_waitcnt lgkmcnt(4)
  v_mfma_f32_16x16x32_bf16 v[20:23], v[44:47], v[76:79], v[20:23]
  s_waitcnt lgkmcnt(3)
  v_mfma_f32_16x16x32_bf16 v[20:23], v[48:51], v[80:83], v[20:23]
  s_waitcnt lgkmcnt(2)
  v_mfma_f32_16x16x32_bf16 v[20:23], v[52:55], v[84:87], v[20:23]
  s_waitcnt lgkmcnt(1)
  v_mfma_f32_16x16x32_bf16 v[20:23], v[56:59], v[88:91], v[20:23]
  s_waitcnt lgkmcnt(0)
  v_mfma_f32_16x16x32_bf16 v[20:23], v[60:63], v[92:95], v[20:23]
  s_nop 7
  v_max3_f32 v14, v20, v21, v14
  v_max3_f32 v14, v22, v23, v14
  ds_read_b128 v[32:35], v1 offset:4096
  ds_read_b128 v[36:39], v2 offset:4096
  ds_read_b128 v[40:43], v1 offset:12288
  ds_read_b128 v[44:47], v2 offset:12288
  ds_read_b128 v[48:51], v1 offset:20480
  ds_read_b128 v[52:55], v2 offset:20480
  ds_read_b128 v[56:59], v1 offset:28672
  ds_read_b128 v[60:63], v2 offset:28672
  s_waitcnt lgkmcnt(7)
  v_mfma_f32_16x16x32_bf16 v[16:19], v[32:35], v[128:131], 0
  s_waitcnt lgkmcnt(6)
  v_mfma_f32_16x16x32_bf16 v[16:19], v[36:39], v[132:135], v[16:19]
  s_waitcnt lgkmcnt(5)
  v_mfma_f32_16x16x32_bf16 v[16:19], v[40:43], v[136:139], v[16:19]
  s_waitcnt lgkmcnt(4)
  v_mfma_f32_16x16x32_bf16 v[16:19], v[44:47], v[140:143], v[16:19]
  s_waitcnt lgkmcnt(3)
  v_mfma_f32_16x16x32_bf16 v[16:19], v[48:51], v[144:147], v[16:19]
  s_waitcnt lgkmcnt(2)
  v_mfma_f32_16x16x32_bf16 v[16:19], v[52:55], v[148:151], v[16:19]
  s_waitcnt lgkmcnt(1)
  v_mfma_f32_16x16x32_bf16 v[16:19], v[56:59], v[152:155], v[16:19]
  s_waitcnt lgkmcnt(0)
  v_mfma_f32_16x16x32_bf16 v[16:19], v[60:63], v[156:159], v[16:19]
  s_nop 7
  v_max3_f32 v10, v16, v17, v10
  v_max3_f32 v10, v18, v19, v10
  v_mfma_f32_16x16x32_bf16 v[20:23], v[32:35], v[160:163], 0
  v_mfma_f32_16x16x32_bf16 v[20:23], v[36:39], v[164:167], v[20:23]
  v_mfma_f32_16x16x32_bf16 v[20:23], v[40:43], v[168:171], v[20:23]
  v_mfma_f32_16x16x32_bf16 v[20:23], v[44:47], v[172:175], v[20:23]
  v_mfma_f32_16x16x32_bf16 v[20:23], v[48:51], v[176:179], v[20:23]
  v_mfma_f32_16x16x32_bf16 v[20:23], v[52:55], v[180:183], v[20:23]
  v_mfma_f32_16x16x32_bf16 v[20:23], v[56:59], v[184:187], v[20:23]
  v_mfma_f32_16x16x32_bf16 v[20:23], v[60:63], v[188:191], v[20:23]
  s_nop 7
  v_max3_f32 v11, v20, v21, v11
  v_max3_f32 v11, v22, v23, v11
  v_mfma_f32_16x16x32_bf16 v[16:19], v[32:35], v[192:195], 0
  v_mfma_f32_16x16x32_bf16 v[16:19], v[36:39], v[196:199], v[16:19]
  v_mfma_f32_16x16x32_bf16 v[16:19], v[40:43], v[200:203], v[16:19]
  v_mfma_f32_16x16x32_bf16 v[16:19], v[44:47], v[204:207], v[16:19]
  v_mfma_f32_16x16x32_bf16 v[16:19], v[48:51], v[208:211], v[16:19]
  v_mfma_f32_16x16x32_bf16 v[16:19], v[52:55], v[212:215], v[16:19]
  v_mfma_f32_16x16x32_bf16 v[16:19], v[56:59], v[216:219], v[16:19]
  v_mfma_f32_16x16x32_bf16 v[16:19], v[60:63], v[220:223], v[16:19]
  s_nop 7
  v_max3_f32 v12, v16, v17, v12
  v_max3_f32 v12, v18, v19, v12
  v_mfma_f32_16x16x32_bf16 v[20:23], v[32:35], v[224:227], 0
  v_mfma_f32_16x16x32_bf16 v[20:23], v[36:39], v[228:231], v[20:23]
  v_mfma_f32_16x16x32_bf16 v[20:23], v[40:43], v[232:235], v[20:23]
  v_mfma_f32_16x16x32_bf16 v[20:23], v[44:47], v[236:239], v[20:23]
  v_mfma_f32_16x16x32_bf16 v[20:23], v[48:51], v[240:243], v[20:23]
  v_mfma_f32_16x16x32_bf16 v[20:23], v[52:55], v[244:247], v[20:23]
  v_mfma_f32_16x16x32_bf16 v[20:23], v[56:59], v[248:251], v[20:23]
  v_mfma_f32_16x16x32_bf16 v[20:23], v[60:63], v[252:255], v[20:23]
  s_nop 7
  v_max3_f32 v13, v20, v21, v13
  v_max3_f32 v13, v22, v23, v13
  ds_read_b128 v[32:35], v1 offset:6144
  ds_read_b128 v[36:39], v2 offset:6144
  ds_read_b128 v[40:43], v1 offset:14336
  ds_read_b128 v[44:47], v2 offset:14336
  ds_read_b128 v[48:51], v1 offset:22528
  ds_read_b128 v[52:55], v2 offset:22528
  ds_read_b128 v[56:59], v1 offset:30720
  ds_read_b128 v[60:63], v2 offset:30720
  s_waitcnt lgkmcnt(7)
  v_mfma_f32_16x16x32_bf16 v[16:19], v[32:35], v[128:131], 0
  s_waitcnt lgkmcnt(6)
  v_mfma_f32_16x16x32_bf16 v[16:19], v[36:39], v[132:135], v[16:19]
  s_waitcnt lgkmcnt(5)
  v_mfma_f32_16x16x32_bf16 v[16:19], v[40:43], v[136:139], v[16:19]
  s_waitcnt lgkmcnt(4)
  v_mfma_f32_16x16x32_bf16 v[16:19], v[44:47], v[140:143], v[16:19]
  s_waitcnt lgkmcnt(3)
  v_mfma_f32_16x16x32_bf16 v[16:19], v[48:51], v[144:147], v[16:19]
  s_waitcnt lgkmcnt(2)
  v_mfma_f32_16x16x32_bf16 v[16:19], v[52:55], v[148:151], v[16:19]
  s_waitcnt lgkmcnt(1)
  v_mfma_f32_16x16x32_bf16 v[16:19], v[56:59], v[152:155], v[16:19]
  s_waitcnt lgkmcnt(0)
  v_mfma_f32_16x16x32_bf16 v[16:19], v[60:63], v[156:159], v[16:19]
  s_nop 7
  v_max3_f32 v10, v16, v17, v10
  v_max3_f32 v10, v18, v19, v10
  v_mfma_f32_16x16x32_bf16 v[20:23], v[32:35], v[160:163], 0
  v_mfma_f32_16x16x32_bf16 v[20:23], v[36:39], v[164:167], v[20:23]
  v_mfma_f32_16x16x32_bf16 v[20:23], v[40:43], v[168:171], v[20:23]
  v_mfma_f32_16x16x32_bf16 v[20:23], v[44:47], v[172:175], v[20:23]
  v_mfma_f32_16x16x32_bf16 v[20:23], v[48:51], v[176:179], v[20:23]
  v_mfma_f32_16x16x32_bf16 v[20:23], v[52:55], v[180:183], v[20:23]
  v_mfma_f32_16x16x32_bf16 v[20:23], v[56:59], v[184:187], v[20:23]
  v_mfma_f32_16x16x32_bf16 v[20:23], v[60:63], v[188:191], v[20:23]
  s_nop 7
  v_max3_f32 v11, v20, v21, v11
  v_max3_f32 v11, v22, v23, v11
  v_mfma_f32_16x16x32_bf16 v[16:19], v[32:35], v[192:195], 0
  v_mfma_f32_16x16x32_bf16 v[16:19], v[36:39], v[196:199], v[16:19]
  v_mfma_f32_16x16x32_bf16 v[16:19], v[40:43], v[200:203], v[16:19]
  v_mfma_f32_16x16x32_bf16 v[16:19], v[44:47], v[204:207], v[16:19]
  v_mfma_f32_16x16x32_bf16 v[16:19], v[48:51], v[208:211], v[16:19]
  v_mfma_f32_16x16x32_bf16 v[16:19], v[52:55], v[212:215], v[16:19]
  v_mfma_f32_16x16x32_bf16 v[16:19], v[56:59], v[216:219], v[16:19]
  v_mfma_f32_16x16x32_bf16 v[16:19], v[60:63], v[220:223], v[16:19]
  s_nop 7
  v_max3_f32 v12, v16, v17, v12
  v_max3_f32 v12, v18, v19, v12
  v_mfma_f32_16x16x32_bf16 v[20:23], v[32:35], v[224:227], 0
  v_mfma_f32_16x16x32_bf16 v[20:23], v[36:39], v[228:231], v[20:23]
  v_mfma_f32_16x16x32_bf16 v[20:23], v[40:43], v[232:235], v[20:23]
  v_mfma_f32_16x16x32_bf16 v[20:23], v[44:47], v[236:239], v[20:23]
  v_mfma_f32_16x16x32_bf16 v[20:23], v[48:51], v[240:243], v[20:23]
  v_mfma_f32_16x16x32_bf16 v[20:23], v[52:55], v[244:247], v[20:23]
  v_mfma_f32_16x16x32_bf16 v[20:23], v[56:59], v[248:251], v[20:23]
  v_mfma_f32_16x16x32_bf16 v[20:23], v[60:63], v[252:255], v[20:23]
  s_nop 7
  v_max3_f32 v13, v20, v21, v13
  v_max3_f32 v13, v22, v23, v13
  s_waitcnt lgkmcnt(0)
  s_nop 9
  s_barrier
  s_sub_u32 s29, s29, 1
  s_cmp_lg_u32 s29, 0
  s_cbranch_scc1 K1_MAXL_P0
  v_mov_b32 v15, v10
  s_nop 1
  v_permlane32_swap_b32 v10, v15
  v_max_f32 v10, v10, v15
  v_mov_b32 v15, v10
  s_nop 1
  v_permlane16_swap_b32 v10, v15
  v_max_f32 v10, v10, v15
  v_mov_b32 v15, v11
  s_nop 1
  v_permlane32_swap_b32 v11, v15
  v_max_f32 v11, v11, v15
  v_mov_b32 v15, v11
  s_nop 1
  v_permlane16_swap_b32 v11, v15
  v_max_f32 v11, v11, v15
  v_mov_b32 v15, v12
  s_nop 1
  v_permlane32_swap_b32 v12, v15
  v_max_f32 v12, v12, v15
  v_mov_b32 v15, v12
  s_nop 1
  v_permlane16_swap_b32 v12, v15
  v_max_f32 v12, v12, v15
  v_mov_b32 v15, v13
  s_nop 1
  v_permlane32_swap_b32 v13, v15
  v_max_f32 v13, v13, v15
  v_mov_b32 v15, v13
  s_nop 1
  v_permlane16_swap_b32 v13, v15
  v_max_f32 v13, v13, v15
  v_mov_b32 v15, v14
  s_nop 1
  v_permlane32_swap_b32 v14, v15
  v_max_f32 v14, v14, v15
  v_mov_b32 v15, v14
  s_nop 1
  v_permlane16_swap_b32 v14, v15
  v_max_f32 v14, v14, v15
  ds_write_b32 v9, v14 offset:10240
  s_waitcnt lgkmcnt(0)
  s_barrier
  ds_read_b32 v15, v9 offset:10244
  s_waitcnt lgkmcnt(0)
  v_max_f32 v14, v14, v15
  ds_write_b32 v9, v10 offset:12288
  ds_write_b32 v9, v11 offset:12292
  ds_write_b32 v9, v12 offset:12296
  ds_write_b32 v9, v13 offset:12300
  ds_write_b32 v9, v14 offset:13312
  s_lshl_b32 s30, s28, 7
  s_mov_b32 s31, s30
  s_lshl_b32 s33, s28, 13
  s_add_u32 s32, s33, 98304
  v_mbcnt_lo_u32_b32 v16, -1, 0
  v_mbcnt_hi_u32_b32 v16, -1, v16
  v_and_b32 v17, 15, v16
  v_lshrrev_b32 v18, 4, v16
  v_bfe_u32 v19, v16, 2, 2
  v_and_b32 v20, 3, v16
  v_lshrrev_b32 v21, 3, v16
  v_and_b32 v22, 7, v16
  v_and_b32 v23, 1, v18
  v_lshlrev_b32 v23, 1, v23
  v_lshrrev_b32 v24, 1, v18
  v_or_b32 v23, v23, v24
  v_bfe_u32 v24, v17, 1, 1
  v_and_b32 v25, 4, v17
  v_or_b32 v24, v24, v25
  v_xor_b32 v23, v23, v24
  v_lshlrev_b32 v23, 4, v23
  v_lshlrev_b32 v24, 7, v17
  v_add_u32 v23, v23, v24
  v_add_u32 v1, 98304, v23
  v_xor_b32 v2, 64, v1
  v_lshrrev_b32 v23, 1, v19
  v_and_b32 v24, 1, v18
  v_lshlrev_b32 v24, 1, v24
  v_or_b32 v23, v23, v24
  v_lshlrev_b32 v24, 2, v18
  v_add_u32 v24, v24, v19
  v_lshlrev_b32 v24, 7, v24
  v_lshlrev_b32 v25, 3, v20
  v_add_u32 v24, v24, v25
  v_add_u32 v24, 65536, v24
  v_xor_b32 v25, 0, v23
  v_lshlrev_b32 v25, 5, v25
  v_add_u32 v3, v24, v25
  v_xor_b32 v25, 1, v23
  v_lshlrev_b32 v25, 5, v25
  v_add_u32 v4, v24, v25
  v_xor_b32 v25, 2, v23
  v_lshlrev_b32 v25, 5, v25
  v_add_u32 v5, v24, v25
  v_xor_b32 v25, 3, v23
  v_lshlrev_b32 v25, 5, v25
  v_add_u32 v6, v24, v25
  v_mov_b32 v10, 0
  v_mov_b32 v11, 0
  v_mov_b32 v12, 0
  v_mov_b32 v13, 0
  v_mov_b32 v14, 0
  s_add_u32 m0, s32, 0
  s_add_u32 s34, s30, 0
  buffer_load_dwordx4 v7, s[8:11], s34 offen nt lds
  s_add_u32 m0, s32, 1024
  s_add_u32 s34, s30, 4096
  buffer_load_dwordx4 v7, s[8:11], s34 offen nt lds
  s_add_u32 m0, s32, 2048
  s_add_u32 s34, s30, 8192
  buffer_load_dwordx4 v7, s[8:11], s34 offen nt lds
  s_add_u32 m0, s32, 3072
  s_add_u32 s34, s30, 12288
  buffer_load_dwordx4 v7, s[8:11], s34 offen nt lds
  s_add_u32 m0, s32, 4096
  s_add_u32 s34, s30, 16384
  buffer_load_dwordx4 v7, s[8:11], s34 offen nt lds
  s_add_u32 m0, s32, 5120
  s_add_u32 s34, s30, 20480
  buffer_load_dwordx4 v7, s[8:11], s34 offen nt lds
  s_add_u32 m0, s32, 6144
  s_add_u32 s34, s30, 24576
  buffer_load_dwordx4 v7, s[8:11], s34 offen nt lds
  s_add_u32 m0, s32, 7168
  s_add_u32 s34, s30, 28672
  buffer_load_dwordx4 v7, s[8:11], s34 offen nt lds
  s_add_u32 s30, s30, 32768
  s_xor_b32 s32, s32, 65536
  s_add_u32 m0, s33, 0
  s_add_u32 s34, s31, 0
  buffer_load_dwordx4 v8, s[12:15], s34 offen nt lds
  s_add_u32 m0, s33, 1024
  s_add_u32 s34, s31, 4096
  buffer_load_dwordx4 v8, s[12:15], s34 offen nt lds
  s_add_u32 m0, s33, 2048
  s_add_u32 s34, s31, 8192
  buffer_load_dwordx4 v8, s[12:15], s34 offen nt lds
  s_add_u32 m0, s33, 3072
  s_add_u32 s34, s31, 12288
  buffer_load_dwordx4 v8, s[12:15], s34 offen nt lds
  s_add_u32 m0, s33, 4096
  s_add_u32 s34, s31, 16384
  buffer_load_dwordx4 v8, s[12:15], s34 offen nt lds
  s_add_u32 m0, s33, 5120
  s_add_u32 s34, s31, 20480
  buffer_load_dwordx4 v8, s[12:15], s34 offen nt lds
  s_add_u32 m0, s33, 6144
  s_add_u32 s34, s31, 24576
  buffer_load_dwordx4 v8, s[12:15], s34 offen nt lds
  s_add_u32 m0, s33, 7168
  s_add_u32 s34, s31, 28672
  buffer_load_dwordx4 v8, s[12:15], s34 offen nt lds
  s_add_u32 s31, s31, 32768
  s_xor_b32 s33, s33, 65536
  s_add_u32 m0, s32, 0
  s_add_u32 s34, s30, 0
  buffer_load_dwordx4 v7, s[8:11], s34 offen nt lds
  s_add_u32 m0, s32, 1024
  s_add_u32 s34, s30, 4096
  buffer_load_dwordx4 v7, s[8:11], s34 offen nt lds
  s_add_u32 m0, s32, 2048
  s_add_u32 s34, s30, 8192
  buffer_load_dwordx4 v7, s[8:11], s34 offen nt lds
  s_add_u32 m0, s32, 3072
  s_add_u32 s34, s30, 12288
  buffer_load_dwordx4 v7, s[8:11], s34 offen nt lds
  s_add_u32 m0, s32, 4096
  s_add_u32 s34, s30, 16384
  buffer_load_dwordx4 v7, s[8:11], s34 offen nt lds
  s_add_u32 m0, s32, 5120
  s_add_u32 s34, s30, 20480
  buffer_load_dwordx4 v7, s[8:11], s34 offen nt lds
  s_add_u32 m0, s32, 6144
  s_add_u32 s34, s30, 24576
  buffer_load_dwordx4 v7, s[8:11], s34 offen nt lds
  s_add_u32 m0, s32, 7168
  s_add_u32 s34, s30, 28672
  buffer_load_dwordx4 v7, s[8:11], s34 offen nt lds
  s_add_u32 s30, s30, 32768
  s_xor_b32 s32, s32, 65536
  s_waitcnt lgkmcnt(0)
  s_waitcnt vmcnt(16)
  s_barrier
  ds_read_b128 v[32:35], v1 offset:0
  ds_read_b128 v[36:39], v2 offset:0
  ds_read_b128 v[40:43], v1 offset:8192
  ds_read_b128 v[44:47], v2 offset:8192
  ds_read_b128 v[48:51], v1 offset:16384
  ds_read_b128 v[52:55], v2 offset:16384
  ds_read_b128 v[56:59], v1 offset:24576
  ds_read_b128 v[60:63], v2 offset:24576
  s_waitcnt lgkmcnt(7)
  v_mfma_f32_16x16x32_bf16 v[16:19], v[32:35], v[128:131], 0
  ds_read_b128 v[80:83], v9 offset:0
  ds_read_b128 v[84:87], v9 offset:1024
  s_waitcnt lgkmcnt(8)
  v_mfma_f32_16x16x32_bf16 v[16:19], v[36:39], v[132:135], v[16:19]
  ds_read_b128 v[88:91], v9 offset:2048
  ds_read_b128 v[92:95], v9 offset:3072
  s_waitcnt lgkmcnt(9)
  v_mfma_f32_16x16x32_bf16 v[16:19], v[40:43], v[136:139], v[16:19]
  v_xor_b32 v3, 65536, v3
  v_xor_b32 v4, 65536, v4
  s_waitcnt lgkmcnt(8)
  v_mfma_f32_16x16x32_bf16 v[16:19], v[44:47], v[140:143], v[16:19]
  v_xor_b32 v5, 65536, v5
  v_xor_b32 v6, 65536, v6
  s_waitcnt lgkmcnt(7)
  v_mfma_f32_16x16x32_bf16 v[16:19], v[48:51], v[144:147], v[16:19]
  s_waitcnt lgkmcnt(6)
  v_mfma_f32_16x16x32_bf16 v[16:19], v[52:55], v[148:151], v[16:19]
  s_waitcnt lgkmcnt(5)
  v_mfma_f32_16x16x32_bf16 v[16:19], v[56:59], v[152:155], v[16:19]
  s_waitcnt lgkmcnt(4)
  v_mfma_f32_16x16x32_bf16 v[16:19], v[60:63], v[156:159], v[16:19]
  v_mfma_f32_16x16x32_bf16 v[20:23], v[32:35], v[160:163], 0
  ds_read_b128 v[24:27], v1 offset:2048
  v_mfma_f32_16x16x32_bf16 v[20:23], v[36:39], v[164:167], v[20:23]
  ds_read_b128 v[28:31], v2 offset:2048
  v_mfma_f32_16x16x32_bf16 v[20:23], v[40:43], v[168:171], v[20:23]
  ds_read_b32 v0, v9 offset:12288
  s_waitcnt lgkmcnt(0)
  s_nop 0
  v_sub_f32 v16, v16, v0
  v_mfma_f32_16x16x32_bf16 v[20:23], v[44:47], v[172:175], v[20:23]
  v_sub_f32 v17, v17, v0
  v_sub_f32 v18, v18, v0
  v_mfma_f32_16x16x32_bf16 v[20:23], v[48:51], v[176:179], v[20:23]
  v_sub_f32 v19, v19, v0
  v_mfma_f32_16x16x32_bf16 v[20:23], v[52:55], v[180:183], v[20:23]
  v_exp_f32 v16, v16
  v_mfma_f32_16x16x32_bf16 v[20:23], v[56:59], v[184:187], v[20:23]
  v_exp_f32 v17, v17
  v_mfma_f32_16x16x32_bf16 v[20:23], v[60:63], v[188:191], v[20:23]
  v_exp_f32 v18, v18
  v_exp_f32 v19, v19
  v_add_f32 v10, v10, v16
  v_add_f32 v10, v10, v17
  v_add_f32 v10, v10, v18
  v_add_f32 v10, v10, v19
  v_cvt_pk_bf16_f32 v64, v16, v17
  v_cvt_pk_bf16_f32 v65, v18, v19
  v_mfma_f32_16x16x32_bf16 v[16:19], v[32:35], v[192:195], 0
  v_mfma_f32_16x16x32_bf16 v[16:19], v[36:39], v[196:199], v[16:19]
  v_mfma_f32_16x16x32_bf16 v[16:19], v[40:43], v[200:203], v[16:19]
  ds_read_b32 v15, v9 offset:12292
  s_waitcnt lgkmcnt(0)
  v_sub_f32 v20, v20, v15
  v_mfma_f32_16x16x32_bf16 v[16:19], v[44:47], v[204:207], v[16:19]
  v_sub_f32 v21, v21, v15
  v_sub_f32 v22, v22, v15
  v_mfma_f32_16x16x32_bf16 v[16:19], v[48:51], v[208:211], v[16:19]
  v_sub_f32 v23, v23, v15
  v_mfma_f32_16x16x32_bf16 v[16:19], v[52:55], v[212:215], v[16:19]
  v_exp_f32 v20, v20
  v_mfma_f32_16x16x32_bf16 v[16:19], v[56:59], v[216:219], v[16:19]
  v_exp_f32 v21, v21
  v_mfma_f32_16x16x32_bf16 v[16:19], v[60:63], v[220:223], v[16:19]
  v_exp_f32 v22, v22
  v_exp_f32 v23, v23
  v_add_f32 v11, v11, v20
  v_add_f32 v11, v11, v21
  v_add_f32 v11, v11, v22
  v_add_f32 v11, v11, v23
  v_cvt_pk_bf16_f32 v68, v20, v21
  v_cvt_pk_bf16_f32 v69, v22, v23
  v_mfma_f32_16x16x32_bf16 v[20:23], v[32:35], v[224:227], 0
  v_mfma_f32_16x16x32_bf16 v[20:23], v[36:39], v[228:231], v[20:23]
  v_mfma_f32_16x16x32_bf16 v[20:23], v[40:43], v[232:235], v[20:23]
  ds_read_b32 v0, v9 offset:12296
  s_waitcnt lgkmcnt(0)
  v_sub_f32 v16, v16, v0
  v_mfma_f32_16x16x32_bf16 v[20:23], v[44:47], v[236:239], v[20:23]
  v_sub_f32 v17, v17, v0
  v_sub_f32 v18, v18, v0
  v_mfma_f32_16x16x32_bf16 v[20:23], v[48:51], v[240:243], v[20:23]
  v_sub_f32 v19, v19, v0
  v_mfma_f32_16x16x32_bf16 v[20:23], v[52:55], v[244:247], v[20:23]
  v_exp_f32 v16, v16
  v_mfma_f32_16x16x32_bf16 v[20:23], v[56:59], v[248:251], v[20:23]
  v_exp_f32 v17, v17
  v_mfma_f32_16x16x32_bf16 v[20:23], v[60:63], v[252:255], v[20:23]
  v_exp_f32 v18, v18
  v_exp_f32 v19, v19
  v_add_f32 v12, v12, v16
  v_add_f32 v12, v12, v17
  v_add_f32 v12, v12, v18
  v_add_f32 v12, v12, v19
  v_cvt_pk_bf16_f32 v72, v16, v17
  v_cvt_pk_bf16_f32 v73, v18, v19
  v_mfma_f32_16x16x32_bf16 v[16:19], v[32:35], v[80:83], 0
  ds_read_b128 v[80:83], v9 offset:4096
  ds_read_b128 v[32:35], v1 offset:10240
  v_mfma_f32_16x16x32_bf16 v[16:19], v[36:39], v[84:87], v[16:19]
  ds_read_b128 v[84:87], v9 offset:5120
  ds_read_b128 v[36:39], v2 offset:10240
  v_mfma_f32_16x16x32_bf16 v[16:19], v[40:43], v[88:91], v[16:19]
  ds_read_b128 v[88:91], v9 offset:6144
  ds_read_b128 v[40:43], v1 offset:18432
  v_mfma_f32_16x16x32_bf16 v[16:19], v[44:47], v[92:95], v[16:19]
  ds_read_b128 v[92:95], v9 offset:7168
  ds_read_b128 v[44:47], v2 offset:18432
  s_waitcnt lgkmcnt(7)
  v_mfma_f32_16x16x32_bf16 v[16:19], v[48:51], v[80:83], v[16:19]
  ds_read_b128 v[48:51], v1 offset:26624
  ds_read_b32 v15, v9 offset:12300
  s_waitcnt lgkmcnt(7)
  v_mfma_f32_16x16x32_bf16 v[16:19], v[52:55], v[84:87], v[16:19]
  ds_read_b128 v[52:55], v2 offset:26624
  s_waitcnt lgkmcnt(1)
  v_sub_f32 v20, v20, v15
  v_mfma_f32_16x16x32_bf16 v[16:19], v[56:59], v[88:91], v[16:19]
  v_sub_f32 v21, v21, v15
  v_sub_f32 v22, v22, v15
  v_mfma_f32_16x16x32_bf16 v[16:19], v[60:63], v[92:95], v[16:19]
  v_sub_f32 v23, v23, v15
  v_exp_f32 v20, v20
  v_exp_f32 v21, v21
  v_exp_f32 v22, v22
  v_exp_f32 v23, v23
  v_add_f32 v13, v13, v20
  v_add_f32 v13, v13, v21
  v_add_f32 v13, v13, v22
  v_add_f32 v13, v13, v23
  v_cvt_pk_bf16_f32 v76, v20, v21
  v_cvt_pk_bf16_f32 v77, v22, v23
  v_mfma_f32_16x16x32_bf16 v[20:23], v[24:27], v[128:131], 0
  ds_read_b128 v[80:83], v9 offset:0
  ds_read_b128 v[84:87], v9 offset:1024
  v_mfma_f32_16x16x32_bf16 v[20:23], v[28:31], v[132:135], v[20:23]
  ds_read_b128 v[88:91], v9 offset:2048
  ds_read_b128 v[92:95], v9 offset:3072
  v_mfma_f32_16x16x32_bf16 v[20:23], v[32:35], v[136:139], v[20:23]
  ds_read_b32 v0, v9 offset:13312
  s_waitcnt lgkmcnt(0)
  v_sub_f32 v16, v16, v0
  v_mfma_f32_16x16x32_bf16 v[20:23], v[36:39], v[140:143], v[20:23]
  v_sub_f32 v17, v17, v0
  v_sub_f32 v18, v18, v0
  v_mfma_f32_16x16x32_bf16 v[20:23], v[40:43], v[144:147], v[20:23]
  v_sub_f32 v19, v19, v0
  v_mfma_f32_16x16x32_bf16 v[20:23], v[44:47], v[148:151], v[20:23]
  v_exp_f32 v16, v16
  v_mfma_f32_16x16x32_bf16 v[20:23], v[48:51], v[152:155], v[20:23]
  v_exp_f32 v17, v17
  v_mfma_f32_16x16x32_bf16 v[20:23], v[52:55], v[156:159], v[20:23]
  v_exp_f32 v18, v18
  v_exp_f32 v19, v19
  v_add_f32 v14, v14, v16
  v_add_f32 v14, v14, v17
  v_add_f32 v14, v14, v18
  v_add_f32 v14, v14, v19
  v_cvt_pk_bf16_f32 v16, v16, v17
  v_cvt_pk_bf16_f32 v17, v18, v19
  ds_write_b64 v9, v[16:17] offset:8192
  v_mfma_f32_16x16x32_bf16 v[16:19], v[24:27], v[160:163], 0
  ds_read_b128 v[56:59], v1 offset:4096
  v_mfma_f32_16x16x32_bf16 v[16:19], v[28:31], v[164:167], v[16:19]
  ds_read_b128 v[60:63], v2 offset:4096
  v_mfma_f32_16x16x32_bf16 v[16:19], v[32:35], v[168:171], v[16:19]
  ds_read_b32 v15, v9 offset:12288
  s_waitcnt lgkmcnt(0)
  v_sub_f32 v20, v20, v15
  v_mfma_f32_16x16x32_bf16 v[16:19], v[36:39], v[172:175], v[16:19]
  v_sub_f32 v21, v21, v15
  v_sub_f32 v22, v22, v15
  v_mfma_f32_16x16x32_bf16 v[16:19], v[40:43], v[176:179], v[16:19]
  v_sub_f32 v23, v23, v15
  v_mfma_f32_16x16x32_bf16 v[16:19], v[44:47], v[180:183], v[16:19]
  v_exp_f32 v20, v20
  v_mfma_f32_16x16x32_bf16 v[16:19], v[48:51], v[184:187], v[16:19]
  v_exp_f32 v21, v21
  v_mfma_f32_16x16x32_bf16 v[16:19], v[52:55], v[188:191], v[16:19]
  v_exp_f32 v22, v22
  v_exp_f32 v23, v23
  v_add_f32 v10, v10, v20
  v_add_f32 v10, v10, v21
  v_add_f32 v10, v10, v22
  v_add_f32 v10, v10, v23
  v_cvt_pk_bf16_f32 v66, v20, v21
  v_cvt_pk_bf16_f32 v67, v22, v23
  v_mfma_f32_16x16x32_bf16 v[20:23], v[24:27], v[192:195], 0
  v_mfma_f32_16x16x32_bf16 v[20:23], v[28:31], v[196:199], v[20:23]
  v_mfma_f32_16x16x32_bf16 v[20:23], v[32:35], v[200:203], v[20:23]
  ds_read_b32 v0, v9 offset:12292
  s_waitcnt lgkmcnt(0)
  v_sub_f32 v16, v16, v0
  v_mfma_f32_16x16x32_bf16 v[20:23], v[36:39], v[204:207], v[20:23]
  v_sub_f32 v17, v17, v0
  v_sub_f32 v18, v18, v0
  v_mfma_f32_16x16x32_bf16 v[20:23], v[40:43], v[208:211], v[20:23]
  v_sub_f32 v19, v19, v0
  v_mfma_f32_16x16x32_bf16 v[20:23], v[44:47], v[212:215], v[20:23]
  v_exp_f32 v16, v16
  v_mfma_f32_16x16x32_bf16 v[20:23], v[48:51], v[216:219], v[20:23]
  v_exp_f32 v17, v17
  v_mfma_f32_16x16x32_bf16 v[20:23], v[52:55], v[220:223], v[20:23]
  v_exp_f32 v18, v18
  v_exp_f32 v19, v19
  v_add_f32 v11, v11, v16
  v_add_f32 v11, v11, v17
  v_add_f32 v11, v11, v18
  v_add_f32 v11, v11, v19
  v_cvt_pk_bf16_f32 v70, v16, v17
  v_cvt_pk_bf16_f32 v71, v18, v19
  v_mfma_f32_16x16x32_bf16 v[16:19], v[24:27], v[224:227], 0
  v_mfma_f32_16x16x32_bf16 v[16:19], v[28:31], v[228:231], v[16:19]
  v_mfma_f32_16x16x32_bf16 v[16:19], v[32:35], v[232:235], v[16:19]
  ds_read_b32 v15, v9 offset:12296
  s_waitcnt lgkmcnt(0)
  v_sub_f32 v20, v20, v15
  v_mfma_f32_16x16x32_bf16 v[16:19], v[36:39], v[236:239], v[16:19]
  v_sub_f32 v21, v21, v15
  v_sub_f32 v22, v22, v15
  v_mfma_f32_16x16x32_bf16 v[16:19], v[40:43], v[240:243], v[16:19]
  v_sub_f32 v23, v23, v15
  v_mfma_f32_16x16x32_bf16 v[16:19], v[44:47], v[244:247], v[16:19]
  v_exp_f32 v20, v20
  v_mfma_f32_16x16x32_bf16 v[16:19], v[48:51], v[248:251], v[16:19]
  v_exp_f32 v21, v21
  v_mfma_f32_16x16x32_bf16 v[16:19], v[52:55], v[252:255], v[16:19]
  v_exp_f32 v22, v22
  v_exp_f32 v23, v23
  v_add_f32 v12, v12, v20
  v_add_f32 v12, v12, v21
  v_add_f32 v12, v12, v22
  v_add_f32 v12, v12, v23
  v_cvt_pk_bf16_f32 v74, v20, v21
  v_cvt_pk_bf16_f32 v75, v22, v23
  v_mfma_f32_16x16x32_bf16 v[20:23], v[24:27], v[80:83], 0
  ds_read_b128 v[80:83], v9 offset:4096
  ds_read_b128 v[24:27], v1 offset:12288
  v_mfma_f32_16x16x32_bf16 v[20:23], v[28:31], v[84:87], v[20:23]
  ds_read_b128 v[84:87], v9 offset:5120
  ds_read_b128 v[28:31], v2 offset:12288
  v_mfma_f32_16x16x32_bf16 v[20:23], v[32:35], v[88:91], v[20:23]
  ds_read_b128 v[88:91], v9 offset:6144
  ds_read_b128 v[32:35], v1 offset:20480
  v_mfma_f32_16x16x32_bf16 v[20:23], v[36:39], v[92:95], v[20:23]
  ds_read_b128 v[92:95], v9 offset:7168
  ds_read_b128 v[36:39], v2 offset:20480
  s_waitcnt lgkmcnt(7)
  v_mfma_f32_16x16x32_bf16 v[20:23], v[40:43], v[80:83], v[20:23]
  ds_read_b128 v[40:43], v1 offset:28672
  ds_read_b32 v0, v9 offset:12300
  s_waitcnt lgkmcnt(7)
  v_mfma_f32_16x16x32_bf16 v[20:23], v[44:47], v[84:87], v[20:23]
  ds_read_b128 v[44:47], v2 offset:28672
  s_waitcnt lgkmcnt(1)
  v_sub_f32 v16, v16, v0
  v_mfma_f32_16x16x32_bf16 v[20:23], v[48:51], v[88:91], v[20:23]
  v_sub_f32 v17, v17, v0
  v_sub_f32 v18, v18, v0
  v_mfma_f32_16x16x32_bf16 v[20:23], v[52:55], v[92:95], v[20:23]
  v_sub_f32 v19, v19, v0
  v_exp_f32 v16, v16
  v_exp_f32 v17, v17
  v_exp_f32 v18, v18
  v_exp_f32 v19, v19
  v_add_f32 v13, v13, v16
  v_add_f32 v13, v13, v17
  v_add_f32 v13, v13, v18
  v_add_f32 v13, v13, v19
  v_cvt_pk_bf16_f32 v78, v16, v17
  v_cvt_pk_bf16_f32 v79, v18, v19
  v_mfma_f32_16x16x32_bf16 v[16:19], v[56:59], v[128:131], 0
  v_mfma_f32_16x16x32_bf16 v[16:19], v[60:63], v[132:135], v[16:19]
  v_mfma_f32_16x16x32_bf16 v[16:19], v[24:27], v[136:139], v[16:19]
  ds_read_b32 v15, v9 offset:13312
  s_waitcnt lgkmcnt(0)
  v_sub_f32 v20, v20, v15
  v_mfma_f32_16x16x32_bf16 v[16:19], v[28:31], v[140:143], v[16:19]
  v_sub_f32 v21, v21, v15
  v_sub_f32 v22, v22, v15
  v_mfma_f32_16x16x32_bf16 v[16:19], v[32:35], v[144:147], v[16:19]
  v_sub_f32 v23, v23, v15
  v_mfma_f32_16x16x32_bf16 v[16:19], v[36:39], v[148:151], v[16:19]
  v_exp_f32 v20, v20
  v_mfma_f32_16x16x32_bf16 v[16:19], v[40:43], v[152:155], v[16:19]
  v_exp_f32 v21, v21
  v_mfma_f32_16x16x32_bf16 v[16:19], v[44:47], v[156:159], v[16:19]
  v_exp_f32 v22, v22
  v_exp_f32 v23, v23
  v_add_f32 v14, v14, v20
  v_add_f32 v14, v14, v21
  v_add_f32 v14, v14, v22
  v_add_f32 v14, v14, v23
  v_cvt_pk_bf16_f32 v20, v20, v21
  v_cvt_pk_bf16_f32 v21, v22, v23
  ds_write_b64 v9, v[20:21] offset:8200
  v_mfma_f32_16x16x32_bf16 v[20:23], v[56:59], v[160:163], 0
  ds_read_b128 v[48:51], v1 offset:6144
  v_mfma_f32_16x16x32_bf16 v[20:23], v[60:63], v[164:167], v[20:23]
  ds_read_b128 v[52:55], v2 offset:6144
  v_mfma_f32_16x16x32_bf16 v[20:23], v[24:27], v[168:171], v[20:23]
  ds_read_b32 v0, v9 offset:12288
  s_waitcnt lgkmcnt(0)
  v_sub_f32 v16, v16, v0
  v_mfma_f32_16x16x32_bf16 v[20:23], v[28:31], v[172:175], v[20:23]
  v_sub_f32 v17, v17, v0
  v_sub_f32 v18, v18, v0
  v_mfma_f32_16x16x32_bf16 v[20:23], v[32:35], v[176:179], v[20:23]
  v_sub_f32 v19, v19, v0
  v_mfma_f32_16x16x32_bf16 v[20:23], v[36:39], v[180:183], v[20:23]
  v_exp_f32 v16, v16
  v_mfma_f32_16x16x32_bf16 v[20:23], v[40:43], v[184:187], v[20:23]
  v_exp_f32 v17, v17
  v_mfma_f32_16x16x32_bf16 v[20:23], v[44:47], v[188:191], v[20:23]
  v_exp_f32 v18, v18
  v_exp_f32 v19, v19
  v_add_f32 v10, v10, v16
  v_add_f32 v10, v10, v17
  v_add_f32 v10, v10, v18
  v_add_f32 v10, v10, v19
  v_cvt_pk_bf16_f32 v80, v16, v17
  v_cvt_pk_bf16_f32 v81, v18, v19
  v_mfma_f32_16x16x32_bf16 v[16:19], v[56:59], v[192:195], 0
  s_waitcnt vmcnt(8)
  s_barrier
  v_mfma_f32_16x16x32_bf16 v[16:19], v[60:63], v[196:199], v[16:19]
  s_add_u32 m0, s33, 0
  s_add_u32 s34, s31, 0
  buffer_load_dwordx4 v8, s[12:15], s34 offen nt lds
  v_mfma_f32_16x16x32_bf16 v[16:19], v[24:27], v[200:203], v[16:19]
  ds_read_b32 v15, v9 offset:12292
  s_waitcnt lgkmcnt(0)
  v_sub_f32 v20, v20, v15
  v_mfma_f32_16x16x32_bf16 v[16:19], v[28:31], v[204:207], v[16:19]
  v_sub_f32 v21, v21, v15
  v_sub_f32 v22, v22, v15
  v_mfma_f32_16x16x32_bf16 v[16:19], v[32:35], v[208:211], v[16:19]
  v_sub_f32 v23, v23, v15
  v_mfma_f32_16x16x32_bf16 v[16:19], v[36:39], v[212:215], v[16:19]
  v_exp_f32 v20, v20
  v_mfma_f32_16x16x32_bf16 v[16:19], v[40:43], v[216:219], v[16:19]
  s_add_u32 m0, s33, 1024
  s_add_u32 s34, s31, 4096
  buffer_load_dwordx4 v8, s[12:15], s34 offen nt lds
  v_mfma_f32_16x16x32_bf16 v[16:19], v[44:47], v[220:223], v[16:19]
  v_exp_f32 v21, v21
  v_exp_f32 v22, v22
  v_exp_f32 v23, v23
  v_add_f32 v11, v11, v20
  v_add_f32 v11, v11, v21
  v_add_f32 v11, v11, v22
  v_add_f32 v11, v11, v23
  v_cvt_pk_bf16_f32 v84, v20, v21
  v_cvt_pk_bf16_f32 v85, v22, v23
  v_mfma_f32_16x16x32_bf16 v[20:23], v[56:59], v[224:227], 0
  ds_read_b128 v[56:59], v1 offset:14336
  v_mfma_f32_16x16x32_bf16 v[20:23], v[60:63], v[228:231], v[20:23]
  ds_read_b128 v[60:63], v2 offset:14336
  v_mfma_f32_16x16x32_bf16 v[20:23], v[24:27], v[232:235], v[20:23]
  ds_read_b128 v[24:27], v1 offset:22528
  ds_read_b32 v0, v9 offset:12296
  v_mfma_f32_16x16x32_bf16 v[20:23], v[28:31], v[236:239], v[20:23]
  s_add_u32 m0, s33, 2048
  s_add_u32 s34, s31, 8192
  buffer_load_dwordx4 v8, s[12:15], s34 offen nt lds
  v_mfma_f32_16x16x32_bf16 v[20:23], v[32:35], v[240:243], v[20:23]
  ds_read_b128 v[28:31], v2 offset:22528
  ds_read_b128 v[32:35], v1 offset:30720
  v_mfma_f32_16x16x32_bf16 v[20:23], v[36:39], v[244:247], v[20:23]
  ds_read_b128 v[36:39], v2 offset:30720
  s_waitcnt lgkmcnt(3)
  v_sub_f32 v16, v16, v0
  v_mfma_f32_16x16x32_bf16 v[20:23], v[40:43], v[248:251], v[20:23]
  v_sub_f32 v17, v17, v0
  v_sub_f32 v18, v18, v0
  v_mfma_f32_16x16x32_bf16 v[20:23], v[44:47], v[252:255], v[20:23]
  v_sub_f32 v19, v19, v0
  v_exp_f32 v16, v16
  v_exp_f32 v17, v17
  v_exp_f32 v18, v18
  v_exp_f32 v19, v19
  v_add_f32 v12, v12, v16
  v_add_f32 v12, v12, v17
  v_add_f32 v12, v12, v18
  v_add_f32 v12, v12, v19
  v_cvt_pk_bf16_f32 v88, v16, v17
  v_cvt_pk_bf16_f32 v89, v18, v19
  v_mfma_f32_16x16x32_bf16 v[16:19], v[48:51], v[128:131], 0
  s_add_u32 m0, s33, 3072
  s_add_u32 s34, s31, 12288
  buffer_load_dwordx4 v8, s[12:15], s34 offen nt lds
  v_mfma_f32_16x16x32_bf16 v[16:19], v[52:55], v[132:135], v[16:19]
  v_mfma_f32_16x16x32_bf16 v[16:19], v[56:59], v[136:139], v[16:19]
  ds_read_b32 v15, v9 offset:12300
  s_waitcnt lgkmcnt(0)
  v_sub_f32 v20, v20, v15
  v_mfma_f32_16x16x32_bf16 v[16:19], v[60:63], v[140:143], v[16:19]
  v_sub_f32 v21, v21, v15
  v_sub_f32 v22, v22, v15
  v_mfma_f32_16x16x32_bf16 v[16:19], v[24:27], v[144:147], v[16:19]
  v_sub_f32 v23, v23, v15
  v_mfma_f32_16x16x32_bf16 v[16:19], v[28:31], v[148:151], v[16:19]
  s_add_u32 m0, s33, 4096
  s_add_u32 s34, s31, 16384
  buffer_load_dwordx4 v8, s[12:15], s34 offen nt lds
  v_mfma_f32_16x16x32_bf16 v[16:19], v[32:35], v[152:155], v[16:19]
  v_exp_f32 v20, v20
  v_mfma_f32_16x16x32_bf16 v[16:19], v[36:39], v[156:159], v[16:19]
  v_exp_f32 v21, v21
  v_exp_f32 v22, v22
  v_exp_f32 v23, v23
  v_add_f32 v13, v13, v20
  v_add_f32 v13, v13, v21
  v_add_f32 v13, v13, v22
  v_add_f32 v13, v13, v23
  v_cvt_pk_bf16_f32 v92, v20, v21
  v_cvt_pk_bf16_f32 v93, v22, v23
  v_mfma_f32_16x16x32_bf16 v[20:23], v[48:51], v[160:163], 0
  ds_read_b64_tr_b16 v[40:41], v3 offset:16384
  ds_read_b64_tr_b16 v[42:43], v3 offset:18432
  v_mfma_f32_16x16x32_bf16 v[20:23], v[52:55], v[164:167], v[20:23]
  ds_read_b64_tr_b16 v[44:45], v3 offset:20480
  ds_read_b64_tr_b16 v[46:47], v3 offset:22528
  v_mfma_f32_16x16x32_bf16 v[20:23], v[56:59], v[168:171], v[20:23]
  s_add_u32 m0, s33, 5120
  s_add_u32 s34, s31, 20480
  buffer_load_dwordx4 v8, s[12:15], s34 offen nt lds
  v_mfma_f32_16x16x32_bf16 v[20:23], v[60:63], v[172:175], v[20:23]
  ds_read_b32 v0, v9 offset:12288
  s_waitcnt lgkmcnt(0)
  v_sub_f32 v16, v16, v0
  v_mfma_f32_16x16x32_bf16 v[20:23], v[24:27], v[176:179], v[20:23]
  v_sub_f32 v17, v17, v0
  v_sub_f32 v18, v18, v0
  v_mfma_f32_16x16x32_bf16 v[20:23], v[28:31], v[180:183], v[20:23]
  v_sub_f32 v19, v19, v0
  v_mfma_f32_16x16x32_bf16 v[20:23], v[32:35], v[184:187], v[20:23]
  v_exp_f32 v16, v16
  v_mfma_f32_16x16x32_bf16 v[20:23], v[36:39], v[188:191], v[20:23]
  v_exp_f32 v17, v17
  v_exp_f32 v18, v18
  v_exp_f32 v19, v19
  v_add_f32 v10, v10, v16
  v_add_f32 v10, v10, v17
  v_add_f32 v10, v10, v18
  v_add_f32 v10, v10, v19
  v_cvt_pk_bf16_f32 v82, v16, v17
  v_cvt_pk_bf16_f32 v83, v18, v19
  s_add_u32 m0, s33, 6144
  s_add_u32 s34, s31, 24576
  buffer_load_dwordx4 v8, s[12:15], s34 offen nt lds
  v_mfma_f32_16x16x32_bf16 v[16:19], v[48:51], v[192:195], 0
  v_mfma_f32_16x16x32_bf16 v[16:19], v[52:55], v[196:199], v[16:19]
  v_mfma_f32_16x16x32_bf16 v[16:19], v[56:59], v[200:203], v[16:19]
  ds_read_b32 v15, v9 offset:12292
  s_waitcnt lgkmcnt(0)
  v_sub_f32 v20, v20, v15
  v_mfma_f32_16x16x32_bf16 v[16:19], v[60:63], v[204:207], v[16:19]
  v_sub_f32 v21, v21, v15
  v_sub_f32 v22, v22, v15
  v_mfma_f32_16x16x32_bf16 v[16:19], v[24:27], v[208:211], v[16:19]
  s_add_u32 m0, s33, 7168
  s_add_u32 s34, s31, 28672
  buffer_load_dwordx4 v8, s[12:15], s34 offen nt lds
  s_add_u32 s31, s31, 32768
  s_xor_b32 s33, s33, 65536
  v_mfma_f32_16x16x32_bf16 v[16:19], v[28:31], v[212:215], v[16:19]
  v_sub_f32 v23, v23, v15
  v_mfma_f32_16x16x32_bf16 v[16:19], v[32:35], v[216:219], v[16:19]
  v_exp_f32 v20, v20
  v_mfma_f32_16x16x32_bf16 v[16:19], v[36:39], v[220:223], v[16:19]
  v_exp_f32 v21, v21
  v_exp_f32 v22, v22
  v_exp_f32 v23, v23
  v_add_f32 v11, v11, v20
  v_add_f32 v11, v11, v21
  v_add_f32 v11, v11, v22
  v_add_f32 v11, v11, v23
  v_cvt_pk_bf16_f32 v86, v20, v21
  v_cvt_pk_bf16_f32 v87, v22, v23
  v_mfma_f32_16x16x32_bf16 v[20:23], v[48:51], v[224:227], 0
  ds_read_b64_tr_b16 v[48:49], v4 offset:16384
  ds_read_b64_tr_b16 v[50:51], v4 offset:18432
  v_mfma_f32_16x16x32_bf16 v[20:23], v[52:55], v[228:231], v[20:23]
  ds_read_b64_tr_b16 v[52:53], v4 offset:20480
  ds_read_b64_tr_b16 v[54:55], v4 offset:22528
  v_mfma_f32_16x16x32_bf16 v[20:23], v[56:59], v[232:235], v[20:23]
  ds_read_b32 v0, v9 offset:12296
  s_waitcnt lgkmcnt(0)
  v_sub_f32 v16, v16, v0
  v_mfma_f32_16x16x32_bf16 v[20:23], v[60:63], v[236:239], v[20:23]
  v_sub_f32 v17, v17, v0
  v_sub_f32 v18, v18, v0
  v_mfma_f32_16x16x32_bf16 v[20:23], v[24:27], v[240:243], v[20:23]
  v_sub_f32 v19, v19, v0
  v_mfma_f32_16x16x32_bf16 v[20:23], v[28:31], v[244:247], v[20:23]
  v_exp_f32 v16, v16
  v_mfma_f32_16x16x32_bf16 v[20:23], v[32:35], v[248:251], v[20:23]
  v_exp_f32 v17, v17
  v_mfma_f32_16x16x32_bf16 v[20:23], v[36:39], v[252:255], v[20:23]
  v_exp_f32 v18, v18
  v_exp_f32 v19, v19
  v_add_f32 v12, v12, v16
  v_add_f32 v12, v12, v17
  v_add_f32 v12, v12, v18
  v_add_f32 v12, v12, v19
  v_cvt_pk_bf16_f32 v90, v16, v17
  v_cvt_pk_bf16_f32 v91, v18, v19
  ds_read_b64_tr_b16 v[56:57], v5 offset:16384
  ds_read_b64_tr_b16 v[58:59], v5 offset:18432
  ds_read_b64_tr_b16 v[60:61], v5 offset:20480
  ds_read_b64_tr_b16 v[62:63], v5 offset:22528
  v_mfma_f32_16x16x32_bf16 a[32:35], v[40:43], v[64:67], 0
  v_mfma_f32_16x16x32_bf16 a[32:35], v[44:47], v[80:83], a[32:35]
  ds_read_b32 v15, v9 offset:12300
  s_waitcnt lgkmcnt(0)
  v_sub_f32 v20, v20, v15
  v_mfma_f32_16x16x32_bf16 a[96:99], v[40:43], v[68:71], 0
  v_sub_f32 v21, v21, v15
  v_sub_f32 v22, v22, v15
  v_mfma_f32_16x16x32_bf16 a[96:99], v[44:47], v[84:87], a[96:99]
  v_sub_f32 v23, v23, v15
  v_mfma_f32_16x16x32_bf16 a[160:163], v[40:43], v[72:75], 0
  v_exp_f32 v20, v20
  v_mfma_f32_16x16x32_bf16 a[160:163], v[44:47], v[88:91], a[160:163]
  v_exp_f32 v21, v21
  v_mfma_f32_16x16x32_bf16 a[224:227], v[40:43], v[76:79], 0
  v_exp_f32 v22, v22
  v_exp_f32 v23, v23
  v_add_f32 v13, v13, v20
  v_add_f32 v13, v13, v21
  v_add_f32 v13, v13, v22
  v_add_f32 v13, v13, v23
  v_cvt_pk_bf16_f32 v94, v20, v21
  v_cvt_pk_bf16_f32 v95, v22, v23
  s_nop 1
  v_mfma_f32_16x16x32_bf16 a[224:227], v[44:47], v[92:95], a[224:227]
  ds_read_b64_tr_b16 v[24:25], v6 offset:16384
  ds_read_b64_tr_b16 v[26:27], v6 offset:18432
  v_mfma_f32_16x16x32_bf16 a[36:39], v[48:51], v[64:67], 0
  ds_read_b64_tr_b16 v[28:29], v6 offset:20480
  ds_read_b64_tr_b16 v[30:31], v6 offset:22528
  v_mfma_f32_16x16x32_bf16 a[36:39], v[52:55], v[80:83], a[36:39]
  v_xor_b32 v1, 65536, v1
  v_xor_b32 v2, 65536, v2
  v_mfma_f32_16x16x32_bf16 a[100:103], v[48:51], v[68:71], 0
  v_mfma_f32_16x16x32_bf16 a[100:103], v[52:55], v[84:87], a[100:103]
  v_mfma_f32_16x16x32_bf16 a[164:167], v[48:51], v[72:75], 0
  ds_read_b128 v[16:19], v9 offset:8192
  ds_read_b128 v[20:23], v9 offset:9216
  v_mfma_f32_16x16x32_bf16 a[164:167], v[52:55], v[88:91], a[164:167]
  v_mfma_f32_16x16x32_bf16 a[228:231], v[48:51], v[76:79], 0
  v_mfma_f32_16x16x32_bf16 a[228:231], v[52:55], v[92:95], a[228:231]
  ds_read_b64_tr_b16 v[32:33], v3 offset:24576
  ds_read_b64_tr_b16 v[34:35], v3 offset:26624
  v_mfma_f32_16x16x32_bf16 a[40:43], v[56:59], v[64:67], 0
  ds_read_b64_tr_b16 v[36:37], v3 offset:28672
  ds_read_b64_tr_b16 v[38:39], v3 offset:30720
  v_mfma_f32_16x16x32_bf16 a[40:43], v[60:63], v[80:83], a[40:43]
  v_mfma_f32_16x16x32_bf16 a[104:107], v[56:59], v[68:71], 0
  v_mfma_f32_16x16x32_bf16 a[104:107], v[60:63], v[84:87], a[104:107]
  v_mfma_f32_16x16x32_bf16 a[168:171], v[56:59], v[72:75], 0
  v_mfma_f32_16x16x32_bf16 a[168:171], v[60:63], v[88:91], a[168:171]
  v_mfma_f32_16x16x32_bf16 a[232:235], v[56:59], v[76:79], 0
  v_mfma_f32_16x16x32_bf16 a[232:235], v[60:63], v[92:95], a[232:235]
  ds_read_b64_tr_b16 v[48:49], v4 offset:24576
  ds_read_b64_tr_b16 v[50:51], v4 offset:26624
  s_waitcnt lgkmcnt(10)
  v_mfma_f32_16x16x32_bf16 a[44:47], v[24:27], v[64:67], 0
  ds_read_b64_tr_b16 v[52:53], v4 offset:28672
  ds_read_b64_tr_b16 v[54:55], v4 offset:30720
  s_waitcnt lgkmcnt(10)
  v_mfma_f32_16x16x32_bf16 a[44:47], v[28:31], v[80:83], a[44:47]
  v_mfma_f32_16x16x32_bf16 a[108:111], v[24:27], v[68:71], 0
  v_mfma_f32_16x16x32_bf16 a[108:111], v[28:31], v[84:87], a[108:111]
  v_mfma_f32_16x16x32_bf16 a[172:175], v[24:27], v[72:75], 0
  v_mfma_f32_16x16x32_bf16 a[172:175], v[28:31], v[88:91], a[172:175]
  v_mfma_f32_16x16x32_bf16 a[236:239], v[24:27], v[76:79], 0
  v_mfma_f32_16x16x32_bf16 a[236:239], v[28:31], v[92:95], a[236:239]
  ds_read_b64_tr_b16 v[56:57], v5 offset:24576
  ds_read_b64_tr_b16 v[58:59], v5 offset:26624
  s_waitcnt lgkmcnt(8)
  v_mfma_f32_16x16x32_bf16 a[48:51], v[32:35], v[64:67], 0
  ds_read_b64_tr_b16 v[60:61], v5 offset:28672
  ds_read_b64_tr_b16 v[62:63], v5 offset:30720
  s_waitcnt lgkmcnt(8)
  v_mfma_f32_16x16x32_bf16 a[48:51], v[36:39], v[80:83], a[48:51]
  v_mfma_f32_16x16x32_bf16 a[112:115], v[32:35], v[68:71], 0
  v_mfma_f32_16x16x32_bf16 a[112:115], v[36:39], v[84:87], a[112:115]
  v_mfma_f32_16x16x32_bf16 a[176:179], v[32:35], v[72:75], 0
  v_mfma_f32_16x16x32_bf16 a[176:179], v[36:39], v[88:91], a[176:179]
  v_mfma_f32_16x16x32_bf16 a[240:243], v[32:35], v[76:79], 0
  v_mfma_f32_16x16x32_bf16 a[240:243], v[36:39], v[92:95], a[240:243]
  ds_read_b64_tr_b16 v[40:41], v6 offset:24576
  ds_read_b64_tr_b16 v[42:43], v6 offset:26624
  s_waitcnt lgkmcnt(8)
  v_mfma_f32_16x16x32_bf16 a[52:55], v[48:51], v[64:67], 0
  ds_read_b64_tr_b16 v[44:45], v6 offset:28672
  ds_read_b64_tr_b16 v[46:47], v6 offset:30720
  s_waitcnt lgkmcnt(8)
  v_mfma_f32_16x16x32_bf16 a[52:55], v[52:55], v[80:83], a[52:55]
  v_mfma_f32_16x16x32_bf16 a[116:119], v[48:51], v[68:71], 0
  v_mfma_f32_16x16x32_bf16 a[116:119], v[52:55], v[84:87], a[116:119]
  v_mfma_f32_16x16x32_bf16 a[180:183], v[48:51], v[72:75], 0
  v_mfma_f32_16x16x32_bf16 a[180:183], v[52:55], v[88:91], a[180:183]
  v_mfma_f32_16x16x32_bf16 a[244:247], v[48:51], v[76:79], 0
  v_mfma_f32_16x16x32_bf16 a[244:247], v[52:55], v[92:95], a[244:247]
  ds_read_b64_tr_b16 v[24:25], v3 offset:0
  ds_read_b64_tr_b16 v[26:27], v3 offset:2048
  s_waitcnt lgkmcnt(8)
  v_mfma_f32_16x16x32_bf16 a[56:59], v[56:59], v[64:67], 0
  ds_read_b64_tr_b16 v[28:29], v3 offset:4096
  ds_read_b64_tr_b16 v[30:31], v3 offset:6144
  s_waitcnt lgkmcnt(8)
  v_mfma_f32_16x16x32_bf16 a[56:59], v[60:63], v[80:83], a[56:59]
  v_mfma_f32_16x16x32_bf16 a[120:123], v[56:59], v[68:71], 0
  v_mfma_f32_16x16x32_bf16 a[120:123], v[60:63], v[84:87], a[120:123]
  v_mfma_f32_16x16x32_bf16 a[184:187], v[56:59], v[72:75], 0
  v_mfma_f32_16x16x32_bf16 a[184:187], v[60:63], v[88:91], a[184:187]
  v_mfma_f32_16x16x32_bf16 a[248:251], v[56:59], v[76:79], 0
  v_mfma_f32_16x16x32_bf16 a[248:251], v[60:63], v[92:95], a[248:251]
  ds_read_b64_tr_b16 v[48:49], v4 offset:0
  ds_read_b64_tr_b16 v[50:51], v4 offset:2048
  s_waitcnt lgkmcnt(8)
  v_mfma_f32_16x16x32_bf16 a[60:63], v[40:43], v[64:67], 0
  ds_read_b64_tr_b16 v[52:53], v4 offset:4096
  ds_read_b64_tr_b16 v[54:55], v4 offset:6144
  s_waitcnt lgkmcnt(8)
  v_mfma_f32_16x16x32_bf16 a[60:63], v[44:47], v[80:83], a[60:63]
  v_mfma_f32_16x16x32_bf16 a[124:127], v[40:43], v[68:71], 0
  v_mfma_f32_16x16x32_bf16 a[124:127], v[44:47], v[84:87], a[124:127]
  v_mfma_f32_16x16x32_bf16 a[188:191], v[40:43], v[72:75], 0
  v_mfma_f32_16x16x32_bf16 a[188:191], v[44:47], v[88:91], a[188:191]
  v_mfma_f32_16x16x32_bf16 a[252:255], v[40:43], v[76:79], 0
  v_mfma_f32_16x16x32_bf16 a[252:255], v[44:47], v[92:95], a[252:255]
  ds_read_b64_tr_b16 v[56:57], v5 offset:0
  ds_read_b64_tr_b16 v[58:59], v5 offset:2048
  s_waitcnt lgkmcnt(8)
  v_mfma_f32_16x16x32_bf16 a[0:3], v[24:27], v[64:67], 0
  ds_read_b64_tr_b16 v[60:61], v5 offset:4096
  ds_read_b64_tr_b16 v[62:63], v5 offset:6144
  s_waitcnt lgkmcnt(8)
  v_mfma_f32_16x16x32_bf16 a[0:3], v[28:31], v[80:83], a[0:3]
  v_mfma_f32_16x16x32_bf16 a[64:67], v[24:27], v[68:71], 0
  v_mfma_f32_16x16x32_bf16 a[64:67], v[28:31], v[84:87], a[64:67]
  v_mfma_f32_16x16x32_bf16 a[128:131], v[24:27], v[72:75], 0
  v_mfma_f32_16x16x32_bf16 a[128:131], v[28:31], v[88:91], a[128:131]
  v_mfma_f32_16x16x32_bf16 a[192:195], v[24:27], v[76:79], 0
  v_mfma_f32_16x16x32_bf16 a[192:195], v[28:31], v[92:95], a[192:195]
  v_mfma_f32_16x16x32_bf16 v[96:99], v[24:27], v[16:19], 0
  v_mfma_f32_16x16x32_bf16 v[96:99], v[28:31], v[20:23], v[96:99]
  ds_read_b64_tr_b16 v[32:33], v6 offset:0
  ds_read_b64_tr_b16 v[34:35], v6 offset:2048
  s_waitcnt lgkmcnt(8)
  v_mfma_f32_16x16x32_bf16 a[4:7], v[48:51], v[64:67], 0
  ds_read_b64_tr_b16 v[36:37], v6 offset:4096
  ds_read_b64_tr_b16 v[38:39], v6 offset:6144
  s_waitcnt lgkmcnt(8)
  v_mfma_f32_16x16x32_bf16 a[4:7], v[52:55], v[80:83], a[4:7]
  v_mfma_f32_16x16x32_bf16 a[68:71], v[48:51], v[68:71], 0
  v_mfma_f32_16x16x32_bf16 a[68:71], v[52:55], v[84:87], a[68:71]
  v_mfma_f32_16x16x32_bf16 a[132:135], v[48:51], v[72:75], 0
  v_mfma_f32_16x16x32_bf16 a[132:135], v[52:55], v[88:91], a[132:135]
  v_mfma_f32_16x16x32_bf16 a[196:199], v[48:51], v[76:79], 0
  v_mfma_f32_16x16x32_bf16 a[196:199], v[52:55], v[92:95], a[196:199]
  v_mfma_f32_16x16x32_bf16 v[100:103], v[48:51], v[16:19], 0
  v_mfma_f32_16x16x32_bf16 v[100:103], v[52:55], v[20:23], v[100:103]
  ds_read_b64_tr_b16 v[40:41], v3 offset:8192
  ds_read_b64_tr_b16 v[42:43], v3 offset:10240
  s_waitcnt lgkmcnt(8)
  v_mfma_f32_16x16x32_bf16 a[8:11], v[56:59], v[64:67], 0
  ds_read_b64_tr_b16 v[44:45], v3 offset:12288
  ds_read_b64_tr_b16 v[46:47], v3 offset:14336
  s_waitcnt lgkmcnt(8)
  v_mfma_f32_16x16x32_bf16 a[8:11], v[60:63], v[80:83], a[8:11]
  v_mfma_f32_16x16x32_bf16 a[72:75], v[56:59], v[68:71], 0
  v_mfma_f32_16x16x32_bf16 a[72:75], v[60:63], v[84:87], a[72:75]
  v_mfma_f32_16x16x32_bf16 a[136:139], v[56:59], v[72:75], 0
  v_mfma_f32_16x16x32_bf16 a[136:139], v[60:63], v[88:91], a[136:139]
  v_mfma_f32_16x16x32_bf16 a[200:203], v[56:59], v[76:79], 0
  v_mfma_f32_16x16x32_bf16 a[200:203], v[60:63], v[92:95], a[200:203]
  v_mfma_f32_16x16x32_bf16 v[104:107], v[56:59], v[16:19], 0
  v_mfma_f32_16x16x32_bf16 v[104:107], v[60:63], v[20:23], v[104:107]
  ds_read_b64_tr_b16 v[48:49], v4 offset:8192
  ds_read_b64_tr_b16 v[50:51], v4 offset:10240
  s_waitcnt lgkmcnt(8)
  v_mfma_f32_16x16x32_bf16 a[12:15], v[32:35], v[64:67], 0
  s_waitcnt vmcnt(8)
  s_barrier
  ds_read_b64_tr_b16 v[52:53], v4 offset:12288
  s_waitcnt lgkmcnt(7)
  v_mfma_f32_16x16x32_bf16 a[12:15], v[36:39], v[80:83], a[12:15]
  s_add_u32 m0, s32, 0
  s_add_u32 s34, s30, 0
  buffer_load_dwordx4 v7, s[8:11], s34 offen nt lds
  v_mfma_f32_16x16x32_bf16 a[76:79], v[32:35], v[68:71], 0
  ds_read_b64_tr_b16 v[54:55], v4 offset:14336
  v_mfma_f32_16x16x32_bf16 a[76:79], v[36:39], v[84:87], a[76:79]
  v_mfma_f32_16x16x32_bf16 a[140:143], v[32:35], v[72:75], 0
  v_mfma_f32_16x16x32_bf16 a[140:143], v[36:39], v[88:91], a[140:143]
  v_mfma_f32_16x16x32_bf16 a[204:207], v[32:35], v[76:79], 0
  v_mfma_f32_16x16x32_bf16 a[204:207], v[36:39], v[92:95], a[204:207]
  s_add_u32 m0, s32, 1024
  s_add_u32 s34, s30, 4096
  buffer_load_dwordx4 v7, s[8:11], s34 offen nt lds
  v_mfma_f32_16x16x32_bf16 v[108:111], v[32:35], v[16:19], 0
  v_mfma_f32_16x16x32_bf16 v[108:111], v[36:39], v[20:23], v[108:111]
  ds_read_b64_tr_b16 v[56:57], v5 offset:8192
  ds_read_b64_tr_b16 v[58:59], v5 offset:10240
  s_waitcnt lgkmcnt(8)
  v_mfma_f32_16x16x32_bf16 a[16:19], v[40:43], v[64:67], 0
  ds_read_b64_tr_b16 v[60:61], v5 offset:12288
  ds_read_b64_tr_b16 v[62:63], v5 offset:14336
  s_waitcnt lgkmcnt(8)
  v_mfma_f32_16x16x32_bf16 a[16:19], v[44:47], v[80:83], a[16:19]
  ds_read_b128 v[32:35], v1 offset:0
  ds_read_b128 v[36:39], v2 offset:0
  v_mfma_f32_16x16x32_bf16 a[80:83], v[40:43], v[68:71], 0
  v_mfma_f32_16x16x32_bf16 a[80:83], v[44:47], v[84:87], a[80:83]
  s_add_u32 m0, s32, 2048
  s_add_u32 s34, s30, 8192
  buffer_load_dwordx4 v7, s[8:11], s34 offen nt lds
  v_mfma_f32_16x16x32_bf16 a[144:147], v[40:43], v[72:75], 0
  v_mfma_f32_16x16x32_bf16 a[144:147], v[44:47], v[88:91], a[144:147]
  v_mfma_f32_16x16x32_bf16 a[208:211], v[40:43], v[76:79], 0
  v_mfma_f32_16x16x32_bf16 a[208:211], v[44:47], v[92:95], a[208:211]
  v_mfma_f32_16x16x32_bf16 v[112:115], v[40:43], v[16:19], 0
  v_mfma_f32_16x16x32_bf16 v[112:115], v[44:47], v[20:23], v[112:115]
  s_add_u32 m0, s32, 3072
  s_add_u32 s34, s30, 12288
  buffer_load_dwordx4 v7, s[8:11], s34 offen nt lds
  s_waitcnt lgkmcnt(8)
  v_mfma_f32_16x16x32_bf16 a[20:23], v[48:51], v[64:67], 0
  ds_read_b64_tr_b16 v[24:25], v6 offset:8192
  ds_read_b64_tr_b16 v[26:27], v6 offset:10240
  s_waitcnt lgkmcnt(8)
  v_mfma_f32_16x16x32_bf16 a[20:23], v[52:55], v[80:83], a[20:23]
  ds_read_b64_tr_b16 v[28:29], v6 offset:12288
  ds_read_b64_tr_b16 v[30:31], v6 offset:14336
  v_mfma_f32_16x16x32_bf16 a[84:87], v[48:51], v[68:71], 0
  ds_read_b128 v[40:43], v1 offset:8192
  ds_read_b128 v[44:47], v2 offset:8192
  v_mfma_f32_16x16x32_bf16 a[84:87], v[52:55], v[84:87], a[84:87]
  v_mfma_f32_16x16x32_bf16 a[148:151], v[48:51], v[72:75], 0
  v_mfma_f32_16x16x32_bf16 a[148:151], v[52:55], v[88:91], a[148:151]
  s_add_u32 m0, s32, 4096
  s_add_u32 s34, s30, 16384
  buffer_load_dwordx4 v7, s[8:11], s34 offen nt lds
  v_mfma_f32_16x16x32_bf16 a[212:215], v[48:51], v[76:79], 0
  v_mfma_f32_16x16x32_bf16 a[212:215], v[52:55], v[92:95], a[212:215]
  v_mfma_f32_16x16x32_bf16 v[116:119], v[48:51], v[16:19], 0
  v_mfma_f32_16x16x32_bf16 v[116:119], v[52:55], v[20:23], v[116:119]
  ds_read_b128 v[48:51], v1 offset:16384
  ds_read_b128 v[52:55], v2 offset:16384
  s_waitcnt lgkmcnt(12)
  v_mfma_f32_16x16x32_bf16 a[24:27], v[56:59], v[64:67], 0
  s_waitcnt lgkmcnt(10)
  v_mfma_f32_16x16x32_bf16 a[24:27], v[60:63], v[80:83], a[24:27]
  s_add_u32 m0, s32, 5120
  s_add_u32 s34, s30, 20480
  buffer_load_dwordx4 v7, s[8:11], s34 offen nt lds
  v_mfma_f32_16x16x32_bf16 a[88:91], v[56:59], v[68:71], 0
  v_mfma_f32_16x16x32_bf16 a[88:91], v[60:63], v[84:87], a[88:91]
  v_mfma_f32_16x16x32_bf16 a[152:155], v[56:59], v[72:75], 0
  v_mfma_f32_16x16x32_bf16 a[152:155], v[60:63], v[88:91], a[152:155]
  v_mfma_f32_16x16x32_bf16 a[216:219], v[56:59], v[76:79], 0
  v_mfma_f32_16x16x32_bf16 a[216:219], v[60:63], v[92:95], a[216:219]
  s_add_u32 m0, s32, 6144
  s_add_u32 s34, s30, 24576
  buffer_load_dwordx4 v7, s[8:11], s34 offen nt lds
  v_mfma_f32_16x16x32_bf16 v[120:123], v[56:59], v[16:19], 0
  v_mfma_f32_16x16x32_bf16 v[120:123], v[60:63], v[20:23], v[120:123]
  ds_read_b128 v[56:59], v1 offset:24576
  ds_read_b128 v[60:63], v2 offset:24576
  s_waitcnt lgkmcnt(8)
  v_mfma_f32_16x16x32_bf16 a[28:31], v[24:27], v[64:67], 0
  s_waitcnt lgkmcnt(6)
  v_mfma_f32_16x16x32_bf16 a[28:31], v[28:31], v[80:83], a[28:31]
  v_mfma_f32_16x16x32_bf16 a[92:95], v[24:27], v[68:71], 0
  v_mfma_f32_16x16x32_bf16 a[92:95], v[28:31], v[84:87], a[92:95]
  s_add_u32 m0, s32, 7168
  s_add_u32 s34, s30, 28672
  buffer_load_dwordx4 v7, s[8:11], s34 offen nt lds
  s_add_u32 s30, s30, 32768
  s_xor_b32 s32, s32, 65536
  v_mfma_f32_16x16x32_bf16 a[156:159], v[24:27], v[72:75], 0
  v_mfma_f32_16x16x32_bf16 a[156:159], v[28:31], v[88:91], a[156:159]
  v_mfma_f32_16x16x32_bf16 a[220:223], v[24:27], v[76:79], 0
  v_mfma_f32_16x16x32_bf16 a[220:223], v[28:31], v[92:95], a[220:223]
  v_mfma_f32_16x16x32_bf16 v[124:127], v[24:27], v[16:19], 0
  v_mfma_f32_16x16x32_bf16 v[124:127], v[28:31], v[20:23], v[124:127]
  s_mov_b32 s29, 15
  s_nop 9
K1_SLOOP_P0:
  v_mfma_f32_16x16x32_bf16 v[16:19], v[32:35], v[128:131], 0
  ds_read_b128 v[80:83], v9 offset:0
  ds_read_b128 v[84:87], v9 offset:1024
  v_mfma_f32_16x16x32_bf16 v[16:19], v[36:39], v[132:135], v[16:19]
  ds_read_b128 v[88:91], v9 offset:2048
  ds_read_b128 v[92:95], v9 offset:3072
  s_waitcnt lgkmcnt(9)
  v_mfma_f32_16x16x32_bf16 v[16:19], v[40:43], v[136:139], v[16:19]
  v_xor_b32 v3, 65536, v3
  v_xor_b32 v4, 65536, v4
  s_waitcnt lgkmcnt(8)
  v_mfma_f32_16x16x32_bf16 v[16:19], v[44:47], v[140:143], v[16:19]
  v_xor_b32 v5, 65536, v5
  v_xor_b32 v6, 65536, v6
  s_waitcnt lgkmcnt(7)
  v_mfma_f32_16x16x32_bf16 v[16:19], v[48:51], v[144:147], v[16:19]
  s_waitcnt lgkmcnt(6)
  v_mfma_f32_16x16x32_bf16 v[16:19], v[52:55], v[148:151], v[16:19]
  s_waitcnt lgkmcnt(5)
  v_mfma_f32_16x16x32_bf16 v[16:19], v[56:59], v[152:155], v[16:19]
  s_waitcnt lgkmcnt(4)
  v_mfma_f32_16x16x32_bf16 v[16:19], v[60:63], v[156:159], v[16:19]
  v_mfma_f32_16x16x32_bf16 v[20:23], v[32:35], v[160:163], 0
  ds_read_b128 v[24:27], v1 offset:2048
  v_mfma_f32_16x16x32_bf16 v[20:23], v[36:39], v[164:167], v[20:23]
  ds_read_b128 v[28:31], v2 offset:2048
  v_mfma_f32_16x16x32_bf16 v[20:23], v[40:43], v[168:171], v[20:23]
  ds_read_b32 v0, v9 offset:12288
  s_waitcnt lgkmcnt(0)
  s_nop 0
  v_sub_f32 v16, v16, v0
  v_mfma_f32_16x16x32_bf16 v[20:23], v[44:47], v[172:175], v[20:23]
  v_sub_f32 v17, v17, v0
  v_sub_f32 v18, v18, v0
  v_mfma_f32_16x16x32_bf16 v[20:23], v[48:51], v[176:179], v[20:23]
  v_sub_f32 v19, v19, v0
  v_mfma_f32_16x16x32_bf16 v[20:23], v[52:55], v[180:183], v[20:23]
  v_exp_f32 v16, v16
  v_mfma_f32_16x16x32_bf16 v[20:23], v[56:59], v[184:187], v[20:23]
  v_exp_f32 v17, v17
  v_mfma_f32_16x16x32_bf16 v[20:23], v[60:63], v[188:191], v[20:23]
  v_exp_f32 v18, v18
  v_exp_f32 v19, v19
  v_add_f32 v10, v10, v16
  v_add_f32 v10, v10, v17
  v_add_f32 v10, v10, v18
  v_add_f32 v10, v10, v19
  v_cvt_pk_bf16_f32 v64, v16, v17
  v_cvt_pk_bf16_f32 v65, v18, v19
  v_mfma_f32_16x16x32_bf16 v[16:19], v[32:35], v[192:195], 0
  v_mfma_f32_16x16x32_bf16 v[16:19], v[36:39], v[196:199], v[16:19]
  v_mfma_f32_16x16x32_bf16 v[16:19], v[40:43], v[200:203], v[16:19]
  ds_read_b32 v15, v9 offset:12292
  s_waitcnt lgkmcnt(0)
  v_sub_f32 v20, v20, v15
  v_mfma_f32_16x16x32_bf16 v[16:19], v[44:47], v[204:207], v[16:19]
  v_sub_f32 v21, v21, v15
  v_sub_f32 v22, v22, v15
  v_mfma_f32_16x16x32_bf16 v[16:19], v[48:51], v[208:211], v[16:19]
  v_sub_f32 v23, v23, v15
  v_mfma_f32_16x16x32_bf16 v[16:19], v[52:55], v[212:215], v[16:19]
  v_exp_f32 v20, v20
  v_mfma_f32_16x16x32_bf16 v[16:19], v[56:59], v[216:219], v[16:19]
  v_exp_f32 v21, v21
  v_mfma_f32_16x16x32_bf16 v[16:19], v[60:63], v[220:223], v[16:19]
  v_exp_f32 v22, v22
  v_exp_f32 v23, v23
  v_add_f32 v11, v11, v20
  v_add_f32 v11, v11, v21
  v_add_f32 v11, v11, v22
  v_add_f32 v11, v11, v23
  v_cvt_pk_bf16_f32 v68, v20, v21
  v_cvt_pk_bf16_f32 v69, v22, v23
  v_mfma_f32_16x16x32_bf16 v[20:23], v[32:35], v[224:227], 0
  v_mfma_f32_16x16x32_bf16 v[20:23], v[36:39], v[228:231], v[20:23]
  v_mfma_f32_16x16x32_bf16 v[20:23], v[40:43], v[232:235], v[20:23]
  ds_read_b32 v0, v9 offset:12296
  s_waitcnt lgkmcnt(0)
  v_sub_f32 v16, v16, v0
  v_mfma_f32_16x16x32_bf16 v[20:23], v[44:47], v[236:239], v[20:23]
  v_sub_f32 v17, v17, v0
  v_sub_f32 v18, v18, v0
  v_mfma_f32_16x16x32_bf16 v[20:23], v[48:51], v[240:243], v[20:23]
  v_sub_f32 v19, v19, v0
  v_mfma_f32_16x16x32_bf16 v[20:23], v[52:55], v[244:247], v[20:23]
  v_exp_f32 v16, v16
  v_mfma_f32_16x16x32_bf16 v[20:23], v[56:59], v[248:251], v[20:23]
  v_exp_f32 v17, v17
  v_mfma_f32_16x16x32_bf16 v[20:23], v[60:63], v[252:255], v[20:23]
  v_exp_f32 v18, v18
  v_exp_f32 v19, v19
  v_add_f32 v12, v12, v16
  v_add_f32 v12, v12, v17
  v_add_f32 v12, v12, v18
  v_add_f32 v12, v12, v19
  v_cvt_pk_bf16_f32 v72, v16, v17
  v_cvt_pk_bf16_f32 v73, v18, v19
  v_mfma_f32_16x16x32_bf16 v[16:19], v[32:35], v[80:83], 0
  ds_read_b128 v[80:83], v9 offset:4096
  ds_read_b128 v[32:35], v1 offset:10240
  v_mfma_f32_16x16x32_bf16 v[16:19], v[36:39], v[84:87], v[16:19]
  ds_read_b128 v[84:87], v9 offset:5120
  ds_read_b128 v[36:39], v2 offset:10240
  v_mfma_f32_16x16x32_bf16 v[16:19], v[40:43], v[88:91], v[16:19]
  ds_read_b128 v[88:91], v9 offset:6144
  ds_read_b128 v[40:43], v1 offset:18432
  v_mfma_f32_16x16x32_bf16 v[16:19], v[44:47], v[92:95], v[16:19]
  ds_read_b128 v[92:95], v9 offset:7168
  ds_read_b128 v[44:47], v2 offset:18432
  s_waitcnt lgkmcnt(7)
  v_mfma_f32_16x16x32_bf16 v[16:19], v[48:51], v[80:83], v[16:19]
  ds_read_b128 v[48:51], v1 offset:26624
  ds_read_b32 v15, v9 offset:12300
  s_waitcnt lgkmcnt(7)
  v_mfma_f32_16x16x32_bf16 v[16:19], v[52:55], v[84:87], v[16:19]
  ds_read_b128 v[52:55], v2 offset:26624
  s_waitcnt lgkmcnt(1)
  v_sub_f32 v20, v20, v15
  v_mfma_f32_16x16x32_bf16 v[16:19], v[56:59], v[88:91], v[16:19]
  v_sub_f32 v21, v21, v15
  v_sub_f32 v22, v22, v15
  v_mfma_f32_16x16x32_bf16 v[16:19], v[60:63], v[92:95], v[16:19]
  v_sub_f32 v23, v23, v15
  v_exp_f32 v20, v20
  v_exp_f32 v21, v21
  v_exp_f32 v22, v22
  v_exp_f32 v23, v23
  v_add_f32 v13, v13, v20
  v_add_f32 v13, v13, v21
  v_add_f32 v13, v13, v22
  v_add_f32 v13, v13, v23
  v_cvt_pk_bf16_f32 v76, v20, v21
  v_cvt_pk_bf16_f32 v77, v22, v23
  v_mfma_f32_16x16x32_bf16 v[20:23], v[24:27], v[128:131], 0
  ds_read_b128 v[80:83], v9 offset:0
  ds_read_b128 v[84:87], v9 offset:1024
  v_mfma_f32_16x16x32_bf16 v[20:23], v[28:31], v[132:135], v[20:23]
  ds_read_b128 v[88:91], v9 offset:2048
  ds_read_b128 v[92:95], v9 offset:3072
  v_mfma_f32_16x16x32_bf16 v[20:23], v[32:35], v[136:139], v[20:23]
  ds_read_b32 v0, v9 offset:13312
  s_waitcnt lgkmcnt(0)
  v_sub_f32 v16, v16, v0
  v_mfma_f32_16x16x32_bf16 v[20:23], v[36:39], v[140:143], v[20:23]
  v_sub_f32 v17, v17, v0
  v_sub_f32 v18, v18, v0
  v_mfma_f32_16x16x32_bf16 v[20:23], v[40:43], v[144:147], v[20:23]
  v_sub_f32 v19, v19, v0
  v_mfma_f32_16x16x32_bf16 v[20:23], v[44:47], v[148:151], v[20:23]
  v_exp_f32 v16, v16
  v_mfma_f32_16x16x32_bf16 v[20:23], v[48:51], v[152:155], v[20:23]
  v_exp_f32 v17, v17
  v_mfma_f32_16x16x32_bf16 v[20:23], v[52:55], v[156:159], v[20:23]
  v_exp_f32 v18, v18
  v_exp_f32 v19, v19
  v_add_f32 v14, v14, v16
  v_add_f32 v14, v14, v17
  v_add_f32 v14, v14, v18
  v_add_f32 v14, v14, v19
  v_cvt_pk_bf16_f32 v16, v16, v17
  v_cvt_pk_bf16_f32 v17, v18, v19
  ds_write_b64 v9, v[16:17] offset:8192
  v_mfma_f32_16x16x32_bf16 v[16:19], v[24:27], v[160:163], 0
  ds_read_b128 v[56:59], v1 offset:4096
  v_mfma_f32_16x16x32_bf16 v[16:19], v[28:31], v[164:167], v[16:19]
  ds_read_b128 v[60:63], v2 offset:4096
  v_mfma_f32_16x16x32_bf16 v[16:19], v[32:35], v[168:171], v[16:19]
  ds_read_b32 v15, v9 offset:12288
  s_waitcnt lgkmcnt(0)
  v_sub_f32 v20, v20, v15
  v_mfma_f32_16x16x32_bf16 v[16:19], v[36:39], v[172:175], v[16:19]
  v_sub_f32 v21, v21, v15
  v_sub_f32 v22, v22, v15
  v_mfma_f32_16x16x32_bf16 v[16:19], v[40:43], v[176:179], v[16:19]
  v_sub_f32 v23, v23, v15
  v_mfma_f32_16x16x32_bf16 v[16:19], v[44:47], v[180:183], v[16:19]
  v_exp_f32 v20, v20
  v_mfma_f32_16x16x32_bf16 v[16:19], v[48:51], v[184:187], v[16:19]
  v_exp_f32 v21, v21
  v_mfma_f32_16x16x32_bf16 v[16:19], v[52:55], v[188:191], v[16:19]
  v_exp_f32 v22, v22
  v_exp_f32 v23, v23
  v_add_f32 v10, v10, v20
  v_add_f32 v10, v10, v21
  v_add_f32 v10, v10, v22
  v_add_f32 v10, v10, v23
  v_cvt_pk_bf16_f32 v66, v20, v21
  v_cvt_pk_bf16_f32 v67, v22, v23
  v_mfma_f32_16x16x32_bf16 v[20:23], v[24:27], v[192:195], 0
  v_mfma_f32_16x16x32_bf16 v[20:23], v[28:31], v[196:199], v[20:23]
  v_mfma_f32_16x16x32_bf16 v[20:23], v[32:35], v[200:203], v[20:23]
  ds_read_b32 v0, v9 offset:12292
  s_waitcnt lgkmcnt(0)
  v_sub_f32 v16, v16, v0
  v_mfma_f32_16x16x32_bf16 v[20:23], v[36:39], v[204:207], v[20:23]
  v_sub_f32 v17, v17, v0
  v_sub_f32 v18, v18, v0
  v_mfma_f32_16x16x32_bf16 v[20:23], v[40:43], v[208:211], v[20:23]
  v_sub_f32 v19, v19, v0
  v_mfma_f32_16x16x32_bf16 v[20:23], v[44:47], v[212:215], v[20:23]
  v_exp_f32 v16, v16
  v_mfma_f32_16x16x32_bf16 v[20:23], v[48:51], v[216:219], v[20:23]
  v_exp_f32 v17, v17
  v_mfma_f32_16x16x32_bf16 v[20:23], v[52:55], v[220:223], v[20:23]
  v_exp_f32 v18, v18
  v_exp_f32 v19, v19
  v_add_f32 v11, v11, v16
  v_add_f32 v11, v11, v17
  v_add_f32 v11, v11, v18
  v_add_f32 v11, v11, v19
  v_cvt_pk_bf16_f32 v70, v16, v17
  v_cvt_pk_bf16_f32 v71, v18, v19
  v_mfma_f32_16x16x32_bf16 v[16:19], v[24:27], v[224:227], 0
  v_mfma_f32_16x16x32_bf16 v[16:19], v[28:31], v[228:231], v[16:19]
  v_mfma_f32_16x16x32_bf16 v[16:19], v[32:35], v[232:235], v[16:19]
  ds_read_b32 v15, v9 offset:12296
  s_waitcnt lgkmcnt(0)
  v_sub_f32 v20, v20, v15
  v_mfma_f32_16x16x32_bf16 v[16:19], v[36:39], v[236:239], v[16:19]
  v_sub_f32 v21, v21, v15
  v_sub_f32 v22, v22, v15
  v_mfma_f32_16x16x32_bf16 v[16:19], v[40:43], v[240:243], v[16:19]
  v_sub_f32 v23, v23, v15
  v_mfma_f32_16x16x32_bf16 v[16:19], v[44:47], v[244:247], v[16:19]
  v_exp_f32 v20, v20
  v_mfma_f32_16x16x32_bf16 v[16:19], v[48:51], v[248:251], v[16:19]
  v_exp_f32 v21, v21
  v_mfma_f32_16x16x32_bf16 v[16:19], v[52:55], v[252:255], v[16:19]
  v_exp_f32 v22, v22
  v_exp_f32 v23, v23
  v_add_f32 v12, v12, v20
  v_add_f32 v12, v12, v21
  v_add_f32 v12, v12, v22
  v_add_f32 v12, v12, v23
  v_cvt_pk_bf16_f32 v74, v20, v21
  v_cvt_pk_bf16_f32 v75, v22, v23
  v_mfma_f32_16x16x32_bf16 v[20:23], v[24:27], v[80:83], 0
  ds_read_b128 v[80:83], v9 offset:4096
  ds_read_b128 v[24:27], v1 offset:12288
  v_mfma_f32_16x16x32_bf16 v[20:23], v[28:31], v[84:87], v[20:23]
  ds_read_b128 v[84:87], v9 offset:5120
  ds_read_b128 v[28:31], v2 offset:12288
  v_mfma_f32_16x16x32_bf16 v[20:23], v[32:35], v[88:91], v[20:23]
  ds_read_b128 v[88:91], v9 offset:6144
  ds_read_b128 v[32:35], v1 offset:20480
  v_mfma_f32_16x16x32_bf16 v[20:23], v[36:39], v[92:95], v[20:23]
  ds_read_b128 v[92:95], v9 offset:7168
  ds_read_b128 v[36:39], v2 offset:20480
  s_waitcnt lgkmcnt(7)
  v_mfma_f32_16x16x32_bf16 v[20:23], v[40:43], v[80:83], v[20:23]
  ds_read_b128 v[40:43], v1 offset:28672
  ds_read_b32 v0, v9 offset:12300
  s_waitcnt lgkmcnt(7)
  v_mfma_f32_16x16x32_bf16 v[20:23], v[44:47], v[84:87], v[20:23]
  ds_read_b128 v[44:47], v2 offset:28672
  s_waitcnt lgkmcnt(1)
  v_sub_f32 v16, v16, v0
  v_mfma_f32_16x16x32_bf16 v[20:23], v[48:51], v[88:91], v[20:23]
  v_sub_f32 v17, v17, v0
  v_sub_f32 v18, v18, v0
  v_mfma_f32_16x16x32_bf16 v[20:23], v[52:55], v[92:95], v[20:23]
  v_sub_f32 v19, v19, v0
  v_exp_f32 v16, v16
  v_exp_f32 v17, v17
  v_exp_f32 v18, v18
  v_exp_f32 v19, v19
  v_add_f32 v13, v13, v16
  v_add_f32 v13, v13, v17
  v_add_f32 v13, v13, v18
  v_add_f32 v13, v13, v19
  v_cvt_pk_bf16_f32 v78, v16, v17
  v_cvt_pk_bf16_f32 v79, v18, v19
  v_mfma_f32_16x16x32_bf16 v[16:19], v[56:59], v[128:131], 0
  v_mfma_f32_16x16x32_bf16 v[16:19], v[60:63], v[132:135], v[16:19]
  v_mfma_f32_16x16x32_bf16 v[16:19], v[24:27], v[136:139], v[16:19]
  ds_read_b32 v15, v9 offset:13312
  s_waitcnt lgkmcnt(0)
  v_sub_f32 v20, v20, v15
  v_mfma_f32_16x16x32_bf16 v[16:19], v[28:31], v[140:143], v[16:19]
  v_sub_f32 v21, v21, v15
  v_sub_f32 v22, v22, v15
  v_mfma_f32_16x16x32_bf16 v[16:19], v[32:35], v[144:147], v[16:19]
  v_sub_f32 v23, v23, v15
  v_mfma_f32_16x16x32_bf16 v[16:19], v[36:39], v[148:151], v[16:19]
  v_exp_f32 v20, v20
  v_mfma_f32_16x16x32_bf16 v[16:19], v[40:43], v[152:155], v[16:19]
  v_exp_f32 v21, v21
  v_mfma_f32_16x16x32_bf16 v[16:19], v[44:47], v[156:159], v[16:19]
  v_exp_f32 v22, v22
  v_exp_f32 v23, v23
  v_add_f32 v14, v14, v20
  v_add_f32 v14, v14, v21
  v_add_f32 v14, v14, v22
  v_add_f32 v14, v14, v23
  v_cvt_pk_bf16_f32 v20, v20, v21
  v_cvt_pk_bf16_f32 v21, v22, v23
  ds_write_b64 v9, v[20:21] offset:8200
  v_mfma_f32_16x16x32_bf16 v[20:23], v[56:59], v[160:163], 0
  ds_read_b128 v[48:51], v1 offset:6144
  v_mfma_f32_16x16x32_bf16 v[20:23], v[60:63], v[164:167], v[20:23]
  ds_read_b128 v[52:55], v2 offset:6144
  v_mfma_f32_16x16x32_bf16 v[20:23], v[24:27], v[168:171], v[20:23]
  ds_read_b32 v0, v9 offset:12288
  s_waitcnt lgkmcnt(0)
  v_sub_f32 v16, v16, v0
  v_mfma_f32_16x16x32_bf16 v[20:23], v[28:31], v[172:175], v[20:23]
  v_sub_f32 v17, v17, v0
  v_sub_f32 v18, v18, v0
  v_mfma_f32_16x16x32_bf16 v[20:23], v[32:35], v[176:179], v[20:23]
  v_sub_f32 v19, v19, v0
  v_mfma_f32_16x16x32_bf16 v[20:23], v[36:39], v[180:183], v[20:23]
  v_exp_f32 v16, v16
  v_mfma_f32_16x16x32_bf16 v[20:23], v[40:43], v[184:187], v[20:23]
  v_exp_f32 v17, v17
  v_mfma_f32_16x16x32_bf16 v[20:23], v[44:47], v[188:191], v[20:23]
  v_exp_f32 v18, v18
  v_exp_f32 v19, v19
  v_add_f32 v10, v10, v16
  v_add_f32 v10, v10, v17
  v_add_f32 v10, v10, v18
  v_add_f32 v10, v10, v19
  v_cvt_pk_bf16_f32 v80, v16, v17
  v_cvt_pk_bf16_f32 v81, v18, v19
  v_mfma_f32_16x16x32_bf16 v[16:19], v[56:59], v[192:195], 0
  s_waitcnt vmcnt(8)
  s_barrier
  v_mfma_f32_16x16x32_bf16 v[16:19], v[60:63], v[196:199], v[16:19]
  s_add_u32 m0, s33, 0
  s_add_u32 s34, s31, 0
  buffer_load_dwordx4 v8, s[12:15], s34 offen nt lds
  v_mfma_f32_16x16x32_bf16 v[16:19], v[24:27], v[200:203], v[16:19]
  ds_read_b32 v15, v9 offset:12292
  s_waitcnt lgkmcnt(0)
  v_sub_f32 v20, v20, v15
  v_mfma_f32_16x16x32_bf16 v[16:19], v[28:31], v[204:207], v[16:19]
  v_sub_f32 v21, v21, v15
  v_sub_f32 v22, v22, v15
  v_mfma_f32_16x16x32_bf16 v[16:19], v[32:35], v[208:211], v[16:19]
  v_sub_f32 v23, v23, v15
  v_mfma_f32_16x16x32_bf16 v[16:19], v[36:39], v[212:215], v[16:19]
  v_exp_f32 v20, v20
  v_mfma_f32_16x16x32_bf16 v[16:19], v[40:43], v[216:219], v[16:19]
  s_add_u32 m0, s33, 1024
  s_add_u32 s34, s31, 4096
  buffer_load_dwordx4 v8, s[12:15], s34 offen nt lds
  v_mfma_f32_16x16x32_bf16 v[16:19], v[44:47], v[220:223], v[16:19]
  v_exp_f32 v21, v21
  v_exp_f32 v22, v22
  v_exp_f32 v23, v23
  v_add_f32 v11, v11, v20
  v_add_f32 v11, v11, v21
  v_add_f32 v11, v11, v22
  v_add_f32 v11, v11, v23
  v_cvt_pk_bf16_f32 v84, v20, v21
  v_cvt_pk_bf16_f32 v85, v22, v23
  v_mfma_f32_16x16x32_bf16 v[20:23], v[56:59], v[224:227], 0
  ds_read_b128 v[56:59], v1 offset:14336
  v_mfma_f32_16x16x32_bf16 v[20:23], v[60:63], v[228:231], v[20:23]
  ds_read_b128 v[60:63], v2 offset:14336
  v_mfma_f32_16x16x32_bf16 v[20:23], v[24:27], v[232:235], v[20:23]
  ds_read_b128 v[24:27], v1 offset:22528
  ds_read_b32 v0, v9 offset:12296
  v_mfma_f32_16x16x32_bf16 v[20:23], v[28:31], v[236:239], v[20:23]
  s_add_u32 m0, s33, 2048
  s_add_u32 s34, s31, 8192
  buffer_load_dwordx4 v8, s[12:15], s34 offen nt lds
  v_mfma_f32_16x16x32_bf16 v[20:23], v[32:35], v[240:243], v[20:23]
  ds_read_b128 v[28:31], v2 offset:22528
  ds_read_b128 v[32:35], v1 offset:30720
  v_mfma_f32_16x16x32_bf16 v[20:23], v[36:39], v[244:247], v[20:23]
  ds_read_b128 v[36:39], v2 offset:30720
  s_waitcnt lgkmcnt(3)
  v_sub_f32 v16, v16, v0
  v_mfma_f32_16x16x32_bf16 v[20:23], v[40:43], v[248:251], v[20:23]
  v_sub_f32 v17, v17, v0
  v_sub_f32 v18, v18, v0
  v_mfma_f32_16x16x32_bf16 v[20:23], v[44:47], v[252:255], v[20:23]
  v_sub_f32 v19, v19, v0
  v_exp_f32 v16, v16
  v_exp_f32 v17, v17
  v_exp_f32 v18, v18
  v_exp_f32 v19, v19
  v_add_f32 v12, v12, v16
  v_add_f32 v12, v12, v17
  v_add_f32 v12, v12, v18
  v_add_f32 v12, v12, v19
  v_cvt_pk_bf16_f32 v88, v16, v17
  v_cvt_pk_bf16_f32 v89, v18, v19
  v_mfma_f32_16x16x32_bf16 v[16:19], v[48:51], v[128:131], 0
  s_add_u32 m0, s33, 3072
  s_add_u32 s34, s31, 12288
  buffer_load_dwordx4 v8, s[12:15], s34 offen nt lds
  v_mfma_f32_16x16x32_bf16 v[16:19], v[52:55], v[132:135], v[16:19]
  v_mfma_f32_16x16x32_bf16 v[16:19], v[56:59], v[136:139], v[16:19]
  ds_read_b32 v15, v9 offset:12300
  s_waitcnt lgkmcnt(0)
  v_sub_f32 v20, v20, v15
  v_mfma_f32_16x16x32_bf16 v[16:19], v[60:63], v[140:143], v[16:19]
  v_sub_f32 v21, v21, v15
  v_sub_f32 v22, v22, v15
  v_mfma_f32_16x16x32_bf16 v[16:19], v[24:27], v[144:147], v[16:19]
  v_sub_f32 v23, v23, v15
  v_mfma_f32_16x16x32_bf16 v[16:19], v[28:31], v[148:151], v[16:19]
  s_add_u32 m0, s33, 4096
  s_add_u32 s34, s31, 16384
  buffer_load_dwordx4 v8, s[12:15], s34 offen nt lds
  v_mfma_f32_16x16x32_bf16 v[16:19], v[32:35], v[152:155], v[16:19]
  v_exp_f32 v20, v20
  v_mfma_f32_16x16x32_bf16 v[16:19], v[36:39], v[156:159], v[16:19]
  v_exp_f32 v21, v21
  v_exp_f32 v22, v22
  v_exp_f32 v23, v23
  v_add_f32 v13, v13, v20
  v_add_f32 v13, v13, v21
  v_add_f32 v13, v13, v22
  v_add_f32 v13, v13, v23
  v_cvt_pk_bf16_f32 v92, v20, v21
  v_cvt_pk_bf16_f32 v93, v22, v23
  v_mfma_f32_16x16x32_bf16 v[20:23], v[48:51], v[160:163], 0
  ds_read_b64_tr_b16 v[40:41], v3 offset:16384
  ds_read_b64_tr_b16 v[42:43], v3 offset:18432
  v_mfma_f32_16x16x32_bf16 v[20:23], v[52:55], v[164:167], v[20:23]
  ds_read_b64_tr_b16 v[44:45], v3 offset:20480
  ds_read_b64_tr_b16 v[46:47], v3 offset:22528
  v_mfma_f32_16x16x32_bf16 v[20:23], v[56:59], v[168:171], v[20:23]
  s_add_u32 m0, s33, 5120
  s_add_u32 s34, s31, 20480
  buffer_load_dwordx4 v8, s[12:15], s34 offen nt lds
  v_mfma_f32_16x16x32_bf16 v[20:23], v[60:63], v[172:175], v[20:23]
  ds_read_b32 v0, v9 offset:12288
  s_waitcnt lgkmcnt(0)
  v_sub_f32 v16, v16, v0
  v_mfma_f32_16x16x32_bf16 v[20:23], v[24:27], v[176:179], v[20:23]
  v_sub_f32 v17, v17, v0
  v_sub_f32 v18, v18, v0
  v_mfma_f32_16x16x32_bf16 v[20:23], v[28:31], v[180:183], v[20:23]
  v_sub_f32 v19, v19, v0
  v_mfma_f32_16x16x32_bf16 v[20:23], v[32:35], v[184:187], v[20:23]
  v_exp_f32 v16, v16
  v_mfma_f32_16x16x32_bf16 v[20:23], v[36:39], v[188:191], v[20:23]
  v_exp_f32 v17, v17
  v_exp_f32 v18, v18
  v_exp_f32 v19, v19
  v_add_f32 v10, v10, v16
  v_add_f32 v10, v10, v17
  v_add_f32 v10, v10, v18
  v_add_f32 v10, v10, v19
  v_cvt_pk_bf16_f32 v82, v16, v17
  v_cvt_pk_bf16_f32 v83, v18, v19
  s_add_u32 m0, s33, 6144
  s_add_u32 s34, s31, 24576
  buffer_load_dwordx4 v8, s[12:15], s34 offen nt lds
  v_mfma_f32_16x16x32_bf16 v[16:19], v[48:51], v[192:195], 0
  v_mfma_f32_16x16x32_bf16 v[16:19], v[52:55], v[196:199], v[16:19]
  v_mfma_f32_16x16x32_bf16 v[16:19], v[56:59], v[200:203], v[16:19]
  ds_read_b32 v15, v9 offset:12292
  s_waitcnt lgkmcnt(0)
  v_sub_f32 v20, v20, v15
  v_mfma_f32_16x16x32_bf16 v[16:19], v[60:63], v[204:207], v[16:19]
  v_sub_f32 v21, v21, v15
  v_sub_f32 v22, v22, v15
  v_mfma_f32_16x16x32_bf16 v[16:19], v[24:27], v[208:211], v[16:19]
  s_add_u32 m0, s33, 7168
  s_add_u32 s34, s31, 28672
  buffer_load_dwordx4 v8, s[12:15], s34 offen nt lds
  s_add_u32 s31, s31, 32768
  s_xor_b32 s33, s33, 65536
  v_mfma_f32_16x16x32_bf16 v[16:19], v[28:31], v[212:215], v[16:19]
  v_sub_f32 v23, v23, v15
  v_mfma_f32_16x16x32_bf16 v[16:19], v[32:35], v[216:219], v[16:19]
  v_exp_f32 v20, v20
  v_mfma_f32_16x16x32_bf16 v[16:19], v[36:39], v[220:223], v[16:19]
  v_exp_f32 v21, v21
  v_exp_f32 v22, v22
  v_exp_f32 v23, v23
  v_add_f32 v11, v11, v20
  v_add_f32 v11, v11, v21
  v_add_f32 v11, v11, v22
  v_add_f32 v11, v11, v23
  v_cvt_pk_bf16_f32 v86, v20, v21
  v_cvt_pk_bf16_f32 v87, v22, v23
  v_mfma_f32_16x16x32_bf16 v[20:23], v[48:51], v[224:227], 0
  ds_read_b64_tr_b16 v[48:49], v4 offset:16384
  ds_read_b64_tr_b16 v[50:51], v4 offset:18432
  v_mfma_f32_16x16x32_bf16 v[20:23], v[52:55], v[228:231], v[20:23]
  ds_read_b64_tr_b16 v[52:53], v4 offset:20480
  ds_read_b64_tr_b16 v[54:55], v4 offset:22528
  v_mfma_f32_16x16x32_bf16 v[20:23], v[56:59], v[232:235], v[20:23]
  ds_read_b32 v0, v9 offset:12296
  s_waitcnt lgkmcnt(0)
  v_sub_f32 v16, v16, v0
  v_mfma_f32_16x16x32_bf16 v[20:23], v[60:63], v[236:239], v[20:23]
  v_sub_f32 v17, v17, v0
  v_sub_f32 v18, v18, v0
  v_mfma_f32_16x16x32_bf16 v[20:23], v[24:27], v[240:243], v[20:23]
  v_sub_f32 v19, v19, v0
  v_mfma_f32_16x16x32_bf16 v[20:23], v[28:31], v[244:247], v[20:23]
  v_exp_f32 v16, v16
  v_mfma_f32_16x16x32_bf16 v[20:23], v[32:35], v[248:251], v[20:23]
  v_exp_f32 v17, v17
  v_mfma_f32_16x16x32_bf16 v[20:23], v[36:39], v[252:255], v[20:23]
  v_exp_f32 v18, v18
  v_exp_f32 v19, v19
  v_add_f32 v12, v12, v16
  v_add_f32 v12, v12, v17
  v_add_f32 v12, v12, v18
  v_add_f32 v12, v12, v19
  v_cvt_pk_bf16_f32 v90, v16, v17
  v_cvt_pk_bf16_f32 v91, v18, v19
  ds_read_b64_tr_b16 v[56:57], v5 offset:16384
  ds_read_b64_tr_b16 v[58:59], v5 offset:18432
  ds_read_b64_tr_b16 v[60:61], v5 offset:20480
  ds_read_b64_tr_b16 v[62:63], v5 offset:22528
  v_mfma_f32_16x16x32_bf16 a[32:35], v[40:43], v[64:67], a[32:35]
  v_mfma_f32_16x16x32_bf16 a[32:35], v[44:47], v[80:83], a[32:35]
  ds_read_b32 v15, v9 offset:12300
  s_waitcnt lgkmcnt(0)
  v_sub_f32 v20, v20, v15
  v_mfma_f32_16x16x32_bf16 a[96:99], v[40:43], v[68:71], a[96:99]
  v_sub_f32 v21, v21, v15
  v_sub_f32 v22, v22, v15
  v_mfma_f32_16x16x32_bf16 a[96:99], v[44:47], v[84:87], a[96:99]
  v_sub_f32 v23, v23, v15
  v_mfma_f32_16x16x32_bf16 a[160:163], v[40:43], v[72:75], a[160:163]
  v_exp_f32 v20, v20
  v_mfma_f32_16x16x32_bf16 a[160:163], v[44:47], v[88:91], a[160:163]
  v_exp_f32 v21, v21
  v_mfma_f32_16x16x32_bf16 a[224:227], v[40:43], v[76:79], a[224:227]
  v_exp_f32 v22, v22
  v_exp_f32 v23, v23
  v_add_f32 v13, v13, v20
  v_add_f32 v13, v13, v21
  v_add_f32 v13, v13, v22
  v_add_f32 v13, v13, v23
  v_cvt_pk_bf16_f32 v94, v20, v21
  v_cvt_pk_bf16_f32 v95, v22, v23
  s_nop 1
  v_mfma_f32_16x16x32_bf16 a[224:227], v[44:47], v[92:95], a[224:227]
  ds_read_b64_tr_b16 v[24:25], v6 offset:16384
  ds_read_b64_tr_b16 v[26:27], v6 offset:18432
  v_mfma_f32_16x16x32_bf16 a[36:39], v[48:51], v[64:67], a[36:39]
  ds_read_b64_tr_b16 v[28:29], v6 offset:20480
  ds_read_b64_tr_b16 v[30:31], v6 offset:22528
  v_mfma_f32_16x16x32_bf16 a[36:39], v[52:55], v[80:83], a[36:39]
  v_xor_b32 v1, 65536, v1
  v_xor_b32 v2, 65536, v2
  v_mfma_f32_16x16x32_bf16 a[100:103], v[48:51], v[68:71], a[100:103]
  v_mfma_f32_16x16x32_bf16 a[100:103], v[52:55], v[84:87], a[100:103]
  v_mfma_f32_16x16x32_bf16 a[164:167], v[48:51], v[72:75], a[164:167]
  ds_read_b128 v[16:19], v9 offset:8192
  ds_read_b128 v[20:23], v9 offset:9216
  v_mfma_f32_16x16x32_bf16 a[164:167], v[52:55], v[88:91], a[164:167]
  v_mfma_f32_16x16x32_bf16 a[228:231], v[48:51], v[76:79], a[228:231]
  v_mfma_f32_16x16x32_bf16 a[228:231], v[52:55], v[92:95], a[228:231]
  ds_read_b64_tr_b16 v[32:33], v3 offset:24576
  ds_read_b64_tr_b16 v[34:35], v3 offset:26624
  v_mfma_f32_16x16x32_bf16 a[40:43], v[56:59], v[64:67], a[40:43]
  ds_read_b64_tr_b16 v[36:37], v3 offset:28672
  ds_read_b64_tr_b16 v[38:39], v3 offset:30720
  v_mfma_f32_16x16x32_bf16 a[40:43], v[60:63], v[80:83], a[40:43]
  v_mfma_f32_16x16x32_bf16 a[104:107], v[56:59], v[68:71], a[104:107]
  v_mfma_f32_16x16x32_bf16 a[104:107], v[60:63], v[84:87], a[104:107]
  v_mfma_f32_16x16x32_bf16 a[168:171], v[56:59], v[72:75], a[168:171]
  v_mfma_f32_16x16x32_bf16 a[168:171], v[60:63], v[88:91], a[168:171]
  v_mfma_f32_16x16x32_bf16 a[232:235], v[56:59], v[76:79], a[232:235]
  v_mfma_f32_16x16x32_bf16 a[232:235], v[60:63], v[92:95], a[232:235]
  ds_read_b64_tr_b16 v[48:49], v4 offset:24576
  ds_read_b64_tr_b16 v[50:51], v4 offset:26624
  s_waitcnt lgkmcnt(10)
  v_mfma_f32_16x16x32_bf16 a[44:47], v[24:27], v[64:67], a[44:47]
  ds_read_b64_tr_b16 v[52:53], v4 offset:28672
  ds_read_b64_tr_b16 v[54:55], v4 offset:30720
  s_waitcnt lgkmcnt(10)
  v_mfma_f32_16x16x32_bf16 a[44:47], v[28:31], v[80:83], a[44:47]
  v_mfma_f32_16x16x32_bf16 a[108:111], v[24:27], v[68:71], a[108:111]
  v_mfma_f32_16x16x32_bf16 a[108:111], v[28:31], v[84:87], a[108:111]
  v_mfma_f32_16x16x32_bf16 a[172:175], v[24:27], v[72:75], a[172:175]
  v_mfma_f32_16x16x32_bf16 a[172:175], v[28:31], v[88:91], a[172:175]
  v_mfma_f32_16x16x32_bf16 a[236:239], v[24:27], v[76:79], a[236:239]
  v_mfma_f32_16x16x32_bf16 a[236:239], v[28:31], v[92:95], a[236:239]
  ds_read_b64_tr_b16 v[56:57], v5 offset:24576
  ds_read_b64_tr_b16 v[58:59], v5 offset:26624
  s_waitcnt lgkmcnt(8)
  v_mfma_f32_16x16x32_bf16 a[48:51], v[32:35], v[64:67], a[48:51]
  ds_read_b64_tr_b16 v[60:61], v5 offset:28672
  ds_read_b64_tr_b16 v[62:63], v5 offset:30720
  s_waitcnt lgkmcnt(8)
  v_mfma_f32_16x16x32_bf16 a[48:51], v[36:39], v[80:83], a[48:51]
  v_mfma_f32_16x16x32_bf16 a[112:115], v[32:35], v[68:71], a[112:115]
  v_mfma_f32_16x16x32_bf16 a[112:115], v[36:39], v[84:87], a[112:115]
  v_mfma_f32_16x16x32_bf16 a[176:179], v[32:35], v[72:75], a[176:179]
  v_mfma_f32_16x16x32_bf16 a[176:179], v[36:39], v[88:91], a[176:179]
  v_mfma_f32_16x16x32_bf16 a[240:243], v[32:35], v[76:79], a[240:243]
  v_mfma_f32_16x16x32_bf16 a[240:243], v[36:39], v[92:95], a[240:243]
  ds_read_b64_tr_b16 v[40:41], v6 offset:24576
  ds_read_b64_tr_b16 v[42:43], v6 offset:26624
  s_waitcnt lgkmcnt(8)
  v_mfma_f32_16x16x32_bf16 a[52:55], v[48:51], v[64:67], a[52:55]
  ds_read_b64_tr_b16 v[44:45], v6 offset:28672
  ds_read_b64_tr_b16 v[46:47], v6 offset:30720
  s_waitcnt lgkmcnt(8)
  v_mfma_f32_16x16x32_bf16 a[52:55], v[52:55], v[80:83], a[52:55]
  v_mfma_f32_16x16x32_bf16 a[116:119], v[48:51], v[68:71], a[116:119]
  v_mfma_f32_16x16x32_bf16 a[116:119], v[52:55], v[84:87], a[116:119]
  v_mfma_f32_16x16x32_bf16 a[180:183], v[48:51], v[72:75], a[180:183]
  v_mfma_f32_16x16x32_bf16 a[180:183], v[52:55], v[88:91], a[180:183]
  v_mfma_f32_16x16x32_bf16 a[244:247], v[48:51], v[76:79], a[244:247]
  v_mfma_f32_16x16x32_bf16 a[244:247], v[52:55], v[92:95], a[244:247]
  ds_read_b64_tr_b16 v[24:25], v3 offset:0
  ds_read_b64_tr_b16 v[26:27], v3 offset:2048
  s_waitcnt lgkmcnt(8)
  v_mfma_f32_16x16x32_bf16 a[56:59], v[56:59], v[64:67], a[56:59]
  ds_read_b64_tr_b16 v[28:29], v3 offset:4096
  ds_read_b64_tr_b16 v[30:31], v3 offset:6144
  s_waitcnt lgkmcnt(8)
  v_mfma_f32_16x16x32_bf16 a[56:59], v[60:63], v[80:83], a[56:59]
  v_mfma_f32_16x16x32_bf16 a[120:123], v[56:59], v[68:71], a[120:123]
  v_mfma_f32_16x16x32_bf16 a[120:123], v[60:63], v[84:87], a[120:123]
  v_mfma_f32_16x16x32_bf16 a[184:187], v[56:59], v[72:75], a[184:187]
  v_mfma_f32_16x16x32_bf16 a[184:187], v[60:63], v[88:91], a[184:187]
  v_mfma_f32_16x16x32_bf16 a[248:251], v[56:59], v[76:79], a[248:251]
  v_mfma_f32_16x16x32_bf16 a[248:251], v[60:63], v[92:95], a[248:251]
  ds_read_b64_tr_b16 v[48:49], v4 offset:0
  ds_read_b64_tr_b16 v[50:51], v4 offset:2048
  s_waitcnt lgkmcnt(8)
  v_mfma_f32_16x16x32_bf16 a[60:63], v[40:43], v[64:67], a[60:63]
  ds_read_b64_tr_b16 v[52:53], v4 offset:4096
  ds_read_b64_tr_b16 v[54:55], v4 offset:6144
  s_waitcnt lgkmcnt(8)
  v_mfma_f32_16x16x32_bf16 a[60:63], v[44:47], v[80:83], a[60:63]
  v_mfma_f32_16x16x32_bf16 a[124:127], v[40:43], v[68:71], a[124:127]
  v_mfma_f32_16x16x32_bf16 a[124:127], v[44:47], v[84:87], a[124:127]
  v_mfma_f32_16x16x32_bf16 a[188:191], v[40:43], v[72:75], a[188:191]
  v_mfma_f32_16x16x32_bf16 a[188:191], v[44:47], v[88:91], a[188:191]
  v_mfma_f32_16x16x32_bf16 a[252:255], v[40:43], v[76:79], a[252:255]
  v_mfma_f32_16x16x32_bf16 a[252:255], v[44:47], v[92:95], a[252:255]
  ds_read_b64_tr_b16 v[56:57], v5 offset:0
  ds_read_b64_tr_b16 v[58:59], v5 offset:2048
  s_waitcnt lgkmcnt(8)
  v_mfma_f32_16x16x32_bf16 a[0:3], v[24:27], v[64:67], a[0:3]
  ds_read_b64_tr_b16 v[60:61], v5 offset:4096
  ds_read_b64_tr_b16 v[62:63], v5 offset:6144
  s_waitcnt lgkmcnt(8)
  v_mfma_f32_16x16x32_bf16 a[0:3], v[28:31], v[80:83], a[0:3]
  v_mfma_f32_16x16x32_bf16 a[64:67], v[24:27], v[68:71], a[64:67]
  v_mfma_f32_16x16x32_bf16 a[64:67], v[28:31], v[84:87], a[64:67]
  v_mfma_f32_16x16x32_bf16 a[128:131], v[24:27], v[72:75], a[128:131]
  v_mfma_f32_16x16x32_bf16 a[128:131], v[28:31], v[88:91], a[128:131]
  v_mfma_f32_16x16x32_bf16 a[192:195], v[24:27], v[76:79], a[192:195]
  v_mfma_f32_16x16x32_bf16 a[192:195], v[28:31], v[92:95], a[192:195]
  v_mfma_f32_16x16x32_bf16 v[96:99], v[24:27], v[16:19], v[96:99]
  v_mfma_f32_16x16x32_bf16 v[96:99], v[28:31], v[20:23], v[96:99]
  ds_read_b64_tr_b16 v[32:33], v6 offset:0
  ds_read_b64_tr_b16 v[34:35], v6 offset:2048
  s_waitcnt lgkmcnt(8)
  v_mfma_f32_16x16x32_bf16 a[4:7], v[48:51], v[64:67], a[4:7]
  ds_read_b64_tr_b16 v[36:37], v6 offset:4096
  ds_read_b64_tr_b16 v[38:39], v6 offset:6144
  s_waitcnt lgkmcnt(8)
  v_mfma_f32_16x16x32_bf16 a[4:7], v[52:55], v[80:83], a[4:7]
  v_mfma_f32_16x16x32_bf16 a[68:71], v[48:51], v[68:71], a[68:71]
  v_mfma_f32_16x16x32_bf16 a[68:71], v[52:55], v[84:87], a[68:71]
  v_mfma_f32_16x16x32_bf16 a[132:135], v[48:51], v[72:75], a[132:135]
  v_mfma_f32_16x16x32_bf16 a[132:135], v[52:55], v[88:91], a[132:135]
  v_mfma_f32_16x16x32_bf16 a[196:199], v[48:51], v[76:79], a[196:199]
  v_mfma_f32_16x16x32_bf16 a[196:199], v[52:55], v[92:95], a[196:199]
  v_mfma_f32_16x16x32_bf16 v[100:103], v[48:51], v[16:19], v[100:103]
  v_mfma_f32_16x16x32_bf16 v[100:103], v[52:55], v[20:23], v[100:103]
  ds_read_b64_tr_b16 v[40:41], v3 offset:8192
  ds_read_b64_tr_b16 v[42:43], v3 offset:10240
  s_waitcnt lgkmcnt(8)
  v_mfma_f32_16x16x32_bf16 a[8:11], v[56:59], v[64:67], a[8:11]
  ds_read_b64_tr_b16 v[44:45], v3 offset:12288
  ds_read_b64_tr_b16 v[46:47], v3 offset:14336
  s_waitcnt lgkmcnt(8)
  v_mfma_f32_16x16x32_bf16 a[8:11], v[60:63], v[80:83], a[8:11]
  v_mfma_f32_16x16x32_bf16 a[72:75], v[56:59], v[68:71], a[72:75]
  v_mfma_f32_16x16x32_bf16 a[72:75], v[60:63], v[84:87], a[72:75]
  v_mfma_f32_16x16x32_bf16 a[136:139], v[56:59], v[72:75], a[136:139]
  v_mfma_f32_16x16x32_bf16 a[136:139], v[60:63], v[88:91], a[136:139]
  v_mfma_f32_16x16x32_bf16 a[200:203], v[56:59], v[76:79], a[200:203]
  v_mfma_f32_16x16x32_bf16 a[200:203], v[60:63], v[92:95], a[200:203]
  v_mfma_f32_16x16x32_bf16 v[104:107], v[56:59], v[16:19], v[104:107]
  v_mfma_f32_16x16x32_bf16 v[104:107], v[60:63], v[20:23], v[104:107]
  ds_read_b64_tr_b16 v[48:49], v4 offset:8192
  ds_read_b64_tr_b16 v[50:51], v4 offset:10240
  s_waitcnt lgkmcnt(8)
  v_mfma_f32_16x16x32_bf16 a[12:15], v[32:35], v[64:67], a[12:15]
  s_waitcnt vmcnt(8)
  s_barrier
  ds_read_b64_tr_b16 v[52:53], v4 offset:12288
  s_waitcnt lgkmcnt(7)
  v_mfma_f32_16x16x32_bf16 a[12:15], v[36:39], v[80:83], a[12:15]
  s_add_u32 m0, s32, 0
  s_add_u32 s34, s30, 0
  buffer_load_dwordx4 v7, s[8:11], s34 offen nt lds
  v_mfma_f32_16x16x32_bf16 a[76:79], v[32:35], v[68:71], a[76:79]
  ds_read_b64_tr_b16 v[54:55], v4 offset:14336
  v_mfma_f32_16x16x32_bf16 a[76:79], v[36:39], v[84:87], a[76:79]
  v_mfma_f32_16x16x32_bf16 a[140:143], v[32:35], v[72:75], a[140:143]
  v_mfma_f32_16x16x32_bf16 a[140:143], v[36:39], v[88:91], a[140:143]
  v_mfma_f32_16x16x32_bf16 a[204:207], v[32:35], v[76:79], a[204:207]
  v_mfma_f32_16x16x32_bf16 a[204:207], v[36:39], v[92:95], a[204:207]
  s_add_u32 m0, s32, 1024
  s_add_u32 s34, s30, 4096
  buffer_load_dwordx4 v7, s[8:11], s34 offen nt lds
  v_mfma_f32_16x16x32_bf16 v[108:111], v[32:35], v[16:19], v[108:111]
  v_mfma_f32_16x16x32_bf16 v[108:111], v[36:39], v[20:23], v[108:111]
  ds_read_b64_tr_b16 v[56:57], v5 offset:8192
  ds_read_b64_tr_b16 v[58:59], v5 offset:10240
  s_waitcnt lgkmcnt(8)
  v_mfma_f32_16x16x32_bf16 a[16:19], v[40:43], v[64:67], a[16:19]
  ds_read_b64_tr_b16 v[60:61], v5 offset:12288
  ds_read_b64_tr_b16 v[62:63], v5 offset:14336
  s_waitcnt lgkmcnt(8)
  v_mfma_f32_16x16x32_bf16 a[16:19], v[44:47], v[80:83], a[16:19]
  ds_read_b128 v[32:35], v1 offset:0
  ds_read_b128 v[36:39], v2 offset:0
  v_mfma_f32_16x16x32_bf16 a[80:83], v[40:43], v[68:71], a[80:83]
  v_mfma_f32_16x16x32_bf16 a[80:83], v[44:47], v[84:87], a[80:83]
  s_add_u32 m0, s32, 2048
  s_add_u32 s34, s30, 8192
  buffer_load_dwordx4 v7, s[8:11], s34 offen nt lds
  v_mfma_f32_16x16x32_bf16 a[144:147], v[40:43], v[72:75], a[144:147]
  v_mfma_f32_16x16x32_bf16 a[144:147], v[44:47], v[88:91], a[144:147]
  v_mfma_f32_16x16x32_bf16 a[208:211], v[40:43], v[76:79], a[208:211]
  v_mfma_f32_16x16x32_bf16 a[208:211], v[44:47], v[92:95], a[208:211]
  v_mfma_f32_16x16x32_bf16 v[112:115], v[40:43], v[16:19], v[112:115]
  v_mfma_f32_16x16x32_bf16 v[112:115], v[44:47], v[20:23], v[112:115]
  s_add_u32 m0, s32, 3072
  s_add_u32 s34, s30, 12288
  buffer_load_dwordx4 v7, s[8:11], s34 offen nt lds
  s_waitcnt lgkmcnt(8)
  v_mfma_f32_16x16x32_bf16 a[20:23], v[48:51], v[64:67], a[20:23]
  ds_read_b64_tr_b16 v[24:25], v6 offset:8192
  ds_read_b64_tr_b16 v[26:27], v6 offset:10240
  s_waitcnt lgkmcnt(8)
  v_mfma_f32_16x16x32_bf16 a[20:23], v[52:55], v[80:83], a[20:23]
  ds_read_b64_tr_b16 v[28:29], v6 offset:12288
  ds_read_b64_tr_b16 v[30:31], v6 offset:14336
  v_mfma_f32_16x16x32_bf16 a[84:87], v[48:51], v[68:71], a[84:87]
  ds_read_b128 v[40:43], v1 offset:8192
  ds_read_b128 v[44:47], v2 offset:8192
  v_mfma_f32_16x16x32_bf16 a[84:87], v[52:55], v[84:87], a[84:87]
  v_mfma_f32_16x16x32_bf16 a[148:151], v[48:51], v[72:75], a[148:151]
  v_mfma_f32_16x16x32_bf16 a[148:151], v[52:55], v[88:91], a[148:151]
  s_add_u32 m0, s32, 4096
  s_add_u32 s34, s30, 16384
  buffer_load_dwordx4 v7, s[8:11], s34 offen nt lds
  v_mfma_f32_16x16x32_bf16 a[212:215], v[48:51], v[76:79], a[212:215]
  v_mfma_f32_16x16x32_bf16 a[212:215], v[52:55], v[92:95], a[212:215]
  v_mfma_f32_16x16x32_bf16 v[116:119], v[48:51], v[16:19], v[116:119]
  v_mfma_f32_16x16x32_bf16 v[116:119], v[52:55], v[20:23], v[116:119]
  ds_read_b128 v[48:51], v1 offset:16384
  ds_read_b128 v[52:55], v2 offset:16384
  s_waitcnt lgkmcnt(12)
  v_mfma_f32_16x16x32_bf16 a[24:27], v[56:59], v[64:67], a[24:27]
  s_waitcnt lgkmcnt(10)
  v_mfma_f32_16x16x32_bf16 a[24:27], v[60:63], v[80:83], a[24:27]
  s_add_u32 m0, s32, 5120
  s_add_u32 s34, s30, 20480
  buffer_load_dwordx4 v7, s[8:11], s34 offen nt lds
  v_mfma_f32_16x16x32_bf16 a[88:91], v[56:59], v[68:71], a[88:91]
  v_mfma_f32_16x16x32_bf16 a[88:91], v[60:63], v[84:87], a[88:91]
  v_mfma_f32_16x16x32_bf16 a[152:155], v[56:59], v[72:75], a[152:155]
  v_mfma_f32_16x16x32_bf16 a[152:155], v[60:63], v[88:91], a[152:155]
  v_mfma_f32_16x16x32_bf16 a[216:219], v[56:59], v[76:79], a[216:219]
  v_mfma_f32_16x16x32_bf16 a[216:219], v[60:63], v[92:95], a[216:219]
  s_add_u32 m0, s32, 6144
  s_add_u32 s34, s30, 24576
  buffer_load_dwordx4 v7, s[8:11], s34 offen nt lds
  v_mfma_f32_16x16x32_bf16 v[120:123], v[56:59], v[16:19], v[120:123]
  v_mfma_f32_16x16x32_bf16 v[120:123], v[60:63], v[20:23], v[120:123]
  ds_read_b128 v[56:59], v1 offset:24576
  ds_read_b128 v[60:63], v2 offset:24576
  s_waitcnt lgkmcnt(8)
  v_mfma_f32_16x16x32_bf16 a[28:31], v[24:27], v[64:67], a[28:31]
  s_waitcnt lgkmcnt(6)
  v_mfma_f32_16x16x32_bf16 a[28:31], v[28:31], v[80:83], a[28:31]
  v_mfma_f32_16x16x32_bf16 a[92:95], v[24:27], v[68:71], a[92:95]
  v_mfma_f32_16x16x32_bf16 a[92:95], v[28:31], v[84:87], a[92:95]
  s_add_u32 m0, s32, 7168
  s_add_u32 s34, s30, 28672
  buffer_load_dwordx4 v7, s[8:11], s34 offen nt lds
  s_add_u32 s30, s30, 32768
  s_xor_b32 s32, s32, 65536
  v_mfma_f32_16x16x32_bf16 a[156:159], v[24:27], v[72:75], a[156:159]
  v_mfma_f32_16x16x32_bf16 a[156:159], v[28:31], v[88:91], a[156:159]
  v_mfma_f32_16x16x32_bf16 a[220:223], v[24:27], v[76:79], a[220:223]
  v_mfma_f32_16x16x32_bf16 a[220:223], v[28:31], v[92:95], a[220:223]
  v_mfma_f32_16x16x32_bf16 v[124:127], v[24:27], v[16:19], v[124:127]
  v_mfma_f32_16x16x32_bf16 v[124:127], v[28:31], v[20:23], v[124:127]
  s_sub_u32 s29, s29, 1
  s_cmp_lg_u32 s29, 0
  s_cbranch_scc1 K1_SLOOP_P0
  s_waitcnt vmcnt(0)
  s_waitcnt lgkmcnt(0)
  s_nop 7
  v_mov_b32 v15, v10
  s_nop 1
  v_permlane32_swap_b32 v10, v15
  v_add_f32 v10, v10, v15
  v_mov_b32 v15, v10
  s_nop 1
  v_permlane16_swap_b32 v10, v15
  v_add_f32 v10, v10, v15
  v_mov_b32 v15, v11
  s_nop 1
  v_permlane32_swap_b32 v11, v15
  v_add_f32 v11, v11, v15
  v_mov_b32 v15, v11
  s_nop 1
  v_permlane16_swap_b32 v11, v15
  v_add_f32 v11, v11, v15
  v_mov_b32 v15, v12
  s_nop 1
  v_permlane32_swap_b32 v12, v15
  v_add_f32 v12, v12, v15
  v_mov_b32 v15, v12
  s_nop 1
  v_permlane16_swap_b32 v12, v15
  v_add_f32 v12, v12, v15
  v_mov_b32 v15, v13
  s_nop 1
  v_permlane32_swap_b32 v13, v15
  v_add_f32 v13, v13, v15
  v_mov_b32 v15, v13
  s_nop 1
  v_permlane16_swap_b32 v13, v15
  v_add_f32 v13, v13, v15
  v_mov_b32 v15, v14
  s_nop 1
  v_permlane32_swap_b32 v14, v15
  v_add_f32 v14, v14, v15
  v_mov_b32 v15, v14
  s_nop 1
  v_permlane16_swap_b32 v14, v15
  v_add_f32 v14, v14, v15
  ds_write_b32 v9, v14 offset:10240
  s_waitcnt lgkmcnt(0)
  s_barrier
  ds_read_b32 v15, v9 offset:10244
  s_waitcnt lgkmcnt(0)
  v_add_f32 v14, v14, v15
  v_rcp_f32 v10, v10
  v_rcp_f32 v11, v11
  v_rcp_f32 v12, v12
  v_rcp_f32 v13, v13
  v_rcp_f32 v14, v14
  v_mbcnt_lo_u32_b32 v16, -1, 0
  v_mbcnt_hi_u32_b32 v16, -1, v16
  v_and_b32 v17, 15, v16
  v_lshrrev_b32 v18, 4, v16
  v_bfe_u32 v19, v16, 2, 2
  v_and_b32 v20, 3, v16
  v_lshrrev_b32 v21, 3, v16
  v_and_b32 v22, 7, v16
  v_and_b32 v23, 1, v18
  v_lshlrev_b32 v23, 1, v23
  v_lshrrev_b32 v24, 1, v18
  v_or_b32 v23, v23, v24
  v_lshlrev_b32 v23, 4, v23
  v_add_u32 v23, v23, v17
  v_lshlrev_b32 v1, 4, v23
  v_accvgpr_read_b32 v64, a0
  v_accvgpr_read_b32 v65, a1
  v_accvgpr_read_b32 v66, a2
  v_accvgpr_read_b32 v67, a3
  v_accvgpr_read_b32 v68, a4
  v_accvgpr_read_b32 v69, a5
  v_accvgpr_read_b32 v70, a6
  v_accvgpr_read_b32 v71, a7
  v_mul_f32 v64, v10, v64
  v_mul_f32 v65, v10, v65
  v_mul_f32 v66, v10, v66
  v_mul_f32 v67, v10, v67
  v_mul_f32 v68, v10, v68
  v_mul_f32 v69, v10, v69
  v_mul_f32 v70, v10, v70
  v_mul_f32 v71, v10, v71
  v_cvt_pk_bf16_f32 v32, v64, v65
  v_cvt_pk_bf16_f32 v33, v66, v67
  v_cvt_pk_bf16_f32 v34, v68, v69
  v_cvt_pk_bf16_f32 v35, v70, v71
  s_nop 0
  v_permlane16_swap_b32 v32, v34
  v_permlane16_swap_b32 v33, v35
  s_add_u32 s34, s41, 0
  buffer_store_dwordx4 v[32:35], v1, s[24:27], s34 offen offset:0 sc1
  v_accvgpr_read_b32 v72, a8
  v_accvgpr_read_b32 v73, a9
  v_accvgpr_read_b32 v74, a10
  v_accvgpr_read_b32 v75, a11
  v_accvgpr_read_b32 v76, a12
  v_accvgpr_read_b32 v77, a13
  v_accvgpr_read_b32 v78, a14
  v_accvgpr_read_b32 v79, a15
  v_mul_f32 v72, v10, v72
  v_mul_f32 v73, v10, v73
  v_mul_f32 v74, v10, v74
  v_mul_f32 v75, v10, v75
  v_mul_f32 v76, v10, v76
  v_mul_f32 v77, v10, v77
  v_mul_f32 v78, v10, v78
  v_mul_f32 v79, v10, v79
  v_cvt_pk_bf16_f32 v36, v72, v73
  v_cvt_pk_bf16_f32 v37, v74, v75
  v_cvt_pk_bf16_f32 v38, v76, v77
  v_cvt_pk_bf16_f32 v39, v78, v79
  s_nop 0
  v_permlane16_swap_b32 v36, v38
  v_permlane16_swap_b32 v37, v39
  s_add_u32 s34, s41, 0
  buffer_store_dwordx4 v[36:39], v1, s[24:27], s34 offen offset:1024 sc1
  v_accvgpr_read_b32 v80, a16
  v_accvgpr_read_b32 v81, a17
  v_accvgpr_read_b32 v82, a18
  v_accvgpr_read_b32 v83, a19
  v_accvgpr_read_b32 v84, a20
  v_accvgpr_read_b32 v85, a21
  v_accvgpr_read_b32 v86, a22
  v_accvgpr_read_b32 v87, a23
  v_mul_f32 v80, v10, v80
  v_mul_f32 v81, v10, v81
  v_mul_f32 v82, v10, v82
  v_mul_f32 v83, v10, v83
  v_mul_f32 v84, v10, v84
  v_mul_f32 v85, v10, v85
  v_mul_f32 v86, v10, v86
  v_mul_f32 v87, v10, v87
  v_cvt_pk_bf16_f32 v40, v80, v81
  v_cvt_pk_bf16_f32 v41, v82, v83
  v_cvt_pk_bf16_f32 v42, v84, v85
  v_cvt_pk_bf16_f32 v43, v86, v87
  s_nop 0
  v_permlane16_swap_b32 v40, v42
  v_permlane16_swap_b32 v41, v43
  s_add_u32 s34, s41, 0
  buffer_store_dwordx4 v[40:43], v1, s[24:27], s34 offen offset:2048 sc1
  v_accvgpr_read_b32 v88, a24
  v_accvgpr_read_b32 v89, a25
  v_accvgpr_read_b32 v90, a26
  v_accvgpr_read_b32 v91, a27
  v_accvgpr_read_b32 v92, a28
  v_accvgpr_read_b32 v93, a29
  v_accvgpr_read_b32 v94, a30
  v_accvgpr_read_b32 v95, a31
  v_mul_f32 v88, v10, v88
  v_mul_f32 v89, v10, v89
  v_mul_f32 v90, v10, v90
  v_mul_f32 v91, v10, v91
  v_mul_f32 v92, v10, v92
  v_mul_f32 v93, v10, v93
  v_mul_f32 v94, v10, v94
  v_mul_f32 v95, v10, v95
  v_cvt_pk_bf16_f32 v44, v88, v89
  v_cvt_pk_bf16_f32 v45, v90, v91
  v_cvt_pk_bf16_f32 v46, v92, v93
  v_cvt_pk_bf16_f32 v47, v94, v95
  s_nop 0
  v_permlane16_swap_b32 v44, v46
  v_permlane16_swap_b32 v45, v47
  s_add_u32 s34, s41, 0
  buffer_store_dwordx4 v[44:47], v1, s[24:27], s34 offen offset:3072 sc1
  v_accvgpr_read_b32 v64, a32
  v_accvgpr_read_b32 v65, a33
  v_accvgpr_read_b32 v66, a34
  v_accvgpr_read_b32 v67, a35
  v_accvgpr_read_b32 v68, a36
  v_accvgpr_read_b32 v69, a37
  v_accvgpr_read_b32 v70, a38
  v_accvgpr_read_b32 v71, a39
  v_mul_f32 v64, v10, v64
  v_mul_f32 v65, v10, v65
  v_mul_f32 v66, v10, v66
  v_mul_f32 v67, v10, v67
  v_mul_f32 v68, v10, v68
  v_mul_f32 v69, v10, v69
  v_mul_f32 v70, v10, v70
  v_mul_f32 v71, v10, v71
  v_cvt_pk_bf16_f32 v48, v64, v65
  v_cvt_pk_bf16_f32 v49, v66, v67
  v_cvt_pk_bf16_f32 v50, v68, v69
  v_cvt_pk_bf16_f32 v51, v70, v71
  s_nop 0
  v_permlane16_swap_b32 v48, v50
  v_permlane16_swap_b32 v49, v51
  s_add_u32 s34, s41, 32768
  buffer_store_dwordx4 v[48:51], v1, s[24:27], s34 offen offset:0 sc1
  v_accvgpr_read_b32 v72, a40
  v_accvgpr_read_b32 v73, a41
  v_accvgpr_read_b32 v74, a42
  v_accvgpr_read_b32 v75, a43
  v_accvgpr_read_b32 v76, a44
  v_accvgpr_read_b32 v77, a45
  v_accvgpr_read_b32 v78, a46
  v_accvgpr_read_b32 v79, a47
  v_mul_f32 v72, v10, v72
  v_mul_f32 v73, v10, v73
  v_mul_f32 v74, v10, v74
  v_mul_f32 v75, v10, v75
  v_mul_f32 v76, v10, v76
  v_mul_f32 v77, v10, v77
  v_mul_f32 v78, v10, v78
  v_mul_f32 v79, v10, v79
  v_cvt_pk_bf16_f32 v52, v72, v73
  v_cvt_pk_bf16_f32 v53, v74, v75
  v_cvt_pk_bf16_f32 v54, v76, v77
  v_cvt_pk_bf16_f32 v55, v78, v79
  s_nop 0
  v_permlane16_swap_b32 v52, v54
  v_permlane16_swap_b32 v53, v55
  s_add_u32 s34, s41, 32768
  buffer_store_dwordx4 v[52:55], v1, s[24:27], s34 offen offset:1024 sc1
  v_accvgpr_read_b32 v80, a48
  v_accvgpr_read_b32 v81, a49
  v_accvgpr_read_b32 v82, a50
  v_accvgpr_read_b32 v83, a51
  v_accvgpr_read_b32 v84, a52
  v_accvgpr_read_b32 v85, a53
  v_accvgpr_read_b32 v86, a54
  v_accvgpr_read_b32 v87, a55
  v_mul_f32 v80, v10, v80
  v_mul_f32 v81, v10, v81
  v_mul_f32 v82, v10, v82
  v_mul_f32 v83, v10, v83
  v_mul_f32 v84, v10, v84
  v_mul_f32 v85, v10, v85
  v_mul_f32 v86, v10, v86
  v_mul_f32 v87, v10, v87
  v_cvt_pk_bf16_f32 v56, v80, v81
  v_cvt_pk_bf16_f32 v57, v82, v83
  v_cvt_pk_bf16_f32 v58, v84, v85
  v_cvt_pk_bf16_f32 v59, v86, v87
  s_nop 0
  v_permlane16_swap_b32 v56, v58
  v_permlane16_swap_b32 v57, v59
  s_add_u32 s34, s41, 32768
  buffer_store_dwordx4 v[56:59], v1, s[24:27], s34 offen offset:2048 sc1
  v_accvgpr_read_b32 v88, a56
  v_accvgpr_read_b32 v89, a57
  v_accvgpr_read_b32 v90, a58
  v_accvgpr_read_b32 v91, a59
  v_accvgpr_read_b32 v92, a60
  v_accvgpr_read_b32 v93, a61
  v_accvgpr_read_b32 v94, a62
  v_accvgpr_read_b32 v95, a63
  v_mul_f32 v88, v10, v88
  v_mul_f32 v89, v10, v89
  v_mul_f32 v90, v10, v90
  v_mul_f32 v91, v10, v91
  v_mul_f32 v92, v10, v92
  v_mul_f32 v93, v10, v93
  v_mul_f32 v94, v10, v94
  v_mul_f32 v95, v10, v95
  v_cvt_pk_bf16_f32 v60, v88, v89
  v_cvt_pk_bf16_f32 v61, v90, v91
  v_cvt_pk_bf16_f32 v62, v92, v93
  v_cvt_pk_bf16_f32 v63, v94, v95
  s_nop 0
  v_permlane16_swap_b32 v60, v62
  v_permlane16_swap_b32 v61, v63
  s_add_u32 s34, s41, 32768
  buffer_store_dwordx4 v[60:63], v1, s[24:27], s34 offen offset:3072 sc1
  v_accvgpr_read_b32 v64, a64
  v_accvgpr_read_b32 v65, a65
  v_accvgpr_read_b32 v66, a66
  v_accvgpr_read_b32 v67, a67
  v_accvgpr_read_b32 v68, a68
  v_accvgpr_read_b32 v69, a69
  v_accvgpr_read_b32 v70, a70
  v_accvgpr_read_b32 v71, a71
  v_mul_f32 v64, v11, v64
  v_mul_f32 v65, v11, v65
  v_mul_f32 v66, v11, v66
  v_mul_f32 v67, v11, v67
  v_mul_f32 v68, v11, v68
  v_mul_f32 v69, v11, v69
  v_mul_f32 v70, v11, v70
  v_mul_f32 v71, v11, v71
  v_cvt_pk_bf16_f32 v32, v64, v65
  v_cvt_pk_bf16_f32 v33, v66, v67
  v_cvt_pk_bf16_f32 v34, v68, v69
  v_cvt_pk_bf16_f32 v35, v70, v71
  s_nop 0
  v_permlane16_swap_b32 v32, v34
  v_permlane16_swap_b32 v33, v35
  s_add_u32 s34, s42, 0
  buffer_store_dwordx4 v[32:35], v1, s[24:27], s34 offen offset:0 sc1
  v_accvgpr_read_b32 v72, a72
  v_accvgpr_read_b32 v73, a73
  v_accvgpr_read_b32 v74, a74
  v_accvgpr_read_b32 v75, a75
  v_accvgpr_read_b32 v76, a76
  v_accvgpr_read_b32 v77, a77
  v_accvgpr_read_b32 v78, a78
  v_accvgpr_read_b32 v79, a79
  v_mul_f32 v72, v11, v72
  v_mul_f32 v73, v11, v73
  v_mul_f32 v74, v11, v74
  v_mul_f32 v75, v11, v75
  v_mul_f32 v76, v11, v76
  v_mul_f32 v77, v11, v77
  v_mul_f32 v78, v11, v78
  v_mul_f32 v79, v11, v79
  v_cvt_pk_bf16_f32 v36, v72, v73
  v_cvt_pk_bf16_f32 v37, v74, v75
  v_cvt_pk_bf16_f32 v38, v76, v77
  v_cvt_pk_bf16_f32 v39, v78, v79
  s_nop 0
  v_permlane16_swap_b32 v36, v38
  v_permlane16_swap_b32 v37, v39
  s_add_u32 s34, s42, 0
  buffer_store_dwordx4 v[36:39], v1, s[24:27], s34 offen offset:1024 sc1
  v_accvgpr_read_b32 v80, a80
  v_accvgpr_read_b32 v81, a81
  v_accvgpr_read_b32 v82, a82
  v_accvgpr_read_b32 v83, a83
  v_accvgpr_read_b32 v84, a84
  v_accvgpr_read_b32 v85, a85
  v_accvgpr_read_b32 v86, a86
  v_accvgpr_read_b32 v87, a87
  v_mul_f32 v80, v11, v80
  v_mul_f32 v81, v11, v81
  v_mul_f32 v82, v11, v82
  v_mul_f32 v83, v11, v83
  v_mul_f32 v84, v11, v84
  v_mul_f32 v85, v11, v85
  v_mul_f32 v86, v11, v86
  v_mul_f32 v87, v11, v87
  v_cvt_pk_bf16_f32 v40, v80, v81
  v_cvt_pk_bf16_f32 v41, v82, v83
  v_cvt_pk_bf16_f32 v42, v84, v85
  v_cvt_pk_bf16_f32 v43, v86, v87
  s_nop 0
  v_permlane16_swap_b32 v40, v42
  v_permlane16_swap_b32 v41, v43
  s_add_u32 s34, s42, 0
  buffer_store_dwordx4 v[40:43], v1, s[24:27], s34 offen offset:2048 sc1
  v_accvgpr_read_b32 v88, a88
  v_accvgpr_read_b32 v89, a89
  v_accvgpr_read_b32 v90, a90
  v_accvgpr_read_b32 v91, a91
  v_accvgpr_read_b32 v92, a92
  v_accvgpr_read_b32 v93, a93
  v_accvgpr_read_b32 v94, a94
  v_accvgpr_read_b32 v95, a95
  v_mul_f32 v88, v11, v88
  v_mul_f32 v89, v11, v89
  v_mul_f32 v90, v11, v90
  v_mul_f32 v91, v11, v91
  v_mul_f32 v92, v11, v92
  v_mul_f32 v93, v11, v93
  v_mul_f32 v94, v11, v94
  v_mul_f32 v95, v11, v95
  v_cvt_pk_bf16_f32 v44, v88, v89
  v_cvt_pk_bf16_f32 v45, v90, v91
  v_cvt_pk_bf16_f32 v46, v92, v93
  v_cvt_pk_bf16_f32 v47, v94, v95
  s_nop 0
  v_permlane16_swap_b32 v44, v46
  v_permlane16_swap_b32 v45, v47
  s_add_u32 s34, s42, 0
  buffer_store_dwordx4 v[44:47], v1, s[24:27], s34 offen offset:3072 sc1
  v_accvgpr_read_b32 v64, a96
  v_accvgpr_read_b32 v65, a97
  v_accvgpr_read_b32 v66, a98
  v_accvgpr_read_b32 v67, a99
  v_accvgpr_read_b32 v68, a100
  v_accvgpr_read_b32 v69, a101
  v_accvgpr_read_b32 v70, a102
  v_accvgpr_read_b32 v71, a103
  v_mul_f32 v64, v11, v64
  v_mul_f32 v65, v11, v65
  v_mul_f32 v66, v11, v66
  v_mul_f32 v67, v11, v67
  v_mul_f32 v68, v11, v68
  v_mul_f32 v69, v11, v69
  v_mul_f32 v70, v11, v70
  v_mul_f32 v71, v11, v71
  v_cvt_pk_bf16_f32 v48, v64, v65
  v_cvt_pk_bf16_f32 v49, v66, v67
  v_cvt_pk_bf16_f32 v50, v68, v69
  v_cvt_pk_bf16_f32 v51, v70, v71
  s_nop 0
  v_permlane16_swap_b32 v48, v50
  v_permlane16_swap_b32 v49, v51
  s_add_u32 s34, s42, 32768
  buffer_store_dwordx4 v[48:51], v1, s[24:27], s34 offen offset:0 sc1
  v_accvgpr_read_b32 v72, a104
  v_accvgpr_read_b32 v73, a105
  v_accvgpr_read_b32 v74, a106
  v_accvgpr_read_b32 v75, a107
  v_accvgpr_read_b32 v76, a108
  v_accvgpr_read_b32 v77, a109
  v_accvgpr_read_b32 v78, a110
  v_accvgpr_read_b32 v79, a111
  v_mul_f32 v72, v11, v72
  v_mul_f32 v73, v11, v73
  v_mul_f32 v74, v11, v74
  v_mul_f32 v75, v11, v75
  v_mul_f32 v76, v11, v76
  v_mul_f32 v77, v11, v77
  v_mul_f32 v78, v11, v78
  v_mul_f32 v79, v11, v79
  v_cvt_pk_bf16_f32 v52, v72, v73
  v_cvt_pk_bf16_f32 v53, v74, v75
  v_cvt_pk_bf16_f32 v54, v76, v77
  v_cvt_pk_bf16_f32 v55, v78, v79
  s_nop 0
  v_permlane16_swap_b32 v52, v54
  v_permlane16_swap_b32 v53, v55
  s_add_u32 s34, s42, 32768
  buffer_store_dwordx4 v[52:55], v1, s[24:27], s34 offen offset:1024 sc1
  v_accvgpr_read_b32 v80, a112
  v_accvgpr_read_b32 v81, a113
  v_accvgpr_read_b32 v82, a114
  v_accvgpr_read_b32 v83, a115
  v_accvgpr_read_b32 v84, a116
  v_accvgpr_read_b32 v85, a117
  v_accvgpr_read_b32 v86, a118
  v_accvgpr_read_b32 v87, a119
  v_mul_f32 v80, v11, v80
  v_mul_f32 v81, v11, v81
  v_mul_f32 v82, v11, v82
  v_mul_f32 v83, v11, v83
  v_mul_f32 v84, v11, v84
  v_mul_f32 v85, v11, v85
  v_mul_f32 v86, v11, v86
  v_mul_f32 v87, v11, v87
  v_cvt_pk_bf16_f32 v56, v80, v81
  v_cvt_pk_bf16_f32 v57, v82, v83
  v_cvt_pk_bf16_f32 v58, v84, v85
  v_cvt_pk_bf16_f32 v59, v86, v87
  s_nop 0
  v_permlane16_swap_b32 v56, v58
  v_permlane16_swap_b32 v57, v59
  s_add_u32 s34, s42, 32768
  buffer_store_dwordx4 v[56:59], v1, s[24:27], s34 offen offset:2048 sc1
  v_accvgpr_read_b32 v88, a120
  v_accvgpr_read_b32 v89, a121
  v_accvgpr_read_b32 v90, a122
  v_accvgpr_read_b32 v91, a123
  v_accvgpr_read_b32 v92, a124
  v_accvgpr_read_b32 v93, a125
  v_accvgpr_read_b32 v94, a126
  v_accvgpr_read_b32 v95, a127
  v_mul_f32 v88, v11, v88
  v_mul_f32 v89, v11, v89
  v_mul_f32 v90, v11, v90
  v_mul_f32 v91, v11, v91
  v_mul_f32 v92, v11, v92
  v_mul_f32 v93, v11, v93
  v_mul_f32 v94, v11, v94
  v_mul_f32 v95, v11, v95
  v_cvt_pk_bf16_f32 v60, v88, v89
  v_cvt_pk_bf16_f32 v61, v90, v91
  v_cvt_pk_bf16_f32 v62, v92, v93
  v_cvt_pk_bf16_f32 v63, v94, v95
  s_nop 0
  v_permlane16_swap_b32 v60, v62
  v_permlane16_swap_b32 v61, v63
  s_add_u32 s34, s42, 32768
  buffer_store_dwordx4 v[60:63], v1, s[24:27], s34 offen offset:3072 sc1
  v_accvgpr_read_b32 v64, a128
  v_accvgpr_read_b32 v65, a129
  v_accvgpr_read_b32 v66, a130
  v_accvgpr_read_b32 v67, a131
  v_accvgpr_read_b32 v68, a132
  v_accvgpr_read_b32 v69, a133
  v_accvgpr_read_b32 v70, a134
  v_accvgpr_read_b32 v71, a135
  v_mul_f32 v64, v12, v64
  v_mul_f32 v65, v12, v65
  v_mul_f32 v66, v12, v66
  v_mul_f32 v67, v12, v67
  v_mul_f32 v68, v12, v68
  v_mul_f32 v69, v12, v69
  v_mul_f32 v70, v12, v70
  v_mul_f32 v71, v12, v71
  v_cvt_pk_bf16_f32 v32, v64, v65
  v_cvt_pk_bf16_f32 v33, v66, v67
  v_cvt_pk_bf16_f32 v34, v68, v69
  v_cvt_pk_bf16_f32 v35, v70, v71
  s_nop 0
  v_permlane16_swap_b32 v32, v34
  v_permlane16_swap_b32 v33, v35
  s_add_u32 s34, s43, 0
  buffer_store_dwordx4 v[32:35], v1, s[24:27], s34 offen offset:0 sc1
  v_accvgpr_read_b32 v72, a136
  v_accvgpr_read_b32 v73, a137
  v_accvgpr_read_b32 v74, a138
  v_accvgpr_read_b32 v75, a139
  v_accvgpr_read_b32 v76, a140
  v_accvgpr_read_b32 v77, a141
  v_accvgpr_read_b32 v78, a142
  v_accvgpr_read_b32 v79, a143
  v_mul_f32 v72, v12, v72
  v_mul_f32 v73, v12, v73
  v_mul_f32 v74, v12, v74
  v_mul_f32 v75, v12, v75
  v_mul_f32 v76, v12, v76
  v_mul_f32 v77, v12, v77
  v_mul_f32 v78, v12, v78
  v_mul_f32 v79, v12, v79
  v_cvt_pk_bf16_f32 v36, v72, v73
  v_cvt_pk_bf16_f32 v37, v74, v75
  v_cvt_pk_bf16_f32 v38, v76, v77
  v_cvt_pk_bf16_f32 v39, v78, v79
  s_nop 0
  v_permlane16_swap_b32 v36, v38
  v_permlane16_swap_b32 v37, v39
  s_add_u32 s34, s43, 0
  buffer_store_dwordx4 v[36:39], v1, s[24:27], s34 offen offset:1024 sc1
  v_accvgpr_read_b32 v80, a144
  v_accvgpr_read_b32 v81, a145
  v_accvgpr_read_b32 v82, a146
  v_accvgpr_read_b32 v83, a147
  v_accvgpr_read_b32 v84, a148
  v_accvgpr_read_b32 v85, a149
  v_accvgpr_read_b32 v86, a150
  v_accvgpr_read_b32 v87, a151
  v_mul_f32 v80, v12, v80
  v_mul_f32 v81, v12, v81
  v_mul_f32 v82, v12, v82
  v_mul_f32 v83, v12, v83
  v_mul_f32 v84, v12, v84
  v_mul_f32 v85, v12, v85
  v_mul_f32 v86, v12, v86
  v_mul_f32 v87, v12, v87
  v_cvt_pk_bf16_f32 v40, v80, v81
  v_cvt_pk_bf16_f32 v41, v82, v83
  v_cvt_pk_bf16_f32 v42, v84, v85
  v_cvt_pk_bf16_f32 v43, v86, v87
  s_nop 0
  v_permlane16_swap_b32 v40, v42
  v_permlane16_swap_b32 v41, v43
  s_add_u32 s34, s43, 0
  buffer_store_dwordx4 v[40:43], v1, s[24:27], s34 offen offset:2048 sc1
  v_accvgpr_read_b32 v88, a152
  v_accvgpr_read_b32 v89, a153
  v_accvgpr_read_b32 v90, a154
  v_accvgpr_read_b32 v91, a155
  v_accvgpr_read_b32 v92, a156
  v_accvgpr_read_b32 v93, a157
  v_accvgpr_read_b32 v94, a158
  v_accvgpr_read_b32 v95, a159
  v_mul_f32 v88, v12, v88
  v_mul_f32 v89, v12, v89
  v_mul_f32 v90, v12, v90
  v_mul_f32 v91, v12, v91
  v_mul_f32 v92, v12, v92
  v_mul_f32 v93, v12, v93
  v_mul_f32 v94, v12, v94
  v_mul_f32 v95, v12, v95
  v_cvt_pk_bf16_f32 v44, v88, v89
  v_cvt_pk_bf16_f32 v45, v90, v91
  v_cvt_pk_bf16_f32 v46, v92, v93
  v_cvt_pk_bf16_f32 v47, v94, v95
  s_nop 0
  v_permlane16_swap_b32 v44, v46
  v_permlane16_swap_b32 v45, v47
  s_add_u32 s34, s43, 0
  buffer_store_dwordx4 v[44:47], v1, s[24:27], s34 offen offset:3072 sc1
  v_accvgpr_read_b32 v64, a160
  v_accvgpr_read_b32 v65, a161
  v_accvgpr_read_b32 v66, a162
  v_accvgpr_read_b32 v67, a163
  v_accvgpr_read_b32 v68, a164
  v_accvgpr_read_b32 v69, a165
  v_accvgpr_read_b32 v70, a166
  v_accvgpr_read_b32 v71, a167
  v_mul_f32 v64, v12, v64
  v_mul_f32 v65, v12, v65
  v_mul_f32 v66, v12, v66
  v_mul_f32 v67, v12, v67
  v_mul_f32 v68, v12, v68
  v_mul_f32 v69, v12, v69
  v_mul_f32 v70, v12, v70
  v_mul_f32 v71, v12, v71
  v_cvt_pk_bf16_f32 v48, v64, v65
  v_cvt_pk_bf16_f32 v49, v66, v67
  v_cvt_pk_bf16_f32 v50, v68, v69
  v_cvt_pk_bf16_f32 v51, v70, v71
  s_nop 0
  v_permlane16_swap_b32 v48, v50
  v_permlane16_swap_b32 v49, v51
  s_add_u32 s34, s43, 32768
  buffer_store_dwordx4 v[48:51], v1, s[24:27], s34 offen offset:0 sc1
  v_accvgpr_read_b32 v72, a168
  v_accvgpr_read_b32 v73, a169
  v_accvgpr_read_b32 v74, a170
  v_accvgpr_read_b32 v75, a171
  v_accvgpr_read_b32 v76, a172
  v_accvgpr_read_b32 v77, a173
  v_accvgpr_read_b32 v78, a174
  v_accvgpr_read_b32 v79, a175
  v_mul_f32 v72, v12, v72
  v_mul_f32 v73, v12, v73
  v_mul_f32 v74, v12, v74
  v_mul_f32 v75, v12, v75
  v_mul_f32 v76, v12, v76
  v_mul_f32 v77, v12, v77
  v_mul_f32 v78, v12, v78
  v_mul_f32 v79, v12, v79
  v_cvt_pk_bf16_f32 v52, v72, v73
  v_cvt_pk_bf16_f32 v53, v74, v75
  v_cvt_pk_bf16_f32 v54, v76, v77
  v_cvt_pk_bf16_f32 v55, v78, v79
  s_nop 0
  v_permlane16_swap_b32 v52, v54
  v_permlane16_swap_b32 v53, v55
  s_add_u32 s34, s43, 32768
  buffer_store_dwordx4 v[52:55], v1, s[24:27], s34 offen offset:1024 sc1
  v_accvgpr_read_b32 v80, a176
  v_accvgpr_read_b32 v81, a177
  v_accvgpr_read_b32 v82, a178
  v_accvgpr_read_b32 v83, a179
  v_accvgpr_read_b32 v84, a180
  v_accvgpr_read_b32 v85, a181
  v_accvgpr_read_b32 v86, a182
  v_accvgpr_read_b32 v87, a183
  v_mul_f32 v80, v12, v80
  v_mul_f32 v81, v12, v81
  v_mul_f32 v82, v12, v82
  v_mul_f32 v83, v12, v83
  v_mul_f32 v84, v12, v84
  v_mul_f32 v85, v12, v85
  v_mul_f32 v86, v12, v86
  v_mul_f32 v87, v12, v87
  v_cvt_pk_bf16_f32 v56, v80, v81
  v_cvt_pk_bf16_f32 v57, v82, v83
  v_cvt_pk_bf16_f32 v58, v84, v85
  v_cvt_pk_bf16_f32 v59, v86, v87
  s_nop 0
  v_permlane16_swap_b32 v56, v58
  v_permlane16_swap_b32 v57, v59
  s_add_u32 s34, s43, 32768
  buffer_store_dwordx4 v[56:59], v1, s[24:27], s34 offen offset:2048 sc1
  v_accvgpr_read_b32 v88, a184
  v_accvgpr_read_b32 v89, a185
  v_accvgpr_read_b32 v90, a186
  v_accvgpr_read_b32 v91, a187
  v_accvgpr_read_b32 v92, a188
  v_accvgpr_read_b32 v93, a189
  v_accvgpr_read_b32 v94, a190
  v_accvgpr_read_b32 v95, a191
  v_mul_f32 v88, v12, v88
  v_mul_f32 v89, v12, v89
  v_mul_f32 v90, v12, v90
  v_mul_f32 v91, v12, v91
  v_mul_f32 v92, v12, v92
  v_mul_f32 v93, v12, v93
  v_mul_f32 v94, v12, v94
  v_mul_f32 v95, v12, v95
  v_cvt_pk_bf16_f32 v60, v88, v89
  v_cvt_pk_bf16_f32 v61, v90, v91
  v_cvt_pk_bf16_f32 v62, v92, v93
  v_cvt_pk_bf16_f32 v63, v94, v95
  s_nop 0
  v_permlane16_swap_b32 v60, v62
  v_permlane16_swap_b32 v61, v63
  s_add_u32 s34, s43, 32768
  buffer_store_dwordx4 v[60:63], v1, s[24:27], s34 offen offset:3072 sc1
  v_accvgpr_read_b32 v64, a192
  v_accvgpr_read_b32 v65, a193
  v_accvgpr_read_b32 v66, a194
  v_accvgpr_read_b32 v67, a195
  v_accvgpr_read_b32 v68, a196
  v_accvgpr_read_b32 v69, a197
  v_accvgpr_read_b32 v70, a198
  v_accvgpr_read_b32 v71, a199
  v_mul_f32 v64, v13, v64
  v_mul_f32 v65, v13, v65
  v_mul_f32 v66, v13, v66
  v_mul_f32 v67, v13, v67
  v_mul_f32 v68, v13, v68
  v_mul_f32 v69, v13, v69
  v_mul_f32 v70, v13, v70
  v_mul_f32 v71, v13, v71
  v_cvt_pk_bf16_f32 v32, v64, v65
  v_cvt_pk_bf16_f32 v33, v66, v67
  v_cvt_pk_bf16_f32 v34, v68, v69
  v_cvt_pk_bf16_f32 v35, v70, v71
  s_nop 0
  v_permlane16_swap_b32 v32, v34
  v_permlane16_swap_b32 v33, v35
  s_add_u32 s34, s44, 0
  buffer_store_dwordx4 v[32:35], v1, s[24:27], s34 offen offset:0 sc1
  v_accvgpr_read_b32 v72, a200
  v_accvgpr_read_b32 v73, a201
  v_accvgpr_read_b32 v74, a202
  v_accvgpr_read_b32 v75, a203
  v_accvgpr_read_b32 v76, a204
  v_accvgpr_read_b32 v77, a205
  v_accvgpr_read_b32 v78, a206
  v_accvgpr_read_b32 v79, a207
  v_mul_f32 v72, v13, v72
  v_mul_f32 v73, v13, v73
  v_mul_f32 v74, v13, v74
  v_mul_f32 v75, v13, v75
  v_mul_f32 v76, v13, v76
  v_mul_f32 v77, v13, v77
  v_mul_f32 v78, v13, v78
  v_mul_f32 v79, v13, v79
  v_cvt_pk_bf16_f32 v36, v72, v73
  v_cvt_pk_bf16_f32 v37, v74, v75
  v_cvt_pk_bf16_f32 v38, v76, v77
  v_cvt_pk_bf16_f32 v39, v78, v79
  s_nop 0
  v_permlane16_swap_b32 v36, v38
  v_permlane16_swap_b32 v37, v39
  s_add_u32 s34, s44, 0
  buffer_store_dwordx4 v[36:39], v1, s[24:27], s34 offen offset:1024 sc1
  v_accvgpr_read_b32 v80, a208
  v_accvgpr_read_b32 v81, a209
  v_accvgpr_read_b32 v82, a210
  v_accvgpr_read_b32 v83, a211
  v_accvgpr_read_b32 v84, a212
  v_accvgpr_read_b32 v85, a213
  v_accvgpr_read_b32 v86, a214
  v_accvgpr_read_b32 v87, a215
  v_mul_f32 v80, v13, v80
  v_mul_f32 v81, v13, v81
  v_mul_f32 v82, v13, v82
  v_mul_f32 v83, v13, v83
  v_mul_f32 v84, v13, v84
  v_mul_f32 v85, v13, v85
  v_mul_f32 v86, v13, v86
  v_mul_f32 v87, v13, v87
  v_cvt_pk_bf16_f32 v40, v80, v81
  v_cvt_pk_bf16_f32 v41, v82, v83
  v_cvt_pk_bf16_f32 v42, v84, v85
  v_cvt_pk_bf16_f32 v43, v86, v87
  s_nop 0
  v_permlane16_swap_b32 v40, v42
  v_permlane16_swap_b32 v41, v43
  s_add_u32 s34, s44, 0
  buffer_store_dwordx4 v[40:43], v1, s[24:27], s34 offen offset:2048 sc1
  v_accvgpr_read_b32 v88, a216
  v_accvgpr_read_b32 v89, a217
  v_accvgpr_read_b32 v90, a218
  v_accvgpr_read_b32 v91, a219
  v_accvgpr_read_b32 v92, a220
  v_accvgpr_read_b32 v93, a221
  v_accvgpr_read_b32 v94, a222
  v_accvgpr_read_b32 v95, a223
  v_mul_f32 v88, v13, v88
  v_mul_f32 v89, v13, v89
  v_mul_f32 v90, v13, v90
  v_mul_f32 v91, v13, v91
  v_mul_f32 v92, v13, v92
  v_mul_f32 v93, v13, v93
  v_mul_f32 v94, v13, v94
  v_mul_f32 v95, v13, v95
  v_cvt_pk_bf16_f32 v44, v88, v89
  v_cvt_pk_bf16_f32 v45, v90, v91
  v_cvt_pk_bf16_f32 v46, v92, v93
  v_cvt_pk_bf16_f32 v47, v94, v95
  s_nop 0
  v_permlane16_swap_b32 v44, v46
  v_permlane16_swap_b32 v45, v47
  s_add_u32 s34, s44, 0
  buffer_store_dwordx4 v[44:47], v1, s[24:27], s34 offen offset:3072 sc1
  v_accvgpr_read_b32 v64, a224
  v_accvgpr_read_b32 v65, a225
  v_accvgpr_read_b32 v66, a226
  v_accvgpr_read_b32 v67, a227
  v_accvgpr_read_b32 v68, a228
  v_accvgpr_read_b32 v69, a229
  v_accvgpr_read_b32 v70, a230
  v_accvgpr_read_b32 v71, a231
  v_mul_f32 v64, v13, v64
  v_mul_f32 v65, v13, v65
  v_mul_f32 v66, v13, v66
  v_mul_f32 v67, v13, v67
  v_mul_f32 v68, v13, v68
  v_mul_f32 v69, v13, v69
  v_mul_f32 v70, v13, v70
  v_mul_f32 v71, v13, v71
  v_cvt_pk_bf16_f32 v48, v64, v65
  v_cvt_pk_bf16_f32 v49, v66, v67
  v_cvt_pk_bf16_f32 v50, v68, v69
  v_cvt_pk_bf16_f32 v51, v70, v71
  s_nop 0
  v_permlane16_swap_b32 v48, v50
  v_permlane16_swap_b32 v49, v51
  s_add_u32 s34, s44, 32768
  buffer_store_dwordx4 v[48:51], v1, s[24:27], s34 offen offset:0 sc1
  v_accvgpr_read_b32 v72, a232
  v_accvgpr_read_b32 v73, a233
  v_accvgpr_read_b32 v74, a234
  v_accvgpr_read_b32 v75, a235
  v_accvgpr_read_b32 v76, a236
  v_accvgpr_read_b32 v77, a237
  v_accvgpr_read_b32 v78, a238
  v_accvgpr_read_b32 v79, a239
  v_mul_f32 v72, v13, v72
  v_mul_f32 v73, v13, v73
  v_mul_f32 v74, v13, v74
  v_mul_f32 v75, v13, v75
  v_mul_f32 v76, v13, v76
  v_mul_f32 v77, v13, v77
  v_mul_f32 v78, v13, v78
  v_mul_f32 v79, v13, v79
  v_cvt_pk_bf16_f32 v52, v72, v73
  v_cvt_pk_bf16_f32 v53, v74, v75
  v_cvt_pk_bf16_f32 v54, v76, v77
  v_cvt_pk_bf16_f32 v55, v78, v79
  s_nop 0
  v_permlane16_swap_b32 v52, v54
  v_permlane16_swap_b32 v53, v55
  s_add_u32 s34, s44, 32768
  buffer_store_dwordx4 v[52:55], v1, s[24:27], s34 offen offset:1024 sc1
  v_accvgpr_read_b32 v80, a240
  v_accvgpr_read_b32 v81, a241
  v_accvgpr_read_b32 v82, a242
  v_accvgpr_read_b32 v83, a243
  v_accvgpr_read_b32 v84, a244
  v_accvgpr_read_b32 v85, a245
  v_accvgpr_read_b32 v86, a246
  v_accvgpr_read_b32 v87, a247
  v_mul_f32 v80, v13, v80
  v_mul_f32 v81, v13, v81
  v_mul_f32 v82, v13, v82
  v_mul_f32 v83, v13, v83
  v_mul_f32 v84, v13, v84
  v_mul_f32 v85, v13, v85
  v_mul_f32 v86, v13, v86
  v_mul_f32 v87, v13, v87
  v_cvt_pk_bf16_f32 v56, v80, v81
  v_cvt_pk_bf16_f32 v57, v82, v83
  v_cvt_pk_bf16_f32 v58, v84, v85
  v_cvt_pk_bf16_f32 v59, v86, v87
  s_nop 0
  v_permlane16_swap_b32 v56, v58
  v_permlane16_swap_b32 v57, v59
  s_add_u32 s34, s44, 32768
  buffer_store_dwordx4 v[56:59], v1, s[24:27], s34 offen offset:2048 sc1
  v_accvgpr_read_b32 v88, a248
  v_accvgpr_read_b32 v89, a249
  v_accvgpr_read_b32 v90, a250
  v_accvgpr_read_b32 v91, a251
  v_accvgpr_read_b32 v92, a252
  v_accvgpr_read_b32 v93, a253
  v_accvgpr_read_b32 v94, a254
  v_accvgpr_read_b32 v95, a255
  v_mul_f32 v88, v13, v88
  v_mul_f32 v89, v13, v89
  v_mul_f32 v90, v13, v90
  v_mul_f32 v91, v13, v91
  v_mul_f32 v92, v13, v92
  v_mul_f32 v93, v13, v93
  v_mul_f32 v94, v13, v94
  v_mul_f32 v95, v13, v95
  v_cvt_pk_bf16_f32 v60, v88, v89
  v_cvt_pk_bf16_f32 v61, v90, v91
  v_cvt_pk_bf16_f32 v62, v92, v93
  v_cvt_pk_bf16_f32 v63, v94, v95
  s_nop 0
  v_permlane16_swap_b32 v60, v62
  v_permlane16_swap_b32 v61, v63
  s_add_u32 s34, s44, 32768
  buffer_store_dwordx4 v[60:63], v1, s[24:27], s34 offen offset:3072 sc1
  v_mul_f32 v64, v14, v96
  v_mul_f32 v65, v14, v97
  v_mul_f32 v66, v14, v98
  v_mul_f32 v67, v14, v99
  v_mul_f32 v68, v14, v100
  v_mul_f32 v69, v14, v101
  v_mul_f32 v70, v14, v102
  v_mul_f32 v71, v14, v103
  v_cvt_pk_bf16_f32 v32, v64, v65
  v_cvt_pk_bf16_f32 v33, v66, v67
  v_cvt_pk_bf16_f32 v34, v68, v69
  v_cvt_pk_bf16_f32 v35, v70, v71
  s_nop 0
  v_permlane16_swap_b32 v32, v34
  v_permlane16_swap_b32 v33, v35
  s_add_u32 s34, s45, 0
  buffer_store_dwordx4 v[32:35], v1, s[24:27], s34 offen offset:0 sc1
  v_mul_f32 v72, v14, v104
  v_mul_f32 v73, v14, v105
  v_mul_f32 v74, v14, v106
  v_mul_f32 v75, v14, v107
  v_mul_f32 v76, v14, v108
  v_mul_f32 v77, v14, v109
  v_mul_f32 v78, v14, v110
  v_mul_f32 v79, v14, v111
  v_cvt_pk_bf16_f32 v36, v72, v73
  v_cvt_pk_bf16_f32 v37, v74, v75
  v_cvt_pk_bf16_f32 v38, v76, v77
  v_cvt_pk_bf16_f32 v39, v78, v79
  s_nop 0
  v_permlane16_swap_b32 v36, v38
  v_permlane16_swap_b32 v37, v39
  s_add_u32 s34, s45, 0
  buffer_store_dwordx4 v[36:39], v1, s[24:27], s34 offen offset:1024 sc1
  v_mul_f32 v80, v14, v112
  v_mul_f32 v81, v14, v113
  v_mul_f32 v82, v14, v114
  v_mul_f32 v83, v14, v115
  v_mul_f32 v84, v14, v116
  v_mul_f32 v85, v14, v117
  v_mul_f32 v86, v14, v118
  v_mul_f32 v87, v14, v119
  v_cvt_pk_bf16_f32 v40, v80, v81
  v_cvt_pk_bf16_f32 v41, v82, v83
  v_cvt_pk_bf16_f32 v42, v84, v85
  v_cvt_pk_bf16_f32 v43, v86, v87
  s_nop 0
  v_permlane16_swap_b32 v40, v42
  v_permlane16_swap_b32 v41, v43
  s_add_u32 s34, s45, 0
  buffer_store_dwordx4 v[40:43], v1, s[24:27], s34 offen offset:2048 sc1
  v_mul_f32 v88, v14, v120
  v_mul_f32 v89, v14, v121
  v_mul_f32 v90, v14, v122
  v_mul_f32 v91, v14, v123
  v_mul_f32 v92, v14, v124
  v_mul_f32 v93, v14, v125
  v_mul_f32 v94, v14, v126
  v_mul_f32 v95, v14, v127
  v_cvt_pk_bf16_f32 v44, v88, v89
  v_cvt_pk_bf16_f32 v45, v90, v91
  v_cvt_pk_bf16_f32 v46, v92, v93
  v_cvt_pk_bf16_f32 v47, v94, v95
  s_nop 0
  v_permlane16_swap_b32 v44, v46
  v_permlane16_swap_b32 v45, v47
  s_add_u32 s34, s45, 0
  buffer_store_dwordx4 v[44:47], v1, s[24:27], s34 offen offset:3072 sc1
  s_and_b32 s7, s2, 7
  s_lshl_b32 s7, s7, 5
  s_lshr_b32 s6, s2, 3
  s_add_u32 s7, s7, s6
  s_mul_i32 s6, s7, 9363
  s_lshr_b32 s29, s6, 16
  s_mul_i32 s5, s29, 7
  s_sub_u32 s30, s7, s5
  s_cmp_ge_u32 s29, 18
  s_cselect_b32 s31, 1, 0
  s_mul_i32 s5, s31, 18
  s_sub_u32 s32, s29, s5
  s_and_b32 s33, s2, 1
  s_lshl_b32 s33, s33, 4
  s_cmp_eq_u32 s31, 0
  s_cselect_b32 s6, s66, s68
  s_cselect_b32 s5, s67, s69
  s_lshl_b32 s7, s30, 7
  s_add_u32 s12, s6, s7
  s_addc_u32 s13, s5, 0
  s_sub_u32 s14, 3670016, s7
  s_mov_b32 s15, 0x20000
  s_mul_i32 s36, s33, 114688
  s_mul_i32 s37, s28, 28672
  s_lshl_b32 s38, s28, 12
  v_mbcnt_lo_u32_b32 v250, -1, 0
  v_mbcnt_hi_u32_b32 v250, -1, v250
  v_lshrrev_b32 v251, 3, v250
  v_and_b32 v250, 7, v250
  v_and_b32 v252, 2, v251
  v_xor_b32 v252, v252, v250
  v_lshlrev_b32 v252, 4, v252
  v_mul_u32_u24 v251, 896, v251
  v_add_u32 v251, s37, v251
  v_add_u32 v248, v251, v252
  v_xor_b32 v252, 64, v252
  v_add_u32 v249, v251, v252
  s_add_u32 m0, s38, 0
  s_add_u32 s39, s36, 0
  buffer_load_dwordx4 v248, s[12:15], s39 offen lds
  s_add_u32 m0, s38, 1024
  s_add_u32 s39, s36, 7168
  buffer_load_dwordx4 v249, s[12:15], s39 offen lds
  s_add_u32 m0, s38, 2048
  s_add_u32 s39, s36, 14336
  buffer_load_dwordx4 v248, s[12:15], s39 offen lds
  s_add_u32 m0, s38, 3072
  s_add_u32 s39, s36, 21504
  buffer_load_dwordx4 v249, s[12:15], s39 offen lds
  s_add_u32 s36, s36, 114688
  s_cmp_eq_u32 s36, 3670016
  s_cselect_b32 s36, 0, s36
  s_add_u32 s38, s38, 16384
  s_and_b32 s38, s38, 131071
  s_add_u32 m0, s38, 0
  s_add_u32 s39, s36, 0
  buffer_load_dwordx4 v248, s[12:15], s39 offen lds
  s_add_u32 m0, s38, 1024
  s_add_u32 s39, s36, 7168
  buffer_load_dwordx4 v249, s[12:15], s39 offen lds
  s_add_u32 m0, s38, 2048
  s_add_u32 s39, s36, 14336
  buffer_load_dwordx4 v248, s[12:15], s39 offen lds
  s_add_u32 m0, s38, 3072
  s_add_u32 s39, s36, 21504
  buffer_load_dwordx4 v249, s[12:15], s39 offen lds
  s_add_u32 s36, s36, 114688
  s_cmp_eq_u32 s36, 3670016
  s_cselect_b32 s36, 0, s36
  s_add_u32 s38, s38, 16384
  s_and_b32 s38, s38, 131071
  s_add_u32 m0, s38, 0
  s_add_u32 s39, s36, 0
  buffer_load_dwordx4 v248, s[12:15], s39 offen lds
  s_add_u32 m0, s38, 1024
  s_add_u32 s39, s36, 7168
  buffer_load_dwordx4 v249, s[12:15], s39 offen lds
  s_add_u32 m0, s38, 2048
  s_add_u32 s39, s36, 14336
  buffer_load_dwordx4 v248, s[12:15], s39 offen lds
  s_add_u32 m0, s38, 3072
  s_add_u32 s39, s36, 21504
  buffer_load_dwordx4 v249, s[12:15], s39 offen lds
  s_add_u32 s36, s36, 114688
  s_cmp_eq_u32 s36, 3670016
  s_cselect_b32 s36, 0, s36
  s_add_u32 s38, s38, 16384
  s_and_b32 s38, s38, 131071
  s_add_u32 m0, s38, 0
  s_add_u32 s39, s36, 0
  buffer_load_dwordx4 v248, s[12:15], s39 offen lds
  s_add_u32 m0, s38, 1024
  s_add_u32 s39, s36, 7168
  buffer_load_dwordx4 v249, s[12:15], s39 offen lds
  s_add_u32 m0, s38, 2048
  s_add_u32 s39, s36, 14336
  buffer_load_dwordx4 v248, s[12:15], s39 offen lds
  s_add_u32 m0, s38, 3072
  s_add_u32 s39, s36, 21504
  buffer_load_dwordx4 v249, s[12:15], s39 offen lds
  s_add_u32 s36, s36, 114688
  s_cmp_eq_u32 s36, 3670016
  s_cselect_b32 s36, 0, s36
  s_add_u32 s38, s38, 16384
  s_and_b32 s38, s38, 131071
  s_branch K1_END
K1_SAFE_P1:
  s_waitcnt vmcnt(0)
  s_waitcnt lgkmcnt(0)
  s_barrier
  s_nop 9
  s_lshl_b32 s30, s28, 7
  s_mov_b32 s31, s30
  s_lshl_b32 s33, s28, 13
  s_add_u32 s32, s33, 98304
  v_mbcnt_lo_u32_b32 v16, -1, 0
  v_mbcnt_hi_u32_b32 v16, -1, v16
  v_and_b32 v17, 15, v16
  v_lshrrev_b32 v18, 4, v16
  v_bfe_u32 v19, v16, 2, 2
  v_and_b32 v20, 3, v16
  v_lshrrev_b32 v21, 3, v16
  v_and_b32 v22, 7, v16
  v_and_b32 v23, 1, v18
  v_lshlrev_b32 v23, 1, v23
  v_lshrrev_b32 v24, 1, v18
  v_or_b32 v23, v23, v24
  v_bfe_u32 v24, v17, 1, 1
  v_and_b32 v25, 4, v17
  v_or_b32 v24, v24, v25
  v_xor_b32 v23, v23, v24
  v_lshlrev_b32 v23, 4, v23
  v_lshlrev_b32 v24, 7, v17
  v_add_u32 v23, v23, v24
  v_add_u32 v1, 98304, v23
  v_xor_b32 v2, 64, v1
  v_mov_b32 v10, 4286578688
  v_mov_b32 v11, 4286578688
  v_mov_b32 v12, 4286578688
  v_mov_b32 v13, 4286578688
  v_mov_b32 v14, 4286578688
  s_mov_b32 s29, 16
  s_nop 3
K1_MAXL_P1:
  s_add_u32 m0, s32, 0
  s_add_u32 s34, s30, 0
  buffer_load_dwordx4 v7, s[8:11], s34 offen nt lds
  s_add_u32 m0, s32, 1024
  s_add_u32 s34, s30, 4096
  buffer_load_dwordx4 v7, s[8:11], s34 offen nt lds
  s_add_u32 m0, s32, 2048
  s_add_u32 s34, s30, 8192
  buffer_load_dwordx4 v7, s[8:11], s34 offen nt lds
  s_add_u32 m0, s32, 3072
  s_add_u32 s34, s30, 12288
  buffer_load_dwordx4 v7, s[8:11], s34 offen nt lds
  s_add_u32 m0, s32, 4096
  s_add_u32 s34, s30, 16384
  buffer_load_dwordx4 v7, s[8:11], s34 offen nt lds
  s_add_u32 m0, s32, 5120
  s_add_u32 s34, s30, 20480
  buffer_load_dwordx4 v7, s[8:11], s34 offen nt lds
  s_add_u32 m0, s32, 6144
  s_add_u32 s34, s30, 24576
  buffer_load_dwordx4 v7, s[8:11], s34 offen nt lds
  s_add_u32 m0, s32, 7168
  s_add_u32 s34, s30, 28672
  buffer_load_dwordx4 v7, s[8:11], s34 offen nt lds
  s_add_u32 s30, s30, 32768
  s_xor_b32 s32, s32, 65536
  s_xor_b32 s32, s32, 65536
  s_waitcnt vmcnt(0)
  s_barrier
  ds_read_b128 v[32:35], v1 offset:4096
  ds_read_b128 v[36:39], v2 offset:4096
  ds_read_b128 v[40:43], v1 offset:12288
  ds_read_b128 v[44:47], v2 offset:12288
  ds_read_b128 v[48:51], v1 offset:20480
  ds_read_b128 v[52:55], v2 offset:20480
  ds_read_b128 v[56:59], v1 offset:28672
  ds_read_b128 v[60:63], v2 offset:28672
  s_waitcnt lgkmcnt(7)
  v_mfma_f32_16x16x32_bf16 v[16:19], v[32:35], v[128:131], 0
  s_waitcnt lgkmcnt(6)
  v_mfma_f32_16x16x32_bf16 v[16:19], v[36:39], v[132:135], v[16:19]
  s_waitcnt lgkmcnt(5)
  v_mfma_f32_16x16x32_bf16 v[16:19], v[40:43], v[136:139], v[16:19]
  s_waitcnt lgkmcnt(4)
  v_mfma_f32_16x16x32_bf16 v[16:19], v[44:47], v[140:143], v[16:19]
  s_waitcnt lgkmcnt(3)
  v_mfma_f32_16x16x32_bf16 v[16:19], v[48:51], v[144:147], v[16:19]
  s_waitcnt lgkmcnt(2)
  v_mfma_f32_16x16x32_bf16 v[16:19], v[52:55], v[148:151], v[16:19]
  s_waitcnt lgkmcnt(1)
  v_mfma_f32_16x16x32_bf16 v[16:19], v[56:59], v[152:155], v[16:19]
  s_waitcnt lgkmcnt(0)
  v_mfma_f32_16x16x32_bf16 v[16:19], v[60:63], v[156:159], v[16:19]
  s_nop 7
  v_max3_f32 v10, v16, v17, v10
  v_max3_f32 v10, v18, v19, v10
  v_mfma_f32_16x16x32_bf16 v[20:23], v[32:35], v[160:163], 0
  v_mfma_f32_16x16x32_bf16 v[20:23], v[36:39], v[164:167], v[20:23]
  v_mfma_f32_16x16x32_bf16 v[20:23], v[40:43], v[168:171], v[20:23]
  v_mfma_f32_16x16x32_bf16 v[20:23], v[44:47], v[172:175], v[20:23]
  v_mfma_f32_16x16x32_bf16 v[20:23], v[48:51], v[176:179], v[20:23]
  v_mfma_f32_16x16x32_bf16 v[20:23], v[52:55], v[180:183], v[20:23]
  v_mfma_f32_16x16x32_bf16 v[20:23], v[56:59], v[184:187], v[20:23]
  v_mfma_f32_16x16x32_bf16 v[20:23], v[60:63], v[188:191], v[20:23]
  s_nop 7
  v_max3_f32 v11, v20, v21, v11
  v_max3_f32 v11, v22, v23, v11
  v_mfma_f32_16x16x32_bf16 v[16:19], v[32:35], v[192:195], 0
  v_mfma_f32_16x16x32_bf16 v[16:19], v[36:39], v[196:199], v[16:19]
  v_mfma_f32_16x16x32_bf16 v[16:19], v[40:43], v[200:203], v[16:19]
  v_mfma_f32_16x16x32_bf16 v[16:19], v[44:47], v[204:207], v[16:19]
  v_mfma_f32_16x16x32_bf16 v[16:19], v[48:51], v[208:211], v[16:19]
  v_mfma_f32_16x16x32_bf16 v[16:19], v[52:55], v[212:215], v[16:19]
  v_mfma_f32_16x16x32_bf16 v[16:19], v[56:59], v[216:219], v[16:19]
  v_mfma_f32_16x16x32_bf16 v[16:19], v[60:63], v[220:223], v[16:19]
  s_nop 7
  v_max3_f32 v12, v16, v17, v12
  v_max3_f32 v12, v18, v19, v12
  v_mfma_f32_16x16x32_bf16 v[20:23], v[32:35], v[224:227], 0
  v_mfma_f32_16x16x32_bf16 v[20:23], v[36:39], v[228:231], v[20:23]
  v_mfma_f32_16x16x32_bf16 v[20:23], v[40:43], v[232:235], v[20:23]
  v_mfma_f32_16x16x32_bf16 v[20:23], v[44:47], v[236:239], v[20:23]
  v_mfma_f32_16x16x32_bf16 v[20:23], v[48:51], v[240:243], v[20:23]
  v_mfma_f32_16x16x32_bf16 v[20:23], v[52:55], v[244:247], v[20:23]
  v_mfma_f32_16x16x32_bf16 v[20:23], v[56:59], v[248:251], v[20:23]
  v_mfma_f32_16x16x32_bf16 v[20:23], v[60:63], v[252:255], v[20:23]
  s_nop 7
  v_max3_f32 v13, v20, v21, v13
  v_max3_f32 v13, v22, v23, v13
  ds_read_b128 v[64:67], v9 offset:0
  ds_read_b128 v[68:71], v9 offset:1024
  ds_read_b128 v[72:75], v9 offset:2048
  ds_read_b128 v[76:79], v9 offset:3072
  ds_read_b128 v[80:83], v9 offset:4096
  ds_read_b128 v[84:87], v9 offset:5120
  ds_read_b128 v[88:91], v9 offset:6144
  ds_read_b128 v[92:95], v9 offset:7168
  s_waitcnt lgkmcnt(7)
  v_mfma_f32_16x16x32_bf16 v[16:19], v[32:35], v[64:67], 0
  s_waitcnt lgkmcnt(6)
  v_mfma_f32_16x16x32_bf16 v[16:19], v[36:39], v[68:71], v[16:19]
  s_waitcnt lgkmcnt(5)
  v_mfma_f32_16x16x32_bf16 v[16:19], v[40:43], v[72:75], v[16:19]
  s_waitcnt lgkmcnt(4)
  v_mfma_f32_16x16x32_bf16 v[16:19], v[44:47], v[76:79], v[16:19]
  s_waitcnt lgkmcnt(3)
  v_mfma_f32_16x16x32_bf16 v[16:19], v[48:51], v[80:83], v[16:19]
  s_waitcnt lgkmcnt(2)
  v_mfma_f32_16x16x32_bf16 v[16:19], v[52:55], v[84:87], v[16:19]
  s_waitcnt lgkmcnt(1)
  v_mfma_f32_16x16x32_bf16 v[16:19], v[56:59], v[88:91], v[16:19]
  s_waitcnt lgkmcnt(0)
  v_mfma_f32_16x16x32_bf16 v[16:19], v[60:63], v[92:95], v[16:19]
  s_nop 7
  v_max3_f32 v14, v16, v17, v14
  v_max3_f32 v14, v18, v19, v14
  ds_read_b128 v[32:35], v1 offset:6144
  ds_read_b128 v[36:39], v2 offset:6144
  ds_read_b128 v[40:43], v1 offset:14336
  ds_read_b128 v[44:47], v2 offset:14336
  ds_read_b128 v[48:51], v1 offset:22528
  ds_read_b128 v[52:55], v2 offset:22528
  ds_read_b128 v[56:59], v1 offset:30720
  ds_read_b128 v[60:63], v2 offset:30720
  s_waitcnt lgkmcnt(7)
  v_mfma_f32_16x16x32_bf16 v[20:23], v[32:35], v[128:131], 0
  s_waitcnt lgkmcnt(6)
  v_mfma_f32_16x16x32_bf16 v[20:23], v[36:39], v[132:135], v[20:23]
  s_waitcnt lgkmcnt(5)
  v_mfma_f32_16x16x32_bf16 v[20:23], v[40:43], v[136:139], v[20:23]
  s_waitcnt lgkmcnt(4)
  v_mfma_f32_16x16x32_bf16 v[20:23], v[44:47], v[140:143], v[20:23]
  s_waitcnt lgkmcnt(3)
  v_mfma_f32_16x16x32_bf16 v[20:23], v[48:51], v[144:147], v[20:23]
  s_waitcnt lgkmcnt(2)
  v_mfma_f32_16x16x32_bf16 v[20:23], v[52:55], v[148:151], v[20:23]
  s_waitcnt lgkmcnt(1)
  v_mfma_f32_16x16x32_bf16 v[20:23], v[56:59], v[152:155], v[20:23]
  s_waitcnt lgkmcnt(0)
  v_mfma_f32_16x16x32_bf16 v[20:23], v[60:63], v[156:159], v[20:23]
  s_nop 7
  v_max3_f32 v10, v20, v21, v10
  v_max3_f32 v10, v22, v23, v10
  v_mfma_f32_16x16x32_bf16 v[16:19], v[32:35], v[160:163], 0
  v_mfma_f32_16x16x32_bf16 v[16:19], v[36:39], v[164:167], v[16:19]
  v_mfma_f32_16x16x32_bf16 v[16:19], v[40:43], v[168:171], v[16:19]
  v_mfma_f32_16x16x32_bf16 v[16:19], v[44:47], v[172:175], v[16:19]
  v_mfma_f32_16x16x32_bf16 v[16:19], v[48:51], v[176:179], v[16:19]
  v_mfma_f32_16x16x32_bf16 v[16:19], v[52:55], v[180:183], v[16:19]
  v_mfma_f32_16x16x32_bf16 v[16:19], v[56:59], v[184:187], v[16:19]
  v_mfma_f32_16x16x32_bf16 v[16:19], v[60:63], v[188:191], v[16:19]
  s_nop 7
  v_max3_f32 v11, v16, v17, v11
  v_max3_f32 v11, v18, v19, v11
  v_mfma_f32_16x16x32_bf16 v[20:23], v[32:35], v[192:195], 0
  v_mfma_f32_16x16x32_bf16 v[20:23], v[36:39], v[196:199], v[20:23]
  v_mfma_f32_16x16x32_bf16 v[20:23], v[40:43], v[200:203], v[20:23]
  v_mfma_f32_16x16x32_bf16 v[20:23], v[44:47], v[204:207], v[20:23]
  v_mfma_f32_16x16x32_bf16 v[20:23], v[48:51], v[208:211], v[20:23]
  v_mfma_f32_16x16x32_bf16 v[20:23], v[52:55], v[212:215], v[20:23]
  v_mfma_f32_16x16x32_bf16 v[20:23], v[56:59], v[216:219], v[20:23]
  v_mfma_f32_16x16x32_bf16 v[20:23], v[60:63], v[220:223], v[20:23]
  s_nop 7
  v_max3_f32 v12, v20, v21, v12
  v_max3_f32 v12, v22, v23, v12
  v_mfma_f32_16x16x32_bf16 v[16:19], v[32:35], v[224:227], 0
  v_mfma_f32_16x16x32_bf16 v[16:19], v[36:39], v[228:231], v[16:19]
  v_mfma_f32_16x16x32_bf16 v[16:19], v[40:43], v[232:235], v[16:19]
  v_mfma_f32_16x16x32_bf16 v[16:19], v[44:47], v[236:239], v[16:19]
  v_mfma_f32_16x16x32_bf16 v[16:19], v[48:51], v[240:243], v[16:19]
  v_mfma_f32_16x16x32_bf16 v[16:19], v[52:55], v[244:247], v[16:19]
  v_mfma_f32_16x16x32_bf16 v[16:19], v[56:59], v[248:251], v[16:19]
  v_mfma_f32_16x16x32_bf16 v[16:19], v[60:63], v[252:255], v[16:19]
  s_nop 7
  v_max3_f32 v13, v16, v17, v13
  v_max3_f32 v13, v18, v19, v13
  ds_read_b128 v[64:67], v9 offset:0
  ds_read_b128 v[68:71], v9 offset:1024
  ds_read_b128 v[72:75], v9 offset:2048
  ds_read_b128 v[76:79], v9 offset:3072
  ds_read_b128 v[80:83], v9 offset:4096
  ds_read_b128 v[84:87], v9 offset:5120
  ds_read_b128 v[88:91], v9 offset:6144
  ds_read_b128 v[92:95], v9 offset:7168
  s_waitcnt lgkmcnt(7)
  v_mfma_f32_16x16x32_bf16 v[20:23], v[32:35], v[64:67], 0
  s_waitcnt lgkmcnt(6)
  v_mfma_f32_16x16x32_bf16 v[20:23], v[36:39], v[68:71], v[20:23]
  s_waitcnt lgkmcnt(5)
  v_mfma_f32_16x16x32_bf16 v[20:23], v[40:43], v[72:75], v[20:23]
  s_waitcnt lgkmcnt(4)
  v_mfma_f32_16x16x32_bf16 v[20:23], v[44:47], v[76:79], v[20:23]
  s_waitcnt lgkmcnt(3)
  v_mfma_f32_16x16x32_bf16 v[20:23], v[48:51], v[80:83], v[20:23]
  s_waitcnt lgkmcnt(2)
  v_mfma_f32_16x16x32_bf16 v[20:23], v[52:55], v[84:87], v[20:23]
  s_waitcnt lgkmcnt(1)
  v_mfma_f32_16x16x32_bf16 v[20:23], v[56:59], v[88:91], v[20:23]
  s_waitcnt lgkmcnt(0)
  v_mfma_f32_16x16x32_bf16 v[20:23], v[60:63], v[92:95], v[20:23]
  s_nop 7
  v_max3_f32 v14, v20, v21, v14
  v_max3_f32 v14, v22, v23, v14
  ds_read_b128 v[32:35], v1 offset:0
  ds_read_b128 v[36:39], v2 offset:0
  ds_read_b128 v[40:43], v1 offset:8192
  ds_read_b128 v[44:47], v2 offset:8192
  ds_read_b128 v[48:51], v1 offset:16384
  ds_read_b128 v[52:55], v2 offset:16384
  ds_read_b128 v[56:59], v1 offset:24576
  ds_read_b128 v[60:63], v2 offset:24576
  s_waitcnt lgkmcnt(7)
  v_mfma_f32_16x16x32_bf16 v[16:19], v[32:35], v[128:131], 0
  s_waitcnt lgkmcnt(6)
  v_mfma_f32_16x16x32_bf16 v[16:19], v[36:39], v[132:135], v[16:19]
  s_waitcnt lgkmcnt(5)
  v_mfma_f32_16x16x32_bf16 v[16:19], v[40:43], v[136:139], v[16:19]
  s_waitcnt lgkmcnt(4)
  v_mfma_f32_16x16x32_bf16 v[16:19], v[44:47], v[140:143], v[16:19]
  s_waitcnt lgkmcnt(3)
  v_mfma_f32_16x16x32_bf16 v[16:19], v[48:51], v[144:147], v[16:19]
  s_waitcnt lgkmcnt(2)
  v_mfma_f32_16x16x32_bf16 v[16:19], v[52:55], v[148:151], v[16:19]
  s_waitcnt lgkmcnt(1)
  v_mfma_f32_16x16x32_bf16 v[16:19], v[56:59], v[152:155], v[16:19]
  s_waitcnt lgkmcnt(0)
  v_mfma_f32_16x16x32_bf16 v[16:19], v[60:63], v[156:159], v[16:19]
  s_nop 7
  v_max3_f32 v10, v16, v17, v10
  v_max3_f32 v10, v18, v19, v10
  v_mfma_f32_16x16x32_bf16 v[20:23], v[32:35], v[160:163], 0
  v_mfma_f32_16x16x32_bf16 v[20:23], v[36:39], v[164:167], v[20:23]
  v_mfma_f32_16x16x32_bf16 v[20:23], v[40:43], v[168:171], v[20:23]
  v_mfma_f32_16x16x32_bf16 v[20:23], v[44:47], v[172:175], v[20:23]
  v_mfma_f32_16x16x32_bf16 v[20:23], v[48:51], v[176:179], v[20:23]
  v_mfma_f32_16x16x32_bf16 v[20:23], v[52:55], v[180:183], v[20:23]
  v_mfma_f32_16x16x32_bf16 v[20:23], v[56:59], v[184:187], v[20:23]
  v_mfma_f32_16x16x32_bf16 v[20:23], v[60:63], v[188:191], v[20:23]
  s_nop 7
  v_max3_f32 v11, v20, v21, v11
  v_max3_f32 v11, v22, v23, v11
  v_mfma_f32_16x16x32_bf16 v[16:19], v[32:35], v[192:195], 0
  v_mfma_f32_16x16x32_bf16 v[16:19], v[36:39], v[196:199], v[16:19]
  v_mfma_f32_16x16x32_bf16 v[16:19], v[40:43], v[200:203], v[16:19]
  v_mfma_f32_16x16x32_bf16 v[16:19], v[44:47], v[204:207], v[16:19]
  v_mfma_f32_16x16x32_bf16 v[16:19], v[48:51], v[208:211], v[16:19]
  v_mfma_f32_16x16x32_bf16 v[16:19], v[52:55], v[212:215], v[16:19]
  v_mfma_f32_16x16x32_bf16 v[16:19], v[56:59], v[216:219], v[16:19]
  v_mfma_f32_16x16x32_bf16 v[16:19], v[60:63], v[220:223], v[16:19]
  s_nop 7
  v_max3_f32 v12, v16, v17, v12
  v_max3_f32 v12, v18, v19, v12
  v_mfma_f32_16x16x32_bf16 v[20:23], v[32:35], v[224:227], 0
  v_mfma_f32_16x16x32_bf16 v[20:23], v[36:39], v[228:231], v[20:23]
  v_mfma_f32_16x16x32_bf16 v[20:23], v[40:43], v[232:235], v[20:23]
  v_mfma_f32_16x16x32_bf16 v[20:23], v[44:47], v[236:239], v[20:23]
  v_mfma_f32_16x16x32_bf16 v[20:23], v[48:51], v[240:243], v[20:23]
  v_mfma_f32_16x16x32_bf16 v[20:23], v[52:55], v[244:247], v[20:23]
  v_mfma_f32_16x16x32_bf16 v[20:23], v[56:59], v[248:251], v[20:23]
  v_mfma_f32_16x16x32_bf16 v[20:23], v[60:63], v[252:255], v[20:23]
  s_nop 7
  v_max3_f32 v13, v20, v21, v13
  v_max3_f32 v13, v22, v23, v13
  ds_read_b128 v[32:35], v1 offset:2048
  ds_read_b128 v[36:39], v2 offset:2048
  ds_read_b128 v[40:43], v1 offset:10240
  ds_read_b128 v[44:47], v2 offset:10240
  ds_read_b128 v[48:51], v1 offset:18432
  ds_read_b128 v[52:55], v2 offset:18432
  ds_read_b128 v[56:59], v1 offset:26624
  ds_read_b128 v[60:63], v2 offset:26624
  s_waitcnt lgkmcnt(7)
  v_mfma_f32_16x16x32_bf16 v[16:19], v[32:35], v[128:131], 0
  s_waitcnt lgkmcnt(6)
  v_mfma_f32_16x16x32_bf16 v[16:19], v[36:39], v[132:135], v[16:19]
  s_waitcnt lgkmcnt(5)
  v_mfma_f32_16x16x32_bf16 v[16:19], v[40:43], v[136:139], v[16:19]
  s_waitcnt lgkmcnt(4)
  v_mfma_f32_16x16x32_bf16 v[16:19], v[44:47], v[140:143], v[16:19]
  s_waitcnt lgkmcnt(3)
  v_mfma_f32_16x16x32_bf16 v[16:19], v[48:51], v[144:147], v[16:19]
  s_waitcnt lgkmcnt(2)
  v_mfma_f32_16x16x32_bf16 v[16:19], v[52:55], v[148:151], v[16:19]
  s_waitcnt lgkmcnt(1)
  v_mfma_f32_16x16x32_bf16 v[16:19], v[56:59], v[152:155], v[16:19]
  s_waitcnt lgkmcnt(0)
  v_mfma_f32_16x16x32_bf16 v[16:19], v[60:63], v[156:159], v[16:19]
  s_nop 7
  v_max3_f32 v10, v16, v17, v10
  v_max3_f32 v10, v18, v19, v10
  v_mfma_f32_16x16x32_bf16 v[20:23], v[32:35], v[160:163], 0
  v_mfma_f32_16x16x32_bf16 v[20:23], v[36:39], v[164:167], v[20:23]
  v_mfma_f32_16x16x32_bf16 v[20:23], v[40:43], v[168:171], v[20:23]
  v_mfma_f32_16x16x32_bf16 v[20:23], v[44:47], v[172:175], v[20:23]
  v_mfma_f32_16x16x32_bf16 v[20:23], v[48:51], v[176:179], v[20:23]
  v_mfma_f32_16x16x32_bf16 v[20:23], v[52:55], v[180:183], v[20:23]
  v_mfma_f32_16x16x32_bf16 v[20:23], v[56:59], v[184:187], v[20:23]
  v_mfma_f32_16x16x32_bf16 v[20:23], v[60:63], v[188:191], v[20:23]
  s_nop 7
  v_max3_f32 v11, v20, v21, v11
  v_max3_f32 v11, v22, v23, v11
  v_mfma_f32_16x16x32_bf16 v[16:19], v[32:35], v[192:195], 0
  v_mfma_f32_16x16x32_bf16 v[16:19], v[36:39], v[196:199], v[16:19]
  v_mfma_f32_16x16x32_bf16 v[16:19], v[40:43], v[200:203], v[16:19]
  v_mfma_f32_16x16x32_bf16 v[16:19], v[44:47], v[204:207], v[16:19]
  v_mfma_f32_16x16x32_bf16 v[16:19], v[48:51], v[208:211], v[16:19]
  v_mfma_f32_16x16x32_bf16 v[16:19], v[52:55], v[212:215], v[16:19]
  v_mfma_f32_16x16x32_bf16 v[16:19], v[56:59], v[216:219], v[16:19]
  v_mfma_f32_16x16x32_bf16 v[16:19], v[60:63], v[220:223], v[16:19]
  s_nop 7
  v_max3_f32 v12, v16, v17, v12
  v_max3_f32 v12, v18, v19, v12
  v_mfma_f32_16x16x32_bf16 v[20:23], v[32:35], v[224:227], 0
  v_mfma_f32_16x16x32_bf16 v[20:23], v[36:39], v[228:231], v[20:23]
  v_mfma_f32_16x16x32_bf16 v[20:23], v[40:43], v[232:235], v[20:23]
  v_mfma_f32_16x16x32_bf16 v[20:23], v[44:47], v[236:239], v[20:23]
  v_mfma_f32_16x16x32_bf16 v[20:23], v[48:51], v[240:243], v[20:23]
  v_mfma_f32_16x16x32_bf16 v[20:23], v[52:55], v[244:247], v[20:23]
  v_mfma_f32_16x16x32_bf16 v[20:23], v[56:59], v[248:251], v[20:23]
  v_mfma_f32_16x16x32_bf16 v[20:23], v[60:63], v[252:255], v[20:23]
  s_nop 7
  v_max3_f32 v13, v20, v21, v13
  v_max3_f32 v13, v22, v23, v13
  s_waitcnt lgkmcnt(0)
  s_nop 9
  s_barrier
  s_sub_u32 s29, s29, 1
  s_cmp_lg_u32 s29, 0
  s_cbranch_scc1 K1_MAXL_P1
  v_mov_b32 v15, v10
  s_nop 1
  v_permlane32_swap_b32 v10, v15
  v_max_f32 v10, v10, v15
  v_mov_b32 v15, v10
  s_nop 1
  v_permlane16_swap_b32 v10, v15
  v_max_f32 v10, v10, v15
  v_mov_b32 v15, v11
  s_nop 1
  v_permlane32_swap_b32 v11, v15
  v_max_f32 v11, v11, v15
  v_mov_b32 v15, v11
  s_nop 1
  v_permlane16_swap_b32 v11, v15
  v_max_f32 v11, v11, v15
  v_mov_b32 v15, v12
  s_nop 1
  v_permlane32_swap_b32 v12, v15
  v_max_f32 v12, v12, v15
  v_mov_b32 v15, v12
  s_nop 1
  v_permlane16_swap_b32 v12, v15
  v_max_f32 v12, v12, v15
  v_mov_b32 v15, v13
  s_nop 1
  v_permlane32_swap_b32 v13, v15
  v_max_f32 v13, v13, v15
  v_mov_b32 v15, v13
  s_nop 1
  v_permlane16_swap_b32 v13, v15
  v_max_f32 v13, v13, v15
  v_mov_b32 v15, v14
  s_nop 1
  v_permlane32_swap_b32 v14, v15
  v_max_f32 v14, v14, v15
  v_mov_b32 v15, v14
  s_nop 1
  v_permlane16_swap_b32 v14, v15
  v_max_f32 v14, v14, v15
  ds_write_b32 v9, v14 offset:10244
  s_waitcnt lgkmcnt(0)
  s_barrier
  ds_read_b32 v15, v9 offset:10240
  s_waitcnt lgkmcnt(0)
  v_max_f32 v14, v14, v15
  ds_write_b32 v9, v10 offset:14336
  ds_write_b32 v9, v11 offset:14340
  ds_write_b32 v9, v12 offset:14344
  ds_write_b32 v9, v13 offset:14348
  ds_write_b32 v9, v14 offset:15360
  s_lshl_b32 s30, s28, 7
  s_mov_b32 s31, s30
  s_lshl_b32 s33, s28, 13
  s_add_u32 s32, s33, 98304
  v_mbcnt_lo_u32_b32 v16, -1, 0
  v_mbcnt_hi_u32_b32 v16, -1, v16
  v_and_b32 v17, 15, v16
  v_lshrrev_b32 v18, 4, v16
  v_bfe_u32 v19, v16, 2, 2
  v_and_b32 v20, 3, v16
  v_lshrrev_b32 v21, 3, v16
  v_and_b32 v22, 7, v16
  v_and_b32 v23, 1, v18
  v_lshlrev_b32 v23, 1, v23
  v_lshrrev_b32 v24, 1, v18
  v_or_b32 v23, v23, v24
  v_bfe_u32 v24, v17, 1, 1
  v_and_b32 v25, 4, v17
  v_or_b32 v24, v24, v25
  v_xor_b32 v23, v23, v24
  v_lshlrev_b32 v23, 4, v23
  v_lshlrev_b32 v24, 7, v17
  v_add_u32 v23, v23, v24
  v_add_u32 v1, 98304, v23
  v_xor_b32 v2, 64, v1
  v_lshrrev_b32 v23, 1, v19
  v_and_b32 v24, 1, v18
  v_lshlrev_b32 v24, 1, v24
  v_or_b32 v23, v23, v24
  v_lshlrev_b32 v24, 2, v18
  v_add_u32 v24, v24, v19
  v_lshlrev_b32 v24, 7, v24
  v_lshlrev_b32 v25, 3, v20
  v_add_u32 v24, v24, v25
  v_add_u32 v24, 65536, v24
  v_xor_b32 v25, 0, v23
  v_lshlrev_b32 v25, 5, v25
  v_add_u32 v3, v24, v25
  v_xor_b32 v25, 1, v23
  v_lshlrev_b32 v25, 5, v25
  v_add_u32 v4, v24, v25
  v_xor_b32 v25, 2, v23
  v_lshlrev_b32 v25, 5, v25
  v_add_u32 v5, v24, v25
  v_xor_b32 v25, 3, v23
  v_lshlrev_b32 v25, 5, v25
  v_add_u32 v6, v24, v25
  v_mov_b32 v10, 0
  v_mov_b32 v11, 0
  v_mov_b32 v12, 0
  v_mov_b32 v13, 0
  v_mov_b32 v14, 0
  s_add_u32 m0, s32, 0
  s_add_u32 s34, s30, 0
  buffer_load_dwordx4 v7, s[8:11], s34 offen nt lds
  s_add_u32 m0, s32, 1024
  s_add_u32 s34, s30, 4096
  buffer_load_dwordx4 v7, s[8:11], s34 offen nt lds
  s_add_u32 m0, s32, 2048
  s_add_u32 s34, s30, 8192
  buffer_load_dwordx4 v7, s[8:11], s34 offen nt lds
  s_add_u32 m0, s32, 3072
  s_add_u32 s34, s30, 12288
  buffer_load_dwordx4 v7, s[8:11], s34 offen nt lds
  s_add_u32 m0, s32, 4096
  s_add_u32 s34, s30, 16384
  buffer_load_dwordx4 v7, s[8:11], s34 offen nt lds
  s_add_u32 m0, s32, 5120
  s_add_u32 s34, s30, 20480
  buffer_load_dwordx4 v7, s[8:11], s34 offen nt lds
  s_add_u32 m0, s32, 6144
  s_add_u32 s34, s30, 24576
  buffer_load_dwordx4 v7, s[8:11], s34 offen nt lds
  s_add_u32 m0, s32, 7168
  s_add_u32 s34, s30, 28672
  buffer_load_dwordx4 v7, s[8:11], s34 offen nt lds
  s_add_u32 s30, s30, 32768
  s_xor_b32 s32, s32, 65536
  s_add_u32 m0, s33, 0
  s_add_u32 s34, s31, 0
  buffer_load_dwordx4 v8, s[12:15], s34 offen nt lds
  s_add_u32 m0, s33, 1024
  s_add_u32 s34, s31, 4096
  buffer_load_dwordx4 v8, s[12:15], s34 offen nt lds
  s_add_u32 m0, s33, 2048
  s_add_u32 s34, s31, 8192
  buffer_load_dwordx4 v8, s[12:15], s34 offen nt lds
  s_add_u32 m0, s33, 3072
  s_add_u32 s34, s31, 12288
  buffer_load_dwordx4 v8, s[12:15], s34 offen nt lds
  s_add_u32 m0, s33, 4096
  s_add_u32 s34, s31, 16384
  buffer_load_dwordx4 v8, s[12:15], s34 offen nt lds
  s_add_u32 m0, s33, 5120
  s_add_u32 s34, s31, 20480
  buffer_load_dwordx4 v8, s[12:15], s34 offen nt lds
  s_add_u32 m0, s33, 6144
  s_add_u32 s34, s31, 24576
  buffer_load_dwordx4 v8, s[12:15], s34 offen nt lds
  s_add_u32 m0, s33, 7168
  s_add_u32 s34, s31, 28672
  buffer_load_dwordx4 v8, s[12:15], s34 offen nt lds
  s_add_u32 s31, s31, 32768
  s_xor_b32 s33, s33, 65536
  s_add_u32 m0, s32, 0
  s_add_u32 s34, s30, 0
  buffer_load_dwordx4 v7, s[8:11], s34 offen nt lds
  s_add_u32 m0, s32, 1024
  s_add_u32 s34, s30, 4096
  buffer_load_dwordx4 v7, s[8:11], s34 offen nt lds
  s_add_u32 m0, s32, 2048
  s_add_u32 s34, s30, 8192
  buffer_load_dwordx4 v7, s[8:11], s34 offen nt lds
  s_add_u32 m0, s32, 3072
  s_add_u32 s34, s30, 12288
  buffer_load_dwordx4 v7, s[8:11], s34 offen nt lds
  s_add_u32 m0, s32, 4096
  s_add_u32 s34, s30, 16384
  buffer_load_dwordx4 v7, s[8:11], s34 offen nt lds
  s_add_u32 m0, s32, 5120
  s_add_u32 s34, s30, 20480
  buffer_load_dwordx4 v7, s[8:11], s34 offen nt lds
  s_add_u32 m0, s32, 6144
  s_add_u32 s34, s30, 24576
  buffer_load_dwordx4 v7, s[8:11], s34 offen nt lds
  s_add_u32 m0, s32, 7168
  s_add_u32 s34, s30, 28672
  buffer_load_dwordx4 v7, s[8:11], s34 offen nt lds
  s_add_u32 s30, s30, 32768
  s_xor_b32 s32, s32, 65536
  s_waitcnt lgkmcnt(0)
  s_waitcnt vmcnt(16)
  s_barrier
  ds_read_b128 v[32:35], v1 offset:4096
  ds_read_b128 v[36:39], v2 offset:4096
  ds_read_b128 v[40:43], v1 offset:12288
  ds_read_b128 v[44:47], v2 offset:12288
  ds_read_b128 v[48:51], v1 offset:20480
  ds_read_b128 v[52:55], v2 offset:20480
  ds_read_b128 v[56:59], v1 offset:28672
  ds_read_b128 v[60:63], v2 offset:28672
  s_waitcnt lgkmcnt(7)
  v_mfma_f32_16x16x32_bf16 v[16:19], v[32:35], v[128:131], 0
  ds_read_b128 v[80:83], v9 offset:0
  ds_read_b128 v[84:87], v9 offset:1024
  s_waitcnt lgkmcnt(8)
  v_mfma_f32_16x16x32_bf16 v[16:19], v[36:39], v[132:135], v[16:19]
  ds_read_b128 v[88:91], v9 offset:2048
  ds_read_b128 v[92:95], v9 offset:3072
  s_waitcnt lgkmcnt(9)
  v_mfma_f32_16x16x32_bf16 v[16:19], v[40:43], v[136:139], v[16:19]
  v_xor_b32 v3, 65536, v3
  v_xor_b32 v4, 65536, v4
  s_waitcnt lgkmcnt(8)
  v_mfma_f32_16x16x32_bf16 v[16:19], v[44:47], v[140:143], v[16:19]
  v_xor_b32 v5, 65536, v5
  v_xor_b32 v6, 65536, v6
  s_waitcnt lgkmcnt(7)
  v_mfma_f32_16x16x32_bf16 v[16:19], v[48:51], v[144:147], v[16:19]
  s_waitcnt lgkmcnt(6)
  v_mfma_f32_16x16x32_bf16 v[16:19], v[52:55], v[148:151], v[16:19]
  s_waitcnt lgkmcnt(5)
  v_mfma_f32_16x16x32_bf16 v[16:19], v[56:59], v[152:155], v[16:19]
  s_waitcnt lgkmcnt(4)
  v_mfma_f32_16x16x32_bf16 v[16:19], v[60:63], v[156:159], v[16:19]
  v_mfma_f32_16x16x32_bf16 v[20:23], v[32:35], v[160:163], 0
  ds_read_b128 v[24:27], v1 offset:6144
  v_mfma_f32_16x16x32_bf16 v[20:23], v[36:39], v[164:167], v[20:23]
  ds_read_b128 v[28:31], v2 offset:6144
  v_mfma_f32_16x16x32_bf16 v[20:23], v[40:43], v[168:171], v[20:23]
  ds_read_b32 v0, v9 offset:14336
  s_waitcnt lgkmcnt(0)
  s_nop 0
  v_sub_f32 v16, v16, v0
  v_mfma_f32_16x16x32_bf16 v[20:23], v[44:47], v[172:175], v[20:23]
  v_sub_f32 v17, v17, v0
  v_sub_f32 v18, v18, v0
  v_mfma_f32_16x16x32_bf16 v[20:23], v[48:51], v[176:179], v[20:23]
  v_sub_f32 v19, v19, v0
  v_mfma_f32_16x16x32_bf16 v[20:23], v[52:55], v[180:183], v[20:23]
  v_exp_f32 v16, v16
  v_mfma_f32_16x16x32_bf16 v[20:23], v[56:59], v[184:187], v[20:23]
  v_exp_f32 v17, v17
  v_mfma_f32_16x16x32_bf16 v[20:23], v[60:63], v[188:191], v[20:23]
  v_exp_f32 v18, v18
  v_exp_f32 v19, v19
  v_add_f32 v10, v10, v16
  v_add_f32 v10, v10, v17
  v_add_f32 v10, v10, v18
  v_add_f32 v10, v10, v19
  v_cvt_pk_bf16_f32 v64, v16, v17
  v_cvt_pk_bf16_f32 v65, v18, v19
  v_mfma_f32_16x16x32_bf16 v[16:19], v[32:35], v[192:195], 0
  v_mfma_f32_16x16x32_bf16 v[16:19], v[36:39], v[196:199], v[16:19]
  v_mfma_f32_16x16x32_bf16 v[16:19], v[40:43], v[200:203], v[16:19]
  ds_read_b32 v15, v9 offset:14340
  s_waitcnt lgkmcnt(0)
  v_sub_f32 v20, v20, v15
  v_mfma_f32_16x16x32_bf16 v[16:19], v[44:47], v[204:207], v[16:19]
  v_sub_f32 v21, v21, v15
  v_sub_f32 v22, v22, v15
  v_mfma_f32_16x16x32_bf16 v[16:19], v[48:51], v[208:211], v[16:19]
  v_sub_f32 v23, v23, v15
  v_mfma_f32_16x16x32_bf16 v[16:19], v[52:55], v[212:215], v[16:19]
  v_exp_f32 v20, v20
  v_mfma_f32_16x16x32_bf16 v[16:19], v[56:59], v[216:219], v[16:19]
  v_exp_f32 v21, v21
  v_mfma_f32_16x16x32_bf16 v[16:19], v[60:63], v[220:223], v[16:19]
  v_exp_f32 v22, v22
  v_exp_f32 v23, v23
  v_add_f32 v11, v11, v20
  v_add_f32 v11, v11, v21
  v_add_f32 v11, v11, v22
  v_add_f32 v11, v11, v23
  v_cvt_pk_bf16_f32 v68, v20, v21
  v_cvt_pk_bf16_f32 v69, v22, v23
  v_mfma_f32_16x16x32_bf16 v[20:23], v[32:35], v[224:227], 0
  v_mfma_f32_16x16x32_bf16 v[20:23], v[36:39], v[228:231], v[20:23]
  v_mfma_f32_16x16x32_bf16 v[20:23], v[40:43], v[232:235], v[20:23]
  ds_read_b32 v0, v9 offset:14344
  s_waitcnt lgkmcnt(0)
  v_sub_f32 v16, v16, v0
  v_mfma_f32_16x16x32_bf16 v[20:23], v[44:47], v[236:239], v[20:23]
  v_sub_f32 v17, v17, v0
  v_sub_f32 v18, v18, v0
  v_mfma_f32_16x16x32_bf16 v[20:23], v[48:51], v[240:243], v[20:23]
  v_sub_f32 v19, v19, v0
  v_mfma_f32_16x16x32_bf16 v[20:23], v[52:55], v[244:247], v[20:23]
  v_exp_f32 v16, v16
  v_mfma_f32_16x16x32_bf16 v[20:23], v[56:59], v[248:251], v[20:23]
  v_exp_f32 v17, v17
  v_mfma_f32_16x16x32_bf16 v[20:23], v[60:63], v[252:255], v[20:23]
  v_exp_f32 v18, v18
  v_exp_f32 v19, v19
  v_add_f32 v12, v12, v16
  v_add_f32 v12, v12, v17
  v_add_f32 v12, v12, v18
  v_add_f32 v12, v12, v19
  v_cvt_pk_bf16_f32 v72, v16, v17
  v_cvt_pk_bf16_f32 v73, v18, v19
  v_mfma_f32_16x16x32_bf16 v[16:19], v[32:35], v[80:83], 0
  ds_read_b128 v[80:83], v9 offset:4096
  ds_read_b128 v[32:35], v1 offset:14336
  v_mfma_f32_16x16x32_bf16 v[16:19], v[36:39], v[84:87], v[16:19]
  ds_read_b128 v[84:87], v9 offset:5120
  ds_read_b128 v[36:39], v2 offset:14336
  v_mfma_f32_16x16x32_bf16 v[16:19], v[40:43], v[88:91], v[16:19]
  ds_read_b128 v[88:91], v9 offset:6144
  ds_read_b128 v[40:43], v1 offset:22528
  v_mfma_f32_16x16x32_bf16 v[16:19], v[44:47], v[92:95], v[16:19]
  ds_read_b128 v[92:95], v9 offset:7168
  ds_read_b128 v[44:47], v2 offset:22528
  s_waitcnt lgkmcnt(7)
  v_mfma_f32_16x16x32_bf16 v[16:19], v[48:51], v[80:83], v[16:19]
  ds_read_b128 v[48:51], v1 offset:30720
  ds_read_b32 v15, v9 offset:14348
  s_waitcnt lgkmcnt(7)
  v_mfma_f32_16x16x32_bf16 v[16:19], v[52:55], v[84:87], v[16:19]
  ds_read_b128 v[52:55], v2 offset:30720
  s_waitcnt lgkmcnt(1)
  v_sub_f32 v20, v20, v15
  v_mfma_f32_16x16x32_bf16 v[16:19], v[56:59], v[88:91], v[16:19]
  v_sub_f32 v21, v21, v15
  v_sub_f32 v22, v22, v15
  v_mfma_f32_16x16x32_bf16 v[16:19], v[60:63], v[92:95], v[16:19]
  v_sub_f32 v23, v23, v15
  v_exp_f32 v20, v20
  v_exp_f32 v21, v21
  v_exp_f32 v22, v22
  v_exp_f32 v23, v23
  v_add_f32 v13, v13, v20
  v_add_f32 v13, v13, v21
  v_add_f32 v13, v13, v22
  v_add_f32 v13, v13, v23
  v_cvt_pk_bf16_f32 v76, v20, v21
  v_cvt_pk_bf16_f32 v77, v22, v23
  v_mfma_f32_16x16x32_bf16 v[20:23], v[24:27], v[128:131], 0
  ds_read_b128 v[80:83], v9 offset:0
  ds_read_b128 v[84:87], v9 offset:1024
  v_mfma_f32_16x16x32_bf16 v[20:23], v[28:31], v[132:135], v[20:23]
  ds_read_b128 v[88:91], v9 offset:2048
  ds_read_b128 v[92:95], v9 offset:3072
  v_mfma_f32_16x16x32_bf16 v[20:23], v[32:35], v[136:139], v[20:23]
  ds_read_b32 v0, v9 offset:15360
  s_waitcnt lgkmcnt(0)
  v_sub_f32 v16, v16, v0
  v_mfma_f32_16x16x32_bf16 v[20:23], v[36:39], v[140:143], v[20:23]
  v_sub_f32 v17, v17, v0
  v_sub_f32 v18, v18, v0
  v_mfma_f32_16x16x32_bf16 v[20:23], v[40:43], v[144:147], v[20:23]
  v_sub_f32 v19, v19, v0
  v_mfma_f32_16x16x32_bf16 v[20:23], v[44:47], v[148:151], v[20:23]
  v_exp_f32 v16, v16
  v_mfma_f32_16x16x32_bf16 v[20:23], v[48:51], v[152:155], v[20:23]
  v_exp_f32 v17, v17
  v_mfma_f32_16x16x32_bf16 v[20:23], v[52:55], v[156:159], v[20:23]
  v_exp_f32 v18, v18
  v_exp_f32 v19, v19
  v_add_f32 v14, v14, v16
  v_add_f32 v14, v14, v17
  v_add_f32 v14, v14, v18
  v_add_f32 v14, v14, v19
  v_cvt_pk_bf16_f32 v16, v16, v17
  v_cvt_pk_bf16_f32 v17, v18, v19
  ds_write_b64 v9, v[16:17] offset:9216
  v_mfma_f32_16x16x32_bf16 v[16:19], v[24:27], v[160:163], 0
  ds_read_b128 v[56:59], v1 offset:0
  v_mfma_f32_16x16x32_bf16 v[16:19], v[28:31], v[164:167], v[16:19]
  ds_read_b128 v[60:63], v2 offset:0
  v_mfma_f32_16x16x32_bf16 v[16:19], v[32:35], v[168:171], v[16:19]
  ds_read_b32 v15, v9 offset:14336
  s_waitcnt lgkmcnt(0)
  v_sub_f32 v20, v20, v15
  v_mfma_f32_16x16x32_bf16 v[16:19], v[36:39], v[172:175], v[16:19]
  v_sub_f32 v21, v21, v15
  v_sub_f32 v22, v22, v15
  v_mfma_f32_16x16x32_bf16 v[16:19], v[40:43], v[176:179], v[16:19]
  v_sub_f32 v23, v23, v15
  v_mfma_f32_16x16x32_bf16 v[16:19], v[44:47], v[180:183], v[16:19]
  v_exp_f32 v20, v20
  v_mfma_f32_16x16x32_bf16 v[16:19], v[48:51], v[184:187], v[16:19]
  v_exp_f32 v21, v21
  v_mfma_f32_16x16x32_bf16 v[16:19], v[52:55], v[188:191], v[16:19]
  v_exp_f32 v22, v22
  v_exp_f32 v23, v23
  v_add_f32 v10, v10, v20
  v_add_f32 v10, v10, v21
  v_add_f32 v10, v10, v22
  v_add_f32 v10, v10, v23
  v_cvt_pk_bf16_f32 v66, v20, v21
  v_cvt_pk_bf16_f32 v67, v22, v23
  v_mfma_f32_16x16x32_bf16 v[20:23], v[24:27], v[192:195], 0
  v_mfma_f32_16x16x32_bf16 v[20:23], v[28:31], v[196:199], v[20:23]
  v_mfma_f32_16x16x32_bf16 v[20:23], v[32:35], v[200:203], v[20:23]
  ds_read_b32 v0, v9 offset:14340
  s_waitcnt lgkmcnt(0)
  v_sub_f32 v16, v16, v0
  v_mfma_f32_16x16x32_bf16 v[20:23], v[36:39], v[204:207], v[20:23]
  v_sub_f32 v17, v17, v0
  v_sub_f32 v18, v18, v0
  v_mfma_f32_16x16x32_bf16 v[20:23], v[40:43], v[208:211], v[20:23]
  v_sub_f32 v19, v19, v0
  v_mfma_f32_16x16x32_bf16 v[20:23], v[44:47], v[212:215], v[20:23]
  v_exp_f32 v16, v16
  v_mfma_f32_16x16x32_bf16 v[20:23], v[48:51], v[216:219], v[20:23]
  v_exp_f32 v17, v17
  v_mfma_f32_16x16x32_bf16 v[20:23], v[52:55], v[220:223], v[20:23]
  v_exp_f32 v18, v18
  v_exp_f32 v19, v19
  v_add_f32 v11, v11, v16
  v_add_f32 v11, v11, v17
  v_add_f32 v11, v11, v18
  v_add_f32 v11, v11, v19
  v_cvt_pk_bf16_f32 v70, v16, v17
  v_cvt_pk_bf16_f32 v71, v18, v19
  v_mfma_f32_16x16x32_bf16 v[16:19], v[24:27], v[224:227], 0
  v_mfma_f32_16x16x32_bf16 v[16:19], v[28:31], v[228:231], v[16:19]
  v_mfma_f32_16x16x32_bf16 v[16:19], v[32:35], v[232:235], v[16:19]
  ds_read_b32 v15, v9 offset:14344
  s_waitcnt lgkmcnt(0)
  v_sub_f32 v20, v20, v15
  v_mfma_f32_16x16x32_bf16 v[16:19], v[36:39], v[236:239], v[16:19]
  v_sub_f32 v21, v21, v15
  v_sub_f32 v22, v22, v15
  v_mfma_f32_16x16x32_bf16 v[16:19], v[40:43], v[240:243], v[16:19]
  v_sub_f32 v23, v23, v15
  v_mfma_f32_16x16x32_bf16 v[16:19], v[44:47], v[244:247], v[16:19]
  v_exp_f32 v20, v20
  v_mfma_f32_16x16x32_bf16 v[16:19], v[48:51], v[248:251], v[16:19]
  v_exp_f32 v21, v21
  v_mfma_f32_16x16x32_bf16 v[16:19], v[52:55], v[252:255], v[16:19]
  v_exp_f32 v22, v22
  v_exp_f32 v23, v23
  v_add_f32 v12, v12, v20
  v_add_f32 v12, v12, v21
  v_add_f32 v12, v12, v22
  v_add_f32 v12, v12, v23
  v_cvt_pk_bf16_f32 v74, v20, v21
  v_cvt_pk_bf16_f32 v75, v22, v23
  v_mfma_f32_16x16x32_bf16 v[20:23], v[24:27], v[80:83], 0
  ds_read_b128 v[80:83], v9 offset:4096
  ds_read_b128 v[24:27], v1 offset:8192
  v_mfma_f32_16x16x32_bf16 v[20:23], v[28:31], v[84:87], v[20:23]
  ds_read_b128 v[84:87], v9 offset:5120
  ds_read_b128 v[28:31], v2 offset:8192
  v_mfma_f32_16x16x32_bf16 v[20:23], v[32:35], v[88:91], v[20:23]
  ds_read_b128 v[88:91], v9 offset:6144
  ds_read_b128 v[32:35], v1 offset:16384
  v_mfma_f32_16x16x32_bf16 v[20:23], v[36:39], v[92:95], v[20:23]
  ds_read_b128 v[92:95], v9 offset:7168
  ds_read_b128 v[36:39], v2 offset:16384
  s_waitcnt lgkmcnt(7)
  v_mfma_f32_16x16x32_bf16 v[20:23], v[40:43], v[80:83], v[20:23]
  ds_read_b128 v[40:43], v1 offset:24576
  ds_read_b32 v0, v9 offset:14348
  s_waitcnt lgkmcnt(7)
  v_mfma_f32_16x16x32_bf16 v[20:23], v[44:47], v[84:87], v[20:23]
  ds_read_b128 v[44:47], v2 offset:24576
  s_waitcnt lgkmcnt(1)
  v_sub_f32 v16, v16, v0
  v_mfma_f32_16x16x32_bf16 v[20:23], v[48:51], v[88:91], v[20:23]
  v_sub_f32 v17, v17, v0
  v_sub_f32 v18, v18, v0
  v_mfma_f32_16x16x32_bf16 v[20:23], v[52:55], v[92:95], v[20:23]
  v_sub_f32 v19, v19, v0
  v_exp_f32 v16, v16
  v_exp_f32 v17, v17
  v_exp_f32 v18, v18
  v_exp_f32 v19, v19
  v_add_f32 v13, v13, v16
  v_add_f32 v13, v13, v17
  v_add_f32 v13, v13, v18
  v_add_f32 v13, v13, v19
  v_cvt_pk_bf16_f32 v78, v16, v17
  v_cvt_pk_bf16_f32 v79, v18, v19
  v_mfma_f32_16x16x32_bf16 v[16:19], v[56:59], v[128:131], 0
  v_mfma_f32_16x16x32_bf16 v[16:19], v[60:63], v[132:135], v[16:19]
  v_mfma_f32_16x16x32_bf16 v[16:19], v[24:27], v[136:139], v[16:19]
  ds_read_b32 v15, v9 offset:15360
  s_waitcnt lgkmcnt(0)
  v_sub_f32 v20, v20, v15
  v_mfma_f32_16x16x32_bf16 v[16:19], v[28:31], v[140:143], v[16:19]
  v_sub_f32 v21, v21, v15
  v_sub_f32 v22, v22, v15
  v_mfma_f32_16x16x32_bf16 v[16:19], v[32:35], v[144:147], v[16:19]
  v_sub_f32 v23, v23, v15
  v_mfma_f32_16x16x32_bf16 v[16:19], v[36:39], v[148:151], v[16:19]
  v_exp_f32 v20, v20
  v_mfma_f32_16x16x32_bf16 v[16:19], v[40:43], v[152:155], v[16:19]
  v_exp_f32 v21, v21
  v_mfma_f32_16x16x32_bf16 v[16:19], v[44:47], v[156:159], v[16:19]
  v_exp_f32 v22, v22
  v_exp_f32 v23, v23
  v_add_f32 v14, v14, v20
  v_add_f32 v14, v14, v21
  v_add_f32 v14, v14, v22
  v_add_f32 v14, v14, v23
  v_cvt_pk_bf16_f32 v20, v20, v21
  v_cvt_pk_bf16_f32 v21, v22, v23
  ds_write_b64 v9, v[20:21] offset:9224
  v_mfma_f32_16x16x32_bf16 v[20:23], v[56:59], v[160:163], 0
  ds_read_b128 v[48:51], v1 offset:2048
  v_mfma_f32_16x16x32_bf16 v[20:23], v[60:63], v[164:167], v[20:23]
  ds_read_b128 v[52:55], v2 offset:2048
  v_mfma_f32_16x16x32_bf16 v[20:23], v[24:27], v[168:171], v[20:23]
  ds_read_b32 v0, v9 offset:14336
  s_waitcnt lgkmcnt(0)
  v_sub_f32 v16, v16, v0
  v_mfma_f32_16x16x32_bf16 v[20:23], v[28:31], v[172:175], v[20:23]
  v_sub_f32 v17, v17, v0
  v_sub_f32 v18, v18, v0
  v_mfma_f32_16x16x32_bf16 v[20:23], v[32:35], v[176:179], v[20:23]
  v_sub_f32 v19, v19, v0
  v_mfma_f32_16x16x32_bf16 v[20:23], v[36:39], v[180:183], v[20:23]
  v_exp_f32 v16, v16
  v_mfma_f32_16x16x32_bf16 v[20:23], v[40:43], v[184:187], v[20:23]
  v_exp_f32 v17, v17
  v_mfma_f32_16x16x32_bf16 v[20:23], v[44:47], v[188:191], v[20:23]
  v_exp_f32 v18, v18
  v_exp_f32 v19, v19
  v_add_f32 v10, v10, v16
  v_add_f32 v10, v10, v17
  v_add_f32 v10, v10, v18
  v_add_f32 v10, v10, v19
  v_cvt_pk_bf16_f32 v80, v16, v17
  v_cvt_pk_bf16_f32 v81, v18, v19
  v_mfma_f32_16x16x32_bf16 v[16:19], v[56:59], v[192:195], 0
  s_waitcnt vmcnt(8)
  s_barrier
  v_mfma_f32_16x16x32_bf16 v[16:19], v[60:63], v[196:199], v[16:19]
  s_add_u32 m0, s33, 0
  s_add_u32 s34, s31, 0
  buffer_load_dwordx4 v8, s[12:15], s34 offen nt lds
  v_mfma_f32_16x16x32_bf16 v[16:19], v[24:27], v[200:203], v[16:19]
  ds_read_b32 v15, v9 offset:14340
  s_waitcnt lgkmcnt(0)
  v_sub_f32 v20, v20, v15
  v_mfma_f32_16x16x32_bf16 v[16:19], v[28:31], v[204:207], v[16:19]
  v_sub_f32 v21, v21, v15
  v_sub_f32 v22, v22, v15
  v_mfma_f32_16x16x32_bf16 v[16:19], v[32:35], v[208:211], v[16:19]
  v_sub_f32 v23, v23, v15
  v_mfma_f32_16x16x32_bf16 v[16:19], v[36:39], v[212:215], v[16:19]
  v_exp_f32 v20, v20
  v_mfma_f32_16x16x32_bf16 v[16:19], v[40:43], v[216:219], v[16:19]
  s_add_u32 m0, s33, 1024
  s_add_u32 s34, s31, 4096
  buffer_load_dwordx4 v8, s[12:15], s34 offen nt lds
  v_mfma_f32_16x16x32_bf16 v[16:19], v[44:47], v[220:223], v[16:19]
  v_exp_f32 v21, v21
  v_exp_f32 v22, v22
  v_exp_f32 v23, v23
  v_add_f32 v11, v11, v20
  v_add_f32 v11, v11, v21
  v_add_f32 v11, v11, v22
  v_add_f32 v11, v11, v23
  v_cvt_pk_bf16_f32 v84, v20, v21
  v_cvt_pk_bf16_f32 v85, v22, v23
  v_mfma_f32_16x16x32_bf16 v[20:23], v[56:59], v[224:227], 0
  ds_read_b128 v[56:59], v1 offset:10240
  v_mfma_f32_16x16x32_bf16 v[20:23], v[60:63], v[228:231], v[20:23]
  ds_read_b128 v[60:63], v2 offset:10240
  v_mfma_f32_16x16x32_bf16 v[20:23], v[24:27], v[232:235], v[20:23]
  ds_read_b128 v[24:27], v1 offset:18432
  ds_read_b32 v0, v9 offset:14344
  v_mfma_f32_16x16x32_bf16 v[20:23], v[28:31], v[236:239], v[20:23]
  s_add_u32 m0, s33, 2048
  s_add_u32 s34, s31, 8192
  buffer_load_dwordx4 v8, s[12:15], s34 offen nt lds
  v_mfma_f32_16x16x32_bf16 v[20:23], v[32:35], v[240:243], v[20:23]
  ds_read_b128 v[28:31], v2 offset:18432
  ds_read_b128 v[32:35], v1 offset:26624
  v_mfma_f32_16x16x32_bf16 v[20:23], v[36:39], v[244:247], v[20:23]
  ds_read_b128 v[36:39], v2 offset:26624
  s_waitcnt lgkmcnt(3)
  v_sub_f32 v16, v16, v0
  v_mfma_f32_16x16x32_bf16 v[20:23], v[40:43], v[248:251], v[20:23]
  v_sub_f32 v17, v17, v0
  v_sub_f32 v18, v18, v0
  v_mfma_f32_16x16x32_bf16 v[20:23], v[44:47], v[252:255], v[20:23]
  v_sub_f32 v19, v19, v0
  v_exp_f32 v16, v16
  v_exp_f32 v17, v17
  v_exp_f32 v18, v18
  v_exp_f32 v19, v19
  v_add_f32 v12, v12, v16
  v_add_f32 v12, v12, v17
  v_add_f32 v12, v12, v18
  v_add_f32 v12, v12, v19
  v_cvt_pk_bf16_f32 v88, v16, v17
  v_cvt_pk_bf16_f32 v89, v18, v19
  v_mfma_f32_16x16x32_bf16 v[16:19], v[48:51], v[128:131], 0
  s_add_u32 m0, s33, 3072
  s_add_u32 s34, s31, 12288
  buffer_load_dwordx4 v8, s[12:15], s34 offen nt lds
  v_mfma_f32_16x16x32_bf16 v[16:19], v[52:55], v[132:135], v[16:19]
  v_mfma_f32_16x16x32_bf16 v[16:19], v[56:59], v[136:139], v[16:19]
  ds_read_b32 v15, v9 offset:14348
  s_waitcnt lgkmcnt(0)
  v_sub_f32 v20, v20, v15
  v_mfma_f32_16x16x32_bf16 v[16:19], v[60:63], v[140:143], v[16:19]
  v_sub_f32 v21, v21, v15
  v_sub_f32 v22, v22, v15
  v_mfma_f32_16x16x32_bf16 v[16:19], v[24:27], v[144:147], v[16:19]
  v_sub_f32 v23, v23, v15
  v_mfma_f32_16x16x32_bf16 v[16:19], v[28:31], v[148:151], v[16:19]
  s_add_u32 m0, s33, 4096
  s_add_u32 s34, s31, 16384
  buffer_load_dwordx4 v8, s[12:15], s34 offen nt lds
  v_mfma_f32_16x16x32_bf16 v[16:19], v[32:35], v[152:155], v[16:19]
  v_exp_f32 v20, v20
  v_mfma_f32_16x16x32_bf16 v[16:19], v[36:39], v[156:159], v[16:19]
  v_exp_f32 v21, v21
  v_exp_f32 v22, v22
  v_exp_f32 v23, v23
  v_add_f32 v13, v13, v20
  v_add_f32 v13, v13, v21
  v_add_f32 v13, v13, v22
  v_add_f32 v13, v13, v23
  v_cvt_pk_bf16_f32 v92, v20, v21
  v_cvt_pk_bf16_f32 v93, v22, v23
  v_mfma_f32_16x16x32_bf16 v[20:23], v[48:51], v[160:163], 0
  ds_read_b64_tr_b16 v[40:41], v3 offset:4096
  ds_read_b64_tr_b16 v[42:43], v3 offset:6144
  v_mfma_f32_16x16x32_bf16 v[20:23], v[52:55], v[164:167], v[20:23]
  ds_read_b64_tr_b16 v[44:45], v3 offset:0
  ds_read_b64_tr_b16 v[46:47], v3 offset:2048
  v_mfma_f32_16x16x32_bf16 v[20:23], v[56:59], v[168:171], v[20:23]
  s_add_u32 m0, s33, 5120
  s_add_u32 s34, s31, 20480
  buffer_load_dwordx4 v8, s[12:15], s34 offen nt lds
  v_mfma_f32_16x16x32_bf16 v[20:23], v[60:63], v[172:175], v[20:23]
  ds_read_b32 v0, v9 offset:14336
  s_waitcnt lgkmcnt(0)
  v_sub_f32 v16, v16, v0
  v_mfma_f32_16x16x32_bf16 v[20:23], v[24:27], v[176:179], v[20:23]
  v_sub_f32 v17, v17, v0
  v_sub_f32 v18, v18, v0
  v_mfma_f32_16x16x32_bf16 v[20:23], v[28:31], v[180:183], v[20:23]
  v_sub_f32 v19, v19, v0
  v_mfma_f32_16x16x32_bf16 v[20:23], v[32:35], v[184:187], v[20:23]
  v_exp_f32 v16, v16
  v_mfma_f32_16x16x32_bf16 v[20:23], v[36:39], v[188:191], v[20:23]
  v_exp_f32 v17, v17
  v_exp_f32 v18, v18
  v_exp_f32 v19, v19
  v_add_f32 v10, v10, v16
  v_add_f32 v10, v10, v17
  v_add_f32 v10, v10, v18
  v_add_f32 v10, v10, v19
  v_cvt_pk_bf16_f32 v82, v16, v17
  v_cvt_pk_bf16_f32 v83, v18, v19
  s_add_u32 m0, s33, 6144
  s_add_u32 s34, s31, 24576
  buffer_load_dwordx4 v8, s[12:15], s34 offen nt lds
  v_mfma_f32_16x16x32_bf16 v[16:19], v[48:51], v[192:195], 0
  v_mfma_f32_16x16x32_bf16 v[16:19], v[52:55], v[196:199], v[16:19]
  v_mfma_f32_16x16x32_bf16 v[16:19], v[56:59], v[200:203], v[16:19]
  ds_read_b32 v15, v9 offset:14340
  s_waitcnt lgkmcnt(0)
  v_sub_f32 v20, v20, v15
  v_mfma_f32_16x16x32_bf16 v[16:19], v[60:63], v[204:207], v[16:19]
  v_sub_f32 v21, v21, v15
  v_sub_f32 v22, v22, v15
  v_mfma_f32_16x16x32_bf16 v[16:19], v[24:27], v[208:211], v[16:19]
  s_add_u32 m0, s33, 7168
  s_add_u32 s34, s31, 28672
  buffer_load_dwordx4 v8, s[12:15], s34 offen nt lds
  s_add_u32 s31, s31, 32768
  s_xor_b32 s33, s33, 65536
  v_mfma_f32_16x16x32_bf16 v[16:19], v[28:31], v[212:215], v[16:19]
  v_sub_f32 v23, v23, v15
  v_mfma_f32_16x16x32_bf16 v[16:19], v[32:35], v[216:219], v[16:19]
  v_exp_f32 v20, v20
  v_mfma_f32_16x16x32_bf16 v[16:19], v[36:39], v[220:223], v[16:19]
  v_exp_f32 v21, v21
  v_exp_f32 v22, v22
  v_exp_f32 v23, v23
  v_add_f32 v11, v11, v20
  v_add_f32 v11, v11, v21
  v_add_f32 v11, v11, v22
  v_add_f32 v11, v11, v23
  v_cvt_pk_bf16_f32 v86, v20, v21
  v_cvt_pk_bf16_f32 v87, v22, v23
  v_mfma_f32_16x16x32_bf16 v[20:23], v[48:51], v[224:227], 0
  ds_read_b64_tr_b16 v[48:49], v4 offset:4096
  ds_read_b64_tr_b16 v[50:51], v4 offset:6144
  v_mfma_f32_16x16x32_bf16 v[20:23], v[52:55], v[228:231], v[20:23]
  ds_read_b64_tr_b16 v[52:53], v4 offset:0
  ds_read_b64_tr_b16 v[54:55], v4 offset:2048
  v_mfma_f32_16x16x32_bf16 v[20:23], v[56:59], v[232:235], v[20:23]
  ds_read_b32 v0, v9 offset:14344
  s_waitcnt lgkmcnt(0)
  v_sub_f32 v16, v16, v0
  v_mfma_f32_16x16x32_bf16 v[20:23], v[60:63], v[236:239], v[20:23]
  v_sub_f32 v17, v17, v0
  v_sub_f32 v18, v18, v0
  v_mfma_f32_16x16x32_bf16 v[20:23], v[24:27], v[240:243], v[20:23]
  v_sub_f32 v19, v19, v0
  v_mfma_f32_16x16x32_bf16 v[20:23], v[28:31], v[244:247], v[20:23]
  v_exp_f32 v16, v16
  v_mfma_f32_16x16x32_bf16 v[20:23], v[32:35], v[248:251], v[20:23]
  v_exp_f32 v17, v17
  v_mfma_f32_16x16x32_bf16 v[20:23], v[36:39], v[252:255], v[20:23]
  v_exp_f32 v18, v18
  v_exp_f32 v19, v19
  v_add_f32 v12, v12, v16
  v_add_f32 v12, v12, v17
  v_add_f32 v12, v12, v18
  v_add_f32 v12, v12, v19
  v_cvt_pk_bf16_f32 v90, v16, v17
  v_cvt_pk_bf16_f32 v91, v18, v19
  ds_read_b64_tr_b16 v[56:57], v5 offset:4096
  ds_read_b64_tr_b16 v[58:59], v5 offset:6144
  ds_read_b64_tr_b16 v[60:61], v5 offset:0
  ds_read_b64_tr_b16 v[62:63], v5 offset:2048
  v_mfma_f32_16x16x32_bf16 a[0:3], v[40:43], v[64:67], 0
  v_mfma_f32_16x16x32_bf16 a[0:3], v[44:47], v[80:83], a[0:3]
  ds_read_b32 v15, v9 offset:14348
  s_waitcnt lgkmcnt(0)
  v_sub_f32 v20, v20, v15
  v_mfma_f32_16x16x32_bf16 a[64:67], v[40:43], v[68:71], 0
  v_sub_f32 v21, v21, v15
  v_sub_f32 v22, v22, v15
  v_mfma_f32_16x16x32_bf16 a[64:67], v[44:47], v[84:87], a[64:67]
  v_sub_f32 v23, v23, v15
  v_mfma_f32_16x16x32_bf16 a[128:131], v[40:43], v[72:75], 0
  v_exp_f32 v20, v20
  v_mfma_f32_16x16x32_bf16 a[128:131], v[44:47], v[88:91], a[128:131]
  v_exp_f32 v21, v21
  v_mfma_f32_16x16x32_bf16 a[192:195], v[40:43], v[76:79], 0
  v_exp_f32 v22, v22
  v_exp_f32 v23, v23
  v_add_f32 v13, v13, v20
  v_add_f32 v13, v13, v21
  v_add_f32 v13, v13, v22
  v_add_f32 v13, v13, v23
  v_cvt_pk_bf16_f32 v94, v20, v21
  v_cvt_pk_bf16_f32 v95, v22, v23
  s_nop 1
  v_mfma_f32_16x16x32_bf16 a[192:195], v[44:47], v[92:95], a[192:195]
  ds_read_b64_tr_b16 v[24:25], v6 offset:4096
  ds_read_b64_tr_b16 v[26:27], v6 offset:6144
  v_mfma_f32_16x16x32_bf16 a[4:7], v[48:51], v[64:67], 0
  ds_read_b64_tr_b16 v[28:29], v6 offset:0
  ds_read_b64_tr_b16 v[30:31], v6 offset:2048
  v_mfma_f32_16x16x32_bf16 a[4:7], v[52:55], v[80:83], a[4:7]
  v_xor_b32 v1, 65536, v1
  v_xor_b32 v2, 65536, v2
  v_mfma_f32_16x16x32_bf16 a[68:71], v[48:51], v[68:71], 0
  v_mfma_f32_16x16x32_bf16 a[68:71], v[52:55], v[84:87], a[68:71]
  v_mfma_f32_16x16x32_bf16 a[132:135], v[48:51], v[72:75], 0
  ds_read_b128 v[16:19], v9 offset:9216
  ds_read_b128 v[20:23], v9 offset:8192
  v_mfma_f32_16x16x32_bf16 a[132:135], v[52:55], v[88:91], a[132:135]
  v_mfma_f32_16x16x32_bf16 a[196:199], v[48:51], v[76:79], 0
  v_mfma_f32_16x16x32_bf16 a[196:199], v[52:55], v[92:95], a[196:199]
  ds_read_b64_tr_b16 v[32:33], v3 offset:12288
  ds_read_b64_tr_b16 v[34:35], v3 offset:14336
  v_mfma_f32_16x16x32_bf16 a[8:11], v[56:59], v[64:67], 0
  ds_read_b64_tr_b16 v[36:37], v3 offset:8192
  ds_read_b64_tr_b16 v[38:39], v3 offset:10240
  v_mfma_f32_16x16x32_bf16 a[8:11], v[60:63], v[80:83], a[8:11]
  v_mfma_f32_16x16x32_bf16 a[72:75], v[56:59], v[68:71], 0
  v_mfma_f32_16x16x32_bf16 a[72:75], v[60:63], v[84:87], a[72:75]
  v_mfma_f32_16x16x32_bf16 a[136:139], v[56:59], v[72:75], 0
  v_mfma_f32_16x16x32_bf16 a[136:139], v[60:63], v[88:91], a[136:139]
  v_mfma_f32_16x16x32_bf16 a[200:203], v[56:59], v[76:79], 0
  v_mfma_f32_16x16x32_bf16 a[200:203], v[60:63], v[92:95], a[200:203]
  ds_read_b64_tr_b16 v[48:49], v4 offset:12288
  ds_read_b64_tr_b16 v[50:51], v4 offset:14336
  s_waitcnt lgkmcnt(10)
  v_mfma_f32_16x16x32_bf16 a[12:15], v[24:27], v[64:67], 0
  ds_read_b64_tr_b16 v[52:53], v4 offset:8192
  ds_read_b64_tr_b16 v[54:55], v4 offset:10240
  s_waitcnt lgkmcnt(10)
  v_mfma_f32_16x16x32_bf16 a[12:15], v[28:31], v[80:83], a[12:15]
  v_mfma_f32_16x16x32_bf16 a[76:79], v[24:27], v[68:71], 0
  v_mfma_f32_16x16x32_bf16 a[76:79], v[28:31], v[84:87], a[76:79]
  v_mfma_f32_16x16x32_bf16 a[140:143], v[24:27], v[72:75], 0
  v_mfma_f32_16x16x32_bf16 a[140:143], v[28:31], v[88:91], a[140:143]
  v_mfma_f32_16x16x32_bf16 a[204:207], v[24:27], v[76:79], 0
  v_mfma_f32_16x16x32_bf16 a[204:207], v[28:31], v[92:95], a[204:207]
  ds_read_b64_tr_b16 v[56:57], v5 offset:12288
  ds_read_b64_tr_b16 v[58:59], v5 offset:14336
  s_waitcnt lgkmcnt(8)
  v_mfma_f32_16x16x32_bf16 a[16:19], v[32:35], v[64:67], 0
  ds_read_b64_tr_b16 v[60:61], v5 offset:8192
  ds_read_b64_tr_b16 v[62:63], v5 offset:10240
  s_waitcnt lgkmcnt(8)
  v_mfma_f32_16x16x32_bf16 a[16:19], v[36:39], v[80:83], a[16:19]
  v_mfma_f32_16x16x32_bf16 a[80:83], v[32:35], v[68:71], 0
  v_mfma_f32_16x16x32_bf16 a[80:83], v[36:39], v[84:87], a[80:83]
  v_mfma_f32_16x16x32_bf16 a[144:147], v[32:35], v[72:75], 0
  v_mfma_f32_16x16x32_bf16 a[144:147], v[36:39], v[88:91], a[144:147]
  v_mfma_f32_16x16x32_bf16 a[208:211], v[32:35], v[76:79], 0
  v_mfma_f32_16x16x32_bf16 a[208:211], v[36:39], v[92:95], a[208:211]
  ds_read_b64_tr_b16 v[40:41], v6 offset:12288
  ds_read_b64_tr_b16 v[42:43], v6 offset:14336
  s_waitcnt lgkmcnt(8)
  v_mfma_f32_16x16x32_bf16 a[20:23], v[48:51], v[64:67], 0
  ds_read_b64_tr_b16 v[44:45], v6 offset:8192
  ds_read_b64_tr_b16 v[46:47], v6 offset:10240
  s_waitcnt lgkmcnt(8)
  v_mfma_f32_16x16x32_bf16 a[20:23], v[52:55], v[80:83], a[20:23]
  v_mfma_f32_16x16x32_bf16 a[84:87], v[48:51], v[68:71], 0
  v_mfma_f32_16x16x32_bf16 a[84:87], v[52:55], v[84:87], a[84:87]
  v_mfma_f32_16x16x32_bf16 a[148:151], v[48:51], v[72:75], 0
  v_mfma_f32_16x16x32_bf16 a[148:151], v[52:55], v[88:91], a[148:151]
  v_mfma_f32_16x16x32_bf16 a[212:215], v[48:51], v[76:79], 0
  v_mfma_f32_16x16x32_bf16 a[212:215], v[52:55], v[92:95], a[212:215]
  ds_read_b64_tr_b16 v[24:25], v3 offset:20480
  ds_read_b64_tr_b16 v[26:27], v3 offset:22528
  s_waitcnt lgkmcnt(8)
  v_mfma_f32_16x16x32_bf16 a[24:27], v[56:59], v[64:67], 0
  ds_read_b64_tr_b16 v[28:29], v3 offset:16384
  ds_read_b64_tr_b16 v[30:31], v3 offset:18432
  s_waitcnt lgkmcnt(8)
  v_mfma_f32_16x16x32_bf16 a[24:27], v[60:63], v[80:83], a[24:27]
  v_mfma_f32_16x16x32_bf16 a[88:91], v[56:59], v[68:71], 0
  v_mfma_f32_16x16x32_bf16 a[88:91], v[60:63], v[84:87], a[88:91]
  v_mfma_f32_16x16x32_bf16 a[152:155], v[56:59], v[72:75], 0
  v_mfma_f32_16x16x32_bf16 a[152:155], v[60:63], v[88:91], a[152:155]
  v_mfma_f32_16x16x32_bf16 a[216:219], v[56:59], v[76:79], 0
  v_mfma_f32_16x16x32_bf16 a[216:219], v[60:63], v[92:95], a[216:219]
  ds_read_b64_tr_b16 v[48:49], v4 offset:20480
  ds_read_b64_tr_b16 v[50:51], v4 offset:22528
  s_waitcnt lgkmcnt(8)
  v_mfma_f32_16x16x32_bf16 a[28:31], v[40:43], v[64:67], 0
  ds_read_b64_tr_b16 v[52:53], v4 offset:16384
  ds_read_b64_tr_b16 v[54:55], v4 offset:18432
  s_waitcnt lgkmcnt(8)
  v_mfma_f32_16x16x32_bf16 a[28:31], v[44:47], v[80:83], a[28:31]
  v_mfma_f32_16x16x32_bf16 a[92:95], v[40:43], v[68:71], 0
  v_mfma_f32_16x16x32_bf16 a[92:95], v[44:47], v[84:87], a[92:95]
  v_mfma_f32_16x16x32_bf16 a[156:159], v[40:43], v[72:75], 0
  v_mfma_f32_16x16x32_bf16 a[156:159], v[44:47], v[88:91], a[156:159]
  v_mfma_f32_16x16x32_bf16 a[220:223], v[40:43], v[76:79], 0
  v_mfma_f32_16x16x32_bf16 a[220:223], v[44:47], v[92:95], a[220:223]
  ds_read_b64_tr_b16 v[56:57], v5 offset:20480
  ds_read_b64_tr_b16 v[58:59], v5 offset:22528
  s_waitcnt lgkmcnt(8)
  v_mfma_f32_16x16x32_bf16 a[32:35], v[24:27], v[64:67], 0
  ds_read_b64_tr_b16 v[60:61], v5 offset:16384
  ds_read_b64_tr_b16 v[62:63], v5 offset:18432
  s_waitcnt lgkmcnt(8)
  v_mfma_f32_16x16x32_bf16 a[32:35], v[28:31], v[80:83], a[32:35]
  v_mfma_f32_16x16x32_bf16 a[96:99], v[24:27], v[68:71], 0
  v_mfma_f32_16x16x32_bf16 a[96:99], v[28:31], v[84:87], a[96:99]
  v_mfma_f32_16x16x32_bf16 a[160:163], v[24:27], v[72:75], 0
  v_mfma_f32_16x16x32_bf16 a[160:163], v[28:31], v[88:91], a[160:163]
  v_mfma_f32_16x16x32_bf16 a[224:227], v[24:27], v[76:79], 0
  v_mfma_f32_16x16x32_bf16 a[224:227], v[28:31], v[92:95], a[224:227]
  v_mfma_f32_16x16x32_bf16 v[96:99], v[24:27], v[16:19], 0
  v_mfma_f32_16x16x32_bf16 v[96:99], v[28:31], v[20:23], v[96:99]
  ds_read_b64_tr_b16 v[32:33], v6 offset:20480
  ds_read_b64_tr_b16 v[34:35], v6 offset:22528
  s_waitcnt lgkmcnt(8)
  v_mfma_f32_16x16x32_bf16 a[36:39], v[48:51], v[64:67], 0
  ds_read_b64_tr_b16 v[36:37], v6 offset:16384
  ds_read_b64_tr_b16 v[38:39], v6 offset:18432
  s_waitcnt lgkmcnt(8)
  v_mfma_f32_16x16x32_bf16 a[36:39], v[52:55], v[80:83], a[36:39]
  v_mfma_f32_16x16x32_bf16 a[100:103], v[48:51], v[68:71], 0
  v_mfma_f32_16x16x32_bf16 a[100:103], v[52:55], v[84:87], a[100:103]
  v_mfma_f32_16x16x32_bf16 a[164:167], v[48:51], v[72:75], 0
  v_mfma_f32_16x16x32_bf16 a[164:167], v[52:55], v[88:91], a[164:167]
  v_mfma_f32_16x16x32_bf16 a[228:231], v[48:51], v[76:79], 0
  v_mfma_f32_16x16x32_bf16 a[228:231], v[52:55], v[92:95], a[228:231]
  v_mfma_f32_16x16x32_bf16 v[100:103], v[48:51], v[16:19], 0
  v_mfma_f32_16x16x32_bf16 v[100:103], v[52:55], v[20:23], v[100:103]
  ds_read_b64_tr_b16 v[40:41], v3 offset:28672
  ds_read_b64_tr_b16 v[42:43], v3 offset:30720
  s_waitcnt lgkmcnt(8)
  v_mfma_f32_16x16x32_bf16 a[40:43], v[56:59], v[64:67], 0
  ds_read_b64_tr_b16 v[44:45], v3 offset:24576
  ds_read_b64_tr_b16 v[46:47], v3 offset:26624
  s_waitcnt lgkmcnt(8)
  v_mfma_f32_16x16x32_bf16 a[40:43], v[60:63], v[80:83], a[40:43]
  v_mfma_f32_16x16x32_bf16 a[104:107], v[56:59], v[68:71], 0
  v_mfma_f32_16x16x32_bf16 a[104:107], v[60:63], v[84:87], a[104:107]
  v_mfma_f32_16x16x32_bf16 a[168:171], v[56:59], v[72:75], 0
  v_mfma_f32_16x16x32_bf16 a[168:171], v[60:63], v[88:91], a[168:171]
  v_mfma_f32_16x16x32_bf16 a[232:235], v[56:59], v[76:79], 0
  v_mfma_f32_16x16x32_bf16 a[232:235], v[60:63], v[92:95], a[232:235]
  v_mfma_f32_16x16x32_bf16 v[104:107], v[56:59], v[16:19], 0
  v_mfma_f32_16x16x32_bf16 v[104:107], v[60:63], v[20:23], v[104:107]
  ds_read_b64_tr_b16 v[48:49], v4 offset:28672
  ds_read_b64_tr_b16 v[50:51], v4 offset:30720
  s_waitcnt lgkmcnt(8)
  v_mfma_f32_16x16x32_bf16 a[44:47], v[32:35], v[64:67], 0
  s_waitcnt vmcnt(8)
  s_barrier
  ds_read_b64_tr_b16 v[52:53], v4 offset:24576
  s_waitcnt lgkmcnt(7)
  v_mfma_f32_16x16x32_bf16 a[44:47], v[36:39], v[80:83], a[44:47]
  s_add_u32 m0, s32, 0
  s_add_u32 s34, s30, 0
  buffer_load_dwordx4 v7, s[8:11], s34 offen nt lds
  v_mfma_f32_16x16x32_bf16 a[108:111], v[32:35], v[68:71], 0
  ds_read_b64_tr_b16 v[54:55], v4 offset:26624
  v_mfma_f32_16x16x32_bf16 a[108:111], v[36:39], v[84:87], a[108:111]
  v_mfma_f32_16x16x32_bf16 a[172:175], v[32:35], v[72:75], 0
  v_mfma_f32_16x16x32_bf16 a[172:175], v[36:39], v[88:91], a[172:175]
  v_mfma_f32_16x16x32_bf16 a[236:239], v[32:35], v[76:79], 0
  v_mfma_f32_16x16x32_bf16 a[236:239], v[36:39], v[92:95], a[236:239]
  s_add_u32 m0, s32, 1024
  s_add_u32 s34, s30, 4096
  buffer_load_dwordx4 v7, s[8:11], s34 offen nt lds
  v_mfma_f32_16x16x32_bf16 v[108:111], v[32:35], v[16:19], 0
  v_mfma_f32_16x16x32_bf16 v[108:111], v[36:39], v[20:23], v[108:111]
  ds_read_b64_tr_b16 v[56:57], v5 offset:28672
  ds_read_b64_tr_b16 v[58:59], v5 offset:30720
  s_waitcnt lgkmcnt(8)
  v_mfma_f32_16x16x32_bf16 a[48:51], v[40:43], v[64:67], 0
  ds_read_b64_tr_b16 v[60:61], v5 offset:24576
  ds_read_b64_tr_b16 v[62:63], v5 offset:26624
  s_waitcnt lgkmcnt(8)
  v_mfma_f32_16x16x32_bf16 a[48:51], v[44:47], v[80:83], a[48:51]
  ds_read_b128 v[32:35], v1 offset:4096
  ds_read_b128 v[36:39], v2 offset:4096
  v_mfma_f32_16x16x32_bf16 a[112:115], v[40:43], v[68:71], 0
  v_mfma_f32_16x16x32_bf16 a[112:115], v[44:47], v[84:87], a[112:115]
  s_add_u32 m0, s32, 2048
  s_add_u32 s34, s30, 8192
  buffer_load_dwordx4 v7, s[8:11], s34 offen nt lds
  v_mfma_f32_16x16x32_bf16 a[176:179], v[40:43], v[72:75], 0
  v_mfma_f32_16x16x32_bf16 a[176:179], v[44:47], v[88:91], a[176:179]
  v_mfma_f32_16x16x32_bf16 a[240:243], v[40:43], v[76:79], 0
  v_mfma_f32_16x16x32_bf16 a[240:243], v[44:47], v[92:95], a[240:243]
  v_mfma_f32_16x16x32_bf16 v[112:115], v[40:43], v[16:19], 0
  v_mfma_f32_16x16x32_bf16 v[112:115], v[44:47], v[20:23], v[112:115]
  s_add_u32 m0, s32, 3072
  s_add_u32 s34, s30, 12288
  buffer_load_dwordx4 v7, s[8:11], s34 offen nt lds
  s_waitcnt lgkmcnt(8)
  v_mfma_f32_16x16x32_bf16 a[52:55], v[48:51], v[64:67], 0
  ds_read_b64_tr_b16 v[24:25], v6 offset:28672
  ds_read_b64_tr_b16 v[26:27], v6 offset:30720
  s_waitcnt lgkmcnt(8)
  v_mfma_f32_16x16x32_bf16 a[52:55], v[52:55], v[80:83], a[52:55]
  ds_read_b64_tr_b16 v[28:29], v6 offset:24576
  ds_read_b64_tr_b16 v[30:31], v6 offset:26624
  v_mfma_f32_16x16x32_bf16 a[116:119], v[48:51], v[68:71], 0
  ds_read_b128 v[40:43], v1 offset:12288
  ds_read_b128 v[44:47], v2 offset:12288
  v_mfma_f32_16x16x32_bf16 a[116:119], v[52:55], v[84:87], a[116:119]
  v_mfma_f32_16x16x32_bf16 a[180:183], v[48:51], v[72:75], 0
  v_mfma_f32_16x16x32_bf16 a[180:183], v[52:55], v[88:91], a[180:183]
  s_add_u32 m0, s32, 4096
  s_add_u32 s34, s30, 16384
  buffer_load_dwordx4 v7, s[8:11], s34 offen nt lds
  v_mfma_f32_16x16x32_bf16 a[244:247], v[48:51], v[76:79], 0
  v_mfma_f32_16x16x32_bf16 a[244:247], v[52:55], v[92:95], a[244:247]
  v_mfma_f32_16x16x32_bf16 v[116:119], v[48:51], v[16:19], 0
  v_mfma_f32_16x16x32_bf16 v[116:119], v[52:55], v[20:23], v[116:119]
  ds_read_b128 v[48:51], v1 offset:20480
  ds_read_b128 v[52:55], v2 offset:20480
  s_waitcnt lgkmcnt(12)
  v_mfma_f32_16x16x32_bf16 a[56:59], v[56:59], v[64:67], 0
  s_waitcnt lgkmcnt(10)
  v_mfma_f32_16x16x32_bf16 a[56:59], v[60:63], v[80:83], a[56:59]
  s_add_u32 m0, s32, 5120
  s_add_u32 s34, s30, 20480
  buffer_load_dwordx4 v7, s[8:11], s34 offen nt lds
  v_mfma_f32_16x16x32_bf16 a[120:123], v[56:59], v[68:71], 0
  v_mfma_f32_16x16x32_bf16 a[120:123], v[60:63], v[84:87], a[120:123]
  v_mfma_f32_16x16x32_bf16 a[184:187], v[56:59], v[72:75], 0
  v_mfma_f32_16x16x32_bf16 a[184:187], v[60:63], v[88:91], a[184:187]
  v_mfma_f32_16x16x32_bf16 a[248:251], v[56:59], v[76:79], 0
  v_mfma_f32_16x16x32_bf16 a[248:251], v[60:63], v[92:95], a[248:251]
  s_add_u32 m0, s32, 6144
  s_add_u32 s34, s30, 24576
  buffer_load_dwordx4 v7, s[8:11], s34 offen nt lds
  v_mfma_f32_16x16x32_bf16 v[120:123], v[56:59], v[16:19], 0
  v_mfma_f32_16x16x32_bf16 v[120:123], v[60:63], v[20:23], v[120:123]
  ds_read_b128 v[56:59], v1 offset:28672
  ds_read_b128 v[60:63], v2 offset:28672
  s_waitcnt lgkmcnt(8)
  v_mfma_f32_16x16x32_bf16 a[60:63], v[24:27], v[64:67], 0
  s_waitcnt lgkmcnt(6)
  v_mfma_f32_16x16x32_bf16 a[60:63], v[28:31], v[80:83], a[60:63]
  v_mfma_f32_16x16x32_bf16 a[124:127], v[24:27], v[68:71], 0
  v_mfma_f32_16x16x32_bf16 a[124:127], v[28:31], v[84:87], a[124:127]
  s_add_u32 m0, s32, 7168
  s_add_u32 s34, s30, 28672
  buffer_load_dwordx4 v7, s[8:11], s34 offen nt lds
  s_add_u32 s30, s30, 32768
  s_xor_b32 s32, s32, 65536
  v_mfma_f32_16x16x32_bf16 a[188:191], v[24:27], v[72:75], 0
  v_mfma_f32_16x16x32_bf16 a[188:191], v[28:31], v[88:91], a[188:191]
  v_mfma_f32_16x16x32_bf16 a[252:255], v[24:27], v[76:79], 0
  v_mfma_f32_16x16x32_bf16 a[252:255], v[28:31], v[92:95], a[252:255]
  v_mfma_f32_16x16x32_bf16 v[124:127], v[24:27], v[16:19], 0
  v_mfma_f32_16x16x32_bf16 v[124:127], v[28:31], v[20:23], v[124:127]
  s_mov_b32 s29, 15
  s_nop 9
K1_SLOOP_P1:
  v_mfma_f32_16x16x32_bf16 v[16:19], v[32:35], v[128:131], 0
  ds_read_b128 v[80:83], v9 offset:0
  ds_read_b128 v[84:87], v9 offset:1024
  v_mfma_f32_16x16x32_bf16 v[16:19], v[36:39], v[132:135], v[16:19]
  ds_read_b128 v[88:91], v9 offset:2048
  ds_read_b128 v[92:95], v9 offset:3072
  s_waitcnt lgkmcnt(9)
  v_mfma_f32_16x16x32_bf16 v[16:19], v[40:43], v[136:139], v[16:19]
  v_xor_b32 v3, 65536, v3
  v_xor_b32 v4, 65536, v4
  s_waitcnt lgkmcnt(8)
  v_mfma_f32_16x16x32_bf16 v[16:19], v[44:47], v[140:143], v[16:19]
  v_xor_b32 v5, 65536, v5
  v_xor_b32 v6, 65536, v6
  s_waitcnt lgkmcnt(7)
  v_mfma_f32_16x16x32_bf16 v[16:19], v[48:51], v[144:147], v[16:19]
  s_waitcnt lgkmcnt(6)
  v_mfma_f32_16x16x32_bf16 v[16:19], v[52:55], v[148:151], v[16:19]
  s_waitcnt lgkmcnt(5)
  v_mfma_f32_16x16x32_bf16 v[16:19], v[56:59], v[152:155], v[16:19]
  s_waitcnt lgkmcnt(4)
  v_mfma_f32_16x16x32_bf16 v[16:19], v[60:63], v[156:159], v[16:19]
  v_mfma_f32_16x16x32_bf16 v[20:23], v[32:35], v[160:163], 0
  ds_read_b128 v[24:27], v1 offset:6144
  v_mfma_f32_16x16x32_bf16 v[20:23], v[36:39], v[164:167], v[20:23]
  ds_read_b128 v[28:31], v2 offset:6144
  v_mfma_f32_16x16x32_bf16 v[20:23], v[40:43], v[168:171], v[20:23]
  ds_read_b32 v0, v9 offset:14336
  s_waitcnt lgkmcnt(0)
  s_nop 0
  v_sub_f32 v16, v16, v0
  v_mfma_f32_16x16x32_bf16 v[20:23], v[44:47], v[172:175], v[20:23]
  v_sub_f32 v17, v17, v0
  v_sub_f32 v18, v18, v0
  v_mfma_f32_16x16x32_bf16 v[20:23], v[48:51], v[176:179], v[20:23]
  v_sub_f32 v19, v19, v0
  v_mfma_f32_16x16x32_bf16 v[20:23], v[52:55], v[180:183], v[20:23]
  v_exp_f32 v16, v16
  v_mfma_f32_16x16x32_bf16 v[20:23], v[56:59], v[184:187], v[20:23]
  v_exp_f32 v17, v17
  v_mfma_f32_16x16x32_bf16 v[20:23], v[60:63], v[188:191], v[20:23]
  v_exp_f32 v18, v18
  v_exp_f32 v19, v19
  v_add_f32 v10, v10, v16
  v_add_f32 v10, v10, v17
  v_add_f32 v10, v10, v18
  v_add_f32 v10, v10, v19
  v_cvt_pk_bf16_f32 v64, v16, v17
  v_cvt_pk_bf16_f32 v65, v18, v19
  v_mfma_f32_16x16x32_bf16 v[16:19], v[32:35], v[192:195], 0
  v_mfma_f32_16x16x32_bf16 v[16:19], v[36:39], v[196:199], v[16:19]
  v_mfma_f32_16x16x32_bf16 v[16:19], v[40:43], v[200:203], v[16:19]
  ds_read_b32 v15, v9 offset:14340
  s_waitcnt lgkmcnt(0)
  v_sub_f32 v20, v20, v15
  v_mfma_f32_16x16x32_bf16 v[16:19], v[44:47], v[204:207], v[16:19]
  v_sub_f32 v21, v21, v15
  v_sub_f32 v22, v22, v15
  v_mfma_f32_16x16x32_bf16 v[16:19], v[48:51], v[208:211], v[16:19]
  v_sub_f32 v23, v23, v15
  v_mfma_f32_16x16x32_bf16 v[16:19], v[52:55], v[212:215], v[16:19]
  v_exp_f32 v20, v20
  v_mfma_f32_16x16x32_bf16 v[16:19], v[56:59], v[216:219], v[16:19]
  v_exp_f32 v21, v21
  v_mfma_f32_16x16x32_bf16 v[16:19], v[60:63], v[220:223], v[16:19]
  v_exp_f32 v22, v22
  v_exp_f32 v23, v23
  v_add_f32 v11, v11, v20
  v_add_f32 v11, v11, v21
  v_add_f32 v11, v11, v22
  v_add_f32 v11, v11, v23
  v_cvt_pk_bf16_f32 v68, v20, v21
  v_cvt_pk_bf16_f32 v69, v22, v23
  v_mfma_f32_16x16x32_bf16 v[20:23], v[32:35], v[224:227], 0
  v_mfma_f32_16x16x32_bf16 v[20:23], v[36:39], v[228:231], v[20:23]
  v_mfma_f32_16x16x32_bf16 v[20:23], v[40:43], v[232:235], v[20:23]
  ds_read_b32 v0, v9 offset:14344
  s_waitcnt lgkmcnt(0)
  v_sub_f32 v16, v16, v0
  v_mfma_f32_16x16x32_bf16 v[20:23], v[44:47], v[236:239], v[20:23]
  v_sub_f32 v17, v17, v0
  v_sub_f32 v18, v18, v0
  v_mfma_f32_16x16x32_bf16 v[20:23], v[48:51], v[240:243], v[20:23]
  v_sub_f32 v19, v19, v0
  v_mfma_f32_16x16x32_bf16 v[20:23], v[52:55], v[244:247], v[20:23]
  v_exp_f32 v16, v16
  v_mfma_f32_16x16x32_bf16 v[20:23], v[56:59], v[248:251], v[20:23]
  v_exp_f32 v17, v17
  v_mfma_f32_16x16x32_bf16 v[20:23], v[60:63], v[252:255], v[20:23]
  v_exp_f32 v18, v18
  v_exp_f32 v19, v19
  v_add_f32 v12, v12, v16
  v_add_f32 v12, v12, v17
  v_add_f32 v12, v12, v18
  v_add_f32 v12, v12, v19
  v_cvt_pk_bf16_f32 v72, v16, v17
  v_cvt_pk_bf16_f32 v73, v18, v19
  v_mfma_f32_16x16x32_bf16 v[16:19], v[32:35], v[80:83], 0
  ds_read_b128 v[80:83], v9 offset:4096
  ds_read_b128 v[32:35], v1 offset:14336
  v_mfma_f32_16x16x32_bf16 v[16:19], v[36:39], v[84:87], v[16:19]
  ds_read_b128 v[84:87], v9 offset:5120
  ds_read_b128 v[36:39], v2 offset:14336
  v_mfma_f32_16x16x32_bf16 v[16:19], v[40:43], v[88:91], v[16:19]
  ds_read_b128 v[88:91], v9 offset:6144
  ds_read_b128 v[40:43], v1 offset:22528
  v_mfma_f32_16x16x32_bf16 v[16:19], v[44:47], v[92:95], v[16:19]
  ds_read_b128 v[92:95], v9 offset:7168
  ds_read_b128 v[44:47], v2 offset:22528
  s_waitcnt lgkmcnt(7)
  v_mfma_f32_16x16x32_bf16 v[16:19], v[48:51], v[80:83], v[16:19]
  ds_read_b128 v[48:51], v1 offset:30720
  ds_read_b32 v15, v9 offset:14348
  s_waitcnt lgkmcnt(7)
  v_mfma_f32_16x16x32_bf16 v[16:19], v[52:55], v[84:87], v[16:19]
  ds_read_b128 v[52:55], v2 offset:30720
  s_waitcnt lgkmcnt(1)
  v_sub_f32 v20, v20, v15
  v_mfma_f32_16x16x32_bf16 v[16:19], v[56:59], v[88:91], v[16:19]
  v_sub_f32 v21, v21, v15
  v_sub_f32 v22, v22, v15
  v_mfma_f32_16x16x32_bf16 v[16:19], v[60:63], v[92:95], v[16:19]
  v_sub_f32 v23, v23, v15
  v_exp_f32 v20, v20
  v_exp_f32 v21, v21
  v_exp_f32 v22, v22
  v_exp_f32 v23, v23
  v_add_f32 v13, v13, v20
  v_add_f32 v13, v13, v21
  v_add_f32 v13, v13, v22
  v_add_f32 v13, v13, v23
  v_cvt_pk_bf16_f32 v76, v20, v21
  v_cvt_pk_bf16_f32 v77, v22, v23
  v_mfma_f32_16x16x32_bf16 v[20:23], v[24:27], v[128:131], 0
  ds_read_b128 v[80:83], v9 offset:0
  ds_read_b128 v[84:87], v9 offset:1024
  v_mfma_f32_16x16x32_bf16 v[20:23], v[28:31], v[132:135], v[20:23]
  ds_read_b128 v[88:91], v9 offset:2048
  ds_read_b128 v[92:95], v9 offset:3072
  v_mfma_f32_16x16x32_bf16 v[20:23], v[32:35], v[136:139], v[20:23]
  ds_read_b32 v0, v9 offset:15360
  s_waitcnt lgkmcnt(0)
  v_sub_f32 v16, v16, v0
  v_mfma_f32_16x16x32_bf16 v[20:23], v[36:39], v[140:143], v[20:23]
  v_sub_f32 v17, v17, v0
  v_sub_f32 v18, v18, v0
  v_mfma_f32_16x16x32_bf16 v[20:23], v[40:43], v[144:147], v[20:23]
  v_sub_f32 v19, v19, v0
  v_mfma_f32_16x16x32_bf16 v[20:23], v[44:47], v[148:151], v[20:23]
  v_exp_f32 v16, v16
  v_mfma_f32_16x16x32_bf16 v[20:23], v[48:51], v[152:155], v[20:23]
  v_exp_f32 v17, v17
  v_mfma_f32_16x16x32_bf16 v[20:23], v[52:55], v[156:159], v[20:23]
  v_exp_f32 v18, v18
  v_exp_f32 v19, v19
  v_add_f32 v14, v14, v16
  v_add_f32 v14, v14, v17
  v_add_f32 v14, v14, v18
  v_add_f32 v14, v14, v19
  v_cvt_pk_bf16_f32 v16, v16, v17
  v_cvt_pk_bf16_f32 v17, v18, v19
  ds_write_b64 v9, v[16:17] offset:9216
  v_mfma_f32_16x16x32_bf16 v[16:19], v[24:27], v[160:163], 0
  ds_read_b128 v[56:59], v1 offset:0
  v_mfma_f32_16x16x32_bf16 v[16:19], v[28:31], v[164:167], v[16:19]
  ds_read_b128 v[60:63], v2 offset:0
  v_mfma_f32_16x16x32_bf16 v[16:19], v[32:35], v[168:171], v[16:19]
  ds_read_b32 v15, v9 offset:14336
  s_waitcnt lgkmcnt(0)
  v_sub_f32 v20, v20, v15
  v_mfma_f32_16x16x32_bf16 v[16:19], v[36:39], v[172:175], v[16:19]
  v_sub_f32 v21, v21, v15
  v_sub_f32 v22, v22, v15
  v_mfma_f32_16x16x32_bf16 v[16:19], v[40:43], v[176:179], v[16:19]
  v_sub_f32 v23, v23, v15
  v_mfma_f32_16x16x32_bf16 v[16:19], v[44:47], v[180:183], v[16:19]
  v_exp_f32 v20, v20
  v_mfma_f32_16x16x32_bf16 v[16:19], v[48:51], v[184:187], v[16:19]
  v_exp_f32 v21, v21
  v_mfma_f32_16x16x32_bf16 v[16:19], v[52:55], v[188:191], v[16:19]
  v_exp_f32 v22, v22
  v_exp_f32 v23, v23
  v_add_f32 v10, v10, v20
  v_add_f32 v10, v10, v21
  v_add_f32 v10, v10, v22
  v_add_f32 v10, v10, v23
  v_cvt_pk_bf16_f32 v66, v20, v21
  v_cvt_pk_bf16_f32 v67, v22, v23
  v_mfma_f32_16x16x32_bf16 v[20:23], v[24:27], v[192:195], 0
  v_mfma_f32_16x16x32_bf16 v[20:23], v[28:31], v[196:199], v[20:23]
  v_mfma_f32_16x16x32_bf16 v[20:23], v[32:35], v[200:203], v[20:23]
  ds_read_b32 v0, v9 offset:14340
  s_waitcnt lgkmcnt(0)
  v_sub_f32 v16, v16, v0
  v_mfma_f32_16x16x32_bf16 v[20:23], v[36:39], v[204:207], v[20:23]
  v_sub_f32 v17, v17, v0
  v_sub_f32 v18, v18, v0
  v_mfma_f32_16x16x32_bf16 v[20:23], v[40:43], v[208:211], v[20:23]
  v_sub_f32 v19, v19, v0
  v_mfma_f32_16x16x32_bf16 v[20:23], v[44:47], v[212:215], v[20:23]
  v_exp_f32 v16, v16
  v_mfma_f32_16x16x32_bf16 v[20:23], v[48:51], v[216:219], v[20:23]
  v_exp_f32 v17, v17
  v_mfma_f32_16x16x32_bf16 v[20:23], v[52:55], v[220:223], v[20:23]
  v_exp_f32 v18, v18
  v_exp_f32 v19, v19
  v_add_f32 v11, v11, v16
  v_add_f32 v11, v11, v17
  v_add_f32 v11, v11, v18
  v_add_f32 v11, v11, v19
  v_cvt_pk_bf16_f32 v70, v16, v17
  v_cvt_pk_bf16_f32 v71, v18, v19
  v_mfma_f32_16x16x32_bf16 v[16:19], v[24:27], v[224:227], 0
  v_mfma_f32_16x16x32_bf16 v[16:19], v[28:31], v[228:231], v[16:19]
  v_mfma_f32_16x16x32_bf16 v[16:19], v[32:35], v[232:235], v[16:19]
  ds_read_b32 v15, v9 offset:14344
  s_waitcnt lgkmcnt(0)
  v_sub_f32 v20, v20, v15
  v_mfma_f32_16x16x32_bf16 v[16:19], v[36:39], v[236:239], v[16:19]
  v_sub_f32 v21, v21, v15
  v_sub_f32 v22, v22, v15
  v_mfma_f32_16x16x32_bf16 v[16:19], v[40:43], v[240:243], v[16:19]
  v_sub_f32 v23, v23, v15
  v_mfma_f32_16x16x32_bf16 v[16:19], v[44:47], v[244:247], v[16:19]
  v_exp_f32 v20, v20
  v_mfma_f32_16x16x32_bf16 v[16:19], v[48:51], v[248:251], v[16:19]
  v_exp_f32 v21, v21
  v_mfma_f32_16x16x32_bf16 v[16:19], v[52:55], v[252:255], v[16:19]
  v_exp_f32 v22, v22
  v_exp_f32 v23, v23
  v_add_f32 v12, v12, v20
  v_add_f32 v12, v12, v21
  v_add_f32 v12, v12, v22
  v_add_f32 v12, v12, v23
  v_cvt_pk_bf16_f32 v74, v20, v21
  v_cvt_pk_bf16_f32 v75, v22, v23
  v_mfma_f32_16x16x32_bf16 v[20:23], v[24:27], v[80:83], 0
  ds_read_b128 v[80:83], v9 offset:4096
  ds_read_b128 v[24:27], v1 offset:8192
  v_mfma_f32_16x16x32_bf16 v[20:23], v[28:31], v[84:87], v[20:23]
  ds_read_b128 v[84:87], v9 offset:5120
  ds_read_b128 v[28:31], v2 offset:8192
  v_mfma_f32_16x16x32_bf16 v[20:23], v[32:35], v[88:91], v[20:23]
  ds_read_b128 v[88:91], v9 offset:6144
  ds_read_b128 v[32:35], v1 offset:16384
  v_mfma_f32_16x16x32_bf16 v[20:23], v[36:39], v[92:95], v[20:23]
  ds_read_b128 v[92:95], v9 offset:7168
  ds_read_b128 v[36:39], v2 offset:16384
  s_waitcnt lgkmcnt(7)
  v_mfma_f32_16x16x32_bf16 v[20:23], v[40:43], v[80:83], v[20:23]
  ds_read_b128 v[40:43], v1 offset:24576
  ds_read_b32 v0, v9 offset:14348
  s_waitcnt lgkmcnt(7)
  v_mfma_f32_16x16x32_bf16 v[20:23], v[44:47], v[84:87], v[20:23]
  ds_read_b128 v[44:47], v2 offset:24576
  s_waitcnt lgkmcnt(1)
  v_sub_f32 v16, v16, v0
  v_mfma_f32_16x16x32_bf16 v[20:23], v[48:51], v[88:91], v[20:23]
  v_sub_f32 v17, v17, v0
  v_sub_f32 v18, v18, v0
  v_mfma_f32_16x16x32_bf16 v[20:23], v[52:55], v[92:95], v[20:23]
  v_sub_f32 v19, v19, v0
  v_exp_f32 v16, v16
  v_exp_f32 v17, v17
  v_exp_f32 v18, v18
  v_exp_f32 v19, v19
  v_add_f32 v13, v13, v16
  v_add_f32 v13, v13, v17
  v_add_f32 v13, v13, v18
  v_add_f32 v13, v13, v19
  v_cvt_pk_bf16_f32 v78, v16, v17
  v_cvt_pk_bf16_f32 v79, v18, v19
  v_mfma_f32_16x16x32_bf16 v[16:19], v[56:59], v[128:131], 0
  v_mfma_f32_16x16x32_bf16 v[16:19], v[60:63], v[132:135], v[16:19]
  v_mfma_f32_16x16x32_bf16 v[16:19], v[24:27], v[136:139], v[16:19]
  ds_read_b32 v15, v9 offset:15360
  s_waitcnt lgkmcnt(0)
  v_sub_f32 v20, v20, v15
  v_mfma_f32_16x16x32_bf16 v[16:19], v[28:31], v[140:143], v[16:19]
  v_sub_f32 v21, v21, v15
  v_sub_f32 v22, v22, v15
  v_mfma_f32_16x16x32_bf16 v[16:19], v[32:35], v[144:147], v[16:19]
  v_sub_f32 v23, v23, v15
  v_mfma_f32_16x16x32_bf16 v[16:19], v[36:39], v[148:151], v[16:19]
  v_exp_f32 v20, v20
  v_mfma_f32_16x16x32_bf16 v[16:19], v[40:43], v[152:155], v[16:19]
  v_exp_f32 v21, v21
  v_mfma_f32_16x16x32_bf16 v[16:19], v[44:47], v[156:159], v[16:19]
  v_exp_f32 v22, v22
  v_exp_f32 v23, v23
  v_add_f32 v14, v14, v20
  v_add_f32 v14, v14, v21
  v_add_f32 v14, v14, v22
  v_add_f32 v14, v14, v23
  v_cvt_pk_bf16_f32 v20, v20, v21
  v_cvt_pk_bf16_f32 v21, v22, v23
  ds_write_b64 v9, v[20:21] offset:9224
  v_mfma_f32_16x16x32_bf16 v[20:23], v[56:59], v[160:163], 0
  ds_read_b128 v[48:51], v1 offset:2048
  v_mfma_f32_16x16x32_bf16 v[20:23], v[60:63], v[164:167], v[20:23]
  ds_read_b128 v[52:55], v2 offset:2048
  v_mfma_f32_16x16x32_bf16 v[20:23], v[24:27], v[168:171], v[20:23]
  ds_read_b32 v0, v9 offset:14336
  s_waitcnt lgkmcnt(0)
  v_sub_f32 v16, v16, v0
  v_mfma_f32_16x16x32_bf16 v[20:23], v[28:31], v[172:175], v[20:23]
  v_sub_f32 v17, v17, v0
  v_sub_f32 v18, v18, v0
  v_mfma_f32_16x16x32_bf16 v[20:23], v[32:35], v[176:179], v[20:23]
  v_sub_f32 v19, v19, v0
  v_mfma_f32_16x16x32_bf16 v[20:23], v[36:39], v[180:183], v[20:23]
  v_exp_f32 v16, v16
  v_mfma_f32_16x16x32_bf16 v[20:23], v[40:43], v[184:187], v[20:23]
  v_exp_f32 v17, v17
  v_mfma_f32_16x16x32_bf16 v[20:23], v[44:47], v[188:191], v[20:23]
  v_exp_f32 v18, v18
  v_exp_f32 v19, v19
  v_add_f32 v10, v10, v16
  v_add_f32 v10, v10, v17
  v_add_f32 v10, v10, v18
  v_add_f32 v10, v10, v19
  v_cvt_pk_bf16_f32 v80, v16, v17
  v_cvt_pk_bf16_f32 v81, v18, v19
  v_mfma_f32_16x16x32_bf16 v[16:19], v[56:59], v[192:195], 0
  s_waitcnt vmcnt(8)
  s_barrier
  v_mfma_f32_16x16x32_bf16 v[16:19], v[60:63], v[196:199], v[16:19]
  s_add_u32 m0, s33, 0
  s_add_u32 s34, s31, 0
  buffer_load_dwordx4 v8, s[12:15], s34 offen nt lds
  v_mfma_f32_16x16x32_bf16 v[16:19], v[24:27], v[200:203], v[16:19]
  ds_read_b32 v15, v9 offset:14340
  s_waitcnt lgkmcnt(0)
  v_sub_f32 v20, v20, v15
  v_mfma_f32_16x16x32_bf16 v[16:19], v[28:31], v[204:207], v[16:19]
  v_sub_f32 v21, v21, v15
  v_sub_f32 v22, v22, v15
  v_mfma_f32_16x16x32_bf16 v[16:19], v[32:35], v[208:211], v[16:19]
  v_sub_f32 v23, v23, v15
  v_mfma_f32_16x16x32_bf16 v[16:19], v[36:39], v[212:215], v[16:19]
  v_exp_f32 v20, v20
  v_mfma_f32_16x16x32_bf16 v[16:19], v[40:43], v[216:219], v[16:19]
  s_add_u32 m0, s33, 1024
  s_add_u32 s34, s31, 4096
  buffer_load_dwordx4 v8, s[12:15], s34 offen nt lds
  v_mfma_f32_16x16x32_bf16 v[16:19], v[44:47], v[220:223], v[16:19]
  v_exp_f32 v21, v21
  v_exp_f32 v22, v22
  v_exp_f32 v23, v23
  v_add_f32 v11, v11, v20
  v_add_f32 v11, v11, v21
  v_add_f32 v11, v11, v22
  v_add_f32 v11, v11, v23
  v_cvt_pk_bf16_f32 v84, v20, v21
  v_cvt_pk_bf16_f32 v85, v22, v23
  v_mfma_f32_16x16x32_bf16 v[20:23], v[56:59], v[224:227], 0
  ds_read_b128 v[56:59], v1 offset:10240
  v_mfma_f32_16x16x32_bf16 v[20:23], v[60:63], v[228:231], v[20:23]
  ds_read_b128 v[60:63], v2 offset:10240
  v_mfma_f32_16x16x32_bf16 v[20:23], v[24:27], v[232:235], v[20:23]
  ds_read_b128 v[24:27], v1 offset:18432
  ds_read_b32 v0, v9 offset:14344
  v_mfma_f32_16x16x32_bf16 v[20:23], v[28:31], v[236:239], v[20:23]
  s_add_u32 m0, s33, 2048
  s_add_u32 s34, s31, 8192
  buffer_load_dwordx4 v8, s[12:15], s34 offen nt lds
  v_mfma_f32_16x16x32_bf16 v[20:23], v[32:35], v[240:243], v[20:23]
  ds_read_b128 v[28:31], v2 offset:18432
  ds_read_b128 v[32:35], v1 offset:26624
  v_mfma_f32_16x16x32_bf16 v[20:23], v[36:39], v[244:247], v[20:23]
  ds_read_b128 v[36:39], v2 offset:26624
  s_waitcnt lgkmcnt(3)
  v_sub_f32 v16, v16, v0
  v_mfma_f32_16x16x32_bf16 v[20:23], v[40:43], v[248:251], v[20:23]
  v_sub_f32 v17, v17, v0
  v_sub_f32 v18, v18, v0
  v_mfma_f32_16x16x32_bf16 v[20:23], v[44:47], v[252:255], v[20:23]
  v_sub_f32 v19, v19, v0
  v_exp_f32 v16, v16
  v_exp_f32 v17, v17
  v_exp_f32 v18, v18
  v_exp_f32 v19, v19
  v_add_f32 v12, v12, v16
  v_add_f32 v12, v12, v17
  v_add_f32 v12, v12, v18
  v_add_f32 v12, v12, v19
  v_cvt_pk_bf16_f32 v88, v16, v17
  v_cvt_pk_bf16_f32 v89, v18, v19
  v_mfma_f32_16x16x32_bf16 v[16:19], v[48:51], v[128:131], 0
  s_add_u32 m0, s33, 3072
  s_add_u32 s34, s31, 12288
  buffer_load_dwordx4 v8, s[12:15], s34 offen nt lds
  v_mfma_f32_16x16x32_bf16 v[16:19], v[52:55], v[132:135], v[16:19]
  v_mfma_f32_16x16x32_bf16 v[16:19], v[56:59], v[136:139], v[16:19]
  ds_read_b32 v15, v9 offset:14348
  s_waitcnt lgkmcnt(0)
  v_sub_f32 v20, v20, v15
  v_mfma_f32_16x16x32_bf16 v[16:19], v[60:63], v[140:143], v[16:19]
  v_sub_f32 v21, v21, v15
  v_sub_f32 v22, v22, v15
  v_mfma_f32_16x16x32_bf16 v[16:19], v[24:27], v[144:147], v[16:19]
  v_sub_f32 v23, v23, v15
  v_mfma_f32_16x16x32_bf16 v[16:19], v[28:31], v[148:151], v[16:19]
  s_add_u32 m0, s33, 4096
  s_add_u32 s34, s31, 16384
  buffer_load_dwordx4 v8, s[12:15], s34 offen nt lds
  v_mfma_f32_16x16x32_bf16 v[16:19], v[32:35], v[152:155], v[16:19]
  v_exp_f32 v20, v20
  v_mfma_f32_16x16x32_bf16 v[16:19], v[36:39], v[156:159], v[16:19]
  v_exp_f32 v21, v21
  v_exp_f32 v22, v22
  v_exp_f32 v23, v23
  v_add_f32 v13, v13, v20
  v_add_f32 v13, v13, v21
  v_add_f32 v13, v13, v22
  v_add_f32 v13, v13, v23
  v_cvt_pk_bf16_f32 v92, v20, v21
  v_cvt_pk_bf16_f32 v93, v22, v23
  v_mfma_f32_16x16x32_bf16 v[20:23], v[48:51], v[160:163], 0
  ds_read_b64_tr_b16 v[40:41], v3 offset:4096
  ds_read_b64_tr_b16 v[42:43], v3 offset:6144
  v_mfma_f32_16x16x32_bf16 v[20:23], v[52:55], v[164:167], v[20:23]
  ds_read_b64_tr_b16 v[44:45], v3 offset:0
  ds_read_b64_tr_b16 v[46:47], v3 offset:2048
  v_mfma_f32_16x16x32_bf16 v[20:23], v[56:59], v[168:171], v[20:23]
  s_add_u32 m0, s33, 5120
  s_add_u32 s34, s31, 20480
  buffer_load_dwordx4 v8, s[12:15], s34 offen nt lds
  v_mfma_f32_16x16x32_bf16 v[20:23], v[60:63], v[172:175], v[20:23]
  ds_read_b32 v0, v9 offset:14336
  s_waitcnt lgkmcnt(0)
  v_sub_f32 v16, v16, v0
  v_mfma_f32_16x16x32_bf16 v[20:23], v[24:27], v[176:179], v[20:23]
  v_sub_f32 v17, v17, v0
  v_sub_f32 v18, v18, v0
  v_mfma_f32_16x16x32_bf16 v[20:23], v[28:31], v[180:183], v[20:23]
  v_sub_f32 v19, v19, v0
  v_mfma_f32_16x16x32_bf16 v[20:23], v[32:35], v[184:187], v[20:23]
  v_exp_f32 v16, v16
  v_mfma_f32_16x16x32_bf16 v[20:23], v[36:39], v[188:191], v[20:23]
  v_exp_f32 v17, v17
  v_exp_f32 v18, v18
  v_exp_f32 v19, v19
  v_add_f32 v10, v10, v16
  v_add_f32 v10, v10, v17
  v_add_f32 v10, v10, v18
  v_add_f32 v10, v10, v19
  v_cvt_pk_bf16_f32 v82, v16, v17
  v_cvt_pk_bf16_f32 v83, v18, v19
  s_add_u32 m0, s33, 6144
  s_add_u32 s34, s31, 24576
  buffer_load_dwordx4 v8, s[12:15], s34 offen nt lds
  v_mfma_f32_16x16x32_bf16 v[16:19], v[48:51], v[192:195], 0
  v_mfma_f32_16x16x32_bf16 v[16:19], v[52:55], v[196:199], v[16:19]
  v_mfma_f32_16x16x32_bf16 v[16:19], v[56:59], v[200:203], v[16:19]
  ds_read_b32 v15, v9 offset:14340
  s_waitcnt lgkmcnt(0)
  v_sub_f32 v20, v20, v15
  v_mfma_f32_16x16x32_bf16 v[16:19], v[60:63], v[204:207], v[16:19]
  v_sub_f32 v21, v21, v15
  v_sub_f32 v22, v22, v15
  v_mfma_f32_16x16x32_bf16 v[16:19], v[24:27], v[208:211], v[16:19]
  s_add_u32 m0, s33, 7168
  s_add_u32 s34, s31, 28672
  buffer_load_dwordx4 v8, s[12:15], s34 offen nt lds
  s_add_u32 s31, s31, 32768
  s_xor_b32 s33, s33, 65536
  v_mfma_f32_16x16x32_bf16 v[16:19], v[28:31], v[212:215], v[16:19]
  v_sub_f32 v23, v23, v15
  v_mfma_f32_16x16x32_bf16 v[16:19], v[32:35], v[216:219], v[16:19]
  v_exp_f32 v20, v20
  v_mfma_f32_16x16x32_bf16 v[16:19], v[36:39], v[220:223], v[16:19]
  v_exp_f32 v21, v21
  v_exp_f32 v22, v22
  v_exp_f32 v23, v23
  v_add_f32 v11, v11, v20
  v_add_f32 v11, v11, v21
  v_add_f32 v11, v11, v22
  v_add_f32 v11, v11, v23
  v_cvt_pk_bf16_f32 v86, v20, v21
  v_cvt_pk_bf16_f32 v87, v22, v23
  v_mfma_f32_16x16x32_bf16 v[20:23], v[48:51], v[224:227], 0
  ds_read_b64_tr_b16 v[48:49], v4 offset:4096
  ds_read_b64_tr_b16 v[50:51], v4 offset:6144
  v_mfma_f32_16x16x32_bf16 v[20:23], v[52:55], v[228:231], v[20:23]
  ds_read_b64_tr_b16 v[52:53], v4 offset:0
  ds_read_b64_tr_b16 v[54:55], v4 offset:2048
  v_mfma_f32_16x16x32_bf16 v[20:23], v[56:59], v[232:235], v[20:23]
  ds_read_b32 v0, v9 offset:14344
  s_waitcnt lgkmcnt(0)
  v_sub_f32 v16, v16, v0
  v_mfma_f32_16x16x32_bf16 v[20:23], v[60:63], v[236:239], v[20:23]
  v_sub_f32 v17, v17, v0
  v_sub_f32 v18, v18, v0
  v_mfma_f32_16x16x32_bf16 v[20:23], v[24:27], v[240:243], v[20:23]
  v_sub_f32 v19, v19, v0
  v_mfma_f32_16x16x32_bf16 v[20:23], v[28:31], v[244:247], v[20:23]
  v_exp_f32 v16, v16
  v_mfma_f32_16x16x32_bf16 v[20:23], v[32:35], v[248:251], v[20:23]
  v_exp_f32 v17, v17
  v_mfma_f32_16x16x32_bf16 v[20:23], v[36:39], v[252:255], v[20:23]
  v_exp_f32 v18, v18
  v_exp_f32 v19, v19
  v_add_f32 v12, v12, v16
  v_add_f32 v12, v12, v17
  v_add_f32 v12, v12, v18
  v_add_f32 v12, v12, v19
  v_cvt_pk_bf16_f32 v90, v16, v17
  v_cvt_pk_bf16_f32 v91, v18, v19
  ds_read_b64_tr_b16 v[56:57], v5 offset:4096
  ds_read_b64_tr_b16 v[58:59], v5 offset:6144
  ds_read_b64_tr_b16 v[60:61], v5 offset:0
  ds_read_b64_tr_b16 v[62:63], v5 offset:2048
  v_mfma_f32_16x16x32_bf16 a[0:3], v[40:43], v[64:67], a[0:3]
  v_mfma_f32_16x16x32_bf16 a[0:3], v[44:47], v[80:83], a[0:3]
  ds_read_b32 v15, v9 offset:14348
  s_waitcnt lgkmcnt(0)
  v_sub_f32 v20, v20, v15
  v_mfma_f32_16x16x32_bf16 a[64:67], v[40:43], v[68:71], a[64:67]
  v_sub_f32 v21, v21, v15
  v_sub_f32 v22, v22, v15
  v_mfma_f32_16x16x32_bf16 a[64:67], v[44:47], v[84:87], a[64:67]
  v_sub_f32 v23, v23, v15
  v_mfma_f32_16x16x32_bf16 a[128:131], v[40:43], v[72:75], a[128:131]
  v_exp_f32 v20, v20
  v_mfma_f32_16x16x32_bf16 a[128:131], v[44:47], v[88:91], a[128:131]
  v_exp_f32 v21, v21
  v_mfma_f32_16x16x32_bf16 a[192:195], v[40:43], v[76:79], a[192:195]
  v_exp_f32 v22, v22
  v_exp_f32 v23, v23
  v_add_f32 v13, v13, v20
  v_add_f32 v13, v13, v21
  v_add_f32 v13, v13, v22
  v_add_f32 v13, v13, v23
  v_cvt_pk_bf16_f32 v94, v20, v21
  v_cvt_pk_bf16_f32 v95, v22, v23
  s_nop 1
  v_mfma_f32_16x16x32_bf16 a[192:195], v[44:47], v[92:95], a[192:195]
  ds_read_b64_tr_b16 v[24:25], v6 offset:4096
  ds_read_b64_tr_b16 v[26:27], v6 offset:6144
  v_mfma_f32_16x16x32_bf16 a[4:7], v[48:51], v[64:67], a[4:7]
  ds_read_b64_tr_b16 v[28:29], v6 offset:0
  ds_read_b64_tr_b16 v[30:31], v6 offset:2048
  v_mfma_f32_16x16x32_bf16 a[4:7], v[52:55], v[80:83], a[4:7]
  v_xor_b32 v1, 65536, v1
  v_xor_b32 v2, 65536, v2
  v_mfma_f32_16x16x32_bf16 a[68:71], v[48:51], v[68:71], a[68:71]
  v_mfma_f32_16x16x32_bf16 a[68:71], v[52:55], v[84:87], a[68:71]
  v_mfma_f32_16x16x32_bf16 a[132:135], v[48:51], v[72:75], a[132:135]
  ds_read_b128 v[16:19], v9 offset:9216
  ds_read_b128 v[20:23], v9 offset:8192
  v_mfma_f32_16x16x32_bf16 a[132:135], v[52:55], v[88:91], a[132:135]
  v_mfma_f32_16x16x32_bf16 a[196:199], v[48:51], v[76:79], a[196:199]
  v_mfma_f32_16x16x32_bf16 a[196:199], v[52:55], v[92:95], a[196:199]
  ds_read_b64_tr_b16 v[32:33], v3 offset:12288
  ds_read_b64_tr_b16 v[34:35], v3 offset:14336
  v_mfma_f32_16x16x32_bf16 a[8:11], v[56:59], v[64:67], a[8:11]
  ds_read_b64_tr_b16 v[36:37], v3 offset:8192
  ds_read_b64_tr_b16 v[38:39], v3 offset:10240
  v_mfma_f32_16x16x32_bf16 a[8:11], v[60:63], v[80:83], a[8:11]
  v_mfma_f32_16x16x32_bf16 a[72:75], v[56:59], v[68:71], a[72:75]
  v_mfma_f32_16x16x32_bf16 a[72:75], v[60:63], v[84:87], a[72:75]
  v_mfma_f32_16x16x32_bf16 a[136:139], v[56:59], v[72:75], a[136:139]
  v_mfma_f32_16x16x32_bf16 a[136:139], v[60:63], v[88:91], a[136:139]
  v_mfma_f32_16x16x32_bf16 a[200:203], v[56:59], v[76:79], a[200:203]
  v_mfma_f32_16x16x32_bf16 a[200:203], v[60:63], v[92:95], a[200:203]
  ds_read_b64_tr_b16 v[48:49], v4 offset:12288
  ds_read_b64_tr_b16 v[50:51], v4 offset:14336
  s_waitcnt lgkmcnt(10)
  v_mfma_f32_16x16x32_bf16 a[12:15], v[24:27], v[64:67], a[12:15]
  ds_read_b64_tr_b16 v[52:53], v4 offset:8192
  ds_read_b64_tr_b16 v[54:55], v4 offset:10240
  s_waitcnt lgkmcnt(10)
  v_mfma_f32_16x16x32_bf16 a[12:15], v[28:31], v[80:83], a[12:15]
  v_mfma_f32_16x16x32_bf16 a[76:79], v[24:27], v[68:71], a[76:79]
  v_mfma_f32_16x16x32_bf16 a[76:79], v[28:31], v[84:87], a[76:79]
  v_mfma_f32_16x16x32_bf16 a[140:143], v[24:27], v[72:75], a[140:143]
  v_mfma_f32_16x16x32_bf16 a[140:143], v[28:31], v[88:91], a[140:143]
  v_mfma_f32_16x16x32_bf16 a[204:207], v[24:27], v[76:79], a[204:207]
  v_mfma_f32_16x16x32_bf16 a[204:207], v[28:31], v[92:95], a[204:207]
  ds_read_b64_tr_b16 v[56:57], v5 offset:12288
  ds_read_b64_tr_b16 v[58:59], v5 offset:14336
  s_waitcnt lgkmcnt(8)
  v_mfma_f32_16x16x32_bf16 a[16:19], v[32:35], v[64:67], a[16:19]
  ds_read_b64_tr_b16 v[60:61], v5 offset:8192
  ds_read_b64_tr_b16 v[62:63], v5 offset:10240
  s_waitcnt lgkmcnt(8)
  v_mfma_f32_16x16x32_bf16 a[16:19], v[36:39], v[80:83], a[16:19]
  v_mfma_f32_16x16x32_bf16 a[80:83], v[32:35], v[68:71], a[80:83]
  v_mfma_f32_16x16x32_bf16 a[80:83], v[36:39], v[84:87], a[80:83]
  v_mfma_f32_16x16x32_bf16 a[144:147], v[32:35], v[72:75], a[144:147]
  v_mfma_f32_16x16x32_bf16 a[144:147], v[36:39], v[88:91], a[144:147]
  v_mfma_f32_16x16x32_bf16 a[208:211], v[32:35], v[76:79], a[208:211]
  v_mfma_f32_16x16x32_bf16 a[208:211], v[36:39], v[92:95], a[208:211]
  ds_read_b64_tr_b16 v[40:41], v6 offset:12288
  ds_read_b64_tr_b16 v[42:43], v6 offset:14336
  s_waitcnt lgkmcnt(8)
  v_mfma_f32_16x16x32_bf16 a[20:23], v[48:51], v[64:67], a[20:23]
  ds_read_b64_tr_b16 v[44:45], v6 offset:8192
  ds_read_b64_tr_b16 v[46:47], v6 offset:10240
  s_waitcnt lgkmcnt(8)
  v_mfma_f32_16x16x32_bf16 a[20:23], v[52:55], v[80:83], a[20:23]
  v_mfma_f32_16x16x32_bf16 a[84:87], v[48:51], v[68:71], a[84:87]
  v_mfma_f32_16x16x32_bf16 a[84:87], v[52:55], v[84:87], a[84:87]
  v_mfma_f32_16x16x32_bf16 a[148:151], v[48:51], v[72:75], a[148:151]
  v_mfma_f32_16x16x32_bf16 a[148:151], v[52:55], v[88:91], a[148:151]
  v_mfma_f32_16x16x32_bf16 a[212:215], v[48:51], v[76:79], a[212:215]
  v_mfma_f32_16x16x32_bf16 a[212:215], v[52:55], v[92:95], a[212:215]
  ds_read_b64_tr_b16 v[24:25], v3 offset:20480
  ds_read_b64_tr_b16 v[26:27], v3 offset:22528
  s_waitcnt lgkmcnt(8)
  v_mfma_f32_16x16x32_bf16 a[24:27], v[56:59], v[64:67], a[24:27]
  ds_read_b64_tr_b16 v[28:29], v3 offset:16384
  ds_read_b64_tr_b16 v[30:31], v3 offset:18432
  s_waitcnt lgkmcnt(8)
  v_mfma_f32_16x16x32_bf16 a[24:27], v[60:63], v[80:83], a[24:27]
  v_mfma_f32_16x16x32_bf16 a[88:91], v[56:59], v[68:71], a[88:91]
  v_mfma_f32_16x16x32_bf16 a[88:91], v[60:63], v[84:87], a[88:91]
  v_mfma_f32_16x16x32_bf16 a[152:155], v[56:59], v[72:75], a[152:155]
  v_mfma_f32_16x16x32_bf16 a[152:155], v[60:63], v[88:91], a[152:155]
  v_mfma_f32_16x16x32_bf16 a[216:219], v[56:59], v[76:79], a[216:219]
  v_mfma_f32_16x16x32_bf16 a[216:219], v[60:63], v[92:95], a[216:219]
  ds_read_b64_tr_b16 v[48:49], v4 offset:20480
  ds_read_b64_tr_b16 v[50:51], v4 offset:22528
  s_waitcnt lgkmcnt(8)
  v_mfma_f32_16x16x32_bf16 a[28:31], v[40:43], v[64:67], a[28:31]
  ds_read_b64_tr_b16 v[52:53], v4 offset:16384
  ds_read_b64_tr_b16 v[54:55], v4 offset:18432
  s_waitcnt lgkmcnt(8)
  v_mfma_f32_16x16x32_bf16 a[28:31], v[44:47], v[80:83], a[28:31]
  v_mfma_f32_16x16x32_bf16 a[92:95], v[40:43], v[68:71], a[92:95]
  v_mfma_f32_16x16x32_bf16 a[92:95], v[44:47], v[84:87], a[92:95]
  v_mfma_f32_16x16x32_bf16 a[156:159], v[40:43], v[72:75], a[156:159]
  v_mfma_f32_16x16x32_bf16 a[156:159], v[44:47], v[88:91], a[156:159]
  v_mfma_f32_16x16x32_bf16 a[220:223], v[40:43], v[76:79], a[220:223]
  v_mfma_f32_16x16x32_bf16 a[220:223], v[44:47], v[92:95], a[220:223]
  ds_read_b64_tr_b16 v[56:57], v5 offset:20480
  ds_read_b64_tr_b16 v[58:59], v5 offset:22528
  s_waitcnt lgkmcnt(8)
  v_mfma_f32_16x16x32_bf16 a[32:35], v[24:27], v[64:67], a[32:35]
  ds_read_b64_tr_b16 v[60:61], v5 offset:16384
  ds_read_b64_tr_b16 v[62:63], v5 offset:18432
  s_waitcnt lgkmcnt(8)
  v_mfma_f32_16x16x32_bf16 a[32:35], v[28:31], v[80:83], a[32:35]
  v_mfma_f32_16x16x32_bf16 a[96:99], v[24:27], v[68:71], a[96:99]
  v_mfma_f32_16x16x32_bf16 a[96:99], v[28:31], v[84:87], a[96:99]
  v_mfma_f32_16x16x32_bf16 a[160:163], v[24:27], v[72:75], a[160:163]
  v_mfma_f32_16x16x32_bf16 a[160:163], v[28:31], v[88:91], a[160:163]
  v_mfma_f32_16x16x32_bf16 a[224:227], v[24:27], v[76:79], a[224:227]
  v_mfma_f32_16x16x32_bf16 a[224:227], v[28:31], v[92:95], a[224:227]
  v_mfma_f32_16x16x32_bf16 v[96:99], v[24:27], v[16:19], v[96:99]
  v_mfma_f32_16x16x32_bf16 v[96:99], v[28:31], v[20:23], v[96:99]
  ds_read_b64_tr_b16 v[32:33], v6 offset:20480
  ds_read_b64_tr_b16 v[34:35], v6 offset:22528
  s_waitcnt lgkmcnt(8)
  v_mfma_f32_16x16x32_bf16 a[36:39], v[48:51], v[64:67], a[36:39]
  ds_read_b64_tr_b16 v[36:37], v6 offset:16384
  ds_read_b64_tr_b16 v[38:39], v6 offset:18432
  s_waitcnt lgkmcnt(8)
  v_mfma_f32_16x16x32_bf16 a[36:39], v[52:55], v[80:83], a[36:39]
  v_mfma_f32_16x16x32_bf16 a[100:103], v[48:51], v[68:71], a[100:103]
  v_mfma_f32_16x16x32_bf16 a[100:103], v[52:55], v[84:87], a[100:103]
  v_mfma_f32_16x16x32_bf16 a[164:167], v[48:51], v[72:75], a[164:167]
  v_mfma_f32_16x16x32_bf16 a[164:167], v[52:55], v[88:91], a[164:167]
  v_mfma_f32_16x16x32_bf16 a[228:231], v[48:51], v[76:79], a[228:231]
  v_mfma_f32_16x16x32_bf16 a[228:231], v[52:55], v[92:95], a[228:231]
  v_mfma_f32_16x16x32_bf16 v[100:103], v[48:51], v[16:19], v[100:103]
  v_mfma_f32_16x16x32_bf16 v[100:103], v[52:55], v[20:23], v[100:103]
  ds_read_b64_tr_b16 v[40:41], v3 offset:28672
  ds_read_b64_tr_b16 v[42:43], v3 offset:30720
  s_waitcnt lgkmcnt(8)
  v_mfma_f32_16x16x32_bf16 a[40:43], v[56:59], v[64:67], a[40:43]
  ds_read_b64_tr_b16 v[44:45], v3 offset:24576
  ds_read_b64_tr_b16 v[46:47], v3 offset:26624
  s_waitcnt lgkmcnt(8)
  v_mfma_f32_16x16x32_bf16 a[40:43], v[60:63], v[80:83], a[40:43]
  v_mfma_f32_16x16x32_bf16 a[104:107], v[56:59], v[68:71], a[104:107]
  v_mfma_f32_16x16x32_bf16 a[104:107], v[60:63], v[84:87], a[104:107]
  v_mfma_f32_16x16x32_bf16 a[168:171], v[56:59], v[72:75], a[168:171]
  v_mfma_f32_16x16x32_bf16 a[168:171], v[60:63], v[88:91], a[168:171]
  v_mfma_f32_16x16x32_bf16 a[232:235], v[56:59], v[76:79], a[232:235]
  v_mfma_f32_16x16x32_bf16 a[232:235], v[60:63], v[92:95], a[232:235]
  v_mfma_f32_16x16x32_bf16 v[104:107], v[56:59], v[16:19], v[104:107]
  v_mfma_f32_16x16x32_bf16 v[104:107], v[60:63], v[20:23], v[104:107]
  ds_read_b64_tr_b16 v[48:49], v4 offset:28672
  ds_read_b64_tr_b16 v[50:51], v4 offset:30720
  s_waitcnt lgkmcnt(8)
  v_mfma_f32_16x16x32_bf16 a[44:47], v[32:35], v[64:67], a[44:47]
  s_waitcnt vmcnt(8)
  s_barrier
  ds_read_b64_tr_b16 v[52:53], v4 offset:24576
  s_waitcnt lgkmcnt(7)
  v_mfma_f32_16x16x32_bf16 a[44:47], v[36:39], v[80:83], a[44:47]
  s_add_u32 m0, s32, 0
  s_add_u32 s34, s30, 0
  buffer_load_dwordx4 v7, s[8:11], s34 offen nt lds
  v_mfma_f32_16x16x32_bf16 a[108:111], v[32:35], v[68:71], a[108:111]
  ds_read_b64_tr_b16 v[54:55], v4 offset:26624
  v_mfma_f32_16x16x32_bf16 a[108:111], v[36:39], v[84:87], a[108:111]
  v_mfma_f32_16x16x32_bf16 a[172:175], v[32:35], v[72:75], a[172:175]
  v_mfma_f32_16x16x32_bf16 a[172:175], v[36:39], v[88:91], a[172:175]
  v_mfma_f32_16x16x32_bf16 a[236:239], v[32:35], v[76:79], a[236:239]
  v_mfma_f32_16x16x32_bf16 a[236:239], v[36:39], v[92:95], a[236:239]
  s_add_u32 m0, s32, 1024
  s_add_u32 s34, s30, 4096
  buffer_load_dwordx4 v7, s[8:11], s34 offen nt lds
  v_mfma_f32_16x16x32_bf16 v[108:111], v[32:35], v[16:19], v[108:111]
  v_mfma_f32_16x16x32_bf16 v[108:111], v[36:39], v[20:23], v[108:111]
  ds_read_b64_tr_b16 v[56:57], v5 offset:28672
  ds_read_b64_tr_b16 v[58:59], v5 offset:30720
  s_waitcnt lgkmcnt(8)
  v_mfma_f32_16x16x32_bf16 a[48:51], v[40:43], v[64:67], a[48:51]
  ds_read_b64_tr_b16 v[60:61], v5 offset:24576
  ds_read_b64_tr_b16 v[62:63], v5 offset:26624
  s_waitcnt lgkmcnt(8)
  v_mfma_f32_16x16x32_bf16 a[48:51], v[44:47], v[80:83], a[48:51]
  ds_read_b128 v[32:35], v1 offset:4096
  ds_read_b128 v[36:39], v2 offset:4096
  v_mfma_f32_16x16x32_bf16 a[112:115], v[40:43], v[68:71], a[112:115]
  v_mfma_f32_16x16x32_bf16 a[112:115], v[44:47], v[84:87], a[112:115]
  s_add_u32 m0, s32, 2048
  s_add_u32 s34, s30, 8192
  buffer_load_dwordx4 v7, s[8:11], s34 offen nt lds
  v_mfma_f32_16x16x32_bf16 a[176:179], v[40:43], v[72:75], a[176:179]
  v_mfma_f32_16x16x32_bf16 a[176:179], v[44:47], v[88:91], a[176:179]
  v_mfma_f32_16x16x32_bf16 a[240:243], v[40:43], v[76:79], a[240:243]
  v_mfma_f32_16x16x32_bf16 a[240:243], v[44:47], v[92:95], a[240:243]
  v_mfma_f32_16x16x32_bf16 v[112:115], v[40:43], v[16:19], v[112:115]
  v_mfma_f32_16x16x32_bf16 v[112:115], v[44:47], v[20:23], v[112:115]
  s_add_u32 m0, s32, 3072
  s_add_u32 s34, s30, 12288
  buffer_load_dwordx4 v7, s[8:11], s34 offen nt lds
  s_waitcnt lgkmcnt(8)
  v_mfma_f32_16x16x32_bf16 a[52:55], v[48:51], v[64:67], a[52:55]
  ds_read_b64_tr_b16 v[24:25], v6 offset:28672
  ds_read_b64_tr_b16 v[26:27], v6 offset:30720
  s_waitcnt lgkmcnt(8)
  v_mfma_f32_16x16x32_bf16 a[52:55], v[52:55], v[80:83], a[52:55]
  ds_read_b64_tr_b16 v[28:29], v6 offset:24576
  ds_read_b64_tr_b16 v[30:31], v6 offset:26624
  v_mfma_f32_16x16x32_bf16 a[116:119], v[48:51], v[68:71], a[116:119]
  ds_read_b128 v[40:43], v1 offset:12288
  ds_read_b128 v[44:47], v2 offset:12288
  v_mfma_f32_16x16x32_bf16 a[116:119], v[52:55], v[84:87], a[116:119]
  v_mfma_f32_16x16x32_bf16 a[180:183], v[48:51], v[72:75], a[180:183]
  v_mfma_f32_16x16x32_bf16 a[180:183], v[52:55], v[88:91], a[180:183]
  s_add_u32 m0, s32, 4096
  s_add_u32 s34, s30, 16384
  buffer_load_dwordx4 v7, s[8:11], s34 offen nt lds
  v_mfma_f32_16x16x32_bf16 a[244:247], v[48:51], v[76:79], a[244:247]
  v_mfma_f32_16x16x32_bf16 a[244:247], v[52:55], v[92:95], a[244:247]
  v_mfma_f32_16x16x32_bf16 v[116:119], v[48:51], v[16:19], v[116:119]
  v_mfma_f32_16x16x32_bf16 v[116:119], v[52:55], v[20:23], v[116:119]
  ds_read_b128 v[48:51], v1 offset:20480
  ds_read_b128 v[52:55], v2 offset:20480
  s_waitcnt lgkmcnt(12)
  v_mfma_f32_16x16x32_bf16 a[56:59], v[56:59], v[64:67], a[56:59]
  s_waitcnt lgkmcnt(10)
  v_mfma_f32_16x16x32_bf16 a[56:59], v[60:63], v[80:83], a[56:59]
  s_add_u32 m0, s32, 5120
  s_add_u32 s34, s30, 20480
  buffer_load_dwordx4 v7, s[8:11], s34 offen nt lds
  v_mfma_f32_16x16x32_bf16 a[120:123], v[56:59], v[68:71], a[120:123]
  v_mfma_f32_16x16x32_bf16 a[120:123], v[60:63], v[84:87], a[120:123]
  v_mfma_f32_16x16x32_bf16 a[184:187], v[56:59], v[72:75], a[184:187]
  v_mfma_f32_16x16x32_bf16 a[184:187], v[60:63], v[88:91], a[184:187]
  v_mfma_f32_16x16x32_bf16 a[248:251], v[56:59], v[76:79], a[248:251]
  v_mfma_f32_16x16x32_bf16 a[248:251], v[60:63], v[92:95], a[248:251]
  s_add_u32 m0, s32, 6144
  s_add_u32 s34, s30, 24576
  buffer_load_dwordx4 v7, s[8:11], s34 offen nt lds
  v_mfma_f32_16x16x32_bf16 v[120:123], v[56:59], v[16:19], v[120:123]
  v_mfma_f32_16x16x32_bf16 v[120:123], v[60:63], v[20:23], v[120:123]
  ds_read_b128 v[56:59], v1 offset:28672
  ds_read_b128 v[60:63], v2 offset:28672
  s_waitcnt lgkmcnt(8)
  v_mfma_f32_16x16x32_bf16 a[60:63], v[24:27], v[64:67], a[60:63]
  s_waitcnt lgkmcnt(6)
  v_mfma_f32_16x16x32_bf16 a[60:63], v[28:31], v[80:83], a[60:63]
  v_mfma_f32_16x16x32_bf16 a[124:127], v[24:27], v[68:71], a[124:127]
  v_mfma_f32_16x16x32_bf16 a[124:127], v[28:31], v[84:87], a[124:127]
  s_add_u32 m0, s32, 7168
  s_add_u32 s34, s30, 28672
  buffer_load_dwordx4 v7, s[8:11], s34 offen nt lds
  s_add_u32 s30, s30, 32768
  s_xor_b32 s32, s32, 65536
  v_mfma_f32_16x16x32_bf16 a[188:191], v[24:27], v[72:75], a[188:191]
  v_mfma_f32_16x16x32_bf16 a[188:191], v[28:31], v[88:91], a[188:191]
  v_mfma_f32_16x16x32_bf16 a[252:255], v[24:27], v[76:79], a[252:255]
  v_mfma_f32_16x16x32_bf16 a[252:255], v[28:31], v[92:95], a[252:255]
  v_mfma_f32_16x16x32_bf16 v[124:127], v[24:27], v[16:19], v[124:127]
  v_mfma_f32_16x16x32_bf16 v[124:127], v[28:31], v[20:23], v[124:127]
  s_sub_u32 s29, s29, 1
  s_cmp_lg_u32 s29, 0
  s_cbranch_scc1 K1_SLOOP_P1
  s_waitcnt vmcnt(0)
  s_waitcnt lgkmcnt(0)
  s_nop 7
  v_mov_b32 v15, v10
  s_nop 1
  v_permlane32_swap_b32 v10, v15
  v_add_f32 v10, v10, v15
  v_mov_b32 v15, v10
  s_nop 1
  v_permlane16_swap_b32 v10, v15
  v_add_f32 v10, v10, v15
  v_mov_b32 v15, v11
  s_nop 1
  v_permlane32_swap_b32 v11, v15
  v_add_f32 v11, v11, v15
  v_mov_b32 v15, v11
  s_nop 1
  v_permlane16_swap_b32 v11, v15
  v_add_f32 v11, v11, v15
  v_mov_b32 v15, v12
  s_nop 1
  v_permlane32_swap_b32 v12, v15
  v_add_f32 v12, v12, v15
  v_mov_b32 v15, v12
  s_nop 1
  v_permlane16_swap_b32 v12, v15
  v_add_f32 v12, v12, v15
  v_mov_b32 v15, v13
  s_nop 1
  v_permlane32_swap_b32 v13, v15
  v_add_f32 v13, v13, v15
  v_mov_b32 v15, v13
  s_nop 1
  v_permlane16_swap_b32 v13, v15
  v_add_f32 v13, v13, v15
  v_mov_b32 v15, v14
  s_nop 1
  v_permlane32_swap_b32 v14, v15
  v_add_f32 v14, v14, v15
  v_mov_b32 v15, v14
  s_nop 1
  v_permlane16_swap_b32 v14, v15
  v_add_f32 v14, v14, v15
  ds_write_b32 v9, v14 offset:10244
  s_waitcnt lgkmcnt(0)
  s_barrier
  ds_read_b32 v15, v9 offset:10240
  s_waitcnt lgkmcnt(0)
  v_add_f32 v14, v14, v15
  v_rcp_f32 v10, v10
  v_rcp_f32 v11, v11
  v_rcp_f32 v12, v12
  v_rcp_f32 v13, v13
  v_rcp_f32 v14, v14
  v_mbcnt_lo_u32_b32 v16, -1, 0
  v_mbcnt_hi_u32_b32 v16, -1, v16
  v_and_b32 v17, 15, v16
  v_lshrrev_b32 v18, 4, v16
  v_bfe_u32 v19, v16, 2, 2
  v_and_b32 v20, 3, v16
  v_lshrrev_b32 v21, 3, v16
  v_and_b32 v22, 7, v16
  v_and_b32 v23, 1, v18
  v_lshlrev_b32 v23, 1, v23
  v_lshrrev_b32 v24, 1, v18
  v_or_b32 v23, v23, v24
  v_lshlrev_b32 v23, 4, v23
  v_add_u32 v23, v23, v17
  v_lshlrev_b32 v1, 4, v23
  v_accvgpr_read_b32 v64, a0
  v_accvgpr_read_b32 v65, a1
  v_accvgpr_read_b32 v66, a2
  v_accvgpr_read_b32 v67, a3
  v_accvgpr_read_b32 v68, a4
  v_accvgpr_read_b32 v69, a5
  v_accvgpr_read_b32 v70, a6
  v_accvgpr_read_b32 v71, a7
  v_mul_f32 v64, v10, v64
  v_mul_f32 v65, v10, v65
  v_mul_f32 v66, v10, v66
  v_mul_f32 v67, v10, v67
  v_mul_f32 v68, v10, v68
  v_mul_f32 v69, v10, v69
  v_mul_f32 v70, v10, v70
  v_mul_f32 v71, v10, v71
  v_cvt_pk_bf16_f32 v32, v64, v65
  v_cvt_pk_bf16_f32 v33, v66, v67
  v_cvt_pk_bf16_f32 v34, v68, v69
  v_cvt_pk_bf16_f32 v35, v70, v71
  s_nop 0
  v_permlane16_swap_b32 v32, v34
  v_permlane16_swap_b32 v33, v35
  s_add_u32 s34, s41, 0
  buffer_store_dwordx4 v[32:35], v1, s[24:27], s34 offen offset:0 sc1
  v_accvgpr_read_b32 v72, a8
  v_accvgpr_read_b32 v73, a9
  v_accvgpr_read_b32 v74, a10
  v_accvgpr_read_b32 v75, a11
  v_accvgpr_read_b32 v76, a12
  v_accvgpr_read_b32 v77, a13
  v_accvgpr_read_b32 v78, a14
  v_accvgpr_read_b32 v79, a15
  v_mul_f32 v72, v10, v72
  v_mul_f32 v73, v10, v73
  v_mul_f32 v74, v10, v74
  v_mul_f32 v75, v10, v75
  v_mul_f32 v76, v10, v76
  v_mul_f32 v77, v10, v77
  v_mul_f32 v78, v10, v78
  v_mul_f32 v79, v10, v79
  v_cvt_pk_bf16_f32 v36, v72, v73
  v_cvt_pk_bf16_f32 v37, v74, v75
  v_cvt_pk_bf16_f32 v38, v76, v77
  v_cvt_pk_bf16_f32 v39, v78, v79
  s_nop 0
  v_permlane16_swap_b32 v36, v38
  v_permlane16_swap_b32 v37, v39
  s_add_u32 s34, s41, 0
  buffer_store_dwordx4 v[36:39], v1, s[24:27], s34 offen offset:1024 sc1
  v_accvgpr_read_b32 v80, a16
  v_accvgpr_read_b32 v81, a17
  v_accvgpr_read_b32 v82, a18
  v_accvgpr_read_b32 v83, a19
  v_accvgpr_read_b32 v84, a20
  v_accvgpr_read_b32 v85, a21
  v_accvgpr_read_b32 v86, a22
  v_accvgpr_read_b32 v87, a23
  v_mul_f32 v80, v10, v80
  v_mul_f32 v81, v10, v81
  v_mul_f32 v82, v10, v82
  v_mul_f32 v83, v10, v83
  v_mul_f32 v84, v10, v84
  v_mul_f32 v85, v10, v85
  v_mul_f32 v86, v10, v86
  v_mul_f32 v87, v10, v87
  v_cvt_pk_bf16_f32 v40, v80, v81
  v_cvt_pk_bf16_f32 v41, v82, v83
  v_cvt_pk_bf16_f32 v42, v84, v85
  v_cvt_pk_bf16_f32 v43, v86, v87
  s_nop 0
  v_permlane16_swap_b32 v40, v42
  v_permlane16_swap_b32 v41, v43
  s_add_u32 s34, s41, 0
  buffer_store_dwordx4 v[40:43], v1, s[24:27], s34 offen offset:2048 sc1
  v_accvgpr_read_b32 v88, a24
  v_accvgpr_read_b32 v89, a25
  v_accvgpr_read_b32 v90, a26
  v_accvgpr_read_b32 v91, a27
  v_accvgpr_read_b32 v92, a28
  v_accvgpr_read_b32 v93, a29
  v_accvgpr_read_b32 v94, a30
  v_accvgpr_read_b32 v95, a31
  v_mul_f32 v88, v10, v88
  v_mul_f32 v89, v10, v89
  v_mul_f32 v90, v10, v90
  v_mul_f32 v91, v10, v91
  v_mul_f32 v92, v10, v92
  v_mul_f32 v93, v10, v93
  v_mul_f32 v94, v10, v94
  v_mul_f32 v95, v10, v95
  v_cvt_pk_bf16_f32 v44, v88, v89
  v_cvt_pk_bf16_f32 v45, v90, v91
  v_cvt_pk_bf16_f32 v46, v92, v93
  v_cvt_pk_bf16_f32 v47, v94, v95
  s_nop 0
  v_permlane16_swap_b32 v44, v46
  v_permlane16_swap_b32 v45, v47
  s_add_u32 s34, s41, 0
  buffer_store_dwordx4 v[44:47], v1, s[24:27], s34 offen offset:3072 sc1
  v_accvgpr_read_b32 v64, a32
  v_accvgpr_read_b32 v65, a33
  v_accvgpr_read_b32 v66, a34
  v_accvgpr_read_b32 v67, a35
  v_accvgpr_read_b32 v68, a36
  v_accvgpr_read_b32 v69, a37
  v_accvgpr_read_b32 v70, a38
  v_accvgpr_read_b32 v71, a39
  v_mul_f32 v64, v10, v64
  v_mul_f32 v65, v10, v65
  v_mul_f32 v66, v10, v66
  v_mul_f32 v67, v10, v67
  v_mul_f32 v68, v10, v68
  v_mul_f32 v69, v10, v69
  v_mul_f32 v70, v10, v70
  v_mul_f32 v71, v10, v71
  v_cvt_pk_bf16_f32 v48, v64, v65
  v_cvt_pk_bf16_f32 v49, v66, v67
  v_cvt_pk_bf16_f32 v50, v68, v69
  v_cvt_pk_bf16_f32 v51, v70, v71
  s_nop 0
  v_permlane16_swap_b32 v48, v50
  v_permlane16_swap_b32 v49, v51
  s_add_u32 s34, s41, 32768
  buffer_store_dwordx4 v[48:51], v1, s[24:27], s34 offen offset:0 sc1
  v_accvgpr_read_b32 v72, a40
  v_accvgpr_read_b32 v73, a41
  v_accvgpr_read_b32 v74, a42
  v_accvgpr_read_b32 v75, a43
  v_accvgpr_read_b32 v76, a44
  v_accvgpr_read_b32 v77, a45
  v_accvgpr_read_b32 v78, a46
  v_accvgpr_read_b32 v79, a47
  v_mul_f32 v72, v10, v72
  v_mul_f32 v73, v10, v73
  v_mul_f32 v74, v10, v74
  v_mul_f32 v75, v10, v75
  v_mul_f32 v76, v10, v76
  v_mul_f32 v77, v10, v77
  v_mul_f32 v78, v10, v78
  v_mul_f32 v79, v10, v79
  v_cvt_pk_bf16_f32 v52, v72, v73
  v_cvt_pk_bf16_f32 v53, v74, v75
  v_cvt_pk_bf16_f32 v54, v76, v77
  v_cvt_pk_bf16_f32 v55, v78, v79
  s_nop 0
  v_permlane16_swap_b32 v52, v54
  v_permlane16_swap_b32 v53, v55
  s_add_u32 s34, s41, 32768
  buffer_store_dwordx4 v[52:55], v1, s[24:27], s34 offen offset:1024 sc1
  v_accvgpr_read_b32 v80, a48
  v_accvgpr_read_b32 v81, a49
  v_accvgpr_read_b32 v82, a50
  v_accvgpr_read_b32 v83, a51
  v_accvgpr_read_b32 v84, a52
  v_accvgpr_read_b32 v85, a53
  v_accvgpr_read_b32 v86, a54
  v_accvgpr_read_b32 v87, a55
  v_mul_f32 v80, v10, v80
  v_mul_f32 v81, v10, v81
  v_mul_f32 v82, v10, v82
  v_mul_f32 v83, v10, v83
  v_mul_f32 v84, v10, v84
  v_mul_f32 v85, v10, v85
  v_mul_f32 v86, v10, v86
  v_mul_f32 v87, v10, v87
  v_cvt_pk_bf16_f32 v56, v80, v81
  v_cvt_pk_bf16_f32 v57, v82, v83
  v_cvt_pk_bf16_f32 v58, v84, v85
  v_cvt_pk_bf16_f32 v59, v86, v87
  s_nop 0
  v_permlane16_swap_b32 v56, v58
  v_permlane16_swap_b32 v57, v59
  s_add_u32 s34, s41, 32768
  buffer_store_dwordx4 v[56:59], v1, s[24:27], s34 offen offset:2048 sc1
  v_accvgpr_read_b32 v88, a56
  v_accvgpr_read_b32 v89, a57
  v_accvgpr_read_b32 v90, a58
  v_accvgpr_read_b32 v91, a59
  v_accvgpr_read_b32 v92, a60
  v_accvgpr_read_b32 v93, a61
  v_accvgpr_read_b32 v94, a62
  v_accvgpr_read_b32 v95, a63
  v_mul_f32 v88, v10, v88
  v_mul_f32 v89, v10, v89
  v_mul_f32 v90, v10, v90
  v_mul_f32 v91, v10, v91
  v_mul_f32 v92, v10, v92
  v_mul_f32 v93, v10, v93
  v_mul_f32 v94, v10, v94
  v_mul_f32 v95, v10, v95
  v_cvt_pk_bf16_f32 v60, v88, v89
  v_cvt_pk_bf16_f32 v61, v90, v91
  v_cvt_pk_bf16_f32 v62, v92, v93
  v_cvt_pk_bf16_f32 v63, v94, v95
  s_nop 0
  v_permlane16_swap_b32 v60, v62
  v_permlane16_swap_b32 v61, v63
  s_add_u32 s34, s41, 32768
  buffer_store_dwordx4 v[60:63], v1, s[24:27], s34 offen offset:3072 sc1
  v_accvgpr_read_b32 v64, a64
  v_accvgpr_read_b32 v65, a65
  v_accvgpr_read_b32 v66, a66
  v_accvgpr_read_b32 v67, a67
  v_accvgpr_read_b32 v68, a68
  v_accvgpr_read_b32 v69, a69
  v_accvgpr_read_b32 v70, a70
  v_accvgpr_read_b32 v71, a71
  v_mul_f32 v64, v11, v64
  v_mul_f32 v65, v11, v65
  v_mul_f32 v66, v11, v66
  v_mul_f32 v67, v11, v67
  v_mul_f32 v68, v11, v68
  v_mul_f32 v69, v11, v69
  v_mul_f32 v70, v11, v70
  v_mul_f32 v71, v11, v71
  v_cvt_pk_bf16_f32 v32, v64, v65
  v_cvt_pk_bf16_f32 v33, v66, v67
  v_cvt_pk_bf16_f32 v34, v68, v69
  v_cvt_pk_bf16_f32 v35, v70, v71
  s_nop 0
  v_permlane16_swap_b32 v32, v34
  v_permlane16_swap_b32 v33, v35
  s_add_u32 s34, s42, 0
  buffer_store_dwordx4 v[32:35], v1, s[24:27], s34 offen offset:0 sc1
  v_accvgpr_read_b32 v72, a72
  v_accvgpr_read_b32 v73, a73
  v_accvgpr_read_b32 v74, a74
  v_accvgpr_read_b32 v75, a75
  v_accvgpr_read_b32 v76, a76
  v_accvgpr_read_b32 v77, a77
  v_accvgpr_read_b32 v78, a78
  v_accvgpr_read_b32 v79, a79
  v_mul_f32 v72, v11, v72
  v_mul_f32 v73, v11, v73
  v_mul_f32 v74, v11, v74
  v_mul_f32 v75, v11, v75
  v_mul_f32 v76, v11, v76
  v_mul_f32 v77, v11, v77
  v_mul_f32 v78, v11, v78
  v_mul_f32 v79, v11, v79
  v_cvt_pk_bf16_f32 v36, v72, v73
  v_cvt_pk_bf16_f32 v37, v74, v75
  v_cvt_pk_bf16_f32 v38, v76, v77
  v_cvt_pk_bf16_f32 v39, v78, v79
  s_nop 0
  v_permlane16_swap_b32 v36, v38
  v_permlane16_swap_b32 v37, v39
  s_add_u32 s34, s42, 0
  buffer_store_dwordx4 v[36:39], v1, s[24:27], s34 offen offset:1024 sc1
  v_accvgpr_read_b32 v80, a80
  v_accvgpr_read_b32 v81, a81
  v_accvgpr_read_b32 v82, a82
  v_accvgpr_read_b32 v83, a83
  v_accvgpr_read_b32 v84, a84
  v_accvgpr_read_b32 v85, a85
  v_accvgpr_read_b32 v86, a86
  v_accvgpr_read_b32 v87, a87
  v_mul_f32 v80, v11, v80
  v_mul_f32 v81, v11, v81
  v_mul_f32 v82, v11, v82
  v_mul_f32 v83, v11, v83
  v_mul_f32 v84, v11, v84
  v_mul_f32 v85, v11, v85
  v_mul_f32 v86, v11, v86
  v_mul_f32 v87, v11, v87
  v_cvt_pk_bf16_f32 v40, v80, v81
  v_cvt_pk_bf16_f32 v41, v82, v83
  v_cvt_pk_bf16_f32 v42, v84, v85
  v_cvt_pk_bf16_f32 v43, v86, v87
  s_nop 0
  v_permlane16_swap_b32 v40, v42
  v_permlane16_swap_b32 v41, v43
  s_add_u32 s34, s42, 0
  buffer_store_dwordx4 v[40:43], v1, s[24:27], s34 offen offset:2048 sc1
  v_accvgpr_read_b32 v88, a88
  v_accvgpr_read_b32 v89, a89
  v_accvgpr_read_b32 v90, a90
  v_accvgpr_read_b32 v91, a91
  v_accvgpr_read_b32 v92, a92
  v_accvgpr_read_b32 v93, a93
  v_accvgpr_read_b32 v94, a94
  v_accvgpr_read_b32 v95, a95
  v_mul_f32 v88, v11, v88
  v_mul_f32 v89, v11, v89
  v_mul_f32 v90, v11, v90
  v_mul_f32 v91, v11, v91
  v_mul_f32 v92, v11, v92
  v_mul_f32 v93, v11, v93
  v_mul_f32 v94, v11, v94
  v_mul_f32 v95, v11, v95
  v_cvt_pk_bf16_f32 v44, v88, v89
  v_cvt_pk_bf16_f32 v45, v90, v91
  v_cvt_pk_bf16_f32 v46, v92, v93
  v_cvt_pk_bf16_f32 v47, v94, v95
  s_nop 0
  v_permlane16_swap_b32 v44, v46
  v_permlane16_swap_b32 v45, v47
  s_add_u32 s34, s42, 0
  buffer_store_dwordx4 v[44:47], v1, s[24:27], s34 offen offset:3072 sc1
  v_accvgpr_read_b32 v64, a96
  v_accvgpr_read_b32 v65, a97
  v_accvgpr_read_b32 v66, a98
  v_accvgpr_read_b32 v67, a99
  v_accvgpr_read_b32 v68, a100
  v_accvgpr_read_b32 v69, a101
  v_accvgpr_read_b32 v70, a102
  v_accvgpr_read_b32 v71, a103
  v_mul_f32 v64, v11, v64
  v_mul_f32 v65, v11, v65
  v_mul_f32 v66, v11, v66
  v_mul_f32 v67, v11, v67
  v_mul_f32 v68, v11, v68
  v_mul_f32 v69, v11, v69
  v_mul_f32 v70, v11, v70
  v_mul_f32 v71, v11, v71
  v_cvt_pk_bf16_f32 v48, v64, v65
  v_cvt_pk_bf16_f32 v49, v66, v67
  v_cvt_pk_bf16_f32 v50, v68, v69
  v_cvt_pk_bf16_f32 v51, v70, v71
  s_nop 0
  v_permlane16_swap_b32 v48, v50
  v_permlane16_swap_b32 v49, v51
  s_add_u32 s34, s42, 32768
  buffer_store_dwordx4 v[48:51], v1, s[24:27], s34 offen offset:0 sc1
  v_accvgpr_read_b32 v72, a104
  v_accvgpr_read_b32 v73, a105
  v_accvgpr_read_b32 v74, a106
  v_accvgpr_read_b32 v75, a107
  v_accvgpr_read_b32 v76, a108
  v_accvgpr_read_b32 v77, a109
  v_accvgpr_read_b32 v78, a110
  v_accvgpr_read_b32 v79, a111
  v_mul_f32 v72, v11, v72
  v_mul_f32 v73, v11, v73
  v_mul_f32 v74, v11, v74
  v_mul_f32 v75, v11, v75
  v_mul_f32 v76, v11, v76
  v_mul_f32 v77, v11, v77
  v_mul_f32 v78, v11, v78
  v_mul_f32 v79, v11, v79
  v_cvt_pk_bf16_f32 v52, v72, v73
  v_cvt_pk_bf16_f32 v53, v74, v75
  v_cvt_pk_bf16_f32 v54, v76, v77
  v_cvt_pk_bf16_f32 v55, v78, v79
  s_nop 0
  v_permlane16_swap_b32 v52, v54
  v_permlane16_swap_b32 v53, v55
  s_add_u32 s34, s42, 32768
  buffer_store_dwordx4 v[52:55], v1, s[24:27], s34 offen offset:1024 sc1
  v_accvgpr_read_b32 v80, a112
  v_accvgpr_read_b32 v81, a113
  v_accvgpr_read_b32 v82, a114
  v_accvgpr_read_b32 v83, a115
  v_accvgpr_read_b32 v84, a116
  v_accvgpr_read_b32 v85, a117
  v_accvgpr_read_b32 v86, a118
  v_accvgpr_read_b32 v87, a119
  v_mul_f32 v80, v11, v80
  v_mul_f32 v81, v11, v81
  v_mul_f32 v82, v11, v82
  v_mul_f32 v83, v11, v83
  v_mul_f32 v84, v11, v84
  v_mul_f32 v85, v11, v85
  v_mul_f32 v86, v11, v86
  v_mul_f32 v87, v11, v87
  v_cvt_pk_bf16_f32 v56, v80, v81
  v_cvt_pk_bf16_f32 v57, v82, v83
  v_cvt_pk_bf16_f32 v58, v84, v85
  v_cvt_pk_bf16_f32 v59, v86, v87
  s_nop 0
  v_permlane16_swap_b32 v56, v58
  v_permlane16_swap_b32 v57, v59
  s_add_u32 s34, s42, 32768
  buffer_store_dwordx4 v[56:59], v1, s[24:27], s34 offen offset:2048 sc1
  v_accvgpr_read_b32 v88, a120
  v_accvgpr_read_b32 v89, a121
  v_accvgpr_read_b32 v90, a122
  v_accvgpr_read_b32 v91, a123
  v_accvgpr_read_b32 v92, a124
  v_accvgpr_read_b32 v93, a125
  v_accvgpr_read_b32 v94, a126
  v_accvgpr_read_b32 v95, a127
  v_mul_f32 v88, v11, v88
  v_mul_f32 v89, v11, v89
  v_mul_f32 v90, v11, v90
  v_mul_f32 v91, v11, v91
  v_mul_f32 v92, v11, v92
  v_mul_f32 v93, v11, v93
  v_mul_f32 v94, v11, v94
  v_mul_f32 v95, v11, v95
  v_cvt_pk_bf16_f32 v60, v88, v89
  v_cvt_pk_bf16_f32 v61, v90, v91
  v_cvt_pk_bf16_f32 v62, v92, v93
  v_cvt_pk_bf16_f32 v63, v94, v95
  s_nop 0
  v_permlane16_swap_b32 v60, v62
  v_permlane16_swap_b32 v61, v63
  s_add_u32 s34, s42, 32768
  buffer_store_dwordx4 v[60:63], v1, s[24:27], s34 offen offset:3072 sc1
  v_accvgpr_read_b32 v64, a128
  v_accvgpr_read_b32 v65, a129
  v_accvgpr_read_b32 v66, a130
  v_accvgpr_read_b32 v67, a131
  v_accvgpr_read_b32 v68, a132
  v_accvgpr_read_b32 v69, a133
  v_accvgpr_read_b32 v70, a134
  v_accvgpr_read_b32 v71, a135
  v_mul_f32 v64, v12, v64
  v_mul_f32 v65, v12, v65
  v_mul_f32 v66, v12, v66
  v_mul_f32 v67, v12, v67
  v_mul_f32 v68, v12, v68
  v_mul_f32 v69, v12, v69
  v_mul_f32 v70, v12, v70
  v_mul_f32 v71, v12, v71
  v_cvt_pk_bf16_f32 v32, v64, v65
  v_cvt_pk_bf16_f32 v33, v66, v67
  v_cvt_pk_bf16_f32 v34, v68, v69
  v_cvt_pk_bf16_f32 v35, v70, v71
  s_nop 0
  v_permlane16_swap_b32 v32, v34
  v_permlane16_swap_b32 v33, v35
  s_add_u32 s34, s43, 0
  buffer_store_dwordx4 v[32:35], v1, s[24:27], s34 offen offset:0 sc1
  v_accvgpr_read_b32 v72, a136
  v_accvgpr_read_b32 v73, a137
  v_accvgpr_read_b32 v74, a138
  v_accvgpr_read_b32 v75, a139
  v_accvgpr_read_b32 v76, a140
  v_accvgpr_read_b32 v77, a141
  v_accvgpr_read_b32 v78, a142
  v_accvgpr_read_b32 v79, a143
  v_mul_f32 v72, v12, v72
  v_mul_f32 v73, v12, v73
  v_mul_f32 v74, v12, v74
  v_mul_f32 v75, v12, v75
  v_mul_f32 v76, v12, v76
  v_mul_f32 v77, v12, v77
  v_mul_f32 v78, v12, v78
  v_mul_f32 v79, v12, v79
  v_cvt_pk_bf16_f32 v36, v72, v73
  v_cvt_pk_bf16_f32 v37, v74, v75
  v_cvt_pk_bf16_f32 v38, v76, v77
  v_cvt_pk_bf16_f32 v39, v78, v79
  s_nop 0
  v_permlane16_swap_b32 v36, v38
  v_permlane16_swap_b32 v37, v39
  s_add_u32 s34, s43, 0
  buffer_store_dwordx4 v[36:39], v1, s[24:27], s34 offen offset:1024 sc1
  v_accvgpr_read_b32 v80, a144
  v_accvgpr_read_b32 v81, a145
  v_accvgpr_read_b32 v82, a146
  v_accvgpr_read_b32 v83, a147
  v_accvgpr_read_b32 v84, a148
  v_accvgpr_read_b32 v85, a149
  v_accvgpr_read_b32 v86, a150
  v_accvgpr_read_b32 v87, a151
  v_mul_f32 v80, v12, v80
  v_mul_f32 v81, v12, v81
  v_mul_f32 v82, v12, v82
  v_mul_f32 v83, v12, v83
  v_mul_f32 v84, v12, v84
  v_mul_f32 v85, v12, v85
  v_mul_f32 v86, v12, v86
  v_mul_f32 v87, v12, v87
  v_cvt_pk_bf16_f32 v40, v80, v81
  v_cvt_pk_bf16_f32 v41, v82, v83
  v_cvt_pk_bf16_f32 v42, v84, v85
  v_cvt_pk_bf16_f32 v43, v86, v87
  s_nop 0
  v_permlane16_swap_b32 v40, v42
  v_permlane16_swap_b32 v41, v43
  s_add_u32 s34, s43, 0
  buffer_store_dwordx4 v[40:43], v1, s[24:27], s34 offen offset:2048 sc1
  v_accvgpr_read_b32 v88, a152
  v_accvgpr_read_b32 v89, a153
  v_accvgpr_read_b32 v90, a154
  v_accvgpr_read_b32 v91, a155
  v_accvgpr_read_b32 v92, a156
  v_accvgpr_read_b32 v93, a157
  v_accvgpr_read_b32 v94, a158
  v_accvgpr_read_b32 v95, a159
  v_mul_f32 v88, v12, v88
  v_mul_f32 v89, v12, v89
  v_mul_f32 v90, v12, v90
  v_mul_f32 v91, v12, v91
  v_mul_f32 v92, v12, v92
  v_mul_f32 v93, v12, v93
  v_mul_f32 v94, v12, v94
  v_mul_f32 v95, v12, v95
  v_cvt_pk_bf16_f32 v44, v88, v89
  v_cvt_pk_bf16_f32 v45, v90, v91
  v_cvt_pk_bf16_f32 v46, v92, v93
  v_cvt_pk_bf16_f32 v47, v94, v95
  s_nop 0
  v_permlane16_swap_b32 v44, v46
  v_permlane16_swap_b32 v45, v47
  s_add_u32 s34, s43, 0
  buffer_store_dwordx4 v[44:47], v1, s[24:27], s34 offen offset:3072 sc1
  v_accvgpr_read_b32 v64, a160
  v_accvgpr_read_b32 v65, a161
  v_accvgpr_read_b32 v66, a162
  v_accvgpr_read_b32 v67, a163
  v_accvgpr_read_b32 v68, a164
  v_accvgpr_read_b32 v69, a165
  v_accvgpr_read_b32 v70, a166
  v_accvgpr_read_b32 v71, a167
  v_mul_f32 v64, v12, v64
  v_mul_f32 v65, v12, v65
  v_mul_f32 v66, v12, v66
  v_mul_f32 v67, v12, v67
  v_mul_f32 v68, v12, v68
  v_mul_f32 v69, v12, v69
  v_mul_f32 v70, v12, v70
  v_mul_f32 v71, v12, v71
  v_cvt_pk_bf16_f32 v48, v64, v65
  v_cvt_pk_bf16_f32 v49, v66, v67
  v_cvt_pk_bf16_f32 v50, v68, v69
  v_cvt_pk_bf16_f32 v51, v70, v71
  s_nop 0
  v_permlane16_swap_b32 v48, v50
  v_permlane16_swap_b32 v49, v51
  s_add_u32 s34, s43, 32768
  buffer_store_dwordx4 v[48:51], v1, s[24:27], s34 offen offset:0 sc1
  v_accvgpr_read_b32 v72, a168
  v_accvgpr_read_b32 v73, a169
  v_accvgpr_read_b32 v74, a170
  v_accvgpr_read_b32 v75, a171
  v_accvgpr_read_b32 v76, a172
  v_accvgpr_read_b32 v77, a173
  v_accvgpr_read_b32 v78, a174
  v_accvgpr_read_b32 v79, a175
  v_mul_f32 v72, v12, v72
  v_mul_f32 v73, v12, v73
  v_mul_f32 v74, v12, v74
  v_mul_f32 v75, v12, v75
  v_mul_f32 v76, v12, v76
  v_mul_f32 v77, v12, v77
  v_mul_f32 v78, v12, v78
  v_mul_f32 v79, v12, v79
  v_cvt_pk_bf16_f32 v52, v72, v73
  v_cvt_pk_bf16_f32 v53, v74, v75
  v_cvt_pk_bf16_f32 v54, v76, v77
  v_cvt_pk_bf16_f32 v55, v78, v79
  s_nop 0
  v_permlane16_swap_b32 v52, v54
  v_permlane16_swap_b32 v53, v55
  s_add_u32 s34, s43, 32768
  buffer_store_dwordx4 v[52:55], v1, s[24:27], s34 offen offset:1024 sc1
  v_accvgpr_read_b32 v80, a176
  v_accvgpr_read_b32 v81, a177
  v_accvgpr_read_b32 v82, a178
  v_accvgpr_read_b32 v83, a179
  v_accvgpr_read_b32 v84, a180
  v_accvgpr_read_b32 v85, a181
  v_accvgpr_read_b32 v86, a182
  v_accvgpr_read_b32 v87, a183
  v_mul_f32 v80, v12, v80
  v_mul_f32 v81, v12, v81
  v_mul_f32 v82, v12, v82
  v_mul_f32 v83, v12, v83
  v_mul_f32 v84, v12, v84
  v_mul_f32 v85, v12, v85
  v_mul_f32 v86, v12, v86
  v_mul_f32 v87, v12, v87
  v_cvt_pk_bf16_f32 v56, v80, v81
  v_cvt_pk_bf16_f32 v57, v82, v83
  v_cvt_pk_bf16_f32 v58, v84, v85
  v_cvt_pk_bf16_f32 v59, v86, v87
  s_nop 0
  v_permlane16_swap_b32 v56, v58
  v_permlane16_swap_b32 v57, v59
  s_add_u32 s34, s43, 32768
  buffer_store_dwordx4 v[56:59], v1, s[24:27], s34 offen offset:2048 sc1
  v_accvgpr_read_b32 v88, a184
  v_accvgpr_read_b32 v89, a185
  v_accvgpr_read_b32 v90, a186
  v_accvgpr_read_b32 v91, a187
  v_accvgpr_read_b32 v92, a188
  v_accvgpr_read_b32 v93, a189
  v_accvgpr_read_b32 v94, a190
  v_accvgpr_read_b32 v95, a191
  v_mul_f32 v88, v12, v88
  v_mul_f32 v89, v12, v89
  v_mul_f32 v90, v12, v90
  v_mul_f32 v91, v12, v91
  v_mul_f32 v92, v12, v92
  v_mul_f32 v93, v12, v93
  v_mul_f32 v94, v12, v94
  v_mul_f32 v95, v12, v95
  v_cvt_pk_bf16_f32 v60, v88, v89
  v_cvt_pk_bf16_f32 v61, v90, v91
  v_cvt_pk_bf16_f32 v62, v92, v93
  v_cvt_pk_bf16_f32 v63, v94, v95
  s_nop 0
  v_permlane16_swap_b32 v60, v62
  v_permlane16_swap_b32 v61, v63
  s_add_u32 s34, s43, 32768
  buffer_store_dwordx4 v[60:63], v1, s[24:27], s34 offen offset:3072 sc1
  v_accvgpr_read_b32 v64, a192
  v_accvgpr_read_b32 v65, a193
  v_accvgpr_read_b32 v66, a194
  v_accvgpr_read_b32 v67, a195
  v_accvgpr_read_b32 v68, a196
  v_accvgpr_read_b32 v69, a197
  v_accvgpr_read_b32 v70, a198
  v_accvgpr_read_b32 v71, a199
  v_mul_f32 v64, v13, v64
  v_mul_f32 v65, v13, v65
  v_mul_f32 v66, v13, v66
  v_mul_f32 v67, v13, v67
  v_mul_f32 v68, v13, v68
  v_mul_f32 v69, v13, v69
  v_mul_f32 v70, v13, v70
  v_mul_f32 v71, v13, v71
  v_cvt_pk_bf16_f32 v32, v64, v65
  v_cvt_pk_bf16_f32 v33, v66, v67
  v_cvt_pk_bf16_f32 v34, v68, v69
  v_cvt_pk_bf16_f32 v35, v70, v71
  s_nop 0
  v_permlane16_swap_b32 v32, v34
  v_permlane16_swap_b32 v33, v35
  s_add_u32 s34, s44, 0
  buffer_store_dwordx4 v[32:35], v1, s[24:27], s34 offen offset:0 sc1
  v_accvgpr_read_b32 v72, a200
  v_accvgpr_read_b32 v73, a201
  v_accvgpr_read_b32 v74, a202
  v_accvgpr_read_b32 v75, a203
  v_accvgpr_read_b32 v76, a204
  v_accvgpr_read_b32 v77, a205
  v_accvgpr_read_b32 v78, a206
  v_accvgpr_read_b32 v79, a207
  v_mul_f32 v72, v13, v72
  v_mul_f32 v73, v13, v73
  v_mul_f32 v74, v13, v74
  v_mul_f32 v75, v13, v75
  v_mul_f32 v76, v13, v76
  v_mul_f32 v77, v13, v77
  v_mul_f32 v78, v13, v78
  v_mul_f32 v79, v13, v79
  v_cvt_pk_bf16_f32 v36, v72, v73
  v_cvt_pk_bf16_f32 v37, v74, v75
  v_cvt_pk_bf16_f32 v38, v76, v77
  v_cvt_pk_bf16_f32 v39, v78, v79
  s_nop 0
  v_permlane16_swap_b32 v36, v38
  v_permlane16_swap_b32 v37, v39
  s_add_u32 s34, s44, 0
  buffer_store_dwordx4 v[36:39], v1, s[24:27], s34 offen offset:1024 sc1
  v_accvgpr_read_b32 v80, a208
  v_accvgpr_read_b32 v81, a209
  v_accvgpr_read_b32 v82, a210
  v_accvgpr_read_b32 v83, a211
  v_accvgpr_read_b32 v84, a212
  v_accvgpr_read_b32 v85, a213
  v_accvgpr_read_b32 v86, a214
  v_accvgpr_read_b32 v87, a215
  v_mul_f32 v80, v13, v80
  v_mul_f32 v81, v13, v81
  v_mul_f32 v82, v13, v82
  v_mul_f32 v83, v13, v83
  v_mul_f32 v84, v13, v84
  v_mul_f32 v85, v13, v85
  v_mul_f32 v86, v13, v86
  v_mul_f32 v87, v13, v87
  v_cvt_pk_bf16_f32 v40, v80, v81
  v_cvt_pk_bf16_f32 v41, v82, v83
  v_cvt_pk_bf16_f32 v42, v84, v85
  v_cvt_pk_bf16_f32 v43, v86, v87
  s_nop 0
  v_permlane16_swap_b32 v40, v42
  v_permlane16_swap_b32 v41, v43
  s_add_u32 s34, s44, 0
  buffer_store_dwordx4 v[40:43], v1, s[24:27], s34 offen offset:2048 sc1
  v_accvgpr_read_b32 v88, a216
  v_accvgpr_read_b32 v89, a217
  v_accvgpr_read_b32 v90, a218
  v_accvgpr_read_b32 v91, a219
  v_accvgpr_read_b32 v92, a220
  v_accvgpr_read_b32 v93, a221
  v_accvgpr_read_b32 v94, a222
  v_accvgpr_read_b32 v95, a223
  v_mul_f32 v88, v13, v88
  v_mul_f32 v89, v13, v89
  v_mul_f32 v90, v13, v90
  v_mul_f32 v91, v13, v91
  v_mul_f32 v92, v13, v92
  v_mul_f32 v93, v13, v93
  v_mul_f32 v94, v13, v94
  v_mul_f32 v95, v13, v95
  v_cvt_pk_bf16_f32 v44, v88, v89
  v_cvt_pk_bf16_f32 v45, v90, v91
  v_cvt_pk_bf16_f32 v46, v92, v93
  v_cvt_pk_bf16_f32 v47, v94, v95
  s_nop 0
  v_permlane16_swap_b32 v44, v46
  v_permlane16_swap_b32 v45, v47
  s_add_u32 s34, s44, 0
  buffer_store_dwordx4 v[44:47], v1, s[24:27], s34 offen offset:3072 sc1
  v_accvgpr_read_b32 v64, a224
  v_accvgpr_read_b32 v65, a225
  v_accvgpr_read_b32 v66, a226
  v_accvgpr_read_b32 v67, a227
  v_accvgpr_read_b32 v68, a228
  v_accvgpr_read_b32 v69, a229
  v_accvgpr_read_b32 v70, a230
  v_accvgpr_read_b32 v71, a231
  v_mul_f32 v64, v13, v64
  v_mul_f32 v65, v13, v65
  v_mul_f32 v66, v13, v66
  v_mul_f32 v67, v13, v67
  v_mul_f32 v68, v13, v68
  v_mul_f32 v69, v13, v69
  v_mul_f32 v70, v13, v70
  v_mul_f32 v71, v13, v71
  v_cvt_pk_bf16_f32 v48, v64, v65
  v_cvt_pk_bf16_f32 v49, v66, v67
  v_cvt_pk_bf16_f32 v50, v68, v69
  v_cvt_pk_bf16_f32 v51, v70, v71
  s_nop 0
  v_permlane16_swap_b32 v48, v50
  v_permlane16_swap_b32 v49, v51
  s_add_u32 s34, s44, 32768
  buffer_store_dwordx4 v[48:51], v1, s[24:27], s34 offen offset:0 sc1
  v_accvgpr_read_b32 v72, a232
  v_accvgpr_read_b32 v73, a233
  v_accvgpr_read_b32 v74, a234
  v_accvgpr_read_b32 v75, a235
  v_accvgpr_read_b32 v76, a236
  v_accvgpr_read_b32 v77, a237
  v_accvgpr_read_b32 v78, a238
  v_accvgpr_read_b32 v79, a239
  v_mul_f32 v72, v13, v72
  v_mul_f32 v73, v13, v73
  v_mul_f32 v74, v13, v74
  v_mul_f32 v75, v13, v75
  v_mul_f32 v76, v13, v76
  v_mul_f32 v77, v13, v77
  v_mul_f32 v78, v13, v78
  v_mul_f32 v79, v13, v79
  v_cvt_pk_bf16_f32 v52, v72, v73
  v_cvt_pk_bf16_f32 v53, v74, v75
  v_cvt_pk_bf16_f32 v54, v76, v77
  v_cvt_pk_bf16_f32 v55, v78, v79
  s_nop 0
  v_permlane16_swap_b32 v52, v54
  v_permlane16_swap_b32 v53, v55
  s_add_u32 s34, s44, 32768
  buffer_store_dwordx4 v[52:55], v1, s[24:27], s34 offen offset:1024 sc1
  v_accvgpr_read_b32 v80, a240
  v_accvgpr_read_b32 v81, a241
  v_accvgpr_read_b32 v82, a242
  v_accvgpr_read_b32 v83, a243
  v_accvgpr_read_b32 v84, a244
  v_accvgpr_read_b32 v85, a245
  v_accvgpr_read_b32 v86, a246
  v_accvgpr_read_b32 v87, a247
  v_mul_f32 v80, v13, v80
  v_mul_f32 v81, v13, v81
  v_mul_f32 v82, v13, v82
  v_mul_f32 v83, v13, v83
  v_mul_f32 v84, v13, v84
  v_mul_f32 v85, v13, v85
  v_mul_f32 v86, v13, v86
  v_mul_f32 v87, v13, v87
  v_cvt_pk_bf16_f32 v56, v80, v81
  v_cvt_pk_bf16_f32 v57, v82, v83
  v_cvt_pk_bf16_f32 v58, v84, v85
  v_cvt_pk_bf16_f32 v59, v86, v87
  s_nop 0
  v_permlane16_swap_b32 v56, v58
  v_permlane16_swap_b32 v57, v59
  s_add_u32 s34, s44, 32768
  buffer_store_dwordx4 v[56:59], v1, s[24:27], s34 offen offset:2048 sc1
  v_accvgpr_read_b32 v88, a248
  v_accvgpr_read_b32 v89, a249
  v_accvgpr_read_b32 v90, a250
  v_accvgpr_read_b32 v91, a251
  v_accvgpr_read_b32 v92, a252
  v_accvgpr_read_b32 v93, a253
  v_accvgpr_read_b32 v94, a254
  v_accvgpr_read_b32 v95, a255
  v_mul_f32 v88, v13, v88
  v_mul_f32 v89, v13, v89
  v_mul_f32 v90, v13, v90
  v_mul_f32 v91, v13, v91
  v_mul_f32 v92, v13, v92
  v_mul_f32 v93, v13, v93
  v_mul_f32 v94, v13, v94
  v_mul_f32 v95, v13, v95
  v_cvt_pk_bf16_f32 v60, v88, v89
  v_cvt_pk_bf16_f32 v61, v90, v91
  v_cvt_pk_bf16_f32 v62, v92, v93
  v_cvt_pk_bf16_f32 v63, v94, v95
  s_nop 0
  v_permlane16_swap_b32 v60, v62
  v_permlane16_swap_b32 v61, v63
  s_add_u32 s34, s44, 32768
  buffer_store_dwordx4 v[60:63], v1, s[24:27], s34 offen offset:3072 sc1
  v_mul_f32 v64, v14, v96
  v_mul_f32 v65, v14, v97
  v_mul_f32 v66, v14, v98
  v_mul_f32 v67, v14, v99
  v_mul_f32 v68, v14, v100
  v_mul_f32 v69, v14, v101
  v_mul_f32 v70, v14, v102
  v_mul_f32 v71, v14, v103
  v_cvt_pk_bf16_f32 v32, v64, v65
  v_cvt_pk_bf16_f32 v33, v66, v67
  v_cvt_pk_bf16_f32 v34, v68, v69
  v_cvt_pk_bf16_f32 v35, v70, v71
  s_nop 0
  v_permlane16_swap_b32 v32, v34
  v_permlane16_swap_b32 v33, v35
  s_add_u32 s34, s45, 32768
  buffer_store_dwordx4 v[32:35], v1, s[24:27], s34 offen offset:0 sc1
  v_mul_f32 v72, v14, v104
  v_mul_f32 v73, v14, v105
  v_mul_f32 v74, v14, v106
  v_mul_f32 v75, v14, v107
  v_mul_f32 v76, v14, v108
  v_mul_f32 v77, v14, v109
  v_mul_f32 v78, v14, v110
  v_mul_f32 v79, v14, v111
  v_cvt_pk_bf16_f32 v36, v72, v73
  v_cvt_pk_bf16_f32 v37, v74, v75
  v_cvt_pk_bf16_f32 v38, v76, v77
  v_cvt_pk_bf16_f32 v39, v78, v79
  s_nop 0
  v_permlane16_swap_b32 v36, v38
  v_permlane16_swap_b32 v37, v39
  s_add_u32 s34, s45, 32768
  buffer_store_dwordx4 v[36:39], v1, s[24:27], s34 offen offset:1024 sc1
  v_mul_f32 v80, v14, v112
  v_mul_f32 v81, v14, v113
  v_mul_f32 v82, v14, v114
  v_mul_f32 v83, v14, v115
  v_mul_f32 v84, v14, v116
  v_mul_f32 v85, v14, v117
  v_mul_f32 v86, v14, v118
  v_mul_f32 v87, v14, v119
  v_cvt_pk_bf16_f32 v40, v80, v81
  v_cvt_pk_bf16_f32 v41, v82, v83
  v_cvt_pk_bf16_f32 v42, v84, v85
  v_cvt_pk_bf16_f32 v43, v86, v87
  s_nop 0
  v_permlane16_swap_b32 v40, v42
  v_permlane16_swap_b32 v41, v43
  s_add_u32 s34, s45, 32768
  buffer_store_dwordx4 v[40:43], v1, s[24:27], s34 offen offset:2048 sc1
  v_mul_f32 v88, v14, v120
  v_mul_f32 v89, v14, v121
  v_mul_f32 v90, v14, v122
  v_mul_f32 v91, v14, v123
  v_mul_f32 v92, v14, v124
  v_mul_f32 v93, v14, v125
  v_mul_f32 v94, v14, v126
  v_mul_f32 v95, v14, v127
  v_cvt_pk_bf16_f32 v44, v88, v89
  v_cvt_pk_bf16_f32 v45, v90, v91
  v_cvt_pk_bf16_f32 v46, v92, v93
  v_cvt_pk_bf16_f32 v47, v94, v95
  s_nop 0
  v_permlane16_swap_b32 v44, v46
  v_permlane16_swap_b32 v45, v47
  s_add_u32 s34, s45, 32768
  buffer_store_dwordx4 v[44:47], v1, s[24:27], s34 offen offset:3072 sc1
  s_and_b32 s7, s2, 7
  s_lshl_b32 s7, s7, 5
  s_lshr_b32 s6, s2, 3
  s_add_u32 s7, s7, s6
  s_mul_i32 s6, s7, 9363
  s_lshr_b32 s29, s6, 16
  s_mul_i32 s5, s29, 7
  s_sub_u32 s30, s7, s5
  s_cmp_ge_u32 s29, 18
  s_cselect_b32 s31, 1, 0
  s_mul_i32 s5, s31, 18
  s_sub_u32 s32, s29, s5
  s_and_b32 s33, s2, 1
  s_lshl_b32 s33, s33, 4
  s_cmp_eq_u32 s31, 0
  s_cselect_b32 s6, s66, s68
  s_cselect_b32 s5, s67, s69
  s_lshl_b32 s7, s30, 7
  s_add_u32 s12, s6, s7
  s_addc_u32 s13, s5, 0
  s_sub_u32 s14, 3670016, s7
  s_mov_b32 s15, 0x20000
  s_mul_i32 s36, s33, 114688
  s_mul_i32 s37, s28, 28672
  s_lshl_b32 s38, s28, 12
  v_mbcnt_lo_u32_b32 v250, -1, 0
  v_mbcnt_hi_u32_b32 v250, -1, v250
  v_lshrrev_b32 v251, 3, v250
  v_and_b32 v250, 7, v250
  v_and_b32 v252, 2, v251
  v_xor_b32 v252, v252, v250
  v_lshlrev_b32 v252, 4, v252
  v_mul_u32_u24 v251, 896, v251
  v_add_u32 v251, s37, v251
  v_add_u32 v248, v251, v252
  v_xor_b32 v252, 64, v252
  v_add_u32 v249, v251, v252
  s_add_u32 m0, s38, 0
  s_add_u32 s39, s36, 0
  buffer_load_dwordx4 v248, s[12:15], s39 offen lds
  s_add_u32 m0, s38, 1024
  s_add_u32 s39, s36, 7168
  buffer_load_dwordx4 v249, s[12:15], s39 offen lds
  s_add_u32 m0, s38, 2048
  s_add_u32 s39, s36, 14336
  buffer_load_dwordx4 v248, s[12:15], s39 offen lds
  s_add_u32 m0, s38, 3072
  s_add_u32 s39, s36, 21504
  buffer_load_dwordx4 v249, s[12:15], s39 offen lds
  s_add_u32 s36, s36, 114688
  s_cmp_eq_u32 s36, 3670016
  s_cselect_b32 s36, 0, s36
  s_add_u32 s38, s38, 16384
  s_and_b32 s38, s38, 131071
  s_add_u32 m0, s38, 0
  s_add_u32 s39, s36, 0
  buffer_load_dwordx4 v248, s[12:15], s39 offen lds
  s_add_u32 m0, s38, 1024
  s_add_u32 s39, s36, 7168
  buffer_load_dwordx4 v249, s[12:15], s39 offen lds
  s_add_u32 m0, s38, 2048
  s_add_u32 s39, s36, 14336
  buffer_load_dwordx4 v248, s[12:15], s39 offen lds
  s_add_u32 m0, s38, 3072
  s_add_u32 s39, s36, 21504
  buffer_load_dwordx4 v249, s[12:15], s39 offen lds
  s_add_u32 s36, s36, 114688
  s_cmp_eq_u32 s36, 3670016
  s_cselect_b32 s36, 0, s36
  s_add_u32 s38, s38, 16384
  s_and_b32 s38, s38, 131071
  s_add_u32 m0, s38, 0
  s_add_u32 s39, s36, 0
  buffer_load_dwordx4 v248, s[12:15], s39 offen lds
  s_add_u32 m0, s38, 1024
  s_add_u32 s39, s36, 7168
  buffer_load_dwordx4 v249, s[12:15], s39 offen lds
  s_add_u32 m0, s38, 2048
  s_add_u32 s39, s36, 14336
  buffer_load_dwordx4 v248, s[12:15], s39 offen lds
  s_add_u32 m0, s38, 3072
  s_add_u32 s39, s36, 21504
  buffer_load_dwordx4 v249, s[12:15], s39 offen lds
  s_add_u32 s36, s36, 114688
  s_cmp_eq_u32 s36, 3670016
  s_cselect_b32 s36, 0, s36
  s_add_u32 s38, s38, 16384
  s_and_b32 s38, s38, 131071
  s_add_u32 m0, s38, 0
  s_add_u32 s39, s36, 0
  buffer_load_dwordx4 v248, s[12:15], s39 offen lds
  s_add_u32 m0, s38, 1024
  s_add_u32 s39, s36, 7168
  buffer_load_dwordx4 v249, s[12:15], s39 offen lds
  s_add_u32 m0, s38, 2048
  s_add_u32 s39, s36, 14336
  buffer_load_dwordx4 v248, s[12:15], s39 offen lds
  s_add_u32 m0, s38, 3072
  s_add_u32 s39, s36, 21504
  buffer_load_dwordx4 v249, s[12:15], s39 offen lds
  s_add_u32 s36, s36, 114688
  s_cmp_eq_u32 s36, 3670016
  s_cselect_b32 s36, 0, s36
  s_add_u32 s38, s38, 16384
  s_and_b32 s38, s38, 131071
  s_branch K1_END
K1_CODE_END:
  s_endpgm
.section .rodata,"a"
.p2align 6
.amdhsa_kernel attn_kernel
  .amdhsa_next_free_vgpr 512
  .amdhsa_next_free_sgpr 102
  .amdhsa_accum_offset 256
  .amdhsa_group_segment_fixed_size 0
  .amdhsa_kernarg_size 104
  .amdhsa_user_sgpr_count 2
  .amdhsa_user_sgpr_kernarg_segment_ptr 1
  .amdhsa_system_sgpr_workgroup_id_x 1
.end_amdhsa_kernel
.text
```
